```python
import torch

def _softmax(x, axis=-1):
    return torch.softmax(x, dim=axis)
def _gelu(x):
    return torch.nn.functional.gelu(x, approximate="tanh")
def _silu(x):
    return torch.nn.functional.silu(x)
def _sigmoid(x):
    return torch.sigmoid(x)
def _layernorm(x, axis=-1, eps=1e-5):
    m = x.mean(dim=axis, keepdim=True)
    v = x.var(dim=axis, keepdim=True, unbiased=False)
    return (x - m) / torch.sqrt(v + eps)
def _scatter_add(tgt, idx, src, axis=0):
    return tgt.clone().index_add_(axis, idx, src)
def _segment_sum(src, seg, n):
    out = torch.zeros((n,) + src.shape[1:], dtype=src.dtype)
    return out.index_add_(0, seg, src)
def _pad(x, pw):
    flat = tuple(v for pair in reversed(pw) for v in pair)
    return torch.nn.functional.pad(x, flat)

kernel_name = 'sequential_preLN__softmax_full_mha__glu_gated_reglu__prompt'

def setup_inputs():

    _w = (lambda a: (lambda t: t.to(torch.bfloat16) if t.is_floating_point() else t)(torch.as_tensor(a)))
    def _A_setup():
        B, S, D = 1, 2048, 512
        return {
            "x": _w((lambda *s: torch.randn(*s, dtype=torch.bfloat16) * 0.05)(B, S, D)),
            "wqkv": _w((lambda *s: torch.randn(*s, dtype=torch.bfloat16) * 0.05)(D, 3 * D)),
            "wo": _w((lambda *s: torch.randn(*s, dtype=torch.bfloat16) * 0.05)(D, D)),
        }
    _A_in = _A_setup()

    def _B_setup():
        B, S, D, F = 1, 2048, 512, 1792
        return {
            "x": _w((lambda *s: torch.randn(*s, dtype=torch.bfloat16) * 0.05)(B, S, D)),
            "W_gate": _w((lambda *s: torch.randn(*s, dtype=torch.bfloat16) * 0.4)(D, F) * (2.0 / D) ** 0.5),
            "W_up": _w((lambda *s: torch.randn(*s, dtype=torch.bfloat16) * 0.4)(D, F) * (2.0 / D) ** 0.5),
            "W_down": _w((lambda *s: torch.randn(*s, dtype=torch.bfloat16) * 0.4)(F, D) * (1.0 / F) ** 0.5),
        }
    _B_in = _B_setup()

    return {
        "A_x": _A_in["x"],
        "A_wqkv": _A_in["wqkv"],
        "A_wo": _A_in["wo"],
        "B_x": _B_in["x"],
        "B_W_gate": _B_in["W_gate"],
        "B_W_up": _B_in["W_up"],
        "B_W_down": _B_in["W_down"],
    }

def reference(A_x, A_wqkv, A_wo, B_x, B_W_gate, B_W_up, B_W_down):
    def _A_ref(x, wqkv, wo):
        B, S, D = x.shape
        H = 32; Dh = D // H
        qkv = (lambda x, *d: x.permute(*d))((x @ wqkv).reshape(B, S, 3, H, Dh), 2, 0, 3, 1, 4)
        q, k, v = qkv[0], qkv[1], qkv[2]
        scale = Dh ** -0.5
        scores = torch.einsum("bhqd,bhkd->bhqk", q, k) * scale
        p = _softmax(scores, axis=-1)
        o = torch.einsum("bhqk,bhkd->bhqd", p, v)
        return (lambda x, *d: x.permute(*d))(o, 0, 2, 1, 3).reshape(B, S, D) @ wo

    def _B_ref(x, W_gate, W_up, W_down):
        gate = torch.einsum("bsd,df->bsf", x, W_gate)
        up = torch.einsum("bsd,df->bsf", x, W_up)
        gate = gate * (lambda x, dt: x.to(dt))(gate > 0, gate.dtype)
        h = gate * up
        return torch.einsum("bsf,fd->bsd", h, W_down)

    x = A_x
    h = x + _A_ref(_layernorm(x, axis=-1), A_wqkv, A_wo)
    h2 = h + _B_ref(_layernorm(h, axis=-1), B_W_gate, B_W_up, B_W_down)
    return h2
```

```asm
; @launch kernel=k1_kernel grid=(256,1,1) block=(512,1,1) lds=143360
; @launch kernel=k2_kernel grid=(256,1,1) block=(512,1,1) lds=131072
; @launch kernel=k3_kernel grid=(256,1,1) block=(512,1,1) lds=131072
; @launch kernel=k4_kernel grid=(256,1,1) block=(512,1,1) lds=144640
; @launch kernel=k5_kernel grid=(256,1,1) block=(512,1,1) lds=147456
.amdgcn_target "amdgcn-amd-amdhsa--gfx950"
.text
.globl k1_kernel
.p2align 8
.type k1_kernel,@function
k1_kernel:
s_cmp_ge_u32 s2, 256
s_cbranch_scc1 k1_kernel_end
s_load_dwordx16 s[16:31], s[0:1], 0
s_load_dwordx4 s[32:35], s[0:1], 64
v_and_b32 v1, 63, v0
v_lshrrev_b32 v2, 6, v0
v_lshlrev_b32 v3, 4, v1
s_nop 0
v_readfirstlane_b32 s6, v2
s_and_b32 s7, s2, 7
s_lshr_b32 s8, s2, 3
s_lshr_b32 s9, s7, 1
s_lshl_b32 s9, s9, 2
s_and_b32 s10, s8, 3
s_add_u32 s4, s9, s10
s_and_b32 s9, s7, 1
s_lshl_b32 s9, s9, 3
s_lshr_b32 s10, s8, 2
s_add_u32 s5, s9, s10
s_mov_b32 s61, 0x3f803f80
s_waitcnt lgkmcnt(0)
s_mul_i32 s7, s4, 131072
s_add_u32 s40, s16, s7
s_addc_u32 s41, s17, 0
s_and_b32 s41, s41, 0xffff
s_mov_b32 s42, 131072
s_mov_b32 s43, 0x00020000
s_mul_i32 s7, s5, 192
s_add_u32 s44, s18, s7
s_addc_u32 s45, s19, 0
s_and_b32 s45, s45, 0xffff
s_mov_b32 s46, 0
s_mov_b32 s47, 0x00020000
s_sub_u32 s46, 1572864, s7
s_mov_b32 s52, s34
s_mov_b32 s53, s35
s_and_b32 s53, s53, 0xffff
s_mov_b32 s54, 33554432
s_mov_b32 s55, 0x00020000
v_and_b32 v4, 15, v1
v_lshrrev_b32 v5, 5, v1
v_bfe_u32 v6, v1, 4, 1
v_lshrrev_b32 v7, 2, v4
v_lshl_add_u32 v7, v5, 3, v7
v_and_b32 v8, 3, v4
s_cmp_eq_u32 s6, 1
s_cbranch_scc1 k1_kernel_w1
s_cmp_eq_u32 s6, 2
s_cbranch_scc1 k1_kernel_w2
s_cmp_eq_u32 s6, 3
s_cbranch_scc1 k1_kernel_w3
s_cmp_eq_u32 s6, 4
s_cbranch_scc1 k1_kernel_w4
s_cmp_eq_u32 s6, 5
s_cbranch_scc1 k1_kernel_w5
s_cmp_eq_u32 s6, 6
s_cbranch_scc1 k1_kernel_w6
s_cmp_eq_u32 s6, 7
s_cbranch_scc1 k1_kernel_w7
v_mul_u32_u24 v18, 192, v7
v_lshl_add_u32 v18, v8, 3, v18
v_mul_u32_u24 v19, 32, v6
v_add_u32 v9, v18, v19
v_and_b32 v18, 31, v1
v_bfe_u32 v19, v1, 1, 3
v_add_u32 v20, 0, v5
v_xor_b32 v19, v19, v20
v_lshlrev_b32 v19, 4, v19
v_lshl_add_u32 v14, v18, 7, v19
v_and_b32 v18, 31, v1
v_bfe_u32 v19, v1, 1, 3
v_add_u32 v20, 2, v5
v_xor_b32 v19, v19, v20
v_lshlrev_b32 v19, 4, v19
v_lshl_add_u32 v15, v18, 7, v19
v_and_b32 v18, 31, v1
v_bfe_u32 v19, v1, 1, 3
v_add_u32 v20, 4, v5
v_xor_b32 v19, v19, v20
v_lshlrev_b32 v19, 4, v19
v_lshl_add_u32 v16, v18, 7, v19
v_and_b32 v18, 31, v1
v_bfe_u32 v19, v1, 1, 3
v_add_u32 v20, 6, v5
v_xor_b32 v19, v19, v20
v_lshlrev_b32 v19, 4, v19
v_lshl_add_u32 v17, v18, 7, v19
s_barrier
v_add_u32 v10, 16384, v9
ds_read_b128 v[60:63], v14 offset:0
ds_read_b64_tr_b16 v[24:25], v10 offset:0
ds_read_b64_tr_b16 v[26:27], v10 offset:768
ds_read_b64_tr_b16 v[28:29], v10 offset:64
ds_read_b64_tr_b16 v[30:31], v10 offset:832
ds_read_b64_tr_b16 v[32:33], v10 offset:128
ds_read_b64_tr_b16 v[34:35], v10 offset:896
ds_read_b128 v[64:67], v15 offset:0
ds_read_b64_tr_b16 v[36:37], v10 offset:3072
ds_read_b64_tr_b16 v[38:39], v10 offset:3840
ds_read_b64_tr_b16 v[40:41], v10 offset:3136
ds_read_b64_tr_b16 v[42:43], v10 offset:3904
ds_read_b64_tr_b16 v[44:45], v10 offset:3200
ds_read_b64_tr_b16 v[46:47], v10 offset:3968
ds_read_b128 v[68:71], v16 offset:0
s_waitcnt lgkmcnt(12)
v_mfma_f32_32x32x16_bf16 v[72:87], v[24:27], v[60:63], 0
ds_read_b64_tr_b16 v[48:49], v10 offset:6144
ds_read_b64_tr_b16 v[50:51], v10 offset:6912
s_waitcnt lgkmcnt(12)
v_mfma_f32_32x32x16_bf16 v[88:103], v[28:31], v[60:63], 0
ds_read_b64_tr_b16 v[52:53], v10 offset:6208
ds_read_b64_tr_b16 v[54:55], v10 offset:6976
s_waitcnt lgkmcnt(12)
v_mfma_f32_32x32x16_bf16 v[104:119], v[32:35], v[60:63], 0
ds_read_b64_tr_b16 v[56:57], v10 offset:6272
ds_read_b64_tr_b16 v[58:59], v10 offset:7040
ds_read_b128 v[60:63], v17 offset:0
s_waitcnt lgkmcnt(12)
v_mfma_f32_32x32x16_bf16 v[72:87], v[36:39], v[64:67], v[72:87]
ds_read_b64_tr_b16 v[24:25], v10 offset:9216
ds_read_b64_tr_b16 v[26:27], v10 offset:9984
s_waitcnt lgkmcnt(12)
v_mfma_f32_32x32x16_bf16 v[88:103], v[40:43], v[64:67], v[88:103]
ds_read_b64_tr_b16 v[28:29], v10 offset:9280
ds_read_b64_tr_b16 v[30:31], v10 offset:10048
s_waitcnt lgkmcnt(12)
v_mfma_f32_32x32x16_bf16 v[104:119], v[44:47], v[64:67], v[104:119]
ds_read_b64_tr_b16 v[32:33], v10 offset:9344
ds_read_b64_tr_b16 v[34:35], v10 offset:10112
s_barrier
v_add_u32 v11, 45056, v9
ds_read_b128 v[64:67], v14 offset:28672
s_waitcnt lgkmcnt(12)
v_mfma_f32_32x32x16_bf16 v[72:87], v[48:51], v[68:71], v[72:87]
ds_read_b64_tr_b16 v[36:37], v11 offset:0
ds_read_b64_tr_b16 v[38:39], v11 offset:768
s_waitcnt lgkmcnt(12)
v_mfma_f32_32x32x16_bf16 v[88:103], v[52:55], v[68:71], v[88:103]
ds_read_b64_tr_b16 v[40:41], v11 offset:64
ds_read_b64_tr_b16 v[42:43], v11 offset:832
s_waitcnt lgkmcnt(12)
v_mfma_f32_32x32x16_bf16 v[104:119], v[56:59], v[68:71], v[104:119]
ds_read_b64_tr_b16 v[44:45], v11 offset:128
ds_read_b64_tr_b16 v[46:47], v11 offset:896
ds_read_b128 v[68:71], v15 offset:28672
s_waitcnt lgkmcnt(12)
v_mfma_f32_32x32x16_bf16 v[72:87], v[24:27], v[60:63], v[72:87]
ds_read_b64_tr_b16 v[48:49], v11 offset:3072
ds_read_b64_tr_b16 v[50:51], v11 offset:3840
s_waitcnt lgkmcnt(12)
v_mfma_f32_32x32x16_bf16 v[88:103], v[28:31], v[60:63], v[88:103]
ds_read_b64_tr_b16 v[52:53], v11 offset:3136
ds_read_b64_tr_b16 v[54:55], v11 offset:3904
s_waitcnt lgkmcnt(12)
v_mfma_f32_32x32x16_bf16 v[104:119], v[32:35], v[60:63], v[104:119]
ds_read_b64_tr_b16 v[56:57], v11 offset:3200
ds_read_b64_tr_b16 v[58:59], v11 offset:3968
ds_read_b128 v[60:63], v16 offset:28672
s_waitcnt lgkmcnt(12)
v_mfma_f32_32x32x16_bf16 v[72:87], v[36:39], v[64:67], v[72:87]
ds_read_b64_tr_b16 v[24:25], v11 offset:6144
ds_read_b64_tr_b16 v[26:27], v11 offset:6912
s_waitcnt lgkmcnt(12)
v_mfma_f32_32x32x16_bf16 v[88:103], v[40:43], v[64:67], v[88:103]
ds_read_b64_tr_b16 v[28:29], v11 offset:6208
ds_read_b64_tr_b16 v[30:31], v11 offset:6976
s_waitcnt lgkmcnt(12)
v_mfma_f32_32x32x16_bf16 v[104:119], v[44:47], v[64:67], v[104:119]
ds_read_b64_tr_b16 v[32:33], v11 offset:6272
ds_read_b64_tr_b16 v[34:35], v11 offset:7040
ds_read_b128 v[64:67], v17 offset:28672
s_waitcnt lgkmcnt(12)
v_mfma_f32_32x32x16_bf16 v[72:87], v[48:51], v[68:71], v[72:87]
ds_read_b64_tr_b16 v[36:37], v11 offset:9216
ds_read_b64_tr_b16 v[38:39], v11 offset:9984
s_waitcnt lgkmcnt(12)
v_mfma_f32_32x32x16_bf16 v[88:103], v[52:55], v[68:71], v[88:103]
ds_read_b64_tr_b16 v[40:41], v11 offset:9280
ds_read_b64_tr_b16 v[42:43], v11 offset:10048
s_waitcnt lgkmcnt(12)
v_mfma_f32_32x32x16_bf16 v[104:119], v[56:59], v[68:71], v[104:119]
ds_read_b64_tr_b16 v[44:45], v11 offset:9344
ds_read_b64_tr_b16 v[46:47], v11 offset:10112
s_barrier
v_add_u32 v10, 73728, v9
ds_read_b128 v[68:71], v14 offset:57344
s_waitcnt lgkmcnt(12)
v_mfma_f32_32x32x16_bf16 v[72:87], v[24:27], v[60:63], v[72:87]
ds_read_b64_tr_b16 v[48:49], v10 offset:0
ds_read_b64_tr_b16 v[50:51], v10 offset:768
s_waitcnt lgkmcnt(12)
v_mfma_f32_32x32x16_bf16 v[88:103], v[28:31], v[60:63], v[88:103]
ds_read_b64_tr_b16 v[52:53], v10 offset:64
ds_read_b64_tr_b16 v[54:55], v10 offset:832
s_waitcnt lgkmcnt(12)
v_mfma_f32_32x32x16_bf16 v[104:119], v[32:35], v[60:63], v[104:119]
ds_read_b64_tr_b16 v[56:57], v10 offset:128
ds_read_b64_tr_b16 v[58:59], v10 offset:896
ds_read_b128 v[60:63], v15 offset:57344
s_waitcnt lgkmcnt(12)
v_mfma_f32_32x32x16_bf16 v[72:87], v[36:39], v[64:67], v[72:87]
ds_read_b64_tr_b16 v[24:25], v10 offset:3072
ds_read_b64_tr_b16 v[26:27], v10 offset:3840
s_waitcnt lgkmcnt(12)
v_mfma_f32_32x32x16_bf16 v[88:103], v[40:43], v[64:67], v[88:103]
ds_read_b64_tr_b16 v[28:29], v10 offset:3136
ds_read_b64_tr_b16 v[30:31], v10 offset:3904
s_waitcnt lgkmcnt(12)
v_mfma_f32_32x32x16_bf16 v[104:119], v[44:47], v[64:67], v[104:119]
ds_read_b64_tr_b16 v[32:33], v10 offset:3200
ds_read_b64_tr_b16 v[34:35], v10 offset:3968
ds_read_b128 v[64:67], v16 offset:57344
s_waitcnt lgkmcnt(12)
v_mfma_f32_32x32x16_bf16 v[72:87], v[48:51], v[68:71], v[72:87]
ds_read_b64_tr_b16 v[36:37], v10 offset:6144
ds_read_b64_tr_b16 v[38:39], v10 offset:6912
s_waitcnt lgkmcnt(12)
v_mfma_f32_32x32x16_bf16 v[88:103], v[52:55], v[68:71], v[88:103]
ds_read_b64_tr_b16 v[40:41], v10 offset:6208
ds_read_b64_tr_b16 v[42:43], v10 offset:6976
s_waitcnt lgkmcnt(12)
v_mfma_f32_32x32x16_bf16 v[104:119], v[56:59], v[68:71], v[104:119]
ds_read_b64_tr_b16 v[44:45], v10 offset:6272
ds_read_b64_tr_b16 v[46:47], v10 offset:7040
ds_read_b128 v[68:71], v17 offset:57344
s_waitcnt lgkmcnt(12)
v_mfma_f32_32x32x16_bf16 v[72:87], v[24:27], v[60:63], v[72:87]
ds_read_b64_tr_b16 v[48:49], v10 offset:9216
ds_read_b64_tr_b16 v[50:51], v10 offset:9984
s_waitcnt lgkmcnt(12)
v_mfma_f32_32x32x16_bf16 v[88:103], v[28:31], v[60:63], v[88:103]
ds_read_b64_tr_b16 v[52:53], v10 offset:9280
ds_read_b64_tr_b16 v[54:55], v10 offset:10048
s_waitcnt lgkmcnt(12)
v_mfma_f32_32x32x16_bf16 v[104:119], v[32:35], v[60:63], v[104:119]
ds_read_b64_tr_b16 v[56:57], v10 offset:9344
ds_read_b64_tr_b16 v[58:59], v10 offset:10112
s_barrier
v_add_u32 v11, 102400, v9
v_add_u32 v18, 86016, v14
ds_read_b128 v[60:63], v18
s_waitcnt lgkmcnt(12)
v_mfma_f32_32x32x16_bf16 v[72:87], v[36:39], v[64:67], v[72:87]
ds_read_b64_tr_b16 v[24:25], v11 offset:0
ds_read_b64_tr_b16 v[26:27], v11 offset:768
s_waitcnt lgkmcnt(12)
v_mfma_f32_32x32x16_bf16 v[88:103], v[40:43], v[64:67], v[88:103]
ds_read_b64_tr_b16 v[28:29], v11 offset:64
ds_read_b64_tr_b16 v[30:31], v11 offset:832
s_waitcnt lgkmcnt(12)
v_mfma_f32_32x32x16_bf16 v[104:119], v[44:47], v[64:67], v[104:119]
ds_read_b64_tr_b16 v[32:33], v11 offset:128
ds_read_b64_tr_b16 v[34:35], v11 offset:896
v_add_u32 v19, 86016, v15
ds_read_b128 v[64:67], v19
s_waitcnt lgkmcnt(12)
v_mfma_f32_32x32x16_bf16 v[72:87], v[48:51], v[68:71], v[72:87]
ds_read_b64_tr_b16 v[36:37], v11 offset:3072
ds_read_b64_tr_b16 v[38:39], v11 offset:3840
s_waitcnt lgkmcnt(12)
v_mfma_f32_32x32x16_bf16 v[88:103], v[52:55], v[68:71], v[88:103]
ds_read_b64_tr_b16 v[40:41], v11 offset:3136
ds_read_b64_tr_b16 v[42:43], v11 offset:3904
s_waitcnt lgkmcnt(12)
v_mfma_f32_32x32x16_bf16 v[104:119], v[56:59], v[68:71], v[104:119]
ds_read_b64_tr_b16 v[44:45], v11 offset:3200
ds_read_b64_tr_b16 v[46:47], v11 offset:3968
v_add_u32 v18, 86016, v16
ds_read_b128 v[68:71], v18
s_waitcnt lgkmcnt(12)
v_mfma_f32_32x32x16_bf16 v[72:87], v[24:27], v[60:63], v[72:87]
ds_read_b64_tr_b16 v[48:49], v11 offset:6144
ds_read_b64_tr_b16 v[50:51], v11 offset:6912
s_waitcnt lgkmcnt(12)
v_mfma_f32_32x32x16_bf16 v[88:103], v[28:31], v[60:63], v[88:103]
ds_read_b64_tr_b16 v[52:53], v11 offset:6208
ds_read_b64_tr_b16 v[54:55], v11 offset:6976
s_waitcnt lgkmcnt(12)
v_mfma_f32_32x32x16_bf16 v[104:119], v[32:35], v[60:63], v[104:119]
ds_read_b64_tr_b16 v[56:57], v11 offset:6272
ds_read_b64_tr_b16 v[58:59], v11 offset:7040
v_add_u32 v19, 86016, v17
ds_read_b128 v[60:63], v19
s_waitcnt lgkmcnt(12)
v_mfma_f32_32x32x16_bf16 v[72:87], v[36:39], v[64:67], v[72:87]
ds_read_b64_tr_b16 v[24:25], v11 offset:9216
ds_read_b64_tr_b16 v[26:27], v11 offset:9984
s_waitcnt lgkmcnt(12)
v_mfma_f32_32x32x16_bf16 v[88:103], v[40:43], v[64:67], v[88:103]
ds_read_b64_tr_b16 v[28:29], v11 offset:9280
ds_read_b64_tr_b16 v[30:31], v11 offset:10048
s_waitcnt lgkmcnt(12)
v_mfma_f32_32x32x16_bf16 v[104:119], v[44:47], v[64:67], v[104:119]
ds_read_b64_tr_b16 v[32:33], v11 offset:9344
ds_read_b64_tr_b16 v[34:35], v11 offset:10112
s_barrier
v_add_u32 v10, 131072, v9
v_add_u32 v18, 114688, v14
ds_read_b128 v[64:67], v18
s_waitcnt lgkmcnt(12)
v_mfma_f32_32x32x16_bf16 v[72:87], v[48:51], v[68:71], v[72:87]
ds_read_b64_tr_b16 v[36:37], v10 offset:0
ds_read_b64_tr_b16 v[38:39], v10 offset:768
s_waitcnt lgkmcnt(12)
v_mfma_f32_32x32x16_bf16 v[88:103], v[52:55], v[68:71], v[88:103]
ds_read_b64_tr_b16 v[40:41], v10 offset:64
ds_read_b64_tr_b16 v[42:43], v10 offset:832
s_waitcnt lgkmcnt(12)
v_mfma_f32_32x32x16_bf16 v[104:119], v[56:59], v[68:71], v[104:119]
ds_read_b64_tr_b16 v[44:45], v10 offset:128
ds_read_b64_tr_b16 v[46:47], v10 offset:896
v_add_u32 v19, 114688, v15
ds_read_b128 v[68:71], v19
s_waitcnt lgkmcnt(12)
v_mfma_f32_32x32x16_bf16 v[72:87], v[24:27], v[60:63], v[72:87]
ds_read_b64_tr_b16 v[48:49], v10 offset:3072
ds_read_b64_tr_b16 v[50:51], v10 offset:3840
s_waitcnt lgkmcnt(12)
v_mfma_f32_32x32x16_bf16 v[88:103], v[28:31], v[60:63], v[88:103]
ds_read_b64_tr_b16 v[52:53], v10 offset:3136
ds_read_b64_tr_b16 v[54:55], v10 offset:3904
s_waitcnt lgkmcnt(12)
v_mfma_f32_32x32x16_bf16 v[104:119], v[32:35], v[60:63], v[104:119]
ds_read_b64_tr_b16 v[56:57], v10 offset:3200
ds_read_b64_tr_b16 v[58:59], v10 offset:3968
v_add_u32 v18, 114688, v16
ds_read_b128 v[60:63], v18
s_waitcnt lgkmcnt(12)
v_mfma_f32_32x32x16_bf16 v[72:87], v[36:39], v[64:67], v[72:87]
ds_read_b64_tr_b16 v[24:25], v10 offset:6144
ds_read_b64_tr_b16 v[26:27], v10 offset:6912
s_waitcnt lgkmcnt(12)
v_mfma_f32_32x32x16_bf16 v[88:103], v[40:43], v[64:67], v[88:103]
ds_read_b64_tr_b16 v[28:29], v10 offset:6208
ds_read_b64_tr_b16 v[30:31], v10 offset:6976
s_waitcnt lgkmcnt(12)
v_mfma_f32_32x32x16_bf16 v[104:119], v[44:47], v[64:67], v[104:119]
ds_read_b64_tr_b16 v[32:33], v10 offset:6272
ds_read_b64_tr_b16 v[34:35], v10 offset:7040
v_add_u32 v19, 114688, v17
ds_read_b128 v[64:67], v19
s_waitcnt lgkmcnt(12)
v_mfma_f32_32x32x16_bf16 v[72:87], v[48:51], v[68:71], v[72:87]
ds_read_b64_tr_b16 v[36:37], v10 offset:9216
ds_read_b64_tr_b16 v[38:39], v10 offset:9984
s_waitcnt lgkmcnt(12)
v_mfma_f32_32x32x16_bf16 v[88:103], v[52:55], v[68:71], v[88:103]
ds_read_b64_tr_b16 v[40:41], v10 offset:9280
ds_read_b64_tr_b16 v[42:43], v10 offset:10048
s_waitcnt lgkmcnt(12)
v_mfma_f32_32x32x16_bf16 v[104:119], v[56:59], v[68:71], v[104:119]
ds_read_b64_tr_b16 v[44:45], v10 offset:9344
ds_read_b64_tr_b16 v[46:47], v10 offset:10112
s_barrier
v_add_u32 v11, 16384, v9
ds_read_b128 v[68:71], v14 offset:0
s_waitcnt lgkmcnt(12)
v_mfma_f32_32x32x16_bf16 v[72:87], v[24:27], v[60:63], v[72:87]
ds_read_b64_tr_b16 v[48:49], v11 offset:0
ds_read_b64_tr_b16 v[50:51], v11 offset:768
s_waitcnt lgkmcnt(12)
v_mfma_f32_32x32x16_bf16 v[88:103], v[28:31], v[60:63], v[88:103]
ds_read_b64_tr_b16 v[52:53], v11 offset:64
ds_read_b64_tr_b16 v[54:55], v11 offset:832
s_waitcnt lgkmcnt(12)
v_mfma_f32_32x32x16_bf16 v[104:119], v[32:35], v[60:63], v[104:119]
ds_read_b64_tr_b16 v[56:57], v11 offset:128
ds_read_b64_tr_b16 v[58:59], v11 offset:896
ds_read_b128 v[60:63], v15 offset:0
s_waitcnt lgkmcnt(12)
v_mfma_f32_32x32x16_bf16 v[72:87], v[36:39], v[64:67], v[72:87]
ds_read_b64_tr_b16 v[24:25], v11 offset:3072
ds_read_b64_tr_b16 v[26:27], v11 offset:3840
s_waitcnt lgkmcnt(12)
v_mfma_f32_32x32x16_bf16 v[88:103], v[40:43], v[64:67], v[88:103]
ds_read_b64_tr_b16 v[28:29], v11 offset:3136
ds_read_b64_tr_b16 v[30:31], v11 offset:3904
s_waitcnt lgkmcnt(12)
v_mfma_f32_32x32x16_bf16 v[104:119], v[44:47], v[64:67], v[104:119]
ds_read_b64_tr_b16 v[32:33], v11 offset:3200
ds_read_b64_tr_b16 v[34:35], v11 offset:3968
ds_read_b128 v[64:67], v16 offset:0
s_waitcnt lgkmcnt(12)
v_mfma_f32_32x32x16_bf16 v[72:87], v[48:51], v[68:71], v[72:87]
ds_read_b64_tr_b16 v[36:37], v11 offset:6144
ds_read_b64_tr_b16 v[38:39], v11 offset:6912
s_waitcnt lgkmcnt(12)
v_mfma_f32_32x32x16_bf16 v[88:103], v[52:55], v[68:71], v[88:103]
ds_read_b64_tr_b16 v[40:41], v11 offset:6208
ds_read_b64_tr_b16 v[42:43], v11 offset:6976
s_waitcnt lgkmcnt(12)
v_mfma_f32_32x32x16_bf16 v[104:119], v[56:59], v[68:71], v[104:119]
ds_read_b64_tr_b16 v[44:45], v11 offset:6272
ds_read_b64_tr_b16 v[46:47], v11 offset:7040
ds_read_b128 v[68:71], v17 offset:0
s_waitcnt lgkmcnt(12)
v_mfma_f32_32x32x16_bf16 v[72:87], v[24:27], v[60:63], v[72:87]
ds_read_b64_tr_b16 v[48:49], v11 offset:9216
ds_read_b64_tr_b16 v[50:51], v11 offset:9984
s_waitcnt lgkmcnt(12)
v_mfma_f32_32x32x16_bf16 v[88:103], v[28:31], v[60:63], v[88:103]
ds_read_b64_tr_b16 v[52:53], v11 offset:9280
ds_read_b64_tr_b16 v[54:55], v11 offset:10048
s_waitcnt lgkmcnt(12)
v_mfma_f32_32x32x16_bf16 v[104:119], v[32:35], v[60:63], v[104:119]
ds_read_b64_tr_b16 v[56:57], v11 offset:9344
ds_read_b64_tr_b16 v[58:59], v11 offset:10112
s_barrier
v_add_u32 v10, 45056, v9
ds_read_b128 v[60:63], v14 offset:28672
s_waitcnt lgkmcnt(12)
v_mfma_f32_32x32x16_bf16 v[72:87], v[36:39], v[64:67], v[72:87]
ds_read_b64_tr_b16 v[24:25], v10 offset:0
ds_read_b64_tr_b16 v[26:27], v10 offset:768
s_waitcnt lgkmcnt(12)
v_mfma_f32_32x32x16_bf16 v[88:103], v[40:43], v[64:67], v[88:103]
ds_read_b64_tr_b16 v[28:29], v10 offset:64
ds_read_b64_tr_b16 v[30:31], v10 offset:832
s_waitcnt lgkmcnt(12)
v_mfma_f32_32x32x16_bf16 v[104:119], v[44:47], v[64:67], v[104:119]
ds_read_b64_tr_b16 v[32:33], v10 offset:128
ds_read_b64_tr_b16 v[34:35], v10 offset:896
ds_read_b128 v[64:67], v15 offset:28672
s_waitcnt lgkmcnt(12)
v_mfma_f32_32x32x16_bf16 v[72:87], v[48:51], v[68:71], v[72:87]
ds_read_b64_tr_b16 v[36:37], v10 offset:3072
ds_read_b64_tr_b16 v[38:39], v10 offset:3840
s_waitcnt lgkmcnt(12)
v_mfma_f32_32x32x16_bf16 v[88:103], v[52:55], v[68:71], v[88:103]
ds_read_b64_tr_b16 v[40:41], v10 offset:3136
ds_read_b64_tr_b16 v[42:43], v10 offset:3904
s_waitcnt lgkmcnt(12)
v_mfma_f32_32x32x16_bf16 v[104:119], v[56:59], v[68:71], v[104:119]
ds_read_b64_tr_b16 v[44:45], v10 offset:3200
ds_read_b64_tr_b16 v[46:47], v10 offset:3968
ds_read_b128 v[68:71], v16 offset:28672
s_waitcnt lgkmcnt(12)
v_mfma_f32_32x32x16_bf16 v[72:87], v[24:27], v[60:63], v[72:87]
ds_read_b64_tr_b16 v[48:49], v10 offset:6144
ds_read_b64_tr_b16 v[50:51], v10 offset:6912
s_waitcnt lgkmcnt(12)
v_mfma_f32_32x32x16_bf16 v[88:103], v[28:31], v[60:63], v[88:103]
ds_read_b64_tr_b16 v[52:53], v10 offset:6208
ds_read_b64_tr_b16 v[54:55], v10 offset:6976
s_waitcnt lgkmcnt(12)
v_mfma_f32_32x32x16_bf16 v[104:119], v[32:35], v[60:63], v[104:119]
ds_read_b64_tr_b16 v[56:57], v10 offset:6272
ds_read_b64_tr_b16 v[58:59], v10 offset:7040
ds_read_b128 v[60:63], v17 offset:28672
s_waitcnt lgkmcnt(12)
v_mfma_f32_32x32x16_bf16 v[72:87], v[36:39], v[64:67], v[72:87]
ds_read_b64_tr_b16 v[24:25], v10 offset:9216
ds_read_b64_tr_b16 v[26:27], v10 offset:9984
s_waitcnt lgkmcnt(12)
v_mfma_f32_32x32x16_bf16 v[88:103], v[40:43], v[64:67], v[88:103]
ds_read_b64_tr_b16 v[28:29], v10 offset:9280
ds_read_b64_tr_b16 v[30:31], v10 offset:10048
s_waitcnt lgkmcnt(12)
v_mfma_f32_32x32x16_bf16 v[104:119], v[44:47], v[64:67], v[104:119]
ds_read_b64_tr_b16 v[32:33], v10 offset:9344
ds_read_b64_tr_b16 v[34:35], v10 offset:10112
s_barrier
v_add_u32 v11, 73728, v9
ds_read_b128 v[64:67], v14 offset:57344
s_waitcnt lgkmcnt(12)
v_mfma_f32_32x32x16_bf16 v[72:87], v[48:51], v[68:71], v[72:87]
ds_read_b64_tr_b16 v[36:37], v11 offset:0
ds_read_b64_tr_b16 v[38:39], v11 offset:768
s_waitcnt lgkmcnt(12)
v_mfma_f32_32x32x16_bf16 v[88:103], v[52:55], v[68:71], v[88:103]
ds_read_b64_tr_b16 v[40:41], v11 offset:64
ds_read_b64_tr_b16 v[42:43], v11 offset:832
s_waitcnt lgkmcnt(12)
v_mfma_f32_32x32x16_bf16 v[104:119], v[56:59], v[68:71], v[104:119]
ds_read_b64_tr_b16 v[44:45], v11 offset:128
ds_read_b64_tr_b16 v[46:47], v11 offset:896
ds_read_b128 v[68:71], v15 offset:57344
s_waitcnt lgkmcnt(12)
v_mfma_f32_32x32x16_bf16 v[72:87], v[24:27], v[60:63], v[72:87]
ds_read_b64_tr_b16 v[48:49], v11 offset:3072
ds_read_b64_tr_b16 v[50:51], v11 offset:3840
s_waitcnt lgkmcnt(12)
v_mfma_f32_32x32x16_bf16 v[88:103], v[28:31], v[60:63], v[88:103]
ds_read_b64_tr_b16 v[52:53], v11 offset:3136
ds_read_b64_tr_b16 v[54:55], v11 offset:3904
s_waitcnt lgkmcnt(12)
v_mfma_f32_32x32x16_bf16 v[104:119], v[32:35], v[60:63], v[104:119]
ds_read_b64_tr_b16 v[56:57], v11 offset:3200
ds_read_b64_tr_b16 v[58:59], v11 offset:3968
ds_read_b128 v[60:63], v16 offset:57344
s_waitcnt lgkmcnt(12)
v_mfma_f32_32x32x16_bf16 v[72:87], v[36:39], v[64:67], v[72:87]
ds_read_b64_tr_b16 v[24:25], v11 offset:6144
ds_read_b64_tr_b16 v[26:27], v11 offset:6912
s_waitcnt lgkmcnt(12)
v_mfma_f32_32x32x16_bf16 v[88:103], v[40:43], v[64:67], v[88:103]
ds_read_b64_tr_b16 v[28:29], v11 offset:6208
ds_read_b64_tr_b16 v[30:31], v11 offset:6976
s_waitcnt lgkmcnt(12)
v_mfma_f32_32x32x16_bf16 v[104:119], v[44:47], v[64:67], v[104:119]
ds_read_b64_tr_b16 v[32:33], v11 offset:6272
ds_read_b64_tr_b16 v[34:35], v11 offset:7040
ds_read_b128 v[64:67], v17 offset:57344
s_waitcnt lgkmcnt(12)
v_mfma_f32_32x32x16_bf16 v[72:87], v[48:51], v[68:71], v[72:87]
ds_read_b64_tr_b16 v[36:37], v11 offset:9216
ds_read_b64_tr_b16 v[38:39], v11 offset:9984
s_waitcnt lgkmcnt(12)
v_mfma_f32_32x32x16_bf16 v[88:103], v[52:55], v[68:71], v[88:103]
ds_read_b64_tr_b16 v[40:41], v11 offset:9280
ds_read_b64_tr_b16 v[42:43], v11 offset:10048
s_waitcnt lgkmcnt(12)
v_mfma_f32_32x32x16_bf16 v[104:119], v[56:59], v[68:71], v[104:119]
ds_read_b64_tr_b16 v[44:45], v11 offset:9344
ds_read_b64_tr_b16 v[46:47], v11 offset:10112
s_waitcnt lgkmcnt(11)
v_mfma_f32_32x32x16_bf16 v[72:87], v[24:27], v[60:63], v[72:87]
s_waitcnt lgkmcnt(9)
v_mfma_f32_32x32x16_bf16 v[88:103], v[28:31], v[60:63], v[88:103]
s_waitcnt lgkmcnt(7)
v_mfma_f32_32x32x16_bf16 v[104:119], v[32:35], v[60:63], v[104:119]
s_waitcnt lgkmcnt(4)
v_mfma_f32_32x32x16_bf16 v[72:87], v[36:39], v[64:67], v[72:87]
s_waitcnt lgkmcnt(2)
v_mfma_f32_32x32x16_bf16 v[88:103], v[40:43], v[64:67], v[88:103]
s_waitcnt lgkmcnt(0)
v_mfma_f32_32x32x16_bf16 v[104:119], v[44:47], v[64:67], v[104:119]
s_barrier
v_and_b32 v134, 31, v1
v_lshlrev_b32 v134, 3, v134
v_add_u32 v134, 2048, v134
ds_read_b64 v[132:133], v134
v_lshlrev_b32 v137, 4, v5
v_add_u32 v137, 0, v137
ds_read_b128 v[24:27], v137 offset:0
ds_read_b128 v[28:31], v137 offset:32
ds_read_b128 v[32:35], v137 offset:64
ds_read_b128 v[36:39], v137 offset:96
s_lshl_b32 s7, s4, 2
s_add_u32 s7, s7, 0
v_bfe_u32 v121, v1, 4, 1
v_bfe_u32 v122, v1, 2, 1
v_lshlrev_b32 v122, 3, v122
v_lshl_add_u32 v122, v121, 4, v122
v_and_b32 v123, 3, v1
v_add_u32 v122, v122, v123
v_bfe_u32 v123, v1, 3, 1
v_lshl_add_u32 v122, v123, 2, v122
v_lshlrev_b32 v122, 1, v122
v_mul_u32_u24 v123, 320, v5
v_add_u32 v128, v122, v123
v_add_u32 v128, 4096, v128
v_lshl_add_u32 v122, v5, 4, v4
v_mul_u32_u24 v122, 80, v122
v_lshl_add_u32 v122, v121, 4, v122
v_add_u32 v129, 4096, v122
v_and_b32 v122, 31, v1
v_lshlrev_b32 v122, 4, v122
v_lshl_add_u32 v130, v5, 16, v122
ds_read_b128 v[40:43], v137 offset:128
ds_read_b128 v[44:47], v137 offset:160
ds_read_b128 v[48:51], v137 offset:192
ds_read_b128 v[52:55], v137 offset:224
s_mul_i32 s8, s5, 3
s_add_u32 s8, s8, 0
s_lshr_b32 s9, s8, 4
s_and_b32 s10, s8, 15
s_lshl_b32 s10, s10, 17
s_cmp_eq_u32 s9, 0
s_cselect_b32 s11, 0x3eb8aa3b, 0x3f800000
s_lshr_b32 s12, s9, 0
s_mul_i32 s12, s9, 2097152
s_add_u32 s12, s12, 2097152
s_add_u32 s12, s12, s10
s_lshl_b32 s13, s7, 10
s_add_u32 s12, s12, s13
s_waitcnt lgkmcnt(8)
v_mul_f32 v138, s11, v133
s_waitcnt lgkmcnt(7)
v_pk_fma_f32 v[72:73], v[24:25], v[132:133], v[72:73] op_sel_hi:[1,0,1]
v_pk_fma_f32 v[74:75], v[26:27], v[132:133], v[74:75] op_sel_hi:[1,0,1]
s_waitcnt lgkmcnt(6)
v_pk_fma_f32 v[76:77], v[28:29], v[132:133], v[76:77] op_sel_hi:[1,0,1]
v_pk_fma_f32 v[78:79], v[30:31], v[132:133], v[78:79] op_sel_hi:[1,0,1]
s_waitcnt lgkmcnt(5)
v_pk_fma_f32 v[80:81], v[32:33], v[132:133], v[80:81] op_sel_hi:[1,0,1]
v_pk_fma_f32 v[82:83], v[34:35], v[132:133], v[82:83] op_sel_hi:[1,0,1]
s_waitcnt lgkmcnt(4)
v_pk_fma_f32 v[84:85], v[36:37], v[132:133], v[84:85] op_sel_hi:[1,0,1]
v_pk_fma_f32 v[86:87], v[38:39], v[132:133], v[86:87] op_sel_hi:[1,0,1]
v_pk_mul_f32 v[72:73], v[72:73], v[138:139] op_sel_hi:[1,0]
v_pk_mul_f32 v[74:75], v[74:75], v[138:139] op_sel_hi:[1,0]
v_pk_mul_f32 v[76:77], v[76:77], v[138:139] op_sel_hi:[1,0]
v_pk_mul_f32 v[78:79], v[78:79], v[138:139] op_sel_hi:[1,0]
v_pk_mul_f32 v[80:81], v[80:81], v[138:139] op_sel_hi:[1,0]
v_pk_mul_f32 v[82:83], v[82:83], v[138:139] op_sel_hi:[1,0]
v_pk_mul_f32 v[84:85], v[84:85], v[138:139] op_sel_hi:[1,0]
v_pk_mul_f32 v[86:87], v[86:87], v[138:139] op_sel_hi:[1,0]
s_cmp_eq_u32 s9, 2
s_cbranch_scc1 k1_kernel_w0_t0_v
v_cvt_pk_bf16_f32 v120, v72, v73
v_cvt_pk_bf16_f32 v121, v74, v75
v_cvt_pk_bf16_f32 v122, v76, v77
v_cvt_pk_bf16_f32 v123, v78, v79
s_nop 0
v_permlane32_swap_b32 v120, v122
v_permlane32_swap_b32 v121, v123
v_cvt_pk_bf16_f32 v124, v80, v81
v_cvt_pk_bf16_f32 v125, v82, v83
v_cvt_pk_bf16_f32 v126, v84, v85
v_cvt_pk_bf16_f32 v127, v86, v87
s_nop 0
v_permlane32_swap_b32 v124, v126
v_permlane32_swap_b32 v125, v127
buffer_store_dwordx4 v[120:123], v3, s[52:55], s12 offen sc0 sc1
s_add_u32 s12, s12, 65536
buffer_store_dwordx4 v[124:127], v3, s[52:55], s12 offen sc0 sc1
s_branch k1_kernel_w0_t0_j
k1_kernel_w0_t0_v:
v_cvt_pk_bf16_f32 v120, v72, v73
v_cvt_pk_bf16_f32 v121, v74, v75
v_cvt_pk_bf16_f32 v122, v76, v77
v_cvt_pk_bf16_f32 v123, v78, v79
v_cvt_pk_bf16_f32 v124, v80, v81
v_cvt_pk_bf16_f32 v125, v82, v83
v_cvt_pk_bf16_f32 v126, v84, v85
v_cvt_pk_bf16_f32 v127, v86, v87
ds_write_b16 v128, v120 offset:0
ds_write_b16_d16_hi v128, v120 offset:80
ds_write_b16 v128, v121 offset:160
ds_write_b16_d16_hi v128, v121 offset:240
ds_write_b16 v128, v122 offset:640
ds_write_b16_d16_hi v128, v122 offset:720
ds_write_b16 v128, v123 offset:800
ds_write_b16_d16_hi v128, v123 offset:880
ds_write_b16 v128, v124 offset:1280
ds_write_b16_d16_hi v128, v124 offset:1360
ds_write_b16 v128, v125 offset:1440
s_waitcnt lgkmcnt(13)
ds_write_b16_d16_hi v128, v125 offset:1520
ds_write_b16 v128, v126 offset:1920
s_waitcnt lgkmcnt(13)
ds_write_b16_d16_hi v128, v126 offset:2000
ds_write_b16 v128, v127 offset:2080
s_waitcnt lgkmcnt(13)
ds_write_b16_d16_hi v128, v127 offset:2160
ds_read_b128 v[120:123], v129
s_waitcnt lgkmcnt(13)
ds_read_b128 v[124:127], v129 offset:32
s_waitcnt lgkmcnt(1)
buffer_store_dwordx4 v[120:123], v130, s[52:55], s12 offen sc0 sc1
s_waitcnt lgkmcnt(0)
buffer_store_dwordx4 v[124:127], v130, s[52:55], s12 offen offset:512 sc0 sc1
k1_kernel_w0_t0_j:
s_waitcnt lgkmcnt(0)
ds_read_b128 v[24:27], v137 offset:256
ds_read_b128 v[28:31], v137 offset:288
ds_read_b128 v[32:35], v137 offset:320
ds_read_b128 v[36:39], v137 offset:352
s_mul_i32 s8, s5, 3
s_add_u32 s8, s8, 1
s_lshr_b32 s9, s8, 4
s_and_b32 s10, s8, 15
s_lshl_b32 s10, s10, 17
s_cmp_eq_u32 s9, 0
s_cselect_b32 s11, 0x3eb8aa3b, 0x3f800000
s_lshr_b32 s12, s9, 0
s_mul_i32 s12, s9, 2097152
s_add_u32 s12, s12, 2097152
s_add_u32 s12, s12, s10
s_lshl_b32 s13, s7, 10
s_add_u32 s12, s12, s13
v_mul_f32 v138, s11, v133
v_pk_fma_f32 v[88:89], v[40:41], v[132:133], v[88:89] op_sel_hi:[1,0,1]
v_pk_fma_f32 v[90:91], v[42:43], v[132:133], v[90:91] op_sel_hi:[1,0,1]
v_pk_fma_f32 v[92:93], v[44:45], v[132:133], v[92:93] op_sel_hi:[1,0,1]
v_pk_fma_f32 v[94:95], v[46:47], v[132:133], v[94:95] op_sel_hi:[1,0,1]
v_pk_fma_f32 v[96:97], v[48:49], v[132:133], v[96:97] op_sel_hi:[1,0,1]
v_pk_fma_f32 v[98:99], v[50:51], v[132:133], v[98:99] op_sel_hi:[1,0,1]
v_pk_fma_f32 v[100:101], v[52:53], v[132:133], v[100:101] op_sel_hi:[1,0,1]
v_pk_fma_f32 v[102:103], v[54:55], v[132:133], v[102:103] op_sel_hi:[1,0,1]
v_pk_mul_f32 v[88:89], v[88:89], v[138:139] op_sel_hi:[1,0]
v_pk_mul_f32 v[90:91], v[90:91], v[138:139] op_sel_hi:[1,0]
v_pk_mul_f32 v[92:93], v[92:93], v[138:139] op_sel_hi:[1,0]
v_pk_mul_f32 v[94:95], v[94:95], v[138:139] op_sel_hi:[1,0]
v_pk_mul_f32 v[96:97], v[96:97], v[138:139] op_sel_hi:[1,0]
v_pk_mul_f32 v[98:99], v[98:99], v[138:139] op_sel_hi:[1,0]
v_pk_mul_f32 v[100:101], v[100:101], v[138:139] op_sel_hi:[1,0]
v_pk_mul_f32 v[102:103], v[102:103], v[138:139] op_sel_hi:[1,0]
s_cmp_eq_u32 s9, 2
s_cbranch_scc1 k1_kernel_w0_t1_v
v_cvt_pk_bf16_f32 v120, v88, v89
v_cvt_pk_bf16_f32 v121, v90, v91
v_cvt_pk_bf16_f32 v122, v92, v93
v_cvt_pk_bf16_f32 v123, v94, v95
s_nop 0
v_permlane32_swap_b32 v120, v122
v_permlane32_swap_b32 v121, v123
v_cvt_pk_bf16_f32 v124, v96, v97
v_cvt_pk_bf16_f32 v125, v98, v99
v_cvt_pk_bf16_f32 v126, v100, v101
v_cvt_pk_bf16_f32 v127, v102, v103
s_nop 0
v_permlane32_swap_b32 v124, v126
v_permlane32_swap_b32 v125, v127
buffer_store_dwordx4 v[120:123], v3, s[52:55], s12 offen sc0 sc1
s_add_u32 s12, s12, 65536
buffer_store_dwordx4 v[124:127], v3, s[52:55], s12 offen sc0 sc1
s_branch k1_kernel_w0_t1_j
k1_kernel_w0_t1_v:
v_cvt_pk_bf16_f32 v120, v88, v89
v_cvt_pk_bf16_f32 v121, v90, v91
v_cvt_pk_bf16_f32 v122, v92, v93
v_cvt_pk_bf16_f32 v123, v94, v95
v_cvt_pk_bf16_f32 v124, v96, v97
v_cvt_pk_bf16_f32 v125, v98, v99
v_cvt_pk_bf16_f32 v126, v100, v101
v_cvt_pk_bf16_f32 v127, v102, v103
ds_write_b16 v128, v120 offset:0
ds_write_b16_d16_hi v128, v120 offset:80
ds_write_b16 v128, v121 offset:160
ds_write_b16_d16_hi v128, v121 offset:240
ds_write_b16 v128, v122 offset:640
ds_write_b16_d16_hi v128, v122 offset:720
ds_write_b16 v128, v123 offset:800
ds_write_b16_d16_hi v128, v123 offset:880
ds_write_b16 v128, v124 offset:1280
ds_write_b16_d16_hi v128, v124 offset:1360
ds_write_b16 v128, v125 offset:1440
s_waitcnt lgkmcnt(13)
ds_write_b16_d16_hi v128, v125 offset:1520
ds_write_b16 v128, v126 offset:1920
s_waitcnt lgkmcnt(13)
ds_write_b16_d16_hi v128, v126 offset:2000
ds_write_b16 v128, v127 offset:2080
s_waitcnt lgkmcnt(13)
ds_write_b16_d16_hi v128, v127 offset:2160
ds_read_b128 v[120:123], v129
s_waitcnt lgkmcnt(13)
ds_read_b128 v[124:127], v129 offset:32
s_waitcnt lgkmcnt(1)
buffer_store_dwordx4 v[120:123], v130, s[52:55], s12 offen sc0 sc1
s_waitcnt lgkmcnt(0)
buffer_store_dwordx4 v[124:127], v130, s[52:55], s12 offen offset:512 sc0 sc1
k1_kernel_w0_t1_j:
s_waitcnt lgkmcnt(0)
s_mul_i32 s8, s5, 3
s_add_u32 s8, s8, 2
s_lshr_b32 s9, s8, 4
s_and_b32 s10, s8, 15
s_lshl_b32 s10, s10, 17
s_cmp_eq_u32 s9, 0
s_cselect_b32 s11, 0x3eb8aa3b, 0x3f800000
s_lshr_b32 s12, s9, 0
s_mul_i32 s12, s9, 2097152
s_add_u32 s12, s12, 2097152
s_add_u32 s12, s12, s10
s_lshl_b32 s13, s7, 10
s_add_u32 s12, s12, s13
v_mul_f32 v138, s11, v133
v_pk_fma_f32 v[104:105], v[24:25], v[132:133], v[104:105] op_sel_hi:[1,0,1]
v_pk_fma_f32 v[106:107], v[26:27], v[132:133], v[106:107] op_sel_hi:[1,0,1]
v_pk_fma_f32 v[108:109], v[28:29], v[132:133], v[108:109] op_sel_hi:[1,0,1]
v_pk_fma_f32 v[110:111], v[30:31], v[132:133], v[110:111] op_sel_hi:[1,0,1]
v_pk_fma_f32 v[112:113], v[32:33], v[132:133], v[112:113] op_sel_hi:[1,0,1]
v_pk_fma_f32 v[114:115], v[34:35], v[132:133], v[114:115] op_sel_hi:[1,0,1]
v_pk_fma_f32 v[116:117], v[36:37], v[132:133], v[116:117] op_sel_hi:[1,0,1]
v_pk_fma_f32 v[118:119], v[38:39], v[132:133], v[118:119] op_sel_hi:[1,0,1]
v_pk_mul_f32 v[104:105], v[104:105], v[138:139] op_sel_hi:[1,0]
v_pk_mul_f32 v[106:107], v[106:107], v[138:139] op_sel_hi:[1,0]
v_pk_mul_f32 v[108:109], v[108:109], v[138:139] op_sel_hi:[1,0]
v_pk_mul_f32 v[110:111], v[110:111], v[138:139] op_sel_hi:[1,0]
v_pk_mul_f32 v[112:113], v[112:113], v[138:139] op_sel_hi:[1,0]
v_pk_mul_f32 v[114:115], v[114:115], v[138:139] op_sel_hi:[1,0]
v_pk_mul_f32 v[116:117], v[116:117], v[138:139] op_sel_hi:[1,0]
v_pk_mul_f32 v[118:119], v[118:119], v[138:139] op_sel_hi:[1,0]
s_cmp_eq_u32 s9, 2
s_cbranch_scc1 k1_kernel_w0_t2_v
v_cvt_pk_bf16_f32 v120, v104, v105
v_cvt_pk_bf16_f32 v121, v106, v107
v_cvt_pk_bf16_f32 v122, v108, v109
v_cvt_pk_bf16_f32 v123, v110, v111
s_nop 0
v_permlane32_swap_b32 v120, v122
v_permlane32_swap_b32 v121, v123
v_cvt_pk_bf16_f32 v124, v112, v113
v_cvt_pk_bf16_f32 v125, v114, v115
v_cvt_pk_bf16_f32 v126, v116, v117
v_cvt_pk_bf16_f32 v127, v118, v119
s_nop 0
v_permlane32_swap_b32 v124, v126
v_permlane32_swap_b32 v125, v127
buffer_store_dwordx4 v[120:123], v3, s[52:55], s12 offen sc0 sc1
s_add_u32 s12, s12, 65536
buffer_store_dwordx4 v[124:127], v3, s[52:55], s12 offen sc0 sc1
s_branch k1_kernel_w0_t2_j
k1_kernel_w0_t2_v:
v_cvt_pk_bf16_f32 v120, v104, v105
v_cvt_pk_bf16_f32 v121, v106, v107
v_cvt_pk_bf16_f32 v122, v108, v109
v_cvt_pk_bf16_f32 v123, v110, v111
v_cvt_pk_bf16_f32 v124, v112, v113
v_cvt_pk_bf16_f32 v125, v114, v115
v_cvt_pk_bf16_f32 v126, v116, v117
v_cvt_pk_bf16_f32 v127, v118, v119
ds_write_b16 v128, v120 offset:0
ds_write_b16_d16_hi v128, v120 offset:80
ds_write_b16 v128, v121 offset:160
ds_write_b16_d16_hi v128, v121 offset:240
ds_write_b16 v128, v122 offset:640
ds_write_b16_d16_hi v128, v122 offset:720
ds_write_b16 v128, v123 offset:800
ds_write_b16_d16_hi v128, v123 offset:880
ds_write_b16 v128, v124 offset:1280
ds_write_b16_d16_hi v128, v124 offset:1360
ds_write_b16 v128, v125 offset:1440
ds_write_b16_d16_hi v128, v125 offset:1520
ds_write_b16 v128, v126 offset:1920
ds_write_b16_d16_hi v128, v126 offset:2000
ds_write_b16 v128, v127 offset:2080
s_waitcnt lgkmcnt(13)
ds_write_b16_d16_hi v128, v127 offset:2160
ds_read_b128 v[120:123], v129
s_waitcnt lgkmcnt(13)
ds_read_b128 v[124:127], v129 offset:32
s_waitcnt lgkmcnt(1)
buffer_store_dwordx4 v[120:123], v130, s[52:55], s12 offen sc0 sc1
s_waitcnt lgkmcnt(0)
buffer_store_dwordx4 v[124:127], v130, s[52:55], s12 offen offset:512 sc0 sc1
k1_kernel_w0_t2_j:
s_waitcnt lgkmcnt(0)
s_waitcnt vmcnt(0)
s_branch k1_kernel_end
k1_kernel_w1:
v_mul_u32_u24 v18, 192, v7
v_lshl_add_u32 v18, v8, 3, v18
v_mul_u32_u24 v19, 32, v6
v_add_u32 v9, v18, v19
v_and_b32 v18, 31, v1
v_bfe_u32 v19, v1, 1, 3
v_add_u32 v20, 0, v5
v_xor_b32 v19, v19, v20
v_lshlrev_b32 v19, 4, v19
v_lshl_add_u32 v14, v18, 7, v19
v_and_b32 v18, 31, v1
v_bfe_u32 v19, v1, 1, 3
v_add_u32 v20, 2, v5
v_xor_b32 v19, v19, v20
v_lshlrev_b32 v19, 4, v19
v_lshl_add_u32 v15, v18, 7, v19
v_and_b32 v18, 31, v1
v_bfe_u32 v19, v1, 1, 3
v_add_u32 v20, 4, v5
v_xor_b32 v19, v19, v20
v_lshlrev_b32 v19, 4, v19
v_lshl_add_u32 v16, v18, 7, v19
v_and_b32 v18, 31, v1
v_bfe_u32 v19, v1, 1, 3
v_add_u32 v20, 6, v5
v_xor_b32 v19, v19, v20
v_lshlrev_b32 v19, 4, v19
v_lshl_add_u32 v17, v18, 7, v19
s_barrier
v_add_u32 v10, 16384, v9
ds_read_b128 v[60:63], v14 offset:4096
ds_read_b64_tr_b16 v[24:25], v10 offset:0
ds_read_b64_tr_b16 v[26:27], v10 offset:768
ds_read_b64_tr_b16 v[28:29], v10 offset:64
ds_read_b64_tr_b16 v[30:31], v10 offset:832
ds_read_b64_tr_b16 v[32:33], v10 offset:128
ds_read_b64_tr_b16 v[34:35], v10 offset:896
ds_read_b128 v[64:67], v15 offset:4096
ds_read_b64_tr_b16 v[36:37], v10 offset:3072
ds_read_b64_tr_b16 v[38:39], v10 offset:3840
ds_read_b64_tr_b16 v[40:41], v10 offset:3136
ds_read_b64_tr_b16 v[42:43], v10 offset:3904
ds_read_b64_tr_b16 v[44:45], v10 offset:3200
ds_read_b64_tr_b16 v[46:47], v10 offset:3968
ds_read_b128 v[68:71], v16 offset:4096
s_waitcnt lgkmcnt(12)
v_mfma_f32_32x32x16_bf16 v[72:87], v[24:27], v[60:63], 0
ds_read_b64_tr_b16 v[48:49], v10 offset:6144
ds_read_b64_tr_b16 v[50:51], v10 offset:6912
s_waitcnt lgkmcnt(12)
v_mfma_f32_32x32x16_bf16 v[88:103], v[28:31], v[60:63], 0
ds_read_b64_tr_b16 v[52:53], v10 offset:6208
ds_read_b64_tr_b16 v[54:55], v10 offset:6976
s_waitcnt lgkmcnt(12)
v_mfma_f32_32x32x16_bf16 v[104:119], v[32:35], v[60:63], 0
ds_read_b64_tr_b16 v[56:57], v10 offset:6272
ds_read_b64_tr_b16 v[58:59], v10 offset:7040
ds_read_b128 v[60:63], v17 offset:4096
s_waitcnt lgkmcnt(12)
v_mfma_f32_32x32x16_bf16 v[72:87], v[36:39], v[64:67], v[72:87]
ds_read_b64_tr_b16 v[24:25], v10 offset:9216
ds_read_b64_tr_b16 v[26:27], v10 offset:9984
s_waitcnt lgkmcnt(12)
v_mfma_f32_32x32x16_bf16 v[88:103], v[40:43], v[64:67], v[88:103]
ds_read_b64_tr_b16 v[28:29], v10 offset:9280
ds_read_b64_tr_b16 v[30:31], v10 offset:10048
s_waitcnt lgkmcnt(12)
v_mfma_f32_32x32x16_bf16 v[104:119], v[44:47], v[64:67], v[104:119]
ds_read_b64_tr_b16 v[32:33], v10 offset:9344
ds_read_b64_tr_b16 v[34:35], v10 offset:10112
s_barrier
v_add_u32 v11, 45056, v9
ds_read_b128 v[64:67], v14 offset:32768
s_waitcnt lgkmcnt(12)
v_mfma_f32_32x32x16_bf16 v[72:87], v[48:51], v[68:71], v[72:87]
ds_read_b64_tr_b16 v[36:37], v11 offset:0
ds_read_b64_tr_b16 v[38:39], v11 offset:768
s_waitcnt lgkmcnt(12)
v_mfma_f32_32x32x16_bf16 v[88:103], v[52:55], v[68:71], v[88:103]
ds_read_b64_tr_b16 v[40:41], v11 offset:64
ds_read_b64_tr_b16 v[42:43], v11 offset:832
s_waitcnt lgkmcnt(12)
v_mfma_f32_32x32x16_bf16 v[104:119], v[56:59], v[68:71], v[104:119]
ds_read_b64_tr_b16 v[44:45], v11 offset:128
ds_read_b64_tr_b16 v[46:47], v11 offset:896
ds_read_b128 v[68:71], v15 offset:32768
s_waitcnt lgkmcnt(12)
v_mfma_f32_32x32x16_bf16 v[72:87], v[24:27], v[60:63], v[72:87]
ds_read_b64_tr_b16 v[48:49], v11 offset:3072
ds_read_b64_tr_b16 v[50:51], v11 offset:3840
s_waitcnt lgkmcnt(12)
v_mfma_f32_32x32x16_bf16 v[88:103], v[28:31], v[60:63], v[88:103]
ds_read_b64_tr_b16 v[52:53], v11 offset:3136
ds_read_b64_tr_b16 v[54:55], v11 offset:3904
s_waitcnt lgkmcnt(12)
v_mfma_f32_32x32x16_bf16 v[104:119], v[32:35], v[60:63], v[104:119]
ds_read_b64_tr_b16 v[56:57], v11 offset:3200
ds_read_b64_tr_b16 v[58:59], v11 offset:3968
ds_read_b128 v[60:63], v16 offset:32768
s_waitcnt lgkmcnt(12)
v_mfma_f32_32x32x16_bf16 v[72:87], v[36:39], v[64:67], v[72:87]
ds_read_b64_tr_b16 v[24:25], v11 offset:6144
ds_read_b64_tr_b16 v[26:27], v11 offset:6912
s_waitcnt lgkmcnt(12)
v_mfma_f32_32x32x16_bf16 v[88:103], v[40:43], v[64:67], v[88:103]
ds_read_b64_tr_b16 v[28:29], v11 offset:6208
ds_read_b64_tr_b16 v[30:31], v11 offset:6976
s_waitcnt lgkmcnt(12)
v_mfma_f32_32x32x16_bf16 v[104:119], v[44:47], v[64:67], v[104:119]
ds_read_b64_tr_b16 v[32:33], v11 offset:6272
ds_read_b64_tr_b16 v[34:35], v11 offset:7040
ds_read_b128 v[64:67], v17 offset:32768
s_waitcnt lgkmcnt(12)
v_mfma_f32_32x32x16_bf16 v[72:87], v[48:51], v[68:71], v[72:87]
ds_read_b64_tr_b16 v[36:37], v11 offset:9216
ds_read_b64_tr_b16 v[38:39], v11 offset:9984
s_waitcnt lgkmcnt(12)
v_mfma_f32_32x32x16_bf16 v[88:103], v[52:55], v[68:71], v[88:103]
ds_read_b64_tr_b16 v[40:41], v11 offset:9280
ds_read_b64_tr_b16 v[42:43], v11 offset:10048
s_waitcnt lgkmcnt(12)
v_mfma_f32_32x32x16_bf16 v[104:119], v[56:59], v[68:71], v[104:119]
ds_read_b64_tr_b16 v[44:45], v11 offset:9344
ds_read_b64_tr_b16 v[46:47], v11 offset:10112
s_barrier
v_add_u32 v10, 73728, v9
v_add_u32 v18, 61440, v14
ds_read_b128 v[68:71], v18
s_waitcnt lgkmcnt(12)
v_mfma_f32_32x32x16_bf16 v[72:87], v[24:27], v[60:63], v[72:87]
ds_read_b64_tr_b16 v[48:49], v10 offset:0
ds_read_b64_tr_b16 v[50:51], v10 offset:768
s_waitcnt lgkmcnt(12)
v_mfma_f32_32x32x16_bf16 v[88:103], v[28:31], v[60:63], v[88:103]
ds_read_b64_tr_b16 v[52:53], v10 offset:64
ds_read_b64_tr_b16 v[54:55], v10 offset:832
s_waitcnt lgkmcnt(12)
v_mfma_f32_32x32x16_bf16 v[104:119], v[32:35], v[60:63], v[104:119]
ds_read_b64_tr_b16 v[56:57], v10 offset:128
ds_read_b64_tr_b16 v[58:59], v10 offset:896
v_add_u32 v19, 61440, v15
ds_read_b128 v[60:63], v19
s_waitcnt lgkmcnt(12)
v_mfma_f32_32x32x16_bf16 v[72:87], v[36:39], v[64:67], v[72:87]
ds_read_b64_tr_b16 v[24:25], v10 offset:3072
ds_read_b64_tr_b16 v[26:27], v10 offset:3840
s_waitcnt lgkmcnt(12)
v_mfma_f32_32x32x16_bf16 v[88:103], v[40:43], v[64:67], v[88:103]
ds_read_b64_tr_b16 v[28:29], v10 offset:3136
ds_read_b64_tr_b16 v[30:31], v10 offset:3904
s_waitcnt lgkmcnt(12)
v_mfma_f32_32x32x16_bf16 v[104:119], v[44:47], v[64:67], v[104:119]
ds_read_b64_tr_b16 v[32:33], v10 offset:3200
ds_read_b64_tr_b16 v[34:35], v10 offset:3968
v_add_u32 v18, 61440, v16
ds_read_b128 v[64:67], v18
s_waitcnt lgkmcnt(12)
v_mfma_f32_32x32x16_bf16 v[72:87], v[48:51], v[68:71], v[72:87]
ds_read_b64_tr_b16 v[36:37], v10 offset:6144
ds_read_b64_tr_b16 v[38:39], v10 offset:6912
s_waitcnt lgkmcnt(12)
v_mfma_f32_32x32x16_bf16 v[88:103], v[52:55], v[68:71], v[88:103]
ds_read_b64_tr_b16 v[40:41], v10 offset:6208
ds_read_b64_tr_b16 v[42:43], v10 offset:6976
s_waitcnt lgkmcnt(12)
v_mfma_f32_32x32x16_bf16 v[104:119], v[56:59], v[68:71], v[104:119]
ds_read_b64_tr_b16 v[44:45], v10 offset:6272
ds_read_b64_tr_b16 v[46:47], v10 offset:7040
v_add_u32 v19, 61440, v17
ds_read_b128 v[68:71], v19
s_waitcnt lgkmcnt(12)
v_mfma_f32_32x32x16_bf16 v[72:87], v[24:27], v[60:63], v[72:87]
ds_read_b64_tr_b16 v[48:49], v10 offset:9216
ds_read_b64_tr_b16 v[50:51], v10 offset:9984
s_waitcnt lgkmcnt(12)
v_mfma_f32_32x32x16_bf16 v[88:103], v[28:31], v[60:63], v[88:103]
ds_read_b64_tr_b16 v[52:53], v10 offset:9280
ds_read_b64_tr_b16 v[54:55], v10 offset:10048
s_waitcnt lgkmcnt(12)
v_mfma_f32_32x32x16_bf16 v[104:119], v[32:35], v[60:63], v[104:119]
ds_read_b64_tr_b16 v[56:57], v10 offset:9344
ds_read_b64_tr_b16 v[58:59], v10 offset:10112
s_barrier
v_add_u32 v11, 102400, v9
v_add_u32 v18, 90112, v14
ds_read_b128 v[60:63], v18
s_waitcnt lgkmcnt(12)
v_mfma_f32_32x32x16_bf16 v[72:87], v[36:39], v[64:67], v[72:87]
ds_read_b64_tr_b16 v[24:25], v11 offset:0
ds_read_b64_tr_b16 v[26:27], v11 offset:768
s_waitcnt lgkmcnt(12)
v_mfma_f32_32x32x16_bf16 v[88:103], v[40:43], v[64:67], v[88:103]
ds_read_b64_tr_b16 v[28:29], v11 offset:64
ds_read_b64_tr_b16 v[30:31], v11 offset:832
s_waitcnt lgkmcnt(12)
v_mfma_f32_32x32x16_bf16 v[104:119], v[44:47], v[64:67], v[104:119]
ds_read_b64_tr_b16 v[32:33], v11 offset:128
ds_read_b64_tr_b16 v[34:35], v11 offset:896
v_add_u32 v19, 90112, v15
ds_read_b128 v[64:67], v19
s_waitcnt lgkmcnt(12)
v_mfma_f32_32x32x16_bf16 v[72:87], v[48:51], v[68:71], v[72:87]
ds_read_b64_tr_b16 v[36:37], v11 offset:3072
ds_read_b64_tr_b16 v[38:39], v11 offset:3840
s_waitcnt lgkmcnt(12)
v_mfma_f32_32x32x16_bf16 v[88:103], v[52:55], v[68:71], v[88:103]
ds_read_b64_tr_b16 v[40:41], v11 offset:3136
ds_read_b64_tr_b16 v[42:43], v11 offset:3904
s_waitcnt lgkmcnt(12)
v_mfma_f32_32x32x16_bf16 v[104:119], v[56:59], v[68:71], v[104:119]
ds_read_b64_tr_b16 v[44:45], v11 offset:3200
ds_read_b64_tr_b16 v[46:47], v11 offset:3968
v_add_u32 v18, 90112, v16
ds_read_b128 v[68:71], v18
s_waitcnt lgkmcnt(12)
v_mfma_f32_32x32x16_bf16 v[72:87], v[24:27], v[60:63], v[72:87]
ds_read_b64_tr_b16 v[48:49], v11 offset:6144
ds_read_b64_tr_b16 v[50:51], v11 offset:6912
s_waitcnt lgkmcnt(12)
v_mfma_f32_32x32x16_bf16 v[88:103], v[28:31], v[60:63], v[88:103]
ds_read_b64_tr_b16 v[52:53], v11 offset:6208
ds_read_b64_tr_b16 v[54:55], v11 offset:6976
s_waitcnt lgkmcnt(12)
v_mfma_f32_32x32x16_bf16 v[104:119], v[32:35], v[60:63], v[104:119]
ds_read_b64_tr_b16 v[56:57], v11 offset:6272
ds_read_b64_tr_b16 v[58:59], v11 offset:7040
v_add_u32 v19, 90112, v17
ds_read_b128 v[60:63], v19
s_waitcnt lgkmcnt(12)
v_mfma_f32_32x32x16_bf16 v[72:87], v[36:39], v[64:67], v[72:87]
ds_read_b64_tr_b16 v[24:25], v11 offset:9216
ds_read_b64_tr_b16 v[26:27], v11 offset:9984
s_waitcnt lgkmcnt(12)
v_mfma_f32_32x32x16_bf16 v[88:103], v[40:43], v[64:67], v[88:103]
ds_read_b64_tr_b16 v[28:29], v11 offset:9280
ds_read_b64_tr_b16 v[30:31], v11 offset:10048
s_waitcnt lgkmcnt(12)
v_mfma_f32_32x32x16_bf16 v[104:119], v[44:47], v[64:67], v[104:119]
ds_read_b64_tr_b16 v[32:33], v11 offset:9344
ds_read_b64_tr_b16 v[34:35], v11 offset:10112
s_barrier
v_add_u32 v10, 131072, v9
v_add_u32 v18, 118784, v14
ds_read_b128 v[64:67], v18
s_waitcnt lgkmcnt(12)
v_mfma_f32_32x32x16_bf16 v[72:87], v[48:51], v[68:71], v[72:87]
ds_read_b64_tr_b16 v[36:37], v10 offset:0
ds_read_b64_tr_b16 v[38:39], v10 offset:768
s_waitcnt lgkmcnt(12)
v_mfma_f32_32x32x16_bf16 v[88:103], v[52:55], v[68:71], v[88:103]
ds_read_b64_tr_b16 v[40:41], v10 offset:64
ds_read_b64_tr_b16 v[42:43], v10 offset:832
s_waitcnt lgkmcnt(12)
v_mfma_f32_32x32x16_bf16 v[104:119], v[56:59], v[68:71], v[104:119]
ds_read_b64_tr_b16 v[44:45], v10 offset:128
ds_read_b64_tr_b16 v[46:47], v10 offset:896
v_add_u32 v19, 118784, v15
ds_read_b128 v[68:71], v19
s_waitcnt lgkmcnt(12)
v_mfma_f32_32x32x16_bf16 v[72:87], v[24:27], v[60:63], v[72:87]
ds_read_b64_tr_b16 v[48:49], v10 offset:3072
ds_read_b64_tr_b16 v[50:51], v10 offset:3840
s_waitcnt lgkmcnt(12)
v_mfma_f32_32x32x16_bf16 v[88:103], v[28:31], v[60:63], v[88:103]
ds_read_b64_tr_b16 v[52:53], v10 offset:3136
ds_read_b64_tr_b16 v[54:55], v10 offset:3904
s_waitcnt lgkmcnt(12)
v_mfma_f32_32x32x16_bf16 v[104:119], v[32:35], v[60:63], v[104:119]
ds_read_b64_tr_b16 v[56:57], v10 offset:3200
ds_read_b64_tr_b16 v[58:59], v10 offset:3968
v_add_u32 v18, 118784, v16
ds_read_b128 v[60:63], v18
s_waitcnt lgkmcnt(12)
v_mfma_f32_32x32x16_bf16 v[72:87], v[36:39], v[64:67], v[72:87]
ds_read_b64_tr_b16 v[24:25], v10 offset:6144
ds_read_b64_tr_b16 v[26:27], v10 offset:6912
s_waitcnt lgkmcnt(12)
v_mfma_f32_32x32x16_bf16 v[88:103], v[40:43], v[64:67], v[88:103]
ds_read_b64_tr_b16 v[28:29], v10 offset:6208
ds_read_b64_tr_b16 v[30:31], v10 offset:6976
s_waitcnt lgkmcnt(12)
v_mfma_f32_32x32x16_bf16 v[104:119], v[44:47], v[64:67], v[104:119]
ds_read_b64_tr_b16 v[32:33], v10 offset:6272
ds_read_b64_tr_b16 v[34:35], v10 offset:7040
v_add_u32 v19, 118784, v17
ds_read_b128 v[64:67], v19
s_waitcnt lgkmcnt(12)
v_mfma_f32_32x32x16_bf16 v[72:87], v[48:51], v[68:71], v[72:87]
ds_read_b64_tr_b16 v[36:37], v10 offset:9216
ds_read_b64_tr_b16 v[38:39], v10 offset:9984
s_waitcnt lgkmcnt(12)
v_mfma_f32_32x32x16_bf16 v[88:103], v[52:55], v[68:71], v[88:103]
ds_read_b64_tr_b16 v[40:41], v10 offset:9280
ds_read_b64_tr_b16 v[42:43], v10 offset:10048
s_waitcnt lgkmcnt(12)
v_mfma_f32_32x32x16_bf16 v[104:119], v[56:59], v[68:71], v[104:119]
ds_read_b64_tr_b16 v[44:45], v10 offset:9344
ds_read_b64_tr_b16 v[46:47], v10 offset:10112
s_barrier
v_add_u32 v11, 16384, v9
ds_read_b128 v[68:71], v14 offset:4096
s_waitcnt lgkmcnt(12)
v_mfma_f32_32x32x16_bf16 v[72:87], v[24:27], v[60:63], v[72:87]
ds_read_b64_tr_b16 v[48:49], v11 offset:0
ds_read_b64_tr_b16 v[50:51], v11 offset:768
s_waitcnt lgkmcnt(12)
v_mfma_f32_32x32x16_bf16 v[88:103], v[28:31], v[60:63], v[88:103]
ds_read_b64_tr_b16 v[52:53], v11 offset:64
ds_read_b64_tr_b16 v[54:55], v11 offset:832
s_waitcnt lgkmcnt(12)
v_mfma_f32_32x32x16_bf16 v[104:119], v[32:35], v[60:63], v[104:119]
ds_read_b64_tr_b16 v[56:57], v11 offset:128
ds_read_b64_tr_b16 v[58:59], v11 offset:896
ds_read_b128 v[60:63], v15 offset:4096
s_waitcnt lgkmcnt(12)
v_mfma_f32_32x32x16_bf16 v[72:87], v[36:39], v[64:67], v[72:87]
ds_read_b64_tr_b16 v[24:25], v11 offset:3072
ds_read_b64_tr_b16 v[26:27], v11 offset:3840
s_waitcnt lgkmcnt(12)
v_mfma_f32_32x32x16_bf16 v[88:103], v[40:43], v[64:67], v[88:103]
ds_read_b64_tr_b16 v[28:29], v11 offset:3136
ds_read_b64_tr_b16 v[30:31], v11 offset:3904
s_waitcnt lgkmcnt(12)
v_mfma_f32_32x32x16_bf16 v[104:119], v[44:47], v[64:67], v[104:119]
ds_read_b64_tr_b16 v[32:33], v11 offset:3200
ds_read_b64_tr_b16 v[34:35], v11 offset:3968
ds_read_b128 v[64:67], v16 offset:4096
s_waitcnt lgkmcnt(12)
v_mfma_f32_32x32x16_bf16 v[72:87], v[48:51], v[68:71], v[72:87]
ds_read_b64_tr_b16 v[36:37], v11 offset:6144
ds_read_b64_tr_b16 v[38:39], v11 offset:6912
s_waitcnt lgkmcnt(12)
v_mfma_f32_32x32x16_bf16 v[88:103], v[52:55], v[68:71], v[88:103]
ds_read_b64_tr_b16 v[40:41], v11 offset:6208
ds_read_b64_tr_b16 v[42:43], v11 offset:6976
s_waitcnt lgkmcnt(12)
v_mfma_f32_32x32x16_bf16 v[104:119], v[56:59], v[68:71], v[104:119]
ds_read_b64_tr_b16 v[44:45], v11 offset:6272
ds_read_b64_tr_b16 v[46:47], v11 offset:7040
ds_read_b128 v[68:71], v17 offset:4096
s_waitcnt lgkmcnt(12)
v_mfma_f32_32x32x16_bf16 v[72:87], v[24:27], v[60:63], v[72:87]
ds_read_b64_tr_b16 v[48:49], v11 offset:9216
ds_read_b64_tr_b16 v[50:51], v11 offset:9984
s_waitcnt lgkmcnt(12)
v_mfma_f32_32x32x16_bf16 v[88:103], v[28:31], v[60:63], v[88:103]
ds_read_b64_tr_b16 v[52:53], v11 offset:9280
ds_read_b64_tr_b16 v[54:55], v11 offset:10048
s_waitcnt lgkmcnt(12)
v_mfma_f32_32x32x16_bf16 v[104:119], v[32:35], v[60:63], v[104:119]
ds_read_b64_tr_b16 v[56:57], v11 offset:9344
ds_read_b64_tr_b16 v[58:59], v11 offset:10112
s_barrier
v_add_u32 v10, 45056, v9
ds_read_b128 v[60:63], v14 offset:32768
s_waitcnt lgkmcnt(12)
v_mfma_f32_32x32x16_bf16 v[72:87], v[36:39], v[64:67], v[72:87]
ds_read_b64_tr_b16 v[24:25], v10 offset:0
ds_read_b64_tr_b16 v[26:27], v10 offset:768
s_waitcnt lgkmcnt(12)
v_mfma_f32_32x32x16_bf16 v[88:103], v[40:43], v[64:67], v[88:103]
ds_read_b64_tr_b16 v[28:29], v10 offset:64
ds_read_b64_tr_b16 v[30:31], v10 offset:832
s_waitcnt lgkmcnt(12)
v_mfma_f32_32x32x16_bf16 v[104:119], v[44:47], v[64:67], v[104:119]
ds_read_b64_tr_b16 v[32:33], v10 offset:128
ds_read_b64_tr_b16 v[34:35], v10 offset:896
ds_read_b128 v[64:67], v15 offset:32768
s_waitcnt lgkmcnt(12)
v_mfma_f32_32x32x16_bf16 v[72:87], v[48:51], v[68:71], v[72:87]
ds_read_b64_tr_b16 v[36:37], v10 offset:3072
ds_read_b64_tr_b16 v[38:39], v10 offset:3840
s_waitcnt lgkmcnt(12)
v_mfma_f32_32x32x16_bf16 v[88:103], v[52:55], v[68:71], v[88:103]
ds_read_b64_tr_b16 v[40:41], v10 offset:3136
ds_read_b64_tr_b16 v[42:43], v10 offset:3904
s_waitcnt lgkmcnt(12)
v_mfma_f32_32x32x16_bf16 v[104:119], v[56:59], v[68:71], v[104:119]
ds_read_b64_tr_b16 v[44:45], v10 offset:3200
ds_read_b64_tr_b16 v[46:47], v10 offset:3968
ds_read_b128 v[68:71], v16 offset:32768
s_waitcnt lgkmcnt(12)
v_mfma_f32_32x32x16_bf16 v[72:87], v[24:27], v[60:63], v[72:87]
ds_read_b64_tr_b16 v[48:49], v10 offset:6144
ds_read_b64_tr_b16 v[50:51], v10 offset:6912
s_waitcnt lgkmcnt(12)
v_mfma_f32_32x32x16_bf16 v[88:103], v[28:31], v[60:63], v[88:103]
ds_read_b64_tr_b16 v[52:53], v10 offset:6208
ds_read_b64_tr_b16 v[54:55], v10 offset:6976
s_waitcnt lgkmcnt(12)
v_mfma_f32_32x32x16_bf16 v[104:119], v[32:35], v[60:63], v[104:119]
ds_read_b64_tr_b16 v[56:57], v10 offset:6272
ds_read_b64_tr_b16 v[58:59], v10 offset:7040
ds_read_b128 v[60:63], v17 offset:32768
s_waitcnt lgkmcnt(12)
v_mfma_f32_32x32x16_bf16 v[72:87], v[36:39], v[64:67], v[72:87]
ds_read_b64_tr_b16 v[24:25], v10 offset:9216
ds_read_b64_tr_b16 v[26:27], v10 offset:9984
s_waitcnt lgkmcnt(12)
v_mfma_f32_32x32x16_bf16 v[88:103], v[40:43], v[64:67], v[88:103]
ds_read_b64_tr_b16 v[28:29], v10 offset:9280
ds_read_b64_tr_b16 v[30:31], v10 offset:10048
s_waitcnt lgkmcnt(12)
v_mfma_f32_32x32x16_bf16 v[104:119], v[44:47], v[64:67], v[104:119]
ds_read_b64_tr_b16 v[32:33], v10 offset:9344
ds_read_b64_tr_b16 v[34:35], v10 offset:10112
s_barrier
v_add_u32 v11, 73728, v9
v_add_u32 v18, 61440, v14
ds_read_b128 v[64:67], v18
s_waitcnt lgkmcnt(12)
v_mfma_f32_32x32x16_bf16 v[72:87], v[48:51], v[68:71], v[72:87]
ds_read_b64_tr_b16 v[36:37], v11 offset:0
ds_read_b64_tr_b16 v[38:39], v11 offset:768
s_waitcnt lgkmcnt(12)
v_mfma_f32_32x32x16_bf16 v[88:103], v[52:55], v[68:71], v[88:103]
ds_read_b64_tr_b16 v[40:41], v11 offset:64
ds_read_b64_tr_b16 v[42:43], v11 offset:832
s_waitcnt lgkmcnt(12)
v_mfma_f32_32x32x16_bf16 v[104:119], v[56:59], v[68:71], v[104:119]
ds_read_b64_tr_b16 v[44:45], v11 offset:128
ds_read_b64_tr_b16 v[46:47], v11 offset:896
v_add_u32 v19, 61440, v15
ds_read_b128 v[68:71], v19
s_waitcnt lgkmcnt(12)
v_mfma_f32_32x32x16_bf16 v[72:87], v[24:27], v[60:63], v[72:87]
ds_read_b64_tr_b16 v[48:49], v11 offset:3072
ds_read_b64_tr_b16 v[50:51], v11 offset:3840
s_waitcnt lgkmcnt(12)
v_mfma_f32_32x32x16_bf16 v[88:103], v[28:31], v[60:63], v[88:103]
ds_read_b64_tr_b16 v[52:53], v11 offset:3136
ds_read_b64_tr_b16 v[54:55], v11 offset:3904
s_waitcnt lgkmcnt(12)
v_mfma_f32_32x32x16_bf16 v[104:119], v[32:35], v[60:63], v[104:119]
ds_read_b64_tr_b16 v[56:57], v11 offset:3200
ds_read_b64_tr_b16 v[58:59], v11 offset:3968
v_add_u32 v18, 61440, v16
ds_read_b128 v[60:63], v18
s_waitcnt lgkmcnt(12)
v_mfma_f32_32x32x16_bf16 v[72:87], v[36:39], v[64:67], v[72:87]
ds_read_b64_tr_b16 v[24:25], v11 offset:6144
ds_read_b64_tr_b16 v[26:27], v11 offset:6912
s_waitcnt lgkmcnt(12)
v_mfma_f32_32x32x16_bf16 v[88:103], v[40:43], v[64:67], v[88:103]
ds_read_b64_tr_b16 v[28:29], v11 offset:6208
ds_read_b64_tr_b16 v[30:31], v11 offset:6976
s_waitcnt lgkmcnt(12)
v_mfma_f32_32x32x16_bf16 v[104:119], v[44:47], v[64:67], v[104:119]
ds_read_b64_tr_b16 v[32:33], v11 offset:6272
ds_read_b64_tr_b16 v[34:35], v11 offset:7040
v_add_u32 v19, 61440, v17
ds_read_b128 v[64:67], v19
s_waitcnt lgkmcnt(12)
v_mfma_f32_32x32x16_bf16 v[72:87], v[48:51], v[68:71], v[72:87]
ds_read_b64_tr_b16 v[36:37], v11 offset:9216
ds_read_b64_tr_b16 v[38:39], v11 offset:9984
s_waitcnt lgkmcnt(12)
v_mfma_f32_32x32x16_bf16 v[88:103], v[52:55], v[68:71], v[88:103]
ds_read_b64_tr_b16 v[40:41], v11 offset:9280
ds_read_b64_tr_b16 v[42:43], v11 offset:10048
s_waitcnt lgkmcnt(12)
v_mfma_f32_32x32x16_bf16 v[104:119], v[56:59], v[68:71], v[104:119]
ds_read_b64_tr_b16 v[44:45], v11 offset:9344
ds_read_b64_tr_b16 v[46:47], v11 offset:10112
s_waitcnt lgkmcnt(11)
v_mfma_f32_32x32x16_bf16 v[72:87], v[24:27], v[60:63], v[72:87]
s_waitcnt lgkmcnt(9)
v_mfma_f32_32x32x16_bf16 v[88:103], v[28:31], v[60:63], v[88:103]
s_waitcnt lgkmcnt(7)
v_mfma_f32_32x32x16_bf16 v[104:119], v[32:35], v[60:63], v[104:119]
s_waitcnt lgkmcnt(4)
v_mfma_f32_32x32x16_bf16 v[72:87], v[36:39], v[64:67], v[72:87]
s_waitcnt lgkmcnt(2)
v_mfma_f32_32x32x16_bf16 v[88:103], v[40:43], v[64:67], v[88:103]
s_waitcnt lgkmcnt(0)
v_mfma_f32_32x32x16_bf16 v[104:119], v[44:47], v[64:67], v[104:119]
s_barrier
v_and_b32 v134, 31, v1
v_lshlrev_b32 v134, 3, v134
v_add_u32 v134, 2304, v134
ds_read_b64 v[132:133], v134
v_lshlrev_b32 v137, 4, v5
v_add_u32 v137, 0, v137
ds_read_b128 v[24:27], v137 offset:0
ds_read_b128 v[28:31], v137 offset:32
ds_read_b128 v[32:35], v137 offset:64
ds_read_b128 v[36:39], v137 offset:96
s_lshl_b32 s7, s4, 2
s_add_u32 s7, s7, 1
v_bfe_u32 v121, v1, 4, 1
v_bfe_u32 v122, v1, 2, 1
v_lshlrev_b32 v122, 3, v122
v_lshl_add_u32 v122, v121, 4, v122
v_and_b32 v123, 3, v1
v_add_u32 v122, v122, v123
v_bfe_u32 v123, v1, 3, 1
v_lshl_add_u32 v122, v123, 2, v122
v_lshlrev_b32 v122, 1, v122
v_mul_u32_u24 v123, 320, v5
v_add_u32 v128, v122, v123
v_add_u32 v128, 6656, v128
v_lshl_add_u32 v122, v5, 4, v4
v_mul_u32_u24 v122, 80, v122
v_lshl_add_u32 v122, v121, 4, v122
v_add_u32 v129, 6656, v122
v_and_b32 v122, 31, v1
v_lshlrev_b32 v122, 4, v122
v_lshl_add_u32 v130, v5, 16, v122
ds_read_b128 v[40:43], v137 offset:128
ds_read_b128 v[44:47], v137 offset:160
ds_read_b128 v[48:51], v137 offset:192
ds_read_b128 v[52:55], v137 offset:224
s_mul_i32 s8, s5, 3
s_add_u32 s8, s8, 0
s_lshr_b32 s9, s8, 4
s_and_b32 s10, s8, 15
s_lshl_b32 s10, s10, 17
s_cmp_eq_u32 s9, 0
s_cselect_b32 s11, 0x3eb8aa3b, 0x3f800000
s_lshr_b32 s12, s9, 0
s_mul_i32 s12, s9, 2097152
s_add_u32 s12, s12, 2097152
s_add_u32 s12, s12, s10
s_lshl_b32 s13, s7, 10
s_add_u32 s12, s12, s13
s_waitcnt lgkmcnt(8)
v_mul_f32 v138, s11, v133
s_waitcnt lgkmcnt(7)
v_pk_fma_f32 v[72:73], v[24:25], v[132:133], v[72:73] op_sel_hi:[1,0,1]
v_pk_fma_f32 v[74:75], v[26:27], v[132:133], v[74:75] op_sel_hi:[1,0,1]
s_waitcnt lgkmcnt(6)
v_pk_fma_f32 v[76:77], v[28:29], v[132:133], v[76:77] op_sel_hi:[1,0,1]
v_pk_fma_f32 v[78:79], v[30:31], v[132:133], v[78:79] op_sel_hi:[1,0,1]
s_waitcnt lgkmcnt(5)
v_pk_fma_f32 v[80:81], v[32:33], v[132:133], v[80:81] op_sel_hi:[1,0,1]
v_pk_fma_f32 v[82:83], v[34:35], v[132:133], v[82:83] op_sel_hi:[1,0,1]
s_waitcnt lgkmcnt(4)
v_pk_fma_f32 v[84:85], v[36:37], v[132:133], v[84:85] op_sel_hi:[1,0,1]
v_pk_fma_f32 v[86:87], v[38:39], v[132:133], v[86:87] op_sel_hi:[1,0,1]
v_pk_mul_f32 v[72:73], v[72:73], v[138:139] op_sel_hi:[1,0]
v_pk_mul_f32 v[74:75], v[74:75], v[138:139] op_sel_hi:[1,0]
v_pk_mul_f32 v[76:77], v[76:77], v[138:139] op_sel_hi:[1,0]
v_pk_mul_f32 v[78:79], v[78:79], v[138:139] op_sel_hi:[1,0]
v_pk_mul_f32 v[80:81], v[80:81], v[138:139] op_sel_hi:[1,0]
v_pk_mul_f32 v[82:83], v[82:83], v[138:139] op_sel_hi:[1,0]
v_pk_mul_f32 v[84:85], v[84:85], v[138:139] op_sel_hi:[1,0]
v_pk_mul_f32 v[86:87], v[86:87], v[138:139] op_sel_hi:[1,0]
s_cmp_eq_u32 s9, 2
s_cbranch_scc1 k1_kernel_w1_t0_v
v_cvt_pk_bf16_f32 v120, v72, v73
v_cvt_pk_bf16_f32 v121, v74, v75
v_cvt_pk_bf16_f32 v122, v76, v77
v_cvt_pk_bf16_f32 v123, v78, v79
s_nop 0
v_permlane32_swap_b32 v120, v122
v_permlane32_swap_b32 v121, v123
v_cvt_pk_bf16_f32 v124, v80, v81
v_cvt_pk_bf16_f32 v125, v82, v83
v_cvt_pk_bf16_f32 v126, v84, v85
v_cvt_pk_bf16_f32 v127, v86, v87
s_nop 0
v_permlane32_swap_b32 v124, v126
v_permlane32_swap_b32 v125, v127
buffer_store_dwordx4 v[120:123], v3, s[52:55], s12 offen sc0 sc1
s_add_u32 s12, s12, 65536
buffer_store_dwordx4 v[124:127], v3, s[52:55], s12 offen sc0 sc1
s_branch k1_kernel_w1_t0_j
k1_kernel_w1_t0_v:
v_cvt_pk_bf16_f32 v120, v72, v73
v_cvt_pk_bf16_f32 v121, v74, v75
v_cvt_pk_bf16_f32 v122, v76, v77
v_cvt_pk_bf16_f32 v123, v78, v79
v_cvt_pk_bf16_f32 v124, v80, v81
v_cvt_pk_bf16_f32 v125, v82, v83
v_cvt_pk_bf16_f32 v126, v84, v85
v_cvt_pk_bf16_f32 v127, v86, v87
ds_write_b16 v128, v120 offset:0
ds_write_b16_d16_hi v128, v120 offset:80
ds_write_b16 v128, v121 offset:160
ds_write_b16_d16_hi v128, v121 offset:240
ds_write_b16 v128, v122 offset:640
ds_write_b16_d16_hi v128, v122 offset:720
ds_write_b16 v128, v123 offset:800
ds_write_b16_d16_hi v128, v123 offset:880
ds_write_b16 v128, v124 offset:1280
ds_write_b16_d16_hi v128, v124 offset:1360
ds_write_b16 v128, v125 offset:1440
s_waitcnt lgkmcnt(13)
ds_write_b16_d16_hi v128, v125 offset:1520
ds_write_b16 v128, v126 offset:1920
s_waitcnt lgkmcnt(13)
ds_write_b16_d16_hi v128, v126 offset:2000
ds_write_b16 v128, v127 offset:2080
s_waitcnt lgkmcnt(13)
ds_write_b16_d16_hi v128, v127 offset:2160
ds_read_b128 v[120:123], v129
s_waitcnt lgkmcnt(13)
ds_read_b128 v[124:127], v129 offset:32
s_waitcnt lgkmcnt(1)
buffer_store_dwordx4 v[120:123], v130, s[52:55], s12 offen sc0 sc1
s_waitcnt lgkmcnt(0)
buffer_store_dwordx4 v[124:127], v130, s[52:55], s12 offen offset:512 sc0 sc1
k1_kernel_w1_t0_j:
s_waitcnt lgkmcnt(0)
ds_read_b128 v[24:27], v137 offset:256
ds_read_b128 v[28:31], v137 offset:288
ds_read_b128 v[32:35], v137 offset:320
ds_read_b128 v[36:39], v137 offset:352
s_mul_i32 s8, s5, 3
s_add_u32 s8, s8, 1
s_lshr_b32 s9, s8, 4
s_and_b32 s10, s8, 15
s_lshl_b32 s10, s10, 17
s_cmp_eq_u32 s9, 0
s_cselect_b32 s11, 0x3eb8aa3b, 0x3f800000
s_lshr_b32 s12, s9, 0
s_mul_i32 s12, s9, 2097152
s_add_u32 s12, s12, 2097152
s_add_u32 s12, s12, s10
s_lshl_b32 s13, s7, 10
s_add_u32 s12, s12, s13
v_mul_f32 v138, s11, v133
v_pk_fma_f32 v[88:89], v[40:41], v[132:133], v[88:89] op_sel_hi:[1,0,1]
v_pk_fma_f32 v[90:91], v[42:43], v[132:133], v[90:91] op_sel_hi:[1,0,1]
v_pk_fma_f32 v[92:93], v[44:45], v[132:133], v[92:93] op_sel_hi:[1,0,1]
v_pk_fma_f32 v[94:95], v[46:47], v[132:133], v[94:95] op_sel_hi:[1,0,1]
v_pk_fma_f32 v[96:97], v[48:49], v[132:133], v[96:97] op_sel_hi:[1,0,1]
v_pk_fma_f32 v[98:99], v[50:51], v[132:133], v[98:99] op_sel_hi:[1,0,1]
v_pk_fma_f32 v[100:101], v[52:53], v[132:133], v[100:101] op_sel_hi:[1,0,1]
v_pk_fma_f32 v[102:103], v[54:55], v[132:133], v[102:103] op_sel_hi:[1,0,1]
v_pk_mul_f32 v[88:89], v[88:89], v[138:139] op_sel_hi:[1,0]
v_pk_mul_f32 v[90:91], v[90:91], v[138:139] op_sel_hi:[1,0]
v_pk_mul_f32 v[92:93], v[92:93], v[138:139] op_sel_hi:[1,0]
v_pk_mul_f32 v[94:95], v[94:95], v[138:139] op_sel_hi:[1,0]
v_pk_mul_f32 v[96:97], v[96:97], v[138:139] op_sel_hi:[1,0]
v_pk_mul_f32 v[98:99], v[98:99], v[138:139] op_sel_hi:[1,0]
v_pk_mul_f32 v[100:101], v[100:101], v[138:139] op_sel_hi:[1,0]
v_pk_mul_f32 v[102:103], v[102:103], v[138:139] op_sel_hi:[1,0]
s_cmp_eq_u32 s9, 2
s_cbranch_scc1 k1_kernel_w1_t1_v
v_cvt_pk_bf16_f32 v120, v88, v89
v_cvt_pk_bf16_f32 v121, v90, v91
v_cvt_pk_bf16_f32 v122, v92, v93
v_cvt_pk_bf16_f32 v123, v94, v95
s_nop 0
v_permlane32_swap_b32 v120, v122
v_permlane32_swap_b32 v121, v123
v_cvt_pk_bf16_f32 v124, v96, v97
v_cvt_pk_bf16_f32 v125, v98, v99
v_cvt_pk_bf16_f32 v126, v100, v101
v_cvt_pk_bf16_f32 v127, v102, v103
s_nop 0
v_permlane32_swap_b32 v124, v126
v_permlane32_swap_b32 v125, v127
buffer_store_dwordx4 v[120:123], v3, s[52:55], s12 offen sc0 sc1
s_add_u32 s12, s12, 65536
buffer_store_dwordx4 v[124:127], v3, s[52:55], s12 offen sc0 sc1
s_branch k1_kernel_w1_t1_j
k1_kernel_w1_t1_v:
v_cvt_pk_bf16_f32 v120, v88, v89
v_cvt_pk_bf16_f32 v121, v90, v91
v_cvt_pk_bf16_f32 v122, v92, v93
v_cvt_pk_bf16_f32 v123, v94, v95
v_cvt_pk_bf16_f32 v124, v96, v97
v_cvt_pk_bf16_f32 v125, v98, v99
v_cvt_pk_bf16_f32 v126, v100, v101
v_cvt_pk_bf16_f32 v127, v102, v103
ds_write_b16 v128, v120 offset:0
ds_write_b16_d16_hi v128, v120 offset:80
ds_write_b16 v128, v121 offset:160
ds_write_b16_d16_hi v128, v121 offset:240
ds_write_b16 v128, v122 offset:640
ds_write_b16_d16_hi v128, v122 offset:720
ds_write_b16 v128, v123 offset:800
ds_write_b16_d16_hi v128, v123 offset:880
ds_write_b16 v128, v124 offset:1280
ds_write_b16_d16_hi v128, v124 offset:1360
ds_write_b16 v128, v125 offset:1440
s_waitcnt lgkmcnt(13)
ds_write_b16_d16_hi v128, v125 offset:1520
ds_write_b16 v128, v126 offset:1920
s_waitcnt lgkmcnt(13)
ds_write_b16_d16_hi v128, v126 offset:2000
ds_write_b16 v128, v127 offset:2080
s_waitcnt lgkmcnt(13)
ds_write_b16_d16_hi v128, v127 offset:2160
ds_read_b128 v[120:123], v129
s_waitcnt lgkmcnt(13)
ds_read_b128 v[124:127], v129 offset:32
s_waitcnt lgkmcnt(1)
buffer_store_dwordx4 v[120:123], v130, s[52:55], s12 offen sc0 sc1
s_waitcnt lgkmcnt(0)
buffer_store_dwordx4 v[124:127], v130, s[52:55], s12 offen offset:512 sc0 sc1
k1_kernel_w1_t1_j:
s_waitcnt lgkmcnt(0)
s_mul_i32 s8, s5, 3
s_add_u32 s8, s8, 2
s_lshr_b32 s9, s8, 4
s_and_b32 s10, s8, 15
s_lshl_b32 s10, s10, 17
s_cmp_eq_u32 s9, 0
s_cselect_b32 s11, 0x3eb8aa3b, 0x3f800000
s_lshr_b32 s12, s9, 0
s_mul_i32 s12, s9, 2097152
s_add_u32 s12, s12, 2097152
s_add_u32 s12, s12, s10
s_lshl_b32 s13, s7, 10
s_add_u32 s12, s12, s13
v_mul_f32 v138, s11, v133
v_pk_fma_f32 v[104:105], v[24:25], v[132:133], v[104:105] op_sel_hi:[1,0,1]
v_pk_fma_f32 v[106:107], v[26:27], v[132:133], v[106:107] op_sel_hi:[1,0,1]
v_pk_fma_f32 v[108:109], v[28:29], v[132:133], v[108:109] op_sel_hi:[1,0,1]
v_pk_fma_f32 v[110:111], v[30:31], v[132:133], v[110:111] op_sel_hi:[1,0,1]
v_pk_fma_f32 v[112:113], v[32:33], v[132:133], v[112:113] op_sel_hi:[1,0,1]
v_pk_fma_f32 v[114:115], v[34:35], v[132:133], v[114:115] op_sel_hi:[1,0,1]
v_pk_fma_f32 v[116:117], v[36:37], v[132:133], v[116:117] op_sel_hi:[1,0,1]
v_pk_fma_f32 v[118:119], v[38:39], v[132:133], v[118:119] op_sel_hi:[1,0,1]
v_pk_mul_f32 v[104:105], v[104:105], v[138:139] op_sel_hi:[1,0]
v_pk_mul_f32 v[106:107], v[106:107], v[138:139] op_sel_hi:[1,0]
v_pk_mul_f32 v[108:109], v[108:109], v[138:139] op_sel_hi:[1,0]
v_pk_mul_f32 v[110:111], v[110:111], v[138:139] op_sel_hi:[1,0]
v_pk_mul_f32 v[112:113], v[112:113], v[138:139] op_sel_hi:[1,0]
v_pk_mul_f32 v[114:115], v[114:115], v[138:139] op_sel_hi:[1,0]
v_pk_mul_f32 v[116:117], v[116:117], v[138:139] op_sel_hi:[1,0]
v_pk_mul_f32 v[118:119], v[118:119], v[138:139] op_sel_hi:[1,0]
s_cmp_eq_u32 s9, 2
s_cbranch_scc1 k1_kernel_w1_t2_v
v_cvt_pk_bf16_f32 v120, v104, v105
v_cvt_pk_bf16_f32 v121, v106, v107
v_cvt_pk_bf16_f32 v122, v108, v109
v_cvt_pk_bf16_f32 v123, v110, v111
s_nop 0
v_permlane32_swap_b32 v120, v122
v_permlane32_swap_b32 v121, v123
v_cvt_pk_bf16_f32 v124, v112, v113
v_cvt_pk_bf16_f32 v125, v114, v115
v_cvt_pk_bf16_f32 v126, v116, v117
v_cvt_pk_bf16_f32 v127, v118, v119
s_nop 0
v_permlane32_swap_b32 v124, v126
v_permlane32_swap_b32 v125, v127
buffer_store_dwordx4 v[120:123], v3, s[52:55], s12 offen sc0 sc1
s_add_u32 s12, s12, 65536
buffer_store_dwordx4 v[124:127], v3, s[52:55], s12 offen sc0 sc1
s_branch k1_kernel_w1_t2_j
k1_kernel_w1_t2_v:
v_cvt_pk_bf16_f32 v120, v104, v105
v_cvt_pk_bf16_f32 v121, v106, v107
v_cvt_pk_bf16_f32 v122, v108, v109
v_cvt_pk_bf16_f32 v123, v110, v111
v_cvt_pk_bf16_f32 v124, v112, v113
v_cvt_pk_bf16_f32 v125, v114, v115
v_cvt_pk_bf16_f32 v126, v116, v117
v_cvt_pk_bf16_f32 v127, v118, v119
ds_write_b16 v128, v120 offset:0
ds_write_b16_d16_hi v128, v120 offset:80
ds_write_b16 v128, v121 offset:160
ds_write_b16_d16_hi v128, v121 offset:240
ds_write_b16 v128, v122 offset:640
ds_write_b16_d16_hi v128, v122 offset:720
ds_write_b16 v128, v123 offset:800
ds_write_b16_d16_hi v128, v123 offset:880
ds_write_b16 v128, v124 offset:1280
ds_write_b16_d16_hi v128, v124 offset:1360
ds_write_b16 v128, v125 offset:1440
ds_write_b16_d16_hi v128, v125 offset:1520
ds_write_b16 v128, v126 offset:1920
ds_write_b16_d16_hi v128, v126 offset:2000
ds_write_b16 v128, v127 offset:2080
s_waitcnt lgkmcnt(13)
ds_write_b16_d16_hi v128, v127 offset:2160
ds_read_b128 v[120:123], v129
s_waitcnt lgkmcnt(13)
ds_read_b128 v[124:127], v129 offset:32
s_waitcnt lgkmcnt(1)
buffer_store_dwordx4 v[120:123], v130, s[52:55], s12 offen sc0 sc1
s_waitcnt lgkmcnt(0)
buffer_store_dwordx4 v[124:127], v130, s[52:55], s12 offen offset:512 sc0 sc1
k1_kernel_w1_t2_j:
s_waitcnt lgkmcnt(0)
s_waitcnt vmcnt(0)
s_branch k1_kernel_end
k1_kernel_w2:
v_mul_u32_u24 v18, 192, v7
v_lshl_add_u32 v18, v8, 3, v18
v_mul_u32_u24 v19, 32, v6
v_add_u32 v9, v18, v19
v_and_b32 v18, 31, v1
v_bfe_u32 v19, v1, 1, 3
v_add_u32 v20, 0, v5
v_xor_b32 v19, v19, v20
v_lshlrev_b32 v19, 4, v19
v_lshl_add_u32 v14, v18, 7, v19
v_and_b32 v18, 31, v1
v_bfe_u32 v19, v1, 1, 3
v_add_u32 v20, 2, v5
v_xor_b32 v19, v19, v20
v_lshlrev_b32 v19, 4, v19
v_lshl_add_u32 v15, v18, 7, v19
v_and_b32 v18, 31, v1
v_bfe_u32 v19, v1, 1, 3
v_add_u32 v20, 4, v5
v_xor_b32 v19, v19, v20
v_lshlrev_b32 v19, 4, v19
v_lshl_add_u32 v16, v18, 7, v19
v_and_b32 v18, 31, v1
v_bfe_u32 v19, v1, 1, 3
v_add_u32 v20, 6, v5
v_xor_b32 v19, v19, v20
v_lshlrev_b32 v19, 4, v19
v_lshl_add_u32 v17, v18, 7, v19
s_barrier
v_add_u32 v10, 16384, v9
ds_read_b128 v[60:63], v14 offset:8192
ds_read_b64_tr_b16 v[24:25], v10 offset:0
ds_read_b64_tr_b16 v[26:27], v10 offset:768
ds_read_b64_tr_b16 v[28:29], v10 offset:64
ds_read_b64_tr_b16 v[30:31], v10 offset:832
ds_read_b64_tr_b16 v[32:33], v10 offset:128
ds_read_b64_tr_b16 v[34:35], v10 offset:896
ds_read_b128 v[64:67], v15 offset:8192
ds_read_b64_tr_b16 v[36:37], v10 offset:3072
ds_read_b64_tr_b16 v[38:39], v10 offset:3840
ds_read_b64_tr_b16 v[40:41], v10 offset:3136
ds_read_b64_tr_b16 v[42:43], v10 offset:3904
ds_read_b64_tr_b16 v[44:45], v10 offset:3200
ds_read_b64_tr_b16 v[46:47], v10 offset:3968
ds_read_b128 v[68:71], v16 offset:8192
s_waitcnt lgkmcnt(12)
v_mfma_f32_32x32x16_bf16 v[72:87], v[24:27], v[60:63], 0
ds_read_b64_tr_b16 v[48:49], v10 offset:6144
ds_read_b64_tr_b16 v[50:51], v10 offset:6912
s_waitcnt lgkmcnt(12)
v_mfma_f32_32x32x16_bf16 v[88:103], v[28:31], v[60:63], 0
ds_read_b64_tr_b16 v[52:53], v10 offset:6208
ds_read_b64_tr_b16 v[54:55], v10 offset:6976
s_waitcnt lgkmcnt(12)
v_mfma_f32_32x32x16_bf16 v[104:119], v[32:35], v[60:63], 0
ds_read_b64_tr_b16 v[56:57], v10 offset:6272
ds_read_b64_tr_b16 v[58:59], v10 offset:7040
ds_read_b128 v[60:63], v17 offset:8192
s_waitcnt lgkmcnt(12)
v_mfma_f32_32x32x16_bf16 v[72:87], v[36:39], v[64:67], v[72:87]
ds_read_b64_tr_b16 v[24:25], v10 offset:9216
ds_read_b64_tr_b16 v[26:27], v10 offset:9984
s_waitcnt lgkmcnt(12)
v_mfma_f32_32x32x16_bf16 v[88:103], v[40:43], v[64:67], v[88:103]
ds_read_b64_tr_b16 v[28:29], v10 offset:9280
ds_read_b64_tr_b16 v[30:31], v10 offset:10048
s_waitcnt lgkmcnt(12)
v_mfma_f32_32x32x16_bf16 v[104:119], v[44:47], v[64:67], v[104:119]
ds_read_b64_tr_b16 v[32:33], v10 offset:9344
ds_read_b64_tr_b16 v[34:35], v10 offset:10112
s_barrier
v_add_u32 v11, 45056, v9
ds_read_b128 v[64:67], v14 offset:36864
s_waitcnt lgkmcnt(12)
v_mfma_f32_32x32x16_bf16 v[72:87], v[48:51], v[68:71], v[72:87]
ds_read_b64_tr_b16 v[36:37], v11 offset:0
ds_read_b64_tr_b16 v[38:39], v11 offset:768
s_waitcnt lgkmcnt(12)
v_mfma_f32_32x32x16_bf16 v[88:103], v[52:55], v[68:71], v[88:103]
ds_read_b64_tr_b16 v[40:41], v11 offset:64
ds_read_b64_tr_b16 v[42:43], v11 offset:832
s_waitcnt lgkmcnt(12)
v_mfma_f32_32x32x16_bf16 v[104:119], v[56:59], v[68:71], v[104:119]
ds_read_b64_tr_b16 v[44:45], v11 offset:128
ds_read_b64_tr_b16 v[46:47], v11 offset:896
ds_read_b128 v[68:71], v15 offset:36864
s_waitcnt lgkmcnt(12)
v_mfma_f32_32x32x16_bf16 v[72:87], v[24:27], v[60:63], v[72:87]
ds_read_b64_tr_b16 v[48:49], v11 offset:3072
ds_read_b64_tr_b16 v[50:51], v11 offset:3840
s_waitcnt lgkmcnt(12)
v_mfma_f32_32x32x16_bf16 v[88:103], v[28:31], v[60:63], v[88:103]
ds_read_b64_tr_b16 v[52:53], v11 offset:3136
ds_read_b64_tr_b16 v[54:55], v11 offset:3904
s_waitcnt lgkmcnt(12)
v_mfma_f32_32x32x16_bf16 v[104:119], v[32:35], v[60:63], v[104:119]
ds_read_b64_tr_b16 v[56:57], v11 offset:3200
ds_read_b64_tr_b16 v[58:59], v11 offset:3968
ds_read_b128 v[60:63], v16 offset:36864
s_waitcnt lgkmcnt(12)
v_mfma_f32_32x32x16_bf16 v[72:87], v[36:39], v[64:67], v[72:87]
ds_read_b64_tr_b16 v[24:25], v11 offset:6144
ds_read_b64_tr_b16 v[26:27], v11 offset:6912
s_waitcnt lgkmcnt(12)
v_mfma_f32_32x32x16_bf16 v[88:103], v[40:43], v[64:67], v[88:103]
ds_read_b64_tr_b16 v[28:29], v11 offset:6208
ds_read_b64_tr_b16 v[30:31], v11 offset:6976
s_waitcnt lgkmcnt(12)
v_mfma_f32_32x32x16_bf16 v[104:119], v[44:47], v[64:67], v[104:119]
ds_read_b64_tr_b16 v[32:33], v11 offset:6272
ds_read_b64_tr_b16 v[34:35], v11 offset:7040
ds_read_b128 v[64:67], v17 offset:36864
s_waitcnt lgkmcnt(12)
v_mfma_f32_32x32x16_bf16 v[72:87], v[48:51], v[68:71], v[72:87]
ds_read_b64_tr_b16 v[36:37], v11 offset:9216
ds_read_b64_tr_b16 v[38:39], v11 offset:9984
s_waitcnt lgkmcnt(12)
v_mfma_f32_32x32x16_bf16 v[88:103], v[52:55], v[68:71], v[88:103]
ds_read_b64_tr_b16 v[40:41], v11 offset:9280
ds_read_b64_tr_b16 v[42:43], v11 offset:10048
s_waitcnt lgkmcnt(12)
v_mfma_f32_32x32x16_bf16 v[104:119], v[56:59], v[68:71], v[104:119]
ds_read_b64_tr_b16 v[44:45], v11 offset:9344
ds_read_b64_tr_b16 v[46:47], v11 offset:10112
s_barrier
v_add_u32 v10, 73728, v9
v_add_u32 v18, 65536, v14
ds_read_b128 v[68:71], v18
s_waitcnt lgkmcnt(12)
v_mfma_f32_32x32x16_bf16 v[72:87], v[24:27], v[60:63], v[72:87]
ds_read_b64_tr_b16 v[48:49], v10 offset:0
ds_read_b64_tr_b16 v[50:51], v10 offset:768
s_waitcnt lgkmcnt(12)
v_mfma_f32_32x32x16_bf16 v[88:103], v[28:31], v[60:63], v[88:103]
ds_read_b64_tr_b16 v[52:53], v10 offset:64
ds_read_b64_tr_b16 v[54:55], v10 offset:832
s_waitcnt lgkmcnt(12)
v_mfma_f32_32x32x16_bf16 v[104:119], v[32:35], v[60:63], v[104:119]
ds_read_b64_tr_b16 v[56:57], v10 offset:128
ds_read_b64_tr_b16 v[58:59], v10 offset:896
v_add_u32 v19, 65536, v15
ds_read_b128 v[60:63], v19
s_waitcnt lgkmcnt(12)
v_mfma_f32_32x32x16_bf16 v[72:87], v[36:39], v[64:67], v[72:87]
ds_read_b64_tr_b16 v[24:25], v10 offset:3072
ds_read_b64_tr_b16 v[26:27], v10 offset:3840
s_waitcnt lgkmcnt(12)
v_mfma_f32_32x32x16_bf16 v[88:103], v[40:43], v[64:67], v[88:103]
ds_read_b64_tr_b16 v[28:29], v10 offset:3136
ds_read_b64_tr_b16 v[30:31], v10 offset:3904
s_waitcnt lgkmcnt(12)
v_mfma_f32_32x32x16_bf16 v[104:119], v[44:47], v[64:67], v[104:119]
ds_read_b64_tr_b16 v[32:33], v10 offset:3200
ds_read_b64_tr_b16 v[34:35], v10 offset:3968
v_add_u32 v18, 65536, v16
ds_read_b128 v[64:67], v18
s_waitcnt lgkmcnt(12)
v_mfma_f32_32x32x16_bf16 v[72:87], v[48:51], v[68:71], v[72:87]
ds_read_b64_tr_b16 v[36:37], v10 offset:6144
ds_read_b64_tr_b16 v[38:39], v10 offset:6912
s_waitcnt lgkmcnt(12)
v_mfma_f32_32x32x16_bf16 v[88:103], v[52:55], v[68:71], v[88:103]
ds_read_b64_tr_b16 v[40:41], v10 offset:6208
ds_read_b64_tr_b16 v[42:43], v10 offset:6976
s_waitcnt lgkmcnt(12)
v_mfma_f32_32x32x16_bf16 v[104:119], v[56:59], v[68:71], v[104:119]
ds_read_b64_tr_b16 v[44:45], v10 offset:6272
ds_read_b64_tr_b16 v[46:47], v10 offset:7040
v_add_u32 v19, 65536, v17
ds_read_b128 v[68:71], v19
s_waitcnt lgkmcnt(12)
v_mfma_f32_32x32x16_bf16 v[72:87], v[24:27], v[60:63], v[72:87]
ds_read_b64_tr_b16 v[48:49], v10 offset:9216
ds_read_b64_tr_b16 v[50:51], v10 offset:9984
s_waitcnt lgkmcnt(12)
v_mfma_f32_32x32x16_bf16 v[88:103], v[28:31], v[60:63], v[88:103]
ds_read_b64_tr_b16 v[52:53], v10 offset:9280
ds_read_b64_tr_b16 v[54:55], v10 offset:10048
s_waitcnt lgkmcnt(12)
v_mfma_f32_32x32x16_bf16 v[104:119], v[32:35], v[60:63], v[104:119]
ds_read_b64_tr_b16 v[56:57], v10 offset:9344
ds_read_b64_tr_b16 v[58:59], v10 offset:10112
s_barrier
v_add_u32 v11, 102400, v9
v_add_u32 v18, 94208, v14
ds_read_b128 v[60:63], v18
s_waitcnt lgkmcnt(12)
v_mfma_f32_32x32x16_bf16 v[72:87], v[36:39], v[64:67], v[72:87]
ds_read_b64_tr_b16 v[24:25], v11 offset:0
ds_read_b64_tr_b16 v[26:27], v11 offset:768
s_waitcnt lgkmcnt(12)
v_mfma_f32_32x32x16_bf16 v[88:103], v[40:43], v[64:67], v[88:103]
ds_read_b64_tr_b16 v[28:29], v11 offset:64
ds_read_b64_tr_b16 v[30:31], v11 offset:832
s_waitcnt lgkmcnt(12)
v_mfma_f32_32x32x16_bf16 v[104:119], v[44:47], v[64:67], v[104:119]
ds_read_b64_tr_b16 v[32:33], v11 offset:128
ds_read_b64_tr_b16 v[34:35], v11 offset:896
v_add_u32 v19, 94208, v15
ds_read_b128 v[64:67], v19
s_waitcnt lgkmcnt(12)
v_mfma_f32_32x32x16_bf16 v[72:87], v[48:51], v[68:71], v[72:87]
ds_read_b64_tr_b16 v[36:37], v11 offset:3072
ds_read_b64_tr_b16 v[38:39], v11 offset:3840
s_waitcnt lgkmcnt(12)
v_mfma_f32_32x32x16_bf16 v[88:103], v[52:55], v[68:71], v[88:103]
ds_read_b64_tr_b16 v[40:41], v11 offset:3136
ds_read_b64_tr_b16 v[42:43], v11 offset:3904
s_waitcnt lgkmcnt(12)
v_mfma_f32_32x32x16_bf16 v[104:119], v[56:59], v[68:71], v[104:119]
ds_read_b64_tr_b16 v[44:45], v11 offset:3200
ds_read_b64_tr_b16 v[46:47], v11 offset:3968
v_add_u32 v18, 94208, v16
ds_read_b128 v[68:71], v18
s_waitcnt lgkmcnt(12)
v_mfma_f32_32x32x16_bf16 v[72:87], v[24:27], v[60:63], v[72:87]
ds_read_b64_tr_b16 v[48:49], v11 offset:6144
ds_read_b64_tr_b16 v[50:51], v11 offset:6912
s_waitcnt lgkmcnt(12)
v_mfma_f32_32x32x16_bf16 v[88:103], v[28:31], v[60:63], v[88:103]
ds_read_b64_tr_b16 v[52:53], v11 offset:6208
ds_read_b64_tr_b16 v[54:55], v11 offset:6976
s_waitcnt lgkmcnt(12)
v_mfma_f32_32x32x16_bf16 v[104:119], v[32:35], v[60:63], v[104:119]
ds_read_b64_tr_b16 v[56:57], v11 offset:6272
ds_read_b64_tr_b16 v[58:59], v11 offset:7040
v_add_u32 v19, 94208, v17
ds_read_b128 v[60:63], v19
s_waitcnt lgkmcnt(12)
v_mfma_f32_32x32x16_bf16 v[72:87], v[36:39], v[64:67], v[72:87]
ds_read_b64_tr_b16 v[24:25], v11 offset:9216
ds_read_b64_tr_b16 v[26:27], v11 offset:9984
s_waitcnt lgkmcnt(12)
v_mfma_f32_32x32x16_bf16 v[88:103], v[40:43], v[64:67], v[88:103]
ds_read_b64_tr_b16 v[28:29], v11 offset:9280
ds_read_b64_tr_b16 v[30:31], v11 offset:10048
s_waitcnt lgkmcnt(12)
v_mfma_f32_32x32x16_bf16 v[104:119], v[44:47], v[64:67], v[104:119]
ds_read_b64_tr_b16 v[32:33], v11 offset:9344
ds_read_b64_tr_b16 v[34:35], v11 offset:10112
s_barrier
v_add_u32 v10, 131072, v9
v_add_u32 v18, 122880, v14
ds_read_b128 v[64:67], v18
s_waitcnt lgkmcnt(12)
v_mfma_f32_32x32x16_bf16 v[72:87], v[48:51], v[68:71], v[72:87]
ds_read_b64_tr_b16 v[36:37], v10 offset:0
ds_read_b64_tr_b16 v[38:39], v10 offset:768
s_waitcnt lgkmcnt(12)
v_mfma_f32_32x32x16_bf16 v[88:103], v[52:55], v[68:71], v[88:103]
ds_read_b64_tr_b16 v[40:41], v10 offset:64
ds_read_b64_tr_b16 v[42:43], v10 offset:832
s_waitcnt lgkmcnt(12)
v_mfma_f32_32x32x16_bf16 v[104:119], v[56:59], v[68:71], v[104:119]
ds_read_b64_tr_b16 v[44:45], v10 offset:128
ds_read_b64_tr_b16 v[46:47], v10 offset:896
v_add_u32 v19, 122880, v15
ds_read_b128 v[68:71], v19
s_waitcnt lgkmcnt(12)
v_mfma_f32_32x32x16_bf16 v[72:87], v[24:27], v[60:63], v[72:87]
ds_read_b64_tr_b16 v[48:49], v10 offset:3072
ds_read_b64_tr_b16 v[50:51], v10 offset:3840
s_waitcnt lgkmcnt(12)
v_mfma_f32_32x32x16_bf16 v[88:103], v[28:31], v[60:63], v[88:103]
ds_read_b64_tr_b16 v[52:53], v10 offset:3136
ds_read_b64_tr_b16 v[54:55], v10 offset:3904
s_waitcnt lgkmcnt(12)
v_mfma_f32_32x32x16_bf16 v[104:119], v[32:35], v[60:63], v[104:119]
ds_read_b64_tr_b16 v[56:57], v10 offset:3200
ds_read_b64_tr_b16 v[58:59], v10 offset:3968
v_add_u32 v18, 122880, v16
ds_read_b128 v[60:63], v18
s_waitcnt lgkmcnt(12)
v_mfma_f32_32x32x16_bf16 v[72:87], v[36:39], v[64:67], v[72:87]
ds_read_b64_tr_b16 v[24:25], v10 offset:6144
ds_read_b64_tr_b16 v[26:27], v10 offset:6912
s_waitcnt lgkmcnt(12)
v_mfma_f32_32x32x16_bf16 v[88:103], v[40:43], v[64:67], v[88:103]
ds_read_b64_tr_b16 v[28:29], v10 offset:6208
ds_read_b64_tr_b16 v[30:31], v10 offset:6976
s_waitcnt lgkmcnt(12)
v_mfma_f32_32x32x16_bf16 v[104:119], v[44:47], v[64:67], v[104:119]
ds_read_b64_tr_b16 v[32:33], v10 offset:6272
ds_read_b64_tr_b16 v[34:35], v10 offset:7040
v_add_u32 v19, 122880, v17
ds_read_b128 v[64:67], v19
s_waitcnt lgkmcnt(12)
v_mfma_f32_32x32x16_bf16 v[72:87], v[48:51], v[68:71], v[72:87]
ds_read_b64_tr_b16 v[36:37], v10 offset:9216
ds_read_b64_tr_b16 v[38:39], v10 offset:9984
s_waitcnt lgkmcnt(12)
v_mfma_f32_32x32x16_bf16 v[88:103], v[52:55], v[68:71], v[88:103]
ds_read_b64_tr_b16 v[40:41], v10 offset:9280
ds_read_b64_tr_b16 v[42:43], v10 offset:10048
s_waitcnt lgkmcnt(12)
v_mfma_f32_32x32x16_bf16 v[104:119], v[56:59], v[68:71], v[104:119]
ds_read_b64_tr_b16 v[44:45], v10 offset:9344
ds_read_b64_tr_b16 v[46:47], v10 offset:10112
s_barrier
v_add_u32 v11, 16384, v9
ds_read_b128 v[68:71], v14 offset:8192
s_waitcnt lgkmcnt(12)
v_mfma_f32_32x32x16_bf16 v[72:87], v[24:27], v[60:63], v[72:87]
ds_read_b64_tr_b16 v[48:49], v11 offset:0
ds_read_b64_tr_b16 v[50:51], v11 offset:768
s_waitcnt lgkmcnt(12)
v_mfma_f32_32x32x16_bf16 v[88:103], v[28:31], v[60:63], v[88:103]
ds_read_b64_tr_b16 v[52:53], v11 offset:64
ds_read_b64_tr_b16 v[54:55], v11 offset:832
s_waitcnt lgkmcnt(12)
v_mfma_f32_32x32x16_bf16 v[104:119], v[32:35], v[60:63], v[104:119]
ds_read_b64_tr_b16 v[56:57], v11 offset:128
ds_read_b64_tr_b16 v[58:59], v11 offset:896
ds_read_b128 v[60:63], v15 offset:8192
s_waitcnt lgkmcnt(12)
v_mfma_f32_32x32x16_bf16 v[72:87], v[36:39], v[64:67], v[72:87]
ds_read_b64_tr_b16 v[24:25], v11 offset:3072
ds_read_b64_tr_b16 v[26:27], v11 offset:3840
s_waitcnt lgkmcnt(12)
v_mfma_f32_32x32x16_bf16 v[88:103], v[40:43], v[64:67], v[88:103]
ds_read_b64_tr_b16 v[28:29], v11 offset:3136
ds_read_b64_tr_b16 v[30:31], v11 offset:3904
s_waitcnt lgkmcnt(12)
v_mfma_f32_32x32x16_bf16 v[104:119], v[44:47], v[64:67], v[104:119]
ds_read_b64_tr_b16 v[32:33], v11 offset:3200
ds_read_b64_tr_b16 v[34:35], v11 offset:3968
ds_read_b128 v[64:67], v16 offset:8192
s_waitcnt lgkmcnt(12)
v_mfma_f32_32x32x16_bf16 v[72:87], v[48:51], v[68:71], v[72:87]
ds_read_b64_tr_b16 v[36:37], v11 offset:6144
ds_read_b64_tr_b16 v[38:39], v11 offset:6912
s_waitcnt lgkmcnt(12)
v_mfma_f32_32x32x16_bf16 v[88:103], v[52:55], v[68:71], v[88:103]
ds_read_b64_tr_b16 v[40:41], v11 offset:6208
ds_read_b64_tr_b16 v[42:43], v11 offset:6976
s_waitcnt lgkmcnt(12)
v_mfma_f32_32x32x16_bf16 v[104:119], v[56:59], v[68:71], v[104:119]
ds_read_b64_tr_b16 v[44:45], v11 offset:6272
ds_read_b64_tr_b16 v[46:47], v11 offset:7040
ds_read_b128 v[68:71], v17 offset:8192
s_waitcnt lgkmcnt(12)
v_mfma_f32_32x32x16_bf16 v[72:87], v[24:27], v[60:63], v[72:87]
ds_read_b64_tr_b16 v[48:49], v11 offset:9216
ds_read_b64_tr_b16 v[50:51], v11 offset:9984
s_waitcnt lgkmcnt(12)
v_mfma_f32_32x32x16_bf16 v[88:103], v[28:31], v[60:63], v[88:103]
ds_read_b64_tr_b16 v[52:53], v11 offset:9280
ds_read_b64_tr_b16 v[54:55], v11 offset:10048
s_waitcnt lgkmcnt(12)
v_mfma_f32_32x32x16_bf16 v[104:119], v[32:35], v[60:63], v[104:119]
ds_read_b64_tr_b16 v[56:57], v11 offset:9344
ds_read_b64_tr_b16 v[58:59], v11 offset:10112
s_barrier
v_add_u32 v10, 45056, v9
ds_read_b128 v[60:63], v14 offset:36864
s_waitcnt lgkmcnt(12)
v_mfma_f32_32x32x16_bf16 v[72:87], v[36:39], v[64:67], v[72:87]
ds_read_b64_tr_b16 v[24:25], v10 offset:0
ds_read_b64_tr_b16 v[26:27], v10 offset:768
s_waitcnt lgkmcnt(12)
v_mfma_f32_32x32x16_bf16 v[88:103], v[40:43], v[64:67], v[88:103]
ds_read_b64_tr_b16 v[28:29], v10 offset:64
ds_read_b64_tr_b16 v[30:31], v10 offset:832
s_waitcnt lgkmcnt(12)
v_mfma_f32_32x32x16_bf16 v[104:119], v[44:47], v[64:67], v[104:119]
ds_read_b64_tr_b16 v[32:33], v10 offset:128
ds_read_b64_tr_b16 v[34:35], v10 offset:896
ds_read_b128 v[64:67], v15 offset:36864
s_waitcnt lgkmcnt(12)
v_mfma_f32_32x32x16_bf16 v[72:87], v[48:51], v[68:71], v[72:87]
ds_read_b64_tr_b16 v[36:37], v10 offset:3072
ds_read_b64_tr_b16 v[38:39], v10 offset:3840
s_waitcnt lgkmcnt(12)
v_mfma_f32_32x32x16_bf16 v[88:103], v[52:55], v[68:71], v[88:103]
ds_read_b64_tr_b16 v[40:41], v10 offset:3136
ds_read_b64_tr_b16 v[42:43], v10 offset:3904
s_waitcnt lgkmcnt(12)
v_mfma_f32_32x32x16_bf16 v[104:119], v[56:59], v[68:71], v[104:119]
ds_read_b64_tr_b16 v[44:45], v10 offset:3200
ds_read_b64_tr_b16 v[46:47], v10 offset:3968
ds_read_b128 v[68:71], v16 offset:36864
s_waitcnt lgkmcnt(12)
v_mfma_f32_32x32x16_bf16 v[72:87], v[24:27], v[60:63], v[72:87]
ds_read_b64_tr_b16 v[48:49], v10 offset:6144
ds_read_b64_tr_b16 v[50:51], v10 offset:6912
s_waitcnt lgkmcnt(12)
v_mfma_f32_32x32x16_bf16 v[88:103], v[28:31], v[60:63], v[88:103]
ds_read_b64_tr_b16 v[52:53], v10 offset:6208
ds_read_b64_tr_b16 v[54:55], v10 offset:6976
s_waitcnt lgkmcnt(12)
v_mfma_f32_32x32x16_bf16 v[104:119], v[32:35], v[60:63], v[104:119]
ds_read_b64_tr_b16 v[56:57], v10 offset:6272
ds_read_b64_tr_b16 v[58:59], v10 offset:7040
ds_read_b128 v[60:63], v17 offset:36864
s_waitcnt lgkmcnt(12)
v_mfma_f32_32x32x16_bf16 v[72:87], v[36:39], v[64:67], v[72:87]
ds_read_b64_tr_b16 v[24:25], v10 offset:9216
ds_read_b64_tr_b16 v[26:27], v10 offset:9984
s_waitcnt lgkmcnt(12)
v_mfma_f32_32x32x16_bf16 v[88:103], v[40:43], v[64:67], v[88:103]
ds_read_b64_tr_b16 v[28:29], v10 offset:9280
ds_read_b64_tr_b16 v[30:31], v10 offset:10048
s_waitcnt lgkmcnt(12)
v_mfma_f32_32x32x16_bf16 v[104:119], v[44:47], v[64:67], v[104:119]
ds_read_b64_tr_b16 v[32:33], v10 offset:9344
ds_read_b64_tr_b16 v[34:35], v10 offset:10112
s_barrier
v_add_u32 v11, 73728, v9
v_add_u32 v18, 65536, v14
ds_read_b128 v[64:67], v18
s_waitcnt lgkmcnt(12)
v_mfma_f32_32x32x16_bf16 v[72:87], v[48:51], v[68:71], v[72:87]
ds_read_b64_tr_b16 v[36:37], v11 offset:0
ds_read_b64_tr_b16 v[38:39], v11 offset:768
s_waitcnt lgkmcnt(12)
v_mfma_f32_32x32x16_bf16 v[88:103], v[52:55], v[68:71], v[88:103]
ds_read_b64_tr_b16 v[40:41], v11 offset:64
ds_read_b64_tr_b16 v[42:43], v11 offset:832
s_waitcnt lgkmcnt(12)
v_mfma_f32_32x32x16_bf16 v[104:119], v[56:59], v[68:71], v[104:119]
ds_read_b64_tr_b16 v[44:45], v11 offset:128
ds_read_b64_tr_b16 v[46:47], v11 offset:896
v_add_u32 v19, 65536, v15
ds_read_b128 v[68:71], v19
s_waitcnt lgkmcnt(12)
v_mfma_f32_32x32x16_bf16 v[72:87], v[24:27], v[60:63], v[72:87]
ds_read_b64_tr_b16 v[48:49], v11 offset:3072
ds_read_b64_tr_b16 v[50:51], v11 offset:3840
s_waitcnt lgkmcnt(12)
v_mfma_f32_32x32x16_bf16 v[88:103], v[28:31], v[60:63], v[88:103]
ds_read_b64_tr_b16 v[52:53], v11 offset:3136
ds_read_b64_tr_b16 v[54:55], v11 offset:3904
s_waitcnt lgkmcnt(12)
v_mfma_f32_32x32x16_bf16 v[104:119], v[32:35], v[60:63], v[104:119]
ds_read_b64_tr_b16 v[56:57], v11 offset:3200
ds_read_b64_tr_b16 v[58:59], v11 offset:3968
v_add_u32 v18, 65536, v16
ds_read_b128 v[60:63], v18
s_waitcnt lgkmcnt(12)
v_mfma_f32_32x32x16_bf16 v[72:87], v[36:39], v[64:67], v[72:87]
ds_read_b64_tr_b16 v[24:25], v11 offset:6144
ds_read_b64_tr_b16 v[26:27], v11 offset:6912
s_waitcnt lgkmcnt(12)
v_mfma_f32_32x32x16_bf16 v[88:103], v[40:43], v[64:67], v[88:103]
ds_read_b64_tr_b16 v[28:29], v11 offset:6208
ds_read_b64_tr_b16 v[30:31], v11 offset:6976
s_waitcnt lgkmcnt(12)
v_mfma_f32_32x32x16_bf16 v[104:119], v[44:47], v[64:67], v[104:119]
ds_read_b64_tr_b16 v[32:33], v11 offset:6272
ds_read_b64_tr_b16 v[34:35], v11 offset:7040
v_add_u32 v19, 65536, v17
ds_read_b128 v[64:67], v19
s_waitcnt lgkmcnt(12)
v_mfma_f32_32x32x16_bf16 v[72:87], v[48:51], v[68:71], v[72:87]
ds_read_b64_tr_b16 v[36:37], v11 offset:9216
ds_read_b64_tr_b16 v[38:39], v11 offset:9984
s_waitcnt lgkmcnt(12)
v_mfma_f32_32x32x16_bf16 v[88:103], v[52:55], v[68:71], v[88:103]
ds_read_b64_tr_b16 v[40:41], v11 offset:9280
ds_read_b64_tr_b16 v[42:43], v11 offset:10048
s_waitcnt lgkmcnt(12)
v_mfma_f32_32x32x16_bf16 v[104:119], v[56:59], v[68:71], v[104:119]
ds_read_b64_tr_b16 v[44:45], v11 offset:9344
ds_read_b64_tr_b16 v[46:47], v11 offset:10112
s_waitcnt lgkmcnt(11)
v_mfma_f32_32x32x16_bf16 v[72:87], v[24:27], v[60:63], v[72:87]
s_waitcnt lgkmcnt(9)
v_mfma_f32_32x32x16_bf16 v[88:103], v[28:31], v[60:63], v[88:103]
s_waitcnt lgkmcnt(7)
v_mfma_f32_32x32x16_bf16 v[104:119], v[32:35], v[60:63], v[104:119]
s_waitcnt lgkmcnt(4)
v_mfma_f32_32x32x16_bf16 v[72:87], v[36:39], v[64:67], v[72:87]
s_waitcnt lgkmcnt(2)
v_mfma_f32_32x32x16_bf16 v[88:103], v[40:43], v[64:67], v[88:103]
s_waitcnt lgkmcnt(0)
v_mfma_f32_32x32x16_bf16 v[104:119], v[44:47], v[64:67], v[104:119]
s_barrier
v_and_b32 v134, 31, v1
v_lshlrev_b32 v134, 3, v134
v_add_u32 v134, 2560, v134
ds_read_b64 v[132:133], v134
v_lshlrev_b32 v137, 4, v5
v_add_u32 v137, 0, v137
ds_read_b128 v[24:27], v137 offset:0
ds_read_b128 v[28:31], v137 offset:32
ds_read_b128 v[32:35], v137 offset:64
ds_read_b128 v[36:39], v137 offset:96
s_lshl_b32 s7, s4, 2
s_add_u32 s7, s7, 2
v_bfe_u32 v121, v1, 4, 1
v_bfe_u32 v122, v1, 2, 1
v_lshlrev_b32 v122, 3, v122
v_lshl_add_u32 v122, v121, 4, v122
v_and_b32 v123, 3, v1
v_add_u32 v122, v122, v123
v_bfe_u32 v123, v1, 3, 1
v_lshl_add_u32 v122, v123, 2, v122
v_lshlrev_b32 v122, 1, v122
v_mul_u32_u24 v123, 320, v5
v_add_u32 v128, v122, v123
v_add_u32 v128, 9216, v128
v_lshl_add_u32 v122, v5, 4, v4
v_mul_u32_u24 v122, 80, v122
v_lshl_add_u32 v122, v121, 4, v122
v_add_u32 v129, 9216, v122
v_and_b32 v122, 31, v1
v_lshlrev_b32 v122, 4, v122
v_lshl_add_u32 v130, v5, 16, v122
ds_read_b128 v[40:43], v137 offset:128
ds_read_b128 v[44:47], v137 offset:160
ds_read_b128 v[48:51], v137 offset:192
ds_read_b128 v[52:55], v137 offset:224
s_mul_i32 s8, s5, 3
s_add_u32 s8, s8, 0
s_lshr_b32 s9, s8, 4
s_and_b32 s10, s8, 15
s_lshl_b32 s10, s10, 17
s_cmp_eq_u32 s9, 0
s_cselect_b32 s11, 0x3eb8aa3b, 0x3f800000
s_lshr_b32 s12, s9, 0
s_mul_i32 s12, s9, 2097152
s_add_u32 s12, s12, 2097152
s_add_u32 s12, s12, s10
s_lshl_b32 s13, s7, 10
s_add_u32 s12, s12, s13
s_waitcnt lgkmcnt(8)
v_mul_f32 v138, s11, v133
s_waitcnt lgkmcnt(7)
v_pk_fma_f32 v[72:73], v[24:25], v[132:133], v[72:73] op_sel_hi:[1,0,1]
v_pk_fma_f32 v[74:75], v[26:27], v[132:133], v[74:75] op_sel_hi:[1,0,1]
s_waitcnt lgkmcnt(6)
v_pk_fma_f32 v[76:77], v[28:29], v[132:133], v[76:77] op_sel_hi:[1,0,1]
v_pk_fma_f32 v[78:79], v[30:31], v[132:133], v[78:79] op_sel_hi:[1,0,1]
s_waitcnt lgkmcnt(5)
v_pk_fma_f32 v[80:81], v[32:33], v[132:133], v[80:81] op_sel_hi:[1,0,1]
v_pk_fma_f32 v[82:83], v[34:35], v[132:133], v[82:83] op_sel_hi:[1,0,1]
s_waitcnt lgkmcnt(4)
v_pk_fma_f32 v[84:85], v[36:37], v[132:133], v[84:85] op_sel_hi:[1,0,1]
v_pk_fma_f32 v[86:87], v[38:39], v[132:133], v[86:87] op_sel_hi:[1,0,1]
v_pk_mul_f32 v[72:73], v[72:73], v[138:139] op_sel_hi:[1,0]
v_pk_mul_f32 v[74:75], v[74:75], v[138:139] op_sel_hi:[1,0]
v_pk_mul_f32 v[76:77], v[76:77], v[138:139] op_sel_hi:[1,0]
v_pk_mul_f32 v[78:79], v[78:79], v[138:139] op_sel_hi:[1,0]
v_pk_mul_f32 v[80:81], v[80:81], v[138:139] op_sel_hi:[1,0]
v_pk_mul_f32 v[82:83], v[82:83], v[138:139] op_sel_hi:[1,0]
v_pk_mul_f32 v[84:85], v[84:85], v[138:139] op_sel_hi:[1,0]
v_pk_mul_f32 v[86:87], v[86:87], v[138:139] op_sel_hi:[1,0]
s_cmp_eq_u32 s9, 2
s_cbranch_scc1 k1_kernel_w2_t0_v
v_cvt_pk_bf16_f32 v120, v72, v73
v_cvt_pk_bf16_f32 v121, v74, v75
v_cvt_pk_bf16_f32 v122, v76, v77
v_cvt_pk_bf16_f32 v123, v78, v79
s_nop 0
v_permlane32_swap_b32 v120, v122
v_permlane32_swap_b32 v121, v123
v_cvt_pk_bf16_f32 v124, v80, v81
v_cvt_pk_bf16_f32 v125, v82, v83
v_cvt_pk_bf16_f32 v126, v84, v85
v_cvt_pk_bf16_f32 v127, v86, v87
s_nop 0
v_permlane32_swap_b32 v124, v126
v_permlane32_swap_b32 v125, v127
buffer_store_dwordx4 v[120:123], v3, s[52:55], s12 offen sc0 sc1
s_add_u32 s12, s12, 65536
buffer_store_dwordx4 v[124:127], v3, s[52:55], s12 offen sc0 sc1
s_branch k1_kernel_w2_t0_j
k1_kernel_w2_t0_v:
v_cvt_pk_bf16_f32 v120, v72, v73
v_cvt_pk_bf16_f32 v121, v74, v75
v_cvt_pk_bf16_f32 v122, v76, v77
v_cvt_pk_bf16_f32 v123, v78, v79
v_cvt_pk_bf16_f32 v124, v80, v81
v_cvt_pk_bf16_f32 v125, v82, v83
v_cvt_pk_bf16_f32 v126, v84, v85
v_cvt_pk_bf16_f32 v127, v86, v87
ds_write_b16 v128, v120 offset:0
ds_write_b16_d16_hi v128, v120 offset:80
ds_write_b16 v128, v121 offset:160
ds_write_b16_d16_hi v128, v121 offset:240
ds_write_b16 v128, v122 offset:640
ds_write_b16_d16_hi v128, v122 offset:720
ds_write_b16 v128, v123 offset:800
ds_write_b16_d16_hi v128, v123 offset:880
ds_write_b16 v128, v124 offset:1280
ds_write_b16_d16_hi v128, v124 offset:1360
ds_write_b16 v128, v125 offset:1440
s_waitcnt lgkmcnt(13)
ds_write_b16_d16_hi v128, v125 offset:1520
ds_write_b16 v128, v126 offset:1920
s_waitcnt lgkmcnt(13)
ds_write_b16_d16_hi v128, v126 offset:2000
ds_write_b16 v128, v127 offset:2080
s_waitcnt lgkmcnt(13)
ds_write_b16_d16_hi v128, v127 offset:2160
ds_read_b128 v[120:123], v129
s_waitcnt lgkmcnt(13)
ds_read_b128 v[124:127], v129 offset:32
s_waitcnt lgkmcnt(1)
buffer_store_dwordx4 v[120:123], v130, s[52:55], s12 offen sc0 sc1
s_waitcnt lgkmcnt(0)
buffer_store_dwordx4 v[124:127], v130, s[52:55], s12 offen offset:512 sc0 sc1
k1_kernel_w2_t0_j:
s_waitcnt lgkmcnt(0)
ds_read_b128 v[24:27], v137 offset:256
ds_read_b128 v[28:31], v137 offset:288
ds_read_b128 v[32:35], v137 offset:320
ds_read_b128 v[36:39], v137 offset:352
s_mul_i32 s8, s5, 3
s_add_u32 s8, s8, 1
s_lshr_b32 s9, s8, 4
s_and_b32 s10, s8, 15
s_lshl_b32 s10, s10, 17
s_cmp_eq_u32 s9, 0
s_cselect_b32 s11, 0x3eb8aa3b, 0x3f800000
s_lshr_b32 s12, s9, 0
s_mul_i32 s12, s9, 2097152
s_add_u32 s12, s12, 2097152
s_add_u32 s12, s12, s10
s_lshl_b32 s13, s7, 10
s_add_u32 s12, s12, s13
v_mul_f32 v138, s11, v133
v_pk_fma_f32 v[88:89], v[40:41], v[132:133], v[88:89] op_sel_hi:[1,0,1]
v_pk_fma_f32 v[90:91], v[42:43], v[132:133], v[90:91] op_sel_hi:[1,0,1]
v_pk_fma_f32 v[92:93], v[44:45], v[132:133], v[92:93] op_sel_hi:[1,0,1]
v_pk_fma_f32 v[94:95], v[46:47], v[132:133], v[94:95] op_sel_hi:[1,0,1]
v_pk_fma_f32 v[96:97], v[48:49], v[132:133], v[96:97] op_sel_hi:[1,0,1]
v_pk_fma_f32 v[98:99], v[50:51], v[132:133], v[98:99] op_sel_hi:[1,0,1]
v_pk_fma_f32 v[100:101], v[52:53], v[132:133], v[100:101] op_sel_hi:[1,0,1]
v_pk_fma_f32 v[102:103], v[54:55], v[132:133], v[102:103] op_sel_hi:[1,0,1]
v_pk_mul_f32 v[88:89], v[88:89], v[138:139] op_sel_hi:[1,0]
v_pk_mul_f32 v[90:91], v[90:91], v[138:139] op_sel_hi:[1,0]
v_pk_mul_f32 v[92:93], v[92:93], v[138:139] op_sel_hi:[1,0]
v_pk_mul_f32 v[94:95], v[94:95], v[138:139] op_sel_hi:[1,0]
v_pk_mul_f32 v[96:97], v[96:97], v[138:139] op_sel_hi:[1,0]
v_pk_mul_f32 v[98:99], v[98:99], v[138:139] op_sel_hi:[1,0]
v_pk_mul_f32 v[100:101], v[100:101], v[138:139] op_sel_hi:[1,0]
v_pk_mul_f32 v[102:103], v[102:103], v[138:139] op_sel_hi:[1,0]
s_cmp_eq_u32 s9, 2
s_cbranch_scc1 k1_kernel_w2_t1_v
v_cvt_pk_bf16_f32 v120, v88, v89
v_cvt_pk_bf16_f32 v121, v90, v91
v_cvt_pk_bf16_f32 v122, v92, v93
v_cvt_pk_bf16_f32 v123, v94, v95
s_nop 0
v_permlane32_swap_b32 v120, v122
v_permlane32_swap_b32 v121, v123
v_cvt_pk_bf16_f32 v124, v96, v97
v_cvt_pk_bf16_f32 v125, v98, v99
v_cvt_pk_bf16_f32 v126, v100, v101
v_cvt_pk_bf16_f32 v127, v102, v103
s_nop 0
v_permlane32_swap_b32 v124, v126
v_permlane32_swap_b32 v125, v127
buffer_store_dwordx4 v[120:123], v3, s[52:55], s12 offen sc0 sc1
s_add_u32 s12, s12, 65536
buffer_store_dwordx4 v[124:127], v3, s[52:55], s12 offen sc0 sc1
s_branch k1_kernel_w2_t1_j
k1_kernel_w2_t1_v:
v_cvt_pk_bf16_f32 v120, v88, v89
v_cvt_pk_bf16_f32 v121, v90, v91
v_cvt_pk_bf16_f32 v122, v92, v93
v_cvt_pk_bf16_f32 v123, v94, v95
v_cvt_pk_bf16_f32 v124, v96, v97
v_cvt_pk_bf16_f32 v125, v98, v99
v_cvt_pk_bf16_f32 v126, v100, v101
v_cvt_pk_bf16_f32 v127, v102, v103
ds_write_b16 v128, v120 offset:0
ds_write_b16_d16_hi v128, v120 offset:80
ds_write_b16 v128, v121 offset:160
ds_write_b16_d16_hi v128, v121 offset:240
ds_write_b16 v128, v122 offset:640
ds_write_b16_d16_hi v128, v122 offset:720
ds_write_b16 v128, v123 offset:800
ds_write_b16_d16_hi v128, v123 offset:880
ds_write_b16 v128, v124 offset:1280
ds_write_b16_d16_hi v128, v124 offset:1360
ds_write_b16 v128, v125 offset:1440
s_waitcnt lgkmcnt(13)
ds_write_b16_d16_hi v128, v125 offset:1520
ds_write_b16 v128, v126 offset:1920
s_waitcnt lgkmcnt(13)
ds_write_b16_d16_hi v128, v126 offset:2000
ds_write_b16 v128, v127 offset:2080
s_waitcnt lgkmcnt(13)
ds_write_b16_d16_hi v128, v127 offset:2160
ds_read_b128 v[120:123], v129
s_waitcnt lgkmcnt(13)
ds_read_b128 v[124:127], v129 offset:32
s_waitcnt lgkmcnt(1)
buffer_store_dwordx4 v[120:123], v130, s[52:55], s12 offen sc0 sc1
s_waitcnt lgkmcnt(0)
buffer_store_dwordx4 v[124:127], v130, s[52:55], s12 offen offset:512 sc0 sc1
k1_kernel_w2_t1_j:
s_waitcnt lgkmcnt(0)
s_mul_i32 s8, s5, 3
s_add_u32 s8, s8, 2
s_lshr_b32 s9, s8, 4
s_and_b32 s10, s8, 15
s_lshl_b32 s10, s10, 17
s_cmp_eq_u32 s9, 0
s_cselect_b32 s11, 0x3eb8aa3b, 0x3f800000
s_lshr_b32 s12, s9, 0
s_mul_i32 s12, s9, 2097152
s_add_u32 s12, s12, 2097152
s_add_u32 s12, s12, s10
s_lshl_b32 s13, s7, 10
s_add_u32 s12, s12, s13
v_mul_f32 v138, s11, v133
v_pk_fma_f32 v[104:105], v[24:25], v[132:133], v[104:105] op_sel_hi:[1,0,1]
v_pk_fma_f32 v[106:107], v[26:27], v[132:133], v[106:107] op_sel_hi:[1,0,1]
v_pk_fma_f32 v[108:109], v[28:29], v[132:133], v[108:109] op_sel_hi:[1,0,1]
v_pk_fma_f32 v[110:111], v[30:31], v[132:133], v[110:111] op_sel_hi:[1,0,1]
v_pk_fma_f32 v[112:113], v[32:33], v[132:133], v[112:113] op_sel_hi:[1,0,1]
v_pk_fma_f32 v[114:115], v[34:35], v[132:133], v[114:115] op_sel_hi:[1,0,1]
v_pk_fma_f32 v[116:117], v[36:37], v[132:133], v[116:117] op_sel_hi:[1,0,1]
v_pk_fma_f32 v[118:119], v[38:39], v[132:133], v[118:119] op_sel_hi:[1,0,1]
v_pk_mul_f32 v[104:105], v[104:105], v[138:139] op_sel_hi:[1,0]
v_pk_mul_f32 v[106:107], v[106:107], v[138:139] op_sel_hi:[1,0]
v_pk_mul_f32 v[108:109], v[108:109], v[138:139] op_sel_hi:[1,0]
v_pk_mul_f32 v[110:111], v[110:111], v[138:139] op_sel_hi:[1,0]
v_pk_mul_f32 v[112:113], v[112:113], v[138:139] op_sel_hi:[1,0]
v_pk_mul_f32 v[114:115], v[114:115], v[138:139] op_sel_hi:[1,0]
v_pk_mul_f32 v[116:117], v[116:117], v[138:139] op_sel_hi:[1,0]
v_pk_mul_f32 v[118:119], v[118:119], v[138:139] op_sel_hi:[1,0]
s_cmp_eq_u32 s9, 2
s_cbranch_scc1 k1_kernel_w2_t2_v
v_cvt_pk_bf16_f32 v120, v104, v105
v_cvt_pk_bf16_f32 v121, v106, v107
v_cvt_pk_bf16_f32 v122, v108, v109
v_cvt_pk_bf16_f32 v123, v110, v111
s_nop 0
v_permlane32_swap_b32 v120, v122
v_permlane32_swap_b32 v121, v123
v_cvt_pk_bf16_f32 v124, v112, v113
v_cvt_pk_bf16_f32 v125, v114, v115
v_cvt_pk_bf16_f32 v126, v116, v117
v_cvt_pk_bf16_f32 v127, v118, v119
s_nop 0
v_permlane32_swap_b32 v124, v126
v_permlane32_swap_b32 v125, v127
buffer_store_dwordx4 v[120:123], v3, s[52:55], s12 offen sc0 sc1
s_add_u32 s12, s12, 65536
buffer_store_dwordx4 v[124:127], v3, s[52:55], s12 offen sc0 sc1
s_branch k1_kernel_w2_t2_j
k1_kernel_w2_t2_v:
v_cvt_pk_bf16_f32 v120, v104, v105
v_cvt_pk_bf16_f32 v121, v106, v107
v_cvt_pk_bf16_f32 v122, v108, v109
v_cvt_pk_bf16_f32 v123, v110, v111
v_cvt_pk_bf16_f32 v124, v112, v113
v_cvt_pk_bf16_f32 v125, v114, v115
v_cvt_pk_bf16_f32 v126, v116, v117
v_cvt_pk_bf16_f32 v127, v118, v119
ds_write_b16 v128, v120 offset:0
ds_write_b16_d16_hi v128, v120 offset:80
ds_write_b16 v128, v121 offset:160
ds_write_b16_d16_hi v128, v121 offset:240
ds_write_b16 v128, v122 offset:640
ds_write_b16_d16_hi v128, v122 offset:720
ds_write_b16 v128, v123 offset:800
ds_write_b16_d16_hi v128, v123 offset:880
ds_write_b16 v128, v124 offset:1280
ds_write_b16_d16_hi v128, v124 offset:1360
ds_write_b16 v128, v125 offset:1440
ds_write_b16_d16_hi v128, v125 offset:1520
ds_write_b16 v128, v126 offset:1920
ds_write_b16_d16_hi v128, v126 offset:2000
ds_write_b16 v128, v127 offset:2080
s_waitcnt lgkmcnt(13)
ds_write_b16_d16_hi v128, v127 offset:2160
ds_read_b128 v[120:123], v129
s_waitcnt lgkmcnt(13)
ds_read_b128 v[124:127], v129 offset:32
s_waitcnt lgkmcnt(1)
buffer_store_dwordx4 v[120:123], v130, s[52:55], s12 offen sc0 sc1
s_waitcnt lgkmcnt(0)
buffer_store_dwordx4 v[124:127], v130, s[52:55], s12 offen offset:512 sc0 sc1
k1_kernel_w2_t2_j:
s_waitcnt lgkmcnt(0)
s_waitcnt vmcnt(0)
s_branch k1_kernel_end
k1_kernel_w3:
v_mul_u32_u24 v18, 192, v7
v_lshl_add_u32 v18, v8, 3, v18
v_mul_u32_u24 v19, 32, v6
v_add_u32 v9, v18, v19
v_and_b32 v18, 31, v1
v_bfe_u32 v19, v1, 1, 3
v_add_u32 v20, 0, v5
v_xor_b32 v19, v19, v20
v_lshlrev_b32 v19, 4, v19
v_lshl_add_u32 v14, v18, 7, v19
v_and_b32 v18, 31, v1
v_bfe_u32 v19, v1, 1, 3
v_add_u32 v20, 2, v5
v_xor_b32 v19, v19, v20
v_lshlrev_b32 v19, 4, v19
v_lshl_add_u32 v15, v18, 7, v19
v_and_b32 v18, 31, v1
v_bfe_u32 v19, v1, 1, 3
v_add_u32 v20, 4, v5
v_xor_b32 v19, v19, v20
v_lshlrev_b32 v19, 4, v19
v_lshl_add_u32 v16, v18, 7, v19
v_and_b32 v18, 31, v1
v_bfe_u32 v19, v1, 1, 3
v_add_u32 v20, 6, v5
v_xor_b32 v19, v19, v20
v_lshlrev_b32 v19, 4, v19
v_lshl_add_u32 v17, v18, 7, v19
s_barrier
v_add_u32 v10, 16384, v9
ds_read_b128 v[60:63], v14 offset:12288
ds_read_b64_tr_b16 v[24:25], v10 offset:0
ds_read_b64_tr_b16 v[26:27], v10 offset:768
ds_read_b64_tr_b16 v[28:29], v10 offset:64
ds_read_b64_tr_b16 v[30:31], v10 offset:832
ds_read_b64_tr_b16 v[32:33], v10 offset:128
ds_read_b64_tr_b16 v[34:35], v10 offset:896
ds_read_b128 v[64:67], v15 offset:12288
ds_read_b64_tr_b16 v[36:37], v10 offset:3072
ds_read_b64_tr_b16 v[38:39], v10 offset:3840
ds_read_b64_tr_b16 v[40:41], v10 offset:3136
ds_read_b64_tr_b16 v[42:43], v10 offset:3904
ds_read_b64_tr_b16 v[44:45], v10 offset:3200
ds_read_b64_tr_b16 v[46:47], v10 offset:3968
ds_read_b128 v[68:71], v16 offset:12288
s_waitcnt lgkmcnt(12)
v_mfma_f32_32x32x16_bf16 v[72:87], v[24:27], v[60:63], 0
ds_read_b64_tr_b16 v[48:49], v10 offset:6144
ds_read_b64_tr_b16 v[50:51], v10 offset:6912
s_waitcnt lgkmcnt(12)
v_mfma_f32_32x32x16_bf16 v[88:103], v[28:31], v[60:63], 0
ds_read_b64_tr_b16 v[52:53], v10 offset:6208
ds_read_b64_tr_b16 v[54:55], v10 offset:6976
s_waitcnt lgkmcnt(12)
v_mfma_f32_32x32x16_bf16 v[104:119], v[32:35], v[60:63], 0
ds_read_b64_tr_b16 v[56:57], v10 offset:6272
ds_read_b64_tr_b16 v[58:59], v10 offset:7040
ds_read_b128 v[60:63], v17 offset:12288
s_waitcnt lgkmcnt(12)
v_mfma_f32_32x32x16_bf16 v[72:87], v[36:39], v[64:67], v[72:87]
ds_read_b64_tr_b16 v[24:25], v10 offset:9216
ds_read_b64_tr_b16 v[26:27], v10 offset:9984
s_waitcnt lgkmcnt(12)
v_mfma_f32_32x32x16_bf16 v[88:103], v[40:43], v[64:67], v[88:103]
ds_read_b64_tr_b16 v[28:29], v10 offset:9280
ds_read_b64_tr_b16 v[30:31], v10 offset:10048
s_waitcnt lgkmcnt(12)
v_mfma_f32_32x32x16_bf16 v[104:119], v[44:47], v[64:67], v[104:119]
ds_read_b64_tr_b16 v[32:33], v10 offset:9344
ds_read_b64_tr_b16 v[34:35], v10 offset:10112
s_barrier
v_add_u32 v11, 45056, v9
ds_read_b128 v[64:67], v14 offset:40960
s_waitcnt lgkmcnt(12)
v_mfma_f32_32x32x16_bf16 v[72:87], v[48:51], v[68:71], v[72:87]
ds_read_b64_tr_b16 v[36:37], v11 offset:0
ds_read_b64_tr_b16 v[38:39], v11 offset:768
s_waitcnt lgkmcnt(12)
v_mfma_f32_32x32x16_bf16 v[88:103], v[52:55], v[68:71], v[88:103]
ds_read_b64_tr_b16 v[40:41], v11 offset:64
ds_read_b64_tr_b16 v[42:43], v11 offset:832
s_waitcnt lgkmcnt(12)
v_mfma_f32_32x32x16_bf16 v[104:119], v[56:59], v[68:71], v[104:119]
ds_read_b64_tr_b16 v[44:45], v11 offset:128
ds_read_b64_tr_b16 v[46:47], v11 offset:896
ds_read_b128 v[68:71], v15 offset:40960
s_waitcnt lgkmcnt(12)
v_mfma_f32_32x32x16_bf16 v[72:87], v[24:27], v[60:63], v[72:87]
ds_read_b64_tr_b16 v[48:49], v11 offset:3072
ds_read_b64_tr_b16 v[50:51], v11 offset:3840
s_waitcnt lgkmcnt(12)
v_mfma_f32_32x32x16_bf16 v[88:103], v[28:31], v[60:63], v[88:103]
ds_read_b64_tr_b16 v[52:53], v11 offset:3136
ds_read_b64_tr_b16 v[54:55], v11 offset:3904
s_waitcnt lgkmcnt(12)
v_mfma_f32_32x32x16_bf16 v[104:119], v[32:35], v[60:63], v[104:119]
ds_read_b64_tr_b16 v[56:57], v11 offset:3200
ds_read_b64_tr_b16 v[58:59], v11 offset:3968
ds_read_b128 v[60:63], v16 offset:40960
s_waitcnt lgkmcnt(12)
v_mfma_f32_32x32x16_bf16 v[72:87], v[36:39], v[64:67], v[72:87]
ds_read_b64_tr_b16 v[24:25], v11 offset:6144
ds_read_b64_tr_b16 v[26:27], v11 offset:6912
s_waitcnt lgkmcnt(12)
v_mfma_f32_32x32x16_bf16 v[88:103], v[40:43], v[64:67], v[88:103]
ds_read_b64_tr_b16 v[28:29], v11 offset:6208
ds_read_b64_tr_b16 v[30:31], v11 offset:6976
s_waitcnt lgkmcnt(12)
v_mfma_f32_32x32x16_bf16 v[104:119], v[44:47], v[64:67], v[104:119]
ds_read_b64_tr_b16 v[32:33], v11 offset:6272
ds_read_b64_tr_b16 v[34:35], v11 offset:7040
ds_read_b128 v[64:67], v17 offset:40960
s_waitcnt lgkmcnt(12)
v_mfma_f32_32x32x16_bf16 v[72:87], v[48:51], v[68:71], v[72:87]
ds_read_b64_tr_b16 v[36:37], v11 offset:9216
ds_read_b64_tr_b16 v[38:39], v11 offset:9984
s_waitcnt lgkmcnt(12)
v_mfma_f32_32x32x16_bf16 v[88:103], v[52:55], v[68:71], v[88:103]
ds_read_b64_tr_b16 v[40:41], v11 offset:9280
ds_read_b64_tr_b16 v[42:43], v11 offset:10048
s_waitcnt lgkmcnt(12)
v_mfma_f32_32x32x16_bf16 v[104:119], v[56:59], v[68:71], v[104:119]
ds_read_b64_tr_b16 v[44:45], v11 offset:9344
ds_read_b64_tr_b16 v[46:47], v11 offset:10112
s_barrier
v_add_u32 v10, 73728, v9
v_add_u32 v18, 69632, v14
ds_read_b128 v[68:71], v18
s_waitcnt lgkmcnt(12)
v_mfma_f32_32x32x16_bf16 v[72:87], v[24:27], v[60:63], v[72:87]
ds_read_b64_tr_b16 v[48:49], v10 offset:0
ds_read_b64_tr_b16 v[50:51], v10 offset:768
s_waitcnt lgkmcnt(12)
v_mfma_f32_32x32x16_bf16 v[88:103], v[28:31], v[60:63], v[88:103]
ds_read_b64_tr_b16 v[52:53], v10 offset:64
ds_read_b64_tr_b16 v[54:55], v10 offset:832
s_waitcnt lgkmcnt(12)
v_mfma_f32_32x32x16_bf16 v[104:119], v[32:35], v[60:63], v[104:119]
ds_read_b64_tr_b16 v[56:57], v10 offset:128
ds_read_b64_tr_b16 v[58:59], v10 offset:896
v_add_u32 v19, 69632, v15
ds_read_b128 v[60:63], v19
s_waitcnt lgkmcnt(12)
v_mfma_f32_32x32x16_bf16 v[72:87], v[36:39], v[64:67], v[72:87]
ds_read_b64_tr_b16 v[24:25], v10 offset:3072
ds_read_b64_tr_b16 v[26:27], v10 offset:3840
s_waitcnt lgkmcnt(12)
v_mfma_f32_32x32x16_bf16 v[88:103], v[40:43], v[64:67], v[88:103]
ds_read_b64_tr_b16 v[28:29], v10 offset:3136
ds_read_b64_tr_b16 v[30:31], v10 offset:3904
s_waitcnt lgkmcnt(12)
v_mfma_f32_32x32x16_bf16 v[104:119], v[44:47], v[64:67], v[104:119]
ds_read_b64_tr_b16 v[32:33], v10 offset:3200
ds_read_b64_tr_b16 v[34:35], v10 offset:3968
v_add_u32 v18, 69632, v16
ds_read_b128 v[64:67], v18
s_waitcnt lgkmcnt(12)
v_mfma_f32_32x32x16_bf16 v[72:87], v[48:51], v[68:71], v[72:87]
ds_read_b64_tr_b16 v[36:37], v10 offset:6144
ds_read_b64_tr_b16 v[38:39], v10 offset:6912
s_waitcnt lgkmcnt(12)
v_mfma_f32_32x32x16_bf16 v[88:103], v[52:55], v[68:71], v[88:103]
ds_read_b64_tr_b16 v[40:41], v10 offset:6208
ds_read_b64_tr_b16 v[42:43], v10 offset:6976
s_waitcnt lgkmcnt(12)
v_mfma_f32_32x32x16_bf16 v[104:119], v[56:59], v[68:71], v[104:119]
ds_read_b64_tr_b16 v[44:45], v10 offset:6272
ds_read_b64_tr_b16 v[46:47], v10 offset:7040
v_add_u32 v19, 69632, v17
ds_read_b128 v[68:71], v19
s_waitcnt lgkmcnt(12)
v_mfma_f32_32x32x16_bf16 v[72:87], v[24:27], v[60:63], v[72:87]
ds_read_b64_tr_b16 v[48:49], v10 offset:9216
ds_read_b64_tr_b16 v[50:51], v10 offset:9984
s_waitcnt lgkmcnt(12)
v_mfma_f32_32x32x16_bf16 v[88:103], v[28:31], v[60:63], v[88:103]
ds_read_b64_tr_b16 v[52:53], v10 offset:9280
ds_read_b64_tr_b16 v[54:55], v10 offset:10048
s_waitcnt lgkmcnt(12)
v_mfma_f32_32x32x16_bf16 v[104:119], v[32:35], v[60:63], v[104:119]
ds_read_b64_tr_b16 v[56:57], v10 offset:9344
ds_read_b64_tr_b16 v[58:59], v10 offset:10112
s_barrier
v_add_u32 v11, 102400, v9
v_add_u32 v18, 98304, v14
ds_read_b128 v[60:63], v18
s_waitcnt lgkmcnt(12)
v_mfma_f32_32x32x16_bf16 v[72:87], v[36:39], v[64:67], v[72:87]
ds_read_b64_tr_b16 v[24:25], v11 offset:0
ds_read_b64_tr_b16 v[26:27], v11 offset:768
s_waitcnt lgkmcnt(12)
v_mfma_f32_32x32x16_bf16 v[88:103], v[40:43], v[64:67], v[88:103]
ds_read_b64_tr_b16 v[28:29], v11 offset:64
ds_read_b64_tr_b16 v[30:31], v11 offset:832
s_waitcnt lgkmcnt(12)
v_mfma_f32_32x32x16_bf16 v[104:119], v[44:47], v[64:67], v[104:119]
ds_read_b64_tr_b16 v[32:33], v11 offset:128
ds_read_b64_tr_b16 v[34:35], v11 offset:896
v_add_u32 v19, 98304, v15
ds_read_b128 v[64:67], v19
s_waitcnt lgkmcnt(12)
v_mfma_f32_32x32x16_bf16 v[72:87], v[48:51], v[68:71], v[72:87]
ds_read_b64_tr_b16 v[36:37], v11 offset:3072
ds_read_b64_tr_b16 v[38:39], v11 offset:3840
s_waitcnt lgkmcnt(12)
v_mfma_f32_32x32x16_bf16 v[88:103], v[52:55], v[68:71], v[88:103]
ds_read_b64_tr_b16 v[40:41], v11 offset:3136
ds_read_b64_tr_b16 v[42:43], v11 offset:3904
s_waitcnt lgkmcnt(12)
v_mfma_f32_32x32x16_bf16 v[104:119], v[56:59], v[68:71], v[104:119]
ds_read_b64_tr_b16 v[44:45], v11 offset:3200
ds_read_b64_tr_b16 v[46:47], v11 offset:3968
v_add_u32 v18, 98304, v16
ds_read_b128 v[68:71], v18
s_waitcnt lgkmcnt(12)
v_mfma_f32_32x32x16_bf16 v[72:87], v[24:27], v[60:63], v[72:87]
ds_read_b64_tr_b16 v[48:49], v11 offset:6144
ds_read_b64_tr_b16 v[50:51], v11 offset:6912
s_waitcnt lgkmcnt(12)
v_mfma_f32_32x32x16_bf16 v[88:103], v[28:31], v[60:63], v[88:103]
ds_read_b64_tr_b16 v[52:53], v11 offset:6208
ds_read_b64_tr_b16 v[54:55], v11 offset:6976
s_waitcnt lgkmcnt(12)
v_mfma_f32_32x32x16_bf16 v[104:119], v[32:35], v[60:63], v[104:119]
ds_read_b64_tr_b16 v[56:57], v11 offset:6272
ds_read_b64_tr_b16 v[58:59], v11 offset:7040
v_add_u32 v19, 98304, v17
ds_read_b128 v[60:63], v19
s_waitcnt lgkmcnt(12)
v_mfma_f32_32x32x16_bf16 v[72:87], v[36:39], v[64:67], v[72:87]
ds_read_b64_tr_b16 v[24:25], v11 offset:9216
ds_read_b64_tr_b16 v[26:27], v11 offset:9984
s_waitcnt lgkmcnt(12)
v_mfma_f32_32x32x16_bf16 v[88:103], v[40:43], v[64:67], v[88:103]
ds_read_b64_tr_b16 v[28:29], v11 offset:9280
ds_read_b64_tr_b16 v[30:31], v11 offset:10048
s_waitcnt lgkmcnt(12)
v_mfma_f32_32x32x16_bf16 v[104:119], v[44:47], v[64:67], v[104:119]
ds_read_b64_tr_b16 v[32:33], v11 offset:9344
ds_read_b64_tr_b16 v[34:35], v11 offset:10112
s_barrier
v_add_u32 v10, 131072, v9
v_add_u32 v18, 126976, v14
ds_read_b128 v[64:67], v18
s_waitcnt lgkmcnt(12)
v_mfma_f32_32x32x16_bf16 v[72:87], v[48:51], v[68:71], v[72:87]
ds_read_b64_tr_b16 v[36:37], v10 offset:0
ds_read_b64_tr_b16 v[38:39], v10 offset:768
s_waitcnt lgkmcnt(12)
v_mfma_f32_32x32x16_bf16 v[88:103], v[52:55], v[68:71], v[88:103]
ds_read_b64_tr_b16 v[40:41], v10 offset:64
ds_read_b64_tr_b16 v[42:43], v10 offset:832
s_waitcnt lgkmcnt(12)
v_mfma_f32_32x32x16_bf16 v[104:119], v[56:59], v[68:71], v[104:119]
ds_read_b64_tr_b16 v[44:45], v10 offset:128
ds_read_b64_tr_b16 v[46:47], v10 offset:896
v_add_u32 v19, 126976, v15
ds_read_b128 v[68:71], v19
s_waitcnt lgkmcnt(12)
v_mfma_f32_32x32x16_bf16 v[72:87], v[24:27], v[60:63], v[72:87]
ds_read_b64_tr_b16 v[48:49], v10 offset:3072
ds_read_b64_tr_b16 v[50:51], v10 offset:3840
s_waitcnt lgkmcnt(12)
v_mfma_f32_32x32x16_bf16 v[88:103], v[28:31], v[60:63], v[88:103]
ds_read_b64_tr_b16 v[52:53], v10 offset:3136
ds_read_b64_tr_b16 v[54:55], v10 offset:3904
s_waitcnt lgkmcnt(12)
v_mfma_f32_32x32x16_bf16 v[104:119], v[32:35], v[60:63], v[104:119]
ds_read_b64_tr_b16 v[56:57], v10 offset:3200
ds_read_b64_tr_b16 v[58:59], v10 offset:3968
v_add_u32 v18, 126976, v16
ds_read_b128 v[60:63], v18
s_waitcnt lgkmcnt(12)
v_mfma_f32_32x32x16_bf16 v[72:87], v[36:39], v[64:67], v[72:87]
ds_read_b64_tr_b16 v[24:25], v10 offset:6144
ds_read_b64_tr_b16 v[26:27], v10 offset:6912
s_waitcnt lgkmcnt(12)
v_mfma_f32_32x32x16_bf16 v[88:103], v[40:43], v[64:67], v[88:103]
ds_read_b64_tr_b16 v[28:29], v10 offset:6208
ds_read_b64_tr_b16 v[30:31], v10 offset:6976
s_waitcnt lgkmcnt(12)
v_mfma_f32_32x32x16_bf16 v[104:119], v[44:47], v[64:67], v[104:119]
ds_read_b64_tr_b16 v[32:33], v10 offset:6272
ds_read_b64_tr_b16 v[34:35], v10 offset:7040
v_add_u32 v19, 126976, v17
ds_read_b128 v[64:67], v19
s_waitcnt lgkmcnt(12)
v_mfma_f32_32x32x16_bf16 v[72:87], v[48:51], v[68:71], v[72:87]
ds_read_b64_tr_b16 v[36:37], v10 offset:9216
ds_read_b64_tr_b16 v[38:39], v10 offset:9984
s_waitcnt lgkmcnt(12)
v_mfma_f32_32x32x16_bf16 v[88:103], v[52:55], v[68:71], v[88:103]
ds_read_b64_tr_b16 v[40:41], v10 offset:9280
ds_read_b64_tr_b16 v[42:43], v10 offset:10048
s_waitcnt lgkmcnt(12)
v_mfma_f32_32x32x16_bf16 v[104:119], v[56:59], v[68:71], v[104:119]
ds_read_b64_tr_b16 v[44:45], v10 offset:9344
ds_read_b64_tr_b16 v[46:47], v10 offset:10112
s_barrier
v_add_u32 v11, 16384, v9
ds_read_b128 v[68:71], v14 offset:12288
s_waitcnt lgkmcnt(12)
v_mfma_f32_32x32x16_bf16 v[72:87], v[24:27], v[60:63], v[72:87]
ds_read_b64_tr_b16 v[48:49], v11 offset:0
ds_read_b64_tr_b16 v[50:51], v11 offset:768
s_waitcnt lgkmcnt(12)
v_mfma_f32_32x32x16_bf16 v[88:103], v[28:31], v[60:63], v[88:103]
ds_read_b64_tr_b16 v[52:53], v11 offset:64
ds_read_b64_tr_b16 v[54:55], v11 offset:832
s_waitcnt lgkmcnt(12)
v_mfma_f32_32x32x16_bf16 v[104:119], v[32:35], v[60:63], v[104:119]
ds_read_b64_tr_b16 v[56:57], v11 offset:128
ds_read_b64_tr_b16 v[58:59], v11 offset:896
ds_read_b128 v[60:63], v15 offset:12288
s_waitcnt lgkmcnt(12)
v_mfma_f32_32x32x16_bf16 v[72:87], v[36:39], v[64:67], v[72:87]
ds_read_b64_tr_b16 v[24:25], v11 offset:3072
ds_read_b64_tr_b16 v[26:27], v11 offset:3840
s_waitcnt lgkmcnt(12)
v_mfma_f32_32x32x16_bf16 v[88:103], v[40:43], v[64:67], v[88:103]
ds_read_b64_tr_b16 v[28:29], v11 offset:3136
ds_read_b64_tr_b16 v[30:31], v11 offset:3904
s_waitcnt lgkmcnt(12)
v_mfma_f32_32x32x16_bf16 v[104:119], v[44:47], v[64:67], v[104:119]
ds_read_b64_tr_b16 v[32:33], v11 offset:3200
ds_read_b64_tr_b16 v[34:35], v11 offset:3968
ds_read_b128 v[64:67], v16 offset:12288
s_waitcnt lgkmcnt(12)
v_mfma_f32_32x32x16_bf16 v[72:87], v[48:51], v[68:71], v[72:87]
ds_read_b64_tr_b16 v[36:37], v11 offset:6144
ds_read_b64_tr_b16 v[38:39], v11 offset:6912
s_waitcnt lgkmcnt(12)
v_mfma_f32_32x32x16_bf16 v[88:103], v[52:55], v[68:71], v[88:103]
ds_read_b64_tr_b16 v[40:41], v11 offset:6208
ds_read_b64_tr_b16 v[42:43], v11 offset:6976
s_waitcnt lgkmcnt(12)
v_mfma_f32_32x32x16_bf16 v[104:119], v[56:59], v[68:71], v[104:119]
ds_read_b64_tr_b16 v[44:45], v11 offset:6272
ds_read_b64_tr_b16 v[46:47], v11 offset:7040
ds_read_b128 v[68:71], v17 offset:12288
s_waitcnt lgkmcnt(12)
v_mfma_f32_32x32x16_bf16 v[72:87], v[24:27], v[60:63], v[72:87]
ds_read_b64_tr_b16 v[48:49], v11 offset:9216
ds_read_b64_tr_b16 v[50:51], v11 offset:9984
s_waitcnt lgkmcnt(12)
v_mfma_f32_32x32x16_bf16 v[88:103], v[28:31], v[60:63], v[88:103]
ds_read_b64_tr_b16 v[52:53], v11 offset:9280
ds_read_b64_tr_b16 v[54:55], v11 offset:10048
s_waitcnt lgkmcnt(12)
v_mfma_f32_32x32x16_bf16 v[104:119], v[32:35], v[60:63], v[104:119]
ds_read_b64_tr_b16 v[56:57], v11 offset:9344
ds_read_b64_tr_b16 v[58:59], v11 offset:10112
s_barrier
v_add_u32 v10, 45056, v9
ds_read_b128 v[60:63], v14 offset:40960
s_waitcnt lgkmcnt(12)
v_mfma_f32_32x32x16_bf16 v[72:87], v[36:39], v[64:67], v[72:87]
ds_read_b64_tr_b16 v[24:25], v10 offset:0
ds_read_b64_tr_b16 v[26:27], v10 offset:768
s_waitcnt lgkmcnt(12)
v_mfma_f32_32x32x16_bf16 v[88:103], v[40:43], v[64:67], v[88:103]
ds_read_b64_tr_b16 v[28:29], v10 offset:64
ds_read_b64_tr_b16 v[30:31], v10 offset:832
s_waitcnt lgkmcnt(12)
v_mfma_f32_32x32x16_bf16 v[104:119], v[44:47], v[64:67], v[104:119]
ds_read_b64_tr_b16 v[32:33], v10 offset:128
ds_read_b64_tr_b16 v[34:35], v10 offset:896
ds_read_b128 v[64:67], v15 offset:40960
s_waitcnt lgkmcnt(12)
v_mfma_f32_32x32x16_bf16 v[72:87], v[48:51], v[68:71], v[72:87]
ds_read_b64_tr_b16 v[36:37], v10 offset:3072
ds_read_b64_tr_b16 v[38:39], v10 offset:3840
s_waitcnt lgkmcnt(12)
v_mfma_f32_32x32x16_bf16 v[88:103], v[52:55], v[68:71], v[88:103]
ds_read_b64_tr_b16 v[40:41], v10 offset:3136
ds_read_b64_tr_b16 v[42:43], v10 offset:3904
s_waitcnt lgkmcnt(12)
v_mfma_f32_32x32x16_bf16 v[104:119], v[56:59], v[68:71], v[104:119]
ds_read_b64_tr_b16 v[44:45], v10 offset:3200
ds_read_b64_tr_b16 v[46:47], v10 offset:3968
ds_read_b128 v[68:71], v16 offset:40960
s_waitcnt lgkmcnt(12)
v_mfma_f32_32x32x16_bf16 v[72:87], v[24:27], v[60:63], v[72:87]
ds_read_b64_tr_b16 v[48:49], v10 offset:6144
ds_read_b64_tr_b16 v[50:51], v10 offset:6912
s_waitcnt lgkmcnt(12)
v_mfma_f32_32x32x16_bf16 v[88:103], v[28:31], v[60:63], v[88:103]
ds_read_b64_tr_b16 v[52:53], v10 offset:6208
ds_read_b64_tr_b16 v[54:55], v10 offset:6976
s_waitcnt lgkmcnt(12)
v_mfma_f32_32x32x16_bf16 v[104:119], v[32:35], v[60:63], v[104:119]
ds_read_b64_tr_b16 v[56:57], v10 offset:6272
ds_read_b64_tr_b16 v[58:59], v10 offset:7040
ds_read_b128 v[60:63], v17 offset:40960
s_waitcnt lgkmcnt(12)
v_mfma_f32_32x32x16_bf16 v[72:87], v[36:39], v[64:67], v[72:87]
ds_read_b64_tr_b16 v[24:25], v10 offset:9216
ds_read_b64_tr_b16 v[26:27], v10 offset:9984
s_waitcnt lgkmcnt(12)
v_mfma_f32_32x32x16_bf16 v[88:103], v[40:43], v[64:67], v[88:103]
ds_read_b64_tr_b16 v[28:29], v10 offset:9280
ds_read_b64_tr_b16 v[30:31], v10 offset:10048
s_waitcnt lgkmcnt(12)
v_mfma_f32_32x32x16_bf16 v[104:119], v[44:47], v[64:67], v[104:119]
ds_read_b64_tr_b16 v[32:33], v10 offset:9344
ds_read_b64_tr_b16 v[34:35], v10 offset:10112
s_barrier
v_add_u32 v11, 73728, v9
v_add_u32 v18, 69632, v14
ds_read_b128 v[64:67], v18
s_waitcnt lgkmcnt(12)
v_mfma_f32_32x32x16_bf16 v[72:87], v[48:51], v[68:71], v[72:87]
ds_read_b64_tr_b16 v[36:37], v11 offset:0
ds_read_b64_tr_b16 v[38:39], v11 offset:768
s_waitcnt lgkmcnt(12)
v_mfma_f32_32x32x16_bf16 v[88:103], v[52:55], v[68:71], v[88:103]
ds_read_b64_tr_b16 v[40:41], v11 offset:64
ds_read_b64_tr_b16 v[42:43], v11 offset:832
s_waitcnt lgkmcnt(12)
v_mfma_f32_32x32x16_bf16 v[104:119], v[56:59], v[68:71], v[104:119]
ds_read_b64_tr_b16 v[44:45], v11 offset:128
ds_read_b64_tr_b16 v[46:47], v11 offset:896
v_add_u32 v19, 69632, v15
ds_read_b128 v[68:71], v19
s_waitcnt lgkmcnt(12)
v_mfma_f32_32x32x16_bf16 v[72:87], v[24:27], v[60:63], v[72:87]
ds_read_b64_tr_b16 v[48:49], v11 offset:3072
ds_read_b64_tr_b16 v[50:51], v11 offset:3840
s_waitcnt lgkmcnt(12)
v_mfma_f32_32x32x16_bf16 v[88:103], v[28:31], v[60:63], v[88:103]
ds_read_b64_tr_b16 v[52:53], v11 offset:3136
ds_read_b64_tr_b16 v[54:55], v11 offset:3904
s_waitcnt lgkmcnt(12)
v_mfma_f32_32x32x16_bf16 v[104:119], v[32:35], v[60:63], v[104:119]
ds_read_b64_tr_b16 v[56:57], v11 offset:3200
ds_read_b64_tr_b16 v[58:59], v11 offset:3968
v_add_u32 v18, 69632, v16
ds_read_b128 v[60:63], v18
s_waitcnt lgkmcnt(12)
v_mfma_f32_32x32x16_bf16 v[72:87], v[36:39], v[64:67], v[72:87]
ds_read_b64_tr_b16 v[24:25], v11 offset:6144
ds_read_b64_tr_b16 v[26:27], v11 offset:6912
s_waitcnt lgkmcnt(12)
v_mfma_f32_32x32x16_bf16 v[88:103], v[40:43], v[64:67], v[88:103]
ds_read_b64_tr_b16 v[28:29], v11 offset:6208
ds_read_b64_tr_b16 v[30:31], v11 offset:6976
s_waitcnt lgkmcnt(12)
v_mfma_f32_32x32x16_bf16 v[104:119], v[44:47], v[64:67], v[104:119]
ds_read_b64_tr_b16 v[32:33], v11 offset:6272
ds_read_b64_tr_b16 v[34:35], v11 offset:7040
v_add_u32 v19, 69632, v17
ds_read_b128 v[64:67], v19
s_waitcnt lgkmcnt(12)
v_mfma_f32_32x32x16_bf16 v[72:87], v[48:51], v[68:71], v[72:87]
ds_read_b64_tr_b16 v[36:37], v11 offset:9216
ds_read_b64_tr_b16 v[38:39], v11 offset:9984
s_waitcnt lgkmcnt(12)
v_mfma_f32_32x32x16_bf16 v[88:103], v[52:55], v[68:71], v[88:103]
ds_read_b64_tr_b16 v[40:41], v11 offset:9280
ds_read_b64_tr_b16 v[42:43], v11 offset:10048
s_waitcnt lgkmcnt(12)
v_mfma_f32_32x32x16_bf16 v[104:119], v[56:59], v[68:71], v[104:119]
ds_read_b64_tr_b16 v[44:45], v11 offset:9344
ds_read_b64_tr_b16 v[46:47], v11 offset:10112
s_waitcnt lgkmcnt(11)
v_mfma_f32_32x32x16_bf16 v[72:87], v[24:27], v[60:63], v[72:87]
s_waitcnt lgkmcnt(9)
v_mfma_f32_32x32x16_bf16 v[88:103], v[28:31], v[60:63], v[88:103]
s_waitcnt lgkmcnt(7)
v_mfma_f32_32x32x16_bf16 v[104:119], v[32:35], v[60:63], v[104:119]
s_waitcnt lgkmcnt(4)
v_mfma_f32_32x32x16_bf16 v[72:87], v[36:39], v[64:67], v[72:87]
s_waitcnt lgkmcnt(2)
v_mfma_f32_32x32x16_bf16 v[88:103], v[40:43], v[64:67], v[88:103]
s_waitcnt lgkmcnt(0)
v_mfma_f32_32x32x16_bf16 v[104:119], v[44:47], v[64:67], v[104:119]
s_barrier
v_and_b32 v134, 31, v1
v_lshlrev_b32 v134, 3, v134
v_add_u32 v134, 2816, v134
ds_read_b64 v[132:133], v134
v_lshlrev_b32 v137, 4, v5
v_add_u32 v137, 0, v137
ds_read_b128 v[24:27], v137 offset:0
ds_read_b128 v[28:31], v137 offset:32
ds_read_b128 v[32:35], v137 offset:64
ds_read_b128 v[36:39], v137 offset:96
s_lshl_b32 s7, s4, 2
s_add_u32 s7, s7, 3
v_bfe_u32 v121, v1, 4, 1
v_bfe_u32 v122, v1, 2, 1
v_lshlrev_b32 v122, 3, v122
v_lshl_add_u32 v122, v121, 4, v122
v_and_b32 v123, 3, v1
v_add_u32 v122, v122, v123
v_bfe_u32 v123, v1, 3, 1
v_lshl_add_u32 v122, v123, 2, v122
v_lshlrev_b32 v122, 1, v122
v_mul_u32_u24 v123, 320, v5
v_add_u32 v128, v122, v123
v_add_u32 v128, 11776, v128
v_lshl_add_u32 v122, v5, 4, v4
v_mul_u32_u24 v122, 80, v122
v_lshl_add_u32 v122, v121, 4, v122
v_add_u32 v129, 11776, v122
v_and_b32 v122, 31, v1
v_lshlrev_b32 v122, 4, v122
v_lshl_add_u32 v130, v5, 16, v122
ds_read_b128 v[40:43], v137 offset:128
ds_read_b128 v[44:47], v137 offset:160
ds_read_b128 v[48:51], v137 offset:192
ds_read_b128 v[52:55], v137 offset:224
s_mul_i32 s8, s5, 3
s_add_u32 s8, s8, 0
s_lshr_b32 s9, s8, 4
s_and_b32 s10, s8, 15
s_lshl_b32 s10, s10, 17
s_cmp_eq_u32 s9, 0
s_cselect_b32 s11, 0x3eb8aa3b, 0x3f800000
s_lshr_b32 s12, s9, 0
s_mul_i32 s12, s9, 2097152
s_add_u32 s12, s12, 2097152
s_add_u32 s12, s12, s10
s_lshl_b32 s13, s7, 10
s_add_u32 s12, s12, s13
s_waitcnt lgkmcnt(8)
v_mul_f32 v138, s11, v133
s_waitcnt lgkmcnt(7)
v_pk_fma_f32 v[72:73], v[24:25], v[132:133], v[72:73] op_sel_hi:[1,0,1]
v_pk_fma_f32 v[74:75], v[26:27], v[132:133], v[74:75] op_sel_hi:[1,0,1]
s_waitcnt lgkmcnt(6)
v_pk_fma_f32 v[76:77], v[28:29], v[132:133], v[76:77] op_sel_hi:[1,0,1]
v_pk_fma_f32 v[78:79], v[30:31], v[132:133], v[78:79] op_sel_hi:[1,0,1]
s_waitcnt lgkmcnt(5)
v_pk_fma_f32 v[80:81], v[32:33], v[132:133], v[80:81] op_sel_hi:[1,0,1]
v_pk_fma_f32 v[82:83], v[34:35], v[132:133], v[82:83] op_sel_hi:[1,0,1]
s_waitcnt lgkmcnt(4)
v_pk_fma_f32 v[84:85], v[36:37], v[132:133], v[84:85] op_sel_hi:[1,0,1]
v_pk_fma_f32 v[86:87], v[38:39], v[132:133], v[86:87] op_sel_hi:[1,0,1]
v_pk_mul_f32 v[72:73], v[72:73], v[138:139] op_sel_hi:[1,0]
v_pk_mul_f32 v[74:75], v[74:75], v[138:139] op_sel_hi:[1,0]
v_pk_mul_f32 v[76:77], v[76:77], v[138:139] op_sel_hi:[1,0]
v_pk_mul_f32 v[78:79], v[78:79], v[138:139] op_sel_hi:[1,0]
v_pk_mul_f32 v[80:81], v[80:81], v[138:139] op_sel_hi:[1,0]
v_pk_mul_f32 v[82:83], v[82:83], v[138:139] op_sel_hi:[1,0]
v_pk_mul_f32 v[84:85], v[84:85], v[138:139] op_sel_hi:[1,0]
v_pk_mul_f32 v[86:87], v[86:87], v[138:139] op_sel_hi:[1,0]
s_cmp_eq_u32 s9, 2
s_cbranch_scc1 k1_kernel_w3_t0_v
v_cvt_pk_bf16_f32 v120, v72, v73
v_cvt_pk_bf16_f32 v121, v74, v75
v_cvt_pk_bf16_f32 v122, v76, v77
v_cvt_pk_bf16_f32 v123, v78, v79
s_nop 0
v_permlane32_swap_b32 v120, v122
v_permlane32_swap_b32 v121, v123
v_cvt_pk_bf16_f32 v124, v80, v81
v_cvt_pk_bf16_f32 v125, v82, v83
v_cvt_pk_bf16_f32 v126, v84, v85
v_cvt_pk_bf16_f32 v127, v86, v87
s_nop 0
v_permlane32_swap_b32 v124, v126
v_permlane32_swap_b32 v125, v127
buffer_store_dwordx4 v[120:123], v3, s[52:55], s12 offen sc0 sc1
s_add_u32 s12, s12, 65536
buffer_store_dwordx4 v[124:127], v3, s[52:55], s12 offen sc0 sc1
s_branch k1_kernel_w3_t0_j
k1_kernel_w3_t0_v:
v_cvt_pk_bf16_f32 v120, v72, v73
v_cvt_pk_bf16_f32 v121, v74, v75
v_cvt_pk_bf16_f32 v122, v76, v77
v_cvt_pk_bf16_f32 v123, v78, v79
v_cvt_pk_bf16_f32 v124, v80, v81
v_cvt_pk_bf16_f32 v125, v82, v83
v_cvt_pk_bf16_f32 v126, v84, v85
v_cvt_pk_bf16_f32 v127, v86, v87
ds_write_b16 v128, v120 offset:0
ds_write_b16_d16_hi v128, v120 offset:80
ds_write_b16 v128, v121 offset:160
ds_write_b16_d16_hi v128, v121 offset:240
ds_write_b16 v128, v122 offset:640
ds_write_b16_d16_hi v128, v122 offset:720
ds_write_b16 v128, v123 offset:800
ds_write_b16_d16_hi v128, v123 offset:880
ds_write_b16 v128, v124 offset:1280
ds_write_b16_d16_hi v128, v124 offset:1360
ds_write_b16 v128, v125 offset:1440
s_waitcnt lgkmcnt(13)
ds_write_b16_d16_hi v128, v125 offset:1520
ds_write_b16 v128, v126 offset:1920
s_waitcnt lgkmcnt(13)
ds_write_b16_d16_hi v128, v126 offset:2000
ds_write_b16 v128, v127 offset:2080
s_waitcnt lgkmcnt(13)
ds_write_b16_d16_hi v128, v127 offset:2160
ds_read_b128 v[120:123], v129
s_waitcnt lgkmcnt(13)
ds_read_b128 v[124:127], v129 offset:32
s_waitcnt lgkmcnt(1)
buffer_store_dwordx4 v[120:123], v130, s[52:55], s12 offen sc0 sc1
s_waitcnt lgkmcnt(0)
buffer_store_dwordx4 v[124:127], v130, s[52:55], s12 offen offset:512 sc0 sc1
k1_kernel_w3_t0_j:
s_waitcnt lgkmcnt(0)
ds_read_b128 v[24:27], v137 offset:256
ds_read_b128 v[28:31], v137 offset:288
ds_read_b128 v[32:35], v137 offset:320
ds_read_b128 v[36:39], v137 offset:352
s_mul_i32 s8, s5, 3
s_add_u32 s8, s8, 1
s_lshr_b32 s9, s8, 4
s_and_b32 s10, s8, 15
s_lshl_b32 s10, s10, 17
s_cmp_eq_u32 s9, 0
s_cselect_b32 s11, 0x3eb8aa3b, 0x3f800000
s_lshr_b32 s12, s9, 0
s_mul_i32 s12, s9, 2097152
s_add_u32 s12, s12, 2097152
s_add_u32 s12, s12, s10
s_lshl_b32 s13, s7, 10
s_add_u32 s12, s12, s13
v_mul_f32 v138, s11, v133
v_pk_fma_f32 v[88:89], v[40:41], v[132:133], v[88:89] op_sel_hi:[1,0,1]
v_pk_fma_f32 v[90:91], v[42:43], v[132:133], v[90:91] op_sel_hi:[1,0,1]
v_pk_fma_f32 v[92:93], v[44:45], v[132:133], v[92:93] op_sel_hi:[1,0,1]
v_pk_fma_f32 v[94:95], v[46:47], v[132:133], v[94:95] op_sel_hi:[1,0,1]
v_pk_fma_f32 v[96:97], v[48:49], v[132:133], v[96:97] op_sel_hi:[1,0,1]
v_pk_fma_f32 v[98:99], v[50:51], v[132:133], v[98:99] op_sel_hi:[1,0,1]
v_pk_fma_f32 v[100:101], v[52:53], v[132:133], v[100:101] op_sel_hi:[1,0,1]
v_pk_fma_f32 v[102:103], v[54:55], v[132:133], v[102:103] op_sel_hi:[1,0,1]
v_pk_mul_f32 v[88:89], v[88:89], v[138:139] op_sel_hi:[1,0]
v_pk_mul_f32 v[90:91], v[90:91], v[138:139] op_sel_hi:[1,0]
v_pk_mul_f32 v[92:93], v[92:93], v[138:139] op_sel_hi:[1,0]
v_pk_mul_f32 v[94:95], v[94:95], v[138:139] op_sel_hi:[1,0]
v_pk_mul_f32 v[96:97], v[96:97], v[138:139] op_sel_hi:[1,0]
v_pk_mul_f32 v[98:99], v[98:99], v[138:139] op_sel_hi:[1,0]
v_pk_mul_f32 v[100:101], v[100:101], v[138:139] op_sel_hi:[1,0]
v_pk_mul_f32 v[102:103], v[102:103], v[138:139] op_sel_hi:[1,0]
s_cmp_eq_u32 s9, 2
s_cbranch_scc1 k1_kernel_w3_t1_v
v_cvt_pk_bf16_f32 v120, v88, v89
v_cvt_pk_bf16_f32 v121, v90, v91
v_cvt_pk_bf16_f32 v122, v92, v93
v_cvt_pk_bf16_f32 v123, v94, v95
s_nop 0
v_permlane32_swap_b32 v120, v122
v_permlane32_swap_b32 v121, v123
v_cvt_pk_bf16_f32 v124, v96, v97
v_cvt_pk_bf16_f32 v125, v98, v99
v_cvt_pk_bf16_f32 v126, v100, v101
v_cvt_pk_bf16_f32 v127, v102, v103
s_nop 0
v_permlane32_swap_b32 v124, v126
v_permlane32_swap_b32 v125, v127
buffer_store_dwordx4 v[120:123], v3, s[52:55], s12 offen sc0 sc1
s_add_u32 s12, s12, 65536
buffer_store_dwordx4 v[124:127], v3, s[52:55], s12 offen sc0 sc1
s_branch k1_kernel_w3_t1_j
k1_kernel_w3_t1_v:
v_cvt_pk_bf16_f32 v120, v88, v89
v_cvt_pk_bf16_f32 v121, v90, v91
v_cvt_pk_bf16_f32 v122, v92, v93
v_cvt_pk_bf16_f32 v123, v94, v95
v_cvt_pk_bf16_f32 v124, v96, v97
v_cvt_pk_bf16_f32 v125, v98, v99
v_cvt_pk_bf16_f32 v126, v100, v101
v_cvt_pk_bf16_f32 v127, v102, v103
ds_write_b16 v128, v120 offset:0
ds_write_b16_d16_hi v128, v120 offset:80
ds_write_b16 v128, v121 offset:160
ds_write_b16_d16_hi v128, v121 offset:240
ds_write_b16 v128, v122 offset:640
ds_write_b16_d16_hi v128, v122 offset:720
ds_write_b16 v128, v123 offset:800
ds_write_b16_d16_hi v128, v123 offset:880
ds_write_b16 v128, v124 offset:1280
ds_write_b16_d16_hi v128, v124 offset:1360
ds_write_b16 v128, v125 offset:1440
s_waitcnt lgkmcnt(13)
ds_write_b16_d16_hi v128, v125 offset:1520
ds_write_b16 v128, v126 offset:1920
s_waitcnt lgkmcnt(13)
ds_write_b16_d16_hi v128, v126 offset:2000
ds_write_b16 v128, v127 offset:2080
s_waitcnt lgkmcnt(13)
ds_write_b16_d16_hi v128, v127 offset:2160
ds_read_b128 v[120:123], v129
s_waitcnt lgkmcnt(13)
ds_read_b128 v[124:127], v129 offset:32
s_waitcnt lgkmcnt(1)
buffer_store_dwordx4 v[120:123], v130, s[52:55], s12 offen sc0 sc1
s_waitcnt lgkmcnt(0)
buffer_store_dwordx4 v[124:127], v130, s[52:55], s12 offen offset:512 sc0 sc1
k1_kernel_w3_t1_j:
s_waitcnt lgkmcnt(0)
s_mul_i32 s8, s5, 3
s_add_u32 s8, s8, 2
s_lshr_b32 s9, s8, 4
s_and_b32 s10, s8, 15
s_lshl_b32 s10, s10, 17
s_cmp_eq_u32 s9, 0
s_cselect_b32 s11, 0x3eb8aa3b, 0x3f800000
s_lshr_b32 s12, s9, 0
s_mul_i32 s12, s9, 2097152
s_add_u32 s12, s12, 2097152
s_add_u32 s12, s12, s10
s_lshl_b32 s13, s7, 10
s_add_u32 s12, s12, s13
v_mul_f32 v138, s11, v133
v_pk_fma_f32 v[104:105], v[24:25], v[132:133], v[104:105] op_sel_hi:[1,0,1]
v_pk_fma_f32 v[106:107], v[26:27], v[132:133], v[106:107] op_sel_hi:[1,0,1]
v_pk_fma_f32 v[108:109], v[28:29], v[132:133], v[108:109] op_sel_hi:[1,0,1]
v_pk_fma_f32 v[110:111], v[30:31], v[132:133], v[110:111] op_sel_hi:[1,0,1]
v_pk_fma_f32 v[112:113], v[32:33], v[132:133], v[112:113] op_sel_hi:[1,0,1]
v_pk_fma_f32 v[114:115], v[34:35], v[132:133], v[114:115] op_sel_hi:[1,0,1]
v_pk_fma_f32 v[116:117], v[36:37], v[132:133], v[116:117] op_sel_hi:[1,0,1]
v_pk_fma_f32 v[118:119], v[38:39], v[132:133], v[118:119] op_sel_hi:[1,0,1]
v_pk_mul_f32 v[104:105], v[104:105], v[138:139] op_sel_hi:[1,0]
v_pk_mul_f32 v[106:107], v[106:107], v[138:139] op_sel_hi:[1,0]
v_pk_mul_f32 v[108:109], v[108:109], v[138:139] op_sel_hi:[1,0]
v_pk_mul_f32 v[110:111], v[110:111], v[138:139] op_sel_hi:[1,0]
v_pk_mul_f32 v[112:113], v[112:113], v[138:139] op_sel_hi:[1,0]
v_pk_mul_f32 v[114:115], v[114:115], v[138:139] op_sel_hi:[1,0]
v_pk_mul_f32 v[116:117], v[116:117], v[138:139] op_sel_hi:[1,0]
v_pk_mul_f32 v[118:119], v[118:119], v[138:139] op_sel_hi:[1,0]
s_cmp_eq_u32 s9, 2
s_cbranch_scc1 k1_kernel_w3_t2_v
v_cvt_pk_bf16_f32 v120, v104, v105
v_cvt_pk_bf16_f32 v121, v106, v107
v_cvt_pk_bf16_f32 v122, v108, v109
v_cvt_pk_bf16_f32 v123, v110, v111
s_nop 0
v_permlane32_swap_b32 v120, v122
v_permlane32_swap_b32 v121, v123
v_cvt_pk_bf16_f32 v124, v112, v113
v_cvt_pk_bf16_f32 v125, v114, v115
v_cvt_pk_bf16_f32 v126, v116, v117
v_cvt_pk_bf16_f32 v127, v118, v119
s_nop 0
v_permlane32_swap_b32 v124, v126
v_permlane32_swap_b32 v125, v127
buffer_store_dwordx4 v[120:123], v3, s[52:55], s12 offen sc0 sc1
s_add_u32 s12, s12, 65536
buffer_store_dwordx4 v[124:127], v3, s[52:55], s12 offen sc0 sc1
s_branch k1_kernel_w3_t2_j
k1_kernel_w3_t2_v:
v_cvt_pk_bf16_f32 v120, v104, v105
v_cvt_pk_bf16_f32 v121, v106, v107
v_cvt_pk_bf16_f32 v122, v108, v109
v_cvt_pk_bf16_f32 v123, v110, v111
v_cvt_pk_bf16_f32 v124, v112, v113
v_cvt_pk_bf16_f32 v125, v114, v115
v_cvt_pk_bf16_f32 v126, v116, v117
v_cvt_pk_bf16_f32 v127, v118, v119
ds_write_b16 v128, v120 offset:0
ds_write_b16_d16_hi v128, v120 offset:80
ds_write_b16 v128, v121 offset:160
ds_write_b16_d16_hi v128, v121 offset:240
ds_write_b16 v128, v122 offset:640
ds_write_b16_d16_hi v128, v122 offset:720
ds_write_b16 v128, v123 offset:800
ds_write_b16_d16_hi v128, v123 offset:880
ds_write_b16 v128, v124 offset:1280
ds_write_b16_d16_hi v128, v124 offset:1360
ds_write_b16 v128, v125 offset:1440
ds_write_b16_d16_hi v128, v125 offset:1520
ds_write_b16 v128, v126 offset:1920
ds_write_b16_d16_hi v128, v126 offset:2000
ds_write_b16 v128, v127 offset:2080
s_waitcnt lgkmcnt(13)
ds_write_b16_d16_hi v128, v127 offset:2160
ds_read_b128 v[120:123], v129
s_waitcnt lgkmcnt(13)
ds_read_b128 v[124:127], v129 offset:32
s_waitcnt lgkmcnt(1)
buffer_store_dwordx4 v[120:123], v130, s[52:55], s12 offen sc0 sc1
s_waitcnt lgkmcnt(0)
buffer_store_dwordx4 v[124:127], v130, s[52:55], s12 offen offset:512 sc0 sc1
k1_kernel_w3_t2_j:
s_waitcnt lgkmcnt(0)
s_waitcnt vmcnt(0)
s_branch k1_kernel_end
k1_kernel_w4:
v_add_u32 v9, 0, v1
s_mov_b32 s7, 5462
v_mul_lo_u32 v10, v9, s7
v_lshrrev_b32 v10, 16, v10
v_mul_u32_u24 v11, 12, v10
v_sub_u32 v11, v9, v11
v_lshlrev_b32 v11, 4, v11
s_mov_b32 s7, 3072
v_mul_lo_u32 v10, v10, s7
v_add_u32 v15, v10, v11
v_add_u32 v9, 64, v1
s_mov_b32 s7, 5462
v_mul_lo_u32 v10, v9, s7
v_lshrrev_b32 v10, 16, v10
v_mul_u32_u24 v11, 12, v10
v_sub_u32 v11, v9, v11
v_lshlrev_b32 v11, 4, v11
s_mov_b32 s7, 3072
v_mul_lo_u32 v10, v10, s7
v_add_u32 v16, v10, v11
v_add_u32 v9, 128, v1
s_mov_b32 s7, 5462
v_mul_lo_u32 v10, v9, s7
v_lshrrev_b32 v10, 16, v10
v_mul_u32_u24 v11, 12, v10
v_sub_u32 v11, v9, v11
v_lshlrev_b32 v11, 4, v11
s_mov_b32 s7, 3072
v_mul_lo_u32 v10, v10, s7
v_add_u32 v17, v10, v11
v_lshrrev_b32 v9, 4, v1
v_add_u32 v9, 0, v9
v_and_b32 v9, 7, v9
v_and_b32 v10, 7, v1
v_xor_b32 v9, v9, v10
v_lshlrev_b32 v9, 4, v9
v_lshrrev_b32 v10, 3, v1
v_add_u32 v10, 0, v10
v_lshl_add_u32 v18, v10, 10, v9
v_lshrrev_b32 v9, 4, v1
v_add_u32 v9, 4, v9
v_and_b32 v9, 7, v9
v_and_b32 v10, 7, v1
v_xor_b32 v9, v9, v10
v_lshlrev_b32 v9, 4, v9
v_lshrrev_b32 v10, 3, v1
v_add_u32 v10, 8, v10
v_lshl_add_u32 v19, v10, 10, v9
v_lshrrev_b32 v9, 4, v1
v_add_u32 v9, 8, v9
v_and_b32 v9, 7, v9
v_and_b32 v10, 7, v1
v_xor_b32 v9, v9, v10
v_lshlrev_b32 v9, 4, v9
v_lshrrev_b32 v10, 3, v1
v_add_u32 v10, 16, v10
v_lshl_add_u32 v20, v10, 10, v9
v_lshrrev_b32 v9, 4, v1
v_add_u32 v9, 12, v9
v_and_b32 v9, 7, v9
v_and_b32 v10, 7, v1
v_xor_b32 v9, v9, v10
v_lshlrev_b32 v9, 4, v9
v_lshrrev_b32 v10, 3, v1
v_add_u32 v10, 24, v10
v_lshl_add_u32 v21, v10, 10, v9
s_mov_b32 m0, 0
s_mov_b32 s60, 0
buffer_load_dwordx4 v18, s[40:43], s60 offen lds
s_mov_b32 m0, 1024
s_mov_b32 s60, 0
buffer_load_dwordx4 v19, s[40:43], s60 offen lds
s_mov_b32 m0, 2048
s_mov_b32 s60, 0
buffer_load_dwordx4 v20, s[40:43], s60 offen lds
s_mov_b32 m0, 3072
s_mov_b32 s60, 0
buffer_load_dwordx4 v21, s[40:43], s60 offen lds
s_mov_b32 m0, 16384
s_mov_b32 s60, 0
buffer_load_dwordx4 v15, s[44:47], s60 offen lds
s_mov_b32 m0, 17408
s_mov_b32 s60, 0
buffer_load_dwordx4 v16, s[44:47], s60 offen lds
s_mov_b32 m0, 18432
s_mov_b32 s60, 0
buffer_load_dwordx4 v17, s[44:47], s60 offen lds
s_mov_b32 m0, 28672
s_mov_b32 s60, 128
buffer_load_dwordx4 v18, s[40:43], s60 offen lds
s_mov_b32 m0, 29696
s_mov_b32 s60, 128
buffer_load_dwordx4 v19, s[40:43], s60 offen lds
s_mov_b32 m0, 30720
s_mov_b32 s60, 128
buffer_load_dwordx4 v20, s[40:43], s60 offen lds
s_mov_b32 m0, 31744
s_mov_b32 s60, 128
buffer_load_dwordx4 v21, s[40:43], s60 offen lds
s_mov_b32 m0, 45056
s_mov_b32 s60, 196608
buffer_load_dwordx4 v15, s[44:47], s60 offen lds
s_mov_b32 m0, 46080
s_mov_b32 s60, 196608
buffer_load_dwordx4 v16, s[44:47], s60 offen lds
s_mov_b32 m0, 47104
s_mov_b32 s60, 196608
buffer_load_dwordx4 v17, s[44:47], s60 offen lds
s_mov_b32 m0, 57344
s_mov_b32 s60, 256
buffer_load_dwordx4 v18, s[40:43], s60 offen lds
s_mov_b32 m0, 58368
s_mov_b32 s60, 256
buffer_load_dwordx4 v19, s[40:43], s60 offen lds
s_mov_b32 m0, 59392
s_mov_b32 s60, 256
buffer_load_dwordx4 v20, s[40:43], s60 offen lds
s_mov_b32 m0, 60416
s_mov_b32 s60, 256
buffer_load_dwordx4 v21, s[40:43], s60 offen lds
s_mov_b32 m0, 73728
s_mov_b32 s60, 393216
buffer_load_dwordx4 v15, s[44:47], s60 offen lds
s_mov_b32 m0, 74752
s_mov_b32 s60, 393216
buffer_load_dwordx4 v16, s[44:47], s60 offen lds
s_mov_b32 m0, 75776
s_mov_b32 s60, 393216
buffer_load_dwordx4 v17, s[44:47], s60 offen lds
s_mov_b32 m0, 86016
s_mov_b32 s60, 384
buffer_load_dwordx4 v18, s[40:43], s60 offen lds
s_mov_b32 m0, 87040
s_mov_b32 s60, 384
buffer_load_dwordx4 v19, s[40:43], s60 offen lds
s_mov_b32 m0, 88064
s_mov_b32 s60, 384
buffer_load_dwordx4 v20, s[40:43], s60 offen lds
s_mov_b32 m0, 89088
s_mov_b32 s60, 384
buffer_load_dwordx4 v21, s[40:43], s60 offen lds
s_mov_b32 m0, 102400
s_mov_b32 s60, 589824
buffer_load_dwordx4 v15, s[44:47], s60 offen lds
s_mov_b32 m0, 103424
s_mov_b32 s60, 589824
buffer_load_dwordx4 v16, s[44:47], s60 offen lds
s_mov_b32 m0, 104448
s_mov_b32 s60, 589824
buffer_load_dwordx4 v17, s[44:47], s60 offen lds
s_mov_b32 m0, 114688
s_mov_b32 s60, 512
buffer_load_dwordx4 v18, s[40:43], s60 offen lds
s_mov_b32 m0, 115712
s_mov_b32 s60, 512
buffer_load_dwordx4 v19, s[40:43], s60 offen lds
s_mov_b32 m0, 116736
s_mov_b32 s60, 512
buffer_load_dwordx4 v20, s[40:43], s60 offen lds
s_mov_b32 m0, 117760
s_mov_b32 s60, 512
buffer_load_dwordx4 v21, s[40:43], s60 offen lds
s_mov_b32 m0, 131072
s_mov_b32 s60, 786432
buffer_load_dwordx4 v15, s[44:47], s60 offen lds
s_mov_b32 m0, 132096
s_mov_b32 s60, 786432
buffer_load_dwordx4 v16, s[44:47], s60 offen lds
s_mov_b32 m0, 133120
s_mov_b32 s60, 786432
buffer_load_dwordx4 v17, s[44:47], s60 offen lds
v_mul_u32_u24 v9, 192, v7
v_lshl_add_u32 v9, v8, 3, v9
v_mul_u32_u24 v10, 32, v6
v_add_u32 v22, v9, v10
v_mov_b32 v24, 0
v_mov_b32 v25, 0
v_and_b32 v9, 31, v1
v_bfe_u32 v10, v1, 1, 3
v_add_u32 v11, 0, v5
v_xor_b32 v10, v10, v11
v_lshlrev_b32 v10, 4, v10
v_lshl_add_u32 v44, v9, 7, v10
v_and_b32 v9, 31, v1
v_bfe_u32 v10, v1, 1, 3
v_add_u32 v11, 2, v5
v_xor_b32 v10, v10, v11
v_lshlrev_b32 v10, 4, v10
v_lshl_add_u32 v45, v9, 7, v10
v_and_b32 v9, 31, v1
v_bfe_u32 v10, v1, 1, 3
v_add_u32 v11, 4, v5
v_xor_b32 v10, v10, v11
v_lshlrev_b32 v10, 4, v10
v_lshl_add_u32 v46, v9, 7, v10
v_and_b32 v9, 31, v1
v_bfe_u32 v10, v1, 1, 3
v_add_u32 v11, 6, v5
v_xor_b32 v10, v10, v11
v_lshlrev_b32 v10, 4, v10
v_lshl_add_u32 v47, v9, 7, v10
v_mov_b32 v48, 0
v_mov_b32 v49, 0
v_mov_b32 v50, 0
v_mov_b32 v51, 0
v_mov_b32 v52, 0
v_mov_b32 v53, 0
v_mov_b32 v54, 0
v_mov_b32 v55, 0
s_waitcnt vmcnt(28)
s_barrier
v_add_u32 v23, 16384, v22
ds_read_b128 v[56:59], v44 offset:0
ds_read_b64_tr_b16 v[28:29], v23 offset:0
ds_read_b64_tr_b16 v[30:31], v23 offset:768
ds_read_b128 v[60:63], v45 offset:0
ds_read_b64_tr_b16 v[32:33], v23 offset:3072
ds_read_b64_tr_b16 v[34:35], v23 offset:3840
ds_read_b128 v[64:67], v46 offset:0
ds_read_b64_tr_b16 v[36:37], v23 offset:6144
ds_read_b64_tr_b16 v[38:39], v23 offset:6912
ds_read_b128 v[68:71], v47 offset:0
ds_read_b64_tr_b16 v[40:41], v23 offset:9216
ds_read_b64_tr_b16 v[42:43], v23 offset:9984
s_waitcnt lgkmcnt(11)
v_dot2_f32_bf16 v48, v56, s61, v48
s_waitcnt lgkmcnt(10)
v_dot2_f32_bf16 v24, v28, s61, v24
v_dot2_f32_bf16 v52, v56, v56, v52
v_dot2_f32_bf16 v49, v57, s61, v49
v_dot2_f32_bf16 v25, v29, s61, v25
v_dot2_f32_bf16 v53, v57, v57, v53
v_dot2_f32_bf16 v50, v58, s61, v50
s_waitcnt lgkmcnt(9)
v_dot2_f32_bf16 v24, v30, s61, v24
v_dot2_f32_bf16 v54, v58, v58, v54
v_dot2_f32_bf16 v51, v59, s61, v51
v_dot2_f32_bf16 v25, v31, s61, v25
v_dot2_f32_bf16 v55, v59, v59, v55
s_waitcnt lgkmcnt(8)
v_dot2_f32_bf16 v48, v60, s61, v48
s_waitcnt lgkmcnt(7)
v_dot2_f32_bf16 v24, v32, s61, v24
v_dot2_f32_bf16 v52, v60, v60, v52
v_dot2_f32_bf16 v49, v61, s61, v49
v_dot2_f32_bf16 v25, v33, s61, v25
v_dot2_f32_bf16 v53, v61, v61, v53
v_dot2_f32_bf16 v50, v62, s61, v50
s_waitcnt lgkmcnt(6)
v_dot2_f32_bf16 v24, v34, s61, v24
v_dot2_f32_bf16 v54, v62, v62, v54
v_dot2_f32_bf16 v51, v63, s61, v51
v_dot2_f32_bf16 v25, v35, s61, v25
v_dot2_f32_bf16 v55, v63, v63, v55
s_waitcnt lgkmcnt(5)
v_dot2_f32_bf16 v48, v64, s61, v48
s_waitcnt lgkmcnt(4)
v_dot2_f32_bf16 v24, v36, s61, v24
v_dot2_f32_bf16 v52, v64, v64, v52
v_dot2_f32_bf16 v49, v65, s61, v49
v_dot2_f32_bf16 v25, v37, s61, v25
v_dot2_f32_bf16 v53, v65, v65, v53
v_dot2_f32_bf16 v50, v66, s61, v50
s_waitcnt lgkmcnt(3)
v_dot2_f32_bf16 v24, v38, s61, v24
v_dot2_f32_bf16 v54, v66, v66, v54
v_dot2_f32_bf16 v51, v67, s61, v51
v_dot2_f32_bf16 v25, v39, s61, v25
v_dot2_f32_bf16 v55, v67, v67, v55
s_waitcnt lgkmcnt(2)
v_dot2_f32_bf16 v48, v68, s61, v48
s_waitcnt lgkmcnt(1)
v_dot2_f32_bf16 v24, v40, s61, v24
v_dot2_f32_bf16 v52, v68, v68, v52
v_dot2_f32_bf16 v49, v69, s61, v49
v_dot2_f32_bf16 v25, v41, s61, v25
v_dot2_f32_bf16 v53, v69, v69, v53
v_dot2_f32_bf16 v50, v70, s61, v50
s_waitcnt lgkmcnt(0)
v_dot2_f32_bf16 v24, v42, s61, v24
v_dot2_f32_bf16 v54, v70, v70, v54
v_dot2_f32_bf16 v51, v71, s61, v51
v_dot2_f32_bf16 v25, v43, s61, v25
v_dot2_f32_bf16 v55, v71, v71, v55
s_waitcnt vmcnt(21)
s_barrier
v_add_u32 v23, 45056, v22
ds_read_b128 v[56:59], v44 offset:28672
ds_read_b64_tr_b16 v[28:29], v23 offset:0
ds_read_b64_tr_b16 v[30:31], v23 offset:768
ds_read_b128 v[60:63], v45 offset:28672
ds_read_b64_tr_b16 v[32:33], v23 offset:3072
ds_read_b64_tr_b16 v[34:35], v23 offset:3840
ds_read_b128 v[64:67], v46 offset:28672
ds_read_b64_tr_b16 v[36:37], v23 offset:6144
ds_read_b64_tr_b16 v[38:39], v23 offset:6912
ds_read_b128 v[68:71], v47 offset:28672
ds_read_b64_tr_b16 v[40:41], v23 offset:9216
ds_read_b64_tr_b16 v[42:43], v23 offset:9984
s_waitcnt lgkmcnt(11)
v_dot2_f32_bf16 v48, v56, s61, v48
s_waitcnt lgkmcnt(10)
v_dot2_f32_bf16 v24, v28, s61, v24
v_dot2_f32_bf16 v52, v56, v56, v52
v_dot2_f32_bf16 v49, v57, s61, v49
v_dot2_f32_bf16 v25, v29, s61, v25
v_dot2_f32_bf16 v53, v57, v57, v53
v_dot2_f32_bf16 v50, v58, s61, v50
s_waitcnt lgkmcnt(9)
v_dot2_f32_bf16 v24, v30, s61, v24
v_dot2_f32_bf16 v54, v58, v58, v54
v_dot2_f32_bf16 v51, v59, s61, v51
v_dot2_f32_bf16 v25, v31, s61, v25
v_dot2_f32_bf16 v55, v59, v59, v55
s_waitcnt lgkmcnt(8)
v_dot2_f32_bf16 v48, v60, s61, v48
s_waitcnt lgkmcnt(7)
v_dot2_f32_bf16 v24, v32, s61, v24
v_dot2_f32_bf16 v52, v60, v60, v52
v_dot2_f32_bf16 v49, v61, s61, v49
v_dot2_f32_bf16 v25, v33, s61, v25
v_dot2_f32_bf16 v53, v61, v61, v53
v_dot2_f32_bf16 v50, v62, s61, v50
s_waitcnt lgkmcnt(6)
v_dot2_f32_bf16 v24, v34, s61, v24
v_dot2_f32_bf16 v54, v62, v62, v54
v_dot2_f32_bf16 v51, v63, s61, v51
v_dot2_f32_bf16 v25, v35, s61, v25
v_dot2_f32_bf16 v55, v63, v63, v55
s_waitcnt lgkmcnt(5)
v_dot2_f32_bf16 v48, v64, s61, v48
s_waitcnt lgkmcnt(4)
v_dot2_f32_bf16 v24, v36, s61, v24
v_dot2_f32_bf16 v52, v64, v64, v52
v_dot2_f32_bf16 v49, v65, s61, v49
v_dot2_f32_bf16 v25, v37, s61, v25
v_dot2_f32_bf16 v53, v65, v65, v53
v_dot2_f32_bf16 v50, v66, s61, v50
s_waitcnt lgkmcnt(3)
v_dot2_f32_bf16 v24, v38, s61, v24
v_dot2_f32_bf16 v54, v66, v66, v54
v_dot2_f32_bf16 v51, v67, s61, v51
v_dot2_f32_bf16 v25, v39, s61, v25
v_dot2_f32_bf16 v55, v67, v67, v55
s_waitcnt lgkmcnt(2)
v_dot2_f32_bf16 v48, v68, s61, v48
s_waitcnt lgkmcnt(1)
v_dot2_f32_bf16 v24, v40, s61, v24
v_dot2_f32_bf16 v52, v68, v68, v52
v_dot2_f32_bf16 v49, v69, s61, v49
v_dot2_f32_bf16 v25, v41, s61, v25
v_dot2_f32_bf16 v53, v69, v69, v53
v_dot2_f32_bf16 v50, v70, s61, v50
s_waitcnt lgkmcnt(0)
v_dot2_f32_bf16 v24, v42, s61, v24
v_dot2_f32_bf16 v54, v70, v70, v54
v_dot2_f32_bf16 v51, v71, s61, v51
v_dot2_f32_bf16 v25, v43, s61, v25
v_dot2_f32_bf16 v55, v71, v71, v55
s_waitcnt vmcnt(14)
s_barrier
s_mov_b32 m0, 0
s_mov_b32 s60, 640
buffer_load_dwordx4 v18, s[40:43], s60 offen lds
s_mov_b32 m0, 1024
s_mov_b32 s60, 640
buffer_load_dwordx4 v19, s[40:43], s60 offen lds
s_mov_b32 m0, 2048
s_mov_b32 s60, 640
buffer_load_dwordx4 v20, s[40:43], s60 offen lds
s_mov_b32 m0, 3072
s_mov_b32 s60, 640
buffer_load_dwordx4 v21, s[40:43], s60 offen lds
s_mov_b32 m0, 16384
s_mov_b32 s60, 983040
buffer_load_dwordx4 v15, s[44:47], s60 offen lds
s_mov_b32 m0, 17408
s_mov_b32 s60, 983040
buffer_load_dwordx4 v16, s[44:47], s60 offen lds
s_mov_b32 m0, 18432
s_mov_b32 s60, 983040
buffer_load_dwordx4 v17, s[44:47], s60 offen lds
v_add_u32 v23, 73728, v22
ds_read_b128 v[56:59], v44 offset:57344
ds_read_b64_tr_b16 v[28:29], v23 offset:0
ds_read_b64_tr_b16 v[30:31], v23 offset:768
ds_read_b128 v[60:63], v45 offset:57344
ds_read_b64_tr_b16 v[32:33], v23 offset:3072
ds_read_b64_tr_b16 v[34:35], v23 offset:3840
ds_read_b128 v[64:67], v46 offset:57344
ds_read_b64_tr_b16 v[36:37], v23 offset:6144
ds_read_b64_tr_b16 v[38:39], v23 offset:6912
ds_read_b128 v[68:71], v47 offset:57344
ds_read_b64_tr_b16 v[40:41], v23 offset:9216
ds_read_b64_tr_b16 v[42:43], v23 offset:9984
s_waitcnt lgkmcnt(11)
v_dot2_f32_bf16 v48, v56, s61, v48
s_waitcnt lgkmcnt(10)
v_dot2_f32_bf16 v24, v28, s61, v24
v_dot2_f32_bf16 v52, v56, v56, v52
v_dot2_f32_bf16 v49, v57, s61, v49
v_dot2_f32_bf16 v25, v29, s61, v25
v_dot2_f32_bf16 v53, v57, v57, v53
v_dot2_f32_bf16 v50, v58, s61, v50
s_waitcnt lgkmcnt(9)
v_dot2_f32_bf16 v24, v30, s61, v24
v_dot2_f32_bf16 v54, v58, v58, v54
v_dot2_f32_bf16 v51, v59, s61, v51
v_dot2_f32_bf16 v25, v31, s61, v25
v_dot2_f32_bf16 v55, v59, v59, v55
s_waitcnt lgkmcnt(8)
v_dot2_f32_bf16 v48, v60, s61, v48
s_waitcnt lgkmcnt(7)
v_dot2_f32_bf16 v24, v32, s61, v24
v_dot2_f32_bf16 v52, v60, v60, v52
v_dot2_f32_bf16 v49, v61, s61, v49
v_dot2_f32_bf16 v25, v33, s61, v25
v_dot2_f32_bf16 v53, v61, v61, v53
v_dot2_f32_bf16 v50, v62, s61, v50
s_waitcnt lgkmcnt(6)
v_dot2_f32_bf16 v24, v34, s61, v24
v_dot2_f32_bf16 v54, v62, v62, v54
v_dot2_f32_bf16 v51, v63, s61, v51
v_dot2_f32_bf16 v25, v35, s61, v25
v_dot2_f32_bf16 v55, v63, v63, v55
s_waitcnt lgkmcnt(5)
v_dot2_f32_bf16 v48, v64, s61, v48
s_waitcnt lgkmcnt(4)
v_dot2_f32_bf16 v24, v36, s61, v24
v_dot2_f32_bf16 v52, v64, v64, v52
v_dot2_f32_bf16 v49, v65, s61, v49
v_dot2_f32_bf16 v25, v37, s61, v25
v_dot2_f32_bf16 v53, v65, v65, v53
v_dot2_f32_bf16 v50, v66, s61, v50
s_waitcnt lgkmcnt(3)
v_dot2_f32_bf16 v24, v38, s61, v24
v_dot2_f32_bf16 v54, v66, v66, v54
v_dot2_f32_bf16 v51, v67, s61, v51
v_dot2_f32_bf16 v25, v39, s61, v25
v_dot2_f32_bf16 v55, v67, v67, v55
s_waitcnt lgkmcnt(2)
v_dot2_f32_bf16 v48, v68, s61, v48
s_waitcnt lgkmcnt(1)
v_dot2_f32_bf16 v24, v40, s61, v24
v_dot2_f32_bf16 v52, v68, v68, v52
v_dot2_f32_bf16 v49, v69, s61, v49
v_dot2_f32_bf16 v25, v41, s61, v25
v_dot2_f32_bf16 v53, v69, v69, v53
v_dot2_f32_bf16 v50, v70, s61, v50
s_waitcnt lgkmcnt(0)
v_dot2_f32_bf16 v24, v42, s61, v24
v_dot2_f32_bf16 v54, v70, v70, v54
v_dot2_f32_bf16 v51, v71, s61, v51
v_dot2_f32_bf16 v25, v43, s61, v25
v_dot2_f32_bf16 v55, v71, v71, v55
s_waitcnt vmcnt(14)
s_barrier
s_mov_b32 m0, 28672
s_mov_b32 s60, 768
buffer_load_dwordx4 v18, s[40:43], s60 offen lds
s_mov_b32 m0, 29696
s_mov_b32 s60, 768
buffer_load_dwordx4 v19, s[40:43], s60 offen lds
s_mov_b32 m0, 30720
s_mov_b32 s60, 768
buffer_load_dwordx4 v20, s[40:43], s60 offen lds
s_mov_b32 m0, 31744
s_mov_b32 s60, 768
buffer_load_dwordx4 v21, s[40:43], s60 offen lds
s_mov_b32 m0, 45056
s_mov_b32 s60, 1179648
buffer_load_dwordx4 v15, s[44:47], s60 offen lds
s_mov_b32 m0, 46080
s_mov_b32 s60, 1179648
buffer_load_dwordx4 v16, s[44:47], s60 offen lds
s_mov_b32 m0, 47104
s_mov_b32 s60, 1179648
buffer_load_dwordx4 v17, s[44:47], s60 offen lds
v_add_u32 v23, 102400, v22
v_add_u32 v9, 86016, v44
ds_read_b128 v[56:59], v9
ds_read_b64_tr_b16 v[28:29], v23 offset:0
ds_read_b64_tr_b16 v[30:31], v23 offset:768
v_add_u32 v10, 86016, v45
ds_read_b128 v[60:63], v10
ds_read_b64_tr_b16 v[32:33], v23 offset:3072
ds_read_b64_tr_b16 v[34:35], v23 offset:3840
v_add_u32 v9, 86016, v46
ds_read_b128 v[64:67], v9
ds_read_b64_tr_b16 v[36:37], v23 offset:6144
ds_read_b64_tr_b16 v[38:39], v23 offset:6912
v_add_u32 v10, 86016, v47
ds_read_b128 v[68:71], v10
ds_read_b64_tr_b16 v[40:41], v23 offset:9216
ds_read_b64_tr_b16 v[42:43], v23 offset:9984
s_waitcnt lgkmcnt(11)
v_dot2_f32_bf16 v48, v56, s61, v48
s_waitcnt lgkmcnt(10)
v_dot2_f32_bf16 v24, v28, s61, v24
v_dot2_f32_bf16 v52, v56, v56, v52
v_dot2_f32_bf16 v49, v57, s61, v49
v_dot2_f32_bf16 v25, v29, s61, v25
v_dot2_f32_bf16 v53, v57, v57, v53
v_dot2_f32_bf16 v50, v58, s61, v50
s_waitcnt lgkmcnt(9)
v_dot2_f32_bf16 v24, v30, s61, v24
v_dot2_f32_bf16 v54, v58, v58, v54
v_dot2_f32_bf16 v51, v59, s61, v51
v_dot2_f32_bf16 v25, v31, s61, v25
v_dot2_f32_bf16 v55, v59, v59, v55
s_waitcnt lgkmcnt(8)
v_dot2_f32_bf16 v48, v60, s61, v48
s_waitcnt lgkmcnt(7)
v_dot2_f32_bf16 v24, v32, s61, v24
v_dot2_f32_bf16 v52, v60, v60, v52
v_dot2_f32_bf16 v49, v61, s61, v49
v_dot2_f32_bf16 v25, v33, s61, v25
v_dot2_f32_bf16 v53, v61, v61, v53
v_dot2_f32_bf16 v50, v62, s61, v50
s_waitcnt lgkmcnt(6)
v_dot2_f32_bf16 v24, v34, s61, v24
v_dot2_f32_bf16 v54, v62, v62, v54
v_dot2_f32_bf16 v51, v63, s61, v51
v_dot2_f32_bf16 v25, v35, s61, v25
v_dot2_f32_bf16 v55, v63, v63, v55
s_waitcnt lgkmcnt(5)
v_dot2_f32_bf16 v48, v64, s61, v48
s_waitcnt lgkmcnt(4)
v_dot2_f32_bf16 v24, v36, s61, v24
v_dot2_f32_bf16 v52, v64, v64, v52
v_dot2_f32_bf16 v49, v65, s61, v49
v_dot2_f32_bf16 v25, v37, s61, v25
v_dot2_f32_bf16 v53, v65, v65, v53
v_dot2_f32_bf16 v50, v66, s61, v50
s_waitcnt lgkmcnt(3)
v_dot2_f32_bf16 v24, v38, s61, v24
v_dot2_f32_bf16 v54, v66, v66, v54
v_dot2_f32_bf16 v51, v67, s61, v51
v_dot2_f32_bf16 v25, v39, s61, v25
v_dot2_f32_bf16 v55, v67, v67, v55
s_waitcnt lgkmcnt(2)
v_dot2_f32_bf16 v48, v68, s61, v48
s_waitcnt lgkmcnt(1)
v_dot2_f32_bf16 v24, v40, s61, v24
v_dot2_f32_bf16 v52, v68, v68, v52
v_dot2_f32_bf16 v49, v69, s61, v49
v_dot2_f32_bf16 v25, v41, s61, v25
v_dot2_f32_bf16 v53, v69, v69, v53
v_dot2_f32_bf16 v50, v70, s61, v50
s_waitcnt lgkmcnt(0)
v_dot2_f32_bf16 v24, v42, s61, v24
v_dot2_f32_bf16 v54, v70, v70, v54
v_dot2_f32_bf16 v51, v71, s61, v51
v_dot2_f32_bf16 v25, v43, s61, v25
v_dot2_f32_bf16 v55, v71, v71, v55
s_waitcnt vmcnt(14)
s_barrier
s_mov_b32 m0, 57344
s_mov_b32 s60, 896
buffer_load_dwordx4 v18, s[40:43], s60 offen lds
s_mov_b32 m0, 58368
s_mov_b32 s60, 896
buffer_load_dwordx4 v19, s[40:43], s60 offen lds
s_mov_b32 m0, 59392
s_mov_b32 s60, 896
buffer_load_dwordx4 v20, s[40:43], s60 offen lds
s_mov_b32 m0, 60416
s_mov_b32 s60, 896
buffer_load_dwordx4 v21, s[40:43], s60 offen lds
s_mov_b32 m0, 73728
s_mov_b32 s60, 1376256
buffer_load_dwordx4 v15, s[44:47], s60 offen lds
s_mov_b32 m0, 74752
s_mov_b32 s60, 1376256
buffer_load_dwordx4 v16, s[44:47], s60 offen lds
s_mov_b32 m0, 75776
s_mov_b32 s60, 1376256
buffer_load_dwordx4 v17, s[44:47], s60 offen lds
v_add_u32 v23, 131072, v22
v_add_u32 v9, 114688, v44
ds_read_b128 v[56:59], v9
ds_read_b64_tr_b16 v[28:29], v23 offset:0
ds_read_b64_tr_b16 v[30:31], v23 offset:768
v_add_u32 v10, 114688, v45
ds_read_b128 v[60:63], v10
ds_read_b64_tr_b16 v[32:33], v23 offset:3072
ds_read_b64_tr_b16 v[34:35], v23 offset:3840
v_add_u32 v9, 114688, v46
ds_read_b128 v[64:67], v9
ds_read_b64_tr_b16 v[36:37], v23 offset:6144
ds_read_b64_tr_b16 v[38:39], v23 offset:6912
v_add_u32 v10, 114688, v47
ds_read_b128 v[68:71], v10
ds_read_b64_tr_b16 v[40:41], v23 offset:9216
ds_read_b64_tr_b16 v[42:43], v23 offset:9984
s_waitcnt lgkmcnt(11)
v_dot2_f32_bf16 v48, v56, s61, v48
s_waitcnt lgkmcnt(10)
v_dot2_f32_bf16 v24, v28, s61, v24
v_dot2_f32_bf16 v52, v56, v56, v52
v_dot2_f32_bf16 v49, v57, s61, v49
v_dot2_f32_bf16 v25, v29, s61, v25
v_dot2_f32_bf16 v53, v57, v57, v53
v_dot2_f32_bf16 v50, v58, s61, v50
s_waitcnt lgkmcnt(9)
v_dot2_f32_bf16 v24, v30, s61, v24
v_dot2_f32_bf16 v54, v58, v58, v54
v_dot2_f32_bf16 v51, v59, s61, v51
v_dot2_f32_bf16 v25, v31, s61, v25
v_dot2_f32_bf16 v55, v59, v59, v55
s_waitcnt lgkmcnt(8)
v_dot2_f32_bf16 v48, v60, s61, v48
s_waitcnt lgkmcnt(7)
v_dot2_f32_bf16 v24, v32, s61, v24
v_dot2_f32_bf16 v52, v60, v60, v52
v_dot2_f32_bf16 v49, v61, s61, v49
v_dot2_f32_bf16 v25, v33, s61, v25
v_dot2_f32_bf16 v53, v61, v61, v53
v_dot2_f32_bf16 v50, v62, s61, v50
s_waitcnt lgkmcnt(6)
v_dot2_f32_bf16 v24, v34, s61, v24
v_dot2_f32_bf16 v54, v62, v62, v54
v_dot2_f32_bf16 v51, v63, s61, v51
v_dot2_f32_bf16 v25, v35, s61, v25
v_dot2_f32_bf16 v55, v63, v63, v55
s_waitcnt lgkmcnt(5)
v_dot2_f32_bf16 v48, v64, s61, v48
s_waitcnt lgkmcnt(4)
v_dot2_f32_bf16 v24, v36, s61, v24
v_dot2_f32_bf16 v52, v64, v64, v52
v_dot2_f32_bf16 v49, v65, s61, v49
v_dot2_f32_bf16 v25, v37, s61, v25
v_dot2_f32_bf16 v53, v65, v65, v53
v_dot2_f32_bf16 v50, v66, s61, v50
s_waitcnt lgkmcnt(3)
v_dot2_f32_bf16 v24, v38, s61, v24
v_dot2_f32_bf16 v54, v66, v66, v54
v_dot2_f32_bf16 v51, v67, s61, v51
v_dot2_f32_bf16 v25, v39, s61, v25
v_dot2_f32_bf16 v55, v67, v67, v55
s_waitcnt lgkmcnt(2)
v_dot2_f32_bf16 v48, v68, s61, v48
s_waitcnt lgkmcnt(1)
v_dot2_f32_bf16 v24, v40, s61, v24
v_dot2_f32_bf16 v52, v68, v68, v52
v_dot2_f32_bf16 v49, v69, s61, v49
v_dot2_f32_bf16 v25, v41, s61, v25
v_dot2_f32_bf16 v53, v69, v69, v53
v_dot2_f32_bf16 v50, v70, s61, v50
s_waitcnt lgkmcnt(0)
v_dot2_f32_bf16 v24, v42, s61, v24
v_dot2_f32_bf16 v54, v70, v70, v54
v_dot2_f32_bf16 v51, v71, s61, v51
v_dot2_f32_bf16 v25, v43, s61, v25
v_dot2_f32_bf16 v55, v71, v71, v55
s_waitcnt vmcnt(14)
s_barrier
v_add_u32 v23, 16384, v22
ds_read_b128 v[56:59], v44 offset:0
ds_read_b64_tr_b16 v[28:29], v23 offset:0
ds_read_b64_tr_b16 v[30:31], v23 offset:768
ds_read_b128 v[60:63], v45 offset:0
ds_read_b64_tr_b16 v[32:33], v23 offset:3072
ds_read_b64_tr_b16 v[34:35], v23 offset:3840
ds_read_b128 v[64:67], v46 offset:0
ds_read_b64_tr_b16 v[36:37], v23 offset:6144
ds_read_b64_tr_b16 v[38:39], v23 offset:6912
ds_read_b128 v[68:71], v47 offset:0
ds_read_b64_tr_b16 v[40:41], v23 offset:9216
ds_read_b64_tr_b16 v[42:43], v23 offset:9984
s_waitcnt lgkmcnt(11)
v_dot2_f32_bf16 v48, v56, s61, v48
s_waitcnt lgkmcnt(10)
v_dot2_f32_bf16 v24, v28, s61, v24
v_dot2_f32_bf16 v52, v56, v56, v52
v_dot2_f32_bf16 v49, v57, s61, v49
v_dot2_f32_bf16 v25, v29, s61, v25
v_dot2_f32_bf16 v53, v57, v57, v53
v_dot2_f32_bf16 v50, v58, s61, v50
s_waitcnt lgkmcnt(9)
v_dot2_f32_bf16 v24, v30, s61, v24
v_dot2_f32_bf16 v54, v58, v58, v54
v_dot2_f32_bf16 v51, v59, s61, v51
v_dot2_f32_bf16 v25, v31, s61, v25
v_dot2_f32_bf16 v55, v59, v59, v55
s_waitcnt lgkmcnt(8)
v_dot2_f32_bf16 v48, v60, s61, v48
s_waitcnt lgkmcnt(7)
v_dot2_f32_bf16 v24, v32, s61, v24
v_dot2_f32_bf16 v52, v60, v60, v52
v_dot2_f32_bf16 v49, v61, s61, v49
v_dot2_f32_bf16 v25, v33, s61, v25
v_dot2_f32_bf16 v53, v61, v61, v53
v_dot2_f32_bf16 v50, v62, s61, v50
s_waitcnt lgkmcnt(6)
v_dot2_f32_bf16 v24, v34, s61, v24
v_dot2_f32_bf16 v54, v62, v62, v54
v_dot2_f32_bf16 v51, v63, s61, v51
v_dot2_f32_bf16 v25, v35, s61, v25
v_dot2_f32_bf16 v55, v63, v63, v55
s_waitcnt lgkmcnt(5)
v_dot2_f32_bf16 v48, v64, s61, v48
s_waitcnt lgkmcnt(4)
v_dot2_f32_bf16 v24, v36, s61, v24
v_dot2_f32_bf16 v52, v64, v64, v52
v_dot2_f32_bf16 v49, v65, s61, v49
v_dot2_f32_bf16 v25, v37, s61, v25
v_dot2_f32_bf16 v53, v65, v65, v53
v_dot2_f32_bf16 v50, v66, s61, v50
s_waitcnt lgkmcnt(3)
v_dot2_f32_bf16 v24, v38, s61, v24
v_dot2_f32_bf16 v54, v66, v66, v54
v_dot2_f32_bf16 v51, v67, s61, v51
v_dot2_f32_bf16 v25, v39, s61, v25
v_dot2_f32_bf16 v55, v67, v67, v55
s_waitcnt lgkmcnt(2)
v_dot2_f32_bf16 v48, v68, s61, v48
s_waitcnt lgkmcnt(1)
v_dot2_f32_bf16 v24, v40, s61, v24
v_dot2_f32_bf16 v52, v68, v68, v52
v_dot2_f32_bf16 v49, v69, s61, v49
v_dot2_f32_bf16 v25, v41, s61, v25
v_dot2_f32_bf16 v53, v69, v69, v53
v_dot2_f32_bf16 v50, v70, s61, v50
s_waitcnt lgkmcnt(0)
v_dot2_f32_bf16 v24, v42, s61, v24
v_dot2_f32_bf16 v54, v70, v70, v54
v_dot2_f32_bf16 v51, v71, s61, v51
v_dot2_f32_bf16 v25, v43, s61, v25
v_dot2_f32_bf16 v55, v71, v71, v55
s_waitcnt vmcnt(7)
s_barrier
v_add_u32 v23, 45056, v22
ds_read_b128 v[56:59], v44 offset:28672
ds_read_b64_tr_b16 v[28:29], v23 offset:0
ds_read_b64_tr_b16 v[30:31], v23 offset:768
ds_read_b128 v[60:63], v45 offset:28672
ds_read_b64_tr_b16 v[32:33], v23 offset:3072
ds_read_b64_tr_b16 v[34:35], v23 offset:3840
ds_read_b128 v[64:67], v46 offset:28672
ds_read_b64_tr_b16 v[36:37], v23 offset:6144
ds_read_b64_tr_b16 v[38:39], v23 offset:6912
ds_read_b128 v[68:71], v47 offset:28672
ds_read_b64_tr_b16 v[40:41], v23 offset:9216
ds_read_b64_tr_b16 v[42:43], v23 offset:9984
s_waitcnt lgkmcnt(11)
v_dot2_f32_bf16 v48, v56, s61, v48
s_waitcnt lgkmcnt(10)
v_dot2_f32_bf16 v24, v28, s61, v24
v_dot2_f32_bf16 v52, v56, v56, v52
v_dot2_f32_bf16 v49, v57, s61, v49
v_dot2_f32_bf16 v25, v29, s61, v25
v_dot2_f32_bf16 v53, v57, v57, v53
v_dot2_f32_bf16 v50, v58, s61, v50
s_waitcnt lgkmcnt(9)
v_dot2_f32_bf16 v24, v30, s61, v24
v_dot2_f32_bf16 v54, v58, v58, v54
v_dot2_f32_bf16 v51, v59, s61, v51
v_dot2_f32_bf16 v25, v31, s61, v25
v_dot2_f32_bf16 v55, v59, v59, v55
s_waitcnt lgkmcnt(8)
v_dot2_f32_bf16 v48, v60, s61, v48
s_waitcnt lgkmcnt(7)
v_dot2_f32_bf16 v24, v32, s61, v24
v_dot2_f32_bf16 v52, v60, v60, v52
v_dot2_f32_bf16 v49, v61, s61, v49
v_dot2_f32_bf16 v25, v33, s61, v25
v_dot2_f32_bf16 v53, v61, v61, v53
v_dot2_f32_bf16 v50, v62, s61, v50
s_waitcnt lgkmcnt(6)
v_dot2_f32_bf16 v24, v34, s61, v24
v_dot2_f32_bf16 v54, v62, v62, v54
v_dot2_f32_bf16 v51, v63, s61, v51
v_dot2_f32_bf16 v25, v35, s61, v25
v_dot2_f32_bf16 v55, v63, v63, v55
s_waitcnt lgkmcnt(5)
v_dot2_f32_bf16 v48, v64, s61, v48
s_waitcnt lgkmcnt(4)
v_dot2_f32_bf16 v24, v36, s61, v24
v_dot2_f32_bf16 v52, v64, v64, v52
v_dot2_f32_bf16 v49, v65, s61, v49
v_dot2_f32_bf16 v25, v37, s61, v25
v_dot2_f32_bf16 v53, v65, v65, v53
v_dot2_f32_bf16 v50, v66, s61, v50
s_waitcnt lgkmcnt(3)
v_dot2_f32_bf16 v24, v38, s61, v24
v_dot2_f32_bf16 v54, v66, v66, v54
v_dot2_f32_bf16 v51, v67, s61, v51
v_dot2_f32_bf16 v25, v39, s61, v25
v_dot2_f32_bf16 v55, v67, v67, v55
s_waitcnt lgkmcnt(2)
v_dot2_f32_bf16 v48, v68, s61, v48
s_waitcnt lgkmcnt(1)
v_dot2_f32_bf16 v24, v40, s61, v24
v_dot2_f32_bf16 v52, v68, v68, v52
v_dot2_f32_bf16 v49, v69, s61, v49
v_dot2_f32_bf16 v25, v41, s61, v25
v_dot2_f32_bf16 v53, v69, v69, v53
v_dot2_f32_bf16 v50, v70, s61, v50
s_waitcnt lgkmcnt(0)
v_dot2_f32_bf16 v24, v42, s61, v24
v_dot2_f32_bf16 v54, v70, v70, v54
v_dot2_f32_bf16 v51, v71, s61, v51
v_dot2_f32_bf16 v25, v43, s61, v25
v_dot2_f32_bf16 v55, v71, v71, v55
s_waitcnt vmcnt(0)
s_barrier
v_add_u32 v23, 73728, v22
ds_read_b128 v[56:59], v44 offset:57344
ds_read_b64_tr_b16 v[28:29], v23 offset:0
ds_read_b64_tr_b16 v[30:31], v23 offset:768
ds_read_b128 v[60:63], v45 offset:57344
ds_read_b64_tr_b16 v[32:33], v23 offset:3072
ds_read_b64_tr_b16 v[34:35], v23 offset:3840
ds_read_b128 v[64:67], v46 offset:57344
ds_read_b64_tr_b16 v[36:37], v23 offset:6144
ds_read_b64_tr_b16 v[38:39], v23 offset:6912
ds_read_b128 v[68:71], v47 offset:57344
ds_read_b64_tr_b16 v[40:41], v23 offset:9216
ds_read_b64_tr_b16 v[42:43], v23 offset:9984
s_waitcnt lgkmcnt(11)
v_dot2_f32_bf16 v48, v56, s61, v48
s_waitcnt lgkmcnt(10)
v_dot2_f32_bf16 v24, v28, s61, v24
v_dot2_f32_bf16 v52, v56, v56, v52
v_dot2_f32_bf16 v49, v57, s61, v49
v_dot2_f32_bf16 v25, v29, s61, v25
v_dot2_f32_bf16 v53, v57, v57, v53
v_dot2_f32_bf16 v50, v58, s61, v50
s_waitcnt lgkmcnt(9)
v_dot2_f32_bf16 v24, v30, s61, v24
v_dot2_f32_bf16 v54, v58, v58, v54
v_dot2_f32_bf16 v51, v59, s61, v51
v_dot2_f32_bf16 v25, v31, s61, v25
v_dot2_f32_bf16 v55, v59, v59, v55
s_waitcnt lgkmcnt(8)
v_dot2_f32_bf16 v48, v60, s61, v48
s_waitcnt lgkmcnt(7)
v_dot2_f32_bf16 v24, v32, s61, v24
v_dot2_f32_bf16 v52, v60, v60, v52
v_dot2_f32_bf16 v49, v61, s61, v49
v_dot2_f32_bf16 v25, v33, s61, v25
v_dot2_f32_bf16 v53, v61, v61, v53
v_dot2_f32_bf16 v50, v62, s61, v50
s_waitcnt lgkmcnt(6)
v_dot2_f32_bf16 v24, v34, s61, v24
v_dot2_f32_bf16 v54, v62, v62, v54
v_dot2_f32_bf16 v51, v63, s61, v51
v_dot2_f32_bf16 v25, v35, s61, v25
v_dot2_f32_bf16 v55, v63, v63, v55
s_waitcnt lgkmcnt(5)
v_dot2_f32_bf16 v48, v64, s61, v48
s_waitcnt lgkmcnt(4)
v_dot2_f32_bf16 v24, v36, s61, v24
v_dot2_f32_bf16 v52, v64, v64, v52
v_dot2_f32_bf16 v49, v65, s61, v49
v_dot2_f32_bf16 v25, v37, s61, v25
v_dot2_f32_bf16 v53, v65, v65, v53
v_dot2_f32_bf16 v50, v66, s61, v50
s_waitcnt lgkmcnt(3)
v_dot2_f32_bf16 v24, v38, s61, v24
v_dot2_f32_bf16 v54, v66, v66, v54
v_dot2_f32_bf16 v51, v67, s61, v51
v_dot2_f32_bf16 v25, v39, s61, v25
v_dot2_f32_bf16 v55, v67, v67, v55
s_waitcnt lgkmcnt(2)
v_dot2_f32_bf16 v48, v68, s61, v48
s_waitcnt lgkmcnt(1)
v_dot2_f32_bf16 v24, v40, s61, v24
v_dot2_f32_bf16 v52, v68, v68, v52
v_dot2_f32_bf16 v49, v69, s61, v49
v_dot2_f32_bf16 v25, v41, s61, v25
v_dot2_f32_bf16 v53, v69, v69, v53
v_dot2_f32_bf16 v50, v70, s61, v50
s_waitcnt lgkmcnt(0)
v_dot2_f32_bf16 v24, v42, s61, v24
v_dot2_f32_bf16 v54, v70, v70, v54
v_dot2_f32_bf16 v51, v71, s61, v51
v_dot2_f32_bf16 v25, v43, s61, v25
v_dot2_f32_bf16 v55, v71, v71, v55
v_and_b32 v9, 31, v1
v_lshlrev_b32 v10, 2, v9
v_add_u32 v10, 0, v10
v_lshlrev_b32 v11, 3, v9
v_add_u32 v11, 2048, v11
v_add_f32 v24, v24, v25
v_mov_b32 v74, v24
v_mov_b32 v75, v24
s_nop 1
v_permlane32_swap_b32 v74, v75
v_add_f32 v24, v74, v75
v_add_f32 v48, v48, v49
v_add_f32 v50, v50, v51
v_add_f32 v52, v52, v53
v_add_f32 v54, v54, v55
v_add_f32 v72, v48, v50
v_add_f32 v73, v52, v54
v_mov_b32 v74, v72
v_mov_b32 v75, v72
s_nop 1
v_permlane32_swap_b32 v74, v75
v_add_f32 v72, v74, v75
v_mov_b32 v76, v73
v_mov_b32 v77, v73
s_nop 1
v_permlane32_swap_b32 v76, v77
v_add_f32 v73, v76, v77
v_mul_f32 v72, 0x3b000000, v72
v_mul_f32 v73, 0x3b000000, v73
v_fma_f32 v73, -v72, v72, v73
v_max_f32 v73, 0, v73
v_cvt_pk_bf16_f32 v72, v72, v72
v_cvt_pk_bf16_f32 v73, v73, v73
v_lshlrev_b32 v72, 16, v72
v_lshlrev_b32 v73, 16, v73
v_add_f32 v73, 0x3727c5ac, v73
v_cvt_pk_bf16_f32 v73, v73, v73
v_lshlrev_b32 v73, 16, v73
v_sqrt_f32 v73, v73
s_nop 0
v_cvt_pk_bf16_f32 v73, v73, v73
v_lshlrev_b32 v73, 16, v73
v_rcp_f32 v73, v73
v_sub_f32 v72, 0, v72
s_mov_b64 exec, 0xffffffff
ds_write_b32 v10, v24 offset:0
ds_write_b64 v11, v[72:73]
s_mov_b64 exec, -1
s_waitcnt lgkmcnt(0)
s_barrier
s_branch k1_kernel_end
k1_kernel_w5:
v_add_u32 v9, 192, v1
s_mov_b32 s7, 5462
v_mul_lo_u32 v10, v9, s7
v_lshrrev_b32 v10, 16, v10
v_mul_u32_u24 v11, 12, v10
v_sub_u32 v11, v9, v11
v_lshlrev_b32 v11, 4, v11
s_mov_b32 s7, 3072
v_mul_lo_u32 v10, v10, s7
v_add_u32 v15, v10, v11
v_add_u32 v9, 256, v1
s_mov_b32 s7, 5462
v_mul_lo_u32 v10, v9, s7
v_lshrrev_b32 v10, 16, v10
v_mul_u32_u24 v11, 12, v10
v_sub_u32 v11, v9, v11
v_lshlrev_b32 v11, 4, v11
s_mov_b32 s7, 3072
v_mul_lo_u32 v10, v10, s7
v_add_u32 v16, v10, v11
v_add_u32 v9, 320, v1
s_mov_b32 s7, 5462
v_mul_lo_u32 v10, v9, s7
v_lshrrev_b32 v10, 16, v10
v_mul_u32_u24 v11, 12, v10
v_sub_u32 v11, v9, v11
v_lshlrev_b32 v11, 4, v11
s_mov_b32 s7, 3072
v_mul_lo_u32 v10, v10, s7
v_add_u32 v17, v10, v11
v_lshrrev_b32 v9, 4, v1
v_add_u32 v9, 0, v9
v_and_b32 v9, 7, v9
v_and_b32 v10, 7, v1
v_xor_b32 v9, v9, v10
v_lshlrev_b32 v9, 4, v9
v_lshrrev_b32 v10, 3, v1
v_add_u32 v10, 32, v10
v_lshl_add_u32 v18, v10, 10, v9
v_lshrrev_b32 v9, 4, v1
v_add_u32 v9, 4, v9
v_and_b32 v9, 7, v9
v_and_b32 v10, 7, v1
v_xor_b32 v9, v9, v10
v_lshlrev_b32 v9, 4, v9
v_lshrrev_b32 v10, 3, v1
v_add_u32 v10, 40, v10
v_lshl_add_u32 v19, v10, 10, v9
v_lshrrev_b32 v9, 4, v1
v_add_u32 v9, 8, v9
v_and_b32 v9, 7, v9
v_and_b32 v10, 7, v1
v_xor_b32 v9, v9, v10
v_lshlrev_b32 v9, 4, v9
v_lshrrev_b32 v10, 3, v1
v_add_u32 v10, 48, v10
v_lshl_add_u32 v20, v10, 10, v9
v_lshrrev_b32 v9, 4, v1
v_add_u32 v9, 12, v9
v_and_b32 v9, 7, v9
v_and_b32 v10, 7, v1
v_xor_b32 v9, v9, v10
v_lshlrev_b32 v9, 4, v9
v_lshrrev_b32 v10, 3, v1
v_add_u32 v10, 56, v10
v_lshl_add_u32 v21, v10, 10, v9
s_mov_b32 m0, 4096
s_mov_b32 s60, 0
buffer_load_dwordx4 v18, s[40:43], s60 offen lds
s_mov_b32 m0, 5120
s_mov_b32 s60, 0
buffer_load_dwordx4 v19, s[40:43], s60 offen lds
s_mov_b32 m0, 6144
s_mov_b32 s60, 0
buffer_load_dwordx4 v20, s[40:43], s60 offen lds
s_mov_b32 m0, 7168
s_mov_b32 s60, 0
buffer_load_dwordx4 v21, s[40:43], s60 offen lds
s_mov_b32 m0, 19456
s_mov_b32 s60, 0
buffer_load_dwordx4 v15, s[44:47], s60 offen lds
s_mov_b32 m0, 20480
s_mov_b32 s60, 0
buffer_load_dwordx4 v16, s[44:47], s60 offen lds
s_mov_b32 m0, 21504
s_mov_b32 s60, 0
buffer_load_dwordx4 v17, s[44:47], s60 offen lds
s_mov_b32 m0, 32768
s_mov_b32 s60, 128
buffer_load_dwordx4 v18, s[40:43], s60 offen lds
s_mov_b32 m0, 33792
s_mov_b32 s60, 128
buffer_load_dwordx4 v19, s[40:43], s60 offen lds
s_mov_b32 m0, 34816
s_mov_b32 s60, 128
buffer_load_dwordx4 v20, s[40:43], s60 offen lds
s_mov_b32 m0, 35840
s_mov_b32 s60, 128
buffer_load_dwordx4 v21, s[40:43], s60 offen lds
s_mov_b32 m0, 48128
s_mov_b32 s60, 196608
buffer_load_dwordx4 v15, s[44:47], s60 offen lds
s_mov_b32 m0, 49152
s_mov_b32 s60, 196608
buffer_load_dwordx4 v16, s[44:47], s60 offen lds
s_mov_b32 m0, 50176
s_mov_b32 s60, 196608
buffer_load_dwordx4 v17, s[44:47], s60 offen lds
s_mov_b32 m0, 61440
s_mov_b32 s60, 256
buffer_load_dwordx4 v18, s[40:43], s60 offen lds
s_mov_b32 m0, 62464
s_mov_b32 s60, 256
buffer_load_dwordx4 v19, s[40:43], s60 offen lds
s_mov_b32 m0, 63488
s_mov_b32 s60, 256
buffer_load_dwordx4 v20, s[40:43], s60 offen lds
s_mov_b32 m0, 64512
s_mov_b32 s60, 256
buffer_load_dwordx4 v21, s[40:43], s60 offen lds
s_mov_b32 m0, 76800
s_mov_b32 s60, 393216
buffer_load_dwordx4 v15, s[44:47], s60 offen lds
s_mov_b32 m0, 77824
s_mov_b32 s60, 393216
buffer_load_dwordx4 v16, s[44:47], s60 offen lds
s_mov_b32 m0, 78848
s_mov_b32 s60, 393216
buffer_load_dwordx4 v17, s[44:47], s60 offen lds
s_mov_b32 m0, 90112
s_mov_b32 s60, 384
buffer_load_dwordx4 v18, s[40:43], s60 offen lds
s_mov_b32 m0, 91136
s_mov_b32 s60, 384
buffer_load_dwordx4 v19, s[40:43], s60 offen lds
s_mov_b32 m0, 92160
s_mov_b32 s60, 384
buffer_load_dwordx4 v20, s[40:43], s60 offen lds
s_mov_b32 m0, 93184
s_mov_b32 s60, 384
buffer_load_dwordx4 v21, s[40:43], s60 offen lds
s_mov_b32 m0, 105472
s_mov_b32 s60, 589824
buffer_load_dwordx4 v15, s[44:47], s60 offen lds
s_mov_b32 m0, 106496
s_mov_b32 s60, 589824
buffer_load_dwordx4 v16, s[44:47], s60 offen lds
s_mov_b32 m0, 107520
s_mov_b32 s60, 589824
buffer_load_dwordx4 v17, s[44:47], s60 offen lds
s_mov_b32 m0, 118784
s_mov_b32 s60, 512
buffer_load_dwordx4 v18, s[40:43], s60 offen lds
s_mov_b32 m0, 119808
s_mov_b32 s60, 512
buffer_load_dwordx4 v19, s[40:43], s60 offen lds
s_mov_b32 m0, 120832
s_mov_b32 s60, 512
buffer_load_dwordx4 v20, s[40:43], s60 offen lds
s_mov_b32 m0, 121856
s_mov_b32 s60, 512
buffer_load_dwordx4 v21, s[40:43], s60 offen lds
s_mov_b32 m0, 134144
s_mov_b32 s60, 786432
buffer_load_dwordx4 v15, s[44:47], s60 offen lds
s_mov_b32 m0, 135168
s_mov_b32 s60, 786432
buffer_load_dwordx4 v16, s[44:47], s60 offen lds
s_mov_b32 m0, 136192
s_mov_b32 s60, 786432
buffer_load_dwordx4 v17, s[44:47], s60 offen lds
v_mul_u32_u24 v9, 192, v7
v_lshl_add_u32 v9, v8, 3, v9
v_mul_u32_u24 v10, 32, v6
v_add_u32 v22, v9, v10
v_mov_b32 v24, 0
v_mov_b32 v25, 0
v_and_b32 v9, 31, v1
v_bfe_u32 v10, v1, 1, 3
v_add_u32 v11, 0, v5
v_xor_b32 v10, v10, v11
v_lshlrev_b32 v10, 4, v10
v_lshl_add_u32 v44, v9, 7, v10
v_and_b32 v9, 31, v1
v_bfe_u32 v10, v1, 1, 3
v_add_u32 v11, 2, v5
v_xor_b32 v10, v10, v11
v_lshlrev_b32 v10, 4, v10
v_lshl_add_u32 v45, v9, 7, v10
v_and_b32 v9, 31, v1
v_bfe_u32 v10, v1, 1, 3
v_add_u32 v11, 4, v5
v_xor_b32 v10, v10, v11
v_lshlrev_b32 v10, 4, v10
v_lshl_add_u32 v46, v9, 7, v10
v_and_b32 v9, 31, v1
v_bfe_u32 v10, v1, 1, 3
v_add_u32 v11, 6, v5
v_xor_b32 v10, v10, v11
v_lshlrev_b32 v10, 4, v10
v_lshl_add_u32 v47, v9, 7, v10
v_mov_b32 v48, 0
v_mov_b32 v49, 0
v_mov_b32 v50, 0
v_mov_b32 v51, 0
v_mov_b32 v52, 0
v_mov_b32 v53, 0
v_mov_b32 v54, 0
v_mov_b32 v55, 0
s_waitcnt vmcnt(28)
s_barrier
v_add_u32 v23, 16384, v22
ds_read_b128 v[56:59], v44 offset:4096
ds_read_b64_tr_b16 v[28:29], v23 offset:64
ds_read_b64_tr_b16 v[30:31], v23 offset:832
ds_read_b128 v[60:63], v45 offset:4096
ds_read_b64_tr_b16 v[32:33], v23 offset:3136
ds_read_b64_tr_b16 v[34:35], v23 offset:3904
ds_read_b128 v[64:67], v46 offset:4096
ds_read_b64_tr_b16 v[36:37], v23 offset:6208
ds_read_b64_tr_b16 v[38:39], v23 offset:6976
ds_read_b128 v[68:71], v47 offset:4096
ds_read_b64_tr_b16 v[40:41], v23 offset:9280
ds_read_b64_tr_b16 v[42:43], v23 offset:10048
s_waitcnt lgkmcnt(11)
v_dot2_f32_bf16 v48, v56, s61, v48
s_waitcnt lgkmcnt(10)
v_dot2_f32_bf16 v24, v28, s61, v24
v_dot2_f32_bf16 v52, v56, v56, v52
v_dot2_f32_bf16 v49, v57, s61, v49
v_dot2_f32_bf16 v25, v29, s61, v25
v_dot2_f32_bf16 v53, v57, v57, v53
v_dot2_f32_bf16 v50, v58, s61, v50
s_waitcnt lgkmcnt(9)
v_dot2_f32_bf16 v24, v30, s61, v24
v_dot2_f32_bf16 v54, v58, v58, v54
v_dot2_f32_bf16 v51, v59, s61, v51
v_dot2_f32_bf16 v25, v31, s61, v25
v_dot2_f32_bf16 v55, v59, v59, v55
s_waitcnt lgkmcnt(8)
v_dot2_f32_bf16 v48, v60, s61, v48
s_waitcnt lgkmcnt(7)
v_dot2_f32_bf16 v24, v32, s61, v24
v_dot2_f32_bf16 v52, v60, v60, v52
v_dot2_f32_bf16 v49, v61, s61, v49
v_dot2_f32_bf16 v25, v33, s61, v25
v_dot2_f32_bf16 v53, v61, v61, v53
v_dot2_f32_bf16 v50, v62, s61, v50
s_waitcnt lgkmcnt(6)
v_dot2_f32_bf16 v24, v34, s61, v24
v_dot2_f32_bf16 v54, v62, v62, v54
v_dot2_f32_bf16 v51, v63, s61, v51
v_dot2_f32_bf16 v25, v35, s61, v25
v_dot2_f32_bf16 v55, v63, v63, v55
s_waitcnt lgkmcnt(5)
v_dot2_f32_bf16 v48, v64, s61, v48
s_waitcnt lgkmcnt(4)
v_dot2_f32_bf16 v24, v36, s61, v24
v_dot2_f32_bf16 v52, v64, v64, v52
v_dot2_f32_bf16 v49, v65, s61, v49
v_dot2_f32_bf16 v25, v37, s61, v25
v_dot2_f32_bf16 v53, v65, v65, v53
v_dot2_f32_bf16 v50, v66, s61, v50
s_waitcnt lgkmcnt(3)
v_dot2_f32_bf16 v24, v38, s61, v24
v_dot2_f32_bf16 v54, v66, v66, v54
v_dot2_f32_bf16 v51, v67, s61, v51
v_dot2_f32_bf16 v25, v39, s61, v25
v_dot2_f32_bf16 v55, v67, v67, v55
s_waitcnt lgkmcnt(2)
v_dot2_f32_bf16 v48, v68, s61, v48
s_waitcnt lgkmcnt(1)
v_dot2_f32_bf16 v24, v40, s61, v24
v_dot2_f32_bf16 v52, v68, v68, v52
v_dot2_f32_bf16 v49, v69, s61, v49
v_dot2_f32_bf16 v25, v41, s61, v25
v_dot2_f32_bf16 v53, v69, v69, v53
v_dot2_f32_bf16 v50, v70, s61, v50
s_waitcnt lgkmcnt(0)
v_dot2_f32_bf16 v24, v42, s61, v24
v_dot2_f32_bf16 v54, v70, v70, v54
v_dot2_f32_bf16 v51, v71, s61, v51
v_dot2_f32_bf16 v25, v43, s61, v25
v_dot2_f32_bf16 v55, v71, v71, v55
s_waitcnt vmcnt(21)
s_barrier
v_add_u32 v23, 45056, v22
ds_read_b128 v[56:59], v44 offset:32768
ds_read_b64_tr_b16 v[28:29], v23 offset:64
ds_read_b64_tr_b16 v[30:31], v23 offset:832
ds_read_b128 v[60:63], v45 offset:32768
ds_read_b64_tr_b16 v[32:33], v23 offset:3136
ds_read_b64_tr_b16 v[34:35], v23 offset:3904
ds_read_b128 v[64:67], v46 offset:32768
ds_read_b64_tr_b16 v[36:37], v23 offset:6208
ds_read_b64_tr_b16 v[38:39], v23 offset:6976
ds_read_b128 v[68:71], v47 offset:32768
ds_read_b64_tr_b16 v[40:41], v23 offset:9280
ds_read_b64_tr_b16 v[42:43], v23 offset:10048
s_waitcnt lgkmcnt(11)
v_dot2_f32_bf16 v48, v56, s61, v48
s_waitcnt lgkmcnt(10)
v_dot2_f32_bf16 v24, v28, s61, v24
v_dot2_f32_bf16 v52, v56, v56, v52
v_dot2_f32_bf16 v49, v57, s61, v49
v_dot2_f32_bf16 v25, v29, s61, v25
v_dot2_f32_bf16 v53, v57, v57, v53
v_dot2_f32_bf16 v50, v58, s61, v50
s_waitcnt lgkmcnt(9)
v_dot2_f32_bf16 v24, v30, s61, v24
v_dot2_f32_bf16 v54, v58, v58, v54
v_dot2_f32_bf16 v51, v59, s61, v51
v_dot2_f32_bf16 v25, v31, s61, v25
v_dot2_f32_bf16 v55, v59, v59, v55
s_waitcnt lgkmcnt(8)
v_dot2_f32_bf16 v48, v60, s61, v48
s_waitcnt lgkmcnt(7)
v_dot2_f32_bf16 v24, v32, s61, v24
v_dot2_f32_bf16 v52, v60, v60, v52
v_dot2_f32_bf16 v49, v61, s61, v49
v_dot2_f32_bf16 v25, v33, s61, v25
v_dot2_f32_bf16 v53, v61, v61, v53
v_dot2_f32_bf16 v50, v62, s61, v50
s_waitcnt lgkmcnt(6)
v_dot2_f32_bf16 v24, v34, s61, v24
v_dot2_f32_bf16 v54, v62, v62, v54
v_dot2_f32_bf16 v51, v63, s61, v51
v_dot2_f32_bf16 v25, v35, s61, v25
v_dot2_f32_bf16 v55, v63, v63, v55
s_waitcnt lgkmcnt(5)
v_dot2_f32_bf16 v48, v64, s61, v48
s_waitcnt lgkmcnt(4)
v_dot2_f32_bf16 v24, v36, s61, v24
v_dot2_f32_bf16 v52, v64, v64, v52
v_dot2_f32_bf16 v49, v65, s61, v49
v_dot2_f32_bf16 v25, v37, s61, v25
v_dot2_f32_bf16 v53, v65, v65, v53
v_dot2_f32_bf16 v50, v66, s61, v50
s_waitcnt lgkmcnt(3)
v_dot2_f32_bf16 v24, v38, s61, v24
v_dot2_f32_bf16 v54, v66, v66, v54
v_dot2_f32_bf16 v51, v67, s61, v51
v_dot2_f32_bf16 v25, v39, s61, v25
v_dot2_f32_bf16 v55, v67, v67, v55
s_waitcnt lgkmcnt(2)
v_dot2_f32_bf16 v48, v68, s61, v48
s_waitcnt lgkmcnt(1)
v_dot2_f32_bf16 v24, v40, s61, v24
v_dot2_f32_bf16 v52, v68, v68, v52
v_dot2_f32_bf16 v49, v69, s61, v49
v_dot2_f32_bf16 v25, v41, s61, v25
v_dot2_f32_bf16 v53, v69, v69, v53
v_dot2_f32_bf16 v50, v70, s61, v50
s_waitcnt lgkmcnt(0)
v_dot2_f32_bf16 v24, v42, s61, v24
v_dot2_f32_bf16 v54, v70, v70, v54
v_dot2_f32_bf16 v51, v71, s61, v51
v_dot2_f32_bf16 v25, v43, s61, v25
v_dot2_f32_bf16 v55, v71, v71, v55
s_waitcnt vmcnt(14)
s_barrier
s_mov_b32 m0, 4096
s_mov_b32 s60, 640
buffer_load_dwordx4 v18, s[40:43], s60 offen lds
s_mov_b32 m0, 5120
s_mov_b32 s60, 640
buffer_load_dwordx4 v19, s[40:43], s60 offen lds
s_mov_b32 m0, 6144
s_mov_b32 s60, 640
buffer_load_dwordx4 v20, s[40:43], s60 offen lds
s_mov_b32 m0, 7168
s_mov_b32 s60, 640
buffer_load_dwordx4 v21, s[40:43], s60 offen lds
s_mov_b32 m0, 19456
s_mov_b32 s60, 983040
buffer_load_dwordx4 v15, s[44:47], s60 offen lds
s_mov_b32 m0, 20480
s_mov_b32 s60, 983040
buffer_load_dwordx4 v16, s[44:47], s60 offen lds
s_mov_b32 m0, 21504
s_mov_b32 s60, 983040
buffer_load_dwordx4 v17, s[44:47], s60 offen lds
v_add_u32 v23, 73728, v22
v_add_u32 v9, 61440, v44
ds_read_b128 v[56:59], v9
ds_read_b64_tr_b16 v[28:29], v23 offset:64
ds_read_b64_tr_b16 v[30:31], v23 offset:832
v_add_u32 v10, 61440, v45
ds_read_b128 v[60:63], v10
ds_read_b64_tr_b16 v[32:33], v23 offset:3136
ds_read_b64_tr_b16 v[34:35], v23 offset:3904
v_add_u32 v9, 61440, v46
ds_read_b128 v[64:67], v9
ds_read_b64_tr_b16 v[36:37], v23 offset:6208
ds_read_b64_tr_b16 v[38:39], v23 offset:6976
v_add_u32 v10, 61440, v47
ds_read_b128 v[68:71], v10
ds_read_b64_tr_b16 v[40:41], v23 offset:9280
ds_read_b64_tr_b16 v[42:43], v23 offset:10048
s_waitcnt lgkmcnt(11)
v_dot2_f32_bf16 v48, v56, s61, v48
s_waitcnt lgkmcnt(10)
v_dot2_f32_bf16 v24, v28, s61, v24
v_dot2_f32_bf16 v52, v56, v56, v52
v_dot2_f32_bf16 v49, v57, s61, v49
v_dot2_f32_bf16 v25, v29, s61, v25
v_dot2_f32_bf16 v53, v57, v57, v53
v_dot2_f32_bf16 v50, v58, s61, v50
s_waitcnt lgkmcnt(9)
v_dot2_f32_bf16 v24, v30, s61, v24
v_dot2_f32_bf16 v54, v58, v58, v54
v_dot2_f32_bf16 v51, v59, s61, v51
v_dot2_f32_bf16 v25, v31, s61, v25
v_dot2_f32_bf16 v55, v59, v59, v55
s_waitcnt lgkmcnt(8)
v_dot2_f32_bf16 v48, v60, s61, v48
s_waitcnt lgkmcnt(7)
v_dot2_f32_bf16 v24, v32, s61, v24
v_dot2_f32_bf16 v52, v60, v60, v52
v_dot2_f32_bf16 v49, v61, s61, v49
v_dot2_f32_bf16 v25, v33, s61, v25
v_dot2_f32_bf16 v53, v61, v61, v53
v_dot2_f32_bf16 v50, v62, s61, v50
s_waitcnt lgkmcnt(6)
v_dot2_f32_bf16 v24, v34, s61, v24
v_dot2_f32_bf16 v54, v62, v62, v54
v_dot2_f32_bf16 v51, v63, s61, v51
v_dot2_f32_bf16 v25, v35, s61, v25
v_dot2_f32_bf16 v55, v63, v63, v55
s_waitcnt lgkmcnt(5)
v_dot2_f32_bf16 v48, v64, s61, v48
s_waitcnt lgkmcnt(4)
v_dot2_f32_bf16 v24, v36, s61, v24
v_dot2_f32_bf16 v52, v64, v64, v52
v_dot2_f32_bf16 v49, v65, s61, v49
v_dot2_f32_bf16 v25, v37, s61, v25
v_dot2_f32_bf16 v53, v65, v65, v53
v_dot2_f32_bf16 v50, v66, s61, v50
s_waitcnt lgkmcnt(3)
v_dot2_f32_bf16 v24, v38, s61, v24
v_dot2_f32_bf16 v54, v66, v66, v54
v_dot2_f32_bf16 v51, v67, s61, v51
v_dot2_f32_bf16 v25, v39, s61, v25
v_dot2_f32_bf16 v55, v67, v67, v55
s_waitcnt lgkmcnt(2)
v_dot2_f32_bf16 v48, v68, s61, v48
s_waitcnt lgkmcnt(1)
v_dot2_f32_bf16 v24, v40, s61, v24
v_dot2_f32_bf16 v52, v68, v68, v52
v_dot2_f32_bf16 v49, v69, s61, v49
v_dot2_f32_bf16 v25, v41, s61, v25
v_dot2_f32_bf16 v53, v69, v69, v53
v_dot2_f32_bf16 v50, v70, s61, v50
s_waitcnt lgkmcnt(0)
v_dot2_f32_bf16 v24, v42, s61, v24
v_dot2_f32_bf16 v54, v70, v70, v54
v_dot2_f32_bf16 v51, v71, s61, v51
v_dot2_f32_bf16 v25, v43, s61, v25
v_dot2_f32_bf16 v55, v71, v71, v55
s_waitcnt vmcnt(14)
s_barrier
s_mov_b32 m0, 32768
s_mov_b32 s60, 768
buffer_load_dwordx4 v18, s[40:43], s60 offen lds
s_mov_b32 m0, 33792
s_mov_b32 s60, 768
buffer_load_dwordx4 v19, s[40:43], s60 offen lds
s_mov_b32 m0, 34816
s_mov_b32 s60, 768
buffer_load_dwordx4 v20, s[40:43], s60 offen lds
s_mov_b32 m0, 35840
s_mov_b32 s60, 768
buffer_load_dwordx4 v21, s[40:43], s60 offen lds
s_mov_b32 m0, 48128
s_mov_b32 s60, 1179648
buffer_load_dwordx4 v15, s[44:47], s60 offen lds
s_mov_b32 m0, 49152
s_mov_b32 s60, 1179648
buffer_load_dwordx4 v16, s[44:47], s60 offen lds
s_mov_b32 m0, 50176
s_mov_b32 s60, 1179648
buffer_load_dwordx4 v17, s[44:47], s60 offen lds
v_add_u32 v23, 102400, v22
v_add_u32 v9, 90112, v44
ds_read_b128 v[56:59], v9
ds_read_b64_tr_b16 v[28:29], v23 offset:64
ds_read_b64_tr_b16 v[30:31], v23 offset:832
v_add_u32 v10, 90112, v45
ds_read_b128 v[60:63], v10
ds_read_b64_tr_b16 v[32:33], v23 offset:3136
ds_read_b64_tr_b16 v[34:35], v23 offset:3904
v_add_u32 v9, 90112, v46
ds_read_b128 v[64:67], v9
ds_read_b64_tr_b16 v[36:37], v23 offset:6208
ds_read_b64_tr_b16 v[38:39], v23 offset:6976
v_add_u32 v10, 90112, v47
ds_read_b128 v[68:71], v10
ds_read_b64_tr_b16 v[40:41], v23 offset:9280
ds_read_b64_tr_b16 v[42:43], v23 offset:10048
s_waitcnt lgkmcnt(11)
v_dot2_f32_bf16 v48, v56, s61, v48
s_waitcnt lgkmcnt(10)
v_dot2_f32_bf16 v24, v28, s61, v24
v_dot2_f32_bf16 v52, v56, v56, v52
v_dot2_f32_bf16 v49, v57, s61, v49
v_dot2_f32_bf16 v25, v29, s61, v25
v_dot2_f32_bf16 v53, v57, v57, v53
v_dot2_f32_bf16 v50, v58, s61, v50
s_waitcnt lgkmcnt(9)
v_dot2_f32_bf16 v24, v30, s61, v24
v_dot2_f32_bf16 v54, v58, v58, v54
v_dot2_f32_bf16 v51, v59, s61, v51
v_dot2_f32_bf16 v25, v31, s61, v25
v_dot2_f32_bf16 v55, v59, v59, v55
s_waitcnt lgkmcnt(8)
v_dot2_f32_bf16 v48, v60, s61, v48
s_waitcnt lgkmcnt(7)
v_dot2_f32_bf16 v24, v32, s61, v24
v_dot2_f32_bf16 v52, v60, v60, v52
v_dot2_f32_bf16 v49, v61, s61, v49
v_dot2_f32_bf16 v25, v33, s61, v25
v_dot2_f32_bf16 v53, v61, v61, v53
v_dot2_f32_bf16 v50, v62, s61, v50
s_waitcnt lgkmcnt(6)
v_dot2_f32_bf16 v24, v34, s61, v24
v_dot2_f32_bf16 v54, v62, v62, v54
v_dot2_f32_bf16 v51, v63, s61, v51
v_dot2_f32_bf16 v25, v35, s61, v25
v_dot2_f32_bf16 v55, v63, v63, v55
s_waitcnt lgkmcnt(5)
v_dot2_f32_bf16 v48, v64, s61, v48
s_waitcnt lgkmcnt(4)
v_dot2_f32_bf16 v24, v36, s61, v24
v_dot2_f32_bf16 v52, v64, v64, v52
v_dot2_f32_bf16 v49, v65, s61, v49
v_dot2_f32_bf16 v25, v37, s61, v25
v_dot2_f32_bf16 v53, v65, v65, v53
v_dot2_f32_bf16 v50, v66, s61, v50
s_waitcnt lgkmcnt(3)
v_dot2_f32_bf16 v24, v38, s61, v24
v_dot2_f32_bf16 v54, v66, v66, v54
v_dot2_f32_bf16 v51, v67, s61, v51
v_dot2_f32_bf16 v25, v39, s61, v25
v_dot2_f32_bf16 v55, v67, v67, v55
s_waitcnt lgkmcnt(2)
v_dot2_f32_bf16 v48, v68, s61, v48
s_waitcnt lgkmcnt(1)
v_dot2_f32_bf16 v24, v40, s61, v24
v_dot2_f32_bf16 v52, v68, v68, v52
v_dot2_f32_bf16 v49, v69, s61, v49
v_dot2_f32_bf16 v25, v41, s61, v25
v_dot2_f32_bf16 v53, v69, v69, v53
v_dot2_f32_bf16 v50, v70, s61, v50
s_waitcnt lgkmcnt(0)
v_dot2_f32_bf16 v24, v42, s61, v24
v_dot2_f32_bf16 v54, v70, v70, v54
v_dot2_f32_bf16 v51, v71, s61, v51
v_dot2_f32_bf16 v25, v43, s61, v25
v_dot2_f32_bf16 v55, v71, v71, v55
s_waitcnt vmcnt(14)
s_barrier
s_mov_b32 m0, 61440
s_mov_b32 s60, 896
buffer_load_dwordx4 v18, s[40:43], s60 offen lds
s_mov_b32 m0, 62464
s_mov_b32 s60, 896
buffer_load_dwordx4 v19, s[40:43], s60 offen lds
s_mov_b32 m0, 63488
s_mov_b32 s60, 896
buffer_load_dwordx4 v20, s[40:43], s60 offen lds
s_mov_b32 m0, 64512
s_mov_b32 s60, 896
buffer_load_dwordx4 v21, s[40:43], s60 offen lds
s_mov_b32 m0, 76800
s_mov_b32 s60, 1376256
buffer_load_dwordx4 v15, s[44:47], s60 offen lds
s_mov_b32 m0, 77824
s_mov_b32 s60, 1376256
buffer_load_dwordx4 v16, s[44:47], s60 offen lds
s_mov_b32 m0, 78848
s_mov_b32 s60, 1376256
buffer_load_dwordx4 v17, s[44:47], s60 offen lds
v_add_u32 v23, 131072, v22
v_add_u32 v9, 118784, v44
ds_read_b128 v[56:59], v9
ds_read_b64_tr_b16 v[28:29], v23 offset:64
ds_read_b64_tr_b16 v[30:31], v23 offset:832
v_add_u32 v10, 118784, v45
ds_read_b128 v[60:63], v10
ds_read_b64_tr_b16 v[32:33], v23 offset:3136
ds_read_b64_tr_b16 v[34:35], v23 offset:3904
v_add_u32 v9, 118784, v46
ds_read_b128 v[64:67], v9
ds_read_b64_tr_b16 v[36:37], v23 offset:6208
ds_read_b64_tr_b16 v[38:39], v23 offset:6976
v_add_u32 v10, 118784, v47
ds_read_b128 v[68:71], v10
ds_read_b64_tr_b16 v[40:41], v23 offset:9280
ds_read_b64_tr_b16 v[42:43], v23 offset:10048
s_waitcnt lgkmcnt(11)
v_dot2_f32_bf16 v48, v56, s61, v48
s_waitcnt lgkmcnt(10)
v_dot2_f32_bf16 v24, v28, s61, v24
v_dot2_f32_bf16 v52, v56, v56, v52
v_dot2_f32_bf16 v49, v57, s61, v49
v_dot2_f32_bf16 v25, v29, s61, v25
v_dot2_f32_bf16 v53, v57, v57, v53
v_dot2_f32_bf16 v50, v58, s61, v50
s_waitcnt lgkmcnt(9)
v_dot2_f32_bf16 v24, v30, s61, v24
v_dot2_f32_bf16 v54, v58, v58, v54
v_dot2_f32_bf16 v51, v59, s61, v51
v_dot2_f32_bf16 v25, v31, s61, v25
v_dot2_f32_bf16 v55, v59, v59, v55
s_waitcnt lgkmcnt(8)
v_dot2_f32_bf16 v48, v60, s61, v48
s_waitcnt lgkmcnt(7)
v_dot2_f32_bf16 v24, v32, s61, v24
v_dot2_f32_bf16 v52, v60, v60, v52
v_dot2_f32_bf16 v49, v61, s61, v49
v_dot2_f32_bf16 v25, v33, s61, v25
v_dot2_f32_bf16 v53, v61, v61, v53
v_dot2_f32_bf16 v50, v62, s61, v50
s_waitcnt lgkmcnt(6)
v_dot2_f32_bf16 v24, v34, s61, v24
v_dot2_f32_bf16 v54, v62, v62, v54
v_dot2_f32_bf16 v51, v63, s61, v51
v_dot2_f32_bf16 v25, v35, s61, v25
v_dot2_f32_bf16 v55, v63, v63, v55
s_waitcnt lgkmcnt(5)
v_dot2_f32_bf16 v48, v64, s61, v48
s_waitcnt lgkmcnt(4)
v_dot2_f32_bf16 v24, v36, s61, v24
v_dot2_f32_bf16 v52, v64, v64, v52
v_dot2_f32_bf16 v49, v65, s61, v49
v_dot2_f32_bf16 v25, v37, s61, v25
v_dot2_f32_bf16 v53, v65, v65, v53
v_dot2_f32_bf16 v50, v66, s61, v50
s_waitcnt lgkmcnt(3)
v_dot2_f32_bf16 v24, v38, s61, v24
v_dot2_f32_bf16 v54, v66, v66, v54
v_dot2_f32_bf16 v51, v67, s61, v51
v_dot2_f32_bf16 v25, v39, s61, v25
v_dot2_f32_bf16 v55, v67, v67, v55
s_waitcnt lgkmcnt(2)
v_dot2_f32_bf16 v48, v68, s61, v48
s_waitcnt lgkmcnt(1)
v_dot2_f32_bf16 v24, v40, s61, v24
v_dot2_f32_bf16 v52, v68, v68, v52
v_dot2_f32_bf16 v49, v69, s61, v49
v_dot2_f32_bf16 v25, v41, s61, v25
v_dot2_f32_bf16 v53, v69, v69, v53
v_dot2_f32_bf16 v50, v70, s61, v50
s_waitcnt lgkmcnt(0)
v_dot2_f32_bf16 v24, v42, s61, v24
v_dot2_f32_bf16 v54, v70, v70, v54
v_dot2_f32_bf16 v51, v71, s61, v51
v_dot2_f32_bf16 v25, v43, s61, v25
v_dot2_f32_bf16 v55, v71, v71, v55
s_waitcnt vmcnt(14)
s_barrier
v_add_u32 v23, 16384, v22
ds_read_b128 v[56:59], v44 offset:4096
ds_read_b64_tr_b16 v[28:29], v23 offset:64
ds_read_b64_tr_b16 v[30:31], v23 offset:832
ds_read_b128 v[60:63], v45 offset:4096
ds_read_b64_tr_b16 v[32:33], v23 offset:3136
ds_read_b64_tr_b16 v[34:35], v23 offset:3904
ds_read_b128 v[64:67], v46 offset:4096
ds_read_b64_tr_b16 v[36:37], v23 offset:6208
ds_read_b64_tr_b16 v[38:39], v23 offset:6976
ds_read_b128 v[68:71], v47 offset:4096
ds_read_b64_tr_b16 v[40:41], v23 offset:9280
ds_read_b64_tr_b16 v[42:43], v23 offset:10048
s_waitcnt lgkmcnt(11)
v_dot2_f32_bf16 v48, v56, s61, v48
s_waitcnt lgkmcnt(10)
v_dot2_f32_bf16 v24, v28, s61, v24
v_dot2_f32_bf16 v52, v56, v56, v52
v_dot2_f32_bf16 v49, v57, s61, v49
v_dot2_f32_bf16 v25, v29, s61, v25
v_dot2_f32_bf16 v53, v57, v57, v53
v_dot2_f32_bf16 v50, v58, s61, v50
s_waitcnt lgkmcnt(9)
v_dot2_f32_bf16 v24, v30, s61, v24
v_dot2_f32_bf16 v54, v58, v58, v54
v_dot2_f32_bf16 v51, v59, s61, v51
v_dot2_f32_bf16 v25, v31, s61, v25
v_dot2_f32_bf16 v55, v59, v59, v55
s_waitcnt lgkmcnt(8)
v_dot2_f32_bf16 v48, v60, s61, v48
s_waitcnt lgkmcnt(7)
v_dot2_f32_bf16 v24, v32, s61, v24
v_dot2_f32_bf16 v52, v60, v60, v52
v_dot2_f32_bf16 v49, v61, s61, v49
v_dot2_f32_bf16 v25, v33, s61, v25
v_dot2_f32_bf16 v53, v61, v61, v53
v_dot2_f32_bf16 v50, v62, s61, v50
s_waitcnt lgkmcnt(6)
v_dot2_f32_bf16 v24, v34, s61, v24
v_dot2_f32_bf16 v54, v62, v62, v54
v_dot2_f32_bf16 v51, v63, s61, v51
v_dot2_f32_bf16 v25, v35, s61, v25
v_dot2_f32_bf16 v55, v63, v63, v55
s_waitcnt lgkmcnt(5)
v_dot2_f32_bf16 v48, v64, s61, v48
s_waitcnt lgkmcnt(4)
v_dot2_f32_bf16 v24, v36, s61, v24
v_dot2_f32_bf16 v52, v64, v64, v52
v_dot2_f32_bf16 v49, v65, s61, v49
v_dot2_f32_bf16 v25, v37, s61, v25
v_dot2_f32_bf16 v53, v65, v65, v53
v_dot2_f32_bf16 v50, v66, s61, v50
s_waitcnt lgkmcnt(3)
v_dot2_f32_bf16 v24, v38, s61, v24
v_dot2_f32_bf16 v54, v66, v66, v54
v_dot2_f32_bf16 v51, v67, s61, v51
v_dot2_f32_bf16 v25, v39, s61, v25
v_dot2_f32_bf16 v55, v67, v67, v55
s_waitcnt lgkmcnt(2)
v_dot2_f32_bf16 v48, v68, s61, v48
s_waitcnt lgkmcnt(1)
v_dot2_f32_bf16 v24, v40, s61, v24
v_dot2_f32_bf16 v52, v68, v68, v52
v_dot2_f32_bf16 v49, v69, s61, v49
v_dot2_f32_bf16 v25, v41, s61, v25
v_dot2_f32_bf16 v53, v69, v69, v53
v_dot2_f32_bf16 v50, v70, s61, v50
s_waitcnt lgkmcnt(0)
v_dot2_f32_bf16 v24, v42, s61, v24
v_dot2_f32_bf16 v54, v70, v70, v54
v_dot2_f32_bf16 v51, v71, s61, v51
v_dot2_f32_bf16 v25, v43, s61, v25
v_dot2_f32_bf16 v55, v71, v71, v55
s_waitcnt vmcnt(7)
s_barrier
v_add_u32 v23, 45056, v22
ds_read_b128 v[56:59], v44 offset:32768
ds_read_b64_tr_b16 v[28:29], v23 offset:64
ds_read_b64_tr_b16 v[30:31], v23 offset:832
ds_read_b128 v[60:63], v45 offset:32768
ds_read_b64_tr_b16 v[32:33], v23 offset:3136
ds_read_b64_tr_b16 v[34:35], v23 offset:3904
ds_read_b128 v[64:67], v46 offset:32768
ds_read_b64_tr_b16 v[36:37], v23 offset:6208
ds_read_b64_tr_b16 v[38:39], v23 offset:6976
ds_read_b128 v[68:71], v47 offset:32768
ds_read_b64_tr_b16 v[40:41], v23 offset:9280
ds_read_b64_tr_b16 v[42:43], v23 offset:10048
s_waitcnt lgkmcnt(11)
v_dot2_f32_bf16 v48, v56, s61, v48
s_waitcnt lgkmcnt(10)
v_dot2_f32_bf16 v24, v28, s61, v24
v_dot2_f32_bf16 v52, v56, v56, v52
v_dot2_f32_bf16 v49, v57, s61, v49
v_dot2_f32_bf16 v25, v29, s61, v25
v_dot2_f32_bf16 v53, v57, v57, v53
v_dot2_f32_bf16 v50, v58, s61, v50
s_waitcnt lgkmcnt(9)
v_dot2_f32_bf16 v24, v30, s61, v24
v_dot2_f32_bf16 v54, v58, v58, v54
v_dot2_f32_bf16 v51, v59, s61, v51
v_dot2_f32_bf16 v25, v31, s61, v25
v_dot2_f32_bf16 v55, v59, v59, v55
s_waitcnt lgkmcnt(8)
v_dot2_f32_bf16 v48, v60, s61, v48
s_waitcnt lgkmcnt(7)
v_dot2_f32_bf16 v24, v32, s61, v24
v_dot2_f32_bf16 v52, v60, v60, v52
v_dot2_f32_bf16 v49, v61, s61, v49
v_dot2_f32_bf16 v25, v33, s61, v25
v_dot2_f32_bf16 v53, v61, v61, v53
v_dot2_f32_bf16 v50, v62, s61, v50
s_waitcnt lgkmcnt(6)
v_dot2_f32_bf16 v24, v34, s61, v24
v_dot2_f32_bf16 v54, v62, v62, v54
v_dot2_f32_bf16 v51, v63, s61, v51
v_dot2_f32_bf16 v25, v35, s61, v25
v_dot2_f32_bf16 v55, v63, v63, v55
s_waitcnt lgkmcnt(5)
v_dot2_f32_bf16 v48, v64, s61, v48
s_waitcnt lgkmcnt(4)
v_dot2_f32_bf16 v24, v36, s61, v24
v_dot2_f32_bf16 v52, v64, v64, v52
v_dot2_f32_bf16 v49, v65, s61, v49
v_dot2_f32_bf16 v25, v37, s61, v25
v_dot2_f32_bf16 v53, v65, v65, v53
v_dot2_f32_bf16 v50, v66, s61, v50
s_waitcnt lgkmcnt(3)
v_dot2_f32_bf16 v24, v38, s61, v24
v_dot2_f32_bf16 v54, v66, v66, v54
v_dot2_f32_bf16 v51, v67, s61, v51
v_dot2_f32_bf16 v25, v39, s61, v25
v_dot2_f32_bf16 v55, v67, v67, v55
s_waitcnt lgkmcnt(2)
v_dot2_f32_bf16 v48, v68, s61, v48
s_waitcnt lgkmcnt(1)
v_dot2_f32_bf16 v24, v40, s61, v24
v_dot2_f32_bf16 v52, v68, v68, v52
v_dot2_f32_bf16 v49, v69, s61, v49
v_dot2_f32_bf16 v25, v41, s61, v25
v_dot2_f32_bf16 v53, v69, v69, v53
v_dot2_f32_bf16 v50, v70, s61, v50
s_waitcnt lgkmcnt(0)
v_dot2_f32_bf16 v24, v42, s61, v24
v_dot2_f32_bf16 v54, v70, v70, v54
v_dot2_f32_bf16 v51, v71, s61, v51
v_dot2_f32_bf16 v25, v43, s61, v25
v_dot2_f32_bf16 v55, v71, v71, v55
s_waitcnt vmcnt(0)
s_barrier
v_add_u32 v23, 73728, v22
v_add_u32 v9, 61440, v44
ds_read_b128 v[56:59], v9
ds_read_b64_tr_b16 v[28:29], v23 offset:64
ds_read_b64_tr_b16 v[30:31], v23 offset:832
v_add_u32 v10, 61440, v45
ds_read_b128 v[60:63], v10
ds_read_b64_tr_b16 v[32:33], v23 offset:3136
ds_read_b64_tr_b16 v[34:35], v23 offset:3904
v_add_u32 v9, 61440, v46
ds_read_b128 v[64:67], v9
ds_read_b64_tr_b16 v[36:37], v23 offset:6208
ds_read_b64_tr_b16 v[38:39], v23 offset:6976
v_add_u32 v10, 61440, v47
ds_read_b128 v[68:71], v10
ds_read_b64_tr_b16 v[40:41], v23 offset:9280
ds_read_b64_tr_b16 v[42:43], v23 offset:10048
s_waitcnt lgkmcnt(11)
v_dot2_f32_bf16 v48, v56, s61, v48
s_waitcnt lgkmcnt(10)
v_dot2_f32_bf16 v24, v28, s61, v24
v_dot2_f32_bf16 v52, v56, v56, v52
v_dot2_f32_bf16 v49, v57, s61, v49
v_dot2_f32_bf16 v25, v29, s61, v25
v_dot2_f32_bf16 v53, v57, v57, v53
v_dot2_f32_bf16 v50, v58, s61, v50
s_waitcnt lgkmcnt(9)
v_dot2_f32_bf16 v24, v30, s61, v24
v_dot2_f32_bf16 v54, v58, v58, v54
v_dot2_f32_bf16 v51, v59, s61, v51
v_dot2_f32_bf16 v25, v31, s61, v25
v_dot2_f32_bf16 v55, v59, v59, v55
s_waitcnt lgkmcnt(8)
v_dot2_f32_bf16 v48, v60, s61, v48
s_waitcnt lgkmcnt(7)
v_dot2_f32_bf16 v24, v32, s61, v24
v_dot2_f32_bf16 v52, v60, v60, v52
v_dot2_f32_bf16 v49, v61, s61, v49
v_dot2_f32_bf16 v25, v33, s61, v25
v_dot2_f32_bf16 v53, v61, v61, v53
v_dot2_f32_bf16 v50, v62, s61, v50
s_waitcnt lgkmcnt(6)
v_dot2_f32_bf16 v24, v34, s61, v24
v_dot2_f32_bf16 v54, v62, v62, v54
v_dot2_f32_bf16 v51, v63, s61, v51
v_dot2_f32_bf16 v25, v35, s61, v25
v_dot2_f32_bf16 v55, v63, v63, v55
s_waitcnt lgkmcnt(5)
v_dot2_f32_bf16 v48, v64, s61, v48
s_waitcnt lgkmcnt(4)
v_dot2_f32_bf16 v24, v36, s61, v24
v_dot2_f32_bf16 v52, v64, v64, v52
v_dot2_f32_bf16 v49, v65, s61, v49
v_dot2_f32_bf16 v25, v37, s61, v25
v_dot2_f32_bf16 v53, v65, v65, v53
v_dot2_f32_bf16 v50, v66, s61, v50
s_waitcnt lgkmcnt(3)
v_dot2_f32_bf16 v24, v38, s61, v24
v_dot2_f32_bf16 v54, v66, v66, v54
v_dot2_f32_bf16 v51, v67, s61, v51
v_dot2_f32_bf16 v25, v39, s61, v25
v_dot2_f32_bf16 v55, v67, v67, v55
s_waitcnt lgkmcnt(2)
v_dot2_f32_bf16 v48, v68, s61, v48
s_waitcnt lgkmcnt(1)
v_dot2_f32_bf16 v24, v40, s61, v24
v_dot2_f32_bf16 v52, v68, v68, v52
v_dot2_f32_bf16 v49, v69, s61, v49
v_dot2_f32_bf16 v25, v41, s61, v25
v_dot2_f32_bf16 v53, v69, v69, v53
v_dot2_f32_bf16 v50, v70, s61, v50
s_waitcnt lgkmcnt(0)
v_dot2_f32_bf16 v24, v42, s61, v24
v_dot2_f32_bf16 v54, v70, v70, v54
v_dot2_f32_bf16 v51, v71, s61, v51
v_dot2_f32_bf16 v25, v43, s61, v25
v_dot2_f32_bf16 v55, v71, v71, v55
v_and_b32 v9, 31, v1
v_lshlrev_b32 v10, 2, v9
v_add_u32 v10, 0, v10
v_lshlrev_b32 v11, 3, v9
v_add_u32 v11, 2304, v11
v_add_f32 v24, v24, v25
v_mov_b32 v74, v24
v_mov_b32 v75, v24
s_nop 1
v_permlane32_swap_b32 v74, v75
v_add_f32 v24, v74, v75
v_add_f32 v48, v48, v49
v_add_f32 v50, v50, v51
v_add_f32 v52, v52, v53
v_add_f32 v54, v54, v55
v_add_f32 v72, v48, v50
v_add_f32 v73, v52, v54
v_mov_b32 v74, v72
v_mov_b32 v75, v72
s_nop 1
v_permlane32_swap_b32 v74, v75
v_add_f32 v72, v74, v75
v_mov_b32 v76, v73
v_mov_b32 v77, v73
s_nop 1
v_permlane32_swap_b32 v76, v77
v_add_f32 v73, v76, v77
v_mul_f32 v72, 0x3b000000, v72
v_mul_f32 v73, 0x3b000000, v73
v_fma_f32 v73, -v72, v72, v73
v_max_f32 v73, 0, v73
v_cvt_pk_bf16_f32 v72, v72, v72
v_cvt_pk_bf16_f32 v73, v73, v73
v_lshlrev_b32 v72, 16, v72
v_lshlrev_b32 v73, 16, v73
v_add_f32 v73, 0x3727c5ac, v73
v_cvt_pk_bf16_f32 v73, v73, v73
v_lshlrev_b32 v73, 16, v73
v_sqrt_f32 v73, v73
s_nop 0
v_cvt_pk_bf16_f32 v73, v73, v73
v_lshlrev_b32 v73, 16, v73
v_rcp_f32 v73, v73
v_sub_f32 v72, 0, v72
s_mov_b64 exec, 0xffffffff
ds_write_b32 v10, v24 offset:128
ds_write_b64 v11, v[72:73]
s_mov_b64 exec, -1
s_waitcnt lgkmcnt(0)
s_barrier
s_branch k1_kernel_end
k1_kernel_w6:
v_add_u32 v9, 384, v1
s_mov_b32 s7, 5462
v_mul_lo_u32 v10, v9, s7
v_lshrrev_b32 v10, 16, v10
v_mul_u32_u24 v11, 12, v10
v_sub_u32 v11, v9, v11
v_lshlrev_b32 v11, 4, v11
s_mov_b32 s7, 3072
v_mul_lo_u32 v10, v10, s7
v_add_u32 v15, v10, v11
v_add_u32 v9, 448, v1
s_mov_b32 s7, 5462
v_mul_lo_u32 v10, v9, s7
v_lshrrev_b32 v10, 16, v10
v_mul_u32_u24 v11, 12, v10
v_sub_u32 v11, v9, v11
v_lshlrev_b32 v11, 4, v11
s_mov_b32 s7, 3072
v_mul_lo_u32 v10, v10, s7
v_add_u32 v16, v10, v11
v_add_u32 v9, 512, v1
s_mov_b32 s7, 5462
v_mul_lo_u32 v10, v9, s7
v_lshrrev_b32 v10, 16, v10
v_mul_u32_u24 v11, 12, v10
v_sub_u32 v11, v9, v11
v_lshlrev_b32 v11, 4, v11
s_mov_b32 s7, 3072
v_mul_lo_u32 v10, v10, s7
v_add_u32 v17, v10, v11
v_lshrrev_b32 v9, 4, v1
v_add_u32 v9, 0, v9
v_and_b32 v9, 7, v9
v_and_b32 v10, 7, v1
v_xor_b32 v9, v9, v10
v_lshlrev_b32 v9, 4, v9
v_lshrrev_b32 v10, 3, v1
v_add_u32 v10, 64, v10
v_lshl_add_u32 v18, v10, 10, v9
v_lshrrev_b32 v9, 4, v1
v_add_u32 v9, 4, v9
v_and_b32 v9, 7, v9
v_and_b32 v10, 7, v1
v_xor_b32 v9, v9, v10
v_lshlrev_b32 v9, 4, v9
v_lshrrev_b32 v10, 3, v1
v_add_u32 v10, 72, v10
v_lshl_add_u32 v19, v10, 10, v9
v_lshrrev_b32 v9, 4, v1
v_add_u32 v9, 8, v9
v_and_b32 v9, 7, v9
v_and_b32 v10, 7, v1
v_xor_b32 v9, v9, v10
v_lshlrev_b32 v9, 4, v9
v_lshrrev_b32 v10, 3, v1
v_add_u32 v10, 80, v10
v_lshl_add_u32 v20, v10, 10, v9
v_lshrrev_b32 v9, 4, v1
v_add_u32 v9, 12, v9
v_and_b32 v9, 7, v9
v_and_b32 v10, 7, v1
v_xor_b32 v9, v9, v10
v_lshlrev_b32 v9, 4, v9
v_lshrrev_b32 v10, 3, v1
v_add_u32 v10, 88, v10
v_lshl_add_u32 v21, v10, 10, v9
s_mov_b32 m0, 8192
s_mov_b32 s60, 0
buffer_load_dwordx4 v18, s[40:43], s60 offen lds
s_mov_b32 m0, 9216
s_mov_b32 s60, 0
buffer_load_dwordx4 v19, s[40:43], s60 offen lds
s_mov_b32 m0, 10240
s_mov_b32 s60, 0
buffer_load_dwordx4 v20, s[40:43], s60 offen lds
s_mov_b32 m0, 11264
s_mov_b32 s60, 0
buffer_load_dwordx4 v21, s[40:43], s60 offen lds
s_mov_b32 m0, 22528
s_mov_b32 s60, 0
buffer_load_dwordx4 v15, s[44:47], s60 offen lds
s_mov_b32 m0, 23552
s_mov_b32 s60, 0
buffer_load_dwordx4 v16, s[44:47], s60 offen lds
s_mov_b32 m0, 24576
s_mov_b32 s60, 0
buffer_load_dwordx4 v17, s[44:47], s60 offen lds
s_mov_b32 m0, 36864
s_mov_b32 s60, 128
buffer_load_dwordx4 v18, s[40:43], s60 offen lds
s_mov_b32 m0, 37888
s_mov_b32 s60, 128
buffer_load_dwordx4 v19, s[40:43], s60 offen lds
s_mov_b32 m0, 38912
s_mov_b32 s60, 128
buffer_load_dwordx4 v20, s[40:43], s60 offen lds
s_mov_b32 m0, 39936
s_mov_b32 s60, 128
buffer_load_dwordx4 v21, s[40:43], s60 offen lds
s_mov_b32 m0, 51200
s_mov_b32 s60, 196608
buffer_load_dwordx4 v15, s[44:47], s60 offen lds
s_mov_b32 m0, 52224
s_mov_b32 s60, 196608
buffer_load_dwordx4 v16, s[44:47], s60 offen lds
s_mov_b32 m0, 53248
s_mov_b32 s60, 196608
buffer_load_dwordx4 v17, s[44:47], s60 offen lds
s_mov_b32 m0, 65536
s_mov_b32 s60, 256
buffer_load_dwordx4 v18, s[40:43], s60 offen lds
s_mov_b32 m0, 66560
s_mov_b32 s60, 256
buffer_load_dwordx4 v19, s[40:43], s60 offen lds
s_mov_b32 m0, 67584
s_mov_b32 s60, 256
buffer_load_dwordx4 v20, s[40:43], s60 offen lds
s_mov_b32 m0, 68608
s_mov_b32 s60, 256
buffer_load_dwordx4 v21, s[40:43], s60 offen lds
s_mov_b32 m0, 79872
s_mov_b32 s60, 393216
buffer_load_dwordx4 v15, s[44:47], s60 offen lds
s_mov_b32 m0, 80896
s_mov_b32 s60, 393216
buffer_load_dwordx4 v16, s[44:47], s60 offen lds
s_mov_b32 m0, 81920
s_mov_b32 s60, 393216
buffer_load_dwordx4 v17, s[44:47], s60 offen lds
s_mov_b32 m0, 94208
s_mov_b32 s60, 384
buffer_load_dwordx4 v18, s[40:43], s60 offen lds
s_mov_b32 m0, 95232
s_mov_b32 s60, 384
buffer_load_dwordx4 v19, s[40:43], s60 offen lds
s_mov_b32 m0, 96256
s_mov_b32 s60, 384
buffer_load_dwordx4 v20, s[40:43], s60 offen lds
s_mov_b32 m0, 97280
s_mov_b32 s60, 384
buffer_load_dwordx4 v21, s[40:43], s60 offen lds
s_mov_b32 m0, 108544
s_mov_b32 s60, 589824
buffer_load_dwordx4 v15, s[44:47], s60 offen lds
s_mov_b32 m0, 109568
s_mov_b32 s60, 589824
buffer_load_dwordx4 v16, s[44:47], s60 offen lds
s_mov_b32 m0, 110592
s_mov_b32 s60, 589824
buffer_load_dwordx4 v17, s[44:47], s60 offen lds
s_mov_b32 m0, 122880
s_mov_b32 s60, 512
buffer_load_dwordx4 v18, s[40:43], s60 offen lds
s_mov_b32 m0, 123904
s_mov_b32 s60, 512
buffer_load_dwordx4 v19, s[40:43], s60 offen lds
s_mov_b32 m0, 124928
s_mov_b32 s60, 512
buffer_load_dwordx4 v20, s[40:43], s60 offen lds
s_mov_b32 m0, 125952
s_mov_b32 s60, 512
buffer_load_dwordx4 v21, s[40:43], s60 offen lds
s_mov_b32 m0, 137216
s_mov_b32 s60, 786432
buffer_load_dwordx4 v15, s[44:47], s60 offen lds
s_mov_b32 m0, 138240
s_mov_b32 s60, 786432
buffer_load_dwordx4 v16, s[44:47], s60 offen lds
s_mov_b32 m0, 139264
s_mov_b32 s60, 786432
buffer_load_dwordx4 v17, s[44:47], s60 offen lds
v_mul_u32_u24 v9, 192, v7
v_lshl_add_u32 v9, v8, 3, v9
v_mul_u32_u24 v10, 32, v6
v_add_u32 v22, v9, v10
v_mov_b32 v24, 0
v_mov_b32 v25, 0
v_and_b32 v9, 31, v1
v_bfe_u32 v10, v1, 1, 3
v_add_u32 v11, 0, v5
v_xor_b32 v10, v10, v11
v_lshlrev_b32 v10, 4, v10
v_lshl_add_u32 v44, v9, 7, v10
v_and_b32 v9, 31, v1
v_bfe_u32 v10, v1, 1, 3
v_add_u32 v11, 2, v5
v_xor_b32 v10, v10, v11
v_lshlrev_b32 v10, 4, v10
v_lshl_add_u32 v45, v9, 7, v10
v_and_b32 v9, 31, v1
v_bfe_u32 v10, v1, 1, 3
v_add_u32 v11, 4, v5
v_xor_b32 v10, v10, v11
v_lshlrev_b32 v10, 4, v10
v_lshl_add_u32 v46, v9, 7, v10
v_and_b32 v9, 31, v1
v_bfe_u32 v10, v1, 1, 3
v_add_u32 v11, 6, v5
v_xor_b32 v10, v10, v11
v_lshlrev_b32 v10, 4, v10
v_lshl_add_u32 v47, v9, 7, v10
v_mov_b32 v48, 0
v_mov_b32 v49, 0
v_mov_b32 v50, 0
v_mov_b32 v51, 0
v_mov_b32 v52, 0
v_mov_b32 v53, 0
v_mov_b32 v54, 0
v_mov_b32 v55, 0
s_waitcnt vmcnt(28)
s_barrier
v_add_u32 v23, 16384, v22
ds_read_b128 v[56:59], v44 offset:8192
ds_read_b64_tr_b16 v[28:29], v23 offset:128
ds_read_b64_tr_b16 v[30:31], v23 offset:896
ds_read_b128 v[60:63], v45 offset:8192
ds_read_b64_tr_b16 v[32:33], v23 offset:3200
ds_read_b64_tr_b16 v[34:35], v23 offset:3968
ds_read_b128 v[64:67], v46 offset:8192
ds_read_b64_tr_b16 v[36:37], v23 offset:6272
ds_read_b64_tr_b16 v[38:39], v23 offset:7040
ds_read_b128 v[68:71], v47 offset:8192
ds_read_b64_tr_b16 v[40:41], v23 offset:9344
ds_read_b64_tr_b16 v[42:43], v23 offset:10112
s_waitcnt lgkmcnt(11)
v_dot2_f32_bf16 v48, v56, s61, v48
s_waitcnt lgkmcnt(10)
v_dot2_f32_bf16 v24, v28, s61, v24
v_dot2_f32_bf16 v52, v56, v56, v52
v_dot2_f32_bf16 v49, v57, s61, v49
v_dot2_f32_bf16 v25, v29, s61, v25
v_dot2_f32_bf16 v53, v57, v57, v53
v_dot2_f32_bf16 v50, v58, s61, v50
s_waitcnt lgkmcnt(9)
v_dot2_f32_bf16 v24, v30, s61, v24
v_dot2_f32_bf16 v54, v58, v58, v54
v_dot2_f32_bf16 v51, v59, s61, v51
v_dot2_f32_bf16 v25, v31, s61, v25
v_dot2_f32_bf16 v55, v59, v59, v55
s_waitcnt lgkmcnt(8)
v_dot2_f32_bf16 v48, v60, s61, v48
s_waitcnt lgkmcnt(7)
v_dot2_f32_bf16 v24, v32, s61, v24
v_dot2_f32_bf16 v52, v60, v60, v52
v_dot2_f32_bf16 v49, v61, s61, v49
v_dot2_f32_bf16 v25, v33, s61, v25
v_dot2_f32_bf16 v53, v61, v61, v53
v_dot2_f32_bf16 v50, v62, s61, v50
s_waitcnt lgkmcnt(6)
v_dot2_f32_bf16 v24, v34, s61, v24
v_dot2_f32_bf16 v54, v62, v62, v54
v_dot2_f32_bf16 v51, v63, s61, v51
v_dot2_f32_bf16 v25, v35, s61, v25
v_dot2_f32_bf16 v55, v63, v63, v55
s_waitcnt lgkmcnt(5)
v_dot2_f32_bf16 v48, v64, s61, v48
s_waitcnt lgkmcnt(4)
v_dot2_f32_bf16 v24, v36, s61, v24
v_dot2_f32_bf16 v52, v64, v64, v52
v_dot2_f32_bf16 v49, v65, s61, v49
v_dot2_f32_bf16 v25, v37, s61, v25
v_dot2_f32_bf16 v53, v65, v65, v53
v_dot2_f32_bf16 v50, v66, s61, v50
s_waitcnt lgkmcnt(3)
v_dot2_f32_bf16 v24, v38, s61, v24
v_dot2_f32_bf16 v54, v66, v66, v54
v_dot2_f32_bf16 v51, v67, s61, v51
v_dot2_f32_bf16 v25, v39, s61, v25
v_dot2_f32_bf16 v55, v67, v67, v55
s_waitcnt lgkmcnt(2)
v_dot2_f32_bf16 v48, v68, s61, v48
s_waitcnt lgkmcnt(1)
v_dot2_f32_bf16 v24, v40, s61, v24
v_dot2_f32_bf16 v52, v68, v68, v52
v_dot2_f32_bf16 v49, v69, s61, v49
v_dot2_f32_bf16 v25, v41, s61, v25
v_dot2_f32_bf16 v53, v69, v69, v53
v_dot2_f32_bf16 v50, v70, s61, v50
s_waitcnt lgkmcnt(0)
v_dot2_f32_bf16 v24, v42, s61, v24
v_dot2_f32_bf16 v54, v70, v70, v54
v_dot2_f32_bf16 v51, v71, s61, v51
v_dot2_f32_bf16 v25, v43, s61, v25
v_dot2_f32_bf16 v55, v71, v71, v55
s_waitcnt vmcnt(21)
s_barrier
v_add_u32 v23, 45056, v22
ds_read_b128 v[56:59], v44 offset:36864
ds_read_b64_tr_b16 v[28:29], v23 offset:128
ds_read_b64_tr_b16 v[30:31], v23 offset:896
ds_read_b128 v[60:63], v45 offset:36864
ds_read_b64_tr_b16 v[32:33], v23 offset:3200
ds_read_b64_tr_b16 v[34:35], v23 offset:3968
ds_read_b128 v[64:67], v46 offset:36864
ds_read_b64_tr_b16 v[36:37], v23 offset:6272
ds_read_b64_tr_b16 v[38:39], v23 offset:7040
ds_read_b128 v[68:71], v47 offset:36864
ds_read_b64_tr_b16 v[40:41], v23 offset:9344
ds_read_b64_tr_b16 v[42:43], v23 offset:10112
s_waitcnt lgkmcnt(11)
v_dot2_f32_bf16 v48, v56, s61, v48
s_waitcnt lgkmcnt(10)
v_dot2_f32_bf16 v24, v28, s61, v24
v_dot2_f32_bf16 v52, v56, v56, v52
v_dot2_f32_bf16 v49, v57, s61, v49
v_dot2_f32_bf16 v25, v29, s61, v25
v_dot2_f32_bf16 v53, v57, v57, v53
v_dot2_f32_bf16 v50, v58, s61, v50
s_waitcnt lgkmcnt(9)
v_dot2_f32_bf16 v24, v30, s61, v24
v_dot2_f32_bf16 v54, v58, v58, v54
v_dot2_f32_bf16 v51, v59, s61, v51
v_dot2_f32_bf16 v25, v31, s61, v25
v_dot2_f32_bf16 v55, v59, v59, v55
s_waitcnt lgkmcnt(8)
v_dot2_f32_bf16 v48, v60, s61, v48
s_waitcnt lgkmcnt(7)
v_dot2_f32_bf16 v24, v32, s61, v24
v_dot2_f32_bf16 v52, v60, v60, v52
v_dot2_f32_bf16 v49, v61, s61, v49
v_dot2_f32_bf16 v25, v33, s61, v25
v_dot2_f32_bf16 v53, v61, v61, v53
v_dot2_f32_bf16 v50, v62, s61, v50
s_waitcnt lgkmcnt(6)
v_dot2_f32_bf16 v24, v34, s61, v24
v_dot2_f32_bf16 v54, v62, v62, v54
v_dot2_f32_bf16 v51, v63, s61, v51
v_dot2_f32_bf16 v25, v35, s61, v25
v_dot2_f32_bf16 v55, v63, v63, v55
s_waitcnt lgkmcnt(5)
v_dot2_f32_bf16 v48, v64, s61, v48
s_waitcnt lgkmcnt(4)
v_dot2_f32_bf16 v24, v36, s61, v24
v_dot2_f32_bf16 v52, v64, v64, v52
v_dot2_f32_bf16 v49, v65, s61, v49
v_dot2_f32_bf16 v25, v37, s61, v25
v_dot2_f32_bf16 v53, v65, v65, v53
v_dot2_f32_bf16 v50, v66, s61, v50
s_waitcnt lgkmcnt(3)
v_dot2_f32_bf16 v24, v38, s61, v24
v_dot2_f32_bf16 v54, v66, v66, v54
v_dot2_f32_bf16 v51, v67, s61, v51
v_dot2_f32_bf16 v25, v39, s61, v25
v_dot2_f32_bf16 v55, v67, v67, v55
s_waitcnt lgkmcnt(2)
v_dot2_f32_bf16 v48, v68, s61, v48
s_waitcnt lgkmcnt(1)
v_dot2_f32_bf16 v24, v40, s61, v24
v_dot2_f32_bf16 v52, v68, v68, v52
v_dot2_f32_bf16 v49, v69, s61, v49
v_dot2_f32_bf16 v25, v41, s61, v25
v_dot2_f32_bf16 v53, v69, v69, v53
v_dot2_f32_bf16 v50, v70, s61, v50
s_waitcnt lgkmcnt(0)
v_dot2_f32_bf16 v24, v42, s61, v24
v_dot2_f32_bf16 v54, v70, v70, v54
v_dot2_f32_bf16 v51, v71, s61, v51
v_dot2_f32_bf16 v25, v43, s61, v25
v_dot2_f32_bf16 v55, v71, v71, v55
s_waitcnt vmcnt(14)
s_barrier
s_mov_b32 m0, 8192
s_mov_b32 s60, 640
buffer_load_dwordx4 v18, s[40:43], s60 offen lds
s_mov_b32 m0, 9216
s_mov_b32 s60, 640
buffer_load_dwordx4 v19, s[40:43], s60 offen lds
s_mov_b32 m0, 10240
s_mov_b32 s60, 640
buffer_load_dwordx4 v20, s[40:43], s60 offen lds
s_mov_b32 m0, 11264
s_mov_b32 s60, 640
buffer_load_dwordx4 v21, s[40:43], s60 offen lds
s_mov_b32 m0, 22528
s_mov_b32 s60, 983040
buffer_load_dwordx4 v15, s[44:47], s60 offen lds
s_mov_b32 m0, 23552
s_mov_b32 s60, 983040
buffer_load_dwordx4 v16, s[44:47], s60 offen lds
s_mov_b32 m0, 24576
s_mov_b32 s60, 983040
buffer_load_dwordx4 v17, s[44:47], s60 offen lds
v_add_u32 v23, 73728, v22
v_add_u32 v9, 65536, v44
ds_read_b128 v[56:59], v9
ds_read_b64_tr_b16 v[28:29], v23 offset:128
ds_read_b64_tr_b16 v[30:31], v23 offset:896
v_add_u32 v10, 65536, v45
ds_read_b128 v[60:63], v10
ds_read_b64_tr_b16 v[32:33], v23 offset:3200
ds_read_b64_tr_b16 v[34:35], v23 offset:3968
v_add_u32 v9, 65536, v46
ds_read_b128 v[64:67], v9
ds_read_b64_tr_b16 v[36:37], v23 offset:6272
ds_read_b64_tr_b16 v[38:39], v23 offset:7040
v_add_u32 v10, 65536, v47
ds_read_b128 v[68:71], v10
ds_read_b64_tr_b16 v[40:41], v23 offset:9344
ds_read_b64_tr_b16 v[42:43], v23 offset:10112
s_waitcnt lgkmcnt(11)
v_dot2_f32_bf16 v48, v56, s61, v48
s_waitcnt lgkmcnt(10)
v_dot2_f32_bf16 v24, v28, s61, v24
v_dot2_f32_bf16 v52, v56, v56, v52
v_dot2_f32_bf16 v49, v57, s61, v49
v_dot2_f32_bf16 v25, v29, s61, v25
v_dot2_f32_bf16 v53, v57, v57, v53
v_dot2_f32_bf16 v50, v58, s61, v50
s_waitcnt lgkmcnt(9)
v_dot2_f32_bf16 v24, v30, s61, v24
v_dot2_f32_bf16 v54, v58, v58, v54
v_dot2_f32_bf16 v51, v59, s61, v51
v_dot2_f32_bf16 v25, v31, s61, v25
v_dot2_f32_bf16 v55, v59, v59, v55
s_waitcnt lgkmcnt(8)
v_dot2_f32_bf16 v48, v60, s61, v48
s_waitcnt lgkmcnt(7)
v_dot2_f32_bf16 v24, v32, s61, v24
v_dot2_f32_bf16 v52, v60, v60, v52
v_dot2_f32_bf16 v49, v61, s61, v49
v_dot2_f32_bf16 v25, v33, s61, v25
v_dot2_f32_bf16 v53, v61, v61, v53
v_dot2_f32_bf16 v50, v62, s61, v50
s_waitcnt lgkmcnt(6)
v_dot2_f32_bf16 v24, v34, s61, v24
v_dot2_f32_bf16 v54, v62, v62, v54
v_dot2_f32_bf16 v51, v63, s61, v51
v_dot2_f32_bf16 v25, v35, s61, v25
v_dot2_f32_bf16 v55, v63, v63, v55
s_waitcnt lgkmcnt(5)
v_dot2_f32_bf16 v48, v64, s61, v48
s_waitcnt lgkmcnt(4)
v_dot2_f32_bf16 v24, v36, s61, v24
v_dot2_f32_bf16 v52, v64, v64, v52
v_dot2_f32_bf16 v49, v65, s61, v49
v_dot2_f32_bf16 v25, v37, s61, v25
v_dot2_f32_bf16 v53, v65, v65, v53
v_dot2_f32_bf16 v50, v66, s61, v50
s_waitcnt lgkmcnt(3)
v_dot2_f32_bf16 v24, v38, s61, v24
v_dot2_f32_bf16 v54, v66, v66, v54
v_dot2_f32_bf16 v51, v67, s61, v51
v_dot2_f32_bf16 v25, v39, s61, v25
v_dot2_f32_bf16 v55, v67, v67, v55
s_waitcnt lgkmcnt(2)
v_dot2_f32_bf16 v48, v68, s61, v48
s_waitcnt lgkmcnt(1)
v_dot2_f32_bf16 v24, v40, s61, v24
v_dot2_f32_bf16 v52, v68, v68, v52
v_dot2_f32_bf16 v49, v69, s61, v49
v_dot2_f32_bf16 v25, v41, s61, v25
v_dot2_f32_bf16 v53, v69, v69, v53
v_dot2_f32_bf16 v50, v70, s61, v50
s_waitcnt lgkmcnt(0)
v_dot2_f32_bf16 v24, v42, s61, v24
v_dot2_f32_bf16 v54, v70, v70, v54
v_dot2_f32_bf16 v51, v71, s61, v51
v_dot2_f32_bf16 v25, v43, s61, v25
v_dot2_f32_bf16 v55, v71, v71, v55
s_waitcnt vmcnt(14)
s_barrier
s_mov_b32 m0, 36864
s_mov_b32 s60, 768
buffer_load_dwordx4 v18, s[40:43], s60 offen lds
s_mov_b32 m0, 37888
s_mov_b32 s60, 768
buffer_load_dwordx4 v19, s[40:43], s60 offen lds
s_mov_b32 m0, 38912
s_mov_b32 s60, 768
buffer_load_dwordx4 v20, s[40:43], s60 offen lds
s_mov_b32 m0, 39936
s_mov_b32 s60, 768
buffer_load_dwordx4 v21, s[40:43], s60 offen lds
s_mov_b32 m0, 51200
s_mov_b32 s60, 1179648
buffer_load_dwordx4 v15, s[44:47], s60 offen lds
s_mov_b32 m0, 52224
s_mov_b32 s60, 1179648
buffer_load_dwordx4 v16, s[44:47], s60 offen lds
s_mov_b32 m0, 53248
s_mov_b32 s60, 1179648
buffer_load_dwordx4 v17, s[44:47], s60 offen lds
v_add_u32 v23, 102400, v22
v_add_u32 v9, 94208, v44
ds_read_b128 v[56:59], v9
ds_read_b64_tr_b16 v[28:29], v23 offset:128
ds_read_b64_tr_b16 v[30:31], v23 offset:896
v_add_u32 v10, 94208, v45
ds_read_b128 v[60:63], v10
ds_read_b64_tr_b16 v[32:33], v23 offset:3200
ds_read_b64_tr_b16 v[34:35], v23 offset:3968
v_add_u32 v9, 94208, v46
ds_read_b128 v[64:67], v9
ds_read_b64_tr_b16 v[36:37], v23 offset:6272
ds_read_b64_tr_b16 v[38:39], v23 offset:7040
v_add_u32 v10, 94208, v47
ds_read_b128 v[68:71], v10
ds_read_b64_tr_b16 v[40:41], v23 offset:9344
ds_read_b64_tr_b16 v[42:43], v23 offset:10112
s_waitcnt lgkmcnt(11)
v_dot2_f32_bf16 v48, v56, s61, v48
s_waitcnt lgkmcnt(10)
v_dot2_f32_bf16 v24, v28, s61, v24
v_dot2_f32_bf16 v52, v56, v56, v52
v_dot2_f32_bf16 v49, v57, s61, v49
v_dot2_f32_bf16 v25, v29, s61, v25
v_dot2_f32_bf16 v53, v57, v57, v53
v_dot2_f32_bf16 v50, v58, s61, v50
s_waitcnt lgkmcnt(9)
v_dot2_f32_bf16 v24, v30, s61, v24
v_dot2_f32_bf16 v54, v58, v58, v54
v_dot2_f32_bf16 v51, v59, s61, v51
v_dot2_f32_bf16 v25, v31, s61, v25
v_dot2_f32_bf16 v55, v59, v59, v55
s_waitcnt lgkmcnt(8)
v_dot2_f32_bf16 v48, v60, s61, v48
s_waitcnt lgkmcnt(7)
v_dot2_f32_bf16 v24, v32, s61, v24
v_dot2_f32_bf16 v52, v60, v60, v52
v_dot2_f32_bf16 v49, v61, s61, v49
v_dot2_f32_bf16 v25, v33, s61, v25
v_dot2_f32_bf16 v53, v61, v61, v53
v_dot2_f32_bf16 v50, v62, s61, v50
s_waitcnt lgkmcnt(6)
v_dot2_f32_bf16 v24, v34, s61, v24
v_dot2_f32_bf16 v54, v62, v62, v54
v_dot2_f32_bf16 v51, v63, s61, v51
v_dot2_f32_bf16 v25, v35, s61, v25
v_dot2_f32_bf16 v55, v63, v63, v55
s_waitcnt lgkmcnt(5)
v_dot2_f32_bf16 v48, v64, s61, v48
s_waitcnt lgkmcnt(4)
v_dot2_f32_bf16 v24, v36, s61, v24
v_dot2_f32_bf16 v52, v64, v64, v52
v_dot2_f32_bf16 v49, v65, s61, v49
v_dot2_f32_bf16 v25, v37, s61, v25
v_dot2_f32_bf16 v53, v65, v65, v53
v_dot2_f32_bf16 v50, v66, s61, v50
s_waitcnt lgkmcnt(3)
v_dot2_f32_bf16 v24, v38, s61, v24
v_dot2_f32_bf16 v54, v66, v66, v54
v_dot2_f32_bf16 v51, v67, s61, v51
v_dot2_f32_bf16 v25, v39, s61, v25
v_dot2_f32_bf16 v55, v67, v67, v55
s_waitcnt lgkmcnt(2)
v_dot2_f32_bf16 v48, v68, s61, v48
s_waitcnt lgkmcnt(1)
v_dot2_f32_bf16 v24, v40, s61, v24
v_dot2_f32_bf16 v52, v68, v68, v52
v_dot2_f32_bf16 v49, v69, s61, v49
v_dot2_f32_bf16 v25, v41, s61, v25
v_dot2_f32_bf16 v53, v69, v69, v53
v_dot2_f32_bf16 v50, v70, s61, v50
s_waitcnt lgkmcnt(0)
v_dot2_f32_bf16 v24, v42, s61, v24
v_dot2_f32_bf16 v54, v70, v70, v54
v_dot2_f32_bf16 v51, v71, s61, v51
v_dot2_f32_bf16 v25, v43, s61, v25
v_dot2_f32_bf16 v55, v71, v71, v55
s_waitcnt vmcnt(14)
s_barrier
s_mov_b32 m0, 65536
s_mov_b32 s60, 896
buffer_load_dwordx4 v18, s[40:43], s60 offen lds
s_mov_b32 m0, 66560
s_mov_b32 s60, 896
buffer_load_dwordx4 v19, s[40:43], s60 offen lds
s_mov_b32 m0, 67584
s_mov_b32 s60, 896
buffer_load_dwordx4 v20, s[40:43], s60 offen lds
s_mov_b32 m0, 68608
s_mov_b32 s60, 896
buffer_load_dwordx4 v21, s[40:43], s60 offen lds
s_mov_b32 m0, 79872
s_mov_b32 s60, 1376256
buffer_load_dwordx4 v15, s[44:47], s60 offen lds
s_mov_b32 m0, 80896
s_mov_b32 s60, 1376256
buffer_load_dwordx4 v16, s[44:47], s60 offen lds
s_mov_b32 m0, 81920
s_mov_b32 s60, 1376256
buffer_load_dwordx4 v17, s[44:47], s60 offen lds
v_add_u32 v23, 131072, v22
v_add_u32 v9, 122880, v44
ds_read_b128 v[56:59], v9
ds_read_b64_tr_b16 v[28:29], v23 offset:128
ds_read_b64_tr_b16 v[30:31], v23 offset:896
v_add_u32 v10, 122880, v45
ds_read_b128 v[60:63], v10
ds_read_b64_tr_b16 v[32:33], v23 offset:3200
ds_read_b64_tr_b16 v[34:35], v23 offset:3968
v_add_u32 v9, 122880, v46
ds_read_b128 v[64:67], v9
ds_read_b64_tr_b16 v[36:37], v23 offset:6272
ds_read_b64_tr_b16 v[38:39], v23 offset:7040
v_add_u32 v10, 122880, v47
ds_read_b128 v[68:71], v10
ds_read_b64_tr_b16 v[40:41], v23 offset:9344
ds_read_b64_tr_b16 v[42:43], v23 offset:10112
s_waitcnt lgkmcnt(11)
v_dot2_f32_bf16 v48, v56, s61, v48
s_waitcnt lgkmcnt(10)
v_dot2_f32_bf16 v24, v28, s61, v24
v_dot2_f32_bf16 v52, v56, v56, v52
v_dot2_f32_bf16 v49, v57, s61, v49
v_dot2_f32_bf16 v25, v29, s61, v25
v_dot2_f32_bf16 v53, v57, v57, v53
v_dot2_f32_bf16 v50, v58, s61, v50
s_waitcnt lgkmcnt(9)
v_dot2_f32_bf16 v24, v30, s61, v24
v_dot2_f32_bf16 v54, v58, v58, v54
v_dot2_f32_bf16 v51, v59, s61, v51
v_dot2_f32_bf16 v25, v31, s61, v25
v_dot2_f32_bf16 v55, v59, v59, v55
s_waitcnt lgkmcnt(8)
v_dot2_f32_bf16 v48, v60, s61, v48
s_waitcnt lgkmcnt(7)
v_dot2_f32_bf16 v24, v32, s61, v24
v_dot2_f32_bf16 v52, v60, v60, v52
v_dot2_f32_bf16 v49, v61, s61, v49
v_dot2_f32_bf16 v25, v33, s61, v25
v_dot2_f32_bf16 v53, v61, v61, v53
v_dot2_f32_bf16 v50, v62, s61, v50
s_waitcnt lgkmcnt(6)
v_dot2_f32_bf16 v24, v34, s61, v24
v_dot2_f32_bf16 v54, v62, v62, v54
v_dot2_f32_bf16 v51, v63, s61, v51
v_dot2_f32_bf16 v25, v35, s61, v25
v_dot2_f32_bf16 v55, v63, v63, v55
s_waitcnt lgkmcnt(5)
v_dot2_f32_bf16 v48, v64, s61, v48
s_waitcnt lgkmcnt(4)
v_dot2_f32_bf16 v24, v36, s61, v24
v_dot2_f32_bf16 v52, v64, v64, v52
v_dot2_f32_bf16 v49, v65, s61, v49
v_dot2_f32_bf16 v25, v37, s61, v25
v_dot2_f32_bf16 v53, v65, v65, v53
v_dot2_f32_bf16 v50, v66, s61, v50
s_waitcnt lgkmcnt(3)
v_dot2_f32_bf16 v24, v38, s61, v24
v_dot2_f32_bf16 v54, v66, v66, v54
v_dot2_f32_bf16 v51, v67, s61, v51
v_dot2_f32_bf16 v25, v39, s61, v25
v_dot2_f32_bf16 v55, v67, v67, v55
s_waitcnt lgkmcnt(2)
v_dot2_f32_bf16 v48, v68, s61, v48
s_waitcnt lgkmcnt(1)
v_dot2_f32_bf16 v24, v40, s61, v24
v_dot2_f32_bf16 v52, v68, v68, v52
v_dot2_f32_bf16 v49, v69, s61, v49
v_dot2_f32_bf16 v25, v41, s61, v25
v_dot2_f32_bf16 v53, v69, v69, v53
v_dot2_f32_bf16 v50, v70, s61, v50
s_waitcnt lgkmcnt(0)
v_dot2_f32_bf16 v24, v42, s61, v24
v_dot2_f32_bf16 v54, v70, v70, v54
v_dot2_f32_bf16 v51, v71, s61, v51
v_dot2_f32_bf16 v25, v43, s61, v25
v_dot2_f32_bf16 v55, v71, v71, v55
s_waitcnt vmcnt(14)
s_barrier
v_add_u32 v23, 16384, v22
ds_read_b128 v[56:59], v44 offset:8192
ds_read_b64_tr_b16 v[28:29], v23 offset:128
ds_read_b64_tr_b16 v[30:31], v23 offset:896
ds_read_b128 v[60:63], v45 offset:8192
ds_read_b64_tr_b16 v[32:33], v23 offset:3200
ds_read_b64_tr_b16 v[34:35], v23 offset:3968
ds_read_b128 v[64:67], v46 offset:8192
ds_read_b64_tr_b16 v[36:37], v23 offset:6272
ds_read_b64_tr_b16 v[38:39], v23 offset:7040
ds_read_b128 v[68:71], v47 offset:8192
ds_read_b64_tr_b16 v[40:41], v23 offset:9344
ds_read_b64_tr_b16 v[42:43], v23 offset:10112
s_waitcnt lgkmcnt(11)
v_dot2_f32_bf16 v48, v56, s61, v48
s_waitcnt lgkmcnt(10)
v_dot2_f32_bf16 v24, v28, s61, v24
v_dot2_f32_bf16 v52, v56, v56, v52
v_dot2_f32_bf16 v49, v57, s61, v49
v_dot2_f32_bf16 v25, v29, s61, v25
v_dot2_f32_bf16 v53, v57, v57, v53
v_dot2_f32_bf16 v50, v58, s61, v50
s_waitcnt lgkmcnt(9)
v_dot2_f32_bf16 v24, v30, s61, v24
v_dot2_f32_bf16 v54, v58, v58, v54
v_dot2_f32_bf16 v51, v59, s61, v51
v_dot2_f32_bf16 v25, v31, s61, v25
v_dot2_f32_bf16 v55, v59, v59, v55
s_waitcnt lgkmcnt(8)
v_dot2_f32_bf16 v48, v60, s61, v48
s_waitcnt lgkmcnt(7)
v_dot2_f32_bf16 v24, v32, s61, v24
v_dot2_f32_bf16 v52, v60, v60, v52
v_dot2_f32_bf16 v49, v61, s61, v49
v_dot2_f32_bf16 v25, v33, s61, v25
v_dot2_f32_bf16 v53, v61, v61, v53
v_dot2_f32_bf16 v50, v62, s61, v50
s_waitcnt lgkmcnt(6)
v_dot2_f32_bf16 v24, v34, s61, v24
v_dot2_f32_bf16 v54, v62, v62, v54
v_dot2_f32_bf16 v51, v63, s61, v51
v_dot2_f32_bf16 v25, v35, s61, v25
v_dot2_f32_bf16 v55, v63, v63, v55
s_waitcnt lgkmcnt(5)
v_dot2_f32_bf16 v48, v64, s61, v48
s_waitcnt lgkmcnt(4)
v_dot2_f32_bf16 v24, v36, s61, v24
v_dot2_f32_bf16 v52, v64, v64, v52
v_dot2_f32_bf16 v49, v65, s61, v49
v_dot2_f32_bf16 v25, v37, s61, v25
v_dot2_f32_bf16 v53, v65, v65, v53
v_dot2_f32_bf16 v50, v66, s61, v50
s_waitcnt lgkmcnt(3)
v_dot2_f32_bf16 v24, v38, s61, v24
v_dot2_f32_bf16 v54, v66, v66, v54
v_dot2_f32_bf16 v51, v67, s61, v51
v_dot2_f32_bf16 v25, v39, s61, v25
v_dot2_f32_bf16 v55, v67, v67, v55
s_waitcnt lgkmcnt(2)
v_dot2_f32_bf16 v48, v68, s61, v48
s_waitcnt lgkmcnt(1)
v_dot2_f32_bf16 v24, v40, s61, v24
v_dot2_f32_bf16 v52, v68, v68, v52
v_dot2_f32_bf16 v49, v69, s61, v49
v_dot2_f32_bf16 v25, v41, s61, v25
v_dot2_f32_bf16 v53, v69, v69, v53
v_dot2_f32_bf16 v50, v70, s61, v50
s_waitcnt lgkmcnt(0)
v_dot2_f32_bf16 v24, v42, s61, v24
v_dot2_f32_bf16 v54, v70, v70, v54
v_dot2_f32_bf16 v51, v71, s61, v51
v_dot2_f32_bf16 v25, v43, s61, v25
v_dot2_f32_bf16 v55, v71, v71, v55
s_waitcnt vmcnt(7)
s_barrier
v_add_u32 v23, 45056, v22
ds_read_b128 v[56:59], v44 offset:36864
ds_read_b64_tr_b16 v[28:29], v23 offset:128
ds_read_b64_tr_b16 v[30:31], v23 offset:896
ds_read_b128 v[60:63], v45 offset:36864
ds_read_b64_tr_b16 v[32:33], v23 offset:3200
ds_read_b64_tr_b16 v[34:35], v23 offset:3968
ds_read_b128 v[64:67], v46 offset:36864
ds_read_b64_tr_b16 v[36:37], v23 offset:6272
ds_read_b64_tr_b16 v[38:39], v23 offset:7040
ds_read_b128 v[68:71], v47 offset:36864
ds_read_b64_tr_b16 v[40:41], v23 offset:9344
ds_read_b64_tr_b16 v[42:43], v23 offset:10112
s_waitcnt lgkmcnt(11)
v_dot2_f32_bf16 v48, v56, s61, v48
s_waitcnt lgkmcnt(10)
v_dot2_f32_bf16 v24, v28, s61, v24
v_dot2_f32_bf16 v52, v56, v56, v52
v_dot2_f32_bf16 v49, v57, s61, v49
v_dot2_f32_bf16 v25, v29, s61, v25
v_dot2_f32_bf16 v53, v57, v57, v53
v_dot2_f32_bf16 v50, v58, s61, v50
s_waitcnt lgkmcnt(9)
v_dot2_f32_bf16 v24, v30, s61, v24
v_dot2_f32_bf16 v54, v58, v58, v54
v_dot2_f32_bf16 v51, v59, s61, v51
v_dot2_f32_bf16 v25, v31, s61, v25
v_dot2_f32_bf16 v55, v59, v59, v55
s_waitcnt lgkmcnt(8)
v_dot2_f32_bf16 v48, v60, s61, v48
s_waitcnt lgkmcnt(7)
v_dot2_f32_bf16 v24, v32, s61, v24
v_dot2_f32_bf16 v52, v60, v60, v52
v_dot2_f32_bf16 v49, v61, s61, v49
v_dot2_f32_bf16 v25, v33, s61, v25
v_dot2_f32_bf16 v53, v61, v61, v53
v_dot2_f32_bf16 v50, v62, s61, v50
s_waitcnt lgkmcnt(6)
v_dot2_f32_bf16 v24, v34, s61, v24
v_dot2_f32_bf16 v54, v62, v62, v54
v_dot2_f32_bf16 v51, v63, s61, v51
v_dot2_f32_bf16 v25, v35, s61, v25
v_dot2_f32_bf16 v55, v63, v63, v55
s_waitcnt lgkmcnt(5)
v_dot2_f32_bf16 v48, v64, s61, v48
s_waitcnt lgkmcnt(4)
v_dot2_f32_bf16 v24, v36, s61, v24
v_dot2_f32_bf16 v52, v64, v64, v52
v_dot2_f32_bf16 v49, v65, s61, v49
v_dot2_f32_bf16 v25, v37, s61, v25
v_dot2_f32_bf16 v53, v65, v65, v53
v_dot2_f32_bf16 v50, v66, s61, v50
s_waitcnt lgkmcnt(3)
v_dot2_f32_bf16 v24, v38, s61, v24
v_dot2_f32_bf16 v54, v66, v66, v54
v_dot2_f32_bf16 v51, v67, s61, v51
v_dot2_f32_bf16 v25, v39, s61, v25
v_dot2_f32_bf16 v55, v67, v67, v55
s_waitcnt lgkmcnt(2)
v_dot2_f32_bf16 v48, v68, s61, v48
s_waitcnt lgkmcnt(1)
v_dot2_f32_bf16 v24, v40, s61, v24
v_dot2_f32_bf16 v52, v68, v68, v52
v_dot2_f32_bf16 v49, v69, s61, v49
v_dot2_f32_bf16 v25, v41, s61, v25
v_dot2_f32_bf16 v53, v69, v69, v53
v_dot2_f32_bf16 v50, v70, s61, v50
s_waitcnt lgkmcnt(0)
v_dot2_f32_bf16 v24, v42, s61, v24
v_dot2_f32_bf16 v54, v70, v70, v54
v_dot2_f32_bf16 v51, v71, s61, v51
v_dot2_f32_bf16 v25, v43, s61, v25
v_dot2_f32_bf16 v55, v71, v71, v55
s_waitcnt vmcnt(0)
s_barrier
v_add_u32 v23, 73728, v22
v_add_u32 v9, 65536, v44
ds_read_b128 v[56:59], v9
ds_read_b64_tr_b16 v[28:29], v23 offset:128
ds_read_b64_tr_b16 v[30:31], v23 offset:896
v_add_u32 v10, 65536, v45
ds_read_b128 v[60:63], v10
ds_read_b64_tr_b16 v[32:33], v23 offset:3200
ds_read_b64_tr_b16 v[34:35], v23 offset:3968
v_add_u32 v9, 65536, v46
ds_read_b128 v[64:67], v9
ds_read_b64_tr_b16 v[36:37], v23 offset:6272
ds_read_b64_tr_b16 v[38:39], v23 offset:7040
v_add_u32 v10, 65536, v47
ds_read_b128 v[68:71], v10
ds_read_b64_tr_b16 v[40:41], v23 offset:9344
ds_read_b64_tr_b16 v[42:43], v23 offset:10112
s_waitcnt lgkmcnt(11)
v_dot2_f32_bf16 v48, v56, s61, v48
s_waitcnt lgkmcnt(10)
v_dot2_f32_bf16 v24, v28, s61, v24
v_dot2_f32_bf16 v52, v56, v56, v52
v_dot2_f32_bf16 v49, v57, s61, v49
v_dot2_f32_bf16 v25, v29, s61, v25
v_dot2_f32_bf16 v53, v57, v57, v53
v_dot2_f32_bf16 v50, v58, s61, v50
s_waitcnt lgkmcnt(9)
v_dot2_f32_bf16 v24, v30, s61, v24
v_dot2_f32_bf16 v54, v58, v58, v54
v_dot2_f32_bf16 v51, v59, s61, v51
v_dot2_f32_bf16 v25, v31, s61, v25
v_dot2_f32_bf16 v55, v59, v59, v55
s_waitcnt lgkmcnt(8)
v_dot2_f32_bf16 v48, v60, s61, v48
s_waitcnt lgkmcnt(7)
v_dot2_f32_bf16 v24, v32, s61, v24
v_dot2_f32_bf16 v52, v60, v60, v52
v_dot2_f32_bf16 v49, v61, s61, v49
v_dot2_f32_bf16 v25, v33, s61, v25
v_dot2_f32_bf16 v53, v61, v61, v53
v_dot2_f32_bf16 v50, v62, s61, v50
s_waitcnt lgkmcnt(6)
v_dot2_f32_bf16 v24, v34, s61, v24
v_dot2_f32_bf16 v54, v62, v62, v54
v_dot2_f32_bf16 v51, v63, s61, v51
v_dot2_f32_bf16 v25, v35, s61, v25
v_dot2_f32_bf16 v55, v63, v63, v55
s_waitcnt lgkmcnt(5)
v_dot2_f32_bf16 v48, v64, s61, v48
s_waitcnt lgkmcnt(4)
v_dot2_f32_bf16 v24, v36, s61, v24
v_dot2_f32_bf16 v52, v64, v64, v52
v_dot2_f32_bf16 v49, v65, s61, v49
v_dot2_f32_bf16 v25, v37, s61, v25
v_dot2_f32_bf16 v53, v65, v65, v53
v_dot2_f32_bf16 v50, v66, s61, v50
s_waitcnt lgkmcnt(3)
v_dot2_f32_bf16 v24, v38, s61, v24
v_dot2_f32_bf16 v54, v66, v66, v54
v_dot2_f32_bf16 v51, v67, s61, v51
v_dot2_f32_bf16 v25, v39, s61, v25
v_dot2_f32_bf16 v55, v67, v67, v55
s_waitcnt lgkmcnt(2)
v_dot2_f32_bf16 v48, v68, s61, v48
s_waitcnt lgkmcnt(1)
v_dot2_f32_bf16 v24, v40, s61, v24
v_dot2_f32_bf16 v52, v68, v68, v52
v_dot2_f32_bf16 v49, v69, s61, v49
v_dot2_f32_bf16 v25, v41, s61, v25
v_dot2_f32_bf16 v53, v69, v69, v53
v_dot2_f32_bf16 v50, v70, s61, v50
s_waitcnt lgkmcnt(0)
v_dot2_f32_bf16 v24, v42, s61, v24
v_dot2_f32_bf16 v54, v70, v70, v54
v_dot2_f32_bf16 v51, v71, s61, v51
v_dot2_f32_bf16 v25, v43, s61, v25
v_dot2_f32_bf16 v55, v71, v71, v55
v_and_b32 v9, 31, v1
v_lshlrev_b32 v10, 2, v9
v_add_u32 v10, 0, v10
v_lshlrev_b32 v11, 3, v9
v_add_u32 v11, 2560, v11
v_add_f32 v24, v24, v25
v_mov_b32 v74, v24
v_mov_b32 v75, v24
s_nop 1
v_permlane32_swap_b32 v74, v75
v_add_f32 v24, v74, v75
v_add_f32 v48, v48, v49
v_add_f32 v50, v50, v51
v_add_f32 v52, v52, v53
v_add_f32 v54, v54, v55
v_add_f32 v72, v48, v50
v_add_f32 v73, v52, v54
v_mov_b32 v74, v72
v_mov_b32 v75, v72
s_nop 1
v_permlane32_swap_b32 v74, v75
v_add_f32 v72, v74, v75
v_mov_b32 v76, v73
v_mov_b32 v77, v73
s_nop 1
v_permlane32_swap_b32 v76, v77
v_add_f32 v73, v76, v77
v_mul_f32 v72, 0x3b000000, v72
v_mul_f32 v73, 0x3b000000, v73
v_fma_f32 v73, -v72, v72, v73
v_max_f32 v73, 0, v73
v_cvt_pk_bf16_f32 v72, v72, v72
v_cvt_pk_bf16_f32 v73, v73, v73
v_lshlrev_b32 v72, 16, v72
v_lshlrev_b32 v73, 16, v73
v_add_f32 v73, 0x3727c5ac, v73
v_cvt_pk_bf16_f32 v73, v73, v73
v_lshlrev_b32 v73, 16, v73
v_sqrt_f32 v73, v73
s_nop 0
v_cvt_pk_bf16_f32 v73, v73, v73
v_lshlrev_b32 v73, 16, v73
v_rcp_f32 v73, v73
v_sub_f32 v72, 0, v72
s_mov_b64 exec, 0xffffffff
ds_write_b32 v10, v24 offset:256
ds_write_b64 v11, v[72:73]
s_mov_b64 exec, -1
s_waitcnt lgkmcnt(0)
s_barrier
s_branch k1_kernel_end
k1_kernel_w7:
v_add_u32 v9, 576, v1
s_mov_b32 s7, 5462
v_mul_lo_u32 v10, v9, s7
v_lshrrev_b32 v10, 16, v10
v_mul_u32_u24 v11, 12, v10
v_sub_u32 v11, v9, v11
v_lshlrev_b32 v11, 4, v11
s_mov_b32 s7, 3072
v_mul_lo_u32 v10, v10, s7
v_add_u32 v15, v10, v11
v_add_u32 v9, 640, v1
s_mov_b32 s7, 5462
v_mul_lo_u32 v10, v9, s7
v_lshrrev_b32 v10, 16, v10
v_mul_u32_u24 v11, 12, v10
v_sub_u32 v11, v9, v11
v_lshlrev_b32 v11, 4, v11
s_mov_b32 s7, 3072
v_mul_lo_u32 v10, v10, s7
v_add_u32 v16, v10, v11
v_add_u32 v9, 704, v1
s_mov_b32 s7, 5462
v_mul_lo_u32 v10, v9, s7
v_lshrrev_b32 v10, 16, v10
v_mul_u32_u24 v11, 12, v10
v_sub_u32 v11, v9, v11
v_lshlrev_b32 v11, 4, v11
s_mov_b32 s7, 3072
v_mul_lo_u32 v10, v10, s7
v_add_u32 v17, v10, v11
v_lshrrev_b32 v9, 4, v1
v_add_u32 v9, 0, v9
v_and_b32 v9, 7, v9
v_and_b32 v10, 7, v1
v_xor_b32 v9, v9, v10
v_lshlrev_b32 v9, 4, v9
v_lshrrev_b32 v10, 3, v1
v_add_u32 v10, 96, v10
v_lshl_add_u32 v18, v10, 10, v9
v_lshrrev_b32 v9, 4, v1
v_add_u32 v9, 4, v9
v_and_b32 v9, 7, v9
v_and_b32 v10, 7, v1
v_xor_b32 v9, v9, v10
v_lshlrev_b32 v9, 4, v9
v_lshrrev_b32 v10, 3, v1
v_add_u32 v10, 104, v10
v_lshl_add_u32 v19, v10, 10, v9
v_lshrrev_b32 v9, 4, v1
v_add_u32 v9, 8, v9
v_and_b32 v9, 7, v9
v_and_b32 v10, 7, v1
v_xor_b32 v9, v9, v10
v_lshlrev_b32 v9, 4, v9
v_lshrrev_b32 v10, 3, v1
v_add_u32 v10, 112, v10
v_lshl_add_u32 v20, v10, 10, v9
v_lshrrev_b32 v9, 4, v1
v_add_u32 v9, 12, v9
v_and_b32 v9, 7, v9
v_and_b32 v10, 7, v1
v_xor_b32 v9, v9, v10
v_lshlrev_b32 v9, 4, v9
v_lshrrev_b32 v10, 3, v1
v_add_u32 v10, 120, v10
v_lshl_add_u32 v21, v10, 10, v9
s_mov_b32 m0, 12288
s_mov_b32 s60, 0
buffer_load_dwordx4 v18, s[40:43], s60 offen lds
s_mov_b32 m0, 13312
s_mov_b32 s60, 0
buffer_load_dwordx4 v19, s[40:43], s60 offen lds
s_mov_b32 m0, 14336
s_mov_b32 s60, 0
buffer_load_dwordx4 v20, s[40:43], s60 offen lds
s_mov_b32 m0, 15360
s_mov_b32 s60, 0
buffer_load_dwordx4 v21, s[40:43], s60 offen lds
s_mov_b32 m0, 25600
s_mov_b32 s60, 0
buffer_load_dwordx4 v15, s[44:47], s60 offen lds
s_mov_b32 m0, 26624
s_mov_b32 s60, 0
buffer_load_dwordx4 v16, s[44:47], s60 offen lds
s_mov_b32 m0, 27648
s_mov_b32 s60, 0
buffer_load_dwordx4 v17, s[44:47], s60 offen lds
s_mov_b32 m0, 40960
s_mov_b32 s60, 128
buffer_load_dwordx4 v18, s[40:43], s60 offen lds
s_mov_b32 m0, 41984
s_mov_b32 s60, 128
buffer_load_dwordx4 v19, s[40:43], s60 offen lds
s_mov_b32 m0, 43008
s_mov_b32 s60, 128
buffer_load_dwordx4 v20, s[40:43], s60 offen lds
s_mov_b32 m0, 44032
s_mov_b32 s60, 128
buffer_load_dwordx4 v21, s[40:43], s60 offen lds
s_mov_b32 m0, 54272
s_mov_b32 s60, 196608
buffer_load_dwordx4 v15, s[44:47], s60 offen lds
s_mov_b32 m0, 55296
s_mov_b32 s60, 196608
buffer_load_dwordx4 v16, s[44:47], s60 offen lds
s_mov_b32 m0, 56320
s_mov_b32 s60, 196608
buffer_load_dwordx4 v17, s[44:47], s60 offen lds
s_mov_b32 m0, 69632
s_mov_b32 s60, 256
buffer_load_dwordx4 v18, s[40:43], s60 offen lds
s_mov_b32 m0, 70656
s_mov_b32 s60, 256
buffer_load_dwordx4 v19, s[40:43], s60 offen lds
s_mov_b32 m0, 71680
s_mov_b32 s60, 256
buffer_load_dwordx4 v20, s[40:43], s60 offen lds
s_mov_b32 m0, 72704
s_mov_b32 s60, 256
buffer_load_dwordx4 v21, s[40:43], s60 offen lds
s_mov_b32 m0, 82944
s_mov_b32 s60, 393216
buffer_load_dwordx4 v15, s[44:47], s60 offen lds
s_mov_b32 m0, 83968
s_mov_b32 s60, 393216
buffer_load_dwordx4 v16, s[44:47], s60 offen lds
s_mov_b32 m0, 84992
s_mov_b32 s60, 393216
buffer_load_dwordx4 v17, s[44:47], s60 offen lds
s_mov_b32 m0, 98304
s_mov_b32 s60, 384
buffer_load_dwordx4 v18, s[40:43], s60 offen lds
s_mov_b32 m0, 99328
s_mov_b32 s60, 384
buffer_load_dwordx4 v19, s[40:43], s60 offen lds
s_mov_b32 m0, 100352
s_mov_b32 s60, 384
buffer_load_dwordx4 v20, s[40:43], s60 offen lds
s_mov_b32 m0, 101376
s_mov_b32 s60, 384
buffer_load_dwordx4 v21, s[40:43], s60 offen lds
s_mov_b32 m0, 111616
s_mov_b32 s60, 589824
buffer_load_dwordx4 v15, s[44:47], s60 offen lds
s_mov_b32 m0, 112640
s_mov_b32 s60, 589824
buffer_load_dwordx4 v16, s[44:47], s60 offen lds
s_mov_b32 m0, 113664
s_mov_b32 s60, 589824
buffer_load_dwordx4 v17, s[44:47], s60 offen lds
s_mov_b32 m0, 126976
s_mov_b32 s60, 512
buffer_load_dwordx4 v18, s[40:43], s60 offen lds
s_mov_b32 m0, 128000
s_mov_b32 s60, 512
buffer_load_dwordx4 v19, s[40:43], s60 offen lds
s_mov_b32 m0, 129024
s_mov_b32 s60, 512
buffer_load_dwordx4 v20, s[40:43], s60 offen lds
s_mov_b32 m0, 130048
s_mov_b32 s60, 512
buffer_load_dwordx4 v21, s[40:43], s60 offen lds
s_mov_b32 m0, 140288
s_mov_b32 s60, 786432
buffer_load_dwordx4 v15, s[44:47], s60 offen lds
s_mov_b32 m0, 141312
s_mov_b32 s60, 786432
buffer_load_dwordx4 v16, s[44:47], s60 offen lds
s_mov_b32 m0, 142336
s_mov_b32 s60, 786432
buffer_load_dwordx4 v17, s[44:47], s60 offen lds
v_mul_u32_u24 v9, 192, v7
v_lshl_add_u32 v9, v8, 3, v9
v_mul_u32_u24 v10, 32, v6
v_add_u32 v22, v9, v10
v_and_b32 v9, 31, v1
v_bfe_u32 v10, v1, 1, 3
v_add_u32 v11, 0, v5
v_xor_b32 v10, v10, v11
v_lshlrev_b32 v10, 4, v10
v_lshl_add_u32 v24, v9, 7, v10
v_and_b32 v9, 31, v1
v_bfe_u32 v10, v1, 1, 3
v_add_u32 v11, 2, v5
v_xor_b32 v10, v10, v11
v_lshlrev_b32 v10, 4, v10
v_lshl_add_u32 v25, v9, 7, v10
v_and_b32 v9, 31, v1
v_bfe_u32 v10, v1, 1, 3
v_add_u32 v11, 4, v5
v_xor_b32 v10, v10, v11
v_lshlrev_b32 v10, 4, v10
v_lshl_add_u32 v26, v9, 7, v10
v_and_b32 v9, 31, v1
v_bfe_u32 v10, v1, 1, 3
v_add_u32 v11, 6, v5
v_xor_b32 v10, v10, v11
v_lshlrev_b32 v10, 4, v10
v_lshl_add_u32 v27, v9, 7, v10
v_mov_b32 v28, 0
v_mov_b32 v29, 0
v_mov_b32 v30, 0
v_mov_b32 v31, 0
v_mov_b32 v32, 0
v_mov_b32 v33, 0
v_mov_b32 v34, 0
v_mov_b32 v35, 0
s_waitcnt vmcnt(28)
s_barrier
v_add_u32 v23, 16384, v22
ds_read_b128 v[36:39], v24 offset:12288
ds_read_b128 v[40:43], v25 offset:12288
ds_read_b128 v[44:47], v26 offset:12288
ds_read_b128 v[48:51], v27 offset:12288
s_waitcnt lgkmcnt(3)
v_dot2_f32_bf16 v28, v36, s61, v28
v_dot2_f32_bf16 v32, v36, v36, v32
v_dot2_f32_bf16 v29, v37, s61, v29
v_dot2_f32_bf16 v33, v37, v37, v33
v_dot2_f32_bf16 v30, v38, s61, v30
v_dot2_f32_bf16 v34, v38, v38, v34
v_dot2_f32_bf16 v31, v39, s61, v31
v_dot2_f32_bf16 v35, v39, v39, v35
s_waitcnt lgkmcnt(2)
v_dot2_f32_bf16 v28, v40, s61, v28
v_dot2_f32_bf16 v32, v40, v40, v32
v_dot2_f32_bf16 v29, v41, s61, v29
v_dot2_f32_bf16 v33, v41, v41, v33
v_dot2_f32_bf16 v30, v42, s61, v30
v_dot2_f32_bf16 v34, v42, v42, v34
v_dot2_f32_bf16 v31, v43, s61, v31
v_dot2_f32_bf16 v35, v43, v43, v35
s_waitcnt lgkmcnt(1)
v_dot2_f32_bf16 v28, v44, s61, v28
v_dot2_f32_bf16 v32, v44, v44, v32
v_dot2_f32_bf16 v29, v45, s61, v29
v_dot2_f32_bf16 v33, v45, v45, v33
v_dot2_f32_bf16 v30, v46, s61, v30
v_dot2_f32_bf16 v34, v46, v46, v34
v_dot2_f32_bf16 v31, v47, s61, v31
v_dot2_f32_bf16 v35, v47, v47, v35
s_waitcnt lgkmcnt(0)
v_dot2_f32_bf16 v28, v48, s61, v28
v_dot2_f32_bf16 v32, v48, v48, v32
v_dot2_f32_bf16 v29, v49, s61, v29
v_dot2_f32_bf16 v33, v49, v49, v33
v_dot2_f32_bf16 v30, v50, s61, v30
v_dot2_f32_bf16 v34, v50, v50, v34
v_dot2_f32_bf16 v31, v51, s61, v31
v_dot2_f32_bf16 v35, v51, v51, v35
s_waitcnt vmcnt(21)
s_barrier
v_add_u32 v23, 45056, v22
ds_read_b128 v[36:39], v24 offset:40960
ds_read_b128 v[40:43], v25 offset:40960
ds_read_b128 v[44:47], v26 offset:40960
ds_read_b128 v[48:51], v27 offset:40960
s_waitcnt lgkmcnt(3)
v_dot2_f32_bf16 v28, v36, s61, v28
v_dot2_f32_bf16 v32, v36, v36, v32
v_dot2_f32_bf16 v29, v37, s61, v29
v_dot2_f32_bf16 v33, v37, v37, v33
v_dot2_f32_bf16 v30, v38, s61, v30
v_dot2_f32_bf16 v34, v38, v38, v34
v_dot2_f32_bf16 v31, v39, s61, v31
v_dot2_f32_bf16 v35, v39, v39, v35
s_waitcnt lgkmcnt(2)
v_dot2_f32_bf16 v28, v40, s61, v28
v_dot2_f32_bf16 v32, v40, v40, v32
v_dot2_f32_bf16 v29, v41, s61, v29
v_dot2_f32_bf16 v33, v41, v41, v33
v_dot2_f32_bf16 v30, v42, s61, v30
v_dot2_f32_bf16 v34, v42, v42, v34
v_dot2_f32_bf16 v31, v43, s61, v31
v_dot2_f32_bf16 v35, v43, v43, v35
s_waitcnt lgkmcnt(1)
v_dot2_f32_bf16 v28, v44, s61, v28
v_dot2_f32_bf16 v32, v44, v44, v32
v_dot2_f32_bf16 v29, v45, s61, v29
v_dot2_f32_bf16 v33, v45, v45, v33
v_dot2_f32_bf16 v30, v46, s61, v30
v_dot2_f32_bf16 v34, v46, v46, v34
v_dot2_f32_bf16 v31, v47, s61, v31
v_dot2_f32_bf16 v35, v47, v47, v35
s_waitcnt lgkmcnt(0)
v_dot2_f32_bf16 v28, v48, s61, v28
v_dot2_f32_bf16 v32, v48, v48, v32
v_dot2_f32_bf16 v29, v49, s61, v29
v_dot2_f32_bf16 v33, v49, v49, v33
v_dot2_f32_bf16 v30, v50, s61, v30
v_dot2_f32_bf16 v34, v50, v50, v34
v_dot2_f32_bf16 v31, v51, s61, v31
v_dot2_f32_bf16 v35, v51, v51, v35
s_waitcnt vmcnt(14)
s_barrier
s_mov_b32 m0, 12288
s_mov_b32 s60, 640
buffer_load_dwordx4 v18, s[40:43], s60 offen lds
s_mov_b32 m0, 13312
s_mov_b32 s60, 640
buffer_load_dwordx4 v19, s[40:43], s60 offen lds
s_mov_b32 m0, 14336
s_mov_b32 s60, 640
buffer_load_dwordx4 v20, s[40:43], s60 offen lds
s_mov_b32 m0, 15360
s_mov_b32 s60, 640
buffer_load_dwordx4 v21, s[40:43], s60 offen lds
s_mov_b32 m0, 25600
s_mov_b32 s60, 983040
buffer_load_dwordx4 v15, s[44:47], s60 offen lds
s_mov_b32 m0, 26624
s_mov_b32 s60, 983040
buffer_load_dwordx4 v16, s[44:47], s60 offen lds
s_mov_b32 m0, 27648
s_mov_b32 s60, 983040
buffer_load_dwordx4 v17, s[44:47], s60 offen lds
v_add_u32 v23, 73728, v22
v_add_u32 v9, 69632, v24
ds_read_b128 v[36:39], v9
v_add_u32 v10, 69632, v25
ds_read_b128 v[40:43], v10
v_add_u32 v9, 69632, v26
ds_read_b128 v[44:47], v9
v_add_u32 v10, 69632, v27
ds_read_b128 v[48:51], v10
s_waitcnt lgkmcnt(3)
v_dot2_f32_bf16 v28, v36, s61, v28
v_dot2_f32_bf16 v32, v36, v36, v32
v_dot2_f32_bf16 v29, v37, s61, v29
v_dot2_f32_bf16 v33, v37, v37, v33
v_dot2_f32_bf16 v30, v38, s61, v30
v_dot2_f32_bf16 v34, v38, v38, v34
v_dot2_f32_bf16 v31, v39, s61, v31
v_dot2_f32_bf16 v35, v39, v39, v35
s_waitcnt lgkmcnt(2)
v_dot2_f32_bf16 v28, v40, s61, v28
v_dot2_f32_bf16 v32, v40, v40, v32
v_dot2_f32_bf16 v29, v41, s61, v29
v_dot2_f32_bf16 v33, v41, v41, v33
v_dot2_f32_bf16 v30, v42, s61, v30
v_dot2_f32_bf16 v34, v42, v42, v34
v_dot2_f32_bf16 v31, v43, s61, v31
v_dot2_f32_bf16 v35, v43, v43, v35
s_waitcnt lgkmcnt(1)
v_dot2_f32_bf16 v28, v44, s61, v28
v_dot2_f32_bf16 v32, v44, v44, v32
v_dot2_f32_bf16 v29, v45, s61, v29
v_dot2_f32_bf16 v33, v45, v45, v33
v_dot2_f32_bf16 v30, v46, s61, v30
v_dot2_f32_bf16 v34, v46, v46, v34
v_dot2_f32_bf16 v31, v47, s61, v31
v_dot2_f32_bf16 v35, v47, v47, v35
s_waitcnt lgkmcnt(0)
v_dot2_f32_bf16 v28, v48, s61, v28
v_dot2_f32_bf16 v32, v48, v48, v32
v_dot2_f32_bf16 v29, v49, s61, v29
v_dot2_f32_bf16 v33, v49, v49, v33
v_dot2_f32_bf16 v30, v50, s61, v30
v_dot2_f32_bf16 v34, v50, v50, v34
v_dot2_f32_bf16 v31, v51, s61, v31
v_dot2_f32_bf16 v35, v51, v51, v35
s_waitcnt vmcnt(14)
s_barrier
s_mov_b32 m0, 40960
s_mov_b32 s60, 768
buffer_load_dwordx4 v18, s[40:43], s60 offen lds
s_mov_b32 m0, 41984
s_mov_b32 s60, 768
buffer_load_dwordx4 v19, s[40:43], s60 offen lds
s_mov_b32 m0, 43008
s_mov_b32 s60, 768
buffer_load_dwordx4 v20, s[40:43], s60 offen lds
s_mov_b32 m0, 44032
s_mov_b32 s60, 768
buffer_load_dwordx4 v21, s[40:43], s60 offen lds
s_mov_b32 m0, 54272
s_mov_b32 s60, 1179648
buffer_load_dwordx4 v15, s[44:47], s60 offen lds
s_mov_b32 m0, 55296
s_mov_b32 s60, 1179648
buffer_load_dwordx4 v16, s[44:47], s60 offen lds
s_mov_b32 m0, 56320
s_mov_b32 s60, 1179648
buffer_load_dwordx4 v17, s[44:47], s60 offen lds
v_add_u32 v23, 102400, v22
v_add_u32 v9, 98304, v24
ds_read_b128 v[36:39], v9
v_add_u32 v10, 98304, v25
ds_read_b128 v[40:43], v10
v_add_u32 v9, 98304, v26
ds_read_b128 v[44:47], v9
v_add_u32 v10, 98304, v27
ds_read_b128 v[48:51], v10
s_waitcnt lgkmcnt(3)
v_dot2_f32_bf16 v28, v36, s61, v28
v_dot2_f32_bf16 v32, v36, v36, v32
v_dot2_f32_bf16 v29, v37, s61, v29
v_dot2_f32_bf16 v33, v37, v37, v33
v_dot2_f32_bf16 v30, v38, s61, v30
v_dot2_f32_bf16 v34, v38, v38, v34
v_dot2_f32_bf16 v31, v39, s61, v31
v_dot2_f32_bf16 v35, v39, v39, v35
s_waitcnt lgkmcnt(2)
v_dot2_f32_bf16 v28, v40, s61, v28
v_dot2_f32_bf16 v32, v40, v40, v32
v_dot2_f32_bf16 v29, v41, s61, v29
v_dot2_f32_bf16 v33, v41, v41, v33
v_dot2_f32_bf16 v30, v42, s61, v30
v_dot2_f32_bf16 v34, v42, v42, v34
v_dot2_f32_bf16 v31, v43, s61, v31
v_dot2_f32_bf16 v35, v43, v43, v35
s_waitcnt lgkmcnt(1)
v_dot2_f32_bf16 v28, v44, s61, v28
v_dot2_f32_bf16 v32, v44, v44, v32
v_dot2_f32_bf16 v29, v45, s61, v29
v_dot2_f32_bf16 v33, v45, v45, v33
v_dot2_f32_bf16 v30, v46, s61, v30
v_dot2_f32_bf16 v34, v46, v46, v34
v_dot2_f32_bf16 v31, v47, s61, v31
v_dot2_f32_bf16 v35, v47, v47, v35
s_waitcnt lgkmcnt(0)
v_dot2_f32_bf16 v28, v48, s61, v28
v_dot2_f32_bf16 v32, v48, v48, v32
v_dot2_f32_bf16 v29, v49, s61, v29
v_dot2_f32_bf16 v33, v49, v49, v33
v_dot2_f32_bf16 v30, v50, s61, v30
v_dot2_f32_bf16 v34, v50, v50, v34
v_dot2_f32_bf16 v31, v51, s61, v31
v_dot2_f32_bf16 v35, v51, v51, v35
s_waitcnt vmcnt(14)
s_barrier
s_mov_b32 m0, 69632
s_mov_b32 s60, 896
buffer_load_dwordx4 v18, s[40:43], s60 offen lds
s_mov_b32 m0, 70656
s_mov_b32 s60, 896
buffer_load_dwordx4 v19, s[40:43], s60 offen lds
s_mov_b32 m0, 71680
s_mov_b32 s60, 896
buffer_load_dwordx4 v20, s[40:43], s60 offen lds
s_mov_b32 m0, 72704
s_mov_b32 s60, 896
buffer_load_dwordx4 v21, s[40:43], s60 offen lds
s_mov_b32 m0, 82944
s_mov_b32 s60, 1376256
buffer_load_dwordx4 v15, s[44:47], s60 offen lds
s_mov_b32 m0, 83968
s_mov_b32 s60, 1376256
buffer_load_dwordx4 v16, s[44:47], s60 offen lds
s_mov_b32 m0, 84992
s_mov_b32 s60, 1376256
buffer_load_dwordx4 v17, s[44:47], s60 offen lds
v_add_u32 v23, 131072, v22
v_add_u32 v9, 126976, v24
ds_read_b128 v[36:39], v9
v_add_u32 v10, 126976, v25
ds_read_b128 v[40:43], v10
v_add_u32 v9, 126976, v26
ds_read_b128 v[44:47], v9
v_add_u32 v10, 126976, v27
ds_read_b128 v[48:51], v10
s_waitcnt lgkmcnt(3)
v_dot2_f32_bf16 v28, v36, s61, v28
v_dot2_f32_bf16 v32, v36, v36, v32
v_dot2_f32_bf16 v29, v37, s61, v29
v_dot2_f32_bf16 v33, v37, v37, v33
v_dot2_f32_bf16 v30, v38, s61, v30
v_dot2_f32_bf16 v34, v38, v38, v34
v_dot2_f32_bf16 v31, v39, s61, v31
v_dot2_f32_bf16 v35, v39, v39, v35
s_waitcnt lgkmcnt(2)
v_dot2_f32_bf16 v28, v40, s61, v28
v_dot2_f32_bf16 v32, v40, v40, v32
v_dot2_f32_bf16 v29, v41, s61, v29
v_dot2_f32_bf16 v33, v41, v41, v33
v_dot2_f32_bf16 v30, v42, s61, v30
v_dot2_f32_bf16 v34, v42, v42, v34
v_dot2_f32_bf16 v31, v43, s61, v31
v_dot2_f32_bf16 v35, v43, v43, v35
s_waitcnt lgkmcnt(1)
v_dot2_f32_bf16 v28, v44, s61, v28
v_dot2_f32_bf16 v32, v44, v44, v32
v_dot2_f32_bf16 v29, v45, s61, v29
v_dot2_f32_bf16 v33, v45, v45, v33
v_dot2_f32_bf16 v30, v46, s61, v30
v_dot2_f32_bf16 v34, v46, v46, v34
v_dot2_f32_bf16 v31, v47, s61, v31
v_dot2_f32_bf16 v35, v47, v47, v35
s_waitcnt lgkmcnt(0)
v_dot2_f32_bf16 v28, v48, s61, v28
v_dot2_f32_bf16 v32, v48, v48, v32
v_dot2_f32_bf16 v29, v49, s61, v29
v_dot2_f32_bf16 v33, v49, v49, v33
v_dot2_f32_bf16 v30, v50, s61, v30
v_dot2_f32_bf16 v34, v50, v50, v34
v_dot2_f32_bf16 v31, v51, s61, v31
v_dot2_f32_bf16 v35, v51, v51, v35
s_waitcnt vmcnt(14)
s_barrier
v_add_u32 v23, 16384, v22
ds_read_b128 v[36:39], v24 offset:12288
ds_read_b128 v[40:43], v25 offset:12288
ds_read_b128 v[44:47], v26 offset:12288
ds_read_b128 v[48:51], v27 offset:12288
s_waitcnt lgkmcnt(3)
v_dot2_f32_bf16 v28, v36, s61, v28
v_dot2_f32_bf16 v32, v36, v36, v32
v_dot2_f32_bf16 v29, v37, s61, v29
v_dot2_f32_bf16 v33, v37, v37, v33
v_dot2_f32_bf16 v30, v38, s61, v30
v_dot2_f32_bf16 v34, v38, v38, v34
v_dot2_f32_bf16 v31, v39, s61, v31
v_dot2_f32_bf16 v35, v39, v39, v35
s_waitcnt lgkmcnt(2)
v_dot2_f32_bf16 v28, v40, s61, v28
v_dot2_f32_bf16 v32, v40, v40, v32
v_dot2_f32_bf16 v29, v41, s61, v29
v_dot2_f32_bf16 v33, v41, v41, v33
v_dot2_f32_bf16 v30, v42, s61, v30
v_dot2_f32_bf16 v34, v42, v42, v34
v_dot2_f32_bf16 v31, v43, s61, v31
v_dot2_f32_bf16 v35, v43, v43, v35
s_waitcnt lgkmcnt(1)
v_dot2_f32_bf16 v28, v44, s61, v28
v_dot2_f32_bf16 v32, v44, v44, v32
v_dot2_f32_bf16 v29, v45, s61, v29
v_dot2_f32_bf16 v33, v45, v45, v33
v_dot2_f32_bf16 v30, v46, s61, v30
v_dot2_f32_bf16 v34, v46, v46, v34
v_dot2_f32_bf16 v31, v47, s61, v31
v_dot2_f32_bf16 v35, v47, v47, v35
s_waitcnt lgkmcnt(0)
v_dot2_f32_bf16 v28, v48, s61, v28
v_dot2_f32_bf16 v32, v48, v48, v32
v_dot2_f32_bf16 v29, v49, s61, v29
v_dot2_f32_bf16 v33, v49, v49, v33
v_dot2_f32_bf16 v30, v50, s61, v30
v_dot2_f32_bf16 v34, v50, v50, v34
v_dot2_f32_bf16 v31, v51, s61, v31
v_dot2_f32_bf16 v35, v51, v51, v35
s_waitcnt vmcnt(7)
s_barrier
v_add_u32 v23, 45056, v22
ds_read_b128 v[36:39], v24 offset:40960
ds_read_b128 v[40:43], v25 offset:40960
ds_read_b128 v[44:47], v26 offset:40960
ds_read_b128 v[48:51], v27 offset:40960
s_waitcnt lgkmcnt(3)
v_dot2_f32_bf16 v28, v36, s61, v28
v_dot2_f32_bf16 v32, v36, v36, v32
v_dot2_f32_bf16 v29, v37, s61, v29
v_dot2_f32_bf16 v33, v37, v37, v33
v_dot2_f32_bf16 v30, v38, s61, v30
v_dot2_f32_bf16 v34, v38, v38, v34
v_dot2_f32_bf16 v31, v39, s61, v31
v_dot2_f32_bf16 v35, v39, v39, v35
s_waitcnt lgkmcnt(2)
v_dot2_f32_bf16 v28, v40, s61, v28
v_dot2_f32_bf16 v32, v40, v40, v32
v_dot2_f32_bf16 v29, v41, s61, v29
v_dot2_f32_bf16 v33, v41, v41, v33
v_dot2_f32_bf16 v30, v42, s61, v30
v_dot2_f32_bf16 v34, v42, v42, v34
v_dot2_f32_bf16 v31, v43, s61, v31
v_dot2_f32_bf16 v35, v43, v43, v35
s_waitcnt lgkmcnt(1)
v_dot2_f32_bf16 v28, v44, s61, v28
v_dot2_f32_bf16 v32, v44, v44, v32
v_dot2_f32_bf16 v29, v45, s61, v29
v_dot2_f32_bf16 v33, v45, v45, v33
v_dot2_f32_bf16 v30, v46, s61, v30
v_dot2_f32_bf16 v34, v46, v46, v34
v_dot2_f32_bf16 v31, v47, s61, v31
v_dot2_f32_bf16 v35, v47, v47, v35
s_waitcnt lgkmcnt(0)
v_dot2_f32_bf16 v28, v48, s61, v28
v_dot2_f32_bf16 v32, v48, v48, v32
v_dot2_f32_bf16 v29, v49, s61, v29
v_dot2_f32_bf16 v33, v49, v49, v33
v_dot2_f32_bf16 v30, v50, s61, v30
v_dot2_f32_bf16 v34, v50, v50, v34
v_dot2_f32_bf16 v31, v51, s61, v31
v_dot2_f32_bf16 v35, v51, v51, v35
s_waitcnt vmcnt(0)
s_barrier
v_add_u32 v23, 73728, v22
v_add_u32 v9, 69632, v24
ds_read_b128 v[36:39], v9
v_add_u32 v10, 69632, v25
ds_read_b128 v[40:43], v10
v_add_u32 v9, 69632, v26
ds_read_b128 v[44:47], v9
v_add_u32 v10, 69632, v27
ds_read_b128 v[48:51], v10
s_waitcnt lgkmcnt(3)
v_dot2_f32_bf16 v28, v36, s61, v28
v_dot2_f32_bf16 v32, v36, v36, v32
v_dot2_f32_bf16 v29, v37, s61, v29
v_dot2_f32_bf16 v33, v37, v37, v33
v_dot2_f32_bf16 v30, v38, s61, v30
v_dot2_f32_bf16 v34, v38, v38, v34
v_dot2_f32_bf16 v31, v39, s61, v31
v_dot2_f32_bf16 v35, v39, v39, v35
s_waitcnt lgkmcnt(2)
v_dot2_f32_bf16 v28, v40, s61, v28
v_dot2_f32_bf16 v32, v40, v40, v32
v_dot2_f32_bf16 v29, v41, s61, v29
v_dot2_f32_bf16 v33, v41, v41, v33
v_dot2_f32_bf16 v30, v42, s61, v30
v_dot2_f32_bf16 v34, v42, v42, v34
v_dot2_f32_bf16 v31, v43, s61, v31
v_dot2_f32_bf16 v35, v43, v43, v35
s_waitcnt lgkmcnt(1)
v_dot2_f32_bf16 v28, v44, s61, v28
v_dot2_f32_bf16 v32, v44, v44, v32
v_dot2_f32_bf16 v29, v45, s61, v29
v_dot2_f32_bf16 v33, v45, v45, v33
v_dot2_f32_bf16 v30, v46, s61, v30
v_dot2_f32_bf16 v34, v46, v46, v34
v_dot2_f32_bf16 v31, v47, s61, v31
v_dot2_f32_bf16 v35, v47, v47, v35
s_waitcnt lgkmcnt(0)
v_dot2_f32_bf16 v28, v48, s61, v28
v_dot2_f32_bf16 v32, v48, v48, v32
v_dot2_f32_bf16 v29, v49, s61, v29
v_dot2_f32_bf16 v33, v49, v49, v33
v_dot2_f32_bf16 v30, v50, s61, v30
v_dot2_f32_bf16 v34, v50, v50, v34
v_dot2_f32_bf16 v31, v51, s61, v31
v_dot2_f32_bf16 v35, v51, v51, v35
v_and_b32 v9, 31, v1
v_lshlrev_b32 v10, 2, v9
v_add_u32 v10, 0, v10
v_lshlrev_b32 v11, 3, v9
v_add_u32 v11, 2816, v11
v_add_f32 v28, v28, v29
v_add_f32 v30, v30, v31
v_add_f32 v32, v32, v33
v_add_f32 v34, v34, v35
v_add_f32 v52, v28, v30
v_add_f32 v53, v32, v34
v_mov_b32 v54, v52
v_mov_b32 v55, v52
s_nop 1
v_permlane32_swap_b32 v54, v55
v_add_f32 v52, v54, v55
v_mov_b32 v56, v53
v_mov_b32 v57, v53
s_nop 1
v_permlane32_swap_b32 v56, v57
v_add_f32 v53, v56, v57
v_mul_f32 v52, 0x3b000000, v52
v_mul_f32 v53, 0x3b000000, v53
v_fma_f32 v53, -v52, v52, v53
v_max_f32 v53, 0, v53
v_cvt_pk_bf16_f32 v52, v52, v52
v_cvt_pk_bf16_f32 v53, v53, v53
v_lshlrev_b32 v52, 16, v52
v_lshlrev_b32 v53, 16, v53
v_add_f32 v53, 0x3727c5ac, v53
v_cvt_pk_bf16_f32 v53, v53, v53
v_lshlrev_b32 v53, 16, v53
v_sqrt_f32 v53, v53
s_nop 0
v_cvt_pk_bf16_f32 v53, v53, v53
v_lshlrev_b32 v53, 16, v53
v_rcp_f32 v53, v53
v_sub_f32 v52, 0, v52
s_mov_b64 exec, 0xffffffff
ds_write_b64 v11, v[52:53]
s_mov_b64 exec, -1
s_waitcnt lgkmcnt(0)
s_barrier
k1_kernel_end:
s_endpgm
.section .rodata,"a"
.p2align 6
.amdhsa_kernel k1_kernel
  .amdhsa_next_free_vgpr 144
  .amdhsa_next_free_sgpr 96
  .amdhsa_accum_offset 144
  .amdhsa_group_segment_fixed_size 0
  .amdhsa_kernarg_size 80
  .amdhsa_user_sgpr_count 2
  .amdhsa_user_sgpr_kernarg_segment_ptr 1
  .amdhsa_system_sgpr_workgroup_id_x 1
.end_amdhsa_kernel
.text
.globl k2_kernel
.p2align 8
.type k2_kernel,@function
k2_kernel:
s_cmp_ge_u32 s2, 256
s_cbranch_scc1 k2_kernel_end
s_load_dwordx16 s[16:31], s[0:1], 0
s_load_dwordx4 s[32:35], s[0:1], 64
v_and_b32 v1, 63, v0
v_lshrrev_b32 v4, 6, v0
s_nop 0
v_readfirstlane_b32 s6, v4
s_and_b32 s7, s2, 7
s_lshr_b32 s8, s2, 3
s_lshl_b32 s9, s7, 2
s_and_b32 s10, s8, 3
s_add_u32 s4, s9, s10
s_lshr_b32 s5, s8, 2
s_lshl_b32 s5, s5, 3
s_add_u32 s5, s5, s6
s_waitcnt lgkmcnt(0)
s_lshl_b32 s7, s4, 16
s_add_u32 s40, s34, s7
s_addc_u32 s41, s35, 0
s_add_u32 s40, s40, 4194304
s_addc_u32 s41, s41, 0
s_and_b32 s41, s41, 0xffff
s_mov_b32 s42, 65536
s_mov_b32 s43, 0x00020000
s_add_u32 s44, s34, s7
s_addc_u32 s45, s35, 0
s_add_u32 s44, s44, 6291456
s_addc_u32 s45, s45, 0
s_and_b32 s45, s45, 0xffff
s_mov_b32 s46, 65536
s_mov_b32 s47, 0x00020000
s_mov_b32 s48, s34
s_mov_b32 s49, s35
s_and_b32 s49, s49, 0xffff
s_mov_b32 s50, 33554432
s_mov_b32 s51, 0x00020000
v_lshlrev_b32 v2, 4, v1
s_lshl_b32 s11, s6, 10
s_lshl_b32 s12, s5, 10
s_add_u32 s12, s12, s7
s_add_u32 s12, s12, 2097152
buffer_load_dwordx4 v[8:11], v2, s[48:51], s12 offen
s_add_u32 s13, s11, 0
s_add_u32 m0, s11, 0
s_nop 0
buffer_load_dwordx4 v2, s[40:43], s13 offen lds
s_add_u32 m0, s11, 65536
s_nop 0
buffer_load_dwordx4 v2, s[44:47], s13 offen lds
s_barrier
s_add_u32 s13, s11, 8192
s_add_u32 m0, s11, 8192
s_nop 0
buffer_load_dwordx4 v2, s[40:43], s13 offen lds
s_add_u32 m0, s11, 73728
s_nop 0
buffer_load_dwordx4 v2, s[44:47], s13 offen lds
s_lshl_b32 s38, s2, 3
s_add_u32 s38, s38, s6
s_cmp_lt_u32 s38, 512
s_cselect_b32 s36, s20, s24
s_cselect_b32 s37, s21, s25
s_cselect_b32 s39, 0, 512
s_sub_u32 s39, s38, s39
s_lshl_b32 s39, s39, 10
v_add_u32 v120, s39, v2
global_load_dwordx4 v[124:127], v120, s[36:37]
s_add_u32 s38, s38, 2048
s_cmp_lt_u32 s38, 2304
s_cselect_b32 s36, s24, s26
s_cselect_b32 s37, s25, s27
s_cselect_b32 s39, 0, 1792
s_add_u32 s39, s39, 512
s_sub_u32 s39, s38, s39
s_lshl_b32 s39, s39, 10
v_add_u32 v121, s39, v2
global_load_dwordx4 v[128:131], v121, s[36:37]
s_add_u32 s38, s38, 2048
s_min_u32 s38, s38, 5887
s_sub_u32 s39, s38, 4096
s_lshl_b32 s39, s39, 10
v_add_u32 v122, s39, v2
global_load_dwordx4 v[132:135], v122, s[28:29]
v_and_b32 v4, 15, v1
v_lshrrev_b32 v5, 5, v1
v_lshl_add_u32 v4, v5, 4, v4
v_lshlrev_b32 v3, 4, v4
v_add_u32 v3, 0x10000, v3
s_mov_b32 s20, 0x0000ffff
s_mov_b32 s21, 0x0000ffff
s_mov_b32 s14, 0
v_and_b32 v4, 31, v1
v_mov_b32 v5, 0
v_mov_b32 v6, 0x3f803f80
v_cmp_eq_u32 vcc, 16, v4
s_nop 1
v_cndmask_b32 v5, v5, v6, vcc
v_cmp_eq_u32 vcc, 20, v4
s_nop 1
v_cndmask_b32 v5, v5, v6, vcc
v_mov_b32 v20, v5
v_mov_b32 v21, v5
v_mov_b32 v22, v5
v_mov_b32 v23, v5
v_mov_b32 v24, v5
v_mov_b32 v25, v5
v_mov_b32 v26, v5
v_mov_b32 v27, v5
v_mov_b32 v28, v5
v_mov_b32 v29, v5
v_mov_b32 v30, v5
v_mov_b32 v31, v5
v_mov_b32 v32, v5
v_mov_b32 v33, v5
v_mov_b32 v34, v5
v_mov_b32 v35, v5
s_waitcnt vmcnt(5)
s_barrier
ds_read_b128 v[12:15], v2 offset:0
s_waitcnt lgkmcnt(0)
v_mfma_f32_32x32x16_bf16 v[36:51], v[12:15], v[8:11], 0
s_nop 11
v_max3_f32 v108, v36, v37, v38
v_max3_f32 v108, v108, v39, v40
v_max3_f32 v108, v108, v41, v42
v_max3_f32 v108, v108, v43, v44
v_max3_f32 v108, v108, v45, v46
v_max3_f32 v108, v108, v47, v48
v_max3_f32 v108, v108, v49, v50
v_max_f32 v108, v108, v51
v_mov_b32 v109, v108
v_mov_b32 v110, v108
s_nop 1
v_permlane32_swap_b32 v109, v110
v_max_f32 v108, v109, v110
v_sub_f32 v108, 0, v108
v_mov_b32 v92, v108
v_mov_b32 v93, v108
v_mov_b32 v94, v108
v_mov_b32 v95, v108
v_mov_b32 v96, v108
v_mov_b32 v97, v108
v_mov_b32 v98, v108
v_mov_b32 v99, v108
v_mov_b32 v100, v108
v_mov_b32 v101, v108
v_mov_b32 v102, v108
v_mov_b32 v103, v108
v_mov_b32 v104, v108
v_mov_b32 v105, v108
v_mov_b32 v106, v108
v_mov_b32 v107, v108
k2_kernel_main:
ds_read_b128 v[12:15], v2 offset:0
s_mov_b64 exec, s[20:21]
ds_read_b128 v[20:23], v3 offset:0
ds_read_b128 v[24:27], v3 offset:512
s_mov_b64 exec, -1
s_waitcnt lgkmcnt(2)
v_mfma_f32_32x32x16_bf16 v[36:51], v[12:15], v[8:11], v[92:107]
ds_read_b128 v[16:19], v2 offset:1024
s_nop 10
v_exp_f32 v36, v36
v_exp_f32 v37, v37
v_exp_f32 v38, v38
v_exp_f32 v39, v39
v_exp_f32 v40, v40
v_exp_f32 v41, v41
s_waitcnt lgkmcnt(0)
v_mfma_f32_32x32x16_bf16 v[52:67], v[16:19], v[8:11], v[92:107]
ds_read_b128 v[12:15], v2 offset:2048
v_exp_f32 v42, v42
v_exp_f32 v43, v43
v_cvt_pk_bf16_f32 v68, v36, v37
v_cvt_pk_bf16_f32 v69, v38, v39
v_exp_f32 v44, v44
v_exp_f32 v45, v45
v_exp_f32 v46, v46
v_exp_f32 v47, v47
v_cvt_pk_bf16_f32 v70, v40, v41
v_cvt_pk_bf16_f32 v71, v42, v43
v_exp_f32 v48, v48
v_exp_f32 v49, v49
v_mfma_f32_32x32x16_bf16 v[76:91], v[20:23], v[68:71], 0
v_exp_f32 v50, v50
v_exp_f32 v51, v51
s_mov_b64 exec, s[20:21]
ds_read_b128 v[28:31], v3 offset:1024
ds_read_b128 v[32:35], v3 offset:1536
s_mov_b64 exec, -1
v_cvt_pk_bf16_f32 v72, v44, v45
v_cvt_pk_bf16_f32 v73, v46, v47
v_cvt_pk_bf16_f32 v74, v48, v49
v_cvt_pk_bf16_f32 v75, v50, v51
v_exp_f32 v52, v52
v_exp_f32 v53, v53
v_mfma_f32_32x32x16_bf16 v[76:91], v[24:27], v[72:75], v[76:91]
v_exp_f32 v54, v54
v_exp_f32 v55, v55
v_exp_f32 v56, v56
v_exp_f32 v57, v57
s_waitcnt lgkmcnt(2)
v_mfma_f32_32x32x16_bf16 v[36:51], v[12:15], v[8:11], v[92:107]
ds_read_b128 v[16:19], v2 offset:3072
v_exp_f32 v58, v58
v_exp_f32 v59, v59
v_cvt_pk_bf16_f32 v68, v52, v53
v_cvt_pk_bf16_f32 v69, v54, v55
v_exp_f32 v60, v60
v_exp_f32 v61, v61
v_exp_f32 v62, v62
v_exp_f32 v63, v63
v_cvt_pk_bf16_f32 v70, v56, v57
v_cvt_pk_bf16_f32 v71, v58, v59
v_exp_f32 v64, v64
v_exp_f32 v65, v65
s_waitcnt lgkmcnt(2)
v_mfma_f32_32x32x16_bf16 v[76:91], v[28:31], v[68:71], v[76:91]
v_exp_f32 v66, v66
v_exp_f32 v67, v67
s_mov_b64 exec, s[20:21]
ds_read_b128 v[20:23], v3 offset:2048
ds_read_b128 v[24:27], v3 offset:2560
s_mov_b64 exec, -1
v_cvt_pk_bf16_f32 v72, v60, v61
v_cvt_pk_bf16_f32 v73, v62, v63
v_cvt_pk_bf16_f32 v74, v64, v65
v_cvt_pk_bf16_f32 v75, v66, v67
v_exp_f32 v36, v36
v_exp_f32 v37, v37
s_waitcnt lgkmcnt(3)
v_mfma_f32_32x32x16_bf16 v[76:91], v[32:35], v[72:75], v[76:91]
v_exp_f32 v38, v38
v_exp_f32 v39, v39
v_exp_f32 v40, v40
v_exp_f32 v41, v41
s_waitcnt lgkmcnt(2)
v_mfma_f32_32x32x16_bf16 v[52:67], v[16:19], v[8:11], v[92:107]
ds_read_b128 v[12:15], v2 offset:4096
v_exp_f32 v42, v42
v_exp_f32 v43, v43
v_cvt_pk_bf16_f32 v68, v36, v37
v_cvt_pk_bf16_f32 v69, v38, v39
v_exp_f32 v44, v44
v_exp_f32 v45, v45
v_exp_f32 v46, v46
v_exp_f32 v47, v47
v_cvt_pk_bf16_f32 v70, v40, v41
v_cvt_pk_bf16_f32 v71, v42, v43
v_exp_f32 v48, v48
v_exp_f32 v49, v49
s_waitcnt lgkmcnt(2)
v_mfma_f32_32x32x16_bf16 v[76:91], v[20:23], v[68:71], v[76:91]
v_exp_f32 v50, v50
v_exp_f32 v51, v51
s_mov_b64 exec, s[20:21]
ds_read_b128 v[28:31], v3 offset:3072
ds_read_b128 v[32:35], v3 offset:3584
s_mov_b64 exec, -1
v_cvt_pk_bf16_f32 v72, v44, v45
v_cvt_pk_bf16_f32 v73, v46, v47
v_cvt_pk_bf16_f32 v74, v48, v49
v_cvt_pk_bf16_f32 v75, v50, v51
v_exp_f32 v52, v52
v_exp_f32 v53, v53
s_waitcnt lgkmcnt(3)
v_mfma_f32_32x32x16_bf16 v[76:91], v[24:27], v[72:75], v[76:91]
v_exp_f32 v54, v54
v_exp_f32 v55, v55
v_exp_f32 v56, v56
v_exp_f32 v57, v57
s_waitcnt lgkmcnt(2)
v_mfma_f32_32x32x16_bf16 v[36:51], v[12:15], v[8:11], v[92:107]
ds_read_b128 v[16:19], v2 offset:5120
v_exp_f32 v58, v58
v_exp_f32 v59, v59
v_cvt_pk_bf16_f32 v68, v52, v53
v_cvt_pk_bf16_f32 v69, v54, v55
v_exp_f32 v60, v60
v_exp_f32 v61, v61
v_exp_f32 v62, v62
v_exp_f32 v63, v63
v_cvt_pk_bf16_f32 v70, v56, v57
v_cvt_pk_bf16_f32 v71, v58, v59
v_exp_f32 v64, v64
v_exp_f32 v65, v65
s_waitcnt lgkmcnt(2)
v_mfma_f32_32x32x16_bf16 v[76:91], v[28:31], v[68:71], v[76:91]
v_exp_f32 v66, v66
v_exp_f32 v67, v67
s_mov_b64 exec, s[20:21]
ds_read_b128 v[20:23], v3 offset:4096
ds_read_b128 v[24:27], v3 offset:4608
s_mov_b64 exec, -1
v_cvt_pk_bf16_f32 v72, v60, v61
v_cvt_pk_bf16_f32 v73, v62, v63
v_cvt_pk_bf16_f32 v74, v64, v65
v_cvt_pk_bf16_f32 v75, v66, v67
v_exp_f32 v36, v36
v_exp_f32 v37, v37
s_waitcnt lgkmcnt(3)
v_mfma_f32_32x32x16_bf16 v[76:91], v[32:35], v[72:75], v[76:91]
v_exp_f32 v38, v38
v_exp_f32 v39, v39
v_exp_f32 v40, v40
v_exp_f32 v41, v41
s_waitcnt lgkmcnt(2)
v_mfma_f32_32x32x16_bf16 v[52:67], v[16:19], v[8:11], v[92:107]
ds_read_b128 v[12:15], v2 offset:6144
v_exp_f32 v42, v42
v_exp_f32 v43, v43
v_cvt_pk_bf16_f32 v68, v36, v37
v_cvt_pk_bf16_f32 v69, v38, v39
v_exp_f32 v44, v44
v_exp_f32 v45, v45
v_exp_f32 v46, v46
v_exp_f32 v47, v47
v_cvt_pk_bf16_f32 v70, v40, v41
v_cvt_pk_bf16_f32 v71, v42, v43
v_exp_f32 v48, v48
v_exp_f32 v49, v49
s_waitcnt lgkmcnt(2)
v_mfma_f32_32x32x16_bf16 v[76:91], v[20:23], v[68:71], v[76:91]
v_exp_f32 v50, v50
v_exp_f32 v51, v51
s_mov_b64 exec, s[20:21]
ds_read_b128 v[28:31], v3 offset:5120
ds_read_b128 v[32:35], v3 offset:5632
s_mov_b64 exec, -1
v_cvt_pk_bf16_f32 v72, v44, v45
v_cvt_pk_bf16_f32 v73, v46, v47
v_cvt_pk_bf16_f32 v74, v48, v49
v_cvt_pk_bf16_f32 v75, v50, v51
v_exp_f32 v52, v52
v_exp_f32 v53, v53
s_waitcnt lgkmcnt(3)
v_mfma_f32_32x32x16_bf16 v[76:91], v[24:27], v[72:75], v[76:91]
v_exp_f32 v54, v54
v_exp_f32 v55, v55
v_exp_f32 v56, v56
v_exp_f32 v57, v57
s_waitcnt lgkmcnt(2)
v_mfma_f32_32x32x16_bf16 v[36:51], v[12:15], v[8:11], v[92:107]
ds_read_b128 v[16:19], v2 offset:7168
v_exp_f32 v58, v58
v_exp_f32 v59, v59
v_cvt_pk_bf16_f32 v68, v52, v53
v_cvt_pk_bf16_f32 v69, v54, v55
v_exp_f32 v60, v60
v_exp_f32 v61, v61
v_exp_f32 v62, v62
v_exp_f32 v63, v63
v_cvt_pk_bf16_f32 v70, v56, v57
v_cvt_pk_bf16_f32 v71, v58, v59
v_exp_f32 v64, v64
v_exp_f32 v65, v65
s_waitcnt lgkmcnt(2)
v_mfma_f32_32x32x16_bf16 v[76:91], v[28:31], v[68:71], v[76:91]
v_exp_f32 v66, v66
v_exp_f32 v67, v67
s_mov_b64 exec, s[20:21]
ds_read_b128 v[20:23], v3 offset:6144
ds_read_b128 v[24:27], v3 offset:6656
s_mov_b64 exec, -1
v_cvt_pk_bf16_f32 v72, v60, v61
v_cvt_pk_bf16_f32 v73, v62, v63
v_cvt_pk_bf16_f32 v74, v64, v65
v_cvt_pk_bf16_f32 v75, v66, v67
v_exp_f32 v36, v36
v_exp_f32 v37, v37
s_waitcnt lgkmcnt(3)
v_mfma_f32_32x32x16_bf16 v[76:91], v[32:35], v[72:75], v[76:91]
v_exp_f32 v38, v38
v_exp_f32 v39, v39
v_exp_f32 v40, v40
v_exp_f32 v41, v41
s_cmp_lg_u32 s14, 0
s_cbranch_scc1 k2_kernel_sk_1
s_waitcnt vmcnt(3)
s_barrier
s_add_u32 s13, s11, 16384
s_add_u32 m0, s11, 16384
s_nop 0
buffer_load_dwordx4 v2, s[40:43], s13 offen lds
s_add_u32 m0, s11, 81920
s_nop 0
buffer_load_dwordx4 v2, s[44:47], s13 offen lds
k2_kernel_sk_1:
s_waitcnt lgkmcnt(2)
v_mfma_f32_32x32x16_bf16 v[52:67], v[16:19], v[8:11], v[92:107]
ds_read_b128 v[12:15], v2 offset:8192
v_exp_f32 v42, v42
v_exp_f32 v43, v43
v_cvt_pk_bf16_f32 v68, v36, v37
v_cvt_pk_bf16_f32 v69, v38, v39
v_exp_f32 v44, v44
v_exp_f32 v45, v45
v_exp_f32 v46, v46
v_exp_f32 v47, v47
v_cvt_pk_bf16_f32 v70, v40, v41
v_cvt_pk_bf16_f32 v71, v42, v43
v_exp_f32 v48, v48
v_exp_f32 v49, v49
s_waitcnt lgkmcnt(2)
v_mfma_f32_32x32x16_bf16 v[76:91], v[20:23], v[68:71], v[76:91]
v_exp_f32 v50, v50
v_exp_f32 v51, v51
s_mov_b64 exec, s[20:21]
ds_read_b128 v[28:31], v3 offset:7168
ds_read_b128 v[32:35], v3 offset:7680
s_mov_b64 exec, -1
v_cvt_pk_bf16_f32 v72, v44, v45
v_cvt_pk_bf16_f32 v73, v46, v47
v_cvt_pk_bf16_f32 v74, v48, v49
v_cvt_pk_bf16_f32 v75, v50, v51
v_exp_f32 v52, v52
v_exp_f32 v53, v53
s_waitcnt lgkmcnt(3)
v_mfma_f32_32x32x16_bf16 v[76:91], v[24:27], v[72:75], v[76:91]
v_exp_f32 v54, v54
v_exp_f32 v55, v55
v_exp_f32 v56, v56
v_exp_f32 v57, v57
s_waitcnt lgkmcnt(2)
v_mfma_f32_32x32x16_bf16 v[36:51], v[12:15], v[8:11], v[92:107]
ds_read_b128 v[16:19], v2 offset:9216
v_exp_f32 v58, v58
v_exp_f32 v59, v59
v_cvt_pk_bf16_f32 v68, v52, v53
v_cvt_pk_bf16_f32 v69, v54, v55
v_exp_f32 v60, v60
v_exp_f32 v61, v61
v_exp_f32 v62, v62
v_exp_f32 v63, v63
v_cvt_pk_bf16_f32 v70, v56, v57
v_cvt_pk_bf16_f32 v71, v58, v59
v_exp_f32 v64, v64
v_exp_f32 v65, v65
s_waitcnt lgkmcnt(2)
v_mfma_f32_32x32x16_bf16 v[76:91], v[28:31], v[68:71], v[76:91]
v_exp_f32 v66, v66
v_exp_f32 v67, v67
s_mov_b64 exec, s[20:21]
ds_read_b128 v[20:23], v3 offset:8192
ds_read_b128 v[24:27], v3 offset:8704
s_mov_b64 exec, -1
v_cvt_pk_bf16_f32 v72, v60, v61
v_cvt_pk_bf16_f32 v73, v62, v63
v_cvt_pk_bf16_f32 v74, v64, v65
v_cvt_pk_bf16_f32 v75, v66, v67
v_exp_f32 v36, v36
v_exp_f32 v37, v37
s_waitcnt lgkmcnt(3)
v_mfma_f32_32x32x16_bf16 v[76:91], v[32:35], v[72:75], v[76:91]
v_exp_f32 v38, v38
v_exp_f32 v39, v39
v_exp_f32 v40, v40
v_exp_f32 v41, v41
s_waitcnt lgkmcnt(2)
v_mfma_f32_32x32x16_bf16 v[52:67], v[16:19], v[8:11], v[92:107]
ds_read_b128 v[12:15], v2 offset:10240
v_exp_f32 v42, v42
v_exp_f32 v43, v43
v_cvt_pk_bf16_f32 v68, v36, v37
v_cvt_pk_bf16_f32 v69, v38, v39
v_exp_f32 v44, v44
v_exp_f32 v45, v45
v_exp_f32 v46, v46
v_exp_f32 v47, v47
v_cvt_pk_bf16_f32 v70, v40, v41
v_cvt_pk_bf16_f32 v71, v42, v43
v_exp_f32 v48, v48
v_exp_f32 v49, v49
s_waitcnt lgkmcnt(2)
v_mfma_f32_32x32x16_bf16 v[76:91], v[20:23], v[68:71], v[76:91]
v_exp_f32 v50, v50
v_exp_f32 v51, v51
s_mov_b64 exec, s[20:21]
ds_read_b128 v[28:31], v3 offset:9216
ds_read_b128 v[32:35], v3 offset:9728
s_mov_b64 exec, -1
v_cvt_pk_bf16_f32 v72, v44, v45
v_cvt_pk_bf16_f32 v73, v46, v47
v_cvt_pk_bf16_f32 v74, v48, v49
v_cvt_pk_bf16_f32 v75, v50, v51
v_exp_f32 v52, v52
v_exp_f32 v53, v53
s_waitcnt lgkmcnt(3)
v_mfma_f32_32x32x16_bf16 v[76:91], v[24:27], v[72:75], v[76:91]
v_exp_f32 v54, v54
v_exp_f32 v55, v55
v_exp_f32 v56, v56
v_exp_f32 v57, v57
s_waitcnt lgkmcnt(2)
v_mfma_f32_32x32x16_bf16 v[36:51], v[12:15], v[8:11], v[92:107]
ds_read_b128 v[16:19], v2 offset:11264
v_exp_f32 v58, v58
v_exp_f32 v59, v59
v_cvt_pk_bf16_f32 v68, v52, v53
v_cvt_pk_bf16_f32 v69, v54, v55
v_exp_f32 v60, v60
v_exp_f32 v61, v61
v_exp_f32 v62, v62
v_exp_f32 v63, v63
v_cvt_pk_bf16_f32 v70, v56, v57
v_cvt_pk_bf16_f32 v71, v58, v59
v_exp_f32 v64, v64
v_exp_f32 v65, v65
s_waitcnt lgkmcnt(2)
v_mfma_f32_32x32x16_bf16 v[76:91], v[28:31], v[68:71], v[76:91]
v_exp_f32 v66, v66
v_exp_f32 v67, v67
s_mov_b64 exec, s[20:21]
ds_read_b128 v[20:23], v3 offset:10240
ds_read_b128 v[24:27], v3 offset:10752
s_mov_b64 exec, -1
v_cvt_pk_bf16_f32 v72, v60, v61
v_cvt_pk_bf16_f32 v73, v62, v63
v_cvt_pk_bf16_f32 v74, v64, v65
v_cvt_pk_bf16_f32 v75, v66, v67
v_exp_f32 v36, v36
v_exp_f32 v37, v37
s_waitcnt lgkmcnt(3)
v_mfma_f32_32x32x16_bf16 v[76:91], v[32:35], v[72:75], v[76:91]
v_exp_f32 v38, v38
v_exp_f32 v39, v39
v_exp_f32 v40, v40
v_exp_f32 v41, v41
s_waitcnt lgkmcnt(2)
v_mfma_f32_32x32x16_bf16 v[52:67], v[16:19], v[8:11], v[92:107]
ds_read_b128 v[12:15], v2 offset:12288
v_exp_f32 v42, v42
v_exp_f32 v43, v43
v_cvt_pk_bf16_f32 v68, v36, v37
v_cvt_pk_bf16_f32 v69, v38, v39
v_exp_f32 v44, v44
v_exp_f32 v45, v45
v_exp_f32 v46, v46
v_exp_f32 v47, v47
v_cvt_pk_bf16_f32 v70, v40, v41
v_cvt_pk_bf16_f32 v71, v42, v43
v_exp_f32 v48, v48
v_exp_f32 v49, v49
s_waitcnt lgkmcnt(2)
v_mfma_f32_32x32x16_bf16 v[76:91], v[20:23], v[68:71], v[76:91]
v_exp_f32 v50, v50
v_exp_f32 v51, v51
s_mov_b64 exec, s[20:21]
ds_read_b128 v[28:31], v3 offset:11264
ds_read_b128 v[32:35], v3 offset:11776
s_mov_b64 exec, -1
v_cvt_pk_bf16_f32 v72, v44, v45
v_cvt_pk_bf16_f32 v73, v46, v47
v_cvt_pk_bf16_f32 v74, v48, v49
v_cvt_pk_bf16_f32 v75, v50, v51
v_exp_f32 v52, v52
v_exp_f32 v53, v53
s_waitcnt lgkmcnt(3)
v_mfma_f32_32x32x16_bf16 v[76:91], v[24:27], v[72:75], v[76:91]
v_exp_f32 v54, v54
v_exp_f32 v55, v55
v_exp_f32 v56, v56
v_exp_f32 v57, v57
s_waitcnt lgkmcnt(2)
v_mfma_f32_32x32x16_bf16 v[36:51], v[12:15], v[8:11], v[92:107]
ds_read_b128 v[16:19], v2 offset:13312
v_exp_f32 v58, v58
v_exp_f32 v59, v59
v_cvt_pk_bf16_f32 v68, v52, v53
v_cvt_pk_bf16_f32 v69, v54, v55
v_exp_f32 v60, v60
v_exp_f32 v61, v61
v_exp_f32 v62, v62
v_exp_f32 v63, v63
v_cvt_pk_bf16_f32 v70, v56, v57
v_cvt_pk_bf16_f32 v71, v58, v59
v_exp_f32 v64, v64
v_exp_f32 v65, v65
s_waitcnt lgkmcnt(2)
v_mfma_f32_32x32x16_bf16 v[76:91], v[28:31], v[68:71], v[76:91]
v_exp_f32 v66, v66
v_exp_f32 v67, v67
s_mov_b64 exec, s[20:21]
ds_read_b128 v[20:23], v3 offset:12288
ds_read_b128 v[24:27], v3 offset:12800
s_mov_b64 exec, -1
v_cvt_pk_bf16_f32 v72, v60, v61
v_cvt_pk_bf16_f32 v73, v62, v63
v_cvt_pk_bf16_f32 v74, v64, v65
v_cvt_pk_bf16_f32 v75, v66, v67
v_exp_f32 v36, v36
v_exp_f32 v37, v37
s_waitcnt lgkmcnt(3)
v_mfma_f32_32x32x16_bf16 v[76:91], v[32:35], v[72:75], v[76:91]
v_exp_f32 v38, v38
v_exp_f32 v39, v39
v_exp_f32 v40, v40
v_exp_f32 v41, v41
s_waitcnt lgkmcnt(2)
v_mfma_f32_32x32x16_bf16 v[52:67], v[16:19], v[8:11], v[92:107]
ds_read_b128 v[12:15], v2 offset:14336
v_exp_f32 v42, v42
v_exp_f32 v43, v43
v_cvt_pk_bf16_f32 v68, v36, v37
v_cvt_pk_bf16_f32 v69, v38, v39
v_exp_f32 v44, v44
v_exp_f32 v45, v45
v_exp_f32 v46, v46
v_exp_f32 v47, v47
v_cvt_pk_bf16_f32 v70, v40, v41
v_cvt_pk_bf16_f32 v71, v42, v43
v_exp_f32 v48, v48
v_exp_f32 v49, v49
s_waitcnt lgkmcnt(2)
v_mfma_f32_32x32x16_bf16 v[76:91], v[20:23], v[68:71], v[76:91]
v_exp_f32 v50, v50
v_exp_f32 v51, v51
s_mov_b64 exec, s[20:21]
ds_read_b128 v[28:31], v3 offset:13312
ds_read_b128 v[32:35], v3 offset:13824
s_mov_b64 exec, -1
v_cvt_pk_bf16_f32 v72, v44, v45
v_cvt_pk_bf16_f32 v73, v46, v47
v_cvt_pk_bf16_f32 v74, v48, v49
v_cvt_pk_bf16_f32 v75, v50, v51
v_exp_f32 v52, v52
v_exp_f32 v53, v53
s_waitcnt lgkmcnt(3)
v_mfma_f32_32x32x16_bf16 v[76:91], v[24:27], v[72:75], v[76:91]
v_exp_f32 v54, v54
v_exp_f32 v55, v55
v_exp_f32 v56, v56
v_exp_f32 v57, v57
s_waitcnt lgkmcnt(2)
v_mfma_f32_32x32x16_bf16 v[36:51], v[12:15], v[8:11], v[92:107]
ds_read_b128 v[16:19], v2 offset:15360
v_exp_f32 v58, v58
v_exp_f32 v59, v59
v_cvt_pk_bf16_f32 v68, v52, v53
v_cvt_pk_bf16_f32 v69, v54, v55
v_exp_f32 v60, v60
v_exp_f32 v61, v61
v_exp_f32 v62, v62
v_exp_f32 v63, v63
v_cvt_pk_bf16_f32 v70, v56, v57
v_cvt_pk_bf16_f32 v71, v58, v59
v_exp_f32 v64, v64
v_exp_f32 v65, v65
s_waitcnt lgkmcnt(2)
v_mfma_f32_32x32x16_bf16 v[76:91], v[28:31], v[68:71], v[76:91]
v_exp_f32 v66, v66
v_exp_f32 v67, v67
s_mov_b64 exec, s[20:21]
ds_read_b128 v[20:23], v3 offset:14336
ds_read_b128 v[24:27], v3 offset:14848
s_mov_b64 exec, -1
v_cvt_pk_bf16_f32 v72, v60, v61
v_cvt_pk_bf16_f32 v73, v62, v63
v_cvt_pk_bf16_f32 v74, v64, v65
v_cvt_pk_bf16_f32 v75, v66, v67
v_exp_f32 v36, v36
v_exp_f32 v37, v37
s_waitcnt lgkmcnt(3)
v_mfma_f32_32x32x16_bf16 v[76:91], v[32:35], v[72:75], v[76:91]
v_exp_f32 v38, v38
v_exp_f32 v39, v39
v_exp_f32 v40, v40
v_exp_f32 v41, v41
s_cmp_lg_u32 s14, 0
s_cbranch_scc1 k2_kernel_sk_2
s_waitcnt vmcnt(0)
s_barrier
s_add_u32 s13, s11, 24576
s_add_u32 m0, s11, 24576
s_nop 0
buffer_load_dwordx4 v2, s[40:43], s13 offen lds
s_add_u32 m0, s11, 90112
s_nop 0
buffer_load_dwordx4 v2, s[44:47], s13 offen lds
k2_kernel_sk_2:
s_waitcnt lgkmcnt(2)
v_mfma_f32_32x32x16_bf16 v[52:67], v[16:19], v[8:11], v[92:107]
ds_read_b128 v[12:15], v2 offset:16384
v_exp_f32 v42, v42
v_exp_f32 v43, v43
v_cvt_pk_bf16_f32 v68, v36, v37
v_cvt_pk_bf16_f32 v69, v38, v39
v_exp_f32 v44, v44
v_exp_f32 v45, v45
v_exp_f32 v46, v46
v_exp_f32 v47, v47
v_cvt_pk_bf16_f32 v70, v40, v41
v_cvt_pk_bf16_f32 v71, v42, v43
v_exp_f32 v48, v48
v_exp_f32 v49, v49
s_waitcnt lgkmcnt(2)
v_mfma_f32_32x32x16_bf16 v[76:91], v[20:23], v[68:71], v[76:91]
v_exp_f32 v50, v50
v_exp_f32 v51, v51
s_mov_b64 exec, s[20:21]
ds_read_b128 v[28:31], v3 offset:15360
ds_read_b128 v[32:35], v3 offset:15872
s_mov_b64 exec, -1
v_cvt_pk_bf16_f32 v72, v44, v45
v_cvt_pk_bf16_f32 v73, v46, v47
v_cvt_pk_bf16_f32 v74, v48, v49
v_cvt_pk_bf16_f32 v75, v50, v51
v_exp_f32 v52, v52
v_exp_f32 v53, v53
s_waitcnt lgkmcnt(3)
v_mfma_f32_32x32x16_bf16 v[76:91], v[24:27], v[72:75], v[76:91]
v_exp_f32 v54, v54
v_exp_f32 v55, v55
v_exp_f32 v56, v56
v_exp_f32 v57, v57
s_waitcnt lgkmcnt(2)
v_mfma_f32_32x32x16_bf16 v[36:51], v[12:15], v[8:11], v[92:107]
ds_read_b128 v[16:19], v2 offset:17408
v_exp_f32 v58, v58
v_exp_f32 v59, v59
v_cvt_pk_bf16_f32 v68, v52, v53
v_cvt_pk_bf16_f32 v69, v54, v55
v_exp_f32 v60, v60
v_exp_f32 v61, v61
v_exp_f32 v62, v62
v_exp_f32 v63, v63
v_cvt_pk_bf16_f32 v70, v56, v57
v_cvt_pk_bf16_f32 v71, v58, v59
v_exp_f32 v64, v64
v_exp_f32 v65, v65
s_waitcnt lgkmcnt(2)
v_mfma_f32_32x32x16_bf16 v[76:91], v[28:31], v[68:71], v[76:91]
v_exp_f32 v66, v66
v_exp_f32 v67, v67
s_mov_b64 exec, s[20:21]
ds_read_b128 v[20:23], v3 offset:16384
ds_read_b128 v[24:27], v3 offset:16896
s_mov_b64 exec, -1
v_cvt_pk_bf16_f32 v72, v60, v61
v_cvt_pk_bf16_f32 v73, v62, v63
v_cvt_pk_bf16_f32 v74, v64, v65
v_cvt_pk_bf16_f32 v75, v66, v67
v_exp_f32 v36, v36
v_exp_f32 v37, v37
s_waitcnt lgkmcnt(3)
v_mfma_f32_32x32x16_bf16 v[76:91], v[32:35], v[72:75], v[76:91]
v_exp_f32 v38, v38
v_exp_f32 v39, v39
v_exp_f32 v40, v40
v_exp_f32 v41, v41
s_waitcnt lgkmcnt(2)
v_mfma_f32_32x32x16_bf16 v[52:67], v[16:19], v[8:11], v[92:107]
ds_read_b128 v[12:15], v2 offset:18432
v_exp_f32 v42, v42
v_exp_f32 v43, v43
v_cvt_pk_bf16_f32 v68, v36, v37
v_cvt_pk_bf16_f32 v69, v38, v39
v_exp_f32 v44, v44
v_exp_f32 v45, v45
v_exp_f32 v46, v46
v_exp_f32 v47, v47
v_cvt_pk_bf16_f32 v70, v40, v41
v_cvt_pk_bf16_f32 v71, v42, v43
v_exp_f32 v48, v48
v_exp_f32 v49, v49
s_waitcnt lgkmcnt(2)
v_mfma_f32_32x32x16_bf16 v[76:91], v[20:23], v[68:71], v[76:91]
v_exp_f32 v50, v50
v_exp_f32 v51, v51
s_mov_b64 exec, s[20:21]
ds_read_b128 v[28:31], v3 offset:17408
ds_read_b128 v[32:35], v3 offset:17920
s_mov_b64 exec, -1
v_cvt_pk_bf16_f32 v72, v44, v45
v_cvt_pk_bf16_f32 v73, v46, v47
v_cvt_pk_bf16_f32 v74, v48, v49
v_cvt_pk_bf16_f32 v75, v50, v51
v_exp_f32 v52, v52
v_exp_f32 v53, v53
s_waitcnt lgkmcnt(3)
v_mfma_f32_32x32x16_bf16 v[76:91], v[24:27], v[72:75], v[76:91]
v_exp_f32 v54, v54
v_exp_f32 v55, v55
v_exp_f32 v56, v56
v_exp_f32 v57, v57
s_waitcnt lgkmcnt(2)
v_mfma_f32_32x32x16_bf16 v[36:51], v[12:15], v[8:11], v[92:107]
ds_read_b128 v[16:19], v2 offset:19456
v_exp_f32 v58, v58
v_exp_f32 v59, v59
v_cvt_pk_bf16_f32 v68, v52, v53
v_cvt_pk_bf16_f32 v69, v54, v55
v_exp_f32 v60, v60
v_exp_f32 v61, v61
v_exp_f32 v62, v62
v_exp_f32 v63, v63
v_cvt_pk_bf16_f32 v70, v56, v57
v_cvt_pk_bf16_f32 v71, v58, v59
v_exp_f32 v64, v64
v_exp_f32 v65, v65
s_waitcnt lgkmcnt(2)
v_mfma_f32_32x32x16_bf16 v[76:91], v[28:31], v[68:71], v[76:91]
v_exp_f32 v66, v66
v_exp_f32 v67, v67
s_mov_b64 exec, s[20:21]
ds_read_b128 v[20:23], v3 offset:18432
ds_read_b128 v[24:27], v3 offset:18944
s_mov_b64 exec, -1
v_cvt_pk_bf16_f32 v72, v60, v61
v_cvt_pk_bf16_f32 v73, v62, v63
v_cvt_pk_bf16_f32 v74, v64, v65
v_cvt_pk_bf16_f32 v75, v66, v67
v_exp_f32 v36, v36
v_exp_f32 v37, v37
s_waitcnt lgkmcnt(3)
v_mfma_f32_32x32x16_bf16 v[76:91], v[32:35], v[72:75], v[76:91]
v_exp_f32 v38, v38
v_exp_f32 v39, v39
v_exp_f32 v40, v40
v_exp_f32 v41, v41
s_waitcnt lgkmcnt(2)
v_mfma_f32_32x32x16_bf16 v[52:67], v[16:19], v[8:11], v[92:107]
ds_read_b128 v[12:15], v2 offset:20480
v_exp_f32 v42, v42
v_exp_f32 v43, v43
v_cvt_pk_bf16_f32 v68, v36, v37
v_cvt_pk_bf16_f32 v69, v38, v39
v_exp_f32 v44, v44
v_exp_f32 v45, v45
v_exp_f32 v46, v46
v_exp_f32 v47, v47
v_cvt_pk_bf16_f32 v70, v40, v41
v_cvt_pk_bf16_f32 v71, v42, v43
v_exp_f32 v48, v48
v_exp_f32 v49, v49
s_waitcnt lgkmcnt(2)
v_mfma_f32_32x32x16_bf16 v[76:91], v[20:23], v[68:71], v[76:91]
v_exp_f32 v50, v50
v_exp_f32 v51, v51
s_mov_b64 exec, s[20:21]
ds_read_b128 v[28:31], v3 offset:19456
ds_read_b128 v[32:35], v3 offset:19968
s_mov_b64 exec, -1
v_cvt_pk_bf16_f32 v72, v44, v45
v_cvt_pk_bf16_f32 v73, v46, v47
v_cvt_pk_bf16_f32 v74, v48, v49
v_cvt_pk_bf16_f32 v75, v50, v51
v_exp_f32 v52, v52
v_exp_f32 v53, v53
s_waitcnt lgkmcnt(3)
v_mfma_f32_32x32x16_bf16 v[76:91], v[24:27], v[72:75], v[76:91]
v_exp_f32 v54, v54
v_exp_f32 v55, v55
v_exp_f32 v56, v56
v_exp_f32 v57, v57
s_waitcnt lgkmcnt(2)
v_mfma_f32_32x32x16_bf16 v[36:51], v[12:15], v[8:11], v[92:107]
ds_read_b128 v[16:19], v2 offset:21504
v_exp_f32 v58, v58
v_exp_f32 v59, v59
v_cvt_pk_bf16_f32 v68, v52, v53
v_cvt_pk_bf16_f32 v69, v54, v55
v_exp_f32 v60, v60
v_exp_f32 v61, v61
v_exp_f32 v62, v62
v_exp_f32 v63, v63
v_cvt_pk_bf16_f32 v70, v56, v57
v_cvt_pk_bf16_f32 v71, v58, v59
v_exp_f32 v64, v64
v_exp_f32 v65, v65
s_waitcnt lgkmcnt(2)
v_mfma_f32_32x32x16_bf16 v[76:91], v[28:31], v[68:71], v[76:91]
v_exp_f32 v66, v66
v_exp_f32 v67, v67
s_mov_b64 exec, s[20:21]
ds_read_b128 v[20:23], v3 offset:20480
ds_read_b128 v[24:27], v3 offset:20992
s_mov_b64 exec, -1
v_cvt_pk_bf16_f32 v72, v60, v61
v_cvt_pk_bf16_f32 v73, v62, v63
v_cvt_pk_bf16_f32 v74, v64, v65
v_cvt_pk_bf16_f32 v75, v66, v67
v_exp_f32 v36, v36
v_exp_f32 v37, v37
s_waitcnt lgkmcnt(3)
v_mfma_f32_32x32x16_bf16 v[76:91], v[32:35], v[72:75], v[76:91]
v_exp_f32 v38, v38
v_exp_f32 v39, v39
v_exp_f32 v40, v40
v_exp_f32 v41, v41
s_waitcnt lgkmcnt(2)
v_mfma_f32_32x32x16_bf16 v[52:67], v[16:19], v[8:11], v[92:107]
ds_read_b128 v[12:15], v2 offset:22528
v_exp_f32 v42, v42
v_exp_f32 v43, v43
v_cvt_pk_bf16_f32 v68, v36, v37
v_cvt_pk_bf16_f32 v69, v38, v39
v_exp_f32 v44, v44
v_exp_f32 v45, v45
v_exp_f32 v46, v46
v_exp_f32 v47, v47
v_cvt_pk_bf16_f32 v70, v40, v41
v_cvt_pk_bf16_f32 v71, v42, v43
v_exp_f32 v48, v48
v_exp_f32 v49, v49
s_waitcnt lgkmcnt(2)
v_mfma_f32_32x32x16_bf16 v[76:91], v[20:23], v[68:71], v[76:91]
v_exp_f32 v50, v50
v_exp_f32 v51, v51
s_mov_b64 exec, s[20:21]
ds_read_b128 v[28:31], v3 offset:21504
ds_read_b128 v[32:35], v3 offset:22016
s_mov_b64 exec, -1
v_cvt_pk_bf16_f32 v72, v44, v45
v_cvt_pk_bf16_f32 v73, v46, v47
v_cvt_pk_bf16_f32 v74, v48, v49
v_cvt_pk_bf16_f32 v75, v50, v51
v_exp_f32 v52, v52
v_exp_f32 v53, v53
s_waitcnt lgkmcnt(3)
v_mfma_f32_32x32x16_bf16 v[76:91], v[24:27], v[72:75], v[76:91]
v_exp_f32 v54, v54
v_exp_f32 v55, v55
v_exp_f32 v56, v56
v_exp_f32 v57, v57
s_waitcnt lgkmcnt(2)
v_mfma_f32_32x32x16_bf16 v[36:51], v[12:15], v[8:11], v[92:107]
ds_read_b128 v[16:19], v2 offset:23552
v_exp_f32 v58, v58
v_exp_f32 v59, v59
v_cvt_pk_bf16_f32 v68, v52, v53
v_cvt_pk_bf16_f32 v69, v54, v55
v_exp_f32 v60, v60
v_exp_f32 v61, v61
v_exp_f32 v62, v62
v_exp_f32 v63, v63
v_cvt_pk_bf16_f32 v70, v56, v57
v_cvt_pk_bf16_f32 v71, v58, v59
v_exp_f32 v64, v64
v_exp_f32 v65, v65
s_waitcnt lgkmcnt(2)
v_mfma_f32_32x32x16_bf16 v[76:91], v[28:31], v[68:71], v[76:91]
v_exp_f32 v66, v66
v_exp_f32 v67, v67
s_mov_b64 exec, s[20:21]
ds_read_b128 v[20:23], v3 offset:22528
ds_read_b128 v[24:27], v3 offset:23040
s_mov_b64 exec, -1
v_cvt_pk_bf16_f32 v72, v60, v61
v_cvt_pk_bf16_f32 v73, v62, v63
v_cvt_pk_bf16_f32 v74, v64, v65
v_cvt_pk_bf16_f32 v75, v66, v67
v_exp_f32 v36, v36
v_exp_f32 v37, v37
s_waitcnt lgkmcnt(3)
v_mfma_f32_32x32x16_bf16 v[76:91], v[32:35], v[72:75], v[76:91]
v_exp_f32 v38, v38
v_exp_f32 v39, v39
v_exp_f32 v40, v40
v_exp_f32 v41, v41
s_cmp_lg_u32 s14, 0
s_cbranch_scc1 k2_kernel_sk_3
s_waitcnt vmcnt(0)
s_barrier
s_add_u32 s13, s11, 32768
s_add_u32 m0, s11, 32768
s_nop 0
buffer_load_dwordx4 v2, s[40:43], s13 offen lds
s_add_u32 m0, s11, 98304
s_nop 0
buffer_load_dwordx4 v2, s[44:47], s13 offen lds
k2_kernel_sk_3:
s_waitcnt lgkmcnt(2)
v_mfma_f32_32x32x16_bf16 v[52:67], v[16:19], v[8:11], v[92:107]
ds_read_b128 v[12:15], v2 offset:24576
v_exp_f32 v42, v42
v_exp_f32 v43, v43
v_cvt_pk_bf16_f32 v68, v36, v37
v_cvt_pk_bf16_f32 v69, v38, v39
v_exp_f32 v44, v44
v_exp_f32 v45, v45
v_exp_f32 v46, v46
v_exp_f32 v47, v47
v_cvt_pk_bf16_f32 v70, v40, v41
v_cvt_pk_bf16_f32 v71, v42, v43
v_exp_f32 v48, v48
v_exp_f32 v49, v49
s_waitcnt lgkmcnt(2)
v_mfma_f32_32x32x16_bf16 v[76:91], v[20:23], v[68:71], v[76:91]
v_exp_f32 v50, v50
v_exp_f32 v51, v51
s_mov_b64 exec, s[20:21]
ds_read_b128 v[28:31], v3 offset:23552
ds_read_b128 v[32:35], v3 offset:24064
s_mov_b64 exec, -1
v_cvt_pk_bf16_f32 v72, v44, v45
v_cvt_pk_bf16_f32 v73, v46, v47
v_cvt_pk_bf16_f32 v74, v48, v49
v_cvt_pk_bf16_f32 v75, v50, v51
v_exp_f32 v52, v52
v_exp_f32 v53, v53
s_waitcnt lgkmcnt(3)
v_mfma_f32_32x32x16_bf16 v[76:91], v[24:27], v[72:75], v[76:91]
v_exp_f32 v54, v54
v_exp_f32 v55, v55
v_exp_f32 v56, v56
v_exp_f32 v57, v57
s_waitcnt lgkmcnt(2)
v_mfma_f32_32x32x16_bf16 v[36:51], v[12:15], v[8:11], v[92:107]
ds_read_b128 v[16:19], v2 offset:25600
v_exp_f32 v58, v58
v_exp_f32 v59, v59
v_cvt_pk_bf16_f32 v68, v52, v53
v_cvt_pk_bf16_f32 v69, v54, v55
v_exp_f32 v60, v60
v_exp_f32 v61, v61
v_exp_f32 v62, v62
v_exp_f32 v63, v63
v_cvt_pk_bf16_f32 v70, v56, v57
v_cvt_pk_bf16_f32 v71, v58, v59
v_exp_f32 v64, v64
v_exp_f32 v65, v65
s_waitcnt lgkmcnt(2)
v_mfma_f32_32x32x16_bf16 v[76:91], v[28:31], v[68:71], v[76:91]
v_exp_f32 v66, v66
v_exp_f32 v67, v67
s_mov_b64 exec, s[20:21]
ds_read_b128 v[20:23], v3 offset:24576
ds_read_b128 v[24:27], v3 offset:25088
s_mov_b64 exec, -1
v_cvt_pk_bf16_f32 v72, v60, v61
v_cvt_pk_bf16_f32 v73, v62, v63
v_cvt_pk_bf16_f32 v74, v64, v65
v_cvt_pk_bf16_f32 v75, v66, v67
v_exp_f32 v36, v36
v_exp_f32 v37, v37
s_waitcnt lgkmcnt(3)
v_mfma_f32_32x32x16_bf16 v[76:91], v[32:35], v[72:75], v[76:91]
v_exp_f32 v38, v38
v_exp_f32 v39, v39
v_exp_f32 v40, v40
v_exp_f32 v41, v41
s_waitcnt lgkmcnt(2)
v_mfma_f32_32x32x16_bf16 v[52:67], v[16:19], v[8:11], v[92:107]
ds_read_b128 v[12:15], v2 offset:26624
v_exp_f32 v42, v42
v_exp_f32 v43, v43
v_cvt_pk_bf16_f32 v68, v36, v37
v_cvt_pk_bf16_f32 v69, v38, v39
v_exp_f32 v44, v44
v_exp_f32 v45, v45
v_exp_f32 v46, v46
v_exp_f32 v47, v47
v_cvt_pk_bf16_f32 v70, v40, v41
v_cvt_pk_bf16_f32 v71, v42, v43
v_exp_f32 v48, v48
v_exp_f32 v49, v49
s_waitcnt lgkmcnt(2)
v_mfma_f32_32x32x16_bf16 v[76:91], v[20:23], v[68:71], v[76:91]
v_exp_f32 v50, v50
v_exp_f32 v51, v51
s_mov_b64 exec, s[20:21]
ds_read_b128 v[28:31], v3 offset:25600
ds_read_b128 v[32:35], v3 offset:26112
s_mov_b64 exec, -1
v_cvt_pk_bf16_f32 v72, v44, v45
v_cvt_pk_bf16_f32 v73, v46, v47
v_cvt_pk_bf16_f32 v74, v48, v49
v_cvt_pk_bf16_f32 v75, v50, v51
v_exp_f32 v52, v52
v_exp_f32 v53, v53
s_waitcnt lgkmcnt(3)
v_mfma_f32_32x32x16_bf16 v[76:91], v[24:27], v[72:75], v[76:91]
v_exp_f32 v54, v54
v_exp_f32 v55, v55
v_exp_f32 v56, v56
v_exp_f32 v57, v57
s_waitcnt lgkmcnt(2)
v_mfma_f32_32x32x16_bf16 v[36:51], v[12:15], v[8:11], v[92:107]
ds_read_b128 v[16:19], v2 offset:27648
v_exp_f32 v58, v58
v_exp_f32 v59, v59
v_cvt_pk_bf16_f32 v68, v52, v53
v_cvt_pk_bf16_f32 v69, v54, v55
v_exp_f32 v60, v60
v_exp_f32 v61, v61
v_exp_f32 v62, v62
v_exp_f32 v63, v63
v_cvt_pk_bf16_f32 v70, v56, v57
v_cvt_pk_bf16_f32 v71, v58, v59
v_exp_f32 v64, v64
v_exp_f32 v65, v65
s_waitcnt lgkmcnt(2)
v_mfma_f32_32x32x16_bf16 v[76:91], v[28:31], v[68:71], v[76:91]
v_exp_f32 v66, v66
v_exp_f32 v67, v67
s_mov_b64 exec, s[20:21]
ds_read_b128 v[20:23], v3 offset:26624
ds_read_b128 v[24:27], v3 offset:27136
s_mov_b64 exec, -1
v_cvt_pk_bf16_f32 v72, v60, v61
v_cvt_pk_bf16_f32 v73, v62, v63
v_cvt_pk_bf16_f32 v74, v64, v65
v_cvt_pk_bf16_f32 v75, v66, v67
v_exp_f32 v36, v36
v_exp_f32 v37, v37
s_waitcnt lgkmcnt(3)
v_mfma_f32_32x32x16_bf16 v[76:91], v[32:35], v[72:75], v[76:91]
v_exp_f32 v38, v38
v_exp_f32 v39, v39
v_exp_f32 v40, v40
v_exp_f32 v41, v41
s_waitcnt lgkmcnt(2)
v_mfma_f32_32x32x16_bf16 v[52:67], v[16:19], v[8:11], v[92:107]
ds_read_b128 v[12:15], v2 offset:28672
v_exp_f32 v42, v42
v_exp_f32 v43, v43
v_cvt_pk_bf16_f32 v68, v36, v37
v_cvt_pk_bf16_f32 v69, v38, v39
v_exp_f32 v44, v44
v_exp_f32 v45, v45
v_exp_f32 v46, v46
v_exp_f32 v47, v47
v_cvt_pk_bf16_f32 v70, v40, v41
v_cvt_pk_bf16_f32 v71, v42, v43
v_exp_f32 v48, v48
v_exp_f32 v49, v49
s_waitcnt lgkmcnt(2)
v_mfma_f32_32x32x16_bf16 v[76:91], v[20:23], v[68:71], v[76:91]
v_exp_f32 v50, v50
v_exp_f32 v51, v51
s_mov_b64 exec, s[20:21]
ds_read_b128 v[28:31], v3 offset:27648
ds_read_b128 v[32:35], v3 offset:28160
s_mov_b64 exec, -1
v_cvt_pk_bf16_f32 v72, v44, v45
v_cvt_pk_bf16_f32 v73, v46, v47
v_cvt_pk_bf16_f32 v74, v48, v49
v_cvt_pk_bf16_f32 v75, v50, v51
v_exp_f32 v52, v52
v_exp_f32 v53, v53
s_waitcnt lgkmcnt(3)
v_mfma_f32_32x32x16_bf16 v[76:91], v[24:27], v[72:75], v[76:91]
v_exp_f32 v54, v54
v_exp_f32 v55, v55
v_exp_f32 v56, v56
v_exp_f32 v57, v57
s_waitcnt lgkmcnt(2)
v_mfma_f32_32x32x16_bf16 v[36:51], v[12:15], v[8:11], v[92:107]
ds_read_b128 v[16:19], v2 offset:29696
v_exp_f32 v58, v58
v_exp_f32 v59, v59
v_cvt_pk_bf16_f32 v68, v52, v53
v_cvt_pk_bf16_f32 v69, v54, v55
v_exp_f32 v60, v60
v_exp_f32 v61, v61
v_exp_f32 v62, v62
v_exp_f32 v63, v63
v_cvt_pk_bf16_f32 v70, v56, v57
v_cvt_pk_bf16_f32 v71, v58, v59
v_exp_f32 v64, v64
v_exp_f32 v65, v65
s_waitcnt lgkmcnt(2)
v_mfma_f32_32x32x16_bf16 v[76:91], v[28:31], v[68:71], v[76:91]
v_exp_f32 v66, v66
v_exp_f32 v67, v67
s_mov_b64 exec, s[20:21]
ds_read_b128 v[20:23], v3 offset:28672
ds_read_b128 v[24:27], v3 offset:29184
s_mov_b64 exec, -1
v_cvt_pk_bf16_f32 v72, v60, v61
v_cvt_pk_bf16_f32 v73, v62, v63
v_cvt_pk_bf16_f32 v74, v64, v65
v_cvt_pk_bf16_f32 v75, v66, v67
v_exp_f32 v36, v36
v_exp_f32 v37, v37
s_waitcnt lgkmcnt(3)
v_mfma_f32_32x32x16_bf16 v[76:91], v[32:35], v[72:75], v[76:91]
v_exp_f32 v38, v38
v_exp_f32 v39, v39
v_exp_f32 v40, v40
v_exp_f32 v41, v41
s_waitcnt lgkmcnt(2)
v_mfma_f32_32x32x16_bf16 v[52:67], v[16:19], v[8:11], v[92:107]
ds_read_b128 v[12:15], v2 offset:30720
v_exp_f32 v42, v42
v_exp_f32 v43, v43
v_cvt_pk_bf16_f32 v68, v36, v37
v_cvt_pk_bf16_f32 v69, v38, v39
v_exp_f32 v44, v44
v_exp_f32 v45, v45
v_exp_f32 v46, v46
v_exp_f32 v47, v47
v_cvt_pk_bf16_f32 v70, v40, v41
v_cvt_pk_bf16_f32 v71, v42, v43
v_exp_f32 v48, v48
v_exp_f32 v49, v49
s_waitcnt lgkmcnt(2)
v_mfma_f32_32x32x16_bf16 v[76:91], v[20:23], v[68:71], v[76:91]
v_exp_f32 v50, v50
v_exp_f32 v51, v51
s_mov_b64 exec, s[20:21]
ds_read_b128 v[28:31], v3 offset:29696
ds_read_b128 v[32:35], v3 offset:30208
s_mov_b64 exec, -1
v_cvt_pk_bf16_f32 v72, v44, v45
v_cvt_pk_bf16_f32 v73, v46, v47
v_cvt_pk_bf16_f32 v74, v48, v49
v_cvt_pk_bf16_f32 v75, v50, v51
v_exp_f32 v52, v52
v_exp_f32 v53, v53
s_waitcnt lgkmcnt(3)
v_mfma_f32_32x32x16_bf16 v[76:91], v[24:27], v[72:75], v[76:91]
v_exp_f32 v54, v54
v_exp_f32 v55, v55
v_exp_f32 v56, v56
v_exp_f32 v57, v57
s_waitcnt lgkmcnt(2)
v_mfma_f32_32x32x16_bf16 v[36:51], v[12:15], v[8:11], v[92:107]
ds_read_b128 v[16:19], v2 offset:31744
v_exp_f32 v58, v58
v_exp_f32 v59, v59
v_cvt_pk_bf16_f32 v68, v52, v53
v_cvt_pk_bf16_f32 v69, v54, v55
v_exp_f32 v60, v60
v_exp_f32 v61, v61
v_exp_f32 v62, v62
v_exp_f32 v63, v63
v_cvt_pk_bf16_f32 v70, v56, v57
v_cvt_pk_bf16_f32 v71, v58, v59
v_exp_f32 v64, v64
v_exp_f32 v65, v65
s_waitcnt lgkmcnt(2)
v_mfma_f32_32x32x16_bf16 v[76:91], v[28:31], v[68:71], v[76:91]
v_exp_f32 v66, v66
v_exp_f32 v67, v67
s_mov_b64 exec, s[20:21]
ds_read_b128 v[20:23], v3 offset:30720
ds_read_b128 v[24:27], v3 offset:31232
s_mov_b64 exec, -1
v_cvt_pk_bf16_f32 v72, v60, v61
v_cvt_pk_bf16_f32 v73, v62, v63
v_cvt_pk_bf16_f32 v74, v64, v65
v_cvt_pk_bf16_f32 v75, v66, v67
v_exp_f32 v36, v36
v_exp_f32 v37, v37
s_waitcnt lgkmcnt(3)
v_mfma_f32_32x32x16_bf16 v[76:91], v[32:35], v[72:75], v[76:91]
v_exp_f32 v38, v38
v_exp_f32 v39, v39
v_exp_f32 v40, v40
v_exp_f32 v41, v41
s_cmp_lg_u32 s14, 0
s_cbranch_scc1 k2_kernel_sk_4
s_waitcnt vmcnt(0)
s_barrier
s_add_u32 s13, s11, 40960
s_add_u32 m0, s11, 40960
s_nop 0
buffer_load_dwordx4 v2, s[40:43], s13 offen lds
s_add_u32 m0, s11, 106496
s_nop 0
buffer_load_dwordx4 v2, s[44:47], s13 offen lds
k2_kernel_sk_4:
s_waitcnt lgkmcnt(2)
v_mfma_f32_32x32x16_bf16 v[52:67], v[16:19], v[8:11], v[92:107]
ds_read_b128 v[12:15], v2 offset:32768
v_exp_f32 v42, v42
v_exp_f32 v43, v43
v_cvt_pk_bf16_f32 v68, v36, v37
v_cvt_pk_bf16_f32 v69, v38, v39
v_exp_f32 v44, v44
v_exp_f32 v45, v45
v_exp_f32 v46, v46
v_exp_f32 v47, v47
v_cvt_pk_bf16_f32 v70, v40, v41
v_cvt_pk_bf16_f32 v71, v42, v43
v_exp_f32 v48, v48
v_exp_f32 v49, v49
s_waitcnt lgkmcnt(2)
v_mfma_f32_32x32x16_bf16 v[76:91], v[20:23], v[68:71], v[76:91]
v_exp_f32 v50, v50
v_exp_f32 v51, v51
s_mov_b64 exec, s[20:21]
ds_read_b128 v[28:31], v3 offset:31744
ds_read_b128 v[32:35], v3 offset:32256
s_mov_b64 exec, -1
v_cvt_pk_bf16_f32 v72, v44, v45
v_cvt_pk_bf16_f32 v73, v46, v47
v_cvt_pk_bf16_f32 v74, v48, v49
v_cvt_pk_bf16_f32 v75, v50, v51
v_exp_f32 v52, v52
v_exp_f32 v53, v53
s_waitcnt lgkmcnt(3)
v_mfma_f32_32x32x16_bf16 v[76:91], v[24:27], v[72:75], v[76:91]
v_exp_f32 v54, v54
v_exp_f32 v55, v55
v_exp_f32 v56, v56
v_exp_f32 v57, v57
s_waitcnt lgkmcnt(2)
v_mfma_f32_32x32x16_bf16 v[36:51], v[12:15], v[8:11], v[92:107]
ds_read_b128 v[16:19], v2 offset:33792
v_exp_f32 v58, v58
v_exp_f32 v59, v59
v_cvt_pk_bf16_f32 v68, v52, v53
v_cvt_pk_bf16_f32 v69, v54, v55
v_exp_f32 v60, v60
v_exp_f32 v61, v61
v_exp_f32 v62, v62
v_exp_f32 v63, v63
v_cvt_pk_bf16_f32 v70, v56, v57
v_cvt_pk_bf16_f32 v71, v58, v59
v_exp_f32 v64, v64
v_exp_f32 v65, v65
s_waitcnt lgkmcnt(2)
v_mfma_f32_32x32x16_bf16 v[76:91], v[28:31], v[68:71], v[76:91]
v_exp_f32 v66, v66
v_exp_f32 v67, v67
s_mov_b64 exec, s[20:21]
ds_read_b128 v[20:23], v3 offset:32768
ds_read_b128 v[24:27], v3 offset:33280
s_mov_b64 exec, -1
v_cvt_pk_bf16_f32 v72, v60, v61
v_cvt_pk_bf16_f32 v73, v62, v63
v_cvt_pk_bf16_f32 v74, v64, v65
v_cvt_pk_bf16_f32 v75, v66, v67
v_exp_f32 v36, v36
v_exp_f32 v37, v37
s_waitcnt lgkmcnt(3)
v_mfma_f32_32x32x16_bf16 v[76:91], v[32:35], v[72:75], v[76:91]
v_exp_f32 v38, v38
v_exp_f32 v39, v39
v_exp_f32 v40, v40
v_exp_f32 v41, v41
s_waitcnt lgkmcnt(2)
v_mfma_f32_32x32x16_bf16 v[52:67], v[16:19], v[8:11], v[92:107]
ds_read_b128 v[12:15], v2 offset:34816
v_exp_f32 v42, v42
v_exp_f32 v43, v43
v_cvt_pk_bf16_f32 v68, v36, v37
v_cvt_pk_bf16_f32 v69, v38, v39
v_exp_f32 v44, v44
v_exp_f32 v45, v45
v_exp_f32 v46, v46
v_exp_f32 v47, v47
v_cvt_pk_bf16_f32 v70, v40, v41
v_cvt_pk_bf16_f32 v71, v42, v43
v_exp_f32 v48, v48
v_exp_f32 v49, v49
s_waitcnt lgkmcnt(2)
v_mfma_f32_32x32x16_bf16 v[76:91], v[20:23], v[68:71], v[76:91]
v_exp_f32 v50, v50
v_exp_f32 v51, v51
s_mov_b64 exec, s[20:21]
ds_read_b128 v[28:31], v3 offset:33792
ds_read_b128 v[32:35], v3 offset:34304
s_mov_b64 exec, -1
v_cvt_pk_bf16_f32 v72, v44, v45
v_cvt_pk_bf16_f32 v73, v46, v47
v_cvt_pk_bf16_f32 v74, v48, v49
v_cvt_pk_bf16_f32 v75, v50, v51
v_exp_f32 v52, v52
v_exp_f32 v53, v53
s_waitcnt lgkmcnt(3)
v_mfma_f32_32x32x16_bf16 v[76:91], v[24:27], v[72:75], v[76:91]
v_exp_f32 v54, v54
v_exp_f32 v55, v55
v_exp_f32 v56, v56
v_exp_f32 v57, v57
s_waitcnt lgkmcnt(2)
v_mfma_f32_32x32x16_bf16 v[36:51], v[12:15], v[8:11], v[92:107]
ds_read_b128 v[16:19], v2 offset:35840
v_exp_f32 v58, v58
v_exp_f32 v59, v59
v_cvt_pk_bf16_f32 v68, v52, v53
v_cvt_pk_bf16_f32 v69, v54, v55
v_exp_f32 v60, v60
v_exp_f32 v61, v61
v_exp_f32 v62, v62
v_exp_f32 v63, v63
v_cvt_pk_bf16_f32 v70, v56, v57
v_cvt_pk_bf16_f32 v71, v58, v59
v_exp_f32 v64, v64
v_exp_f32 v65, v65
s_waitcnt lgkmcnt(2)
v_mfma_f32_32x32x16_bf16 v[76:91], v[28:31], v[68:71], v[76:91]
v_exp_f32 v66, v66
v_exp_f32 v67, v67
s_mov_b64 exec, s[20:21]
ds_read_b128 v[20:23], v3 offset:34816
ds_read_b128 v[24:27], v3 offset:35328
s_mov_b64 exec, -1
v_cvt_pk_bf16_f32 v72, v60, v61
v_cvt_pk_bf16_f32 v73, v62, v63
v_cvt_pk_bf16_f32 v74, v64, v65
v_cvt_pk_bf16_f32 v75, v66, v67
v_exp_f32 v36, v36
v_exp_f32 v37, v37
s_waitcnt lgkmcnt(3)
v_mfma_f32_32x32x16_bf16 v[76:91], v[32:35], v[72:75], v[76:91]
v_exp_f32 v38, v38
v_exp_f32 v39, v39
v_exp_f32 v40, v40
v_exp_f32 v41, v41
s_waitcnt lgkmcnt(2)
v_mfma_f32_32x32x16_bf16 v[52:67], v[16:19], v[8:11], v[92:107]
ds_read_b128 v[12:15], v2 offset:36864
v_exp_f32 v42, v42
v_exp_f32 v43, v43
v_cvt_pk_bf16_f32 v68, v36, v37
v_cvt_pk_bf16_f32 v69, v38, v39
v_exp_f32 v44, v44
v_exp_f32 v45, v45
v_exp_f32 v46, v46
v_exp_f32 v47, v47
v_cvt_pk_bf16_f32 v70, v40, v41
v_cvt_pk_bf16_f32 v71, v42, v43
v_exp_f32 v48, v48
v_exp_f32 v49, v49
s_waitcnt lgkmcnt(2)
v_mfma_f32_32x32x16_bf16 v[76:91], v[20:23], v[68:71], v[76:91]
v_exp_f32 v50, v50
v_exp_f32 v51, v51
s_mov_b64 exec, s[20:21]
ds_read_b128 v[28:31], v3 offset:35840
ds_read_b128 v[32:35], v3 offset:36352
s_mov_b64 exec, -1
v_cvt_pk_bf16_f32 v72, v44, v45
v_cvt_pk_bf16_f32 v73, v46, v47
v_cvt_pk_bf16_f32 v74, v48, v49
v_cvt_pk_bf16_f32 v75, v50, v51
v_exp_f32 v52, v52
v_exp_f32 v53, v53
s_waitcnt lgkmcnt(3)
v_mfma_f32_32x32x16_bf16 v[76:91], v[24:27], v[72:75], v[76:91]
v_exp_f32 v54, v54
v_exp_f32 v55, v55
v_exp_f32 v56, v56
v_exp_f32 v57, v57
s_waitcnt lgkmcnt(2)
v_mfma_f32_32x32x16_bf16 v[36:51], v[12:15], v[8:11], v[92:107]
ds_read_b128 v[16:19], v2 offset:37888
v_exp_f32 v58, v58
v_exp_f32 v59, v59
v_cvt_pk_bf16_f32 v68, v52, v53
v_cvt_pk_bf16_f32 v69, v54, v55
v_exp_f32 v60, v60
v_exp_f32 v61, v61
v_exp_f32 v62, v62
v_exp_f32 v63, v63
v_cvt_pk_bf16_f32 v70, v56, v57
v_cvt_pk_bf16_f32 v71, v58, v59
v_exp_f32 v64, v64
v_exp_f32 v65, v65
s_waitcnt lgkmcnt(2)
v_mfma_f32_32x32x16_bf16 v[76:91], v[28:31], v[68:71], v[76:91]
v_exp_f32 v66, v66
v_exp_f32 v67, v67
s_mov_b64 exec, s[20:21]
ds_read_b128 v[20:23], v3 offset:36864
ds_read_b128 v[24:27], v3 offset:37376
s_mov_b64 exec, -1
v_cvt_pk_bf16_f32 v72, v60, v61
v_cvt_pk_bf16_f32 v73, v62, v63
v_cvt_pk_bf16_f32 v74, v64, v65
v_cvt_pk_bf16_f32 v75, v66, v67
v_exp_f32 v36, v36
v_exp_f32 v37, v37
s_waitcnt lgkmcnt(3)
v_mfma_f32_32x32x16_bf16 v[76:91], v[32:35], v[72:75], v[76:91]
v_exp_f32 v38, v38
v_exp_f32 v39, v39
v_exp_f32 v40, v40
v_exp_f32 v41, v41
s_waitcnt lgkmcnt(2)
v_mfma_f32_32x32x16_bf16 v[52:67], v[16:19], v[8:11], v[92:107]
ds_read_b128 v[12:15], v2 offset:38912
v_exp_f32 v42, v42
v_exp_f32 v43, v43
v_cvt_pk_bf16_f32 v68, v36, v37
v_cvt_pk_bf16_f32 v69, v38, v39
v_exp_f32 v44, v44
v_exp_f32 v45, v45
v_exp_f32 v46, v46
v_exp_f32 v47, v47
v_cvt_pk_bf16_f32 v70, v40, v41
v_cvt_pk_bf16_f32 v71, v42, v43
v_exp_f32 v48, v48
v_exp_f32 v49, v49
s_waitcnt lgkmcnt(2)
v_mfma_f32_32x32x16_bf16 v[76:91], v[20:23], v[68:71], v[76:91]
v_exp_f32 v50, v50
v_exp_f32 v51, v51
s_mov_b64 exec, s[20:21]
ds_read_b128 v[28:31], v3 offset:37888
ds_read_b128 v[32:35], v3 offset:38400
s_mov_b64 exec, -1
v_cvt_pk_bf16_f32 v72, v44, v45
v_cvt_pk_bf16_f32 v73, v46, v47
v_cvt_pk_bf16_f32 v74, v48, v49
v_cvt_pk_bf16_f32 v75, v50, v51
v_exp_f32 v52, v52
v_exp_f32 v53, v53
s_waitcnt lgkmcnt(3)
v_mfma_f32_32x32x16_bf16 v[76:91], v[24:27], v[72:75], v[76:91]
v_exp_f32 v54, v54
v_exp_f32 v55, v55
v_exp_f32 v56, v56
v_exp_f32 v57, v57
s_waitcnt lgkmcnt(2)
v_mfma_f32_32x32x16_bf16 v[36:51], v[12:15], v[8:11], v[92:107]
ds_read_b128 v[16:19], v2 offset:39936
v_exp_f32 v58, v58
v_exp_f32 v59, v59
v_cvt_pk_bf16_f32 v68, v52, v53
v_cvt_pk_bf16_f32 v69, v54, v55
v_exp_f32 v60, v60
v_exp_f32 v61, v61
v_exp_f32 v62, v62
v_exp_f32 v63, v63
v_cvt_pk_bf16_f32 v70, v56, v57
v_cvt_pk_bf16_f32 v71, v58, v59
v_exp_f32 v64, v64
v_exp_f32 v65, v65
s_waitcnt lgkmcnt(2)
v_mfma_f32_32x32x16_bf16 v[76:91], v[28:31], v[68:71], v[76:91]
v_exp_f32 v66, v66
v_exp_f32 v67, v67
s_mov_b64 exec, s[20:21]
ds_read_b128 v[20:23], v3 offset:38912
ds_read_b128 v[24:27], v3 offset:39424
s_mov_b64 exec, -1
v_cvt_pk_bf16_f32 v72, v60, v61
v_cvt_pk_bf16_f32 v73, v62, v63
v_cvt_pk_bf16_f32 v74, v64, v65
v_cvt_pk_bf16_f32 v75, v66, v67
v_exp_f32 v36, v36
v_exp_f32 v37, v37
s_waitcnt lgkmcnt(3)
v_mfma_f32_32x32x16_bf16 v[76:91], v[32:35], v[72:75], v[76:91]
v_exp_f32 v38, v38
v_exp_f32 v39, v39
v_exp_f32 v40, v40
v_exp_f32 v41, v41
s_cmp_lg_u32 s14, 0
s_cbranch_scc1 k2_kernel_sk_5
s_waitcnt vmcnt(0)
s_barrier
s_add_u32 s13, s11, 49152
s_add_u32 m0, s11, 49152
s_nop 0
buffer_load_dwordx4 v2, s[40:43], s13 offen lds
s_add_u32 m0, s11, 114688
s_nop 0
buffer_load_dwordx4 v2, s[44:47], s13 offen lds
k2_kernel_sk_5:
s_waitcnt lgkmcnt(2)
v_mfma_f32_32x32x16_bf16 v[52:67], v[16:19], v[8:11], v[92:107]
ds_read_b128 v[12:15], v2 offset:40960
v_exp_f32 v42, v42
v_exp_f32 v43, v43
v_cvt_pk_bf16_f32 v68, v36, v37
v_cvt_pk_bf16_f32 v69, v38, v39
v_exp_f32 v44, v44
v_exp_f32 v45, v45
v_exp_f32 v46, v46
v_exp_f32 v47, v47
v_cvt_pk_bf16_f32 v70, v40, v41
v_cvt_pk_bf16_f32 v71, v42, v43
v_exp_f32 v48, v48
v_exp_f32 v49, v49
s_waitcnt lgkmcnt(2)
v_mfma_f32_32x32x16_bf16 v[76:91], v[20:23], v[68:71], v[76:91]
v_exp_f32 v50, v50
v_exp_f32 v51, v51
s_mov_b64 exec, s[20:21]
ds_read_b128 v[28:31], v3 offset:39936
ds_read_b128 v[32:35], v3 offset:40448
s_mov_b64 exec, -1
v_cvt_pk_bf16_f32 v72, v44, v45
v_cvt_pk_bf16_f32 v73, v46, v47
v_cvt_pk_bf16_f32 v74, v48, v49
v_cvt_pk_bf16_f32 v75, v50, v51
v_exp_f32 v52, v52
v_exp_f32 v53, v53
s_waitcnt lgkmcnt(3)
v_mfma_f32_32x32x16_bf16 v[76:91], v[24:27], v[72:75], v[76:91]
v_exp_f32 v54, v54
v_exp_f32 v55, v55
v_exp_f32 v56, v56
v_exp_f32 v57, v57
s_waitcnt lgkmcnt(2)
v_mfma_f32_32x32x16_bf16 v[36:51], v[12:15], v[8:11], v[92:107]
ds_read_b128 v[16:19], v2 offset:41984
v_exp_f32 v58, v58
v_exp_f32 v59, v59
v_cvt_pk_bf16_f32 v68, v52, v53
v_cvt_pk_bf16_f32 v69, v54, v55
v_exp_f32 v60, v60
v_exp_f32 v61, v61
v_exp_f32 v62, v62
v_exp_f32 v63, v63
v_cvt_pk_bf16_f32 v70, v56, v57
v_cvt_pk_bf16_f32 v71, v58, v59
v_exp_f32 v64, v64
v_exp_f32 v65, v65
s_waitcnt lgkmcnt(2)
v_mfma_f32_32x32x16_bf16 v[76:91], v[28:31], v[68:71], v[76:91]
v_exp_f32 v66, v66
v_exp_f32 v67, v67
s_mov_b64 exec, s[20:21]
ds_read_b128 v[20:23], v3 offset:40960
ds_read_b128 v[24:27], v3 offset:41472
s_mov_b64 exec, -1
v_cvt_pk_bf16_f32 v72, v60, v61
v_cvt_pk_bf16_f32 v73, v62, v63
v_cvt_pk_bf16_f32 v74, v64, v65
v_cvt_pk_bf16_f32 v75, v66, v67
v_exp_f32 v36, v36
v_exp_f32 v37, v37
s_waitcnt lgkmcnt(3)
v_mfma_f32_32x32x16_bf16 v[76:91], v[32:35], v[72:75], v[76:91]
v_exp_f32 v38, v38
v_exp_f32 v39, v39
v_exp_f32 v40, v40
v_exp_f32 v41, v41
s_waitcnt lgkmcnt(2)
v_mfma_f32_32x32x16_bf16 v[52:67], v[16:19], v[8:11], v[92:107]
ds_read_b128 v[12:15], v2 offset:43008
v_exp_f32 v42, v42
v_exp_f32 v43, v43
v_cvt_pk_bf16_f32 v68, v36, v37
v_cvt_pk_bf16_f32 v69, v38, v39
v_exp_f32 v44, v44
v_exp_f32 v45, v45
v_exp_f32 v46, v46
v_exp_f32 v47, v47
v_cvt_pk_bf16_f32 v70, v40, v41
v_cvt_pk_bf16_f32 v71, v42, v43
v_exp_f32 v48, v48
v_exp_f32 v49, v49
s_waitcnt lgkmcnt(2)
v_mfma_f32_32x32x16_bf16 v[76:91], v[20:23], v[68:71], v[76:91]
v_exp_f32 v50, v50
v_exp_f32 v51, v51
s_mov_b64 exec, s[20:21]
ds_read_b128 v[28:31], v3 offset:41984
ds_read_b128 v[32:35], v3 offset:42496
s_mov_b64 exec, -1
v_cvt_pk_bf16_f32 v72, v44, v45
v_cvt_pk_bf16_f32 v73, v46, v47
v_cvt_pk_bf16_f32 v74, v48, v49
v_cvt_pk_bf16_f32 v75, v50, v51
v_exp_f32 v52, v52
v_exp_f32 v53, v53
s_waitcnt lgkmcnt(3)
v_mfma_f32_32x32x16_bf16 v[76:91], v[24:27], v[72:75], v[76:91]
v_exp_f32 v54, v54
v_exp_f32 v55, v55
v_exp_f32 v56, v56
v_exp_f32 v57, v57
s_waitcnt lgkmcnt(2)
v_mfma_f32_32x32x16_bf16 v[36:51], v[12:15], v[8:11], v[92:107]
ds_read_b128 v[16:19], v2 offset:44032
v_exp_f32 v58, v58
v_exp_f32 v59, v59
v_cvt_pk_bf16_f32 v68, v52, v53
v_cvt_pk_bf16_f32 v69, v54, v55
v_exp_f32 v60, v60
v_exp_f32 v61, v61
v_exp_f32 v62, v62
v_exp_f32 v63, v63
v_cvt_pk_bf16_f32 v70, v56, v57
v_cvt_pk_bf16_f32 v71, v58, v59
v_exp_f32 v64, v64
v_exp_f32 v65, v65
s_waitcnt lgkmcnt(2)
v_mfma_f32_32x32x16_bf16 v[76:91], v[28:31], v[68:71], v[76:91]
v_exp_f32 v66, v66
v_exp_f32 v67, v67
s_mov_b64 exec, s[20:21]
ds_read_b128 v[20:23], v3 offset:43008
ds_read_b128 v[24:27], v3 offset:43520
s_mov_b64 exec, -1
v_cvt_pk_bf16_f32 v72, v60, v61
v_cvt_pk_bf16_f32 v73, v62, v63
v_cvt_pk_bf16_f32 v74, v64, v65
v_cvt_pk_bf16_f32 v75, v66, v67
v_exp_f32 v36, v36
v_exp_f32 v37, v37
s_waitcnt lgkmcnt(3)
v_mfma_f32_32x32x16_bf16 v[76:91], v[32:35], v[72:75], v[76:91]
v_exp_f32 v38, v38
v_exp_f32 v39, v39
v_exp_f32 v40, v40
v_exp_f32 v41, v41
s_waitcnt lgkmcnt(2)
v_mfma_f32_32x32x16_bf16 v[52:67], v[16:19], v[8:11], v[92:107]
ds_read_b128 v[12:15], v2 offset:45056
v_exp_f32 v42, v42
v_exp_f32 v43, v43
v_cvt_pk_bf16_f32 v68, v36, v37
v_cvt_pk_bf16_f32 v69, v38, v39
v_exp_f32 v44, v44
v_exp_f32 v45, v45
v_exp_f32 v46, v46
v_exp_f32 v47, v47
v_cvt_pk_bf16_f32 v70, v40, v41
v_cvt_pk_bf16_f32 v71, v42, v43
v_exp_f32 v48, v48
v_exp_f32 v49, v49
s_waitcnt lgkmcnt(2)
v_mfma_f32_32x32x16_bf16 v[76:91], v[20:23], v[68:71], v[76:91]
v_exp_f32 v50, v50
v_exp_f32 v51, v51
s_mov_b64 exec, s[20:21]
ds_read_b128 v[28:31], v3 offset:44032
ds_read_b128 v[32:35], v3 offset:44544
s_mov_b64 exec, -1
v_cvt_pk_bf16_f32 v72, v44, v45
v_cvt_pk_bf16_f32 v73, v46, v47
v_cvt_pk_bf16_f32 v74, v48, v49
v_cvt_pk_bf16_f32 v75, v50, v51
v_exp_f32 v52, v52
v_exp_f32 v53, v53
s_waitcnt lgkmcnt(3)
v_mfma_f32_32x32x16_bf16 v[76:91], v[24:27], v[72:75], v[76:91]
v_exp_f32 v54, v54
v_exp_f32 v55, v55
v_exp_f32 v56, v56
v_exp_f32 v57, v57
s_waitcnt lgkmcnt(2)
v_mfma_f32_32x32x16_bf16 v[36:51], v[12:15], v[8:11], v[92:107]
ds_read_b128 v[16:19], v2 offset:46080
v_exp_f32 v58, v58
v_exp_f32 v59, v59
v_cvt_pk_bf16_f32 v68, v52, v53
v_cvt_pk_bf16_f32 v69, v54, v55
v_exp_f32 v60, v60
v_exp_f32 v61, v61
v_exp_f32 v62, v62
v_exp_f32 v63, v63
v_cvt_pk_bf16_f32 v70, v56, v57
v_cvt_pk_bf16_f32 v71, v58, v59
v_exp_f32 v64, v64
v_exp_f32 v65, v65
s_waitcnt lgkmcnt(2)
v_mfma_f32_32x32x16_bf16 v[76:91], v[28:31], v[68:71], v[76:91]
v_exp_f32 v66, v66
v_exp_f32 v67, v67
s_mov_b64 exec, s[20:21]
ds_read_b128 v[20:23], v3 offset:45056
ds_read_b128 v[24:27], v3 offset:45568
s_mov_b64 exec, -1
v_cvt_pk_bf16_f32 v72, v60, v61
v_cvt_pk_bf16_f32 v73, v62, v63
v_cvt_pk_bf16_f32 v74, v64, v65
v_cvt_pk_bf16_f32 v75, v66, v67
v_exp_f32 v36, v36
v_exp_f32 v37, v37
s_waitcnt lgkmcnt(3)
v_mfma_f32_32x32x16_bf16 v[76:91], v[32:35], v[72:75], v[76:91]
v_exp_f32 v38, v38
v_exp_f32 v39, v39
v_exp_f32 v40, v40
v_exp_f32 v41, v41
s_waitcnt lgkmcnt(2)
v_mfma_f32_32x32x16_bf16 v[52:67], v[16:19], v[8:11], v[92:107]
ds_read_b128 v[12:15], v2 offset:47104
v_exp_f32 v42, v42
v_exp_f32 v43, v43
v_cvt_pk_bf16_f32 v68, v36, v37
v_cvt_pk_bf16_f32 v69, v38, v39
v_exp_f32 v44, v44
v_exp_f32 v45, v45
v_exp_f32 v46, v46
v_exp_f32 v47, v47
v_cvt_pk_bf16_f32 v70, v40, v41
v_cvt_pk_bf16_f32 v71, v42, v43
v_exp_f32 v48, v48
v_exp_f32 v49, v49
s_waitcnt lgkmcnt(2)
v_mfma_f32_32x32x16_bf16 v[76:91], v[20:23], v[68:71], v[76:91]
v_exp_f32 v50, v50
v_exp_f32 v51, v51
s_mov_b64 exec, s[20:21]
ds_read_b128 v[28:31], v3 offset:46080
ds_read_b128 v[32:35], v3 offset:46592
s_mov_b64 exec, -1
v_cvt_pk_bf16_f32 v72, v44, v45
v_cvt_pk_bf16_f32 v73, v46, v47
v_cvt_pk_bf16_f32 v74, v48, v49
v_cvt_pk_bf16_f32 v75, v50, v51
v_exp_f32 v52, v52
v_exp_f32 v53, v53
s_waitcnt lgkmcnt(3)
v_mfma_f32_32x32x16_bf16 v[76:91], v[24:27], v[72:75], v[76:91]
v_exp_f32 v54, v54
v_exp_f32 v55, v55
v_exp_f32 v56, v56
v_exp_f32 v57, v57
s_waitcnt lgkmcnt(2)
v_mfma_f32_32x32x16_bf16 v[36:51], v[12:15], v[8:11], v[92:107]
ds_read_b128 v[16:19], v2 offset:48128
v_exp_f32 v58, v58
v_exp_f32 v59, v59
v_cvt_pk_bf16_f32 v68, v52, v53
v_cvt_pk_bf16_f32 v69, v54, v55
v_exp_f32 v60, v60
v_exp_f32 v61, v61
v_exp_f32 v62, v62
v_exp_f32 v63, v63
v_cvt_pk_bf16_f32 v70, v56, v57
v_cvt_pk_bf16_f32 v71, v58, v59
v_exp_f32 v64, v64
v_exp_f32 v65, v65
s_waitcnt lgkmcnt(2)
v_mfma_f32_32x32x16_bf16 v[76:91], v[28:31], v[68:71], v[76:91]
v_exp_f32 v66, v66
v_exp_f32 v67, v67
s_mov_b64 exec, s[20:21]
ds_read_b128 v[20:23], v3 offset:47104
ds_read_b128 v[24:27], v3 offset:47616
s_mov_b64 exec, -1
v_cvt_pk_bf16_f32 v72, v60, v61
v_cvt_pk_bf16_f32 v73, v62, v63
v_cvt_pk_bf16_f32 v74, v64, v65
v_cvt_pk_bf16_f32 v75, v66, v67
v_exp_f32 v36, v36
v_exp_f32 v37, v37
s_waitcnt lgkmcnt(3)
v_mfma_f32_32x32x16_bf16 v[76:91], v[32:35], v[72:75], v[76:91]
v_exp_f32 v38, v38
v_exp_f32 v39, v39
v_exp_f32 v40, v40
v_exp_f32 v41, v41
s_cmp_lg_u32 s14, 0
s_cbranch_scc1 k2_kernel_sk_6
s_waitcnt vmcnt(0)
s_barrier
s_add_u32 s13, s11, 57344
s_add_u32 m0, s11, 57344
s_nop 0
buffer_load_dwordx4 v2, s[40:43], s13 offen lds
s_add_u32 m0, s11, 122880
s_nop 0
buffer_load_dwordx4 v2, s[44:47], s13 offen lds
k2_kernel_sk_6:
s_waitcnt lgkmcnt(2)
v_mfma_f32_32x32x16_bf16 v[52:67], v[16:19], v[8:11], v[92:107]
ds_read_b128 v[12:15], v2 offset:49152
v_exp_f32 v42, v42
v_exp_f32 v43, v43
v_cvt_pk_bf16_f32 v68, v36, v37
v_cvt_pk_bf16_f32 v69, v38, v39
v_exp_f32 v44, v44
v_exp_f32 v45, v45
v_exp_f32 v46, v46
v_exp_f32 v47, v47
v_cvt_pk_bf16_f32 v70, v40, v41
v_cvt_pk_bf16_f32 v71, v42, v43
v_exp_f32 v48, v48
v_exp_f32 v49, v49
s_waitcnt lgkmcnt(2)
v_mfma_f32_32x32x16_bf16 v[76:91], v[20:23], v[68:71], v[76:91]
v_exp_f32 v50, v50
v_exp_f32 v51, v51
s_mov_b64 exec, s[20:21]
ds_read_b128 v[28:31], v3 offset:48128
ds_read_b128 v[32:35], v3 offset:48640
s_mov_b64 exec, -1
v_cvt_pk_bf16_f32 v72, v44, v45
v_cvt_pk_bf16_f32 v73, v46, v47
v_cvt_pk_bf16_f32 v74, v48, v49
v_cvt_pk_bf16_f32 v75, v50, v51
v_exp_f32 v52, v52
v_exp_f32 v53, v53
s_waitcnt lgkmcnt(3)
v_mfma_f32_32x32x16_bf16 v[76:91], v[24:27], v[72:75], v[76:91]
v_exp_f32 v54, v54
v_exp_f32 v55, v55
v_exp_f32 v56, v56
v_exp_f32 v57, v57
s_waitcnt lgkmcnt(2)
v_mfma_f32_32x32x16_bf16 v[36:51], v[12:15], v[8:11], v[92:107]
ds_read_b128 v[16:19], v2 offset:50176
v_exp_f32 v58, v58
v_exp_f32 v59, v59
v_cvt_pk_bf16_f32 v68, v52, v53
v_cvt_pk_bf16_f32 v69, v54, v55
v_exp_f32 v60, v60
v_exp_f32 v61, v61
v_exp_f32 v62, v62
v_exp_f32 v63, v63
v_cvt_pk_bf16_f32 v70, v56, v57
v_cvt_pk_bf16_f32 v71, v58, v59
v_exp_f32 v64, v64
v_exp_f32 v65, v65
s_waitcnt lgkmcnt(2)
v_mfma_f32_32x32x16_bf16 v[76:91], v[28:31], v[68:71], v[76:91]
v_exp_f32 v66, v66
v_exp_f32 v67, v67
s_mov_b64 exec, s[20:21]
ds_read_b128 v[20:23], v3 offset:49152
ds_read_b128 v[24:27], v3 offset:49664
s_mov_b64 exec, -1
v_cvt_pk_bf16_f32 v72, v60, v61
v_cvt_pk_bf16_f32 v73, v62, v63
v_cvt_pk_bf16_f32 v74, v64, v65
v_cvt_pk_bf16_f32 v75, v66, v67
v_exp_f32 v36, v36
v_exp_f32 v37, v37
s_waitcnt lgkmcnt(3)
v_mfma_f32_32x32x16_bf16 v[76:91], v[32:35], v[72:75], v[76:91]
v_exp_f32 v38, v38
v_exp_f32 v39, v39
v_exp_f32 v40, v40
v_exp_f32 v41, v41
s_waitcnt lgkmcnt(2)
v_mfma_f32_32x32x16_bf16 v[52:67], v[16:19], v[8:11], v[92:107]
ds_read_b128 v[12:15], v2 offset:51200
v_exp_f32 v42, v42
v_exp_f32 v43, v43
v_cvt_pk_bf16_f32 v68, v36, v37
v_cvt_pk_bf16_f32 v69, v38, v39
v_exp_f32 v44, v44
v_exp_f32 v45, v45
v_exp_f32 v46, v46
v_exp_f32 v47, v47
v_cvt_pk_bf16_f32 v70, v40, v41
v_cvt_pk_bf16_f32 v71, v42, v43
v_exp_f32 v48, v48
v_exp_f32 v49, v49
s_waitcnt lgkmcnt(2)
v_mfma_f32_32x32x16_bf16 v[76:91], v[20:23], v[68:71], v[76:91]
v_exp_f32 v50, v50
v_exp_f32 v51, v51
s_mov_b64 exec, s[20:21]
ds_read_b128 v[28:31], v3 offset:50176
ds_read_b128 v[32:35], v3 offset:50688
s_mov_b64 exec, -1
v_cvt_pk_bf16_f32 v72, v44, v45
v_cvt_pk_bf16_f32 v73, v46, v47
v_cvt_pk_bf16_f32 v74, v48, v49
v_cvt_pk_bf16_f32 v75, v50, v51
v_exp_f32 v52, v52
v_exp_f32 v53, v53
s_waitcnt lgkmcnt(3)
v_mfma_f32_32x32x16_bf16 v[76:91], v[24:27], v[72:75], v[76:91]
v_exp_f32 v54, v54
v_exp_f32 v55, v55
v_exp_f32 v56, v56
v_exp_f32 v57, v57
s_waitcnt lgkmcnt(2)
v_mfma_f32_32x32x16_bf16 v[36:51], v[12:15], v[8:11], v[92:107]
ds_read_b128 v[16:19], v2 offset:52224
v_exp_f32 v58, v58
v_exp_f32 v59, v59
v_cvt_pk_bf16_f32 v68, v52, v53
v_cvt_pk_bf16_f32 v69, v54, v55
v_exp_f32 v60, v60
v_exp_f32 v61, v61
v_exp_f32 v62, v62
v_exp_f32 v63, v63
v_cvt_pk_bf16_f32 v70, v56, v57
v_cvt_pk_bf16_f32 v71, v58, v59
v_exp_f32 v64, v64
v_exp_f32 v65, v65
s_waitcnt lgkmcnt(2)
v_mfma_f32_32x32x16_bf16 v[76:91], v[28:31], v[68:71], v[76:91]
v_exp_f32 v66, v66
v_exp_f32 v67, v67
s_mov_b64 exec, s[20:21]
ds_read_b128 v[20:23], v3 offset:51200
ds_read_b128 v[24:27], v3 offset:51712
s_mov_b64 exec, -1
v_cvt_pk_bf16_f32 v72, v60, v61
v_cvt_pk_bf16_f32 v73, v62, v63
v_cvt_pk_bf16_f32 v74, v64, v65
v_cvt_pk_bf16_f32 v75, v66, v67
v_exp_f32 v36, v36
v_exp_f32 v37, v37
s_waitcnt lgkmcnt(3)
v_mfma_f32_32x32x16_bf16 v[76:91], v[32:35], v[72:75], v[76:91]
v_exp_f32 v38, v38
v_exp_f32 v39, v39
v_exp_f32 v40, v40
v_exp_f32 v41, v41
s_waitcnt lgkmcnt(2)
v_mfma_f32_32x32x16_bf16 v[52:67], v[16:19], v[8:11], v[92:107]
ds_read_b128 v[12:15], v2 offset:53248
v_exp_f32 v42, v42
v_exp_f32 v43, v43
v_cvt_pk_bf16_f32 v68, v36, v37
v_cvt_pk_bf16_f32 v69, v38, v39
v_exp_f32 v44, v44
v_exp_f32 v45, v45
v_exp_f32 v46, v46
v_exp_f32 v47, v47
v_cvt_pk_bf16_f32 v70, v40, v41
v_cvt_pk_bf16_f32 v71, v42, v43
v_exp_f32 v48, v48
v_exp_f32 v49, v49
s_waitcnt lgkmcnt(2)
v_mfma_f32_32x32x16_bf16 v[76:91], v[20:23], v[68:71], v[76:91]
v_exp_f32 v50, v50
v_exp_f32 v51, v51
s_mov_b64 exec, s[20:21]
ds_read_b128 v[28:31], v3 offset:52224
ds_read_b128 v[32:35], v3 offset:52736
s_mov_b64 exec, -1
v_cvt_pk_bf16_f32 v72, v44, v45
v_cvt_pk_bf16_f32 v73, v46, v47
v_cvt_pk_bf16_f32 v74, v48, v49
v_cvt_pk_bf16_f32 v75, v50, v51
v_exp_f32 v52, v52
v_exp_f32 v53, v53
s_waitcnt lgkmcnt(3)
v_mfma_f32_32x32x16_bf16 v[76:91], v[24:27], v[72:75], v[76:91]
v_exp_f32 v54, v54
v_exp_f32 v55, v55
v_exp_f32 v56, v56
v_exp_f32 v57, v57
s_waitcnt lgkmcnt(2)
v_mfma_f32_32x32x16_bf16 v[36:51], v[12:15], v[8:11], v[92:107]
ds_read_b128 v[16:19], v2 offset:54272
v_exp_f32 v58, v58
v_exp_f32 v59, v59
v_cvt_pk_bf16_f32 v68, v52, v53
v_cvt_pk_bf16_f32 v69, v54, v55
v_exp_f32 v60, v60
v_exp_f32 v61, v61
v_exp_f32 v62, v62
v_exp_f32 v63, v63
v_cvt_pk_bf16_f32 v70, v56, v57
v_cvt_pk_bf16_f32 v71, v58, v59
v_exp_f32 v64, v64
v_exp_f32 v65, v65
s_waitcnt lgkmcnt(2)
v_mfma_f32_32x32x16_bf16 v[76:91], v[28:31], v[68:71], v[76:91]
v_exp_f32 v66, v66
v_exp_f32 v67, v67
s_mov_b64 exec, s[20:21]
ds_read_b128 v[20:23], v3 offset:53248
ds_read_b128 v[24:27], v3 offset:53760
s_mov_b64 exec, -1
v_cvt_pk_bf16_f32 v72, v60, v61
v_cvt_pk_bf16_f32 v73, v62, v63
v_cvt_pk_bf16_f32 v74, v64, v65
v_cvt_pk_bf16_f32 v75, v66, v67
v_exp_f32 v36, v36
v_exp_f32 v37, v37
s_waitcnt lgkmcnt(3)
v_mfma_f32_32x32x16_bf16 v[76:91], v[32:35], v[72:75], v[76:91]
v_exp_f32 v38, v38
v_exp_f32 v39, v39
v_exp_f32 v40, v40
v_exp_f32 v41, v41
s_waitcnt lgkmcnt(2)
v_mfma_f32_32x32x16_bf16 v[52:67], v[16:19], v[8:11], v[92:107]
ds_read_b128 v[12:15], v2 offset:55296
v_exp_f32 v42, v42
v_exp_f32 v43, v43
v_cvt_pk_bf16_f32 v68, v36, v37
v_cvt_pk_bf16_f32 v69, v38, v39
v_exp_f32 v44, v44
v_exp_f32 v45, v45
v_exp_f32 v46, v46
v_exp_f32 v47, v47
v_cvt_pk_bf16_f32 v70, v40, v41
v_cvt_pk_bf16_f32 v71, v42, v43
v_exp_f32 v48, v48
v_exp_f32 v49, v49
s_waitcnt lgkmcnt(2)
v_mfma_f32_32x32x16_bf16 v[76:91], v[20:23], v[68:71], v[76:91]
v_exp_f32 v50, v50
v_exp_f32 v51, v51
s_mov_b64 exec, s[20:21]
ds_read_b128 v[28:31], v3 offset:54272
ds_read_b128 v[32:35], v3 offset:54784
s_mov_b64 exec, -1
v_cvt_pk_bf16_f32 v72, v44, v45
v_cvt_pk_bf16_f32 v73, v46, v47
v_cvt_pk_bf16_f32 v74, v48, v49
v_cvt_pk_bf16_f32 v75, v50, v51
v_exp_f32 v52, v52
v_exp_f32 v53, v53
s_waitcnt lgkmcnt(3)
v_mfma_f32_32x32x16_bf16 v[76:91], v[24:27], v[72:75], v[76:91]
v_exp_f32 v54, v54
v_exp_f32 v55, v55
v_exp_f32 v56, v56
v_exp_f32 v57, v57
s_waitcnt lgkmcnt(2)
v_mfma_f32_32x32x16_bf16 v[36:51], v[12:15], v[8:11], v[92:107]
ds_read_b128 v[16:19], v2 offset:56320
v_exp_f32 v58, v58
v_exp_f32 v59, v59
v_cvt_pk_bf16_f32 v68, v52, v53
v_cvt_pk_bf16_f32 v69, v54, v55
v_exp_f32 v60, v60
v_exp_f32 v61, v61
v_exp_f32 v62, v62
v_exp_f32 v63, v63
v_cvt_pk_bf16_f32 v70, v56, v57
v_cvt_pk_bf16_f32 v71, v58, v59
v_exp_f32 v64, v64
v_exp_f32 v65, v65
s_waitcnt lgkmcnt(2)
v_mfma_f32_32x32x16_bf16 v[76:91], v[28:31], v[68:71], v[76:91]
v_exp_f32 v66, v66
v_exp_f32 v67, v67
s_mov_b64 exec, s[20:21]
ds_read_b128 v[20:23], v3 offset:55296
ds_read_b128 v[24:27], v3 offset:55808
s_mov_b64 exec, -1
v_cvt_pk_bf16_f32 v72, v60, v61
v_cvt_pk_bf16_f32 v73, v62, v63
v_cvt_pk_bf16_f32 v74, v64, v65
v_cvt_pk_bf16_f32 v75, v66, v67
v_exp_f32 v36, v36
v_exp_f32 v37, v37
s_waitcnt lgkmcnt(3)
v_mfma_f32_32x32x16_bf16 v[76:91], v[32:35], v[72:75], v[76:91]
v_exp_f32 v38, v38
v_exp_f32 v39, v39
v_exp_f32 v40, v40
v_exp_f32 v41, v41
s_cmp_lg_u32 s14, 0
s_cbranch_scc1 k2_kernel_sk_7
s_waitcnt vmcnt(0)
s_barrier
k2_kernel_sk_7:
s_waitcnt lgkmcnt(2)
v_mfma_f32_32x32x16_bf16 v[52:67], v[16:19], v[8:11], v[92:107]
ds_read_b128 v[12:15], v2 offset:57344
v_exp_f32 v42, v42
v_exp_f32 v43, v43
v_cvt_pk_bf16_f32 v68, v36, v37
v_cvt_pk_bf16_f32 v69, v38, v39
v_exp_f32 v44, v44
v_exp_f32 v45, v45
v_exp_f32 v46, v46
v_exp_f32 v47, v47
v_cvt_pk_bf16_f32 v70, v40, v41
v_cvt_pk_bf16_f32 v71, v42, v43
v_exp_f32 v48, v48
v_exp_f32 v49, v49
s_waitcnt lgkmcnt(2)
v_mfma_f32_32x32x16_bf16 v[76:91], v[20:23], v[68:71], v[76:91]
v_exp_f32 v50, v50
v_exp_f32 v51, v51
s_mov_b64 exec, s[20:21]
ds_read_b128 v[28:31], v3 offset:56320
ds_read_b128 v[32:35], v3 offset:56832
s_mov_b64 exec, -1
v_cvt_pk_bf16_f32 v72, v44, v45
v_cvt_pk_bf16_f32 v73, v46, v47
v_cvt_pk_bf16_f32 v74, v48, v49
v_cvt_pk_bf16_f32 v75, v50, v51
v_exp_f32 v52, v52
v_exp_f32 v53, v53
s_waitcnt lgkmcnt(3)
v_mfma_f32_32x32x16_bf16 v[76:91], v[24:27], v[72:75], v[76:91]
v_exp_f32 v54, v54
v_exp_f32 v55, v55
v_exp_f32 v56, v56
v_exp_f32 v57, v57
s_waitcnt lgkmcnt(2)
v_mfma_f32_32x32x16_bf16 v[36:51], v[12:15], v[8:11], v[92:107]
ds_read_b128 v[16:19], v2 offset:58368
v_exp_f32 v58, v58
v_exp_f32 v59, v59
v_cvt_pk_bf16_f32 v68, v52, v53
v_cvt_pk_bf16_f32 v69, v54, v55
v_exp_f32 v60, v60
v_exp_f32 v61, v61
v_exp_f32 v62, v62
v_exp_f32 v63, v63
v_cvt_pk_bf16_f32 v70, v56, v57
v_cvt_pk_bf16_f32 v71, v58, v59
v_exp_f32 v64, v64
v_exp_f32 v65, v65
s_waitcnt lgkmcnt(2)
v_mfma_f32_32x32x16_bf16 v[76:91], v[28:31], v[68:71], v[76:91]
v_exp_f32 v66, v66
v_exp_f32 v67, v67
s_mov_b64 exec, s[20:21]
ds_read_b128 v[20:23], v3 offset:57344
ds_read_b128 v[24:27], v3 offset:57856
s_mov_b64 exec, -1
v_cvt_pk_bf16_f32 v72, v60, v61
v_cvt_pk_bf16_f32 v73, v62, v63
v_cvt_pk_bf16_f32 v74, v64, v65
v_cvt_pk_bf16_f32 v75, v66, v67
v_exp_f32 v36, v36
v_exp_f32 v37, v37
s_waitcnt lgkmcnt(3)
v_mfma_f32_32x32x16_bf16 v[76:91], v[32:35], v[72:75], v[76:91]
v_exp_f32 v38, v38
v_exp_f32 v39, v39
v_exp_f32 v40, v40
v_exp_f32 v41, v41
s_waitcnt lgkmcnt(2)
v_mfma_f32_32x32x16_bf16 v[52:67], v[16:19], v[8:11], v[92:107]
ds_read_b128 v[12:15], v2 offset:59392
v_exp_f32 v42, v42
v_exp_f32 v43, v43
v_cvt_pk_bf16_f32 v68, v36, v37
v_cvt_pk_bf16_f32 v69, v38, v39
v_exp_f32 v44, v44
v_exp_f32 v45, v45
v_exp_f32 v46, v46
v_exp_f32 v47, v47
v_cvt_pk_bf16_f32 v70, v40, v41
v_cvt_pk_bf16_f32 v71, v42, v43
v_exp_f32 v48, v48
v_exp_f32 v49, v49
s_waitcnt lgkmcnt(2)
v_mfma_f32_32x32x16_bf16 v[76:91], v[20:23], v[68:71], v[76:91]
v_exp_f32 v50, v50
v_exp_f32 v51, v51
s_mov_b64 exec, s[20:21]
ds_read_b128 v[28:31], v3 offset:58368
ds_read_b128 v[32:35], v3 offset:58880
s_mov_b64 exec, -1
v_cvt_pk_bf16_f32 v72, v44, v45
v_cvt_pk_bf16_f32 v73, v46, v47
v_cvt_pk_bf16_f32 v74, v48, v49
v_cvt_pk_bf16_f32 v75, v50, v51
v_exp_f32 v52, v52
v_exp_f32 v53, v53
s_waitcnt lgkmcnt(3)
v_mfma_f32_32x32x16_bf16 v[76:91], v[24:27], v[72:75], v[76:91]
v_exp_f32 v54, v54
v_exp_f32 v55, v55
v_exp_f32 v56, v56
v_exp_f32 v57, v57
s_waitcnt lgkmcnt(2)
v_mfma_f32_32x32x16_bf16 v[36:51], v[12:15], v[8:11], v[92:107]
ds_read_b128 v[16:19], v2 offset:60416
v_exp_f32 v58, v58
v_exp_f32 v59, v59
v_cvt_pk_bf16_f32 v68, v52, v53
v_cvt_pk_bf16_f32 v69, v54, v55
v_exp_f32 v60, v60
v_exp_f32 v61, v61
v_exp_f32 v62, v62
v_exp_f32 v63, v63
v_cvt_pk_bf16_f32 v70, v56, v57
v_cvt_pk_bf16_f32 v71, v58, v59
v_exp_f32 v64, v64
v_exp_f32 v65, v65
s_waitcnt lgkmcnt(2)
v_mfma_f32_32x32x16_bf16 v[76:91], v[28:31], v[68:71], v[76:91]
v_exp_f32 v66, v66
v_exp_f32 v67, v67
s_mov_b64 exec, s[20:21]
ds_read_b128 v[20:23], v3 offset:59392
ds_read_b128 v[24:27], v3 offset:59904
s_mov_b64 exec, -1
v_cvt_pk_bf16_f32 v72, v60, v61
v_cvt_pk_bf16_f32 v73, v62, v63
v_cvt_pk_bf16_f32 v74, v64, v65
v_cvt_pk_bf16_f32 v75, v66, v67
v_exp_f32 v36, v36
v_exp_f32 v37, v37
s_waitcnt lgkmcnt(3)
v_mfma_f32_32x32x16_bf16 v[76:91], v[32:35], v[72:75], v[76:91]
v_exp_f32 v38, v38
v_exp_f32 v39, v39
v_exp_f32 v40, v40
v_exp_f32 v41, v41
s_waitcnt lgkmcnt(2)
v_mfma_f32_32x32x16_bf16 v[52:67], v[16:19], v[8:11], v[92:107]
ds_read_b128 v[12:15], v2 offset:61440
v_exp_f32 v42, v42
v_exp_f32 v43, v43
v_cvt_pk_bf16_f32 v68, v36, v37
v_cvt_pk_bf16_f32 v69, v38, v39
v_exp_f32 v44, v44
v_exp_f32 v45, v45
v_exp_f32 v46, v46
v_exp_f32 v47, v47
v_cvt_pk_bf16_f32 v70, v40, v41
v_cvt_pk_bf16_f32 v71, v42, v43
v_exp_f32 v48, v48
v_exp_f32 v49, v49
s_waitcnt lgkmcnt(2)
v_mfma_f32_32x32x16_bf16 v[76:91], v[20:23], v[68:71], v[76:91]
v_exp_f32 v50, v50
v_exp_f32 v51, v51
s_mov_b64 exec, s[20:21]
ds_read_b128 v[28:31], v3 offset:60416
ds_read_b128 v[32:35], v3 offset:60928
s_mov_b64 exec, -1
v_cvt_pk_bf16_f32 v72, v44, v45
v_cvt_pk_bf16_f32 v73, v46, v47
v_cvt_pk_bf16_f32 v74, v48, v49
v_cvt_pk_bf16_f32 v75, v50, v51
v_exp_f32 v52, v52
v_exp_f32 v53, v53
s_waitcnt lgkmcnt(3)
v_mfma_f32_32x32x16_bf16 v[76:91], v[24:27], v[72:75], v[76:91]
v_exp_f32 v54, v54
v_exp_f32 v55, v55
v_exp_f32 v56, v56
v_exp_f32 v57, v57
s_waitcnt lgkmcnt(2)
v_mfma_f32_32x32x16_bf16 v[36:51], v[12:15], v[8:11], v[92:107]
ds_read_b128 v[16:19], v2 offset:62464
v_exp_f32 v58, v58
v_exp_f32 v59, v59
v_cvt_pk_bf16_f32 v68, v52, v53
v_cvt_pk_bf16_f32 v69, v54, v55
v_exp_f32 v60, v60
v_exp_f32 v61, v61
v_exp_f32 v62, v62
v_exp_f32 v63, v63
v_cvt_pk_bf16_f32 v70, v56, v57
v_cvt_pk_bf16_f32 v71, v58, v59
v_exp_f32 v64, v64
v_exp_f32 v65, v65
s_waitcnt lgkmcnt(2)
v_mfma_f32_32x32x16_bf16 v[76:91], v[28:31], v[68:71], v[76:91]
v_exp_f32 v66, v66
v_exp_f32 v67, v67
s_mov_b64 exec, s[20:21]
ds_read_b128 v[20:23], v3 offset:61440
ds_read_b128 v[24:27], v3 offset:61952
s_mov_b64 exec, -1
v_cvt_pk_bf16_f32 v72, v60, v61
v_cvt_pk_bf16_f32 v73, v62, v63
v_cvt_pk_bf16_f32 v74, v64, v65
v_cvt_pk_bf16_f32 v75, v66, v67
v_exp_f32 v36, v36
v_exp_f32 v37, v37
s_waitcnt lgkmcnt(3)
v_mfma_f32_32x32x16_bf16 v[76:91], v[32:35], v[72:75], v[76:91]
v_exp_f32 v38, v38
v_exp_f32 v39, v39
v_exp_f32 v40, v40
v_exp_f32 v41, v41
s_waitcnt lgkmcnt(2)
v_mfma_f32_32x32x16_bf16 v[52:67], v[16:19], v[8:11], v[92:107]
ds_read_b128 v[12:15], v2 offset:63488
v_exp_f32 v42, v42
v_exp_f32 v43, v43
v_cvt_pk_bf16_f32 v68, v36, v37
v_cvt_pk_bf16_f32 v69, v38, v39
v_exp_f32 v44, v44
v_exp_f32 v45, v45
v_exp_f32 v46, v46
v_exp_f32 v47, v47
v_cvt_pk_bf16_f32 v70, v40, v41
v_cvt_pk_bf16_f32 v71, v42, v43
v_exp_f32 v48, v48
v_exp_f32 v49, v49
s_waitcnt lgkmcnt(2)
v_mfma_f32_32x32x16_bf16 v[76:91], v[20:23], v[68:71], v[76:91]
v_exp_f32 v50, v50
v_exp_f32 v51, v51
s_mov_b64 exec, s[20:21]
ds_read_b128 v[28:31], v3 offset:62464
ds_read_b128 v[32:35], v3 offset:62976
s_mov_b64 exec, -1
v_cvt_pk_bf16_f32 v72, v44, v45
v_cvt_pk_bf16_f32 v73, v46, v47
v_cvt_pk_bf16_f32 v74, v48, v49
v_cvt_pk_bf16_f32 v75, v50, v51
v_exp_f32 v52, v52
v_exp_f32 v53, v53
s_waitcnt lgkmcnt(3)
v_mfma_f32_32x32x16_bf16 v[76:91], v[24:27], v[72:75], v[76:91]
v_exp_f32 v54, v54
v_exp_f32 v55, v55
v_exp_f32 v56, v56
v_exp_f32 v57, v57
s_waitcnt lgkmcnt(2)
v_mfma_f32_32x32x16_bf16 v[36:51], v[12:15], v[8:11], v[92:107]
ds_read_b128 v[16:19], v2 offset:64512
v_exp_f32 v58, v58
v_exp_f32 v59, v59
v_cvt_pk_bf16_f32 v68, v52, v53
v_cvt_pk_bf16_f32 v69, v54, v55
v_exp_f32 v60, v60
v_exp_f32 v61, v61
v_exp_f32 v62, v62
v_exp_f32 v63, v63
v_cvt_pk_bf16_f32 v70, v56, v57
v_cvt_pk_bf16_f32 v71, v58, v59
v_exp_f32 v64, v64
v_exp_f32 v65, v65
s_waitcnt lgkmcnt(2)
v_mfma_f32_32x32x16_bf16 v[76:91], v[28:31], v[68:71], v[76:91]
v_exp_f32 v66, v66
v_exp_f32 v67, v67
s_mov_b64 exec, s[20:21]
ds_read_b128 v[20:23], v3 offset:63488
ds_read_b128 v[24:27], v3 offset:64000
s_mov_b64 exec, -1
v_cvt_pk_bf16_f32 v72, v60, v61
v_cvt_pk_bf16_f32 v73, v62, v63
v_cvt_pk_bf16_f32 v74, v64, v65
v_cvt_pk_bf16_f32 v75, v66, v67
v_exp_f32 v36, v36
v_exp_f32 v37, v37
s_waitcnt lgkmcnt(3)
v_mfma_f32_32x32x16_bf16 v[76:91], v[32:35], v[72:75], v[76:91]
v_exp_f32 v38, v38
v_exp_f32 v39, v39
v_exp_f32 v40, v40
v_exp_f32 v41, v41
s_waitcnt lgkmcnt(2)
v_mfma_f32_32x32x16_bf16 v[52:67], v[16:19], v[8:11], v[92:107]
v_exp_f32 v42, v42
v_exp_f32 v43, v43
v_cvt_pk_bf16_f32 v68, v36, v37
v_cvt_pk_bf16_f32 v69, v38, v39
v_exp_f32 v44, v44
v_exp_f32 v45, v45
v_exp_f32 v46, v46
v_exp_f32 v47, v47
v_cvt_pk_bf16_f32 v70, v40, v41
v_cvt_pk_bf16_f32 v71, v42, v43
v_exp_f32 v48, v48
v_exp_f32 v49, v49
s_waitcnt lgkmcnt(1)
v_mfma_f32_32x32x16_bf16 v[76:91], v[20:23], v[68:71], v[76:91]
v_exp_f32 v50, v50
v_exp_f32 v51, v51
s_mov_b64 exec, s[20:21]
ds_read_b128 v[28:31], v3 offset:64512
ds_read_b128 v[32:35], v3 offset:65024
s_mov_b64 exec, -1
v_cvt_pk_bf16_f32 v72, v44, v45
v_cvt_pk_bf16_f32 v73, v46, v47
v_cvt_pk_bf16_f32 v74, v48, v49
v_cvt_pk_bf16_f32 v75, v50, v51
v_exp_f32 v52, v52
v_exp_f32 v53, v53
s_waitcnt lgkmcnt(2)
v_mfma_f32_32x32x16_bf16 v[76:91], v[24:27], v[72:75], v[76:91]
v_exp_f32 v54, v54
v_exp_f32 v55, v55
v_exp_f32 v56, v56
v_exp_f32 v57, v57
v_exp_f32 v58, v58
v_exp_f32 v59, v59
v_cvt_pk_bf16_f32 v68, v52, v53
v_cvt_pk_bf16_f32 v69, v54, v55
v_exp_f32 v60, v60
v_exp_f32 v61, v61
v_exp_f32 v62, v62
v_exp_f32 v63, v63
v_cvt_pk_bf16_f32 v70, v56, v57
v_cvt_pk_bf16_f32 v71, v58, v59
v_exp_f32 v64, v64
v_exp_f32 v65, v65
s_waitcnt lgkmcnt(1)
v_mfma_f32_32x32x16_bf16 v[76:91], v[28:31], v[68:71], v[76:91]
v_exp_f32 v66, v66
v_exp_f32 v67, v67
v_cvt_pk_bf16_f32 v72, v60, v61
v_cvt_pk_bf16_f32 v73, v62, v63
v_cvt_pk_bf16_f32 v74, v64, v65
v_cvt_pk_bf16_f32 v75, v66, v67
s_waitcnt lgkmcnt(0)
s_nop 0
v_mfma_f32_32x32x16_bf16 v[76:91], v[32:35], v[72:75], v[76:91]
s_cmp_lg_u32 s14, 0
s_cbranch_scc1 k2_kernel_ok
s_mov_b32 s15, 0x4e800000
s_nop 8
v_cmp_nge_f32 vcc, s15, v84
s_cbranch_vccz k2_kernel_ok
v_mov_b32 v108, 0xff7fffff
v_mov_b32 v111, v2
s_mov_b32 s15, 64
k2_kernel_fmax:
ds_read_b128 v[12:15], v111
s_waitcnt lgkmcnt(0)
v_mfma_f32_32x32x16_bf16 v[36:51], v[12:15], v[8:11], 0
s_nop 11
v_max3_f32 v112, v36, v37, v38
v_max3_f32 v112, v112, v39, v40
v_max3_f32 v112, v112, v41, v42
v_max3_f32 v112, v112, v43, v44
v_max3_f32 v112, v112, v45, v46
v_max3_f32 v112, v112, v47, v48
v_max3_f32 v112, v112, v49, v50
v_max_f32 v112, v112, v51
v_max_f32 v108, v108, v112
v_add_u32 v111, 0x400, v111
s_sub_u32 s15, s15, 1
s_cmp_lg_u32 s15, 0
s_cbranch_scc1 k2_kernel_fmax
v_mov_b32 v109, v108
v_mov_b32 v110, v108
s_nop 1
v_permlane32_swap_b32 v109, v110
v_max_f32 v108, v109, v110
v_sub_f32 v108, 0, v108
v_mov_b32 v92, v108
v_mov_b32 v93, v108
v_mov_b32 v94, v108
v_mov_b32 v95, v108
v_mov_b32 v96, v108
v_mov_b32 v97, v108
v_mov_b32 v98, v108
v_mov_b32 v99, v108
v_mov_b32 v100, v108
v_mov_b32 v101, v108
v_mov_b32 v102, v108
v_mov_b32 v103, v108
v_mov_b32 v104, v108
v_mov_b32 v105, v108
v_mov_b32 v106, v108
v_mov_b32 v107, v108
s_mov_b32 s14, 1
s_branch k2_kernel_main
k2_kernel_ok:
s_nop 11
v_rcp_f32 v108, v84
s_nop 0
v_mul_f32 v76, v76, v108
v_mul_f32 v77, v77, v108
v_mul_f32 v78, v78, v108
v_mul_f32 v79, v79, v108
v_mul_f32 v80, v80, v108
v_mul_f32 v81, v81, v108
v_mul_f32 v82, v82, v108
v_mul_f32 v83, v83, v108
v_cvt_pk_bf16_f32 v68, v76, v77
v_cvt_pk_bf16_f32 v69, v78, v79
v_cvt_pk_bf16_f32 v70, v80, v81
v_cvt_pk_bf16_f32 v71, v82, v83
s_nop 0
v_permlane32_swap_b32 v68, v70
v_permlane32_swap_b32 v69, v71
s_lshl_b32 s12, s5, 5
s_add_u32 s12, s12, s4
s_lshl_b32 s12, s12, 10
s_add_u32 s12, s12, 8388608
buffer_store_dwordx4 v[68:71], v2, s[48:51], s12 offen
s_waitcnt vmcnt(0)
k2_kernel_end:
s_endpgm
.section .rodata,"a"
.p2align 6
.amdhsa_kernel k2_kernel
  .amdhsa_next_free_vgpr 136
  .amdhsa_next_free_sgpr 96
  .amdhsa_accum_offset 136
  .amdhsa_group_segment_fixed_size 0
  .amdhsa_kernarg_size 80
  .amdhsa_user_sgpr_count 2
  .amdhsa_user_sgpr_kernarg_segment_ptr 1
  .amdhsa_system_sgpr_workgroup_id_x 1
.end_amdhsa_kernel
.text
.globl k3_kernel
.p2align 8
.type k3_kernel,@function
k3_kernel:
s_cmp_ge_u32 s2, 256
s_cbranch_scc1 k3_kernel_end
s_load_dwordx16 s[16:31], s[0:1], 0
s_load_dwordx4 s[32:35], s[0:1], 64
v_and_b32 v1, 63, v0
v_lshrrev_b32 v2, 6, v0
v_lshlrev_b32 v3, 4, v1
s_nop 0
v_readfirstlane_b32 s6, v2
s_and_b32 s7, s2, 7
s_lshr_b32 s8, s2, 3
s_lshl_b32 s9, s7, 2
s_and_b32 s10, s8, 3
s_add_u32 s4, s9, s10
s_lshr_b32 s5, s8, 2
s_mov_b32 s61, 0x3f803f80
s_waitcnt lgkmcnt(0)
s_mul_i32 s7, s4, 65536
s_add_u32 s40, s34, s7
s_addc_u32 s41, s35, 0
s_add_u32 s40, s40, 8388608
s_addc_u32 s41, s41, 0
s_and_b32 s41, s41, 0xffff
s_mov_b32 s42, 65536
s_mov_b32 s43, 0x00020000
s_mul_i32 s7, s5, 128
s_add_u32 s44, s20, s7
s_addc_u32 s45, s21, 0
s_and_b32 s45, s45, 0xffff
s_mov_b32 s46, 0
s_mov_b32 s47, 0x00020000
s_sub_u32 s46, 524288, s7
s_mov_b32 s52, s34
s_mov_b32 s53, s35
s_and_b32 s53, s53, 0xffff
s_mov_b32 s54, 33554432
s_mov_b32 s55, 0x00020000
s_mov_b32 s56, s16
s_mov_b32 s57, s17
s_and_b32 s57, s57, 0xffff
s_mov_b32 s58, 2097152
s_mov_b32 s59, 0x00020000
v_and_b32 v4, 15, v1
v_lshrrev_b32 v5, 5, v1
v_bfe_u32 v6, v1, 4, 1
v_lshrrev_b32 v7, 2, v4
v_lshl_add_u32 v7, v5, 3, v7
v_and_b32 v8, 3, v4
s_cmp_eq_u32 s6, 1
s_cbranch_scc1 k3_kernel_w1
s_cmp_eq_u32 s6, 2
s_cbranch_scc1 k3_kernel_w2
s_cmp_eq_u32 s6, 3
s_cbranch_scc1 k3_kernel_w3
s_cmp_eq_u32 s6, 4
s_cbranch_scc1 k3_kernel_w4
s_cmp_eq_u32 s6, 5
s_cbranch_scc1 k3_kernel_w5
s_cmp_eq_u32 s6, 6
s_cbranch_scc1 k3_kernel_w6
s_cmp_eq_u32 s6, 7
s_cbranch_scc1 k3_kernel_w7
s_lshl_b32 s7, s4, 1
s_add_u32 s7, s7, 0
s_lshl_b32 s8, s5, 7
s_add_u32 s8, s8, 0
s_lshl_b32 s9, s7, 15
s_add_u32 s9, s9, s8
v_and_b32 v86, 31, v1
v_lshlrev_b32 v86, 10, v86
v_lshl_add_u32 v86, v5, 3, v86
buffer_load_dwordx2 v[88:89], v86, s[56:59], s9 offen offset:0
buffer_load_dwordx2 v[90:91], v86, s[56:59], s9 offen offset:16
buffer_load_dwordx2 v[92:93], v86, s[56:59], s9 offen offset:32
buffer_load_dwordx2 v[94:95], v86, s[56:59], s9 offen offset:48
v_lshrrev_b32 v14, 1, v8
v_lshl_add_u32 v14, v6, 1, v14
v_add_u32 v14, 0, v14
v_bfe_u32 v15, v4, 3, 1
v_lshlrev_b32 v15, 2, v15
v_xor_b32 v14, v14, v15
v_lshlrev_b32 v14, 4, v14
v_and_b32 v15, 1, v4
v_lshl_add_u32 v14, v15, 3, v14
v_lshl_add_u32 v9, v7, 7, v14
s_barrier
v_add_u32 v10, 8192, v9
v_add_u32 v12, 0, v3
ds_read_b128 v[40:43], v12 offset:0
ds_read_b64_tr_b16 v[20:21], v10 offset:0
ds_read_b64_tr_b16 v[22:23], v10 offset:512
ds_read_b128 v[44:47], v12 offset:1024
ds_read_b64_tr_b16 v[24:25], v10 offset:2048
ds_read_b64_tr_b16 v[26:27], v10 offset:2560
ds_read_b128 v[48:51], v12 offset:2048
ds_read_b64_tr_b16 v[28:29], v10 offset:4096
ds_read_b64_tr_b16 v[30:31], v10 offset:4608
ds_read_b128 v[52:55], v12 offset:3072
ds_read_b64_tr_b16 v[32:33], v10 offset:6144
ds_read_b64_tr_b16 v[34:35], v10 offset:6656
s_barrier
v_add_u32 v11, 24576, v9
v_add_u32 v13, 16384, v3
ds_read_b128 v[56:59], v13 offset:0
s_waitcnt lgkmcnt(10)
v_mfma_f32_32x32x16_bf16 v[60:75], v[20:23], v[40:43], 0
ds_read_b64_tr_b16 v[36:37], v11 offset:0
ds_read_b64_tr_b16 v[38:39], v11 offset:512
ds_read_b128 v[40:43], v13 offset:1024
s_waitcnt lgkmcnt(10)
v_mfma_f32_32x32x16_bf16 v[60:75], v[24:27], v[44:47], v[60:75]
ds_read_b64_tr_b16 v[20:21], v11 offset:2048
ds_read_b64_tr_b16 v[22:23], v11 offset:2560
ds_read_b128 v[44:47], v13 offset:2048
s_waitcnt lgkmcnt(10)
v_mfma_f32_32x32x16_bf16 v[60:75], v[28:31], v[48:51], v[60:75]
ds_read_b64_tr_b16 v[24:25], v11 offset:4096
ds_read_b64_tr_b16 v[26:27], v11 offset:4608
ds_read_b128 v[48:51], v13 offset:3072
s_waitcnt lgkmcnt(10)
v_mfma_f32_32x32x16_bf16 v[60:75], v[32:35], v[52:55], v[60:75]
ds_read_b64_tr_b16 v[28:29], v11 offset:6144
ds_read_b64_tr_b16 v[30:31], v11 offset:6656
s_barrier
v_add_u32 v10, 40960, v9
v_add_u32 v12, 32768, v3
ds_read_b128 v[52:55], v12 offset:0
s_waitcnt lgkmcnt(10)
v_mfma_f32_32x32x16_bf16 v[60:75], v[36:39], v[56:59], v[60:75]
ds_read_b64_tr_b16 v[32:33], v10 offset:0
ds_read_b64_tr_b16 v[34:35], v10 offset:512
ds_read_b128 v[56:59], v12 offset:1024
s_waitcnt lgkmcnt(10)
v_mfma_f32_32x32x16_bf16 v[60:75], v[20:23], v[40:43], v[60:75]
ds_read_b64_tr_b16 v[36:37], v10 offset:2048
ds_read_b64_tr_b16 v[38:39], v10 offset:2560
ds_read_b128 v[40:43], v12 offset:2048
s_waitcnt lgkmcnt(10)
v_mfma_f32_32x32x16_bf16 v[60:75], v[24:27], v[44:47], v[60:75]
ds_read_b64_tr_b16 v[20:21], v10 offset:4096
ds_read_b64_tr_b16 v[22:23], v10 offset:4608
ds_read_b128 v[44:47], v12 offset:3072
s_waitcnt lgkmcnt(10)
v_mfma_f32_32x32x16_bf16 v[60:75], v[28:31], v[48:51], v[60:75]
ds_read_b64_tr_b16 v[24:25], v10 offset:6144
ds_read_b64_tr_b16 v[26:27], v10 offset:6656
s_barrier
v_add_u32 v11, 57344, v9
v_add_u32 v13, 49152, v3
ds_read_b128 v[48:51], v13 offset:0
s_waitcnt lgkmcnt(10)
v_mfma_f32_32x32x16_bf16 v[60:75], v[32:35], v[52:55], v[60:75]
ds_read_b64_tr_b16 v[28:29], v11 offset:0
ds_read_b64_tr_b16 v[30:31], v11 offset:512
ds_read_b128 v[52:55], v13 offset:1024
s_waitcnt lgkmcnt(10)
v_mfma_f32_32x32x16_bf16 v[60:75], v[36:39], v[56:59], v[60:75]
ds_read_b64_tr_b16 v[32:33], v11 offset:2048
ds_read_b64_tr_b16 v[34:35], v11 offset:2560
ds_read_b128 v[56:59], v13 offset:2048
s_waitcnt lgkmcnt(10)
v_mfma_f32_32x32x16_bf16 v[60:75], v[20:23], v[40:43], v[60:75]
ds_read_b64_tr_b16 v[36:37], v11 offset:4096
ds_read_b64_tr_b16 v[38:39], v11 offset:4608
ds_read_b128 v[40:43], v13 offset:3072
s_waitcnt lgkmcnt(10)
v_mfma_f32_32x32x16_bf16 v[60:75], v[24:27], v[44:47], v[60:75]
ds_read_b64_tr_b16 v[20:21], v11 offset:6144
ds_read_b64_tr_b16 v[22:23], v11 offset:6656
s_barrier
v_add_u32 v10, 73728, v9
v_add_u32 v12, 65536, v3
ds_read_b128 v[44:47], v12 offset:0
s_waitcnt lgkmcnt(10)
v_mfma_f32_32x32x16_bf16 v[60:75], v[28:31], v[48:51], v[60:75]
ds_read_b64_tr_b16 v[24:25], v10 offset:0
ds_read_b64_tr_b16 v[26:27], v10 offset:512
ds_read_b128 v[48:51], v12 offset:1024
s_waitcnt lgkmcnt(10)
v_mfma_f32_32x32x16_bf16 v[60:75], v[32:35], v[52:55], v[60:75]
ds_read_b64_tr_b16 v[28:29], v10 offset:2048
ds_read_b64_tr_b16 v[30:31], v10 offset:2560
ds_read_b128 v[52:55], v12 offset:2048
s_waitcnt lgkmcnt(10)
v_mfma_f32_32x32x16_bf16 v[60:75], v[36:39], v[56:59], v[60:75]
ds_read_b64_tr_b16 v[32:33], v10 offset:4096
ds_read_b64_tr_b16 v[34:35], v10 offset:4608
ds_read_b128 v[56:59], v12 offset:3072
s_waitcnt lgkmcnt(10)
v_mfma_f32_32x32x16_bf16 v[60:75], v[20:23], v[40:43], v[60:75]
ds_read_b64_tr_b16 v[36:37], v10 offset:6144
ds_read_b64_tr_b16 v[38:39], v10 offset:6656
s_barrier
v_add_u32 v11, 90112, v9
v_add_u32 v13, 81920, v3
ds_read_b128 v[40:43], v13 offset:0
s_waitcnt lgkmcnt(10)
v_mfma_f32_32x32x16_bf16 v[60:75], v[24:27], v[44:47], v[60:75]
ds_read_b64_tr_b16 v[20:21], v11 offset:0
ds_read_b64_tr_b16 v[22:23], v11 offset:512
ds_read_b128 v[44:47], v13 offset:1024
s_waitcnt lgkmcnt(10)
v_mfma_f32_32x32x16_bf16 v[60:75], v[28:31], v[48:51], v[60:75]
ds_read_b64_tr_b16 v[24:25], v11 offset:2048
ds_read_b64_tr_b16 v[26:27], v11 offset:2560
ds_read_b128 v[48:51], v13 offset:2048
s_waitcnt lgkmcnt(10)
v_mfma_f32_32x32x16_bf16 v[60:75], v[32:35], v[52:55], v[60:75]
ds_read_b64_tr_b16 v[28:29], v11 offset:4096
ds_read_b64_tr_b16 v[30:31], v11 offset:4608
ds_read_b128 v[52:55], v13 offset:3072
s_waitcnt lgkmcnt(10)
v_mfma_f32_32x32x16_bf16 v[60:75], v[36:39], v[56:59], v[60:75]
ds_read_b64_tr_b16 v[32:33], v11 offset:6144
ds_read_b64_tr_b16 v[34:35], v11 offset:6656
s_barrier
v_add_u32 v10, 106496, v9
v_add_u32 v12, 98304, v3
ds_read_b128 v[56:59], v12 offset:0
s_waitcnt lgkmcnt(10)
v_mfma_f32_32x32x16_bf16 v[60:75], v[20:23], v[40:43], v[60:75]
ds_read_b64_tr_b16 v[36:37], v10 offset:0
ds_read_b64_tr_b16 v[38:39], v10 offset:512
ds_read_b128 v[40:43], v12 offset:1024
s_waitcnt lgkmcnt(10)
v_mfma_f32_32x32x16_bf16 v[60:75], v[24:27], v[44:47], v[60:75]
ds_read_b64_tr_b16 v[20:21], v10 offset:2048
ds_read_b64_tr_b16 v[22:23], v10 offset:2560
ds_read_b128 v[44:47], v12 offset:2048
s_waitcnt lgkmcnt(10)
v_mfma_f32_32x32x16_bf16 v[60:75], v[28:31], v[48:51], v[60:75]
ds_read_b64_tr_b16 v[24:25], v10 offset:4096
ds_read_b64_tr_b16 v[26:27], v10 offset:4608
ds_read_b128 v[48:51], v12 offset:3072
s_waitcnt lgkmcnt(10)
v_mfma_f32_32x32x16_bf16 v[60:75], v[32:35], v[52:55], v[60:75]
ds_read_b64_tr_b16 v[28:29], v10 offset:6144
ds_read_b64_tr_b16 v[30:31], v10 offset:6656
s_barrier
v_add_u32 v11, 122880, v9
v_add_u32 v13, 114688, v3
ds_read_b128 v[52:55], v13 offset:0
s_waitcnt lgkmcnt(10)
v_mfma_f32_32x32x16_bf16 v[60:75], v[36:39], v[56:59], v[60:75]
ds_read_b64_tr_b16 v[32:33], v11 offset:0
ds_read_b64_tr_b16 v[34:35], v11 offset:512
ds_read_b128 v[56:59], v13 offset:1024
s_waitcnt lgkmcnt(10)
v_mfma_f32_32x32x16_bf16 v[60:75], v[20:23], v[40:43], v[60:75]
ds_read_b64_tr_b16 v[36:37], v11 offset:2048
ds_read_b64_tr_b16 v[38:39], v11 offset:2560
ds_read_b128 v[40:43], v13 offset:2048
s_waitcnt lgkmcnt(10)
v_mfma_f32_32x32x16_bf16 v[60:75], v[24:27], v[44:47], v[60:75]
ds_read_b64_tr_b16 v[20:21], v11 offset:4096
ds_read_b64_tr_b16 v[22:23], v11 offset:4608
ds_read_b128 v[44:47], v13 offset:3072
s_waitcnt lgkmcnt(10)
v_mfma_f32_32x32x16_bf16 v[60:75], v[28:31], v[48:51], v[60:75]
ds_read_b64_tr_b16 v[24:25], v11 offset:6144
ds_read_b64_tr_b16 v[26:27], v11 offset:6656
s_waitcnt lgkmcnt(9)
v_mfma_f32_32x32x16_bf16 v[60:75], v[32:35], v[52:55], v[60:75]
s_waitcnt lgkmcnt(6)
v_mfma_f32_32x32x16_bf16 v[60:75], v[36:39], v[56:59], v[60:75]
s_waitcnt lgkmcnt(3)
v_mfma_f32_32x32x16_bf16 v[60:75], v[20:23], v[40:43], v[60:75]
s_waitcnt lgkmcnt(0)
v_mfma_f32_32x32x16_bf16 v[60:75], v[24:27], v[44:47], v[60:75]
s_nop 11
v_cvt_pk_bf16_f32 v76, v60, v61
v_cvt_pk_bf16_f32 v77, v62, v63
v_cvt_pk_bf16_f32 v78, v64, v65
v_cvt_pk_bf16_f32 v79, v66, v67
v_cvt_pk_bf16_f32 v80, v68, v69
v_cvt_pk_bf16_f32 v81, v70, v71
v_cvt_pk_bf16_f32 v82, v72, v73
v_cvt_pk_bf16_f32 v83, v74, v75
v_lshlrev_b32 v60, 16, v76
v_and_b32 v61, 0xffff0000, v76
v_lshlrev_b32 v62, 16, v77
v_and_b32 v63, 0xffff0000, v77
v_lshlrev_b32 v64, 16, v78
v_and_b32 v65, 0xffff0000, v78
v_lshlrev_b32 v66, 16, v79
v_and_b32 v67, 0xffff0000, v79
v_lshlrev_b32 v68, 16, v80
v_and_b32 v69, 0xffff0000, v80
v_lshlrev_b32 v70, 16, v81
v_and_b32 v71, 0xffff0000, v81
v_lshlrev_b32 v72, 16, v82
v_and_b32 v73, 0xffff0000, v82
v_lshlrev_b32 v74, 16, v83
v_and_b32 v75, 0xffff0000, v83
s_waitcnt vmcnt(3)
v_lshlrev_b32 v84, 16, v88
v_and_b32 v85, 0xffff0000, v88
v_add_f32 v60, v60, v84
v_add_f32 v61, v61, v85
v_lshlrev_b32 v84, 16, v89
v_and_b32 v85, 0xffff0000, v89
v_add_f32 v62, v62, v84
v_add_f32 v63, v63, v85
s_waitcnt vmcnt(2)
v_lshlrev_b32 v84, 16, v90
v_and_b32 v85, 0xffff0000, v90
v_add_f32 v64, v64, v84
v_add_f32 v65, v65, v85
v_lshlrev_b32 v84, 16, v91
v_and_b32 v85, 0xffff0000, v91
v_add_f32 v66, v66, v84
v_add_f32 v67, v67, v85
s_waitcnt vmcnt(1)
v_lshlrev_b32 v84, 16, v92
v_and_b32 v85, 0xffff0000, v92
v_add_f32 v68, v68, v84
v_add_f32 v69, v69, v85
v_lshlrev_b32 v84, 16, v93
v_and_b32 v85, 0xffff0000, v93
v_add_f32 v70, v70, v84
v_add_f32 v71, v71, v85
s_waitcnt vmcnt(0)
v_lshlrev_b32 v84, 16, v94
v_and_b32 v85, 0xffff0000, v94
v_add_f32 v72, v72, v84
v_add_f32 v73, v73, v85
v_lshlrev_b32 v84, 16, v95
v_and_b32 v85, 0xffff0000, v95
v_add_f32 v74, v74, v84
v_add_f32 v75, v75, v85
v_cvt_pk_bf16_f32 v76, v60, v61
v_cvt_pk_bf16_f32 v77, v62, v63
v_cvt_pk_bf16_f32 v78, v64, v65
v_cvt_pk_bf16_f32 v79, v66, v67
v_cvt_pk_bf16_f32 v80, v68, v69
v_cvt_pk_bf16_f32 v81, v70, v71
v_cvt_pk_bf16_f32 v82, v72, v73
v_cvt_pk_bf16_f32 v83, v74, v75
v_mov_b32 v96, 0
v_mov_b32 v97, 0
v_mov_b32 v60, 0
v_mov_b32 v61, 0
v_dot2_f32_bf16 v96, v76, s61, v96
v_dot2_f32_bf16 v97, v76, v76, v97
v_dot2_f32_bf16 v60, v77, s61, v60
v_dot2_f32_bf16 v61, v77, v77, v61
v_dot2_f32_bf16 v96, v78, s61, v96
v_dot2_f32_bf16 v97, v78, v78, v97
v_dot2_f32_bf16 v60, v79, s61, v60
v_dot2_f32_bf16 v61, v79, v79, v61
v_dot2_f32_bf16 v96, v80, s61, v96
v_dot2_f32_bf16 v97, v80, v80, v97
v_dot2_f32_bf16 v60, v81, s61, v60
v_dot2_f32_bf16 v61, v81, v81, v61
v_dot2_f32_bf16 v96, v82, s61, v96
v_dot2_f32_bf16 v97, v82, v82, v97
v_dot2_f32_bf16 v60, v83, s61, v60
v_dot2_f32_bf16 v61, v83, v83, v61
s_nop 1
v_add_f32 v96, v96, v60
v_add_f32 v97, v97, v61
v_permlane32_swap_b32 v76, v78
v_permlane32_swap_b32 v77, v79
v_permlane32_swap_b32 v80, v82
v_permlane32_swap_b32 v81, v83
s_lshl_b32 s10, s7, 5
s_lshr_b32 s11, s8, 5
s_add_u32 s10, s10, s11
s_lshl_b32 s10, s10, 10
s_add_u32 s10, s10, 10485760
buffer_store_dwordx4 v[76:79], v3, s[52:55], s10 offen
buffer_store_dwordx4 v[80:83], v3, s[52:55], s10 offen offset:1024
v_mov_b32 v84, v96
v_mov_b32 v85, v96
s_nop 1
v_permlane32_swap_b32 v84, v85
v_add_f32 v96, v84, v85
v_mov_b32 v86, v97
v_mov_b32 v87, v97
s_nop 1
v_permlane32_swap_b32 v86, v87
v_add_f32 v97, v86, v87
s_lshl_b32 s10, s5, 1
s_add_u32 s10, s10, 0
s_bfe_u32 s11, s10, 0x20001
s_lshl_b32 s12, s7, 2
s_add_u32 s12, s12, s11
s_lshl_b32 s12, s12, 10
s_lshr_b32 s11, s10, 3
s_lshl_b32 s11, s11, 9
s_add_u32 s12, s12, s11
s_and_b32 s11, s10, 1
s_lshl_b32 s11, s11, 3
s_add_u32 s12, s12, s11
s_add_u32 s12, s12, 14680064
s_mov_b64 exec, 0xffffffff
buffer_store_dwordx2 v[96:97], v3, s[52:55], s12 offen
s_mov_b64 exec, -1
s_waitcnt vmcnt(0)
s_branch k3_kernel_end
k3_kernel_w1:
s_lshl_b32 s7, s4, 1
s_add_u32 s7, s7, 0
s_lshl_b32 s8, s5, 7
s_add_u32 s8, s8, 64
s_lshl_b32 s9, s7, 15
s_add_u32 s9, s9, s8
v_and_b32 v86, 31, v1
v_lshlrev_b32 v86, 10, v86
v_lshl_add_u32 v86, v5, 3, v86
buffer_load_dwordx2 v[88:89], v86, s[56:59], s9 offen offset:0
buffer_load_dwordx2 v[90:91], v86, s[56:59], s9 offen offset:16
buffer_load_dwordx2 v[92:93], v86, s[56:59], s9 offen offset:32
buffer_load_dwordx2 v[94:95], v86, s[56:59], s9 offen offset:48
v_lshrrev_b32 v14, 1, v8
v_lshl_add_u32 v14, v6, 1, v14
v_add_u32 v14, 4, v14
v_bfe_u32 v15, v4, 3, 1
v_lshlrev_b32 v15, 2, v15
v_xor_b32 v14, v14, v15
v_lshlrev_b32 v14, 4, v14
v_and_b32 v15, 1, v4
v_lshl_add_u32 v14, v15, 3, v14
v_lshl_add_u32 v9, v7, 7, v14
s_barrier
v_add_u32 v10, 8192, v9
v_add_u32 v12, 0, v3
ds_read_b128 v[40:43], v12 offset:0
ds_read_b64_tr_b16 v[20:21], v10 offset:0
ds_read_b64_tr_b16 v[22:23], v10 offset:512
ds_read_b128 v[44:47], v12 offset:1024
ds_read_b64_tr_b16 v[24:25], v10 offset:2048
ds_read_b64_tr_b16 v[26:27], v10 offset:2560
ds_read_b128 v[48:51], v12 offset:2048
ds_read_b64_tr_b16 v[28:29], v10 offset:4096
ds_read_b64_tr_b16 v[30:31], v10 offset:4608
ds_read_b128 v[52:55], v12 offset:3072
ds_read_b64_tr_b16 v[32:33], v10 offset:6144
ds_read_b64_tr_b16 v[34:35], v10 offset:6656
s_barrier
v_add_u32 v11, 24576, v9
v_add_u32 v13, 16384, v3
ds_read_b128 v[56:59], v13 offset:0
s_waitcnt lgkmcnt(10)
v_mfma_f32_32x32x16_bf16 v[60:75], v[20:23], v[40:43], 0
ds_read_b64_tr_b16 v[36:37], v11 offset:0
ds_read_b64_tr_b16 v[38:39], v11 offset:512
ds_read_b128 v[40:43], v13 offset:1024
s_waitcnt lgkmcnt(10)
v_mfma_f32_32x32x16_bf16 v[60:75], v[24:27], v[44:47], v[60:75]
ds_read_b64_tr_b16 v[20:21], v11 offset:2048
ds_read_b64_tr_b16 v[22:23], v11 offset:2560
ds_read_b128 v[44:47], v13 offset:2048
s_waitcnt lgkmcnt(10)
v_mfma_f32_32x32x16_bf16 v[60:75], v[28:31], v[48:51], v[60:75]
ds_read_b64_tr_b16 v[24:25], v11 offset:4096
ds_read_b64_tr_b16 v[26:27], v11 offset:4608
ds_read_b128 v[48:51], v13 offset:3072
s_waitcnt lgkmcnt(10)
v_mfma_f32_32x32x16_bf16 v[60:75], v[32:35], v[52:55], v[60:75]
ds_read_b64_tr_b16 v[28:29], v11 offset:6144
ds_read_b64_tr_b16 v[30:31], v11 offset:6656
s_barrier
v_add_u32 v10, 40960, v9
v_add_u32 v12, 32768, v3
ds_read_b128 v[52:55], v12 offset:0
s_waitcnt lgkmcnt(10)
v_mfma_f32_32x32x16_bf16 v[60:75], v[36:39], v[56:59], v[60:75]
ds_read_b64_tr_b16 v[32:33], v10 offset:0
ds_read_b64_tr_b16 v[34:35], v10 offset:512
ds_read_b128 v[56:59], v12 offset:1024
s_waitcnt lgkmcnt(10)
v_mfma_f32_32x32x16_bf16 v[60:75], v[20:23], v[40:43], v[60:75]
ds_read_b64_tr_b16 v[36:37], v10 offset:2048
ds_read_b64_tr_b16 v[38:39], v10 offset:2560
ds_read_b128 v[40:43], v12 offset:2048
s_waitcnt lgkmcnt(10)
v_mfma_f32_32x32x16_bf16 v[60:75], v[24:27], v[44:47], v[60:75]
ds_read_b64_tr_b16 v[20:21], v10 offset:4096
ds_read_b64_tr_b16 v[22:23], v10 offset:4608
ds_read_b128 v[44:47], v12 offset:3072
s_waitcnt lgkmcnt(10)
v_mfma_f32_32x32x16_bf16 v[60:75], v[28:31], v[48:51], v[60:75]
ds_read_b64_tr_b16 v[24:25], v10 offset:6144
ds_read_b64_tr_b16 v[26:27], v10 offset:6656
s_barrier
v_add_u32 v11, 57344, v9
v_add_u32 v13, 49152, v3
ds_read_b128 v[48:51], v13 offset:0
s_waitcnt lgkmcnt(10)
v_mfma_f32_32x32x16_bf16 v[60:75], v[32:35], v[52:55], v[60:75]
ds_read_b64_tr_b16 v[28:29], v11 offset:0
ds_read_b64_tr_b16 v[30:31], v11 offset:512
ds_read_b128 v[52:55], v13 offset:1024
s_waitcnt lgkmcnt(10)
v_mfma_f32_32x32x16_bf16 v[60:75], v[36:39], v[56:59], v[60:75]
ds_read_b64_tr_b16 v[32:33], v11 offset:2048
ds_read_b64_tr_b16 v[34:35], v11 offset:2560
ds_read_b128 v[56:59], v13 offset:2048
s_waitcnt lgkmcnt(10)
v_mfma_f32_32x32x16_bf16 v[60:75], v[20:23], v[40:43], v[60:75]
ds_read_b64_tr_b16 v[36:37], v11 offset:4096
ds_read_b64_tr_b16 v[38:39], v11 offset:4608
ds_read_b128 v[40:43], v13 offset:3072
s_waitcnt lgkmcnt(10)
v_mfma_f32_32x32x16_bf16 v[60:75], v[24:27], v[44:47], v[60:75]
ds_read_b64_tr_b16 v[20:21], v11 offset:6144
ds_read_b64_tr_b16 v[22:23], v11 offset:6656
s_barrier
v_add_u32 v10, 73728, v9
v_add_u32 v12, 65536, v3
ds_read_b128 v[44:47], v12 offset:0
s_waitcnt lgkmcnt(10)
v_mfma_f32_32x32x16_bf16 v[60:75], v[28:31], v[48:51], v[60:75]
ds_read_b64_tr_b16 v[24:25], v10 offset:0
ds_read_b64_tr_b16 v[26:27], v10 offset:512
ds_read_b128 v[48:51], v12 offset:1024
s_waitcnt lgkmcnt(10)
v_mfma_f32_32x32x16_bf16 v[60:75], v[32:35], v[52:55], v[60:75]
ds_read_b64_tr_b16 v[28:29], v10 offset:2048
ds_read_b64_tr_b16 v[30:31], v10 offset:2560
ds_read_b128 v[52:55], v12 offset:2048
s_waitcnt lgkmcnt(10)
v_mfma_f32_32x32x16_bf16 v[60:75], v[36:39], v[56:59], v[60:75]
ds_read_b64_tr_b16 v[32:33], v10 offset:4096
ds_read_b64_tr_b16 v[34:35], v10 offset:4608
ds_read_b128 v[56:59], v12 offset:3072
s_waitcnt lgkmcnt(10)
v_mfma_f32_32x32x16_bf16 v[60:75], v[20:23], v[40:43], v[60:75]
ds_read_b64_tr_b16 v[36:37], v10 offset:6144
ds_read_b64_tr_b16 v[38:39], v10 offset:6656
s_barrier
v_add_u32 v11, 90112, v9
v_add_u32 v13, 81920, v3
ds_read_b128 v[40:43], v13 offset:0
s_waitcnt lgkmcnt(10)
v_mfma_f32_32x32x16_bf16 v[60:75], v[24:27], v[44:47], v[60:75]
ds_read_b64_tr_b16 v[20:21], v11 offset:0
ds_read_b64_tr_b16 v[22:23], v11 offset:512
ds_read_b128 v[44:47], v13 offset:1024
s_waitcnt lgkmcnt(10)
v_mfma_f32_32x32x16_bf16 v[60:75], v[28:31], v[48:51], v[60:75]
ds_read_b64_tr_b16 v[24:25], v11 offset:2048
ds_read_b64_tr_b16 v[26:27], v11 offset:2560
ds_read_b128 v[48:51], v13 offset:2048
s_waitcnt lgkmcnt(10)
v_mfma_f32_32x32x16_bf16 v[60:75], v[32:35], v[52:55], v[60:75]
ds_read_b64_tr_b16 v[28:29], v11 offset:4096
ds_read_b64_tr_b16 v[30:31], v11 offset:4608
ds_read_b128 v[52:55], v13 offset:3072
s_waitcnt lgkmcnt(10)
v_mfma_f32_32x32x16_bf16 v[60:75], v[36:39], v[56:59], v[60:75]
ds_read_b64_tr_b16 v[32:33], v11 offset:6144
ds_read_b64_tr_b16 v[34:35], v11 offset:6656
s_barrier
v_add_u32 v10, 106496, v9
v_add_u32 v12, 98304, v3
ds_read_b128 v[56:59], v12 offset:0
s_waitcnt lgkmcnt(10)
v_mfma_f32_32x32x16_bf16 v[60:75], v[20:23], v[40:43], v[60:75]
ds_read_b64_tr_b16 v[36:37], v10 offset:0
ds_read_b64_tr_b16 v[38:39], v10 offset:512
ds_read_b128 v[40:43], v12 offset:1024
s_waitcnt lgkmcnt(10)
v_mfma_f32_32x32x16_bf16 v[60:75], v[24:27], v[44:47], v[60:75]
ds_read_b64_tr_b16 v[20:21], v10 offset:2048
ds_read_b64_tr_b16 v[22:23], v10 offset:2560
ds_read_b128 v[44:47], v12 offset:2048
s_waitcnt lgkmcnt(10)
v_mfma_f32_32x32x16_bf16 v[60:75], v[28:31], v[48:51], v[60:75]
ds_read_b64_tr_b16 v[24:25], v10 offset:4096
ds_read_b64_tr_b16 v[26:27], v10 offset:4608
ds_read_b128 v[48:51], v12 offset:3072
s_waitcnt lgkmcnt(10)
v_mfma_f32_32x32x16_bf16 v[60:75], v[32:35], v[52:55], v[60:75]
ds_read_b64_tr_b16 v[28:29], v10 offset:6144
ds_read_b64_tr_b16 v[30:31], v10 offset:6656
s_barrier
v_add_u32 v11, 122880, v9
v_add_u32 v13, 114688, v3
ds_read_b128 v[52:55], v13 offset:0
s_waitcnt lgkmcnt(10)
v_mfma_f32_32x32x16_bf16 v[60:75], v[36:39], v[56:59], v[60:75]
ds_read_b64_tr_b16 v[32:33], v11 offset:0
ds_read_b64_tr_b16 v[34:35], v11 offset:512
ds_read_b128 v[56:59], v13 offset:1024
s_waitcnt lgkmcnt(10)
v_mfma_f32_32x32x16_bf16 v[60:75], v[20:23], v[40:43], v[60:75]
ds_read_b64_tr_b16 v[36:37], v11 offset:2048
ds_read_b64_tr_b16 v[38:39], v11 offset:2560
ds_read_b128 v[40:43], v13 offset:2048
s_waitcnt lgkmcnt(10)
v_mfma_f32_32x32x16_bf16 v[60:75], v[24:27], v[44:47], v[60:75]
ds_read_b64_tr_b16 v[20:21], v11 offset:4096
ds_read_b64_tr_b16 v[22:23], v11 offset:4608
ds_read_b128 v[44:47], v13 offset:3072
s_waitcnt lgkmcnt(10)
v_mfma_f32_32x32x16_bf16 v[60:75], v[28:31], v[48:51], v[60:75]
ds_read_b64_tr_b16 v[24:25], v11 offset:6144
ds_read_b64_tr_b16 v[26:27], v11 offset:6656
s_waitcnt lgkmcnt(9)
v_mfma_f32_32x32x16_bf16 v[60:75], v[32:35], v[52:55], v[60:75]
s_waitcnt lgkmcnt(6)
v_mfma_f32_32x32x16_bf16 v[60:75], v[36:39], v[56:59], v[60:75]
s_waitcnt lgkmcnt(3)
v_mfma_f32_32x32x16_bf16 v[60:75], v[20:23], v[40:43], v[60:75]
s_waitcnt lgkmcnt(0)
v_mfma_f32_32x32x16_bf16 v[60:75], v[24:27], v[44:47], v[60:75]
s_nop 11
v_cvt_pk_bf16_f32 v76, v60, v61
v_cvt_pk_bf16_f32 v77, v62, v63
v_cvt_pk_bf16_f32 v78, v64, v65
v_cvt_pk_bf16_f32 v79, v66, v67
v_cvt_pk_bf16_f32 v80, v68, v69
v_cvt_pk_bf16_f32 v81, v70, v71
v_cvt_pk_bf16_f32 v82, v72, v73
v_cvt_pk_bf16_f32 v83, v74, v75
v_lshlrev_b32 v60, 16, v76
v_and_b32 v61, 0xffff0000, v76
v_lshlrev_b32 v62, 16, v77
v_and_b32 v63, 0xffff0000, v77
v_lshlrev_b32 v64, 16, v78
v_and_b32 v65, 0xffff0000, v78
v_lshlrev_b32 v66, 16, v79
v_and_b32 v67, 0xffff0000, v79
v_lshlrev_b32 v68, 16, v80
v_and_b32 v69, 0xffff0000, v80
v_lshlrev_b32 v70, 16, v81
v_and_b32 v71, 0xffff0000, v81
v_lshlrev_b32 v72, 16, v82
v_and_b32 v73, 0xffff0000, v82
v_lshlrev_b32 v74, 16, v83
v_and_b32 v75, 0xffff0000, v83
s_waitcnt vmcnt(3)
v_lshlrev_b32 v84, 16, v88
v_and_b32 v85, 0xffff0000, v88
v_add_f32 v60, v60, v84
v_add_f32 v61, v61, v85
v_lshlrev_b32 v84, 16, v89
v_and_b32 v85, 0xffff0000, v89
v_add_f32 v62, v62, v84
v_add_f32 v63, v63, v85
s_waitcnt vmcnt(2)
v_lshlrev_b32 v84, 16, v90
v_and_b32 v85, 0xffff0000, v90
v_add_f32 v64, v64, v84
v_add_f32 v65, v65, v85
v_lshlrev_b32 v84, 16, v91
v_and_b32 v85, 0xffff0000, v91
v_add_f32 v66, v66, v84
v_add_f32 v67, v67, v85
s_waitcnt vmcnt(1)
v_lshlrev_b32 v84, 16, v92
v_and_b32 v85, 0xffff0000, v92
v_add_f32 v68, v68, v84
v_add_f32 v69, v69, v85
v_lshlrev_b32 v84, 16, v93
v_and_b32 v85, 0xffff0000, v93
v_add_f32 v70, v70, v84
v_add_f32 v71, v71, v85
s_waitcnt vmcnt(0)
v_lshlrev_b32 v84, 16, v94
v_and_b32 v85, 0xffff0000, v94
v_add_f32 v72, v72, v84
v_add_f32 v73, v73, v85
v_lshlrev_b32 v84, 16, v95
v_and_b32 v85, 0xffff0000, v95
v_add_f32 v74, v74, v84
v_add_f32 v75, v75, v85
v_cvt_pk_bf16_f32 v76, v60, v61
v_cvt_pk_bf16_f32 v77, v62, v63
v_cvt_pk_bf16_f32 v78, v64, v65
v_cvt_pk_bf16_f32 v79, v66, v67
v_cvt_pk_bf16_f32 v80, v68, v69
v_cvt_pk_bf16_f32 v81, v70, v71
v_cvt_pk_bf16_f32 v82, v72, v73
v_cvt_pk_bf16_f32 v83, v74, v75
v_mov_b32 v96, 0
v_mov_b32 v97, 0
v_mov_b32 v60, 0
v_mov_b32 v61, 0
v_dot2_f32_bf16 v96, v76, s61, v96
v_dot2_f32_bf16 v97, v76, v76, v97
v_dot2_f32_bf16 v60, v77, s61, v60
v_dot2_f32_bf16 v61, v77, v77, v61
v_dot2_f32_bf16 v96, v78, s61, v96
v_dot2_f32_bf16 v97, v78, v78, v97
v_dot2_f32_bf16 v60, v79, s61, v60
v_dot2_f32_bf16 v61, v79, v79, v61
v_dot2_f32_bf16 v96, v80, s61, v96
v_dot2_f32_bf16 v97, v80, v80, v97
v_dot2_f32_bf16 v60, v81, s61, v60
v_dot2_f32_bf16 v61, v81, v81, v61
v_dot2_f32_bf16 v96, v82, s61, v96
v_dot2_f32_bf16 v97, v82, v82, v97
v_dot2_f32_bf16 v60, v83, s61, v60
v_dot2_f32_bf16 v61, v83, v83, v61
s_nop 1
v_add_f32 v96, v96, v60
v_add_f32 v97, v97, v61
v_permlane32_swap_b32 v76, v78
v_permlane32_swap_b32 v77, v79
v_permlane32_swap_b32 v80, v82
v_permlane32_swap_b32 v81, v83
s_lshl_b32 s10, s7, 5
s_lshr_b32 s11, s8, 5
s_add_u32 s10, s10, s11
s_lshl_b32 s10, s10, 10
s_add_u32 s10, s10, 10485760
buffer_store_dwordx4 v[76:79], v3, s[52:55], s10 offen
buffer_store_dwordx4 v[80:83], v3, s[52:55], s10 offen offset:1024
v_mov_b32 v84, v96
v_mov_b32 v85, v96
s_nop 1
v_permlane32_swap_b32 v84, v85
v_add_f32 v96, v84, v85
v_mov_b32 v86, v97
v_mov_b32 v87, v97
s_nop 1
v_permlane32_swap_b32 v86, v87
v_add_f32 v97, v86, v87
s_lshl_b32 s10, s5, 1
s_add_u32 s10, s10, 1
s_bfe_u32 s11, s10, 0x20001
s_lshl_b32 s12, s7, 2
s_add_u32 s12, s12, s11
s_lshl_b32 s12, s12, 10
s_lshr_b32 s11, s10, 3
s_lshl_b32 s11, s11, 9
s_add_u32 s12, s12, s11
s_and_b32 s11, s10, 1
s_lshl_b32 s11, s11, 3
s_add_u32 s12, s12, s11
s_add_u32 s12, s12, 14680064
s_mov_b64 exec, 0xffffffff
buffer_store_dwordx2 v[96:97], v3, s[52:55], s12 offen
s_mov_b64 exec, -1
s_waitcnt vmcnt(0)
s_branch k3_kernel_end
k3_kernel_w2:
s_lshl_b32 s7, s4, 1
s_add_u32 s7, s7, 1
s_lshl_b32 s8, s5, 7
s_add_u32 s8, s8, 0
s_lshl_b32 s9, s7, 15
s_add_u32 s9, s9, s8
v_and_b32 v86, 31, v1
v_lshlrev_b32 v86, 10, v86
v_lshl_add_u32 v86, v5, 3, v86
buffer_load_dwordx2 v[88:89], v86, s[56:59], s9 offen offset:0
buffer_load_dwordx2 v[90:91], v86, s[56:59], s9 offen offset:16
buffer_load_dwordx2 v[92:93], v86, s[56:59], s9 offen offset:32
buffer_load_dwordx2 v[94:95], v86, s[56:59], s9 offen offset:48
v_lshrrev_b32 v14, 1, v8
v_lshl_add_u32 v14, v6, 1, v14
v_add_u32 v14, 0, v14
v_bfe_u32 v15, v4, 3, 1
v_lshlrev_b32 v15, 2, v15
v_xor_b32 v14, v14, v15
v_lshlrev_b32 v14, 4, v14
v_and_b32 v15, 1, v4
v_lshl_add_u32 v14, v15, 3, v14
v_lshl_add_u32 v9, v7, 7, v14
s_barrier
v_add_u32 v10, 8192, v9
v_add_u32 v12, 4096, v3
ds_read_b128 v[40:43], v12 offset:0
ds_read_b64_tr_b16 v[20:21], v10 offset:0
ds_read_b64_tr_b16 v[22:23], v10 offset:512
ds_read_b128 v[44:47], v12 offset:1024
ds_read_b64_tr_b16 v[24:25], v10 offset:2048
ds_read_b64_tr_b16 v[26:27], v10 offset:2560
ds_read_b128 v[48:51], v12 offset:2048
ds_read_b64_tr_b16 v[28:29], v10 offset:4096
ds_read_b64_tr_b16 v[30:31], v10 offset:4608
ds_read_b128 v[52:55], v12 offset:3072
ds_read_b64_tr_b16 v[32:33], v10 offset:6144
ds_read_b64_tr_b16 v[34:35], v10 offset:6656
s_barrier
v_add_u32 v11, 24576, v9
v_add_u32 v13, 20480, v3
ds_read_b128 v[56:59], v13 offset:0
s_waitcnt lgkmcnt(10)
v_mfma_f32_32x32x16_bf16 v[60:75], v[20:23], v[40:43], 0
ds_read_b64_tr_b16 v[36:37], v11 offset:0
ds_read_b64_tr_b16 v[38:39], v11 offset:512
ds_read_b128 v[40:43], v13 offset:1024
s_waitcnt lgkmcnt(10)
v_mfma_f32_32x32x16_bf16 v[60:75], v[24:27], v[44:47], v[60:75]
ds_read_b64_tr_b16 v[20:21], v11 offset:2048
ds_read_b64_tr_b16 v[22:23], v11 offset:2560
ds_read_b128 v[44:47], v13 offset:2048
s_waitcnt lgkmcnt(10)
v_mfma_f32_32x32x16_bf16 v[60:75], v[28:31], v[48:51], v[60:75]
ds_read_b64_tr_b16 v[24:25], v11 offset:4096
ds_read_b64_tr_b16 v[26:27], v11 offset:4608
ds_read_b128 v[48:51], v13 offset:3072
s_waitcnt lgkmcnt(10)
v_mfma_f32_32x32x16_bf16 v[60:75], v[32:35], v[52:55], v[60:75]
ds_read_b64_tr_b16 v[28:29], v11 offset:6144
ds_read_b64_tr_b16 v[30:31], v11 offset:6656
s_barrier
v_add_u32 v10, 40960, v9
v_add_u32 v12, 36864, v3
ds_read_b128 v[52:55], v12 offset:0
s_waitcnt lgkmcnt(10)
v_mfma_f32_32x32x16_bf16 v[60:75], v[36:39], v[56:59], v[60:75]
ds_read_b64_tr_b16 v[32:33], v10 offset:0
ds_read_b64_tr_b16 v[34:35], v10 offset:512
ds_read_b128 v[56:59], v12 offset:1024
s_waitcnt lgkmcnt(10)
v_mfma_f32_32x32x16_bf16 v[60:75], v[20:23], v[40:43], v[60:75]
ds_read_b64_tr_b16 v[36:37], v10 offset:2048
ds_read_b64_tr_b16 v[38:39], v10 offset:2560
ds_read_b128 v[40:43], v12 offset:2048
s_waitcnt lgkmcnt(10)
v_mfma_f32_32x32x16_bf16 v[60:75], v[24:27], v[44:47], v[60:75]
ds_read_b64_tr_b16 v[20:21], v10 offset:4096
ds_read_b64_tr_b16 v[22:23], v10 offset:4608
ds_read_b128 v[44:47], v12 offset:3072
s_waitcnt lgkmcnt(10)
v_mfma_f32_32x32x16_bf16 v[60:75], v[28:31], v[48:51], v[60:75]
ds_read_b64_tr_b16 v[24:25], v10 offset:6144
ds_read_b64_tr_b16 v[26:27], v10 offset:6656
s_barrier
v_add_u32 v11, 57344, v9
v_add_u32 v13, 53248, v3
ds_read_b128 v[48:51], v13 offset:0
s_waitcnt lgkmcnt(10)
v_mfma_f32_32x32x16_bf16 v[60:75], v[32:35], v[52:55], v[60:75]
ds_read_b64_tr_b16 v[28:29], v11 offset:0
ds_read_b64_tr_b16 v[30:31], v11 offset:512
ds_read_b128 v[52:55], v13 offset:1024
s_waitcnt lgkmcnt(10)
v_mfma_f32_32x32x16_bf16 v[60:75], v[36:39], v[56:59], v[60:75]
ds_read_b64_tr_b16 v[32:33], v11 offset:2048
ds_read_b64_tr_b16 v[34:35], v11 offset:2560
ds_read_b128 v[56:59], v13 offset:2048
s_waitcnt lgkmcnt(10)
v_mfma_f32_32x32x16_bf16 v[60:75], v[20:23], v[40:43], v[60:75]
ds_read_b64_tr_b16 v[36:37], v11 offset:4096
ds_read_b64_tr_b16 v[38:39], v11 offset:4608
ds_read_b128 v[40:43], v13 offset:3072
s_waitcnt lgkmcnt(10)
v_mfma_f32_32x32x16_bf16 v[60:75], v[24:27], v[44:47], v[60:75]
ds_read_b64_tr_b16 v[20:21], v11 offset:6144
ds_read_b64_tr_b16 v[22:23], v11 offset:6656
s_barrier
v_add_u32 v10, 73728, v9
v_add_u32 v12, 69632, v3
ds_read_b128 v[44:47], v12 offset:0
s_waitcnt lgkmcnt(10)
v_mfma_f32_32x32x16_bf16 v[60:75], v[28:31], v[48:51], v[60:75]
ds_read_b64_tr_b16 v[24:25], v10 offset:0
ds_read_b64_tr_b16 v[26:27], v10 offset:512
ds_read_b128 v[48:51], v12 offset:1024
s_waitcnt lgkmcnt(10)
v_mfma_f32_32x32x16_bf16 v[60:75], v[32:35], v[52:55], v[60:75]
ds_read_b64_tr_b16 v[28:29], v10 offset:2048
ds_read_b64_tr_b16 v[30:31], v10 offset:2560
ds_read_b128 v[52:55], v12 offset:2048
s_waitcnt lgkmcnt(10)
v_mfma_f32_32x32x16_bf16 v[60:75], v[36:39], v[56:59], v[60:75]
ds_read_b64_tr_b16 v[32:33], v10 offset:4096
ds_read_b64_tr_b16 v[34:35], v10 offset:4608
ds_read_b128 v[56:59], v12 offset:3072
s_waitcnt lgkmcnt(10)
v_mfma_f32_32x32x16_bf16 v[60:75], v[20:23], v[40:43], v[60:75]
ds_read_b64_tr_b16 v[36:37], v10 offset:6144
ds_read_b64_tr_b16 v[38:39], v10 offset:6656
s_barrier
v_add_u32 v11, 90112, v9
v_add_u32 v13, 86016, v3
ds_read_b128 v[40:43], v13 offset:0
s_waitcnt lgkmcnt(10)
v_mfma_f32_32x32x16_bf16 v[60:75], v[24:27], v[44:47], v[60:75]
ds_read_b64_tr_b16 v[20:21], v11 offset:0
ds_read_b64_tr_b16 v[22:23], v11 offset:512
ds_read_b128 v[44:47], v13 offset:1024
s_waitcnt lgkmcnt(10)
v_mfma_f32_32x32x16_bf16 v[60:75], v[28:31], v[48:51], v[60:75]
ds_read_b64_tr_b16 v[24:25], v11 offset:2048
ds_read_b64_tr_b16 v[26:27], v11 offset:2560
ds_read_b128 v[48:51], v13 offset:2048
s_waitcnt lgkmcnt(10)
v_mfma_f32_32x32x16_bf16 v[60:75], v[32:35], v[52:55], v[60:75]
ds_read_b64_tr_b16 v[28:29], v11 offset:4096
ds_read_b64_tr_b16 v[30:31], v11 offset:4608
ds_read_b128 v[52:55], v13 offset:3072
s_waitcnt lgkmcnt(10)
v_mfma_f32_32x32x16_bf16 v[60:75], v[36:39], v[56:59], v[60:75]
ds_read_b64_tr_b16 v[32:33], v11 offset:6144
ds_read_b64_tr_b16 v[34:35], v11 offset:6656
s_barrier
v_add_u32 v10, 106496, v9
v_add_u32 v12, 102400, v3
ds_read_b128 v[56:59], v12 offset:0
s_waitcnt lgkmcnt(10)
v_mfma_f32_32x32x16_bf16 v[60:75], v[20:23], v[40:43], v[60:75]
ds_read_b64_tr_b16 v[36:37], v10 offset:0
ds_read_b64_tr_b16 v[38:39], v10 offset:512
ds_read_b128 v[40:43], v12 offset:1024
s_waitcnt lgkmcnt(10)
v_mfma_f32_32x32x16_bf16 v[60:75], v[24:27], v[44:47], v[60:75]
ds_read_b64_tr_b16 v[20:21], v10 offset:2048
ds_read_b64_tr_b16 v[22:23], v10 offset:2560
ds_read_b128 v[44:47], v12 offset:2048
s_waitcnt lgkmcnt(10)
v_mfma_f32_32x32x16_bf16 v[60:75], v[28:31], v[48:51], v[60:75]
ds_read_b64_tr_b16 v[24:25], v10 offset:4096
ds_read_b64_tr_b16 v[26:27], v10 offset:4608
ds_read_b128 v[48:51], v12 offset:3072
s_waitcnt lgkmcnt(10)
v_mfma_f32_32x32x16_bf16 v[60:75], v[32:35], v[52:55], v[60:75]
ds_read_b64_tr_b16 v[28:29], v10 offset:6144
ds_read_b64_tr_b16 v[30:31], v10 offset:6656
s_barrier
v_add_u32 v11, 122880, v9
v_add_u32 v13, 118784, v3
ds_read_b128 v[52:55], v13 offset:0
s_waitcnt lgkmcnt(10)
v_mfma_f32_32x32x16_bf16 v[60:75], v[36:39], v[56:59], v[60:75]
ds_read_b64_tr_b16 v[32:33], v11 offset:0
ds_read_b64_tr_b16 v[34:35], v11 offset:512
ds_read_b128 v[56:59], v13 offset:1024
s_waitcnt lgkmcnt(10)
v_mfma_f32_32x32x16_bf16 v[60:75], v[20:23], v[40:43], v[60:75]
ds_read_b64_tr_b16 v[36:37], v11 offset:2048
ds_read_b64_tr_b16 v[38:39], v11 offset:2560
ds_read_b128 v[40:43], v13 offset:2048
s_waitcnt lgkmcnt(10)
v_mfma_f32_32x32x16_bf16 v[60:75], v[24:27], v[44:47], v[60:75]
ds_read_b64_tr_b16 v[20:21], v11 offset:4096
ds_read_b64_tr_b16 v[22:23], v11 offset:4608
ds_read_b128 v[44:47], v13 offset:3072
s_waitcnt lgkmcnt(10)
v_mfma_f32_32x32x16_bf16 v[60:75], v[28:31], v[48:51], v[60:75]
ds_read_b64_tr_b16 v[24:25], v11 offset:6144
ds_read_b64_tr_b16 v[26:27], v11 offset:6656
s_waitcnt lgkmcnt(9)
v_mfma_f32_32x32x16_bf16 v[60:75], v[32:35], v[52:55], v[60:75]
s_waitcnt lgkmcnt(6)
v_mfma_f32_32x32x16_bf16 v[60:75], v[36:39], v[56:59], v[60:75]
s_waitcnt lgkmcnt(3)
v_mfma_f32_32x32x16_bf16 v[60:75], v[20:23], v[40:43], v[60:75]
s_waitcnt lgkmcnt(0)
v_mfma_f32_32x32x16_bf16 v[60:75], v[24:27], v[44:47], v[60:75]
s_nop 11
v_cvt_pk_bf16_f32 v76, v60, v61
v_cvt_pk_bf16_f32 v77, v62, v63
v_cvt_pk_bf16_f32 v78, v64, v65
v_cvt_pk_bf16_f32 v79, v66, v67
v_cvt_pk_bf16_f32 v80, v68, v69
v_cvt_pk_bf16_f32 v81, v70, v71
v_cvt_pk_bf16_f32 v82, v72, v73
v_cvt_pk_bf16_f32 v83, v74, v75
v_lshlrev_b32 v60, 16, v76
v_and_b32 v61, 0xffff0000, v76
v_lshlrev_b32 v62, 16, v77
v_and_b32 v63, 0xffff0000, v77
v_lshlrev_b32 v64, 16, v78
v_and_b32 v65, 0xffff0000, v78
v_lshlrev_b32 v66, 16, v79
v_and_b32 v67, 0xffff0000, v79
v_lshlrev_b32 v68, 16, v80
v_and_b32 v69, 0xffff0000, v80
v_lshlrev_b32 v70, 16, v81
v_and_b32 v71, 0xffff0000, v81
v_lshlrev_b32 v72, 16, v82
v_and_b32 v73, 0xffff0000, v82
v_lshlrev_b32 v74, 16, v83
v_and_b32 v75, 0xffff0000, v83
s_waitcnt vmcnt(3)
v_lshlrev_b32 v84, 16, v88
v_and_b32 v85, 0xffff0000, v88
v_add_f32 v60, v60, v84
v_add_f32 v61, v61, v85
v_lshlrev_b32 v84, 16, v89
v_and_b32 v85, 0xffff0000, v89
v_add_f32 v62, v62, v84
v_add_f32 v63, v63, v85
s_waitcnt vmcnt(2)
v_lshlrev_b32 v84, 16, v90
v_and_b32 v85, 0xffff0000, v90
v_add_f32 v64, v64, v84
v_add_f32 v65, v65, v85
v_lshlrev_b32 v84, 16, v91
v_and_b32 v85, 0xffff0000, v91
v_add_f32 v66, v66, v84
v_add_f32 v67, v67, v85
s_waitcnt vmcnt(1)
v_lshlrev_b32 v84, 16, v92
v_and_b32 v85, 0xffff0000, v92
v_add_f32 v68, v68, v84
v_add_f32 v69, v69, v85
v_lshlrev_b32 v84, 16, v93
v_and_b32 v85, 0xffff0000, v93
v_add_f32 v70, v70, v84
v_add_f32 v71, v71, v85
s_waitcnt vmcnt(0)
v_lshlrev_b32 v84, 16, v94
v_and_b32 v85, 0xffff0000, v94
v_add_f32 v72, v72, v84
v_add_f32 v73, v73, v85
v_lshlrev_b32 v84, 16, v95
v_and_b32 v85, 0xffff0000, v95
v_add_f32 v74, v74, v84
v_add_f32 v75, v75, v85
v_cvt_pk_bf16_f32 v76, v60, v61
v_cvt_pk_bf16_f32 v77, v62, v63
v_cvt_pk_bf16_f32 v78, v64, v65
v_cvt_pk_bf16_f32 v79, v66, v67
v_cvt_pk_bf16_f32 v80, v68, v69
v_cvt_pk_bf16_f32 v81, v70, v71
v_cvt_pk_bf16_f32 v82, v72, v73
v_cvt_pk_bf16_f32 v83, v74, v75
v_mov_b32 v96, 0
v_mov_b32 v97, 0
v_mov_b32 v60, 0
v_mov_b32 v61, 0
v_dot2_f32_bf16 v96, v76, s61, v96
v_dot2_f32_bf16 v97, v76, v76, v97
v_dot2_f32_bf16 v60, v77, s61, v60
v_dot2_f32_bf16 v61, v77, v77, v61
v_dot2_f32_bf16 v96, v78, s61, v96
v_dot2_f32_bf16 v97, v78, v78, v97
v_dot2_f32_bf16 v60, v79, s61, v60
v_dot2_f32_bf16 v61, v79, v79, v61
v_dot2_f32_bf16 v96, v80, s61, v96
v_dot2_f32_bf16 v97, v80, v80, v97
v_dot2_f32_bf16 v60, v81, s61, v60
v_dot2_f32_bf16 v61, v81, v81, v61
v_dot2_f32_bf16 v96, v82, s61, v96
v_dot2_f32_bf16 v97, v82, v82, v97
v_dot2_f32_bf16 v60, v83, s61, v60
v_dot2_f32_bf16 v61, v83, v83, v61
s_nop 1
v_add_f32 v96, v96, v60
v_add_f32 v97, v97, v61
v_permlane32_swap_b32 v76, v78
v_permlane32_swap_b32 v77, v79
v_permlane32_swap_b32 v80, v82
v_permlane32_swap_b32 v81, v83
s_lshl_b32 s10, s7, 5
s_lshr_b32 s11, s8, 5
s_add_u32 s10, s10, s11
s_lshl_b32 s10, s10, 10
s_add_u32 s10, s10, 10485760
buffer_store_dwordx4 v[76:79], v3, s[52:55], s10 offen
buffer_store_dwordx4 v[80:83], v3, s[52:55], s10 offen offset:1024
v_mov_b32 v84, v96
v_mov_b32 v85, v96
s_nop 1
v_permlane32_swap_b32 v84, v85
v_add_f32 v96, v84, v85
v_mov_b32 v86, v97
v_mov_b32 v87, v97
s_nop 1
v_permlane32_swap_b32 v86, v87
v_add_f32 v97, v86, v87
s_lshl_b32 s10, s5, 1
s_add_u32 s10, s10, 0
s_bfe_u32 s11, s10, 0x20001
s_lshl_b32 s12, s7, 2
s_add_u32 s12, s12, s11
s_lshl_b32 s12, s12, 10
s_lshr_b32 s11, s10, 3
s_lshl_b32 s11, s11, 9
s_add_u32 s12, s12, s11
s_and_b32 s11, s10, 1
s_lshl_b32 s11, s11, 3
s_add_u32 s12, s12, s11
s_add_u32 s12, s12, 14680064
s_mov_b64 exec, 0xffffffff
buffer_store_dwordx2 v[96:97], v3, s[52:55], s12 offen
s_mov_b64 exec, -1
s_waitcnt vmcnt(0)
s_branch k3_kernel_end
k3_kernel_w3:
s_lshl_b32 s7, s4, 1
s_add_u32 s7, s7, 1
s_lshl_b32 s8, s5, 7
s_add_u32 s8, s8, 64
s_lshl_b32 s9, s7, 15
s_add_u32 s9, s9, s8
v_and_b32 v86, 31, v1
v_lshlrev_b32 v86, 10, v86
v_lshl_add_u32 v86, v5, 3, v86
buffer_load_dwordx2 v[88:89], v86, s[56:59], s9 offen offset:0
buffer_load_dwordx2 v[90:91], v86, s[56:59], s9 offen offset:16
buffer_load_dwordx2 v[92:93], v86, s[56:59], s9 offen offset:32
buffer_load_dwordx2 v[94:95], v86, s[56:59], s9 offen offset:48
v_lshrrev_b32 v14, 1, v8
v_lshl_add_u32 v14, v6, 1, v14
v_add_u32 v14, 4, v14
v_bfe_u32 v15, v4, 3, 1
v_lshlrev_b32 v15, 2, v15
v_xor_b32 v14, v14, v15
v_lshlrev_b32 v14, 4, v14
v_and_b32 v15, 1, v4
v_lshl_add_u32 v14, v15, 3, v14
v_lshl_add_u32 v9, v7, 7, v14
s_barrier
v_add_u32 v10, 8192, v9
v_add_u32 v12, 4096, v3
ds_read_b128 v[40:43], v12 offset:0
ds_read_b64_tr_b16 v[20:21], v10 offset:0
ds_read_b64_tr_b16 v[22:23], v10 offset:512
ds_read_b128 v[44:47], v12 offset:1024
ds_read_b64_tr_b16 v[24:25], v10 offset:2048
ds_read_b64_tr_b16 v[26:27], v10 offset:2560
ds_read_b128 v[48:51], v12 offset:2048
ds_read_b64_tr_b16 v[28:29], v10 offset:4096
ds_read_b64_tr_b16 v[30:31], v10 offset:4608
ds_read_b128 v[52:55], v12 offset:3072
ds_read_b64_tr_b16 v[32:33], v10 offset:6144
ds_read_b64_tr_b16 v[34:35], v10 offset:6656
s_barrier
v_add_u32 v11, 24576, v9
v_add_u32 v13, 20480, v3
ds_read_b128 v[56:59], v13 offset:0
s_waitcnt lgkmcnt(10)
v_mfma_f32_32x32x16_bf16 v[60:75], v[20:23], v[40:43], 0
ds_read_b64_tr_b16 v[36:37], v11 offset:0
ds_read_b64_tr_b16 v[38:39], v11 offset:512
ds_read_b128 v[40:43], v13 offset:1024
s_waitcnt lgkmcnt(10)
v_mfma_f32_32x32x16_bf16 v[60:75], v[24:27], v[44:47], v[60:75]
ds_read_b64_tr_b16 v[20:21], v11 offset:2048
ds_read_b64_tr_b16 v[22:23], v11 offset:2560
ds_read_b128 v[44:47], v13 offset:2048
s_waitcnt lgkmcnt(10)
v_mfma_f32_32x32x16_bf16 v[60:75], v[28:31], v[48:51], v[60:75]
ds_read_b64_tr_b16 v[24:25], v11 offset:4096
ds_read_b64_tr_b16 v[26:27], v11 offset:4608
ds_read_b128 v[48:51], v13 offset:3072
s_waitcnt lgkmcnt(10)
v_mfma_f32_32x32x16_bf16 v[60:75], v[32:35], v[52:55], v[60:75]
ds_read_b64_tr_b16 v[28:29], v11 offset:6144
ds_read_b64_tr_b16 v[30:31], v11 offset:6656
s_barrier
v_add_u32 v10, 40960, v9
v_add_u32 v12, 36864, v3
ds_read_b128 v[52:55], v12 offset:0
s_waitcnt lgkmcnt(10)
v_mfma_f32_32x32x16_bf16 v[60:75], v[36:39], v[56:59], v[60:75]
ds_read_b64_tr_b16 v[32:33], v10 offset:0
ds_read_b64_tr_b16 v[34:35], v10 offset:512
ds_read_b128 v[56:59], v12 offset:1024
s_waitcnt lgkmcnt(10)
v_mfma_f32_32x32x16_bf16 v[60:75], v[20:23], v[40:43], v[60:75]
ds_read_b64_tr_b16 v[36:37], v10 offset:2048
ds_read_b64_tr_b16 v[38:39], v10 offset:2560
ds_read_b128 v[40:43], v12 offset:2048
s_waitcnt lgkmcnt(10)
v_mfma_f32_32x32x16_bf16 v[60:75], v[24:27], v[44:47], v[60:75]
ds_read_b64_tr_b16 v[20:21], v10 offset:4096
ds_read_b64_tr_b16 v[22:23], v10 offset:4608
ds_read_b128 v[44:47], v12 offset:3072
s_waitcnt lgkmcnt(10)
v_mfma_f32_32x32x16_bf16 v[60:75], v[28:31], v[48:51], v[60:75]
ds_read_b64_tr_b16 v[24:25], v10 offset:6144
ds_read_b64_tr_b16 v[26:27], v10 offset:6656
s_barrier
v_add_u32 v11, 57344, v9
v_add_u32 v13, 53248, v3
ds_read_b128 v[48:51], v13 offset:0
s_waitcnt lgkmcnt(10)
v_mfma_f32_32x32x16_bf16 v[60:75], v[32:35], v[52:55], v[60:75]
ds_read_b64_tr_b16 v[28:29], v11 offset:0
ds_read_b64_tr_b16 v[30:31], v11 offset:512
ds_read_b128 v[52:55], v13 offset:1024
s_waitcnt lgkmcnt(10)
v_mfma_f32_32x32x16_bf16 v[60:75], v[36:39], v[56:59], v[60:75]
ds_read_b64_tr_b16 v[32:33], v11 offset:2048
ds_read_b64_tr_b16 v[34:35], v11 offset:2560
ds_read_b128 v[56:59], v13 offset:2048
s_waitcnt lgkmcnt(10)
v_mfma_f32_32x32x16_bf16 v[60:75], v[20:23], v[40:43], v[60:75]
ds_read_b64_tr_b16 v[36:37], v11 offset:4096
ds_read_b64_tr_b16 v[38:39], v11 offset:4608
ds_read_b128 v[40:43], v13 offset:3072
s_waitcnt lgkmcnt(10)
v_mfma_f32_32x32x16_bf16 v[60:75], v[24:27], v[44:47], v[60:75]
ds_read_b64_tr_b16 v[20:21], v11 offset:6144
ds_read_b64_tr_b16 v[22:23], v11 offset:6656
s_barrier
v_add_u32 v10, 73728, v9
v_add_u32 v12, 69632, v3
ds_read_b128 v[44:47], v12 offset:0
s_waitcnt lgkmcnt(10)
v_mfma_f32_32x32x16_bf16 v[60:75], v[28:31], v[48:51], v[60:75]
ds_read_b64_tr_b16 v[24:25], v10 offset:0
ds_read_b64_tr_b16 v[26:27], v10 offset:512
ds_read_b128 v[48:51], v12 offset:1024
s_waitcnt lgkmcnt(10)
v_mfma_f32_32x32x16_bf16 v[60:75], v[32:35], v[52:55], v[60:75]
ds_read_b64_tr_b16 v[28:29], v10 offset:2048
ds_read_b64_tr_b16 v[30:31], v10 offset:2560
ds_read_b128 v[52:55], v12 offset:2048
s_waitcnt lgkmcnt(10)
v_mfma_f32_32x32x16_bf16 v[60:75], v[36:39], v[56:59], v[60:75]
ds_read_b64_tr_b16 v[32:33], v10 offset:4096
ds_read_b64_tr_b16 v[34:35], v10 offset:4608
ds_read_b128 v[56:59], v12 offset:3072
s_waitcnt lgkmcnt(10)
v_mfma_f32_32x32x16_bf16 v[60:75], v[20:23], v[40:43], v[60:75]
ds_read_b64_tr_b16 v[36:37], v10 offset:6144
ds_read_b64_tr_b16 v[38:39], v10 offset:6656
s_barrier
v_add_u32 v11, 90112, v9
v_add_u32 v13, 86016, v3
ds_read_b128 v[40:43], v13 offset:0
s_waitcnt lgkmcnt(10)
v_mfma_f32_32x32x16_bf16 v[60:75], v[24:27], v[44:47], v[60:75]
ds_read_b64_tr_b16 v[20:21], v11 offset:0
ds_read_b64_tr_b16 v[22:23], v11 offset:512
ds_read_b128 v[44:47], v13 offset:1024
s_waitcnt lgkmcnt(10)
v_mfma_f32_32x32x16_bf16 v[60:75], v[28:31], v[48:51], v[60:75]
ds_read_b64_tr_b16 v[24:25], v11 offset:2048
ds_read_b64_tr_b16 v[26:27], v11 offset:2560
ds_read_b128 v[48:51], v13 offset:2048
s_waitcnt lgkmcnt(10)
v_mfma_f32_32x32x16_bf16 v[60:75], v[32:35], v[52:55], v[60:75]
ds_read_b64_tr_b16 v[28:29], v11 offset:4096
ds_read_b64_tr_b16 v[30:31], v11 offset:4608
ds_read_b128 v[52:55], v13 offset:3072
s_waitcnt lgkmcnt(10)
v_mfma_f32_32x32x16_bf16 v[60:75], v[36:39], v[56:59], v[60:75]
ds_read_b64_tr_b16 v[32:33], v11 offset:6144
ds_read_b64_tr_b16 v[34:35], v11 offset:6656
s_barrier
v_add_u32 v10, 106496, v9
v_add_u32 v12, 102400, v3
ds_read_b128 v[56:59], v12 offset:0
s_waitcnt lgkmcnt(10)
v_mfma_f32_32x32x16_bf16 v[60:75], v[20:23], v[40:43], v[60:75]
ds_read_b64_tr_b16 v[36:37], v10 offset:0
ds_read_b64_tr_b16 v[38:39], v10 offset:512
ds_read_b128 v[40:43], v12 offset:1024
s_waitcnt lgkmcnt(10)
v_mfma_f32_32x32x16_bf16 v[60:75], v[24:27], v[44:47], v[60:75]
ds_read_b64_tr_b16 v[20:21], v10 offset:2048
ds_read_b64_tr_b16 v[22:23], v10 offset:2560
ds_read_b128 v[44:47], v12 offset:2048
s_waitcnt lgkmcnt(10)
v_mfma_f32_32x32x16_bf16 v[60:75], v[28:31], v[48:51], v[60:75]
ds_read_b64_tr_b16 v[24:25], v10 offset:4096
ds_read_b64_tr_b16 v[26:27], v10 offset:4608
ds_read_b128 v[48:51], v12 offset:3072
s_waitcnt lgkmcnt(10)
v_mfma_f32_32x32x16_bf16 v[60:75], v[32:35], v[52:55], v[60:75]
ds_read_b64_tr_b16 v[28:29], v10 offset:6144
ds_read_b64_tr_b16 v[30:31], v10 offset:6656
s_barrier
v_add_u32 v11, 122880, v9
v_add_u32 v13, 118784, v3
ds_read_b128 v[52:55], v13 offset:0
s_waitcnt lgkmcnt(10)
v_mfma_f32_32x32x16_bf16 v[60:75], v[36:39], v[56:59], v[60:75]
ds_read_b64_tr_b16 v[32:33], v11 offset:0
ds_read_b64_tr_b16 v[34:35], v11 offset:512
ds_read_b128 v[56:59], v13 offset:1024
s_waitcnt lgkmcnt(10)
v_mfma_f32_32x32x16_bf16 v[60:75], v[20:23], v[40:43], v[60:75]
ds_read_b64_tr_b16 v[36:37], v11 offset:2048
ds_read_b64_tr_b16 v[38:39], v11 offset:2560
ds_read_b128 v[40:43], v13 offset:2048
s_waitcnt lgkmcnt(10)
v_mfma_f32_32x32x16_bf16 v[60:75], v[24:27], v[44:47], v[60:75]
ds_read_b64_tr_b16 v[20:21], v11 offset:4096
ds_read_b64_tr_b16 v[22:23], v11 offset:4608
ds_read_b128 v[44:47], v13 offset:3072
s_waitcnt lgkmcnt(10)
v_mfma_f32_32x32x16_bf16 v[60:75], v[28:31], v[48:51], v[60:75]
ds_read_b64_tr_b16 v[24:25], v11 offset:6144
ds_read_b64_tr_b16 v[26:27], v11 offset:6656
s_waitcnt lgkmcnt(9)
v_mfma_f32_32x32x16_bf16 v[60:75], v[32:35], v[52:55], v[60:75]
s_waitcnt lgkmcnt(6)
v_mfma_f32_32x32x16_bf16 v[60:75], v[36:39], v[56:59], v[60:75]
s_waitcnt lgkmcnt(3)
v_mfma_f32_32x32x16_bf16 v[60:75], v[20:23], v[40:43], v[60:75]
s_waitcnt lgkmcnt(0)
v_mfma_f32_32x32x16_bf16 v[60:75], v[24:27], v[44:47], v[60:75]
s_nop 11
v_cvt_pk_bf16_f32 v76, v60, v61
v_cvt_pk_bf16_f32 v77, v62, v63
v_cvt_pk_bf16_f32 v78, v64, v65
v_cvt_pk_bf16_f32 v79, v66, v67
v_cvt_pk_bf16_f32 v80, v68, v69
v_cvt_pk_bf16_f32 v81, v70, v71
v_cvt_pk_bf16_f32 v82, v72, v73
v_cvt_pk_bf16_f32 v83, v74, v75
v_lshlrev_b32 v60, 16, v76
v_and_b32 v61, 0xffff0000, v76
v_lshlrev_b32 v62, 16, v77
v_and_b32 v63, 0xffff0000, v77
v_lshlrev_b32 v64, 16, v78
v_and_b32 v65, 0xffff0000, v78
v_lshlrev_b32 v66, 16, v79
v_and_b32 v67, 0xffff0000, v79
v_lshlrev_b32 v68, 16, v80
v_and_b32 v69, 0xffff0000, v80
v_lshlrev_b32 v70, 16, v81
v_and_b32 v71, 0xffff0000, v81
v_lshlrev_b32 v72, 16, v82
v_and_b32 v73, 0xffff0000, v82
v_lshlrev_b32 v74, 16, v83
v_and_b32 v75, 0xffff0000, v83
s_waitcnt vmcnt(3)
v_lshlrev_b32 v84, 16, v88
v_and_b32 v85, 0xffff0000, v88
v_add_f32 v60, v60, v84
v_add_f32 v61, v61, v85
v_lshlrev_b32 v84, 16, v89
v_and_b32 v85, 0xffff0000, v89
v_add_f32 v62, v62, v84
v_add_f32 v63, v63, v85
s_waitcnt vmcnt(2)
v_lshlrev_b32 v84, 16, v90
v_and_b32 v85, 0xffff0000, v90
v_add_f32 v64, v64, v84
v_add_f32 v65, v65, v85
v_lshlrev_b32 v84, 16, v91
v_and_b32 v85, 0xffff0000, v91
v_add_f32 v66, v66, v84
v_add_f32 v67, v67, v85
s_waitcnt vmcnt(1)
v_lshlrev_b32 v84, 16, v92
v_and_b32 v85, 0xffff0000, v92
v_add_f32 v68, v68, v84
v_add_f32 v69, v69, v85
v_lshlrev_b32 v84, 16, v93
v_and_b32 v85, 0xffff0000, v93
v_add_f32 v70, v70, v84
v_add_f32 v71, v71, v85
s_waitcnt vmcnt(0)
v_lshlrev_b32 v84, 16, v94
v_and_b32 v85, 0xffff0000, v94
v_add_f32 v72, v72, v84
v_add_f32 v73, v73, v85
v_lshlrev_b32 v84, 16, v95
v_and_b32 v85, 0xffff0000, v95
v_add_f32 v74, v74, v84
v_add_f32 v75, v75, v85
v_cvt_pk_bf16_f32 v76, v60, v61
v_cvt_pk_bf16_f32 v77, v62, v63
v_cvt_pk_bf16_f32 v78, v64, v65
v_cvt_pk_bf16_f32 v79, v66, v67
v_cvt_pk_bf16_f32 v80, v68, v69
v_cvt_pk_bf16_f32 v81, v70, v71
v_cvt_pk_bf16_f32 v82, v72, v73
v_cvt_pk_bf16_f32 v83, v74, v75
v_mov_b32 v96, 0
v_mov_b32 v97, 0
v_mov_b32 v60, 0
v_mov_b32 v61, 0
v_dot2_f32_bf16 v96, v76, s61, v96
v_dot2_f32_bf16 v97, v76, v76, v97
v_dot2_f32_bf16 v60, v77, s61, v60
v_dot2_f32_bf16 v61, v77, v77, v61
v_dot2_f32_bf16 v96, v78, s61, v96
v_dot2_f32_bf16 v97, v78, v78, v97
v_dot2_f32_bf16 v60, v79, s61, v60
v_dot2_f32_bf16 v61, v79, v79, v61
v_dot2_f32_bf16 v96, v80, s61, v96
v_dot2_f32_bf16 v97, v80, v80, v97
v_dot2_f32_bf16 v60, v81, s61, v60
v_dot2_f32_bf16 v61, v81, v81, v61
v_dot2_f32_bf16 v96, v82, s61, v96
v_dot2_f32_bf16 v97, v82, v82, v97
v_dot2_f32_bf16 v60, v83, s61, v60
v_dot2_f32_bf16 v61, v83, v83, v61
s_nop 1
v_add_f32 v96, v96, v60
v_add_f32 v97, v97, v61
v_permlane32_swap_b32 v76, v78
v_permlane32_swap_b32 v77, v79
v_permlane32_swap_b32 v80, v82
v_permlane32_swap_b32 v81, v83
s_lshl_b32 s10, s7, 5
s_lshr_b32 s11, s8, 5
s_add_u32 s10, s10, s11
s_lshl_b32 s10, s10, 10
s_add_u32 s10, s10, 10485760
buffer_store_dwordx4 v[76:79], v3, s[52:55], s10 offen
buffer_store_dwordx4 v[80:83], v3, s[52:55], s10 offen offset:1024
v_mov_b32 v84, v96
v_mov_b32 v85, v96
s_nop 1
v_permlane32_swap_b32 v84, v85
v_add_f32 v96, v84, v85
v_mov_b32 v86, v97
v_mov_b32 v87, v97
s_nop 1
v_permlane32_swap_b32 v86, v87
v_add_f32 v97, v86, v87
s_lshl_b32 s10, s5, 1
s_add_u32 s10, s10, 1
s_bfe_u32 s11, s10, 0x20001
s_lshl_b32 s12, s7, 2
s_add_u32 s12, s12, s11
s_lshl_b32 s12, s12, 10
s_lshr_b32 s11, s10, 3
s_lshl_b32 s11, s11, 9
s_add_u32 s12, s12, s11
s_and_b32 s11, s10, 1
s_lshl_b32 s11, s11, 3
s_add_u32 s12, s12, s11
s_add_u32 s12, s12, 14680064
s_mov_b64 exec, 0xffffffff
buffer_store_dwordx2 v[96:97], v3, s[52:55], s12 offen
s_mov_b64 exec, -1
s_waitcnt vmcnt(0)
s_branch k3_kernel_end
k3_kernel_w4:
v_add_u32 v9, 0, v1
v_lshrrev_b32 v10, 3, v9
v_and_b32 v11, 7, v9
v_bfe_u32 v12, v9, 4, 1
v_lshlrev_b32 v12, 2, v12
v_xor_b32 v11, v11, v12
v_lshlrev_b32 v11, 4, v11
s_mov_b32 s7, 1024
v_mul_lo_u32 v10, v10, s7
v_add_u32 v15, v10, v11
v_add_u32 v9, 64, v1
v_lshrrev_b32 v10, 3, v9
v_and_b32 v11, 7, v9
v_bfe_u32 v12, v9, 4, 1
v_lshlrev_b32 v12, 2, v12
v_xor_b32 v11, v11, v12
v_lshlrev_b32 v11, 4, v11
s_mov_b32 s7, 1024
v_mul_lo_u32 v10, v10, s7
v_add_u32 v16, v10, v11
s_mov_b32 m0, 0
s_mov_b32 s60, 0
buffer_load_dwordx4 v3, s[40:43], s60 offen lds
s_mov_b32 m0, 1024
s_mov_b32 s60, 1024
buffer_load_dwordx4 v3, s[40:43], s60 offen lds
s_mov_b32 m0, 8192
s_mov_b32 s60, 0
buffer_load_dwordx4 v15, s[44:47], s60 offen lds
s_mov_b32 m0, 9216
s_mov_b32 s60, 0
buffer_load_dwordx4 v16, s[44:47], s60 offen lds
s_mov_b32 m0, 16384
s_mov_b32 s60, 4096
buffer_load_dwordx4 v3, s[40:43], s60 offen lds
s_mov_b32 m0, 17408
s_mov_b32 s60, 5120
buffer_load_dwordx4 v3, s[40:43], s60 offen lds
s_mov_b32 m0, 24576
s_mov_b32 s60, 65536
buffer_load_dwordx4 v15, s[44:47], s60 offen lds
s_mov_b32 m0, 25600
s_mov_b32 s60, 65536
buffer_load_dwordx4 v16, s[44:47], s60 offen lds
s_mov_b32 m0, 32768
s_mov_b32 s60, 8192
buffer_load_dwordx4 v3, s[40:43], s60 offen lds
s_mov_b32 m0, 33792
s_mov_b32 s60, 9216
buffer_load_dwordx4 v3, s[40:43], s60 offen lds
s_mov_b32 m0, 40960
s_mov_b32 s60, 131072
buffer_load_dwordx4 v15, s[44:47], s60 offen lds
s_mov_b32 m0, 41984
s_mov_b32 s60, 131072
buffer_load_dwordx4 v16, s[44:47], s60 offen lds
s_mov_b32 m0, 49152
s_mov_b32 s60, 12288
buffer_load_dwordx4 v3, s[40:43], s60 offen lds
s_mov_b32 m0, 50176
s_mov_b32 s60, 13312
buffer_load_dwordx4 v3, s[40:43], s60 offen lds
s_mov_b32 m0, 57344
s_mov_b32 s60, 196608
buffer_load_dwordx4 v15, s[44:47], s60 offen lds
s_mov_b32 m0, 58368
s_mov_b32 s60, 196608
buffer_load_dwordx4 v16, s[44:47], s60 offen lds
s_mov_b32 m0, 65536
s_mov_b32 s60, 16384
buffer_load_dwordx4 v3, s[40:43], s60 offen lds
s_mov_b32 m0, 66560
s_mov_b32 s60, 17408
buffer_load_dwordx4 v3, s[40:43], s60 offen lds
s_mov_b32 m0, 73728
s_mov_b32 s60, 262144
buffer_load_dwordx4 v15, s[44:47], s60 offen lds
s_mov_b32 m0, 74752
s_mov_b32 s60, 262144
buffer_load_dwordx4 v16, s[44:47], s60 offen lds
s_mov_b32 m0, 81920
s_mov_b32 s60, 20480
buffer_load_dwordx4 v3, s[40:43], s60 offen lds
s_mov_b32 m0, 82944
s_mov_b32 s60, 21504
buffer_load_dwordx4 v3, s[40:43], s60 offen lds
s_mov_b32 m0, 90112
s_mov_b32 s60, 327680
buffer_load_dwordx4 v15, s[44:47], s60 offen lds
s_mov_b32 m0, 91136
s_mov_b32 s60, 327680
buffer_load_dwordx4 v16, s[44:47], s60 offen lds
s_waitcnt vmcnt(20)
s_barrier
s_mov_b32 m0, 98304
s_mov_b32 s60, 24576
buffer_load_dwordx4 v3, s[40:43], s60 offen lds
s_mov_b32 m0, 99328
s_mov_b32 s60, 25600
buffer_load_dwordx4 v3, s[40:43], s60 offen lds
s_mov_b32 m0, 106496
s_mov_b32 s60, 393216
buffer_load_dwordx4 v15, s[44:47], s60 offen lds
s_mov_b32 m0, 107520
s_mov_b32 s60, 393216
buffer_load_dwordx4 v16, s[44:47], s60 offen lds
s_waitcnt vmcnt(20)
s_barrier
s_mov_b32 m0, 114688
s_mov_b32 s60, 28672
buffer_load_dwordx4 v3, s[40:43], s60 offen lds
s_mov_b32 m0, 115712
s_mov_b32 s60, 29696
buffer_load_dwordx4 v3, s[40:43], s60 offen lds
s_mov_b32 m0, 122880
s_mov_b32 s60, 458752
buffer_load_dwordx4 v15, s[44:47], s60 offen lds
s_mov_b32 m0, 123904
s_mov_b32 s60, 458752
buffer_load_dwordx4 v16, s[44:47], s60 offen lds
s_waitcnt vmcnt(20)
s_barrier
s_waitcnt vmcnt(16)
s_barrier
s_waitcnt vmcnt(12)
s_barrier
s_waitcnt vmcnt(8)
s_barrier
s_waitcnt vmcnt(4)
s_barrier
s_waitcnt vmcnt(0)
s_barrier
s_lshr_b32 s7, s2, 3
s_and_b32 s8, s2, 7
s_lshr_b32 s9, s8, 2
s_and_b32 s8, s8, 3
s_cmp_eq_u32 s9, 0
s_cselect_b32 s62, s24, s26
s_cselect_b32 s63, s25, s27
s_mul_i32 s10, s7, 57344
s_mul_i32 s11, s8, 896
s_add_u32 s10, s10, s11
s_sub_u32 s11, 1835008, s10
s_add_u32 s84, s62, s10
s_addc_u32 s85, s63, 0
s_and_b32 s85, s85, 0xffff
s_mov_b32 s86, s11
s_mov_b32 s87, 0x00020000
s_mov_b32 s60, 0
buffer_load_dwordx4 v[32:35], v3, s[84:87], s60 offen
s_mov_b32 s60, 3584
buffer_load_dwordx4 v[36:39], v3, s[84:87], s60 offen
s_mov_b32 s60, 7168
buffer_load_dwordx4 v[40:43], v3, s[84:87], s60 offen
s_mov_b32 s60, 10752
buffer_load_dwordx4 v[44:47], v3, s[84:87], s60 offen
s_mov_b32 s60, 14336
buffer_load_dwordx4 v[48:51], v3, s[84:87], s60 offen
s_mov_b32 s60, 17920
buffer_load_dwordx4 v[52:55], v3, s[84:87], s60 offen
s_mov_b32 s60, 21504
buffer_load_dwordx4 v[56:59], v3, s[84:87], s60 offen
s_mov_b32 s60, 25088
buffer_load_dwordx4 v[60:63], v3, s[84:87], s60 offen
s_mov_b32 s60, 28672
buffer_load_dwordx4 v[64:67], v3, s[84:87], s60 offen
s_mov_b32 s60, 32256
buffer_load_dwordx4 v[68:71], v3, s[84:87], s60 offen
s_mov_b32 s60, 35840
buffer_load_dwordx4 v[72:75], v3, s[84:87], s60 offen
s_mov_b32 s60, 39424
buffer_load_dwordx4 v[76:79], v3, s[84:87], s60 offen
s_mov_b32 s60, 43008
buffer_load_dwordx4 v[80:83], v3, s[84:87], s60 offen
s_mov_b32 s60, 46592
buffer_load_dwordx4 v[84:87], v3, s[84:87], s60 offen
s_mov_b32 s60, 50176
buffer_load_dwordx4 v[88:91], v3, s[84:87], s60 offen
s_mov_b32 s60, 53760
buffer_load_dwordx4 v[92:95], v3, s[84:87], s60 offen
v_mov_b32 v24, 0
v_mov_b32 v25, 0
v_mov_b32 v26, 0
v_mov_b32 v27, 0
v_mov_b32 v28, 0
v_mov_b32 v29, 0
v_mov_b32 v30, 0
v_mov_b32 v31, 0
s_waitcnt vmcnt(15)
v_lshlrev_b32 v96, 16, v32
v_and_b32 v97, 0xffff0000, v32
v_add_f32 v24, v24, v96
v_add_f32 v25, v25, v97
v_lshlrev_b32 v96, 16, v33
v_and_b32 v97, 0xffff0000, v33
v_add_f32 v26, v26, v96
v_add_f32 v27, v27, v97
v_lshlrev_b32 v96, 16, v34
v_and_b32 v97, 0xffff0000, v34
v_add_f32 v28, v28, v96
v_add_f32 v29, v29, v97
v_lshlrev_b32 v96, 16, v35
v_and_b32 v97, 0xffff0000, v35
v_add_f32 v30, v30, v96
v_add_f32 v31, v31, v97
s_waitcnt vmcnt(14)
v_lshlrev_b32 v96, 16, v36
v_and_b32 v97, 0xffff0000, v36
v_add_f32 v24, v24, v96
v_add_f32 v25, v25, v97
v_lshlrev_b32 v96, 16, v37
v_and_b32 v97, 0xffff0000, v37
v_add_f32 v26, v26, v96
v_add_f32 v27, v27, v97
v_lshlrev_b32 v96, 16, v38
v_and_b32 v97, 0xffff0000, v38
v_add_f32 v28, v28, v96
v_add_f32 v29, v29, v97
v_lshlrev_b32 v96, 16, v39
v_and_b32 v97, 0xffff0000, v39
v_add_f32 v30, v30, v96
v_add_f32 v31, v31, v97
s_waitcnt vmcnt(13)
v_lshlrev_b32 v96, 16, v40
v_and_b32 v97, 0xffff0000, v40
v_add_f32 v24, v24, v96
v_add_f32 v25, v25, v97
v_lshlrev_b32 v96, 16, v41
v_and_b32 v97, 0xffff0000, v41
v_add_f32 v26, v26, v96
v_add_f32 v27, v27, v97
v_lshlrev_b32 v96, 16, v42
v_and_b32 v97, 0xffff0000, v42
v_add_f32 v28, v28, v96
v_add_f32 v29, v29, v97
v_lshlrev_b32 v96, 16, v43
v_and_b32 v97, 0xffff0000, v43
v_add_f32 v30, v30, v96
v_add_f32 v31, v31, v97
s_waitcnt vmcnt(12)
v_lshlrev_b32 v96, 16, v44
v_and_b32 v97, 0xffff0000, v44
v_add_f32 v24, v24, v96
v_add_f32 v25, v25, v97
v_lshlrev_b32 v96, 16, v45
v_and_b32 v97, 0xffff0000, v45
v_add_f32 v26, v26, v96
v_add_f32 v27, v27, v97
v_lshlrev_b32 v96, 16, v46
v_and_b32 v97, 0xffff0000, v46
v_add_f32 v28, v28, v96
v_add_f32 v29, v29, v97
v_lshlrev_b32 v96, 16, v47
v_and_b32 v97, 0xffff0000, v47
v_add_f32 v30, v30, v96
v_add_f32 v31, v31, v97
s_waitcnt vmcnt(11)
v_lshlrev_b32 v96, 16, v48
v_and_b32 v97, 0xffff0000, v48
v_add_f32 v24, v24, v96
v_add_f32 v25, v25, v97
v_lshlrev_b32 v96, 16, v49
v_and_b32 v97, 0xffff0000, v49
v_add_f32 v26, v26, v96
v_add_f32 v27, v27, v97
v_lshlrev_b32 v96, 16, v50
v_and_b32 v97, 0xffff0000, v50
v_add_f32 v28, v28, v96
v_add_f32 v29, v29, v97
v_lshlrev_b32 v96, 16, v51
v_and_b32 v97, 0xffff0000, v51
v_add_f32 v30, v30, v96
v_add_f32 v31, v31, v97
s_waitcnt vmcnt(10)
v_lshlrev_b32 v96, 16, v52
v_and_b32 v97, 0xffff0000, v52
v_add_f32 v24, v24, v96
v_add_f32 v25, v25, v97
v_lshlrev_b32 v96, 16, v53
v_and_b32 v97, 0xffff0000, v53
v_add_f32 v26, v26, v96
v_add_f32 v27, v27, v97
v_lshlrev_b32 v96, 16, v54
v_and_b32 v97, 0xffff0000, v54
v_add_f32 v28, v28, v96
v_add_f32 v29, v29, v97
v_lshlrev_b32 v96, 16, v55
v_and_b32 v97, 0xffff0000, v55
v_add_f32 v30, v30, v96
v_add_f32 v31, v31, v97
s_waitcnt vmcnt(9)
v_lshlrev_b32 v96, 16, v56
v_and_b32 v97, 0xffff0000, v56
v_add_f32 v24, v24, v96
v_add_f32 v25, v25, v97
v_lshlrev_b32 v96, 16, v57
v_and_b32 v97, 0xffff0000, v57
v_add_f32 v26, v26, v96
v_add_f32 v27, v27, v97
v_lshlrev_b32 v96, 16, v58
v_and_b32 v97, 0xffff0000, v58
v_add_f32 v28, v28, v96
v_add_f32 v29, v29, v97
v_lshlrev_b32 v96, 16, v59
v_and_b32 v97, 0xffff0000, v59
v_add_f32 v30, v30, v96
v_add_f32 v31, v31, v97
s_waitcnt vmcnt(8)
v_lshlrev_b32 v96, 16, v60
v_and_b32 v97, 0xffff0000, v60
v_add_f32 v24, v24, v96
v_add_f32 v25, v25, v97
v_lshlrev_b32 v96, 16, v61
v_and_b32 v97, 0xffff0000, v61
v_add_f32 v26, v26, v96
v_add_f32 v27, v27, v97
v_lshlrev_b32 v96, 16, v62
v_and_b32 v97, 0xffff0000, v62
v_add_f32 v28, v28, v96
v_add_f32 v29, v29, v97
v_lshlrev_b32 v96, 16, v63
v_and_b32 v97, 0xffff0000, v63
v_add_f32 v30, v30, v96
v_add_f32 v31, v31, v97
s_waitcnt vmcnt(7)
v_lshlrev_b32 v96, 16, v64
v_and_b32 v97, 0xffff0000, v64
v_add_f32 v24, v24, v96
v_add_f32 v25, v25, v97
v_lshlrev_b32 v96, 16, v65
v_and_b32 v97, 0xffff0000, v65
v_add_f32 v26, v26, v96
v_add_f32 v27, v27, v97
v_lshlrev_b32 v96, 16, v66
v_and_b32 v97, 0xffff0000, v66
v_add_f32 v28, v28, v96
v_add_f32 v29, v29, v97
v_lshlrev_b32 v96, 16, v67
v_and_b32 v97, 0xffff0000, v67
v_add_f32 v30, v30, v96
v_add_f32 v31, v31, v97
s_waitcnt vmcnt(6)
v_lshlrev_b32 v96, 16, v68
v_and_b32 v97, 0xffff0000, v68
v_add_f32 v24, v24, v96
v_add_f32 v25, v25, v97
v_lshlrev_b32 v96, 16, v69
v_and_b32 v97, 0xffff0000, v69
v_add_f32 v26, v26, v96
v_add_f32 v27, v27, v97
v_lshlrev_b32 v96, 16, v70
v_and_b32 v97, 0xffff0000, v70
v_add_f32 v28, v28, v96
v_add_f32 v29, v29, v97
v_lshlrev_b32 v96, 16, v71
v_and_b32 v97, 0xffff0000, v71
v_add_f32 v30, v30, v96
v_add_f32 v31, v31, v97
s_waitcnt vmcnt(5)
v_lshlrev_b32 v96, 16, v72
v_and_b32 v97, 0xffff0000, v72
v_add_f32 v24, v24, v96
v_add_f32 v25, v25, v97
v_lshlrev_b32 v96, 16, v73
v_and_b32 v97, 0xffff0000, v73
v_add_f32 v26, v26, v96
v_add_f32 v27, v27, v97
v_lshlrev_b32 v96, 16, v74
v_and_b32 v97, 0xffff0000, v74
v_add_f32 v28, v28, v96
v_add_f32 v29, v29, v97
v_lshlrev_b32 v96, 16, v75
v_and_b32 v97, 0xffff0000, v75
v_add_f32 v30, v30, v96
v_add_f32 v31, v31, v97
s_waitcnt vmcnt(4)
v_lshlrev_b32 v96, 16, v76
v_and_b32 v97, 0xffff0000, v76
v_add_f32 v24, v24, v96
v_add_f32 v25, v25, v97
v_lshlrev_b32 v96, 16, v77
v_and_b32 v97, 0xffff0000, v77
v_add_f32 v26, v26, v96
v_add_f32 v27, v27, v97
v_lshlrev_b32 v96, 16, v78
v_and_b32 v97, 0xffff0000, v78
v_add_f32 v28, v28, v96
v_add_f32 v29, v29, v97
v_lshlrev_b32 v96, 16, v79
v_and_b32 v97, 0xffff0000, v79
v_add_f32 v30, v30, v96
v_add_f32 v31, v31, v97
s_waitcnt vmcnt(3)
v_lshlrev_b32 v96, 16, v80
v_and_b32 v97, 0xffff0000, v80
v_add_f32 v24, v24, v96
v_add_f32 v25, v25, v97
v_lshlrev_b32 v96, 16, v81
v_and_b32 v97, 0xffff0000, v81
v_add_f32 v26, v26, v96
v_add_f32 v27, v27, v97
v_lshlrev_b32 v96, 16, v82
v_and_b32 v97, 0xffff0000, v82
v_add_f32 v28, v28, v96
v_add_f32 v29, v29, v97
v_lshlrev_b32 v96, 16, v83
v_and_b32 v97, 0xffff0000, v83
v_add_f32 v30, v30, v96
v_add_f32 v31, v31, v97
s_waitcnt vmcnt(2)
v_lshlrev_b32 v96, 16, v84
v_and_b32 v97, 0xffff0000, v84
v_add_f32 v24, v24, v96
v_add_f32 v25, v25, v97
v_lshlrev_b32 v96, 16, v85
v_and_b32 v97, 0xffff0000, v85
v_add_f32 v26, v26, v96
v_add_f32 v27, v27, v97
v_lshlrev_b32 v96, 16, v86
v_and_b32 v97, 0xffff0000, v86
v_add_f32 v28, v28, v96
v_add_f32 v29, v29, v97
v_lshlrev_b32 v96, 16, v87
v_and_b32 v97, 0xffff0000, v87
v_add_f32 v30, v30, v96
v_add_f32 v31, v31, v97
s_waitcnt vmcnt(1)
v_lshlrev_b32 v96, 16, v88
v_and_b32 v97, 0xffff0000, v88
v_add_f32 v24, v24, v96
v_add_f32 v25, v25, v97
v_lshlrev_b32 v96, 16, v89
v_and_b32 v97, 0xffff0000, v89
v_add_f32 v26, v26, v96
v_add_f32 v27, v27, v97
v_lshlrev_b32 v96, 16, v90
v_and_b32 v97, 0xffff0000, v90
v_add_f32 v28, v28, v96
v_add_f32 v29, v29, v97
v_lshlrev_b32 v96, 16, v91
v_and_b32 v97, 0xffff0000, v91
v_add_f32 v30, v30, v96
v_add_f32 v31, v31, v97
s_waitcnt vmcnt(0)
v_lshlrev_b32 v96, 16, v92
v_and_b32 v97, 0xffff0000, v92
v_add_f32 v24, v24, v96
v_add_f32 v25, v25, v97
v_lshlrev_b32 v96, 16, v93
v_and_b32 v97, 0xffff0000, v93
v_add_f32 v26, v26, v96
v_add_f32 v27, v27, v97
v_lshlrev_b32 v96, 16, v94
v_and_b32 v97, 0xffff0000, v94
v_add_f32 v28, v28, v96
v_add_f32 v29, v29, v97
v_lshlrev_b32 v96, 16, v95
v_and_b32 v97, 0xffff0000, v95
v_add_f32 v30, v30, v96
v_add_f32 v31, v31, v97
s_lshl_b32 s10, s7, 1
s_add_u32 s10, s10, s9
s_mul_i32 s10, s10, 7168
s_mul_i32 s11, s8, 1792
s_add_u32 s10, s10, s11
s_add_u32 s10, s10, 15728640
v_lshlrev_b32 v96, 5, v1
s_mov_b32 exec_lo, -1
s_mov_b32 exec_hi, 0x00ffffff
buffer_store_dwordx4 v[24:27], v96, s[52:55], s10 offen
buffer_store_dwordx4 v[28:31], v96, s[52:55], s10 offen offset:16
s_mov_b64 exec, -1
s_branch k3_kernel_end
k3_kernel_w5:
v_add_u32 v9, 128, v1
v_lshrrev_b32 v10, 3, v9
v_and_b32 v11, 7, v9
v_bfe_u32 v12, v9, 4, 1
v_lshlrev_b32 v12, 2, v12
v_xor_b32 v11, v11, v12
v_lshlrev_b32 v11, 4, v11
s_mov_b32 s7, 1024
v_mul_lo_u32 v10, v10, s7
v_add_u32 v15, v10, v11
v_add_u32 v9, 192, v1
v_lshrrev_b32 v10, 3, v9
v_and_b32 v11, 7, v9
v_bfe_u32 v12, v9, 4, 1
v_lshlrev_b32 v12, 2, v12
v_xor_b32 v11, v11, v12
v_lshlrev_b32 v11, 4, v11
s_mov_b32 s7, 1024
v_mul_lo_u32 v10, v10, s7
v_add_u32 v16, v10, v11
s_mov_b32 m0, 2048
s_mov_b32 s60, 2048
buffer_load_dwordx4 v3, s[40:43], s60 offen lds
s_mov_b32 m0, 3072
s_mov_b32 s60, 3072
buffer_load_dwordx4 v3, s[40:43], s60 offen lds
s_mov_b32 m0, 10240
s_mov_b32 s60, 0
buffer_load_dwordx4 v15, s[44:47], s60 offen lds
s_mov_b32 m0, 11264
s_mov_b32 s60, 0
buffer_load_dwordx4 v16, s[44:47], s60 offen lds
s_mov_b32 m0, 18432
s_mov_b32 s60, 6144
buffer_load_dwordx4 v3, s[40:43], s60 offen lds
s_mov_b32 m0, 19456
s_mov_b32 s60, 7168
buffer_load_dwordx4 v3, s[40:43], s60 offen lds
s_mov_b32 m0, 26624
s_mov_b32 s60, 65536
buffer_load_dwordx4 v15, s[44:47], s60 offen lds
s_mov_b32 m0, 27648
s_mov_b32 s60, 65536
buffer_load_dwordx4 v16, s[44:47], s60 offen lds
s_mov_b32 m0, 34816
s_mov_b32 s60, 10240
buffer_load_dwordx4 v3, s[40:43], s60 offen lds
s_mov_b32 m0, 35840
s_mov_b32 s60, 11264
buffer_load_dwordx4 v3, s[40:43], s60 offen lds
s_mov_b32 m0, 43008
s_mov_b32 s60, 131072
buffer_load_dwordx4 v15, s[44:47], s60 offen lds
s_mov_b32 m0, 44032
s_mov_b32 s60, 131072
buffer_load_dwordx4 v16, s[44:47], s60 offen lds
s_mov_b32 m0, 51200
s_mov_b32 s60, 14336
buffer_load_dwordx4 v3, s[40:43], s60 offen lds
s_mov_b32 m0, 52224
s_mov_b32 s60, 15360
buffer_load_dwordx4 v3, s[40:43], s60 offen lds
s_mov_b32 m0, 59392
s_mov_b32 s60, 196608
buffer_load_dwordx4 v15, s[44:47], s60 offen lds
s_mov_b32 m0, 60416
s_mov_b32 s60, 196608
buffer_load_dwordx4 v16, s[44:47], s60 offen lds
s_mov_b32 m0, 67584
s_mov_b32 s60, 18432
buffer_load_dwordx4 v3, s[40:43], s60 offen lds
s_mov_b32 m0, 68608
s_mov_b32 s60, 19456
buffer_load_dwordx4 v3, s[40:43], s60 offen lds
s_mov_b32 m0, 75776
s_mov_b32 s60, 262144
buffer_load_dwordx4 v15, s[44:47], s60 offen lds
s_mov_b32 m0, 76800
s_mov_b32 s60, 262144
buffer_load_dwordx4 v16, s[44:47], s60 offen lds
s_mov_b32 m0, 83968
s_mov_b32 s60, 22528
buffer_load_dwordx4 v3, s[40:43], s60 offen lds
s_mov_b32 m0, 84992
s_mov_b32 s60, 23552
buffer_load_dwordx4 v3, s[40:43], s60 offen lds
s_mov_b32 m0, 92160
s_mov_b32 s60, 327680
buffer_load_dwordx4 v15, s[44:47], s60 offen lds
s_mov_b32 m0, 93184
s_mov_b32 s60, 327680
buffer_load_dwordx4 v16, s[44:47], s60 offen lds
s_waitcnt vmcnt(20)
s_barrier
s_mov_b32 m0, 100352
s_mov_b32 s60, 26624
buffer_load_dwordx4 v3, s[40:43], s60 offen lds
s_mov_b32 m0, 101376
s_mov_b32 s60, 27648
buffer_load_dwordx4 v3, s[40:43], s60 offen lds
s_mov_b32 m0, 108544
s_mov_b32 s60, 393216
buffer_load_dwordx4 v15, s[44:47], s60 offen lds
s_mov_b32 m0, 109568
s_mov_b32 s60, 393216
buffer_load_dwordx4 v16, s[44:47], s60 offen lds
s_waitcnt vmcnt(20)
s_barrier
s_mov_b32 m0, 116736
s_mov_b32 s60, 30720
buffer_load_dwordx4 v3, s[40:43], s60 offen lds
s_mov_b32 m0, 117760
s_mov_b32 s60, 31744
buffer_load_dwordx4 v3, s[40:43], s60 offen lds
s_mov_b32 m0, 124928
s_mov_b32 s60, 458752
buffer_load_dwordx4 v15, s[44:47], s60 offen lds
s_mov_b32 m0, 125952
s_mov_b32 s60, 458752
buffer_load_dwordx4 v16, s[44:47], s60 offen lds
s_waitcnt vmcnt(20)
s_barrier
s_waitcnt vmcnt(16)
s_barrier
s_waitcnt vmcnt(12)
s_barrier
s_waitcnt vmcnt(8)
s_barrier
s_waitcnt vmcnt(4)
s_barrier
s_waitcnt vmcnt(0)
s_barrier
s_branch k3_kernel_end
k3_kernel_w6:
v_add_u32 v9, 256, v1
v_lshrrev_b32 v10, 3, v9
v_and_b32 v11, 7, v9
v_bfe_u32 v12, v9, 4, 1
v_lshlrev_b32 v12, 2, v12
v_xor_b32 v11, v11, v12
v_lshlrev_b32 v11, 4, v11
s_mov_b32 s7, 1024
v_mul_lo_u32 v10, v10, s7
v_add_u32 v15, v10, v11
v_add_u32 v9, 320, v1
v_lshrrev_b32 v10, 3, v9
v_and_b32 v11, 7, v9
v_bfe_u32 v12, v9, 4, 1
v_lshlrev_b32 v12, 2, v12
v_xor_b32 v11, v11, v12
v_lshlrev_b32 v11, 4, v11
s_mov_b32 s7, 1024
v_mul_lo_u32 v10, v10, s7
v_add_u32 v16, v10, v11
s_mov_b32 m0, 4096
s_mov_b32 s60, 32768
buffer_load_dwordx4 v3, s[40:43], s60 offen lds
s_mov_b32 m0, 5120
s_mov_b32 s60, 33792
buffer_load_dwordx4 v3, s[40:43], s60 offen lds
s_mov_b32 m0, 12288
s_mov_b32 s60, 0
buffer_load_dwordx4 v15, s[44:47], s60 offen lds
s_mov_b32 m0, 13312
s_mov_b32 s60, 0
buffer_load_dwordx4 v16, s[44:47], s60 offen lds
s_mov_b32 m0, 20480
s_mov_b32 s60, 36864
buffer_load_dwordx4 v3, s[40:43], s60 offen lds
s_mov_b32 m0, 21504
s_mov_b32 s60, 37888
buffer_load_dwordx4 v3, s[40:43], s60 offen lds
s_mov_b32 m0, 28672
s_mov_b32 s60, 65536
buffer_load_dwordx4 v15, s[44:47], s60 offen lds
s_mov_b32 m0, 29696
s_mov_b32 s60, 65536
buffer_load_dwordx4 v16, s[44:47], s60 offen lds
s_mov_b32 m0, 36864
s_mov_b32 s60, 40960
buffer_load_dwordx4 v3, s[40:43], s60 offen lds
s_mov_b32 m0, 37888
s_mov_b32 s60, 41984
buffer_load_dwordx4 v3, s[40:43], s60 offen lds
s_mov_b32 m0, 45056
s_mov_b32 s60, 131072
buffer_load_dwordx4 v15, s[44:47], s60 offen lds
s_mov_b32 m0, 46080
s_mov_b32 s60, 131072
buffer_load_dwordx4 v16, s[44:47], s60 offen lds
s_mov_b32 m0, 53248
s_mov_b32 s60, 45056
buffer_load_dwordx4 v3, s[40:43], s60 offen lds
s_mov_b32 m0, 54272
s_mov_b32 s60, 46080
buffer_load_dwordx4 v3, s[40:43], s60 offen lds
s_mov_b32 m0, 61440
s_mov_b32 s60, 196608
buffer_load_dwordx4 v15, s[44:47], s60 offen lds
s_mov_b32 m0, 62464
s_mov_b32 s60, 196608
buffer_load_dwordx4 v16, s[44:47], s60 offen lds
s_mov_b32 m0, 69632
s_mov_b32 s60, 49152
buffer_load_dwordx4 v3, s[40:43], s60 offen lds
s_mov_b32 m0, 70656
s_mov_b32 s60, 50176
buffer_load_dwordx4 v3, s[40:43], s60 offen lds
s_mov_b32 m0, 77824
s_mov_b32 s60, 262144
buffer_load_dwordx4 v15, s[44:47], s60 offen lds
s_mov_b32 m0, 78848
s_mov_b32 s60, 262144
buffer_load_dwordx4 v16, s[44:47], s60 offen lds
s_mov_b32 m0, 86016
s_mov_b32 s60, 53248
buffer_load_dwordx4 v3, s[40:43], s60 offen lds
s_mov_b32 m0, 87040
s_mov_b32 s60, 54272
buffer_load_dwordx4 v3, s[40:43], s60 offen lds
s_mov_b32 m0, 94208
s_mov_b32 s60, 327680
buffer_load_dwordx4 v15, s[44:47], s60 offen lds
s_mov_b32 m0, 95232
s_mov_b32 s60, 327680
buffer_load_dwordx4 v16, s[44:47], s60 offen lds
s_waitcnt vmcnt(20)
s_barrier
s_mov_b32 m0, 102400
s_mov_b32 s60, 57344
buffer_load_dwordx4 v3, s[40:43], s60 offen lds
s_mov_b32 m0, 103424
s_mov_b32 s60, 58368
buffer_load_dwordx4 v3, s[40:43], s60 offen lds
s_mov_b32 m0, 110592
s_mov_b32 s60, 393216
buffer_load_dwordx4 v15, s[44:47], s60 offen lds
s_mov_b32 m0, 111616
s_mov_b32 s60, 393216
buffer_load_dwordx4 v16, s[44:47], s60 offen lds
s_waitcnt vmcnt(20)
s_barrier
s_mov_b32 m0, 118784
s_mov_b32 s60, 61440
buffer_load_dwordx4 v3, s[40:43], s60 offen lds
s_mov_b32 m0, 119808
s_mov_b32 s60, 62464
buffer_load_dwordx4 v3, s[40:43], s60 offen lds
s_mov_b32 m0, 126976
s_mov_b32 s60, 458752
buffer_load_dwordx4 v15, s[44:47], s60 offen lds
s_mov_b32 m0, 128000
s_mov_b32 s60, 458752
buffer_load_dwordx4 v16, s[44:47], s60 offen lds
s_waitcnt vmcnt(20)
s_barrier
s_waitcnt vmcnt(16)
s_barrier
s_waitcnt vmcnt(12)
s_barrier
s_waitcnt vmcnt(8)
s_barrier
s_waitcnt vmcnt(4)
s_barrier
s_waitcnt vmcnt(0)
s_barrier
s_branch k3_kernel_end
k3_kernel_w7:
v_add_u32 v9, 384, v1
v_lshrrev_b32 v10, 3, v9
v_and_b32 v11, 7, v9
v_bfe_u32 v12, v9, 4, 1
v_lshlrev_b32 v12, 2, v12
v_xor_b32 v11, v11, v12
v_lshlrev_b32 v11, 4, v11
s_mov_b32 s7, 1024
v_mul_lo_u32 v10, v10, s7
v_add_u32 v15, v10, v11
v_add_u32 v9, 448, v1
v_lshrrev_b32 v10, 3, v9
v_and_b32 v11, 7, v9
v_bfe_u32 v12, v9, 4, 1
v_lshlrev_b32 v12, 2, v12
v_xor_b32 v11, v11, v12
v_lshlrev_b32 v11, 4, v11
s_mov_b32 s7, 1024
v_mul_lo_u32 v10, v10, s7
v_add_u32 v16, v10, v11
s_mov_b32 m0, 6144
s_mov_b32 s60, 34816
buffer_load_dwordx4 v3, s[40:43], s60 offen lds
s_mov_b32 m0, 7168
s_mov_b32 s60, 35840
buffer_load_dwordx4 v3, s[40:43], s60 offen lds
s_mov_b32 m0, 14336
s_mov_b32 s60, 0
buffer_load_dwordx4 v15, s[44:47], s60 offen lds
s_mov_b32 m0, 15360
s_mov_b32 s60, 0
buffer_load_dwordx4 v16, s[44:47], s60 offen lds
s_mov_b32 m0, 22528
s_mov_b32 s60, 38912
buffer_load_dwordx4 v3, s[40:43], s60 offen lds
s_mov_b32 m0, 23552
s_mov_b32 s60, 39936
buffer_load_dwordx4 v3, s[40:43], s60 offen lds
s_mov_b32 m0, 30720
s_mov_b32 s60, 65536
buffer_load_dwordx4 v15, s[44:47], s60 offen lds
s_mov_b32 m0, 31744
s_mov_b32 s60, 65536
buffer_load_dwordx4 v16, s[44:47], s60 offen lds
s_mov_b32 m0, 38912
s_mov_b32 s60, 43008
buffer_load_dwordx4 v3, s[40:43], s60 offen lds
s_mov_b32 m0, 39936
s_mov_b32 s60, 44032
buffer_load_dwordx4 v3, s[40:43], s60 offen lds
s_mov_b32 m0, 47104
s_mov_b32 s60, 131072
buffer_load_dwordx4 v15, s[44:47], s60 offen lds
s_mov_b32 m0, 48128
s_mov_b32 s60, 131072
buffer_load_dwordx4 v16, s[44:47], s60 offen lds
s_mov_b32 m0, 55296
s_mov_b32 s60, 47104
buffer_load_dwordx4 v3, s[40:43], s60 offen lds
s_mov_b32 m0, 56320
s_mov_b32 s60, 48128
buffer_load_dwordx4 v3, s[40:43], s60 offen lds
s_mov_b32 m0, 63488
s_mov_b32 s60, 196608
buffer_load_dwordx4 v15, s[44:47], s60 offen lds
s_mov_b32 m0, 64512
s_mov_b32 s60, 196608
buffer_load_dwordx4 v16, s[44:47], s60 offen lds
s_mov_b32 m0, 71680
s_mov_b32 s60, 51200
buffer_load_dwordx4 v3, s[40:43], s60 offen lds
s_mov_b32 m0, 72704
s_mov_b32 s60, 52224
buffer_load_dwordx4 v3, s[40:43], s60 offen lds
s_mov_b32 m0, 79872
s_mov_b32 s60, 262144
buffer_load_dwordx4 v15, s[44:47], s60 offen lds
s_mov_b32 m0, 80896
s_mov_b32 s60, 262144
buffer_load_dwordx4 v16, s[44:47], s60 offen lds
s_mov_b32 m0, 88064
s_mov_b32 s60, 55296
buffer_load_dwordx4 v3, s[40:43], s60 offen lds
s_mov_b32 m0, 89088
s_mov_b32 s60, 56320
buffer_load_dwordx4 v3, s[40:43], s60 offen lds
s_mov_b32 m0, 96256
s_mov_b32 s60, 327680
buffer_load_dwordx4 v15, s[44:47], s60 offen lds
s_mov_b32 m0, 97280
s_mov_b32 s60, 327680
buffer_load_dwordx4 v16, s[44:47], s60 offen lds
s_waitcnt vmcnt(20)
s_barrier
s_mov_b32 m0, 104448
s_mov_b32 s60, 59392
buffer_load_dwordx4 v3, s[40:43], s60 offen lds
s_mov_b32 m0, 105472
s_mov_b32 s60, 60416
buffer_load_dwordx4 v3, s[40:43], s60 offen lds
s_mov_b32 m0, 112640
s_mov_b32 s60, 393216
buffer_load_dwordx4 v15, s[44:47], s60 offen lds
s_mov_b32 m0, 113664
s_mov_b32 s60, 393216
buffer_load_dwordx4 v16, s[44:47], s60 offen lds
s_waitcnt vmcnt(20)
s_barrier
s_mov_b32 m0, 120832
s_mov_b32 s60, 63488
buffer_load_dwordx4 v3, s[40:43], s60 offen lds
s_mov_b32 m0, 121856
s_mov_b32 s60, 64512
buffer_load_dwordx4 v3, s[40:43], s60 offen lds
s_mov_b32 m0, 129024
s_mov_b32 s60, 458752
buffer_load_dwordx4 v15, s[44:47], s60 offen lds
s_mov_b32 m0, 130048
s_mov_b32 s60, 458752
buffer_load_dwordx4 v16, s[44:47], s60 offen lds
s_waitcnt vmcnt(20)
s_barrier
s_waitcnt vmcnt(16)
s_barrier
s_waitcnt vmcnt(12)
s_barrier
s_waitcnt vmcnt(8)
s_barrier
s_waitcnt vmcnt(4)
s_barrier
s_waitcnt vmcnt(0)
s_barrier
k3_kernel_end:
s_endpgm
.section .rodata,"a"
.p2align 6
.amdhsa_kernel k3_kernel
  .amdhsa_next_free_vgpr 104
  .amdhsa_next_free_sgpr 96
  .amdhsa_accum_offset 104
  .amdhsa_group_segment_fixed_size 0
  .amdhsa_kernarg_size 80
  .amdhsa_user_sgpr_count 2
  .amdhsa_user_sgpr_kernarg_segment_ptr 1
  .amdhsa_system_sgpr_workgroup_id_x 1
.end_amdhsa_kernel
.text
.globl k4_kernel
.p2align 8
.type k4_kernel,@function
k4_kernel:
s_cmp_ge_u32 s2, 256
s_cbranch_scc1 k4_kernel_end
s_load_dwordx16 s[16:31], s[0:1], 0
s_load_dwordx4 s[32:35], s[0:1], 64
v_and_b32 v1, 63, v0
v_lshrrev_b32 v2, 6, v0
v_lshlrev_b32 v3, 4, v1
s_nop 0
v_readfirstlane_b32 s6, v2
s_and_b32 s7, s2, 7
s_lshr_b32 s8, s2, 3
s_lshr_b32 s9, s7, 1
s_lshl_b32 s9, s9, 2
s_and_b32 s10, s8, 3
s_add_u32 s4, s9, s10
s_and_b32 s9, s7, 1
s_lshl_b32 s9, s9, 3
s_lshr_b32 s10, s8, 2
s_add_u32 s5, s9, s10
s_mov_b32 s61, 0x3f803f80
s_waitcnt lgkmcnt(0)
s_mul_i32 s7, s4, 131072
s_add_u32 s40, s34, s7
s_addc_u32 s41, s35, 0
s_add_u32 s40, s40, 10485760
s_addc_u32 s41, s41, 0
s_and_b32 s41, s41, 0xffff
s_mov_b32 s42, 131072
s_mov_b32 s43, 0x00020000
s_mul_i32 s7, s5, 224
s_add_u32 s44, s24, s7
s_addc_u32 s45, s25, 0
s_and_b32 s45, s45, 0xffff
s_mov_b32 s46, 0
s_mov_b32 s47, 0x00020000
s_sub_u32 s46, 1835008, s7
s_mul_i32 s7, s5, 224
s_add_u32 s48, s26, s7
s_addc_u32 s49, s27, 0
s_and_b32 s49, s49, 0xffff
s_mov_b32 s50, 0
s_mov_b32 s51, 0x00020000
s_sub_u32 s50, 1835008, s7
s_mov_b32 s52, s34
s_mov_b32 s53, s35
s_and_b32 s53, s53, 0xffff
s_mov_b32 s54, 33554432
s_mov_b32 s55, 0x00020000
v_and_b32 v4, 15, v1
v_lshrrev_b32 v5, 5, v1
v_bfe_u32 v6, v1, 4, 1
v_lshrrev_b32 v7, 2, v4
v_lshl_add_u32 v7, v5, 3, v7
v_and_b32 v8, 3, v4
s_cmp_eq_u32 s6, 1
s_cbranch_scc1 k4_kernel_w1
s_cmp_eq_u32 s6, 2
s_cbranch_scc1 k4_kernel_w2
s_cmp_eq_u32 s6, 3
s_cbranch_scc1 k4_kernel_w3
s_cmp_eq_u32 s6, 4
s_cbranch_scc1 k4_kernel_w4
s_cmp_eq_u32 s6, 5
s_cbranch_scc1 k4_kernel_w5
s_cmp_eq_u32 s6, 6
s_cbranch_scc1 k4_kernel_w6
s_cmp_eq_u32 s6, 7
s_cbranch_scc1 k4_kernel_w7
v_mul_u32_u24 v14, 224, v7
v_lshl_add_u32 v14, v8, 3, v14
v_mul_u32_u24 v15, 14464, v6
v_add_u32 v9, v14, v15
s_mov_b32 s60, 0
buffer_load_dwordx4 v[76:79], v3, s[40:43], s60 offen
s_mov_b32 s60, 1024
buffer_load_dwordx4 v[80:83], v3, s[40:43], s60 offen
s_mov_b32 s60, 2048
buffer_load_dwordx4 v[84:87], v3, s[40:43], s60 offen
s_mov_b32 s60, 3072
buffer_load_dwordx4 v[88:91], v3, s[40:43], s60 offen
s_mov_b32 s60, 4096
buffer_load_dwordx4 v[92:95], v3, s[40:43], s60 offen
s_mov_b32 s60, 5120
buffer_load_dwordx4 v[96:99], v3, s[40:43], s60 offen
s_mov_b32 s60, 6144
buffer_load_dwordx4 v[100:103], v3, s[40:43], s60 offen
s_barrier
v_add_u32 v10, 0, v9
ds_read_b64_tr_b16 v[20:21], v10 offset:0
ds_read_b64_tr_b16 v[22:23], v10 offset:896
ds_read_b64_tr_b16 v[24:25], v10 offset:32
ds_read_b64_tr_b16 v[26:27], v10 offset:928
ds_read_b64_tr_b16 v[28:29], v10 offset:64
ds_read_b64_tr_b16 v[30:31], v10 offset:960
ds_read_b64_tr_b16 v[32:33], v10 offset:96
ds_read_b64_tr_b16 v[34:35], v10 offset:992
ds_read_b64_tr_b16 v[36:37], v10 offset:128
ds_read_b64_tr_b16 v[38:39], v10 offset:1024
ds_read_b64_tr_b16 v[40:41], v10 offset:160
ds_read_b64_tr_b16 v[42:43], v10 offset:1056
ds_read_b64_tr_b16 v[44:45], v10 offset:192
ds_read_b64_tr_b16 v[46:47], v10 offset:1088
s_waitcnt vmcnt(6) lgkmcnt(12)
v_mfma_f32_32x32x16_bf16 v[108:123], v[20:23], v[76:79], 0
ds_read_b64_tr_b16 v[48:49], v10 offset:3584
ds_read_b64_tr_b16 v[50:51], v10 offset:4480
s_waitcnt lgkmcnt(12)
v_mfma_f32_32x32x16_bf16 v[124:139], v[24:27], v[76:79], 0
ds_read_b64_tr_b16 v[52:53], v10 offset:3616
ds_read_b64_tr_b16 v[54:55], v10 offset:4512
s_waitcnt lgkmcnt(12)
v_mfma_f32_32x32x16_bf16 v[140:155], v[28:31], v[76:79], 0
ds_read_b64_tr_b16 v[56:57], v10 offset:3648
ds_read_b64_tr_b16 v[58:59], v10 offset:4544
s_waitcnt lgkmcnt(12)
v_mfma_f32_32x32x16_bf16 v[156:171], v[32:35], v[76:79], 0
ds_read_b64_tr_b16 v[60:61], v10 offset:3680
ds_read_b64_tr_b16 v[62:63], v10 offset:4576
s_waitcnt lgkmcnt(12)
v_mfma_f32_32x32x16_bf16 v[172:187], v[36:39], v[76:79], 0
ds_read_b64_tr_b16 v[64:65], v10 offset:3712
ds_read_b64_tr_b16 v[66:67], v10 offset:4608
s_waitcnt lgkmcnt(12)
v_mfma_f32_32x32x16_bf16 v[188:203], v[40:43], v[76:79], 0
ds_read_b64_tr_b16 v[68:69], v10 offset:3744
ds_read_b64_tr_b16 v[70:71], v10 offset:4640
s_waitcnt lgkmcnt(12)
v_mfma_f32_32x32x16_bf16 v[204:219], v[44:47], v[76:79], 0
s_mov_b32 s60, 7168
buffer_load_dwordx4 v[104:107], v3, s[40:43], s60 offen
ds_read_b64_tr_b16 v[72:73], v10 offset:3776
ds_read_b64_tr_b16 v[74:75], v10 offset:4672
s_waitcnt vmcnt(6) lgkmcnt(12)
v_mfma_f32_32x32x16_bf16 v[108:123], v[48:51], v[80:83], v[108:123]
ds_read_b64_tr_b16 v[20:21], v10 offset:7168
ds_read_b64_tr_b16 v[22:23], v10 offset:8064
s_waitcnt lgkmcnt(12)
v_mfma_f32_32x32x16_bf16 v[124:139], v[52:55], v[80:83], v[124:139]
ds_read_b64_tr_b16 v[24:25], v10 offset:7200
ds_read_b64_tr_b16 v[26:27], v10 offset:8096
s_waitcnt lgkmcnt(12)
v_mfma_f32_32x32x16_bf16 v[140:155], v[56:59], v[80:83], v[140:155]
ds_read_b64_tr_b16 v[28:29], v10 offset:7232
ds_read_b64_tr_b16 v[30:31], v10 offset:8128
s_waitcnt lgkmcnt(12)
v_mfma_f32_32x32x16_bf16 v[156:171], v[60:63], v[80:83], v[156:171]
ds_read_b64_tr_b16 v[32:33], v10 offset:7264
ds_read_b64_tr_b16 v[34:35], v10 offset:8160
s_waitcnt lgkmcnt(12)
v_mfma_f32_32x32x16_bf16 v[172:187], v[64:67], v[80:83], v[172:187]
ds_read_b64_tr_b16 v[36:37], v10 offset:7296
ds_read_b64_tr_b16 v[38:39], v10 offset:8192
s_waitcnt lgkmcnt(12)
v_mfma_f32_32x32x16_bf16 v[188:203], v[68:71], v[80:83], v[188:203]
ds_read_b64_tr_b16 v[40:41], v10 offset:7328
ds_read_b64_tr_b16 v[42:43], v10 offset:8224
s_waitcnt lgkmcnt(12)
v_mfma_f32_32x32x16_bf16 v[204:219], v[72:75], v[80:83], v[204:219]
s_mov_b32 s60, 8192
buffer_load_dwordx4 v[76:79], v3, s[40:43], s60 offen
ds_read_b64_tr_b16 v[44:45], v10 offset:7360
ds_read_b64_tr_b16 v[46:47], v10 offset:8256
s_waitcnt vmcnt(6) lgkmcnt(12)
v_mfma_f32_32x32x16_bf16 v[108:123], v[20:23], v[84:87], v[108:123]
ds_read_b64_tr_b16 v[48:49], v10 offset:10752
ds_read_b64_tr_b16 v[50:51], v10 offset:11648
s_waitcnt lgkmcnt(12)
v_mfma_f32_32x32x16_bf16 v[124:139], v[24:27], v[84:87], v[124:139]
ds_read_b64_tr_b16 v[52:53], v10 offset:10784
ds_read_b64_tr_b16 v[54:55], v10 offset:11680
s_waitcnt lgkmcnt(12)
v_mfma_f32_32x32x16_bf16 v[140:155], v[28:31], v[84:87], v[140:155]
ds_read_b64_tr_b16 v[56:57], v10 offset:10816
ds_read_b64_tr_b16 v[58:59], v10 offset:11712
s_waitcnt lgkmcnt(12)
v_mfma_f32_32x32x16_bf16 v[156:171], v[32:35], v[84:87], v[156:171]
ds_read_b64_tr_b16 v[60:61], v10 offset:10848
ds_read_b64_tr_b16 v[62:63], v10 offset:11744
s_waitcnt lgkmcnt(12)
v_mfma_f32_32x32x16_bf16 v[172:187], v[36:39], v[84:87], v[172:187]
ds_read_b64_tr_b16 v[64:65], v10 offset:10880
ds_read_b64_tr_b16 v[66:67], v10 offset:11776
s_waitcnt lgkmcnt(12)
v_mfma_f32_32x32x16_bf16 v[188:203], v[40:43], v[84:87], v[188:203]
ds_read_b64_tr_b16 v[68:69], v10 offset:10912
ds_read_b64_tr_b16 v[70:71], v10 offset:11808
s_waitcnt lgkmcnt(12)
v_mfma_f32_32x32x16_bf16 v[204:219], v[44:47], v[84:87], v[204:219]
s_mov_b32 s60, 9216
buffer_load_dwordx4 v[80:83], v3, s[40:43], s60 offen
ds_read_b64_tr_b16 v[72:73], v10 offset:10944
ds_read_b64_tr_b16 v[74:75], v10 offset:11840
s_barrier
v_add_u32 v11, 28928, v9
s_waitcnt vmcnt(6) lgkmcnt(12)
v_mfma_f32_32x32x16_bf16 v[108:123], v[48:51], v[88:91], v[108:123]
ds_read_b64_tr_b16 v[20:21], v11 offset:0
ds_read_b64_tr_b16 v[22:23], v11 offset:896
s_waitcnt lgkmcnt(12)
v_mfma_f32_32x32x16_bf16 v[124:139], v[52:55], v[88:91], v[124:139]
ds_read_b64_tr_b16 v[24:25], v11 offset:32
ds_read_b64_tr_b16 v[26:27], v11 offset:928
s_waitcnt lgkmcnt(12)
v_mfma_f32_32x32x16_bf16 v[140:155], v[56:59], v[88:91], v[140:155]
ds_read_b64_tr_b16 v[28:29], v11 offset:64
ds_read_b64_tr_b16 v[30:31], v11 offset:960
s_waitcnt lgkmcnt(12)
v_mfma_f32_32x32x16_bf16 v[156:171], v[60:63], v[88:91], v[156:171]
ds_read_b64_tr_b16 v[32:33], v11 offset:96
ds_read_b64_tr_b16 v[34:35], v11 offset:992
s_waitcnt lgkmcnt(12)
v_mfma_f32_32x32x16_bf16 v[172:187], v[64:67], v[88:91], v[172:187]
ds_read_b64_tr_b16 v[36:37], v11 offset:128
ds_read_b64_tr_b16 v[38:39], v11 offset:1024
s_waitcnt lgkmcnt(12)
v_mfma_f32_32x32x16_bf16 v[188:203], v[68:71], v[88:91], v[188:203]
ds_read_b64_tr_b16 v[40:41], v11 offset:160
ds_read_b64_tr_b16 v[42:43], v11 offset:1056
s_waitcnt lgkmcnt(12)
v_mfma_f32_32x32x16_bf16 v[204:219], v[72:75], v[88:91], v[204:219]
s_mov_b32 s60, 10240
buffer_load_dwordx4 v[84:87], v3, s[40:43], s60 offen
ds_read_b64_tr_b16 v[44:45], v11 offset:192
ds_read_b64_tr_b16 v[46:47], v11 offset:1088
s_waitcnt vmcnt(6) lgkmcnt(12)
v_mfma_f32_32x32x16_bf16 v[108:123], v[20:23], v[92:95], v[108:123]
ds_read_b64_tr_b16 v[48:49], v11 offset:3584
ds_read_b64_tr_b16 v[50:51], v11 offset:4480
s_waitcnt lgkmcnt(12)
v_mfma_f32_32x32x16_bf16 v[124:139], v[24:27], v[92:95], v[124:139]
ds_read_b64_tr_b16 v[52:53], v11 offset:3616
ds_read_b64_tr_b16 v[54:55], v11 offset:4512
s_waitcnt lgkmcnt(12)
v_mfma_f32_32x32x16_bf16 v[140:155], v[28:31], v[92:95], v[140:155]
ds_read_b64_tr_b16 v[56:57], v11 offset:3648
ds_read_b64_tr_b16 v[58:59], v11 offset:4544
s_waitcnt lgkmcnt(12)
v_mfma_f32_32x32x16_bf16 v[156:171], v[32:35], v[92:95], v[156:171]
ds_read_b64_tr_b16 v[60:61], v11 offset:3680
ds_read_b64_tr_b16 v[62:63], v11 offset:4576
s_waitcnt lgkmcnt(12)
v_mfma_f32_32x32x16_bf16 v[172:187], v[36:39], v[92:95], v[172:187]
ds_read_b64_tr_b16 v[64:65], v11 offset:3712
ds_read_b64_tr_b16 v[66:67], v11 offset:4608
s_waitcnt lgkmcnt(12)
v_mfma_f32_32x32x16_bf16 v[188:203], v[40:43], v[92:95], v[188:203]
ds_read_b64_tr_b16 v[68:69], v11 offset:3744
ds_read_b64_tr_b16 v[70:71], v11 offset:4640
s_waitcnt lgkmcnt(12)
v_mfma_f32_32x32x16_bf16 v[204:219], v[44:47], v[92:95], v[204:219]
s_mov_b32 s60, 11264
buffer_load_dwordx4 v[88:91], v3, s[40:43], s60 offen
ds_read_b64_tr_b16 v[72:73], v11 offset:3776
ds_read_b64_tr_b16 v[74:75], v11 offset:4672
s_waitcnt vmcnt(6) lgkmcnt(12)
v_mfma_f32_32x32x16_bf16 v[108:123], v[48:51], v[96:99], v[108:123]
ds_read_b64_tr_b16 v[20:21], v11 offset:7168
ds_read_b64_tr_b16 v[22:23], v11 offset:8064
s_waitcnt lgkmcnt(12)
v_mfma_f32_32x32x16_bf16 v[124:139], v[52:55], v[96:99], v[124:139]
ds_read_b64_tr_b16 v[24:25], v11 offset:7200
ds_read_b64_tr_b16 v[26:27], v11 offset:8096
s_waitcnt lgkmcnt(12)
v_mfma_f32_32x32x16_bf16 v[140:155], v[56:59], v[96:99], v[140:155]
ds_read_b64_tr_b16 v[28:29], v11 offset:7232
ds_read_b64_tr_b16 v[30:31], v11 offset:8128
s_waitcnt lgkmcnt(12)
v_mfma_f32_32x32x16_bf16 v[156:171], v[60:63], v[96:99], v[156:171]
ds_read_b64_tr_b16 v[32:33], v11 offset:7264
ds_read_b64_tr_b16 v[34:35], v11 offset:8160
s_waitcnt lgkmcnt(12)
v_mfma_f32_32x32x16_bf16 v[172:187], v[64:67], v[96:99], v[172:187]
ds_read_b64_tr_b16 v[36:37], v11 offset:7296
ds_read_b64_tr_b16 v[38:39], v11 offset:8192
s_waitcnt lgkmcnt(12)
v_mfma_f32_32x32x16_bf16 v[188:203], v[68:71], v[96:99], v[188:203]
ds_read_b64_tr_b16 v[40:41], v11 offset:7328
ds_read_b64_tr_b16 v[42:43], v11 offset:8224
s_waitcnt lgkmcnt(12)
v_mfma_f32_32x32x16_bf16 v[204:219], v[72:75], v[96:99], v[204:219]
s_mov_b32 s60, 12288
buffer_load_dwordx4 v[92:95], v3, s[40:43], s60 offen
ds_read_b64_tr_b16 v[44:45], v11 offset:7360
ds_read_b64_tr_b16 v[46:47], v11 offset:8256
s_waitcnt vmcnt(6) lgkmcnt(12)
v_mfma_f32_32x32x16_bf16 v[108:123], v[20:23], v[100:103], v[108:123]
ds_read_b64_tr_b16 v[48:49], v11 offset:10752
ds_read_b64_tr_b16 v[50:51], v11 offset:11648
s_waitcnt lgkmcnt(12)
v_mfma_f32_32x32x16_bf16 v[124:139], v[24:27], v[100:103], v[124:139]
ds_read_b64_tr_b16 v[52:53], v11 offset:10784
ds_read_b64_tr_b16 v[54:55], v11 offset:11680
s_waitcnt lgkmcnt(12)
v_mfma_f32_32x32x16_bf16 v[140:155], v[28:31], v[100:103], v[140:155]
ds_read_b64_tr_b16 v[56:57], v11 offset:10816
ds_read_b64_tr_b16 v[58:59], v11 offset:11712
s_waitcnt lgkmcnt(12)
v_mfma_f32_32x32x16_bf16 v[156:171], v[32:35], v[100:103], v[156:171]
ds_read_b64_tr_b16 v[60:61], v11 offset:10848
ds_read_b64_tr_b16 v[62:63], v11 offset:11744
s_waitcnt lgkmcnt(12)
v_mfma_f32_32x32x16_bf16 v[172:187], v[36:39], v[100:103], v[172:187]
ds_read_b64_tr_b16 v[64:65], v11 offset:10880
ds_read_b64_tr_b16 v[66:67], v11 offset:11776
s_waitcnt lgkmcnt(12)
v_mfma_f32_32x32x16_bf16 v[188:203], v[40:43], v[100:103], v[188:203]
ds_read_b64_tr_b16 v[68:69], v11 offset:10912
ds_read_b64_tr_b16 v[70:71], v11 offset:11808
s_waitcnt lgkmcnt(12)
v_mfma_f32_32x32x16_bf16 v[204:219], v[44:47], v[100:103], v[204:219]
s_mov_b32 s60, 13312
buffer_load_dwordx4 v[96:99], v3, s[40:43], s60 offen
ds_read_b64_tr_b16 v[72:73], v11 offset:10944
ds_read_b64_tr_b16 v[74:75], v11 offset:11840
s_barrier
v_add_u32 v10, 57856, v9
s_waitcnt vmcnt(6) lgkmcnt(12)
v_mfma_f32_32x32x16_bf16 v[108:123], v[48:51], v[104:107], v[108:123]
ds_read_b64_tr_b16 v[20:21], v10 offset:0
ds_read_b64_tr_b16 v[22:23], v10 offset:896
s_waitcnt lgkmcnt(12)
v_mfma_f32_32x32x16_bf16 v[124:139], v[52:55], v[104:107], v[124:139]
ds_read_b64_tr_b16 v[24:25], v10 offset:32
ds_read_b64_tr_b16 v[26:27], v10 offset:928
s_waitcnt lgkmcnt(12)
v_mfma_f32_32x32x16_bf16 v[140:155], v[56:59], v[104:107], v[140:155]
ds_read_b64_tr_b16 v[28:29], v10 offset:64
ds_read_b64_tr_b16 v[30:31], v10 offset:960
s_waitcnt lgkmcnt(12)
v_mfma_f32_32x32x16_bf16 v[156:171], v[60:63], v[104:107], v[156:171]
ds_read_b64_tr_b16 v[32:33], v10 offset:96
ds_read_b64_tr_b16 v[34:35], v10 offset:992
s_waitcnt lgkmcnt(12)
v_mfma_f32_32x32x16_bf16 v[172:187], v[64:67], v[104:107], v[172:187]
ds_read_b64_tr_b16 v[36:37], v10 offset:128
ds_read_b64_tr_b16 v[38:39], v10 offset:1024
s_waitcnt lgkmcnt(12)
v_mfma_f32_32x32x16_bf16 v[188:203], v[68:71], v[104:107], v[188:203]
ds_read_b64_tr_b16 v[40:41], v10 offset:160
ds_read_b64_tr_b16 v[42:43], v10 offset:1056
s_waitcnt lgkmcnt(12)
v_mfma_f32_32x32x16_bf16 v[204:219], v[72:75], v[104:107], v[204:219]
s_mov_b32 s60, 14336
buffer_load_dwordx4 v[100:103], v3, s[40:43], s60 offen
ds_read_b64_tr_b16 v[44:45], v10 offset:192
ds_read_b64_tr_b16 v[46:47], v10 offset:1088
s_waitcnt vmcnt(6) lgkmcnt(12)
v_mfma_f32_32x32x16_bf16 v[108:123], v[20:23], v[76:79], v[108:123]
ds_read_b64_tr_b16 v[48:49], v10 offset:3584
ds_read_b64_tr_b16 v[50:51], v10 offset:4480
s_waitcnt lgkmcnt(12)
v_mfma_f32_32x32x16_bf16 v[124:139], v[24:27], v[76:79], v[124:139]
ds_read_b64_tr_b16 v[52:53], v10 offset:3616
ds_read_b64_tr_b16 v[54:55], v10 offset:4512
s_waitcnt lgkmcnt(12)
v_mfma_f32_32x32x16_bf16 v[140:155], v[28:31], v[76:79], v[140:155]
ds_read_b64_tr_b16 v[56:57], v10 offset:3648
ds_read_b64_tr_b16 v[58:59], v10 offset:4544
s_waitcnt lgkmcnt(12)
v_mfma_f32_32x32x16_bf16 v[156:171], v[32:35], v[76:79], v[156:171]
ds_read_b64_tr_b16 v[60:61], v10 offset:3680
ds_read_b64_tr_b16 v[62:63], v10 offset:4576
s_waitcnt lgkmcnt(12)
v_mfma_f32_32x32x16_bf16 v[172:187], v[36:39], v[76:79], v[172:187]
ds_read_b64_tr_b16 v[64:65], v10 offset:3712
ds_read_b64_tr_b16 v[66:67], v10 offset:4608
s_waitcnt lgkmcnt(12)
v_mfma_f32_32x32x16_bf16 v[188:203], v[40:43], v[76:79], v[188:203]
ds_read_b64_tr_b16 v[68:69], v10 offset:3744
ds_read_b64_tr_b16 v[70:71], v10 offset:4640
s_waitcnt lgkmcnt(12)
v_mfma_f32_32x32x16_bf16 v[204:219], v[44:47], v[76:79], v[204:219]
s_mov_b32 s60, 15360
buffer_load_dwordx4 v[104:107], v3, s[40:43], s60 offen
ds_read_b64_tr_b16 v[72:73], v10 offset:3776
ds_read_b64_tr_b16 v[74:75], v10 offset:4672
s_waitcnt vmcnt(6) lgkmcnt(12)
v_mfma_f32_32x32x16_bf16 v[108:123], v[48:51], v[80:83], v[108:123]
ds_read_b64_tr_b16 v[20:21], v10 offset:7168
ds_read_b64_tr_b16 v[22:23], v10 offset:8064
s_waitcnt lgkmcnt(12)
v_mfma_f32_32x32x16_bf16 v[124:139], v[52:55], v[80:83], v[124:139]
ds_read_b64_tr_b16 v[24:25], v10 offset:7200
ds_read_b64_tr_b16 v[26:27], v10 offset:8096
s_waitcnt lgkmcnt(12)
v_mfma_f32_32x32x16_bf16 v[140:155], v[56:59], v[80:83], v[140:155]
ds_read_b64_tr_b16 v[28:29], v10 offset:7232
ds_read_b64_tr_b16 v[30:31], v10 offset:8128
s_waitcnt lgkmcnt(12)
v_mfma_f32_32x32x16_bf16 v[156:171], v[60:63], v[80:83], v[156:171]
ds_read_b64_tr_b16 v[32:33], v10 offset:7264
ds_read_b64_tr_b16 v[34:35], v10 offset:8160
s_waitcnt lgkmcnt(12)
v_mfma_f32_32x32x16_bf16 v[172:187], v[64:67], v[80:83], v[172:187]
ds_read_b64_tr_b16 v[36:37], v10 offset:7296
ds_read_b64_tr_b16 v[38:39], v10 offset:8192
s_waitcnt lgkmcnt(12)
v_mfma_f32_32x32x16_bf16 v[188:203], v[68:71], v[80:83], v[188:203]
ds_read_b64_tr_b16 v[40:41], v10 offset:7328
ds_read_b64_tr_b16 v[42:43], v10 offset:8224
s_waitcnt lgkmcnt(12)
v_mfma_f32_32x32x16_bf16 v[204:219], v[72:75], v[80:83], v[204:219]
s_mov_b32 s60, 16384
buffer_load_dwordx4 v[76:79], v3, s[40:43], s60 offen
ds_read_b64_tr_b16 v[44:45], v10 offset:7360
ds_read_b64_tr_b16 v[46:47], v10 offset:8256
s_waitcnt vmcnt(6) lgkmcnt(12)
v_mfma_f32_32x32x16_bf16 v[108:123], v[20:23], v[84:87], v[108:123]
ds_read_b64_tr_b16 v[48:49], v10 offset:10752
ds_read_b64_tr_b16 v[50:51], v10 offset:11648
s_waitcnt lgkmcnt(12)
v_mfma_f32_32x32x16_bf16 v[124:139], v[24:27], v[84:87], v[124:139]
ds_read_b64_tr_b16 v[52:53], v10 offset:10784
ds_read_b64_tr_b16 v[54:55], v10 offset:11680
s_waitcnt lgkmcnt(12)
v_mfma_f32_32x32x16_bf16 v[140:155], v[28:31], v[84:87], v[140:155]
ds_read_b64_tr_b16 v[56:57], v10 offset:10816
ds_read_b64_tr_b16 v[58:59], v10 offset:11712
s_waitcnt lgkmcnt(12)
v_mfma_f32_32x32x16_bf16 v[156:171], v[32:35], v[84:87], v[156:171]
ds_read_b64_tr_b16 v[60:61], v10 offset:10848
ds_read_b64_tr_b16 v[62:63], v10 offset:11744
s_waitcnt lgkmcnt(12)
v_mfma_f32_32x32x16_bf16 v[172:187], v[36:39], v[84:87], v[172:187]
ds_read_b64_tr_b16 v[64:65], v10 offset:10880
ds_read_b64_tr_b16 v[66:67], v10 offset:11776
s_waitcnt lgkmcnt(12)
v_mfma_f32_32x32x16_bf16 v[188:203], v[40:43], v[84:87], v[188:203]
ds_read_b64_tr_b16 v[68:69], v10 offset:10912
ds_read_b64_tr_b16 v[70:71], v10 offset:11808
s_waitcnt lgkmcnt(12)
v_mfma_f32_32x32x16_bf16 v[204:219], v[44:47], v[84:87], v[204:219]
s_mov_b32 s60, 17408
buffer_load_dwordx4 v[80:83], v3, s[40:43], s60 offen
ds_read_b64_tr_b16 v[72:73], v10 offset:10944
ds_read_b64_tr_b16 v[74:75], v10 offset:11840
s_barrier
v_add_u32 v11, 86784, v9
s_waitcnt vmcnt(6) lgkmcnt(12)
v_mfma_f32_32x32x16_bf16 v[108:123], v[48:51], v[88:91], v[108:123]
ds_read_b64_tr_b16 v[20:21], v11 offset:0
ds_read_b64_tr_b16 v[22:23], v11 offset:896
s_waitcnt lgkmcnt(12)
v_mfma_f32_32x32x16_bf16 v[124:139], v[52:55], v[88:91], v[124:139]
ds_read_b64_tr_b16 v[24:25], v11 offset:32
ds_read_b64_tr_b16 v[26:27], v11 offset:928
s_waitcnt lgkmcnt(12)
v_mfma_f32_32x32x16_bf16 v[140:155], v[56:59], v[88:91], v[140:155]
ds_read_b64_tr_b16 v[28:29], v11 offset:64
ds_read_b64_tr_b16 v[30:31], v11 offset:960
s_waitcnt lgkmcnt(12)
v_mfma_f32_32x32x16_bf16 v[156:171], v[60:63], v[88:91], v[156:171]
ds_read_b64_tr_b16 v[32:33], v11 offset:96
ds_read_b64_tr_b16 v[34:35], v11 offset:992
s_waitcnt lgkmcnt(12)
v_mfma_f32_32x32x16_bf16 v[172:187], v[64:67], v[88:91], v[172:187]
ds_read_b64_tr_b16 v[36:37], v11 offset:128
ds_read_b64_tr_b16 v[38:39], v11 offset:1024
s_waitcnt lgkmcnt(12)
v_mfma_f32_32x32x16_bf16 v[188:203], v[68:71], v[88:91], v[188:203]
ds_read_b64_tr_b16 v[40:41], v11 offset:160
ds_read_b64_tr_b16 v[42:43], v11 offset:1056
s_waitcnt lgkmcnt(12)
v_mfma_f32_32x32x16_bf16 v[204:219], v[72:75], v[88:91], v[204:219]
s_mov_b32 s60, 18432
buffer_load_dwordx4 v[84:87], v3, s[40:43], s60 offen
ds_read_b64_tr_b16 v[44:45], v11 offset:192
ds_read_b64_tr_b16 v[46:47], v11 offset:1088
s_waitcnt vmcnt(6) lgkmcnt(12)
v_mfma_f32_32x32x16_bf16 v[108:123], v[20:23], v[92:95], v[108:123]
ds_read_b64_tr_b16 v[48:49], v11 offset:3584
ds_read_b64_tr_b16 v[50:51], v11 offset:4480
s_waitcnt lgkmcnt(12)
v_mfma_f32_32x32x16_bf16 v[124:139], v[24:27], v[92:95], v[124:139]
ds_read_b64_tr_b16 v[52:53], v11 offset:3616
ds_read_b64_tr_b16 v[54:55], v11 offset:4512
s_waitcnt lgkmcnt(12)
v_mfma_f32_32x32x16_bf16 v[140:155], v[28:31], v[92:95], v[140:155]
ds_read_b64_tr_b16 v[56:57], v11 offset:3648
ds_read_b64_tr_b16 v[58:59], v11 offset:4544
s_waitcnt lgkmcnt(12)
v_mfma_f32_32x32x16_bf16 v[156:171], v[32:35], v[92:95], v[156:171]
ds_read_b64_tr_b16 v[60:61], v11 offset:3680
ds_read_b64_tr_b16 v[62:63], v11 offset:4576
s_waitcnt lgkmcnt(12)
v_mfma_f32_32x32x16_bf16 v[172:187], v[36:39], v[92:95], v[172:187]
ds_read_b64_tr_b16 v[64:65], v11 offset:3712
ds_read_b64_tr_b16 v[66:67], v11 offset:4608
s_waitcnt lgkmcnt(12)
v_mfma_f32_32x32x16_bf16 v[188:203], v[40:43], v[92:95], v[188:203]
ds_read_b64_tr_b16 v[68:69], v11 offset:3744
ds_read_b64_tr_b16 v[70:71], v11 offset:4640
s_waitcnt lgkmcnt(12)
v_mfma_f32_32x32x16_bf16 v[204:219], v[44:47], v[92:95], v[204:219]
s_mov_b32 s60, 19456
buffer_load_dwordx4 v[88:91], v3, s[40:43], s60 offen
ds_read_b64_tr_b16 v[72:73], v11 offset:3776
ds_read_b64_tr_b16 v[74:75], v11 offset:4672
s_waitcnt vmcnt(6) lgkmcnt(12)
v_mfma_f32_32x32x16_bf16 v[108:123], v[48:51], v[96:99], v[108:123]
ds_read_b64_tr_b16 v[20:21], v11 offset:7168
ds_read_b64_tr_b16 v[22:23], v11 offset:8064
s_waitcnt lgkmcnt(12)
v_mfma_f32_32x32x16_bf16 v[124:139], v[52:55], v[96:99], v[124:139]
ds_read_b64_tr_b16 v[24:25], v11 offset:7200
ds_read_b64_tr_b16 v[26:27], v11 offset:8096
s_waitcnt lgkmcnt(12)
v_mfma_f32_32x32x16_bf16 v[140:155], v[56:59], v[96:99], v[140:155]
ds_read_b64_tr_b16 v[28:29], v11 offset:7232
ds_read_b64_tr_b16 v[30:31], v11 offset:8128
s_waitcnt lgkmcnt(12)
v_mfma_f32_32x32x16_bf16 v[156:171], v[60:63], v[96:99], v[156:171]
ds_read_b64_tr_b16 v[32:33], v11 offset:7264
ds_read_b64_tr_b16 v[34:35], v11 offset:8160
s_waitcnt lgkmcnt(12)
v_mfma_f32_32x32x16_bf16 v[172:187], v[64:67], v[96:99], v[172:187]
ds_read_b64_tr_b16 v[36:37], v11 offset:7296
ds_read_b64_tr_b16 v[38:39], v11 offset:8192
s_waitcnt lgkmcnt(12)
v_mfma_f32_32x32x16_bf16 v[188:203], v[68:71], v[96:99], v[188:203]
ds_read_b64_tr_b16 v[40:41], v11 offset:7328
ds_read_b64_tr_b16 v[42:43], v11 offset:8224
s_waitcnt lgkmcnt(12)
v_mfma_f32_32x32x16_bf16 v[204:219], v[72:75], v[96:99], v[204:219]
s_mov_b32 s60, 20480
buffer_load_dwordx4 v[92:95], v3, s[40:43], s60 offen
ds_read_b64_tr_b16 v[44:45], v11 offset:7360
ds_read_b64_tr_b16 v[46:47], v11 offset:8256
s_waitcnt vmcnt(6) lgkmcnt(12)
v_mfma_f32_32x32x16_bf16 v[108:123], v[20:23], v[100:103], v[108:123]
ds_read_b64_tr_b16 v[48:49], v11 offset:10752
ds_read_b64_tr_b16 v[50:51], v11 offset:11648
s_waitcnt lgkmcnt(12)
v_mfma_f32_32x32x16_bf16 v[124:139], v[24:27], v[100:103], v[124:139]
ds_read_b64_tr_b16 v[52:53], v11 offset:10784
ds_read_b64_tr_b16 v[54:55], v11 offset:11680
s_waitcnt lgkmcnt(12)
v_mfma_f32_32x32x16_bf16 v[140:155], v[28:31], v[100:103], v[140:155]
ds_read_b64_tr_b16 v[56:57], v11 offset:10816
ds_read_b64_tr_b16 v[58:59], v11 offset:11712
s_waitcnt lgkmcnt(12)
v_mfma_f32_32x32x16_bf16 v[156:171], v[32:35], v[100:103], v[156:171]
ds_read_b64_tr_b16 v[60:61], v11 offset:10848
ds_read_b64_tr_b16 v[62:63], v11 offset:11744
s_waitcnt lgkmcnt(12)
v_mfma_f32_32x32x16_bf16 v[172:187], v[36:39], v[100:103], v[172:187]
ds_read_b64_tr_b16 v[64:65], v11 offset:10880
ds_read_b64_tr_b16 v[66:67], v11 offset:11776
s_waitcnt lgkmcnt(12)
v_mfma_f32_32x32x16_bf16 v[188:203], v[40:43], v[100:103], v[188:203]
ds_read_b64_tr_b16 v[68:69], v11 offset:10912
ds_read_b64_tr_b16 v[70:71], v11 offset:11808
s_waitcnt lgkmcnt(12)
v_mfma_f32_32x32x16_bf16 v[204:219], v[44:47], v[100:103], v[204:219]
s_mov_b32 s60, 21504
buffer_load_dwordx4 v[96:99], v3, s[40:43], s60 offen
ds_read_b64_tr_b16 v[72:73], v11 offset:10944
ds_read_b64_tr_b16 v[74:75], v11 offset:11840
s_barrier
v_add_u32 v10, 115712, v9
s_waitcnt vmcnt(6) lgkmcnt(12)
v_mfma_f32_32x32x16_bf16 v[108:123], v[48:51], v[104:107], v[108:123]
ds_read_b64_tr_b16 v[20:21], v10 offset:0
ds_read_b64_tr_b16 v[22:23], v10 offset:896
s_waitcnt lgkmcnt(12)
v_mfma_f32_32x32x16_bf16 v[124:139], v[52:55], v[104:107], v[124:139]
ds_read_b64_tr_b16 v[24:25], v10 offset:32
ds_read_b64_tr_b16 v[26:27], v10 offset:928
s_waitcnt lgkmcnt(12)
v_mfma_f32_32x32x16_bf16 v[140:155], v[56:59], v[104:107], v[140:155]
ds_read_b64_tr_b16 v[28:29], v10 offset:64
ds_read_b64_tr_b16 v[30:31], v10 offset:960
s_waitcnt lgkmcnt(12)
v_mfma_f32_32x32x16_bf16 v[156:171], v[60:63], v[104:107], v[156:171]
ds_read_b64_tr_b16 v[32:33], v10 offset:96
ds_read_b64_tr_b16 v[34:35], v10 offset:992
s_waitcnt lgkmcnt(12)
v_mfma_f32_32x32x16_bf16 v[172:187], v[64:67], v[104:107], v[172:187]
ds_read_b64_tr_b16 v[36:37], v10 offset:128
ds_read_b64_tr_b16 v[38:39], v10 offset:1024
s_waitcnt lgkmcnt(12)
v_mfma_f32_32x32x16_bf16 v[188:203], v[68:71], v[104:107], v[188:203]
ds_read_b64_tr_b16 v[40:41], v10 offset:160
ds_read_b64_tr_b16 v[42:43], v10 offset:1056
s_waitcnt lgkmcnt(12)
v_mfma_f32_32x32x16_bf16 v[204:219], v[72:75], v[104:107], v[204:219]
s_mov_b32 s60, 22528
buffer_load_dwordx4 v[100:103], v3, s[40:43], s60 offen
ds_read_b64_tr_b16 v[44:45], v10 offset:192
ds_read_b64_tr_b16 v[46:47], v10 offset:1088
s_waitcnt vmcnt(6) lgkmcnt(12)
v_mfma_f32_32x32x16_bf16 v[108:123], v[20:23], v[76:79], v[108:123]
ds_read_b64_tr_b16 v[48:49], v10 offset:3584
ds_read_b64_tr_b16 v[50:51], v10 offset:4480
s_waitcnt lgkmcnt(12)
v_mfma_f32_32x32x16_bf16 v[124:139], v[24:27], v[76:79], v[124:139]
ds_read_b64_tr_b16 v[52:53], v10 offset:3616
ds_read_b64_tr_b16 v[54:55], v10 offset:4512
s_waitcnt lgkmcnt(12)
v_mfma_f32_32x32x16_bf16 v[140:155], v[28:31], v[76:79], v[140:155]
ds_read_b64_tr_b16 v[56:57], v10 offset:3648
ds_read_b64_tr_b16 v[58:59], v10 offset:4544
s_waitcnt lgkmcnt(12)
v_mfma_f32_32x32x16_bf16 v[156:171], v[32:35], v[76:79], v[156:171]
ds_read_b64_tr_b16 v[60:61], v10 offset:3680
ds_read_b64_tr_b16 v[62:63], v10 offset:4576
s_waitcnt lgkmcnt(12)
v_mfma_f32_32x32x16_bf16 v[172:187], v[36:39], v[76:79], v[172:187]
ds_read_b64_tr_b16 v[64:65], v10 offset:3712
ds_read_b64_tr_b16 v[66:67], v10 offset:4608
s_waitcnt lgkmcnt(12)
v_mfma_f32_32x32x16_bf16 v[188:203], v[40:43], v[76:79], v[188:203]
ds_read_b64_tr_b16 v[68:69], v10 offset:3744
ds_read_b64_tr_b16 v[70:71], v10 offset:4640
s_waitcnt lgkmcnt(12)
v_mfma_f32_32x32x16_bf16 v[204:219], v[44:47], v[76:79], v[204:219]
s_mov_b32 s60, 23552
buffer_load_dwordx4 v[104:107], v3, s[40:43], s60 offen
ds_read_b64_tr_b16 v[72:73], v10 offset:3776
ds_read_b64_tr_b16 v[74:75], v10 offset:4672
s_waitcnt vmcnt(6) lgkmcnt(12)
v_mfma_f32_32x32x16_bf16 v[108:123], v[48:51], v[80:83], v[108:123]
ds_read_b64_tr_b16 v[20:21], v10 offset:7168
ds_read_b64_tr_b16 v[22:23], v10 offset:8064
s_waitcnt lgkmcnt(12)
v_mfma_f32_32x32x16_bf16 v[124:139], v[52:55], v[80:83], v[124:139]
ds_read_b64_tr_b16 v[24:25], v10 offset:7200
ds_read_b64_tr_b16 v[26:27], v10 offset:8096
s_waitcnt lgkmcnt(12)
v_mfma_f32_32x32x16_bf16 v[140:155], v[56:59], v[80:83], v[140:155]
ds_read_b64_tr_b16 v[28:29], v10 offset:7232
ds_read_b64_tr_b16 v[30:31], v10 offset:8128
s_waitcnt lgkmcnt(12)
v_mfma_f32_32x32x16_bf16 v[156:171], v[60:63], v[80:83], v[156:171]
ds_read_b64_tr_b16 v[32:33], v10 offset:7264
ds_read_b64_tr_b16 v[34:35], v10 offset:8160
s_waitcnt lgkmcnt(12)
v_mfma_f32_32x32x16_bf16 v[172:187], v[64:67], v[80:83], v[172:187]
ds_read_b64_tr_b16 v[36:37], v10 offset:7296
ds_read_b64_tr_b16 v[38:39], v10 offset:8192
s_waitcnt lgkmcnt(12)
v_mfma_f32_32x32x16_bf16 v[188:203], v[68:71], v[80:83], v[188:203]
ds_read_b64_tr_b16 v[40:41], v10 offset:7328
ds_read_b64_tr_b16 v[42:43], v10 offset:8224
s_waitcnt lgkmcnt(12)
v_mfma_f32_32x32x16_bf16 v[204:219], v[72:75], v[80:83], v[204:219]
s_mov_b32 s60, 24576
buffer_load_dwordx4 v[76:79], v3, s[40:43], s60 offen
ds_read_b64_tr_b16 v[44:45], v10 offset:7360
ds_read_b64_tr_b16 v[46:47], v10 offset:8256
s_waitcnt vmcnt(6) lgkmcnt(12)
v_mfma_f32_32x32x16_bf16 v[108:123], v[20:23], v[84:87], v[108:123]
ds_read_b64_tr_b16 v[48:49], v10 offset:10752
ds_read_b64_tr_b16 v[50:51], v10 offset:11648
s_waitcnt lgkmcnt(12)
v_mfma_f32_32x32x16_bf16 v[124:139], v[24:27], v[84:87], v[124:139]
ds_read_b64_tr_b16 v[52:53], v10 offset:10784
ds_read_b64_tr_b16 v[54:55], v10 offset:11680
s_waitcnt lgkmcnt(12)
v_mfma_f32_32x32x16_bf16 v[140:155], v[28:31], v[84:87], v[140:155]
ds_read_b64_tr_b16 v[56:57], v10 offset:10816
ds_read_b64_tr_b16 v[58:59], v10 offset:11712
s_waitcnt lgkmcnt(12)
v_mfma_f32_32x32x16_bf16 v[156:171], v[32:35], v[84:87], v[156:171]
ds_read_b64_tr_b16 v[60:61], v10 offset:10848
ds_read_b64_tr_b16 v[62:63], v10 offset:11744
s_waitcnt lgkmcnt(12)
v_mfma_f32_32x32x16_bf16 v[172:187], v[36:39], v[84:87], v[172:187]
ds_read_b64_tr_b16 v[64:65], v10 offset:10880
ds_read_b64_tr_b16 v[66:67], v10 offset:11776
s_waitcnt lgkmcnt(12)
v_mfma_f32_32x32x16_bf16 v[188:203], v[40:43], v[84:87], v[188:203]
ds_read_b64_tr_b16 v[68:69], v10 offset:10912
ds_read_b64_tr_b16 v[70:71], v10 offset:11808
s_waitcnt lgkmcnt(12)
v_mfma_f32_32x32x16_bf16 v[204:219], v[44:47], v[84:87], v[204:219]
s_mov_b32 s60, 25600
buffer_load_dwordx4 v[80:83], v3, s[40:43], s60 offen
ds_read_b64_tr_b16 v[72:73], v10 offset:10944
ds_read_b64_tr_b16 v[74:75], v10 offset:11840
s_barrier
v_add_u32 v11, 0, v9
s_waitcnt vmcnt(6) lgkmcnt(12)
v_mfma_f32_32x32x16_bf16 v[108:123], v[48:51], v[88:91], v[108:123]
ds_read_b64_tr_b16 v[20:21], v11 offset:0
ds_read_b64_tr_b16 v[22:23], v11 offset:896
s_waitcnt lgkmcnt(12)
v_mfma_f32_32x32x16_bf16 v[124:139], v[52:55], v[88:91], v[124:139]
ds_read_b64_tr_b16 v[24:25], v11 offset:32
ds_read_b64_tr_b16 v[26:27], v11 offset:928
s_waitcnt lgkmcnt(12)
v_mfma_f32_32x32x16_bf16 v[140:155], v[56:59], v[88:91], v[140:155]
ds_read_b64_tr_b16 v[28:29], v11 offset:64
ds_read_b64_tr_b16 v[30:31], v11 offset:960
s_waitcnt lgkmcnt(12)
v_mfma_f32_32x32x16_bf16 v[156:171], v[60:63], v[88:91], v[156:171]
ds_read_b64_tr_b16 v[32:33], v11 offset:96
ds_read_b64_tr_b16 v[34:35], v11 offset:992
s_waitcnt lgkmcnt(12)
v_mfma_f32_32x32x16_bf16 v[172:187], v[64:67], v[88:91], v[172:187]
ds_read_b64_tr_b16 v[36:37], v11 offset:128
ds_read_b64_tr_b16 v[38:39], v11 offset:1024
s_waitcnt lgkmcnt(12)
v_mfma_f32_32x32x16_bf16 v[188:203], v[68:71], v[88:91], v[188:203]
ds_read_b64_tr_b16 v[40:41], v11 offset:160
ds_read_b64_tr_b16 v[42:43], v11 offset:1056
s_waitcnt lgkmcnt(12)
v_mfma_f32_32x32x16_bf16 v[204:219], v[72:75], v[88:91], v[204:219]
s_mov_b32 s60, 26624
buffer_load_dwordx4 v[84:87], v3, s[40:43], s60 offen
ds_read_b64_tr_b16 v[44:45], v11 offset:192
ds_read_b64_tr_b16 v[46:47], v11 offset:1088
s_waitcnt vmcnt(6) lgkmcnt(12)
v_mfma_f32_32x32x16_bf16 v[108:123], v[20:23], v[92:95], v[108:123]
ds_read_b64_tr_b16 v[48:49], v11 offset:3584
ds_read_b64_tr_b16 v[50:51], v11 offset:4480
s_waitcnt lgkmcnt(12)
v_mfma_f32_32x32x16_bf16 v[124:139], v[24:27], v[92:95], v[124:139]
ds_read_b64_tr_b16 v[52:53], v11 offset:3616
ds_read_b64_tr_b16 v[54:55], v11 offset:4512
s_waitcnt lgkmcnt(12)
v_mfma_f32_32x32x16_bf16 v[140:155], v[28:31], v[92:95], v[140:155]
ds_read_b64_tr_b16 v[56:57], v11 offset:3648
ds_read_b64_tr_b16 v[58:59], v11 offset:4544
s_waitcnt lgkmcnt(12)
v_mfma_f32_32x32x16_bf16 v[156:171], v[32:35], v[92:95], v[156:171]
ds_read_b64_tr_b16 v[60:61], v11 offset:3680
ds_read_b64_tr_b16 v[62:63], v11 offset:4576
s_waitcnt lgkmcnt(12)
v_mfma_f32_32x32x16_bf16 v[172:187], v[36:39], v[92:95], v[172:187]
ds_read_b64_tr_b16 v[64:65], v11 offset:3712
ds_read_b64_tr_b16 v[66:67], v11 offset:4608
s_waitcnt lgkmcnt(12)
v_mfma_f32_32x32x16_bf16 v[188:203], v[40:43], v[92:95], v[188:203]
ds_read_b64_tr_b16 v[68:69], v11 offset:3744
ds_read_b64_tr_b16 v[70:71], v11 offset:4640
s_waitcnt lgkmcnt(12)
v_mfma_f32_32x32x16_bf16 v[204:219], v[44:47], v[92:95], v[204:219]
s_mov_b32 s60, 27648
buffer_load_dwordx4 v[88:91], v3, s[40:43], s60 offen
ds_read_b64_tr_b16 v[72:73], v11 offset:3776
ds_read_b64_tr_b16 v[74:75], v11 offset:4672
s_waitcnt vmcnt(6) lgkmcnt(12)
v_mfma_f32_32x32x16_bf16 v[108:123], v[48:51], v[96:99], v[108:123]
ds_read_b64_tr_b16 v[20:21], v11 offset:7168
ds_read_b64_tr_b16 v[22:23], v11 offset:8064
s_waitcnt lgkmcnt(12)
v_mfma_f32_32x32x16_bf16 v[124:139], v[52:55], v[96:99], v[124:139]
ds_read_b64_tr_b16 v[24:25], v11 offset:7200
ds_read_b64_tr_b16 v[26:27], v11 offset:8096
s_waitcnt lgkmcnt(12)
v_mfma_f32_32x32x16_bf16 v[140:155], v[56:59], v[96:99], v[140:155]
ds_read_b64_tr_b16 v[28:29], v11 offset:7232
ds_read_b64_tr_b16 v[30:31], v11 offset:8128
s_waitcnt lgkmcnt(12)
v_mfma_f32_32x32x16_bf16 v[156:171], v[60:63], v[96:99], v[156:171]
ds_read_b64_tr_b16 v[32:33], v11 offset:7264
ds_read_b64_tr_b16 v[34:35], v11 offset:8160
s_waitcnt lgkmcnt(12)
v_mfma_f32_32x32x16_bf16 v[172:187], v[64:67], v[96:99], v[172:187]
ds_read_b64_tr_b16 v[36:37], v11 offset:7296
ds_read_b64_tr_b16 v[38:39], v11 offset:8192
s_waitcnt lgkmcnt(12)
v_mfma_f32_32x32x16_bf16 v[188:203], v[68:71], v[96:99], v[188:203]
ds_read_b64_tr_b16 v[40:41], v11 offset:7328
ds_read_b64_tr_b16 v[42:43], v11 offset:8224
s_waitcnt lgkmcnt(12)
v_mfma_f32_32x32x16_bf16 v[204:219], v[72:75], v[96:99], v[204:219]
s_mov_b32 s60, 28672
buffer_load_dwordx4 v[92:95], v3, s[40:43], s60 offen
ds_read_b64_tr_b16 v[44:45], v11 offset:7360
ds_read_b64_tr_b16 v[46:47], v11 offset:8256
s_waitcnt vmcnt(6) lgkmcnt(12)
v_mfma_f32_32x32x16_bf16 v[108:123], v[20:23], v[100:103], v[108:123]
ds_read_b64_tr_b16 v[48:49], v11 offset:10752
ds_read_b64_tr_b16 v[50:51], v11 offset:11648
s_waitcnt lgkmcnt(12)
v_mfma_f32_32x32x16_bf16 v[124:139], v[24:27], v[100:103], v[124:139]
ds_read_b64_tr_b16 v[52:53], v11 offset:10784
ds_read_b64_tr_b16 v[54:55], v11 offset:11680
s_waitcnt lgkmcnt(12)
v_mfma_f32_32x32x16_bf16 v[140:155], v[28:31], v[100:103], v[140:155]
ds_read_b64_tr_b16 v[56:57], v11 offset:10816
ds_read_b64_tr_b16 v[58:59], v11 offset:11712
s_waitcnt lgkmcnt(12)
v_mfma_f32_32x32x16_bf16 v[156:171], v[32:35], v[100:103], v[156:171]
ds_read_b64_tr_b16 v[60:61], v11 offset:10848
ds_read_b64_tr_b16 v[62:63], v11 offset:11744
s_waitcnt lgkmcnt(12)
v_mfma_f32_32x32x16_bf16 v[172:187], v[36:39], v[100:103], v[172:187]
ds_read_b64_tr_b16 v[64:65], v11 offset:10880
ds_read_b64_tr_b16 v[66:67], v11 offset:11776
s_waitcnt lgkmcnt(12)
v_mfma_f32_32x32x16_bf16 v[188:203], v[40:43], v[100:103], v[188:203]
ds_read_b64_tr_b16 v[68:69], v11 offset:10912
ds_read_b64_tr_b16 v[70:71], v11 offset:11808
s_waitcnt lgkmcnt(12)
v_mfma_f32_32x32x16_bf16 v[204:219], v[44:47], v[100:103], v[204:219]
s_mov_b32 s60, 29696
buffer_load_dwordx4 v[96:99], v3, s[40:43], s60 offen
ds_read_b64_tr_b16 v[72:73], v11 offset:10944
ds_read_b64_tr_b16 v[74:75], v11 offset:11840
s_barrier
v_add_u32 v10, 28928, v9
s_waitcnt vmcnt(6) lgkmcnt(12)
v_mfma_f32_32x32x16_bf16 v[108:123], v[48:51], v[104:107], v[108:123]
ds_read_b64_tr_b16 v[20:21], v10 offset:0
ds_read_b64_tr_b16 v[22:23], v10 offset:896
s_waitcnt lgkmcnt(12)
v_mfma_f32_32x32x16_bf16 v[124:139], v[52:55], v[104:107], v[124:139]
ds_read_b64_tr_b16 v[24:25], v10 offset:32
ds_read_b64_tr_b16 v[26:27], v10 offset:928
s_waitcnt lgkmcnt(12)
v_mfma_f32_32x32x16_bf16 v[140:155], v[56:59], v[104:107], v[140:155]
ds_read_b64_tr_b16 v[28:29], v10 offset:64
ds_read_b64_tr_b16 v[30:31], v10 offset:960
s_waitcnt lgkmcnt(12)
v_mfma_f32_32x32x16_bf16 v[156:171], v[60:63], v[104:107], v[156:171]
ds_read_b64_tr_b16 v[32:33], v10 offset:96
ds_read_b64_tr_b16 v[34:35], v10 offset:992
s_waitcnt lgkmcnt(12)
v_mfma_f32_32x32x16_bf16 v[172:187], v[64:67], v[104:107], v[172:187]
ds_read_b64_tr_b16 v[36:37], v10 offset:128
ds_read_b64_tr_b16 v[38:39], v10 offset:1024
s_waitcnt lgkmcnt(12)
v_mfma_f32_32x32x16_bf16 v[188:203], v[68:71], v[104:107], v[188:203]
ds_read_b64_tr_b16 v[40:41], v10 offset:160
ds_read_b64_tr_b16 v[42:43], v10 offset:1056
s_waitcnt lgkmcnt(12)
v_mfma_f32_32x32x16_bf16 v[204:219], v[72:75], v[104:107], v[204:219]
s_mov_b32 s60, 30720
buffer_load_dwordx4 v[100:103], v3, s[40:43], s60 offen
ds_read_b64_tr_b16 v[44:45], v10 offset:192
ds_read_b64_tr_b16 v[46:47], v10 offset:1088
s_waitcnt vmcnt(6) lgkmcnt(12)
v_mfma_f32_32x32x16_bf16 v[108:123], v[20:23], v[76:79], v[108:123]
ds_read_b64_tr_b16 v[48:49], v10 offset:3584
ds_read_b64_tr_b16 v[50:51], v10 offset:4480
s_waitcnt lgkmcnt(12)
v_mfma_f32_32x32x16_bf16 v[124:139], v[24:27], v[76:79], v[124:139]
ds_read_b64_tr_b16 v[52:53], v10 offset:3616
ds_read_b64_tr_b16 v[54:55], v10 offset:4512
s_waitcnt lgkmcnt(12)
v_mfma_f32_32x32x16_bf16 v[140:155], v[28:31], v[76:79], v[140:155]
ds_read_b64_tr_b16 v[56:57], v10 offset:3648
ds_read_b64_tr_b16 v[58:59], v10 offset:4544
s_waitcnt lgkmcnt(12)
v_mfma_f32_32x32x16_bf16 v[156:171], v[32:35], v[76:79], v[156:171]
ds_read_b64_tr_b16 v[60:61], v10 offset:3680
ds_read_b64_tr_b16 v[62:63], v10 offset:4576
s_waitcnt lgkmcnt(12)
v_mfma_f32_32x32x16_bf16 v[172:187], v[36:39], v[76:79], v[172:187]
ds_read_b64_tr_b16 v[64:65], v10 offset:3712
ds_read_b64_tr_b16 v[66:67], v10 offset:4608
s_waitcnt lgkmcnt(12)
v_mfma_f32_32x32x16_bf16 v[188:203], v[40:43], v[76:79], v[188:203]
ds_read_b64_tr_b16 v[68:69], v10 offset:3744
ds_read_b64_tr_b16 v[70:71], v10 offset:4640
s_waitcnt lgkmcnt(12)
v_mfma_f32_32x32x16_bf16 v[204:219], v[44:47], v[76:79], v[204:219]
s_mov_b32 s60, 31744
buffer_load_dwordx4 v[104:107], v3, s[40:43], s60 offen
ds_read_b64_tr_b16 v[72:73], v10 offset:3776
ds_read_b64_tr_b16 v[74:75], v10 offset:4672
s_waitcnt vmcnt(6) lgkmcnt(12)
v_mfma_f32_32x32x16_bf16 v[108:123], v[48:51], v[80:83], v[108:123]
ds_read_b64_tr_b16 v[20:21], v10 offset:7168
ds_read_b64_tr_b16 v[22:23], v10 offset:8064
s_waitcnt lgkmcnt(12)
v_mfma_f32_32x32x16_bf16 v[124:139], v[52:55], v[80:83], v[124:139]
ds_read_b64_tr_b16 v[24:25], v10 offset:7200
ds_read_b64_tr_b16 v[26:27], v10 offset:8096
s_waitcnt lgkmcnt(12)
v_mfma_f32_32x32x16_bf16 v[140:155], v[56:59], v[80:83], v[140:155]
ds_read_b64_tr_b16 v[28:29], v10 offset:7232
ds_read_b64_tr_b16 v[30:31], v10 offset:8128
s_waitcnt lgkmcnt(12)
v_mfma_f32_32x32x16_bf16 v[156:171], v[60:63], v[80:83], v[156:171]
ds_read_b64_tr_b16 v[32:33], v10 offset:7264
ds_read_b64_tr_b16 v[34:35], v10 offset:8160
s_waitcnt lgkmcnt(12)
v_mfma_f32_32x32x16_bf16 v[172:187], v[64:67], v[80:83], v[172:187]
ds_read_b64_tr_b16 v[36:37], v10 offset:7296
ds_read_b64_tr_b16 v[38:39], v10 offset:8192
s_waitcnt lgkmcnt(12)
v_mfma_f32_32x32x16_bf16 v[188:203], v[68:71], v[80:83], v[188:203]
ds_read_b64_tr_b16 v[40:41], v10 offset:7328
ds_read_b64_tr_b16 v[42:43], v10 offset:8224
s_waitcnt lgkmcnt(12)
v_mfma_f32_32x32x16_bf16 v[204:219], v[72:75], v[80:83], v[204:219]
ds_read_b64_tr_b16 v[44:45], v10 offset:7360
ds_read_b64_tr_b16 v[46:47], v10 offset:8256
s_waitcnt vmcnt(5) lgkmcnt(12)
v_mfma_f32_32x32x16_bf16 v[108:123], v[20:23], v[84:87], v[108:123]
ds_read_b64_tr_b16 v[48:49], v10 offset:10752
ds_read_b64_tr_b16 v[50:51], v10 offset:11648
s_waitcnt lgkmcnt(12)
v_mfma_f32_32x32x16_bf16 v[124:139], v[24:27], v[84:87], v[124:139]
ds_read_b64_tr_b16 v[52:53], v10 offset:10784
ds_read_b64_tr_b16 v[54:55], v10 offset:11680
s_waitcnt lgkmcnt(12)
v_mfma_f32_32x32x16_bf16 v[140:155], v[28:31], v[84:87], v[140:155]
ds_read_b64_tr_b16 v[56:57], v10 offset:10816
ds_read_b64_tr_b16 v[58:59], v10 offset:11712
s_waitcnt lgkmcnt(12)
v_mfma_f32_32x32x16_bf16 v[156:171], v[32:35], v[84:87], v[156:171]
ds_read_b64_tr_b16 v[60:61], v10 offset:10848
ds_read_b64_tr_b16 v[62:63], v10 offset:11744
s_waitcnt lgkmcnt(12)
v_mfma_f32_32x32x16_bf16 v[172:187], v[36:39], v[84:87], v[172:187]
ds_read_b64_tr_b16 v[64:65], v10 offset:10880
ds_read_b64_tr_b16 v[66:67], v10 offset:11776
s_waitcnt lgkmcnt(12)
v_mfma_f32_32x32x16_bf16 v[188:203], v[40:43], v[84:87], v[188:203]
ds_read_b64_tr_b16 v[68:69], v10 offset:10912
ds_read_b64_tr_b16 v[70:71], v10 offset:11808
s_waitcnt lgkmcnt(12)
v_mfma_f32_32x32x16_bf16 v[204:219], v[44:47], v[84:87], v[204:219]
ds_read_b64_tr_b16 v[72:73], v10 offset:10944
ds_read_b64_tr_b16 v[74:75], v10 offset:11840
s_barrier
v_add_u32 v11, 57856, v9
s_waitcnt vmcnt(4) lgkmcnt(12)
v_mfma_f32_32x32x16_bf16 v[108:123], v[48:51], v[88:91], v[108:123]
ds_read_b64_tr_b16 v[20:21], v11 offset:0
ds_read_b64_tr_b16 v[22:23], v11 offset:896
s_waitcnt lgkmcnt(12)
v_mfma_f32_32x32x16_bf16 v[124:139], v[52:55], v[88:91], v[124:139]
ds_read_b64_tr_b16 v[24:25], v11 offset:32
ds_read_b64_tr_b16 v[26:27], v11 offset:928
s_waitcnt lgkmcnt(12)
v_mfma_f32_32x32x16_bf16 v[140:155], v[56:59], v[88:91], v[140:155]
ds_read_b64_tr_b16 v[28:29], v11 offset:64
ds_read_b64_tr_b16 v[30:31], v11 offset:960
s_waitcnt lgkmcnt(12)
v_mfma_f32_32x32x16_bf16 v[156:171], v[60:63], v[88:91], v[156:171]
ds_read_b64_tr_b16 v[32:33], v11 offset:96
ds_read_b64_tr_b16 v[34:35], v11 offset:992
s_waitcnt lgkmcnt(12)
v_mfma_f32_32x32x16_bf16 v[172:187], v[64:67], v[88:91], v[172:187]
ds_read_b64_tr_b16 v[36:37], v11 offset:128
ds_read_b64_tr_b16 v[38:39], v11 offset:1024
s_waitcnt lgkmcnt(12)
v_mfma_f32_32x32x16_bf16 v[188:203], v[68:71], v[88:91], v[188:203]
ds_read_b64_tr_b16 v[40:41], v11 offset:160
ds_read_b64_tr_b16 v[42:43], v11 offset:1056
s_waitcnt lgkmcnt(12)
v_mfma_f32_32x32x16_bf16 v[204:219], v[72:75], v[88:91], v[204:219]
ds_read_b64_tr_b16 v[44:45], v11 offset:192
ds_read_b64_tr_b16 v[46:47], v11 offset:1088
s_waitcnt vmcnt(3) lgkmcnt(12)
v_mfma_f32_32x32x16_bf16 v[108:123], v[20:23], v[92:95], v[108:123]
ds_read_b64_tr_b16 v[48:49], v11 offset:3584
ds_read_b64_tr_b16 v[50:51], v11 offset:4480
s_waitcnt lgkmcnt(12)
v_mfma_f32_32x32x16_bf16 v[124:139], v[24:27], v[92:95], v[124:139]
ds_read_b64_tr_b16 v[52:53], v11 offset:3616
ds_read_b64_tr_b16 v[54:55], v11 offset:4512
s_waitcnt lgkmcnt(12)
v_mfma_f32_32x32x16_bf16 v[140:155], v[28:31], v[92:95], v[140:155]
ds_read_b64_tr_b16 v[56:57], v11 offset:3648
ds_read_b64_tr_b16 v[58:59], v11 offset:4544
s_waitcnt lgkmcnt(12)
v_mfma_f32_32x32x16_bf16 v[156:171], v[32:35], v[92:95], v[156:171]
ds_read_b64_tr_b16 v[60:61], v11 offset:3680
ds_read_b64_tr_b16 v[62:63], v11 offset:4576
s_waitcnt lgkmcnt(12)
v_mfma_f32_32x32x16_bf16 v[172:187], v[36:39], v[92:95], v[172:187]
ds_read_b64_tr_b16 v[64:65], v11 offset:3712
ds_read_b64_tr_b16 v[66:67], v11 offset:4608
s_waitcnt lgkmcnt(12)
v_mfma_f32_32x32x16_bf16 v[188:203], v[40:43], v[92:95], v[188:203]
ds_read_b64_tr_b16 v[68:69], v11 offset:3744
ds_read_b64_tr_b16 v[70:71], v11 offset:4640
s_waitcnt lgkmcnt(12)
v_mfma_f32_32x32x16_bf16 v[204:219], v[44:47], v[92:95], v[204:219]
ds_read_b64_tr_b16 v[72:73], v11 offset:3776
ds_read_b64_tr_b16 v[74:75], v11 offset:4672
s_waitcnt vmcnt(2) lgkmcnt(12)
v_mfma_f32_32x32x16_bf16 v[108:123], v[48:51], v[96:99], v[108:123]
ds_read_b64_tr_b16 v[20:21], v11 offset:7168
ds_read_b64_tr_b16 v[22:23], v11 offset:8064
s_waitcnt lgkmcnt(12)
v_mfma_f32_32x32x16_bf16 v[124:139], v[52:55], v[96:99], v[124:139]
ds_read_b64_tr_b16 v[24:25], v11 offset:7200
ds_read_b64_tr_b16 v[26:27], v11 offset:8096
s_waitcnt lgkmcnt(12)
v_mfma_f32_32x32x16_bf16 v[140:155], v[56:59], v[96:99], v[140:155]
ds_read_b64_tr_b16 v[28:29], v11 offset:7232
ds_read_b64_tr_b16 v[30:31], v11 offset:8128
s_waitcnt lgkmcnt(12)
v_mfma_f32_32x32x16_bf16 v[156:171], v[60:63], v[96:99], v[156:171]
ds_read_b64_tr_b16 v[32:33], v11 offset:7264
ds_read_b64_tr_b16 v[34:35], v11 offset:8160
s_waitcnt lgkmcnt(12)
v_mfma_f32_32x32x16_bf16 v[172:187], v[64:67], v[96:99], v[172:187]
ds_read_b64_tr_b16 v[36:37], v11 offset:7296
ds_read_b64_tr_b16 v[38:39], v11 offset:8192
s_waitcnt lgkmcnt(12)
v_mfma_f32_32x32x16_bf16 v[188:203], v[68:71], v[96:99], v[188:203]
ds_read_b64_tr_b16 v[40:41], v11 offset:7328
ds_read_b64_tr_b16 v[42:43], v11 offset:8224
s_waitcnt lgkmcnt(12)
v_mfma_f32_32x32x16_bf16 v[204:219], v[72:75], v[96:99], v[204:219]
ds_read_b64_tr_b16 v[44:45], v11 offset:7360
ds_read_b64_tr_b16 v[46:47], v11 offset:8256
s_waitcnt vmcnt(1) lgkmcnt(12)
v_mfma_f32_32x32x16_bf16 v[108:123], v[20:23], v[100:103], v[108:123]
ds_read_b64_tr_b16 v[48:49], v11 offset:10752
ds_read_b64_tr_b16 v[50:51], v11 offset:11648
s_waitcnt lgkmcnt(12)
v_mfma_f32_32x32x16_bf16 v[124:139], v[24:27], v[100:103], v[124:139]
ds_read_b64_tr_b16 v[52:53], v11 offset:10784
ds_read_b64_tr_b16 v[54:55], v11 offset:11680
s_waitcnt lgkmcnt(12)
v_mfma_f32_32x32x16_bf16 v[140:155], v[28:31], v[100:103], v[140:155]
ds_read_b64_tr_b16 v[56:57], v11 offset:10816
ds_read_b64_tr_b16 v[58:59], v11 offset:11712
s_waitcnt lgkmcnt(12)
v_mfma_f32_32x32x16_bf16 v[156:171], v[32:35], v[100:103], v[156:171]
ds_read_b64_tr_b16 v[60:61], v11 offset:10848
ds_read_b64_tr_b16 v[62:63], v11 offset:11744
s_waitcnt lgkmcnt(12)
v_mfma_f32_32x32x16_bf16 v[172:187], v[36:39], v[100:103], v[172:187]
ds_read_b64_tr_b16 v[64:65], v11 offset:10880
ds_read_b64_tr_b16 v[66:67], v11 offset:11776
s_waitcnt lgkmcnt(12)
v_mfma_f32_32x32x16_bf16 v[188:203], v[40:43], v[100:103], v[188:203]
ds_read_b64_tr_b16 v[68:69], v11 offset:10912
ds_read_b64_tr_b16 v[70:71], v11 offset:11808
s_waitcnt lgkmcnt(12)
v_mfma_f32_32x32x16_bf16 v[204:219], v[44:47], v[100:103], v[204:219]
ds_read_b64_tr_b16 v[72:73], v11 offset:10944
ds_read_b64_tr_b16 v[74:75], v11 offset:11840
s_waitcnt vmcnt(0) lgkmcnt(12)
v_mfma_f32_32x32x16_bf16 v[108:123], v[48:51], v[104:107], v[108:123]
s_waitcnt lgkmcnt(10)
v_mfma_f32_32x32x16_bf16 v[124:139], v[52:55], v[104:107], v[124:139]
s_waitcnt lgkmcnt(8)
v_mfma_f32_32x32x16_bf16 v[140:155], v[56:59], v[104:107], v[140:155]
s_waitcnt lgkmcnt(6)
v_mfma_f32_32x32x16_bf16 v[156:171], v[60:63], v[104:107], v[156:171]
s_waitcnt lgkmcnt(4)
v_mfma_f32_32x32x16_bf16 v[172:187], v[64:67], v[104:107], v[172:187]
s_waitcnt lgkmcnt(2)
v_mfma_f32_32x32x16_bf16 v[188:203], v[68:71], v[104:107], v[188:203]
s_waitcnt lgkmcnt(0)
v_mfma_f32_32x32x16_bf16 v[204:219], v[72:75], v[104:107], v[204:219]
s_barrier
v_and_b32 v222, 31, v1
v_lshlrev_b32 v222, 3, v222
v_add_u32 v222, 2048, v222
ds_read_b64 v[220:221], v222
v_lshlrev_b32 v225, 4, v5
v_add_u32 v225, 0, v225
ds_read_b128 v[20:23], v225 offset:0
ds_read_b128 v[24:27], v225 offset:32
ds_read_b128 v[28:31], v225 offset:64
ds_read_b128 v[32:35], v225 offset:96
s_waitcnt lgkmcnt(4)
v_mul_f32 v226, v221, v221
s_lshl_b32 s7, s4, 2
s_add_u32 s7, s7, 0
s_mul_i32 s8, s7, 112
s_mul_i32 s9, s5, 7
s_add_u32 s8, s8, s9
s_lshl_b32 s8, s8, 10
s_add_u32 s8, s8, 16777216
ds_read_b128 v[36:39], v225 offset:128
ds_read_b128 v[40:43], v225 offset:160
ds_read_b128 v[44:47], v225 offset:192
ds_read_b128 v[48:51], v225 offset:224
s_waitcnt lgkmcnt(7)
v_pk_fma_f32 v[108:109], v[20:21], v[220:221], v[108:109] op_sel_hi:[1,0,1]
v_pk_fma_f32 v[110:111], v[22:23], v[220:221], v[110:111] op_sel_hi:[1,0,1]
s_waitcnt lgkmcnt(6)
v_pk_fma_f32 v[112:113], v[24:25], v[220:221], v[112:113] op_sel_hi:[1,0,1]
v_pk_fma_f32 v[114:115], v[26:27], v[220:221], v[114:115] op_sel_hi:[1,0,1]
s_waitcnt lgkmcnt(5)
v_pk_fma_f32 v[116:117], v[28:29], v[220:221], v[116:117] op_sel_hi:[1,0,1]
v_pk_fma_f32 v[118:119], v[30:31], v[220:221], v[118:119] op_sel_hi:[1,0,1]
s_waitcnt lgkmcnt(4)
v_pk_fma_f32 v[120:121], v[32:33], v[220:221], v[120:121] op_sel_hi:[1,0,1]
v_pk_fma_f32 v[122:123], v[34:35], v[220:221], v[122:123] op_sel_hi:[1,0,1]
v_max_f32 v108, 0, v108
v_max_f32 v109, 0, v109
v_max_f32 v110, 0, v110
v_max_f32 v111, 0, v111
v_max_f32 v112, 0, v112
v_max_f32 v113, 0, v113
v_max_f32 v114, 0, v114
v_max_f32 v115, 0, v115
v_pk_mul_f32 v[108:109], v[108:109], v[116:117]
v_pk_mul_f32 v[110:111], v[110:111], v[118:119]
v_pk_mul_f32 v[112:113], v[112:113], v[120:121]
v_pk_mul_f32 v[114:115], v[114:115], v[122:123]
v_pk_mul_f32 v[108:109], v[108:109], v[226:227] op_sel_hi:[1,0]
v_pk_mul_f32 v[110:111], v[110:111], v[226:227] op_sel_hi:[1,0]
v_pk_mul_f32 v[112:113], v[112:113], v[226:227] op_sel_hi:[1,0]
v_pk_mul_f32 v[114:115], v[114:115], v[226:227] op_sel_hi:[1,0]
v_cvt_pk_bf16_f32 v52, v108, v109
v_cvt_pk_bf16_f32 v53, v110, v111
v_cvt_pk_bf16_f32 v54, v112, v113
v_cvt_pk_bf16_f32 v55, v114, v115
s_nop 0
v_permlane32_swap_b32 v52, v54
v_permlane32_swap_b32 v53, v55
buffer_store_dwordx4 v[52:55], v3, s[52:55], s8 offen offset:0
ds_read_b128 v[20:23], v225 offset:256
ds_read_b128 v[24:27], v225 offset:288
ds_read_b128 v[28:31], v225 offset:320
ds_read_b128 v[32:35], v225 offset:352
s_waitcnt lgkmcnt(7)
v_pk_fma_f32 v[124:125], v[36:37], v[220:221], v[124:125] op_sel_hi:[1,0,1]
v_pk_fma_f32 v[126:127], v[38:39], v[220:221], v[126:127] op_sel_hi:[1,0,1]
s_waitcnt lgkmcnt(6)
v_pk_fma_f32 v[128:129], v[40:41], v[220:221], v[128:129] op_sel_hi:[1,0,1]
v_pk_fma_f32 v[130:131], v[42:43], v[220:221], v[130:131] op_sel_hi:[1,0,1]
s_waitcnt lgkmcnt(5)
v_pk_fma_f32 v[132:133], v[44:45], v[220:221], v[132:133] op_sel_hi:[1,0,1]
v_pk_fma_f32 v[134:135], v[46:47], v[220:221], v[134:135] op_sel_hi:[1,0,1]
s_waitcnt lgkmcnt(4)
v_pk_fma_f32 v[136:137], v[48:49], v[220:221], v[136:137] op_sel_hi:[1,0,1]
v_pk_fma_f32 v[138:139], v[50:51], v[220:221], v[138:139] op_sel_hi:[1,0,1]
v_max_f32 v124, 0, v124
v_max_f32 v125, 0, v125
v_max_f32 v126, 0, v126
v_max_f32 v127, 0, v127
v_max_f32 v128, 0, v128
v_max_f32 v129, 0, v129
v_max_f32 v130, 0, v130
v_max_f32 v131, 0, v131
v_pk_mul_f32 v[124:125], v[124:125], v[132:133]
v_pk_mul_f32 v[126:127], v[126:127], v[134:135]
v_pk_mul_f32 v[128:129], v[128:129], v[136:137]
v_pk_mul_f32 v[130:131], v[130:131], v[138:139]
v_pk_mul_f32 v[124:125], v[124:125], v[226:227] op_sel_hi:[1,0]
v_pk_mul_f32 v[126:127], v[126:127], v[226:227] op_sel_hi:[1,0]
v_pk_mul_f32 v[128:129], v[128:129], v[226:227] op_sel_hi:[1,0]
v_pk_mul_f32 v[130:131], v[130:131], v[226:227] op_sel_hi:[1,0]
v_cvt_pk_bf16_f32 v56, v124, v125
v_cvt_pk_bf16_f32 v57, v126, v127
v_cvt_pk_bf16_f32 v58, v128, v129
v_cvt_pk_bf16_f32 v59, v130, v131
s_nop 0
v_permlane32_swap_b32 v56, v58
v_permlane32_swap_b32 v57, v59
buffer_store_dwordx4 v[56:59], v3, s[52:55], s8 offen offset:1024
ds_read_b128 v[36:39], v225 offset:384
ds_read_b128 v[40:43], v225 offset:416
ds_read_b128 v[44:47], v225 offset:448
ds_read_b128 v[48:51], v225 offset:480
s_waitcnt lgkmcnt(7)
v_pk_fma_f32 v[140:141], v[20:21], v[220:221], v[140:141] op_sel_hi:[1,0,1]
v_pk_fma_f32 v[142:143], v[22:23], v[220:221], v[142:143] op_sel_hi:[1,0,1]
s_waitcnt lgkmcnt(6)
v_pk_fma_f32 v[144:145], v[24:25], v[220:221], v[144:145] op_sel_hi:[1,0,1]
v_pk_fma_f32 v[146:147], v[26:27], v[220:221], v[146:147] op_sel_hi:[1,0,1]
s_waitcnt lgkmcnt(5)
v_pk_fma_f32 v[148:149], v[28:29], v[220:221], v[148:149] op_sel_hi:[1,0,1]
v_pk_fma_f32 v[150:151], v[30:31], v[220:221], v[150:151] op_sel_hi:[1,0,1]
s_waitcnt lgkmcnt(4)
v_pk_fma_f32 v[152:153], v[32:33], v[220:221], v[152:153] op_sel_hi:[1,0,1]
v_pk_fma_f32 v[154:155], v[34:35], v[220:221], v[154:155] op_sel_hi:[1,0,1]
v_max_f32 v140, 0, v140
v_max_f32 v141, 0, v141
v_max_f32 v142, 0, v142
v_max_f32 v143, 0, v143
v_max_f32 v144, 0, v144
v_max_f32 v145, 0, v145
v_max_f32 v146, 0, v146
v_max_f32 v147, 0, v147
v_pk_mul_f32 v[140:141], v[140:141], v[148:149]
v_pk_mul_f32 v[142:143], v[142:143], v[150:151]
v_pk_mul_f32 v[144:145], v[144:145], v[152:153]
v_pk_mul_f32 v[146:147], v[146:147], v[154:155]
v_pk_mul_f32 v[140:141], v[140:141], v[226:227] op_sel_hi:[1,0]
v_pk_mul_f32 v[142:143], v[142:143], v[226:227] op_sel_hi:[1,0]
v_pk_mul_f32 v[144:145], v[144:145], v[226:227] op_sel_hi:[1,0]
v_pk_mul_f32 v[146:147], v[146:147], v[226:227] op_sel_hi:[1,0]
v_cvt_pk_bf16_f32 v52, v140, v141
v_cvt_pk_bf16_f32 v53, v142, v143
v_cvt_pk_bf16_f32 v54, v144, v145
v_cvt_pk_bf16_f32 v55, v146, v147
s_nop 0
v_permlane32_swap_b32 v52, v54
v_permlane32_swap_b32 v53, v55
buffer_store_dwordx4 v[52:55], v3, s[52:55], s8 offen offset:2048
ds_read_b128 v[20:23], v225 offset:512
ds_read_b128 v[24:27], v225 offset:544
ds_read_b128 v[28:31], v225 offset:576
ds_read_b128 v[32:35], v225 offset:608
s_waitcnt lgkmcnt(7)
v_pk_fma_f32 v[156:157], v[36:37], v[220:221], v[156:157] op_sel_hi:[1,0,1]
v_pk_fma_f32 v[158:159], v[38:39], v[220:221], v[158:159] op_sel_hi:[1,0,1]
s_waitcnt lgkmcnt(6)
v_pk_fma_f32 v[160:161], v[40:41], v[220:221], v[160:161] op_sel_hi:[1,0,1]
v_pk_fma_f32 v[162:163], v[42:43], v[220:221], v[162:163] op_sel_hi:[1,0,1]
s_waitcnt lgkmcnt(5)
v_pk_fma_f32 v[164:165], v[44:45], v[220:221], v[164:165] op_sel_hi:[1,0,1]
v_pk_fma_f32 v[166:167], v[46:47], v[220:221], v[166:167] op_sel_hi:[1,0,1]
s_waitcnt lgkmcnt(4)
v_pk_fma_f32 v[168:169], v[48:49], v[220:221], v[168:169] op_sel_hi:[1,0,1]
v_pk_fma_f32 v[170:171], v[50:51], v[220:221], v[170:171] op_sel_hi:[1,0,1]
v_max_f32 v156, 0, v156
v_max_f32 v157, 0, v157
v_max_f32 v158, 0, v158
v_max_f32 v159, 0, v159
v_max_f32 v160, 0, v160
v_max_f32 v161, 0, v161
v_max_f32 v162, 0, v162
v_max_f32 v163, 0, v163
v_pk_mul_f32 v[156:157], v[156:157], v[164:165]
v_pk_mul_f32 v[158:159], v[158:159], v[166:167]
v_pk_mul_f32 v[160:161], v[160:161], v[168:169]
v_pk_mul_f32 v[162:163], v[162:163], v[170:171]
v_pk_mul_f32 v[156:157], v[156:157], v[226:227] op_sel_hi:[1,0]
v_pk_mul_f32 v[158:159], v[158:159], v[226:227] op_sel_hi:[1,0]
v_pk_mul_f32 v[160:161], v[160:161], v[226:227] op_sel_hi:[1,0]
v_pk_mul_f32 v[162:163], v[162:163], v[226:227] op_sel_hi:[1,0]
v_cvt_pk_bf16_f32 v56, v156, v157
v_cvt_pk_bf16_f32 v57, v158, v159
v_cvt_pk_bf16_f32 v58, v160, v161
v_cvt_pk_bf16_f32 v59, v162, v163
s_nop 0
v_permlane32_swap_b32 v56, v58
v_permlane32_swap_b32 v57, v59
buffer_store_dwordx4 v[56:59], v3, s[52:55], s8 offen offset:3072
ds_read_b128 v[36:39], v225 offset:640
ds_read_b128 v[40:43], v225 offset:672
ds_read_b128 v[44:47], v225 offset:704
ds_read_b128 v[48:51], v225 offset:736
s_waitcnt lgkmcnt(7)
v_pk_fma_f32 v[172:173], v[20:21], v[220:221], v[172:173] op_sel_hi:[1,0,1]
v_pk_fma_f32 v[174:175], v[22:23], v[220:221], v[174:175] op_sel_hi:[1,0,1]
s_waitcnt lgkmcnt(6)
v_pk_fma_f32 v[176:177], v[24:25], v[220:221], v[176:177] op_sel_hi:[1,0,1]
v_pk_fma_f32 v[178:179], v[26:27], v[220:221], v[178:179] op_sel_hi:[1,0,1]
s_waitcnt lgkmcnt(5)
v_pk_fma_f32 v[180:181], v[28:29], v[220:221], v[180:181] op_sel_hi:[1,0,1]
v_pk_fma_f32 v[182:183], v[30:31], v[220:221], v[182:183] op_sel_hi:[1,0,1]
s_waitcnt lgkmcnt(4)
v_pk_fma_f32 v[184:185], v[32:33], v[220:221], v[184:185] op_sel_hi:[1,0,1]
v_pk_fma_f32 v[186:187], v[34:35], v[220:221], v[186:187] op_sel_hi:[1,0,1]
v_max_f32 v172, 0, v172
v_max_f32 v173, 0, v173
v_max_f32 v174, 0, v174
v_max_f32 v175, 0, v175
v_max_f32 v176, 0, v176
v_max_f32 v177, 0, v177
v_max_f32 v178, 0, v178
v_max_f32 v179, 0, v179
v_pk_mul_f32 v[172:173], v[172:173], v[180:181]
v_pk_mul_f32 v[174:175], v[174:175], v[182:183]
v_pk_mul_f32 v[176:177], v[176:177], v[184:185]
v_pk_mul_f32 v[178:179], v[178:179], v[186:187]
v_pk_mul_f32 v[172:173], v[172:173], v[226:227] op_sel_hi:[1,0]
v_pk_mul_f32 v[174:175], v[174:175], v[226:227] op_sel_hi:[1,0]
v_pk_mul_f32 v[176:177], v[176:177], v[226:227] op_sel_hi:[1,0]
v_pk_mul_f32 v[178:179], v[178:179], v[226:227] op_sel_hi:[1,0]
v_cvt_pk_bf16_f32 v52, v172, v173
v_cvt_pk_bf16_f32 v53, v174, v175
v_cvt_pk_bf16_f32 v54, v176, v177
v_cvt_pk_bf16_f32 v55, v178, v179
s_nop 0
v_permlane32_swap_b32 v52, v54
v_permlane32_swap_b32 v53, v55
s_add_u32 s8, s8, 4096
buffer_store_dwordx4 v[52:55], v3, s[52:55], s8 offen offset:0
ds_read_b128 v[20:23], v225 offset:768
ds_read_b128 v[24:27], v225 offset:800
ds_read_b128 v[28:31], v225 offset:832
ds_read_b128 v[32:35], v225 offset:864
s_waitcnt lgkmcnt(7)
v_pk_fma_f32 v[188:189], v[36:37], v[220:221], v[188:189] op_sel_hi:[1,0,1]
v_pk_fma_f32 v[190:191], v[38:39], v[220:221], v[190:191] op_sel_hi:[1,0,1]
s_waitcnt lgkmcnt(6)
v_pk_fma_f32 v[192:193], v[40:41], v[220:221], v[192:193] op_sel_hi:[1,0,1]
v_pk_fma_f32 v[194:195], v[42:43], v[220:221], v[194:195] op_sel_hi:[1,0,1]
s_waitcnt lgkmcnt(5)
v_pk_fma_f32 v[196:197], v[44:45], v[220:221], v[196:197] op_sel_hi:[1,0,1]
v_pk_fma_f32 v[198:199], v[46:47], v[220:221], v[198:199] op_sel_hi:[1,0,1]
s_waitcnt lgkmcnt(4)
v_pk_fma_f32 v[200:201], v[48:49], v[220:221], v[200:201] op_sel_hi:[1,0,1]
v_pk_fma_f32 v[202:203], v[50:51], v[220:221], v[202:203] op_sel_hi:[1,0,1]
v_max_f32 v188, 0, v188
v_max_f32 v189, 0, v189
v_max_f32 v190, 0, v190
v_max_f32 v191, 0, v191
v_max_f32 v192, 0, v192
v_max_f32 v193, 0, v193
v_max_f32 v194, 0, v194
v_max_f32 v195, 0, v195
v_pk_mul_f32 v[188:189], v[188:189], v[196:197]
v_pk_mul_f32 v[190:191], v[190:191], v[198:199]
v_pk_mul_f32 v[192:193], v[192:193], v[200:201]
v_pk_mul_f32 v[194:195], v[194:195], v[202:203]
v_pk_mul_f32 v[188:189], v[188:189], v[226:227] op_sel_hi:[1,0]
v_pk_mul_f32 v[190:191], v[190:191], v[226:227] op_sel_hi:[1,0]
v_pk_mul_f32 v[192:193], v[192:193], v[226:227] op_sel_hi:[1,0]
v_pk_mul_f32 v[194:195], v[194:195], v[226:227] op_sel_hi:[1,0]
v_cvt_pk_bf16_f32 v56, v188, v189
v_cvt_pk_bf16_f32 v57, v190, v191
v_cvt_pk_bf16_f32 v58, v192, v193
v_cvt_pk_bf16_f32 v59, v194, v195
s_nop 0
v_permlane32_swap_b32 v56, v58
v_permlane32_swap_b32 v57, v59
buffer_store_dwordx4 v[56:59], v3, s[52:55], s8 offen offset:1024
s_waitcnt lgkmcnt(3)
v_pk_fma_f32 v[204:205], v[20:21], v[220:221], v[204:205] op_sel_hi:[1,0,1]
v_pk_fma_f32 v[206:207], v[22:23], v[220:221], v[206:207] op_sel_hi:[1,0,1]
s_waitcnt lgkmcnt(2)
v_pk_fma_f32 v[208:209], v[24:25], v[220:221], v[208:209] op_sel_hi:[1,0,1]
v_pk_fma_f32 v[210:211], v[26:27], v[220:221], v[210:211] op_sel_hi:[1,0,1]
s_waitcnt lgkmcnt(1)
v_pk_fma_f32 v[212:213], v[28:29], v[220:221], v[212:213] op_sel_hi:[1,0,1]
v_pk_fma_f32 v[214:215], v[30:31], v[220:221], v[214:215] op_sel_hi:[1,0,1]
s_waitcnt lgkmcnt(0)
v_pk_fma_f32 v[216:217], v[32:33], v[220:221], v[216:217] op_sel_hi:[1,0,1]
v_pk_fma_f32 v[218:219], v[34:35], v[220:221], v[218:219] op_sel_hi:[1,0,1]
v_max_f32 v204, 0, v204
v_max_f32 v205, 0, v205
v_max_f32 v206, 0, v206
v_max_f32 v207, 0, v207
v_max_f32 v208, 0, v208
v_max_f32 v209, 0, v209
v_max_f32 v210, 0, v210
v_max_f32 v211, 0, v211
v_pk_mul_f32 v[204:205], v[204:205], v[212:213]
v_pk_mul_f32 v[206:207], v[206:207], v[214:215]
v_pk_mul_f32 v[208:209], v[208:209], v[216:217]
v_pk_mul_f32 v[210:211], v[210:211], v[218:219]
v_pk_mul_f32 v[204:205], v[204:205], v[226:227] op_sel_hi:[1,0]
v_pk_mul_f32 v[206:207], v[206:207], v[226:227] op_sel_hi:[1,0]
v_pk_mul_f32 v[208:209], v[208:209], v[226:227] op_sel_hi:[1,0]
v_pk_mul_f32 v[210:211], v[210:211], v[226:227] op_sel_hi:[1,0]
v_cvt_pk_bf16_f32 v52, v204, v205
v_cvt_pk_bf16_f32 v53, v206, v207
v_cvt_pk_bf16_f32 v54, v208, v209
v_cvt_pk_bf16_f32 v55, v210, v211
s_nop 0
v_permlane32_swap_b32 v52, v54
v_permlane32_swap_b32 v53, v55
buffer_store_dwordx4 v[52:55], v3, s[52:55], s8 offen offset:2048
s_waitcnt vmcnt(0)
s_branch k4_kernel_end
k4_kernel_w1:
v_mul_u32_u24 v14, 224, v7
v_lshl_add_u32 v14, v8, 3, v14
v_mul_u32_u24 v15, 14464, v6
v_add_u32 v9, v14, v15
s_mov_b32 s60, 32768
buffer_load_dwordx4 v[76:79], v3, s[40:43], s60 offen
s_mov_b32 s60, 33792
buffer_load_dwordx4 v[80:83], v3, s[40:43], s60 offen
s_mov_b32 s60, 34816
buffer_load_dwordx4 v[84:87], v3, s[40:43], s60 offen
s_mov_b32 s60, 35840
buffer_load_dwordx4 v[88:91], v3, s[40:43], s60 offen
s_mov_b32 s60, 36864
buffer_load_dwordx4 v[92:95], v3, s[40:43], s60 offen
s_mov_b32 s60, 37888
buffer_load_dwordx4 v[96:99], v3, s[40:43], s60 offen
s_mov_b32 s60, 38912
buffer_load_dwordx4 v[100:103], v3, s[40:43], s60 offen
s_barrier
v_add_u32 v10, 0, v9
ds_read_b64_tr_b16 v[20:21], v10 offset:0
ds_read_b64_tr_b16 v[22:23], v10 offset:896
ds_read_b64_tr_b16 v[24:25], v10 offset:32
ds_read_b64_tr_b16 v[26:27], v10 offset:928
ds_read_b64_tr_b16 v[28:29], v10 offset:64
ds_read_b64_tr_b16 v[30:31], v10 offset:960
ds_read_b64_tr_b16 v[32:33], v10 offset:96
ds_read_b64_tr_b16 v[34:35], v10 offset:992
ds_read_b64_tr_b16 v[36:37], v10 offset:128
ds_read_b64_tr_b16 v[38:39], v10 offset:1024
ds_read_b64_tr_b16 v[40:41], v10 offset:160
ds_read_b64_tr_b16 v[42:43], v10 offset:1056
ds_read_b64_tr_b16 v[44:45], v10 offset:192
ds_read_b64_tr_b16 v[46:47], v10 offset:1088
s_waitcnt vmcnt(6) lgkmcnt(12)
v_mfma_f32_32x32x16_bf16 v[108:123], v[20:23], v[76:79], 0
ds_read_b64_tr_b16 v[48:49], v10 offset:3584
ds_read_b64_tr_b16 v[50:51], v10 offset:4480
s_waitcnt lgkmcnt(12)
v_mfma_f32_32x32x16_bf16 v[124:139], v[24:27], v[76:79], 0
ds_read_b64_tr_b16 v[52:53], v10 offset:3616
ds_read_b64_tr_b16 v[54:55], v10 offset:4512
s_waitcnt lgkmcnt(12)
v_mfma_f32_32x32x16_bf16 v[140:155], v[28:31], v[76:79], 0
ds_read_b64_tr_b16 v[56:57], v10 offset:3648
ds_read_b64_tr_b16 v[58:59], v10 offset:4544
s_waitcnt lgkmcnt(12)
v_mfma_f32_32x32x16_bf16 v[156:171], v[32:35], v[76:79], 0
ds_read_b64_tr_b16 v[60:61], v10 offset:3680
ds_read_b64_tr_b16 v[62:63], v10 offset:4576
s_waitcnt lgkmcnt(12)
v_mfma_f32_32x32x16_bf16 v[172:187], v[36:39], v[76:79], 0
ds_read_b64_tr_b16 v[64:65], v10 offset:3712
ds_read_b64_tr_b16 v[66:67], v10 offset:4608
s_waitcnt lgkmcnt(12)
v_mfma_f32_32x32x16_bf16 v[188:203], v[40:43], v[76:79], 0
ds_read_b64_tr_b16 v[68:69], v10 offset:3744
ds_read_b64_tr_b16 v[70:71], v10 offset:4640
s_waitcnt lgkmcnt(12)
v_mfma_f32_32x32x16_bf16 v[204:219], v[44:47], v[76:79], 0
s_mov_b32 s60, 39936
buffer_load_dwordx4 v[104:107], v3, s[40:43], s60 offen
ds_read_b64_tr_b16 v[72:73], v10 offset:3776
ds_read_b64_tr_b16 v[74:75], v10 offset:4672
s_waitcnt vmcnt(6) lgkmcnt(12)
v_mfma_f32_32x32x16_bf16 v[108:123], v[48:51], v[80:83], v[108:123]
ds_read_b64_tr_b16 v[20:21], v10 offset:7168
ds_read_b64_tr_b16 v[22:23], v10 offset:8064
s_waitcnt lgkmcnt(12)
v_mfma_f32_32x32x16_bf16 v[124:139], v[52:55], v[80:83], v[124:139]
ds_read_b64_tr_b16 v[24:25], v10 offset:7200
ds_read_b64_tr_b16 v[26:27], v10 offset:8096
s_waitcnt lgkmcnt(12)
v_mfma_f32_32x32x16_bf16 v[140:155], v[56:59], v[80:83], v[140:155]
ds_read_b64_tr_b16 v[28:29], v10 offset:7232
ds_read_b64_tr_b16 v[30:31], v10 offset:8128
s_waitcnt lgkmcnt(12)
v_mfma_f32_32x32x16_bf16 v[156:171], v[60:63], v[80:83], v[156:171]
ds_read_b64_tr_b16 v[32:33], v10 offset:7264
ds_read_b64_tr_b16 v[34:35], v10 offset:8160
s_waitcnt lgkmcnt(12)
v_mfma_f32_32x32x16_bf16 v[172:187], v[64:67], v[80:83], v[172:187]
ds_read_b64_tr_b16 v[36:37], v10 offset:7296
ds_read_b64_tr_b16 v[38:39], v10 offset:8192
s_waitcnt lgkmcnt(12)
v_mfma_f32_32x32x16_bf16 v[188:203], v[68:71], v[80:83], v[188:203]
ds_read_b64_tr_b16 v[40:41], v10 offset:7328
ds_read_b64_tr_b16 v[42:43], v10 offset:8224
s_waitcnt lgkmcnt(12)
v_mfma_f32_32x32x16_bf16 v[204:219], v[72:75], v[80:83], v[204:219]
s_mov_b32 s60, 40960
buffer_load_dwordx4 v[76:79], v3, s[40:43], s60 offen
ds_read_b64_tr_b16 v[44:45], v10 offset:7360
ds_read_b64_tr_b16 v[46:47], v10 offset:8256
s_waitcnt vmcnt(6) lgkmcnt(12)
v_mfma_f32_32x32x16_bf16 v[108:123], v[20:23], v[84:87], v[108:123]
ds_read_b64_tr_b16 v[48:49], v10 offset:10752
ds_read_b64_tr_b16 v[50:51], v10 offset:11648
s_waitcnt lgkmcnt(12)
v_mfma_f32_32x32x16_bf16 v[124:139], v[24:27], v[84:87], v[124:139]
ds_read_b64_tr_b16 v[52:53], v10 offset:10784
ds_read_b64_tr_b16 v[54:55], v10 offset:11680
s_waitcnt lgkmcnt(12)
v_mfma_f32_32x32x16_bf16 v[140:155], v[28:31], v[84:87], v[140:155]
ds_read_b64_tr_b16 v[56:57], v10 offset:10816
ds_read_b64_tr_b16 v[58:59], v10 offset:11712
s_waitcnt lgkmcnt(12)
v_mfma_f32_32x32x16_bf16 v[156:171], v[32:35], v[84:87], v[156:171]
ds_read_b64_tr_b16 v[60:61], v10 offset:10848
ds_read_b64_tr_b16 v[62:63], v10 offset:11744
s_waitcnt lgkmcnt(12)
v_mfma_f32_32x32x16_bf16 v[172:187], v[36:39], v[84:87], v[172:187]
ds_read_b64_tr_b16 v[64:65], v10 offset:10880
ds_read_b64_tr_b16 v[66:67], v10 offset:11776
s_waitcnt lgkmcnt(12)
v_mfma_f32_32x32x16_bf16 v[188:203], v[40:43], v[84:87], v[188:203]
ds_read_b64_tr_b16 v[68:69], v10 offset:10912
ds_read_b64_tr_b16 v[70:71], v10 offset:11808
s_waitcnt lgkmcnt(12)
v_mfma_f32_32x32x16_bf16 v[204:219], v[44:47], v[84:87], v[204:219]
s_mov_b32 s60, 41984
buffer_load_dwordx4 v[80:83], v3, s[40:43], s60 offen
ds_read_b64_tr_b16 v[72:73], v10 offset:10944
ds_read_b64_tr_b16 v[74:75], v10 offset:11840
s_barrier
v_add_u32 v11, 28928, v9
s_waitcnt vmcnt(6) lgkmcnt(12)
v_mfma_f32_32x32x16_bf16 v[108:123], v[48:51], v[88:91], v[108:123]
ds_read_b64_tr_b16 v[20:21], v11 offset:0
ds_read_b64_tr_b16 v[22:23], v11 offset:896
s_waitcnt lgkmcnt(12)
v_mfma_f32_32x32x16_bf16 v[124:139], v[52:55], v[88:91], v[124:139]
ds_read_b64_tr_b16 v[24:25], v11 offset:32
ds_read_b64_tr_b16 v[26:27], v11 offset:928
s_waitcnt lgkmcnt(12)
v_mfma_f32_32x32x16_bf16 v[140:155], v[56:59], v[88:91], v[140:155]
ds_read_b64_tr_b16 v[28:29], v11 offset:64
ds_read_b64_tr_b16 v[30:31], v11 offset:960
s_waitcnt lgkmcnt(12)
v_mfma_f32_32x32x16_bf16 v[156:171], v[60:63], v[88:91], v[156:171]
ds_read_b64_tr_b16 v[32:33], v11 offset:96
ds_read_b64_tr_b16 v[34:35], v11 offset:992
s_waitcnt lgkmcnt(12)
v_mfma_f32_32x32x16_bf16 v[172:187], v[64:67], v[88:91], v[172:187]
ds_read_b64_tr_b16 v[36:37], v11 offset:128
ds_read_b64_tr_b16 v[38:39], v11 offset:1024
s_waitcnt lgkmcnt(12)
v_mfma_f32_32x32x16_bf16 v[188:203], v[68:71], v[88:91], v[188:203]
ds_read_b64_tr_b16 v[40:41], v11 offset:160
ds_read_b64_tr_b16 v[42:43], v11 offset:1056
s_waitcnt lgkmcnt(12)
v_mfma_f32_32x32x16_bf16 v[204:219], v[72:75], v[88:91], v[204:219]
s_mov_b32 s60, 43008
buffer_load_dwordx4 v[84:87], v3, s[40:43], s60 offen
ds_read_b64_tr_b16 v[44:45], v11 offset:192
ds_read_b64_tr_b16 v[46:47], v11 offset:1088
s_waitcnt vmcnt(6) lgkmcnt(12)
v_mfma_f32_32x32x16_bf16 v[108:123], v[20:23], v[92:95], v[108:123]
ds_read_b64_tr_b16 v[48:49], v11 offset:3584
ds_read_b64_tr_b16 v[50:51], v11 offset:4480
s_waitcnt lgkmcnt(12)
v_mfma_f32_32x32x16_bf16 v[124:139], v[24:27], v[92:95], v[124:139]
ds_read_b64_tr_b16 v[52:53], v11 offset:3616
ds_read_b64_tr_b16 v[54:55], v11 offset:4512
s_waitcnt lgkmcnt(12)
v_mfma_f32_32x32x16_bf16 v[140:155], v[28:31], v[92:95], v[140:155]
ds_read_b64_tr_b16 v[56:57], v11 offset:3648
ds_read_b64_tr_b16 v[58:59], v11 offset:4544
s_waitcnt lgkmcnt(12)
v_mfma_f32_32x32x16_bf16 v[156:171], v[32:35], v[92:95], v[156:171]
ds_read_b64_tr_b16 v[60:61], v11 offset:3680
ds_read_b64_tr_b16 v[62:63], v11 offset:4576
s_waitcnt lgkmcnt(12)
v_mfma_f32_32x32x16_bf16 v[172:187], v[36:39], v[92:95], v[172:187]
ds_read_b64_tr_b16 v[64:65], v11 offset:3712
ds_read_b64_tr_b16 v[66:67], v11 offset:4608
s_waitcnt lgkmcnt(12)
v_mfma_f32_32x32x16_bf16 v[188:203], v[40:43], v[92:95], v[188:203]
ds_read_b64_tr_b16 v[68:69], v11 offset:3744
ds_read_b64_tr_b16 v[70:71], v11 offset:4640
s_waitcnt lgkmcnt(12)
v_mfma_f32_32x32x16_bf16 v[204:219], v[44:47], v[92:95], v[204:219]
s_mov_b32 s60, 44032
buffer_load_dwordx4 v[88:91], v3, s[40:43], s60 offen
ds_read_b64_tr_b16 v[72:73], v11 offset:3776
ds_read_b64_tr_b16 v[74:75], v11 offset:4672
s_waitcnt vmcnt(6) lgkmcnt(12)
v_mfma_f32_32x32x16_bf16 v[108:123], v[48:51], v[96:99], v[108:123]
ds_read_b64_tr_b16 v[20:21], v11 offset:7168
ds_read_b64_tr_b16 v[22:23], v11 offset:8064
s_waitcnt lgkmcnt(12)
v_mfma_f32_32x32x16_bf16 v[124:139], v[52:55], v[96:99], v[124:139]
ds_read_b64_tr_b16 v[24:25], v11 offset:7200
ds_read_b64_tr_b16 v[26:27], v11 offset:8096
s_waitcnt lgkmcnt(12)
v_mfma_f32_32x32x16_bf16 v[140:155], v[56:59], v[96:99], v[140:155]
ds_read_b64_tr_b16 v[28:29], v11 offset:7232
ds_read_b64_tr_b16 v[30:31], v11 offset:8128
s_waitcnt lgkmcnt(12)
v_mfma_f32_32x32x16_bf16 v[156:171], v[60:63], v[96:99], v[156:171]
ds_read_b64_tr_b16 v[32:33], v11 offset:7264
ds_read_b64_tr_b16 v[34:35], v11 offset:8160
s_waitcnt lgkmcnt(12)
v_mfma_f32_32x32x16_bf16 v[172:187], v[64:67], v[96:99], v[172:187]
ds_read_b64_tr_b16 v[36:37], v11 offset:7296
ds_read_b64_tr_b16 v[38:39], v11 offset:8192
s_waitcnt lgkmcnt(12)
v_mfma_f32_32x32x16_bf16 v[188:203], v[68:71], v[96:99], v[188:203]
ds_read_b64_tr_b16 v[40:41], v11 offset:7328
ds_read_b64_tr_b16 v[42:43], v11 offset:8224
s_waitcnt lgkmcnt(12)
v_mfma_f32_32x32x16_bf16 v[204:219], v[72:75], v[96:99], v[204:219]
s_mov_b32 s60, 45056
buffer_load_dwordx4 v[92:95], v3, s[40:43], s60 offen
ds_read_b64_tr_b16 v[44:45], v11 offset:7360
ds_read_b64_tr_b16 v[46:47], v11 offset:8256
s_waitcnt vmcnt(6) lgkmcnt(12)
v_mfma_f32_32x32x16_bf16 v[108:123], v[20:23], v[100:103], v[108:123]
ds_read_b64_tr_b16 v[48:49], v11 offset:10752
ds_read_b64_tr_b16 v[50:51], v11 offset:11648
s_waitcnt lgkmcnt(12)
v_mfma_f32_32x32x16_bf16 v[124:139], v[24:27], v[100:103], v[124:139]
ds_read_b64_tr_b16 v[52:53], v11 offset:10784
ds_read_b64_tr_b16 v[54:55], v11 offset:11680
s_waitcnt lgkmcnt(12)
v_mfma_f32_32x32x16_bf16 v[140:155], v[28:31], v[100:103], v[140:155]
ds_read_b64_tr_b16 v[56:57], v11 offset:10816
ds_read_b64_tr_b16 v[58:59], v11 offset:11712
s_waitcnt lgkmcnt(12)
v_mfma_f32_32x32x16_bf16 v[156:171], v[32:35], v[100:103], v[156:171]
ds_read_b64_tr_b16 v[60:61], v11 offset:10848
ds_read_b64_tr_b16 v[62:63], v11 offset:11744
s_waitcnt lgkmcnt(12)
v_mfma_f32_32x32x16_bf16 v[172:187], v[36:39], v[100:103], v[172:187]
ds_read_b64_tr_b16 v[64:65], v11 offset:10880
ds_read_b64_tr_b16 v[66:67], v11 offset:11776
s_waitcnt lgkmcnt(12)
v_mfma_f32_32x32x16_bf16 v[188:203], v[40:43], v[100:103], v[188:203]
ds_read_b64_tr_b16 v[68:69], v11 offset:10912
ds_read_b64_tr_b16 v[70:71], v11 offset:11808
s_waitcnt lgkmcnt(12)
v_mfma_f32_32x32x16_bf16 v[204:219], v[44:47], v[100:103], v[204:219]
s_mov_b32 s60, 46080
buffer_load_dwordx4 v[96:99], v3, s[40:43], s60 offen
ds_read_b64_tr_b16 v[72:73], v11 offset:10944
ds_read_b64_tr_b16 v[74:75], v11 offset:11840
s_barrier
v_add_u32 v10, 57856, v9
s_waitcnt vmcnt(6) lgkmcnt(12)
v_mfma_f32_32x32x16_bf16 v[108:123], v[48:51], v[104:107], v[108:123]
ds_read_b64_tr_b16 v[20:21], v10 offset:0
ds_read_b64_tr_b16 v[22:23], v10 offset:896
s_waitcnt lgkmcnt(12)
v_mfma_f32_32x32x16_bf16 v[124:139], v[52:55], v[104:107], v[124:139]
ds_read_b64_tr_b16 v[24:25], v10 offset:32
ds_read_b64_tr_b16 v[26:27], v10 offset:928
s_waitcnt lgkmcnt(12)
v_mfma_f32_32x32x16_bf16 v[140:155], v[56:59], v[104:107], v[140:155]
ds_read_b64_tr_b16 v[28:29], v10 offset:64
ds_read_b64_tr_b16 v[30:31], v10 offset:960
s_waitcnt lgkmcnt(12)
v_mfma_f32_32x32x16_bf16 v[156:171], v[60:63], v[104:107], v[156:171]
ds_read_b64_tr_b16 v[32:33], v10 offset:96
ds_read_b64_tr_b16 v[34:35], v10 offset:992
s_waitcnt lgkmcnt(12)
v_mfma_f32_32x32x16_bf16 v[172:187], v[64:67], v[104:107], v[172:187]
ds_read_b64_tr_b16 v[36:37], v10 offset:128
ds_read_b64_tr_b16 v[38:39], v10 offset:1024
s_waitcnt lgkmcnt(12)
v_mfma_f32_32x32x16_bf16 v[188:203], v[68:71], v[104:107], v[188:203]
ds_read_b64_tr_b16 v[40:41], v10 offset:160
ds_read_b64_tr_b16 v[42:43], v10 offset:1056
s_waitcnt lgkmcnt(12)
v_mfma_f32_32x32x16_bf16 v[204:219], v[72:75], v[104:107], v[204:219]
s_mov_b32 s60, 47104
buffer_load_dwordx4 v[100:103], v3, s[40:43], s60 offen
ds_read_b64_tr_b16 v[44:45], v10 offset:192
ds_read_b64_tr_b16 v[46:47], v10 offset:1088
s_waitcnt vmcnt(6) lgkmcnt(12)
v_mfma_f32_32x32x16_bf16 v[108:123], v[20:23], v[76:79], v[108:123]
ds_read_b64_tr_b16 v[48:49], v10 offset:3584
ds_read_b64_tr_b16 v[50:51], v10 offset:4480
s_waitcnt lgkmcnt(12)
v_mfma_f32_32x32x16_bf16 v[124:139], v[24:27], v[76:79], v[124:139]
ds_read_b64_tr_b16 v[52:53], v10 offset:3616
ds_read_b64_tr_b16 v[54:55], v10 offset:4512
s_waitcnt lgkmcnt(12)
v_mfma_f32_32x32x16_bf16 v[140:155], v[28:31], v[76:79], v[140:155]
ds_read_b64_tr_b16 v[56:57], v10 offset:3648
ds_read_b64_tr_b16 v[58:59], v10 offset:4544
s_waitcnt lgkmcnt(12)
v_mfma_f32_32x32x16_bf16 v[156:171], v[32:35], v[76:79], v[156:171]
ds_read_b64_tr_b16 v[60:61], v10 offset:3680
ds_read_b64_tr_b16 v[62:63], v10 offset:4576
s_waitcnt lgkmcnt(12)
v_mfma_f32_32x32x16_bf16 v[172:187], v[36:39], v[76:79], v[172:187]
ds_read_b64_tr_b16 v[64:65], v10 offset:3712
ds_read_b64_tr_b16 v[66:67], v10 offset:4608
s_waitcnt lgkmcnt(12)
v_mfma_f32_32x32x16_bf16 v[188:203], v[40:43], v[76:79], v[188:203]
ds_read_b64_tr_b16 v[68:69], v10 offset:3744
ds_read_b64_tr_b16 v[70:71], v10 offset:4640
s_waitcnt lgkmcnt(12)
v_mfma_f32_32x32x16_bf16 v[204:219], v[44:47], v[76:79], v[204:219]
s_mov_b32 s60, 48128
buffer_load_dwordx4 v[104:107], v3, s[40:43], s60 offen
ds_read_b64_tr_b16 v[72:73], v10 offset:3776
ds_read_b64_tr_b16 v[74:75], v10 offset:4672
s_waitcnt vmcnt(6) lgkmcnt(12)
v_mfma_f32_32x32x16_bf16 v[108:123], v[48:51], v[80:83], v[108:123]
ds_read_b64_tr_b16 v[20:21], v10 offset:7168
ds_read_b64_tr_b16 v[22:23], v10 offset:8064
s_waitcnt lgkmcnt(12)
v_mfma_f32_32x32x16_bf16 v[124:139], v[52:55], v[80:83], v[124:139]
ds_read_b64_tr_b16 v[24:25], v10 offset:7200
ds_read_b64_tr_b16 v[26:27], v10 offset:8096
s_waitcnt lgkmcnt(12)
v_mfma_f32_32x32x16_bf16 v[140:155], v[56:59], v[80:83], v[140:155]
ds_read_b64_tr_b16 v[28:29], v10 offset:7232
ds_read_b64_tr_b16 v[30:31], v10 offset:8128
s_waitcnt lgkmcnt(12)
v_mfma_f32_32x32x16_bf16 v[156:171], v[60:63], v[80:83], v[156:171]
ds_read_b64_tr_b16 v[32:33], v10 offset:7264
ds_read_b64_tr_b16 v[34:35], v10 offset:8160
s_waitcnt lgkmcnt(12)
v_mfma_f32_32x32x16_bf16 v[172:187], v[64:67], v[80:83], v[172:187]
ds_read_b64_tr_b16 v[36:37], v10 offset:7296
ds_read_b64_tr_b16 v[38:39], v10 offset:8192
s_waitcnt lgkmcnt(12)
v_mfma_f32_32x32x16_bf16 v[188:203], v[68:71], v[80:83], v[188:203]
ds_read_b64_tr_b16 v[40:41], v10 offset:7328
ds_read_b64_tr_b16 v[42:43], v10 offset:8224
s_waitcnt lgkmcnt(12)
v_mfma_f32_32x32x16_bf16 v[204:219], v[72:75], v[80:83], v[204:219]
s_mov_b32 s60, 49152
buffer_load_dwordx4 v[76:79], v3, s[40:43], s60 offen
ds_read_b64_tr_b16 v[44:45], v10 offset:7360
ds_read_b64_tr_b16 v[46:47], v10 offset:8256
s_waitcnt vmcnt(6) lgkmcnt(12)
v_mfma_f32_32x32x16_bf16 v[108:123], v[20:23], v[84:87], v[108:123]
ds_read_b64_tr_b16 v[48:49], v10 offset:10752
ds_read_b64_tr_b16 v[50:51], v10 offset:11648
s_waitcnt lgkmcnt(12)
v_mfma_f32_32x32x16_bf16 v[124:139], v[24:27], v[84:87], v[124:139]
ds_read_b64_tr_b16 v[52:53], v10 offset:10784
ds_read_b64_tr_b16 v[54:55], v10 offset:11680
s_waitcnt lgkmcnt(12)
v_mfma_f32_32x32x16_bf16 v[140:155], v[28:31], v[84:87], v[140:155]
ds_read_b64_tr_b16 v[56:57], v10 offset:10816
ds_read_b64_tr_b16 v[58:59], v10 offset:11712
s_waitcnt lgkmcnt(12)
v_mfma_f32_32x32x16_bf16 v[156:171], v[32:35], v[84:87], v[156:171]
ds_read_b64_tr_b16 v[60:61], v10 offset:10848
ds_read_b64_tr_b16 v[62:63], v10 offset:11744
s_waitcnt lgkmcnt(12)
v_mfma_f32_32x32x16_bf16 v[172:187], v[36:39], v[84:87], v[172:187]
ds_read_b64_tr_b16 v[64:65], v10 offset:10880
ds_read_b64_tr_b16 v[66:67], v10 offset:11776
s_waitcnt lgkmcnt(12)
v_mfma_f32_32x32x16_bf16 v[188:203], v[40:43], v[84:87], v[188:203]
ds_read_b64_tr_b16 v[68:69], v10 offset:10912
ds_read_b64_tr_b16 v[70:71], v10 offset:11808
s_waitcnt lgkmcnt(12)
v_mfma_f32_32x32x16_bf16 v[204:219], v[44:47], v[84:87], v[204:219]
s_mov_b32 s60, 50176
buffer_load_dwordx4 v[80:83], v3, s[40:43], s60 offen
ds_read_b64_tr_b16 v[72:73], v10 offset:10944
ds_read_b64_tr_b16 v[74:75], v10 offset:11840
s_barrier
v_add_u32 v11, 86784, v9
s_waitcnt vmcnt(6) lgkmcnt(12)
v_mfma_f32_32x32x16_bf16 v[108:123], v[48:51], v[88:91], v[108:123]
ds_read_b64_tr_b16 v[20:21], v11 offset:0
ds_read_b64_tr_b16 v[22:23], v11 offset:896
s_waitcnt lgkmcnt(12)
v_mfma_f32_32x32x16_bf16 v[124:139], v[52:55], v[88:91], v[124:139]
ds_read_b64_tr_b16 v[24:25], v11 offset:32
ds_read_b64_tr_b16 v[26:27], v11 offset:928
s_waitcnt lgkmcnt(12)
v_mfma_f32_32x32x16_bf16 v[140:155], v[56:59], v[88:91], v[140:155]
ds_read_b64_tr_b16 v[28:29], v11 offset:64
ds_read_b64_tr_b16 v[30:31], v11 offset:960
s_waitcnt lgkmcnt(12)
v_mfma_f32_32x32x16_bf16 v[156:171], v[60:63], v[88:91], v[156:171]
ds_read_b64_tr_b16 v[32:33], v11 offset:96
ds_read_b64_tr_b16 v[34:35], v11 offset:992
s_waitcnt lgkmcnt(12)
v_mfma_f32_32x32x16_bf16 v[172:187], v[64:67], v[88:91], v[172:187]
ds_read_b64_tr_b16 v[36:37], v11 offset:128
ds_read_b64_tr_b16 v[38:39], v11 offset:1024
s_waitcnt lgkmcnt(12)
v_mfma_f32_32x32x16_bf16 v[188:203], v[68:71], v[88:91], v[188:203]
ds_read_b64_tr_b16 v[40:41], v11 offset:160
ds_read_b64_tr_b16 v[42:43], v11 offset:1056
s_waitcnt lgkmcnt(12)
v_mfma_f32_32x32x16_bf16 v[204:219], v[72:75], v[88:91], v[204:219]
s_mov_b32 s60, 51200
buffer_load_dwordx4 v[84:87], v3, s[40:43], s60 offen
ds_read_b64_tr_b16 v[44:45], v11 offset:192
ds_read_b64_tr_b16 v[46:47], v11 offset:1088
s_waitcnt vmcnt(6) lgkmcnt(12)
v_mfma_f32_32x32x16_bf16 v[108:123], v[20:23], v[92:95], v[108:123]
ds_read_b64_tr_b16 v[48:49], v11 offset:3584
ds_read_b64_tr_b16 v[50:51], v11 offset:4480
s_waitcnt lgkmcnt(12)
v_mfma_f32_32x32x16_bf16 v[124:139], v[24:27], v[92:95], v[124:139]
ds_read_b64_tr_b16 v[52:53], v11 offset:3616
ds_read_b64_tr_b16 v[54:55], v11 offset:4512
s_waitcnt lgkmcnt(12)
v_mfma_f32_32x32x16_bf16 v[140:155], v[28:31], v[92:95], v[140:155]
ds_read_b64_tr_b16 v[56:57], v11 offset:3648
ds_read_b64_tr_b16 v[58:59], v11 offset:4544
s_waitcnt lgkmcnt(12)
v_mfma_f32_32x32x16_bf16 v[156:171], v[32:35], v[92:95], v[156:171]
ds_read_b64_tr_b16 v[60:61], v11 offset:3680
ds_read_b64_tr_b16 v[62:63], v11 offset:4576
s_waitcnt lgkmcnt(12)
v_mfma_f32_32x32x16_bf16 v[172:187], v[36:39], v[92:95], v[172:187]
ds_read_b64_tr_b16 v[64:65], v11 offset:3712
ds_read_b64_tr_b16 v[66:67], v11 offset:4608
s_waitcnt lgkmcnt(12)
v_mfma_f32_32x32x16_bf16 v[188:203], v[40:43], v[92:95], v[188:203]
ds_read_b64_tr_b16 v[68:69], v11 offset:3744
ds_read_b64_tr_b16 v[70:71], v11 offset:4640
s_waitcnt lgkmcnt(12)
v_mfma_f32_32x32x16_bf16 v[204:219], v[44:47], v[92:95], v[204:219]
s_mov_b32 s60, 52224
buffer_load_dwordx4 v[88:91], v3, s[40:43], s60 offen
ds_read_b64_tr_b16 v[72:73], v11 offset:3776
ds_read_b64_tr_b16 v[74:75], v11 offset:4672
s_waitcnt vmcnt(6) lgkmcnt(12)
v_mfma_f32_32x32x16_bf16 v[108:123], v[48:51], v[96:99], v[108:123]
ds_read_b64_tr_b16 v[20:21], v11 offset:7168
ds_read_b64_tr_b16 v[22:23], v11 offset:8064
s_waitcnt lgkmcnt(12)
v_mfma_f32_32x32x16_bf16 v[124:139], v[52:55], v[96:99], v[124:139]
ds_read_b64_tr_b16 v[24:25], v11 offset:7200
ds_read_b64_tr_b16 v[26:27], v11 offset:8096
s_waitcnt lgkmcnt(12)
v_mfma_f32_32x32x16_bf16 v[140:155], v[56:59], v[96:99], v[140:155]
ds_read_b64_tr_b16 v[28:29], v11 offset:7232
ds_read_b64_tr_b16 v[30:31], v11 offset:8128
s_waitcnt lgkmcnt(12)
v_mfma_f32_32x32x16_bf16 v[156:171], v[60:63], v[96:99], v[156:171]
ds_read_b64_tr_b16 v[32:33], v11 offset:7264
ds_read_b64_tr_b16 v[34:35], v11 offset:8160
s_waitcnt lgkmcnt(12)
v_mfma_f32_32x32x16_bf16 v[172:187], v[64:67], v[96:99], v[172:187]
ds_read_b64_tr_b16 v[36:37], v11 offset:7296
ds_read_b64_tr_b16 v[38:39], v11 offset:8192
s_waitcnt lgkmcnt(12)
v_mfma_f32_32x32x16_bf16 v[188:203], v[68:71], v[96:99], v[188:203]
ds_read_b64_tr_b16 v[40:41], v11 offset:7328
ds_read_b64_tr_b16 v[42:43], v11 offset:8224
s_waitcnt lgkmcnt(12)
v_mfma_f32_32x32x16_bf16 v[204:219], v[72:75], v[96:99], v[204:219]
s_mov_b32 s60, 53248
buffer_load_dwordx4 v[92:95], v3, s[40:43], s60 offen
ds_read_b64_tr_b16 v[44:45], v11 offset:7360
ds_read_b64_tr_b16 v[46:47], v11 offset:8256
s_waitcnt vmcnt(6) lgkmcnt(12)
v_mfma_f32_32x32x16_bf16 v[108:123], v[20:23], v[100:103], v[108:123]
ds_read_b64_tr_b16 v[48:49], v11 offset:10752
ds_read_b64_tr_b16 v[50:51], v11 offset:11648
s_waitcnt lgkmcnt(12)
v_mfma_f32_32x32x16_bf16 v[124:139], v[24:27], v[100:103], v[124:139]
ds_read_b64_tr_b16 v[52:53], v11 offset:10784
ds_read_b64_tr_b16 v[54:55], v11 offset:11680
s_waitcnt lgkmcnt(12)
v_mfma_f32_32x32x16_bf16 v[140:155], v[28:31], v[100:103], v[140:155]
ds_read_b64_tr_b16 v[56:57], v11 offset:10816
ds_read_b64_tr_b16 v[58:59], v11 offset:11712
s_waitcnt lgkmcnt(12)
v_mfma_f32_32x32x16_bf16 v[156:171], v[32:35], v[100:103], v[156:171]
ds_read_b64_tr_b16 v[60:61], v11 offset:10848
ds_read_b64_tr_b16 v[62:63], v11 offset:11744
s_waitcnt lgkmcnt(12)
v_mfma_f32_32x32x16_bf16 v[172:187], v[36:39], v[100:103], v[172:187]
ds_read_b64_tr_b16 v[64:65], v11 offset:10880
ds_read_b64_tr_b16 v[66:67], v11 offset:11776
s_waitcnt lgkmcnt(12)
v_mfma_f32_32x32x16_bf16 v[188:203], v[40:43], v[100:103], v[188:203]
ds_read_b64_tr_b16 v[68:69], v11 offset:10912
ds_read_b64_tr_b16 v[70:71], v11 offset:11808
s_waitcnt lgkmcnt(12)
v_mfma_f32_32x32x16_bf16 v[204:219], v[44:47], v[100:103], v[204:219]
s_mov_b32 s60, 54272
buffer_load_dwordx4 v[96:99], v3, s[40:43], s60 offen
ds_read_b64_tr_b16 v[72:73], v11 offset:10944
ds_read_b64_tr_b16 v[74:75], v11 offset:11840
s_barrier
v_add_u32 v10, 115712, v9
s_waitcnt vmcnt(6) lgkmcnt(12)
v_mfma_f32_32x32x16_bf16 v[108:123], v[48:51], v[104:107], v[108:123]
ds_read_b64_tr_b16 v[20:21], v10 offset:0
ds_read_b64_tr_b16 v[22:23], v10 offset:896
s_waitcnt lgkmcnt(12)
v_mfma_f32_32x32x16_bf16 v[124:139], v[52:55], v[104:107], v[124:139]
ds_read_b64_tr_b16 v[24:25], v10 offset:32
ds_read_b64_tr_b16 v[26:27], v10 offset:928
s_waitcnt lgkmcnt(12)
v_mfma_f32_32x32x16_bf16 v[140:155], v[56:59], v[104:107], v[140:155]
ds_read_b64_tr_b16 v[28:29], v10 offset:64
ds_read_b64_tr_b16 v[30:31], v10 offset:960
s_waitcnt lgkmcnt(12)
v_mfma_f32_32x32x16_bf16 v[156:171], v[60:63], v[104:107], v[156:171]
ds_read_b64_tr_b16 v[32:33], v10 offset:96
ds_read_b64_tr_b16 v[34:35], v10 offset:992
s_waitcnt lgkmcnt(12)
v_mfma_f32_32x32x16_bf16 v[172:187], v[64:67], v[104:107], v[172:187]
ds_read_b64_tr_b16 v[36:37], v10 offset:128
ds_read_b64_tr_b16 v[38:39], v10 offset:1024
s_waitcnt lgkmcnt(12)
v_mfma_f32_32x32x16_bf16 v[188:203], v[68:71], v[104:107], v[188:203]
ds_read_b64_tr_b16 v[40:41], v10 offset:160
ds_read_b64_tr_b16 v[42:43], v10 offset:1056
s_waitcnt lgkmcnt(12)
v_mfma_f32_32x32x16_bf16 v[204:219], v[72:75], v[104:107], v[204:219]
s_mov_b32 s60, 55296
buffer_load_dwordx4 v[100:103], v3, s[40:43], s60 offen
ds_read_b64_tr_b16 v[44:45], v10 offset:192
ds_read_b64_tr_b16 v[46:47], v10 offset:1088
s_waitcnt vmcnt(6) lgkmcnt(12)
v_mfma_f32_32x32x16_bf16 v[108:123], v[20:23], v[76:79], v[108:123]
ds_read_b64_tr_b16 v[48:49], v10 offset:3584
ds_read_b64_tr_b16 v[50:51], v10 offset:4480
s_waitcnt lgkmcnt(12)
v_mfma_f32_32x32x16_bf16 v[124:139], v[24:27], v[76:79], v[124:139]
ds_read_b64_tr_b16 v[52:53], v10 offset:3616
ds_read_b64_tr_b16 v[54:55], v10 offset:4512
s_waitcnt lgkmcnt(12)
v_mfma_f32_32x32x16_bf16 v[140:155], v[28:31], v[76:79], v[140:155]
ds_read_b64_tr_b16 v[56:57], v10 offset:3648
ds_read_b64_tr_b16 v[58:59], v10 offset:4544
s_waitcnt lgkmcnt(12)
v_mfma_f32_32x32x16_bf16 v[156:171], v[32:35], v[76:79], v[156:171]
ds_read_b64_tr_b16 v[60:61], v10 offset:3680
ds_read_b64_tr_b16 v[62:63], v10 offset:4576
s_waitcnt lgkmcnt(12)
v_mfma_f32_32x32x16_bf16 v[172:187], v[36:39], v[76:79], v[172:187]
ds_read_b64_tr_b16 v[64:65], v10 offset:3712
ds_read_b64_tr_b16 v[66:67], v10 offset:4608
s_waitcnt lgkmcnt(12)
v_mfma_f32_32x32x16_bf16 v[188:203], v[40:43], v[76:79], v[188:203]
ds_read_b64_tr_b16 v[68:69], v10 offset:3744
ds_read_b64_tr_b16 v[70:71], v10 offset:4640
s_waitcnt lgkmcnt(12)
v_mfma_f32_32x32x16_bf16 v[204:219], v[44:47], v[76:79], v[204:219]
s_mov_b32 s60, 56320
buffer_load_dwordx4 v[104:107], v3, s[40:43], s60 offen
ds_read_b64_tr_b16 v[72:73], v10 offset:3776
ds_read_b64_tr_b16 v[74:75], v10 offset:4672
s_waitcnt vmcnt(6) lgkmcnt(12)
v_mfma_f32_32x32x16_bf16 v[108:123], v[48:51], v[80:83], v[108:123]
ds_read_b64_tr_b16 v[20:21], v10 offset:7168
ds_read_b64_tr_b16 v[22:23], v10 offset:8064
s_waitcnt lgkmcnt(12)
v_mfma_f32_32x32x16_bf16 v[124:139], v[52:55], v[80:83], v[124:139]
ds_read_b64_tr_b16 v[24:25], v10 offset:7200
ds_read_b64_tr_b16 v[26:27], v10 offset:8096
s_waitcnt lgkmcnt(12)
v_mfma_f32_32x32x16_bf16 v[140:155], v[56:59], v[80:83], v[140:155]
ds_read_b64_tr_b16 v[28:29], v10 offset:7232
ds_read_b64_tr_b16 v[30:31], v10 offset:8128
s_waitcnt lgkmcnt(12)
v_mfma_f32_32x32x16_bf16 v[156:171], v[60:63], v[80:83], v[156:171]
ds_read_b64_tr_b16 v[32:33], v10 offset:7264
ds_read_b64_tr_b16 v[34:35], v10 offset:8160
s_waitcnt lgkmcnt(12)
v_mfma_f32_32x32x16_bf16 v[172:187], v[64:67], v[80:83], v[172:187]
ds_read_b64_tr_b16 v[36:37], v10 offset:7296
ds_read_b64_tr_b16 v[38:39], v10 offset:8192
s_waitcnt lgkmcnt(12)
v_mfma_f32_32x32x16_bf16 v[188:203], v[68:71], v[80:83], v[188:203]
ds_read_b64_tr_b16 v[40:41], v10 offset:7328
ds_read_b64_tr_b16 v[42:43], v10 offset:8224
s_waitcnt lgkmcnt(12)
v_mfma_f32_32x32x16_bf16 v[204:219], v[72:75], v[80:83], v[204:219]
s_mov_b32 s60, 57344
buffer_load_dwordx4 v[76:79], v3, s[40:43], s60 offen
ds_read_b64_tr_b16 v[44:45], v10 offset:7360
ds_read_b64_tr_b16 v[46:47], v10 offset:8256
s_waitcnt vmcnt(6) lgkmcnt(12)
v_mfma_f32_32x32x16_bf16 v[108:123], v[20:23], v[84:87], v[108:123]
ds_read_b64_tr_b16 v[48:49], v10 offset:10752
ds_read_b64_tr_b16 v[50:51], v10 offset:11648
s_waitcnt lgkmcnt(12)
v_mfma_f32_32x32x16_bf16 v[124:139], v[24:27], v[84:87], v[124:139]
ds_read_b64_tr_b16 v[52:53], v10 offset:10784
ds_read_b64_tr_b16 v[54:55], v10 offset:11680
s_waitcnt lgkmcnt(12)
v_mfma_f32_32x32x16_bf16 v[140:155], v[28:31], v[84:87], v[140:155]
ds_read_b64_tr_b16 v[56:57], v10 offset:10816
ds_read_b64_tr_b16 v[58:59], v10 offset:11712
s_waitcnt lgkmcnt(12)
v_mfma_f32_32x32x16_bf16 v[156:171], v[32:35], v[84:87], v[156:171]
ds_read_b64_tr_b16 v[60:61], v10 offset:10848
ds_read_b64_tr_b16 v[62:63], v10 offset:11744
s_waitcnt lgkmcnt(12)
v_mfma_f32_32x32x16_bf16 v[172:187], v[36:39], v[84:87], v[172:187]
ds_read_b64_tr_b16 v[64:65], v10 offset:10880
ds_read_b64_tr_b16 v[66:67], v10 offset:11776
s_waitcnt lgkmcnt(12)
v_mfma_f32_32x32x16_bf16 v[188:203], v[40:43], v[84:87], v[188:203]
ds_read_b64_tr_b16 v[68:69], v10 offset:10912
ds_read_b64_tr_b16 v[70:71], v10 offset:11808
s_waitcnt lgkmcnt(12)
v_mfma_f32_32x32x16_bf16 v[204:219], v[44:47], v[84:87], v[204:219]
s_mov_b32 s60, 58368
buffer_load_dwordx4 v[80:83], v3, s[40:43], s60 offen
ds_read_b64_tr_b16 v[72:73], v10 offset:10944
ds_read_b64_tr_b16 v[74:75], v10 offset:11840
s_barrier
v_add_u32 v11, 0, v9
s_waitcnt vmcnt(6) lgkmcnt(12)
v_mfma_f32_32x32x16_bf16 v[108:123], v[48:51], v[88:91], v[108:123]
ds_read_b64_tr_b16 v[20:21], v11 offset:0
ds_read_b64_tr_b16 v[22:23], v11 offset:896
s_waitcnt lgkmcnt(12)
v_mfma_f32_32x32x16_bf16 v[124:139], v[52:55], v[88:91], v[124:139]
ds_read_b64_tr_b16 v[24:25], v11 offset:32
ds_read_b64_tr_b16 v[26:27], v11 offset:928
s_waitcnt lgkmcnt(12)
v_mfma_f32_32x32x16_bf16 v[140:155], v[56:59], v[88:91], v[140:155]
ds_read_b64_tr_b16 v[28:29], v11 offset:64
ds_read_b64_tr_b16 v[30:31], v11 offset:960
s_waitcnt lgkmcnt(12)
v_mfma_f32_32x32x16_bf16 v[156:171], v[60:63], v[88:91], v[156:171]
ds_read_b64_tr_b16 v[32:33], v11 offset:96
ds_read_b64_tr_b16 v[34:35], v11 offset:992
s_waitcnt lgkmcnt(12)
v_mfma_f32_32x32x16_bf16 v[172:187], v[64:67], v[88:91], v[172:187]
ds_read_b64_tr_b16 v[36:37], v11 offset:128
ds_read_b64_tr_b16 v[38:39], v11 offset:1024
s_waitcnt lgkmcnt(12)
v_mfma_f32_32x32x16_bf16 v[188:203], v[68:71], v[88:91], v[188:203]
ds_read_b64_tr_b16 v[40:41], v11 offset:160
ds_read_b64_tr_b16 v[42:43], v11 offset:1056
s_waitcnt lgkmcnt(12)
v_mfma_f32_32x32x16_bf16 v[204:219], v[72:75], v[88:91], v[204:219]
s_mov_b32 s60, 59392
buffer_load_dwordx4 v[84:87], v3, s[40:43], s60 offen
ds_read_b64_tr_b16 v[44:45], v11 offset:192
ds_read_b64_tr_b16 v[46:47], v11 offset:1088
s_waitcnt vmcnt(6) lgkmcnt(12)
v_mfma_f32_32x32x16_bf16 v[108:123], v[20:23], v[92:95], v[108:123]
ds_read_b64_tr_b16 v[48:49], v11 offset:3584
ds_read_b64_tr_b16 v[50:51], v11 offset:4480
s_waitcnt lgkmcnt(12)
v_mfma_f32_32x32x16_bf16 v[124:139], v[24:27], v[92:95], v[124:139]
ds_read_b64_tr_b16 v[52:53], v11 offset:3616
ds_read_b64_tr_b16 v[54:55], v11 offset:4512
s_waitcnt lgkmcnt(12)
v_mfma_f32_32x32x16_bf16 v[140:155], v[28:31], v[92:95], v[140:155]
ds_read_b64_tr_b16 v[56:57], v11 offset:3648
ds_read_b64_tr_b16 v[58:59], v11 offset:4544
s_waitcnt lgkmcnt(12)
v_mfma_f32_32x32x16_bf16 v[156:171], v[32:35], v[92:95], v[156:171]
ds_read_b64_tr_b16 v[60:61], v11 offset:3680
ds_read_b64_tr_b16 v[62:63], v11 offset:4576
s_waitcnt lgkmcnt(12)
v_mfma_f32_32x32x16_bf16 v[172:187], v[36:39], v[92:95], v[172:187]
ds_read_b64_tr_b16 v[64:65], v11 offset:3712
ds_read_b64_tr_b16 v[66:67], v11 offset:4608
s_waitcnt lgkmcnt(12)
v_mfma_f32_32x32x16_bf16 v[188:203], v[40:43], v[92:95], v[188:203]
ds_read_b64_tr_b16 v[68:69], v11 offset:3744
ds_read_b64_tr_b16 v[70:71], v11 offset:4640
s_waitcnt lgkmcnt(12)
v_mfma_f32_32x32x16_bf16 v[204:219], v[44:47], v[92:95], v[204:219]
s_mov_b32 s60, 60416
buffer_load_dwordx4 v[88:91], v3, s[40:43], s60 offen
ds_read_b64_tr_b16 v[72:73], v11 offset:3776
ds_read_b64_tr_b16 v[74:75], v11 offset:4672
s_waitcnt vmcnt(6) lgkmcnt(12)
v_mfma_f32_32x32x16_bf16 v[108:123], v[48:51], v[96:99], v[108:123]
ds_read_b64_tr_b16 v[20:21], v11 offset:7168
ds_read_b64_tr_b16 v[22:23], v11 offset:8064
s_waitcnt lgkmcnt(12)
v_mfma_f32_32x32x16_bf16 v[124:139], v[52:55], v[96:99], v[124:139]
ds_read_b64_tr_b16 v[24:25], v11 offset:7200
ds_read_b64_tr_b16 v[26:27], v11 offset:8096
s_waitcnt lgkmcnt(12)
v_mfma_f32_32x32x16_bf16 v[140:155], v[56:59], v[96:99], v[140:155]
ds_read_b64_tr_b16 v[28:29], v11 offset:7232
ds_read_b64_tr_b16 v[30:31], v11 offset:8128
s_waitcnt lgkmcnt(12)
v_mfma_f32_32x32x16_bf16 v[156:171], v[60:63], v[96:99], v[156:171]
ds_read_b64_tr_b16 v[32:33], v11 offset:7264
ds_read_b64_tr_b16 v[34:35], v11 offset:8160
s_waitcnt lgkmcnt(12)
v_mfma_f32_32x32x16_bf16 v[172:187], v[64:67], v[96:99], v[172:187]
ds_read_b64_tr_b16 v[36:37], v11 offset:7296
ds_read_b64_tr_b16 v[38:39], v11 offset:8192
s_waitcnt lgkmcnt(12)
v_mfma_f32_32x32x16_bf16 v[188:203], v[68:71], v[96:99], v[188:203]
ds_read_b64_tr_b16 v[40:41], v11 offset:7328
ds_read_b64_tr_b16 v[42:43], v11 offset:8224
s_waitcnt lgkmcnt(12)
v_mfma_f32_32x32x16_bf16 v[204:219], v[72:75], v[96:99], v[204:219]
s_mov_b32 s60, 61440
buffer_load_dwordx4 v[92:95], v3, s[40:43], s60 offen
ds_read_b64_tr_b16 v[44:45], v11 offset:7360
ds_read_b64_tr_b16 v[46:47], v11 offset:8256
s_waitcnt vmcnt(6) lgkmcnt(12)
v_mfma_f32_32x32x16_bf16 v[108:123], v[20:23], v[100:103], v[108:123]
ds_read_b64_tr_b16 v[48:49], v11 offset:10752
ds_read_b64_tr_b16 v[50:51], v11 offset:11648
s_waitcnt lgkmcnt(12)
v_mfma_f32_32x32x16_bf16 v[124:139], v[24:27], v[100:103], v[124:139]
ds_read_b64_tr_b16 v[52:53], v11 offset:10784
ds_read_b64_tr_b16 v[54:55], v11 offset:11680
s_waitcnt lgkmcnt(12)
v_mfma_f32_32x32x16_bf16 v[140:155], v[28:31], v[100:103], v[140:155]
ds_read_b64_tr_b16 v[56:57], v11 offset:10816
ds_read_b64_tr_b16 v[58:59], v11 offset:11712
s_waitcnt lgkmcnt(12)
v_mfma_f32_32x32x16_bf16 v[156:171], v[32:35], v[100:103], v[156:171]
ds_read_b64_tr_b16 v[60:61], v11 offset:10848
ds_read_b64_tr_b16 v[62:63], v11 offset:11744
s_waitcnt lgkmcnt(12)
v_mfma_f32_32x32x16_bf16 v[172:187], v[36:39], v[100:103], v[172:187]
ds_read_b64_tr_b16 v[64:65], v11 offset:10880
ds_read_b64_tr_b16 v[66:67], v11 offset:11776
s_waitcnt lgkmcnt(12)
v_mfma_f32_32x32x16_bf16 v[188:203], v[40:43], v[100:103], v[188:203]
ds_read_b64_tr_b16 v[68:69], v11 offset:10912
ds_read_b64_tr_b16 v[70:71], v11 offset:11808
s_waitcnt lgkmcnt(12)
v_mfma_f32_32x32x16_bf16 v[204:219], v[44:47], v[100:103], v[204:219]
s_mov_b32 s60, 62464
buffer_load_dwordx4 v[96:99], v3, s[40:43], s60 offen
ds_read_b64_tr_b16 v[72:73], v11 offset:10944
ds_read_b64_tr_b16 v[74:75], v11 offset:11840
s_barrier
v_add_u32 v10, 28928, v9
s_waitcnt vmcnt(6) lgkmcnt(12)
v_mfma_f32_32x32x16_bf16 v[108:123], v[48:51], v[104:107], v[108:123]
ds_read_b64_tr_b16 v[20:21], v10 offset:0
ds_read_b64_tr_b16 v[22:23], v10 offset:896
s_waitcnt lgkmcnt(12)
v_mfma_f32_32x32x16_bf16 v[124:139], v[52:55], v[104:107], v[124:139]
ds_read_b64_tr_b16 v[24:25], v10 offset:32
ds_read_b64_tr_b16 v[26:27], v10 offset:928
s_waitcnt lgkmcnt(12)
v_mfma_f32_32x32x16_bf16 v[140:155], v[56:59], v[104:107], v[140:155]
ds_read_b64_tr_b16 v[28:29], v10 offset:64
ds_read_b64_tr_b16 v[30:31], v10 offset:960
s_waitcnt lgkmcnt(12)
v_mfma_f32_32x32x16_bf16 v[156:171], v[60:63], v[104:107], v[156:171]
ds_read_b64_tr_b16 v[32:33], v10 offset:96
ds_read_b64_tr_b16 v[34:35], v10 offset:992
s_waitcnt lgkmcnt(12)
v_mfma_f32_32x32x16_bf16 v[172:187], v[64:67], v[104:107], v[172:187]
ds_read_b64_tr_b16 v[36:37], v10 offset:128
ds_read_b64_tr_b16 v[38:39], v10 offset:1024
s_waitcnt lgkmcnt(12)
v_mfma_f32_32x32x16_bf16 v[188:203], v[68:71], v[104:107], v[188:203]
ds_read_b64_tr_b16 v[40:41], v10 offset:160
ds_read_b64_tr_b16 v[42:43], v10 offset:1056
s_waitcnt lgkmcnt(12)
v_mfma_f32_32x32x16_bf16 v[204:219], v[72:75], v[104:107], v[204:219]
s_mov_b32 s60, 63488
buffer_load_dwordx4 v[100:103], v3, s[40:43], s60 offen
ds_read_b64_tr_b16 v[44:45], v10 offset:192
ds_read_b64_tr_b16 v[46:47], v10 offset:1088
s_waitcnt vmcnt(6) lgkmcnt(12)
v_mfma_f32_32x32x16_bf16 v[108:123], v[20:23], v[76:79], v[108:123]
ds_read_b64_tr_b16 v[48:49], v10 offset:3584
ds_read_b64_tr_b16 v[50:51], v10 offset:4480
s_waitcnt lgkmcnt(12)
v_mfma_f32_32x32x16_bf16 v[124:139], v[24:27], v[76:79], v[124:139]
ds_read_b64_tr_b16 v[52:53], v10 offset:3616
ds_read_b64_tr_b16 v[54:55], v10 offset:4512
s_waitcnt lgkmcnt(12)
v_mfma_f32_32x32x16_bf16 v[140:155], v[28:31], v[76:79], v[140:155]
ds_read_b64_tr_b16 v[56:57], v10 offset:3648
ds_read_b64_tr_b16 v[58:59], v10 offset:4544
s_waitcnt lgkmcnt(12)
v_mfma_f32_32x32x16_bf16 v[156:171], v[32:35], v[76:79], v[156:171]
ds_read_b64_tr_b16 v[60:61], v10 offset:3680
ds_read_b64_tr_b16 v[62:63], v10 offset:4576
s_waitcnt lgkmcnt(12)
v_mfma_f32_32x32x16_bf16 v[172:187], v[36:39], v[76:79], v[172:187]
ds_read_b64_tr_b16 v[64:65], v10 offset:3712
ds_read_b64_tr_b16 v[66:67], v10 offset:4608
s_waitcnt lgkmcnt(12)
v_mfma_f32_32x32x16_bf16 v[188:203], v[40:43], v[76:79], v[188:203]
ds_read_b64_tr_b16 v[68:69], v10 offset:3744
ds_read_b64_tr_b16 v[70:71], v10 offset:4640
s_waitcnt lgkmcnt(12)
v_mfma_f32_32x32x16_bf16 v[204:219], v[44:47], v[76:79], v[204:219]
s_mov_b32 s60, 64512
buffer_load_dwordx4 v[104:107], v3, s[40:43], s60 offen
ds_read_b64_tr_b16 v[72:73], v10 offset:3776
ds_read_b64_tr_b16 v[74:75], v10 offset:4672
s_waitcnt vmcnt(6) lgkmcnt(12)
v_mfma_f32_32x32x16_bf16 v[108:123], v[48:51], v[80:83], v[108:123]
ds_read_b64_tr_b16 v[20:21], v10 offset:7168
ds_read_b64_tr_b16 v[22:23], v10 offset:8064
s_waitcnt lgkmcnt(12)
v_mfma_f32_32x32x16_bf16 v[124:139], v[52:55], v[80:83], v[124:139]
ds_read_b64_tr_b16 v[24:25], v10 offset:7200
ds_read_b64_tr_b16 v[26:27], v10 offset:8096
s_waitcnt lgkmcnt(12)
v_mfma_f32_32x32x16_bf16 v[140:155], v[56:59], v[80:83], v[140:155]
ds_read_b64_tr_b16 v[28:29], v10 offset:7232
ds_read_b64_tr_b16 v[30:31], v10 offset:8128
s_waitcnt lgkmcnt(12)
v_mfma_f32_32x32x16_bf16 v[156:171], v[60:63], v[80:83], v[156:171]
ds_read_b64_tr_b16 v[32:33], v10 offset:7264
ds_read_b64_tr_b16 v[34:35], v10 offset:8160
s_waitcnt lgkmcnt(12)
v_mfma_f32_32x32x16_bf16 v[172:187], v[64:67], v[80:83], v[172:187]
ds_read_b64_tr_b16 v[36:37], v10 offset:7296
ds_read_b64_tr_b16 v[38:39], v10 offset:8192
s_waitcnt lgkmcnt(12)
v_mfma_f32_32x32x16_bf16 v[188:203], v[68:71], v[80:83], v[188:203]
ds_read_b64_tr_b16 v[40:41], v10 offset:7328
ds_read_b64_tr_b16 v[42:43], v10 offset:8224
s_waitcnt lgkmcnt(12)
v_mfma_f32_32x32x16_bf16 v[204:219], v[72:75], v[80:83], v[204:219]
ds_read_b64_tr_b16 v[44:45], v10 offset:7360
ds_read_b64_tr_b16 v[46:47], v10 offset:8256
s_waitcnt vmcnt(5) lgkmcnt(12)
v_mfma_f32_32x32x16_bf16 v[108:123], v[20:23], v[84:87], v[108:123]
ds_read_b64_tr_b16 v[48:49], v10 offset:10752
ds_read_b64_tr_b16 v[50:51], v10 offset:11648
s_waitcnt lgkmcnt(12)
v_mfma_f32_32x32x16_bf16 v[124:139], v[24:27], v[84:87], v[124:139]
ds_read_b64_tr_b16 v[52:53], v10 offset:10784
ds_read_b64_tr_b16 v[54:55], v10 offset:11680
s_waitcnt lgkmcnt(12)
v_mfma_f32_32x32x16_bf16 v[140:155], v[28:31], v[84:87], v[140:155]
ds_read_b64_tr_b16 v[56:57], v10 offset:10816
ds_read_b64_tr_b16 v[58:59], v10 offset:11712
s_waitcnt lgkmcnt(12)
v_mfma_f32_32x32x16_bf16 v[156:171], v[32:35], v[84:87], v[156:171]
ds_read_b64_tr_b16 v[60:61], v10 offset:10848
ds_read_b64_tr_b16 v[62:63], v10 offset:11744
s_waitcnt lgkmcnt(12)
v_mfma_f32_32x32x16_bf16 v[172:187], v[36:39], v[84:87], v[172:187]
ds_read_b64_tr_b16 v[64:65], v10 offset:10880
ds_read_b64_tr_b16 v[66:67], v10 offset:11776
s_waitcnt lgkmcnt(12)
v_mfma_f32_32x32x16_bf16 v[188:203], v[40:43], v[84:87], v[188:203]
ds_read_b64_tr_b16 v[68:69], v10 offset:10912
ds_read_b64_tr_b16 v[70:71], v10 offset:11808
s_waitcnt lgkmcnt(12)
v_mfma_f32_32x32x16_bf16 v[204:219], v[44:47], v[84:87], v[204:219]
ds_read_b64_tr_b16 v[72:73], v10 offset:10944
ds_read_b64_tr_b16 v[74:75], v10 offset:11840
s_barrier
v_add_u32 v11, 57856, v9
s_waitcnt vmcnt(4) lgkmcnt(12)
v_mfma_f32_32x32x16_bf16 v[108:123], v[48:51], v[88:91], v[108:123]
ds_read_b64_tr_b16 v[20:21], v11 offset:0
ds_read_b64_tr_b16 v[22:23], v11 offset:896
s_waitcnt lgkmcnt(12)
v_mfma_f32_32x32x16_bf16 v[124:139], v[52:55], v[88:91], v[124:139]
ds_read_b64_tr_b16 v[24:25], v11 offset:32
ds_read_b64_tr_b16 v[26:27], v11 offset:928
s_waitcnt lgkmcnt(12)
v_mfma_f32_32x32x16_bf16 v[140:155], v[56:59], v[88:91], v[140:155]
ds_read_b64_tr_b16 v[28:29], v11 offset:64
ds_read_b64_tr_b16 v[30:31], v11 offset:960
s_waitcnt lgkmcnt(12)
v_mfma_f32_32x32x16_bf16 v[156:171], v[60:63], v[88:91], v[156:171]
ds_read_b64_tr_b16 v[32:33], v11 offset:96
ds_read_b64_tr_b16 v[34:35], v11 offset:992
s_waitcnt lgkmcnt(12)
v_mfma_f32_32x32x16_bf16 v[172:187], v[64:67], v[88:91], v[172:187]
ds_read_b64_tr_b16 v[36:37], v11 offset:128
ds_read_b64_tr_b16 v[38:39], v11 offset:1024
s_waitcnt lgkmcnt(12)
v_mfma_f32_32x32x16_bf16 v[188:203], v[68:71], v[88:91], v[188:203]
ds_read_b64_tr_b16 v[40:41], v11 offset:160
ds_read_b64_tr_b16 v[42:43], v11 offset:1056
s_waitcnt lgkmcnt(12)
v_mfma_f32_32x32x16_bf16 v[204:219], v[72:75], v[88:91], v[204:219]
ds_read_b64_tr_b16 v[44:45], v11 offset:192
ds_read_b64_tr_b16 v[46:47], v11 offset:1088
s_waitcnt vmcnt(3) lgkmcnt(12)
v_mfma_f32_32x32x16_bf16 v[108:123], v[20:23], v[92:95], v[108:123]
ds_read_b64_tr_b16 v[48:49], v11 offset:3584
ds_read_b64_tr_b16 v[50:51], v11 offset:4480
s_waitcnt lgkmcnt(12)
v_mfma_f32_32x32x16_bf16 v[124:139], v[24:27], v[92:95], v[124:139]
ds_read_b64_tr_b16 v[52:53], v11 offset:3616
ds_read_b64_tr_b16 v[54:55], v11 offset:4512
s_waitcnt lgkmcnt(12)
v_mfma_f32_32x32x16_bf16 v[140:155], v[28:31], v[92:95], v[140:155]
ds_read_b64_tr_b16 v[56:57], v11 offset:3648
ds_read_b64_tr_b16 v[58:59], v11 offset:4544
s_waitcnt lgkmcnt(12)
v_mfma_f32_32x32x16_bf16 v[156:171], v[32:35], v[92:95], v[156:171]
ds_read_b64_tr_b16 v[60:61], v11 offset:3680
ds_read_b64_tr_b16 v[62:63], v11 offset:4576
s_waitcnt lgkmcnt(12)
v_mfma_f32_32x32x16_bf16 v[172:187], v[36:39], v[92:95], v[172:187]
ds_read_b64_tr_b16 v[64:65], v11 offset:3712
ds_read_b64_tr_b16 v[66:67], v11 offset:4608
s_waitcnt lgkmcnt(12)
v_mfma_f32_32x32x16_bf16 v[188:203], v[40:43], v[92:95], v[188:203]
ds_read_b64_tr_b16 v[68:69], v11 offset:3744
ds_read_b64_tr_b16 v[70:71], v11 offset:4640
s_waitcnt lgkmcnt(12)
v_mfma_f32_32x32x16_bf16 v[204:219], v[44:47], v[92:95], v[204:219]
ds_read_b64_tr_b16 v[72:73], v11 offset:3776
ds_read_b64_tr_b16 v[74:75], v11 offset:4672
s_waitcnt vmcnt(2) lgkmcnt(12)
v_mfma_f32_32x32x16_bf16 v[108:123], v[48:51], v[96:99], v[108:123]
ds_read_b64_tr_b16 v[20:21], v11 offset:7168
ds_read_b64_tr_b16 v[22:23], v11 offset:8064
s_waitcnt lgkmcnt(12)
v_mfma_f32_32x32x16_bf16 v[124:139], v[52:55], v[96:99], v[124:139]
ds_read_b64_tr_b16 v[24:25], v11 offset:7200
ds_read_b64_tr_b16 v[26:27], v11 offset:8096
s_waitcnt lgkmcnt(12)
v_mfma_f32_32x32x16_bf16 v[140:155], v[56:59], v[96:99], v[140:155]
ds_read_b64_tr_b16 v[28:29], v11 offset:7232
ds_read_b64_tr_b16 v[30:31], v11 offset:8128
s_waitcnt lgkmcnt(12)
v_mfma_f32_32x32x16_bf16 v[156:171], v[60:63], v[96:99], v[156:171]
ds_read_b64_tr_b16 v[32:33], v11 offset:7264
ds_read_b64_tr_b16 v[34:35], v11 offset:8160
s_waitcnt lgkmcnt(12)
v_mfma_f32_32x32x16_bf16 v[172:187], v[64:67], v[96:99], v[172:187]
ds_read_b64_tr_b16 v[36:37], v11 offset:7296
ds_read_b64_tr_b16 v[38:39], v11 offset:8192
s_waitcnt lgkmcnt(12)
v_mfma_f32_32x32x16_bf16 v[188:203], v[68:71], v[96:99], v[188:203]
ds_read_b64_tr_b16 v[40:41], v11 offset:7328
ds_read_b64_tr_b16 v[42:43], v11 offset:8224
s_waitcnt lgkmcnt(12)
v_mfma_f32_32x32x16_bf16 v[204:219], v[72:75], v[96:99], v[204:219]
ds_read_b64_tr_b16 v[44:45], v11 offset:7360
ds_read_b64_tr_b16 v[46:47], v11 offset:8256
s_waitcnt vmcnt(1) lgkmcnt(12)
v_mfma_f32_32x32x16_bf16 v[108:123], v[20:23], v[100:103], v[108:123]
ds_read_b64_tr_b16 v[48:49], v11 offset:10752
ds_read_b64_tr_b16 v[50:51], v11 offset:11648
s_waitcnt lgkmcnt(12)
v_mfma_f32_32x32x16_bf16 v[124:139], v[24:27], v[100:103], v[124:139]
ds_read_b64_tr_b16 v[52:53], v11 offset:10784
ds_read_b64_tr_b16 v[54:55], v11 offset:11680
s_waitcnt lgkmcnt(12)
v_mfma_f32_32x32x16_bf16 v[140:155], v[28:31], v[100:103], v[140:155]
ds_read_b64_tr_b16 v[56:57], v11 offset:10816
ds_read_b64_tr_b16 v[58:59], v11 offset:11712
s_waitcnt lgkmcnt(12)
v_mfma_f32_32x32x16_bf16 v[156:171], v[32:35], v[100:103], v[156:171]
ds_read_b64_tr_b16 v[60:61], v11 offset:10848
ds_read_b64_tr_b16 v[62:63], v11 offset:11744
s_waitcnt lgkmcnt(12)
v_mfma_f32_32x32x16_bf16 v[172:187], v[36:39], v[100:103], v[172:187]
ds_read_b64_tr_b16 v[64:65], v11 offset:10880
ds_read_b64_tr_b16 v[66:67], v11 offset:11776
s_waitcnt lgkmcnt(12)
v_mfma_f32_32x32x16_bf16 v[188:203], v[40:43], v[100:103], v[188:203]
ds_read_b64_tr_b16 v[68:69], v11 offset:10912
ds_read_b64_tr_b16 v[70:71], v11 offset:11808
s_waitcnt lgkmcnt(12)
v_mfma_f32_32x32x16_bf16 v[204:219], v[44:47], v[100:103], v[204:219]
ds_read_b64_tr_b16 v[72:73], v11 offset:10944
ds_read_b64_tr_b16 v[74:75], v11 offset:11840
s_waitcnt vmcnt(0) lgkmcnt(12)
v_mfma_f32_32x32x16_bf16 v[108:123], v[48:51], v[104:107], v[108:123]
s_waitcnt lgkmcnt(10)
v_mfma_f32_32x32x16_bf16 v[124:139], v[52:55], v[104:107], v[124:139]
s_waitcnt lgkmcnt(8)
v_mfma_f32_32x32x16_bf16 v[140:155], v[56:59], v[104:107], v[140:155]
s_waitcnt lgkmcnt(6)
v_mfma_f32_32x32x16_bf16 v[156:171], v[60:63], v[104:107], v[156:171]
s_waitcnt lgkmcnt(4)
v_mfma_f32_32x32x16_bf16 v[172:187], v[64:67], v[104:107], v[172:187]
s_waitcnt lgkmcnt(2)
v_mfma_f32_32x32x16_bf16 v[188:203], v[68:71], v[104:107], v[188:203]
s_waitcnt lgkmcnt(0)
v_mfma_f32_32x32x16_bf16 v[204:219], v[72:75], v[104:107], v[204:219]
s_barrier
v_and_b32 v222, 31, v1
v_lshlrev_b32 v222, 3, v222
v_add_u32 v222, 2304, v222
ds_read_b64 v[220:221], v222
v_lshlrev_b32 v225, 4, v5
v_add_u32 v225, 0, v225
ds_read_b128 v[20:23], v225 offset:0
ds_read_b128 v[24:27], v225 offset:32
ds_read_b128 v[28:31], v225 offset:64
ds_read_b128 v[32:35], v225 offset:96
s_waitcnt lgkmcnt(4)
v_mul_f32 v226, v221, v221
s_lshl_b32 s7, s4, 2
s_add_u32 s7, s7, 1
s_mul_i32 s8, s7, 112
s_mul_i32 s9, s5, 7
s_add_u32 s8, s8, s9
s_lshl_b32 s8, s8, 10
s_add_u32 s8, s8, 16777216
ds_read_b128 v[36:39], v225 offset:128
ds_read_b128 v[40:43], v225 offset:160
ds_read_b128 v[44:47], v225 offset:192
ds_read_b128 v[48:51], v225 offset:224
s_waitcnt lgkmcnt(7)
v_pk_fma_f32 v[108:109], v[20:21], v[220:221], v[108:109] op_sel_hi:[1,0,1]
v_pk_fma_f32 v[110:111], v[22:23], v[220:221], v[110:111] op_sel_hi:[1,0,1]
s_waitcnt lgkmcnt(6)
v_pk_fma_f32 v[112:113], v[24:25], v[220:221], v[112:113] op_sel_hi:[1,0,1]
v_pk_fma_f32 v[114:115], v[26:27], v[220:221], v[114:115] op_sel_hi:[1,0,1]
s_waitcnt lgkmcnt(5)
v_pk_fma_f32 v[116:117], v[28:29], v[220:221], v[116:117] op_sel_hi:[1,0,1]
v_pk_fma_f32 v[118:119], v[30:31], v[220:221], v[118:119] op_sel_hi:[1,0,1]
s_waitcnt lgkmcnt(4)
v_pk_fma_f32 v[120:121], v[32:33], v[220:221], v[120:121] op_sel_hi:[1,0,1]
v_pk_fma_f32 v[122:123], v[34:35], v[220:221], v[122:123] op_sel_hi:[1,0,1]
v_max_f32 v108, 0, v108
v_max_f32 v109, 0, v109
v_max_f32 v110, 0, v110
v_max_f32 v111, 0, v111
v_max_f32 v112, 0, v112
v_max_f32 v113, 0, v113
v_max_f32 v114, 0, v114
v_max_f32 v115, 0, v115
v_pk_mul_f32 v[108:109], v[108:109], v[116:117]
v_pk_mul_f32 v[110:111], v[110:111], v[118:119]
v_pk_mul_f32 v[112:113], v[112:113], v[120:121]
v_pk_mul_f32 v[114:115], v[114:115], v[122:123]
v_pk_mul_f32 v[108:109], v[108:109], v[226:227] op_sel_hi:[1,0]
v_pk_mul_f32 v[110:111], v[110:111], v[226:227] op_sel_hi:[1,0]
v_pk_mul_f32 v[112:113], v[112:113], v[226:227] op_sel_hi:[1,0]
v_pk_mul_f32 v[114:115], v[114:115], v[226:227] op_sel_hi:[1,0]
v_cvt_pk_bf16_f32 v52, v108, v109
v_cvt_pk_bf16_f32 v53, v110, v111
v_cvt_pk_bf16_f32 v54, v112, v113
v_cvt_pk_bf16_f32 v55, v114, v115
s_nop 0
v_permlane32_swap_b32 v52, v54
v_permlane32_swap_b32 v53, v55
buffer_store_dwordx4 v[52:55], v3, s[52:55], s8 offen offset:0
ds_read_b128 v[20:23], v225 offset:256
ds_read_b128 v[24:27], v225 offset:288
ds_read_b128 v[28:31], v225 offset:320
ds_read_b128 v[32:35], v225 offset:352
s_waitcnt lgkmcnt(7)
v_pk_fma_f32 v[124:125], v[36:37], v[220:221], v[124:125] op_sel_hi:[1,0,1]
v_pk_fma_f32 v[126:127], v[38:39], v[220:221], v[126:127] op_sel_hi:[1,0,1]
s_waitcnt lgkmcnt(6)
v_pk_fma_f32 v[128:129], v[40:41], v[220:221], v[128:129] op_sel_hi:[1,0,1]
v_pk_fma_f32 v[130:131], v[42:43], v[220:221], v[130:131] op_sel_hi:[1,0,1]
s_waitcnt lgkmcnt(5)
v_pk_fma_f32 v[132:133], v[44:45], v[220:221], v[132:133] op_sel_hi:[1,0,1]
v_pk_fma_f32 v[134:135], v[46:47], v[220:221], v[134:135] op_sel_hi:[1,0,1]
s_waitcnt lgkmcnt(4)
v_pk_fma_f32 v[136:137], v[48:49], v[220:221], v[136:137] op_sel_hi:[1,0,1]
v_pk_fma_f32 v[138:139], v[50:51], v[220:221], v[138:139] op_sel_hi:[1,0,1]
v_max_f32 v124, 0, v124
v_max_f32 v125, 0, v125
v_max_f32 v126, 0, v126
v_max_f32 v127, 0, v127
v_max_f32 v128, 0, v128
v_max_f32 v129, 0, v129
v_max_f32 v130, 0, v130
v_max_f32 v131, 0, v131
v_pk_mul_f32 v[124:125], v[124:125], v[132:133]
v_pk_mul_f32 v[126:127], v[126:127], v[134:135]
v_pk_mul_f32 v[128:129], v[128:129], v[136:137]
v_pk_mul_f32 v[130:131], v[130:131], v[138:139]
v_pk_mul_f32 v[124:125], v[124:125], v[226:227] op_sel_hi:[1,0]
v_pk_mul_f32 v[126:127], v[126:127], v[226:227] op_sel_hi:[1,0]
v_pk_mul_f32 v[128:129], v[128:129], v[226:227] op_sel_hi:[1,0]
v_pk_mul_f32 v[130:131], v[130:131], v[226:227] op_sel_hi:[1,0]
v_cvt_pk_bf16_f32 v56, v124, v125
v_cvt_pk_bf16_f32 v57, v126, v127
v_cvt_pk_bf16_f32 v58, v128, v129
v_cvt_pk_bf16_f32 v59, v130, v131
s_nop 0
v_permlane32_swap_b32 v56, v58
v_permlane32_swap_b32 v57, v59
buffer_store_dwordx4 v[56:59], v3, s[52:55], s8 offen offset:1024
ds_read_b128 v[36:39], v225 offset:384
ds_read_b128 v[40:43], v225 offset:416
ds_read_b128 v[44:47], v225 offset:448
ds_read_b128 v[48:51], v225 offset:480
s_waitcnt lgkmcnt(7)
v_pk_fma_f32 v[140:141], v[20:21], v[220:221], v[140:141] op_sel_hi:[1,0,1]
v_pk_fma_f32 v[142:143], v[22:23], v[220:221], v[142:143] op_sel_hi:[1,0,1]
s_waitcnt lgkmcnt(6)
v_pk_fma_f32 v[144:145], v[24:25], v[220:221], v[144:145] op_sel_hi:[1,0,1]
v_pk_fma_f32 v[146:147], v[26:27], v[220:221], v[146:147] op_sel_hi:[1,0,1]
s_waitcnt lgkmcnt(5)
v_pk_fma_f32 v[148:149], v[28:29], v[220:221], v[148:149] op_sel_hi:[1,0,1]
v_pk_fma_f32 v[150:151], v[30:31], v[220:221], v[150:151] op_sel_hi:[1,0,1]
s_waitcnt lgkmcnt(4)
v_pk_fma_f32 v[152:153], v[32:33], v[220:221], v[152:153] op_sel_hi:[1,0,1]
v_pk_fma_f32 v[154:155], v[34:35], v[220:221], v[154:155] op_sel_hi:[1,0,1]
v_max_f32 v140, 0, v140
v_max_f32 v141, 0, v141
v_max_f32 v142, 0, v142
v_max_f32 v143, 0, v143
v_max_f32 v144, 0, v144
v_max_f32 v145, 0, v145
v_max_f32 v146, 0, v146
v_max_f32 v147, 0, v147
v_pk_mul_f32 v[140:141], v[140:141], v[148:149]
v_pk_mul_f32 v[142:143], v[142:143], v[150:151]
v_pk_mul_f32 v[144:145], v[144:145], v[152:153]
v_pk_mul_f32 v[146:147], v[146:147], v[154:155]
v_pk_mul_f32 v[140:141], v[140:141], v[226:227] op_sel_hi:[1,0]
v_pk_mul_f32 v[142:143], v[142:143], v[226:227] op_sel_hi:[1,0]
v_pk_mul_f32 v[144:145], v[144:145], v[226:227] op_sel_hi:[1,0]
v_pk_mul_f32 v[146:147], v[146:147], v[226:227] op_sel_hi:[1,0]
v_cvt_pk_bf16_f32 v52, v140, v141
v_cvt_pk_bf16_f32 v53, v142, v143
v_cvt_pk_bf16_f32 v54, v144, v145
v_cvt_pk_bf16_f32 v55, v146, v147
s_nop 0
v_permlane32_swap_b32 v52, v54
v_permlane32_swap_b32 v53, v55
buffer_store_dwordx4 v[52:55], v3, s[52:55], s8 offen offset:2048
ds_read_b128 v[20:23], v225 offset:512
ds_read_b128 v[24:27], v225 offset:544
ds_read_b128 v[28:31], v225 offset:576
ds_read_b128 v[32:35], v225 offset:608
s_waitcnt lgkmcnt(7)
v_pk_fma_f32 v[156:157], v[36:37], v[220:221], v[156:157] op_sel_hi:[1,0,1]
v_pk_fma_f32 v[158:159], v[38:39], v[220:221], v[158:159] op_sel_hi:[1,0,1]
s_waitcnt lgkmcnt(6)
v_pk_fma_f32 v[160:161], v[40:41], v[220:221], v[160:161] op_sel_hi:[1,0,1]
v_pk_fma_f32 v[162:163], v[42:43], v[220:221], v[162:163] op_sel_hi:[1,0,1]
s_waitcnt lgkmcnt(5)
v_pk_fma_f32 v[164:165], v[44:45], v[220:221], v[164:165] op_sel_hi:[1,0,1]
v_pk_fma_f32 v[166:167], v[46:47], v[220:221], v[166:167] op_sel_hi:[1,0,1]
s_waitcnt lgkmcnt(4)
v_pk_fma_f32 v[168:169], v[48:49], v[220:221], v[168:169] op_sel_hi:[1,0,1]
v_pk_fma_f32 v[170:171], v[50:51], v[220:221], v[170:171] op_sel_hi:[1,0,1]
v_max_f32 v156, 0, v156
v_max_f32 v157, 0, v157
v_max_f32 v158, 0, v158
v_max_f32 v159, 0, v159
v_max_f32 v160, 0, v160
v_max_f32 v161, 0, v161
v_max_f32 v162, 0, v162
v_max_f32 v163, 0, v163
v_pk_mul_f32 v[156:157], v[156:157], v[164:165]
v_pk_mul_f32 v[158:159], v[158:159], v[166:167]
v_pk_mul_f32 v[160:161], v[160:161], v[168:169]
v_pk_mul_f32 v[162:163], v[162:163], v[170:171]
v_pk_mul_f32 v[156:157], v[156:157], v[226:227] op_sel_hi:[1,0]
v_pk_mul_f32 v[158:159], v[158:159], v[226:227] op_sel_hi:[1,0]
v_pk_mul_f32 v[160:161], v[160:161], v[226:227] op_sel_hi:[1,0]
v_pk_mul_f32 v[162:163], v[162:163], v[226:227] op_sel_hi:[1,0]
v_cvt_pk_bf16_f32 v56, v156, v157
v_cvt_pk_bf16_f32 v57, v158, v159
v_cvt_pk_bf16_f32 v58, v160, v161
v_cvt_pk_bf16_f32 v59, v162, v163
s_nop 0
v_permlane32_swap_b32 v56, v58
v_permlane32_swap_b32 v57, v59
buffer_store_dwordx4 v[56:59], v3, s[52:55], s8 offen offset:3072
ds_read_b128 v[36:39], v225 offset:640
ds_read_b128 v[40:43], v225 offset:672
ds_read_b128 v[44:47], v225 offset:704
ds_read_b128 v[48:51], v225 offset:736
s_waitcnt lgkmcnt(7)
v_pk_fma_f32 v[172:173], v[20:21], v[220:221], v[172:173] op_sel_hi:[1,0,1]
v_pk_fma_f32 v[174:175], v[22:23], v[220:221], v[174:175] op_sel_hi:[1,0,1]
s_waitcnt lgkmcnt(6)
v_pk_fma_f32 v[176:177], v[24:25], v[220:221], v[176:177] op_sel_hi:[1,0,1]
v_pk_fma_f32 v[178:179], v[26:27], v[220:221], v[178:179] op_sel_hi:[1,0,1]
s_waitcnt lgkmcnt(5)
v_pk_fma_f32 v[180:181], v[28:29], v[220:221], v[180:181] op_sel_hi:[1,0,1]
v_pk_fma_f32 v[182:183], v[30:31], v[220:221], v[182:183] op_sel_hi:[1,0,1]
s_waitcnt lgkmcnt(4)
v_pk_fma_f32 v[184:185], v[32:33], v[220:221], v[184:185] op_sel_hi:[1,0,1]
v_pk_fma_f32 v[186:187], v[34:35], v[220:221], v[186:187] op_sel_hi:[1,0,1]
v_max_f32 v172, 0, v172
v_max_f32 v173, 0, v173
v_max_f32 v174, 0, v174
v_max_f32 v175, 0, v175
v_max_f32 v176, 0, v176
v_max_f32 v177, 0, v177
v_max_f32 v178, 0, v178
v_max_f32 v179, 0, v179
v_pk_mul_f32 v[172:173], v[172:173], v[180:181]
v_pk_mul_f32 v[174:175], v[174:175], v[182:183]
v_pk_mul_f32 v[176:177], v[176:177], v[184:185]
v_pk_mul_f32 v[178:179], v[178:179], v[186:187]
v_pk_mul_f32 v[172:173], v[172:173], v[226:227] op_sel_hi:[1,0]
v_pk_mul_f32 v[174:175], v[174:175], v[226:227] op_sel_hi:[1,0]
v_pk_mul_f32 v[176:177], v[176:177], v[226:227] op_sel_hi:[1,0]
v_pk_mul_f32 v[178:179], v[178:179], v[226:227] op_sel_hi:[1,0]
v_cvt_pk_bf16_f32 v52, v172, v173
v_cvt_pk_bf16_f32 v53, v174, v175
v_cvt_pk_bf16_f32 v54, v176, v177
v_cvt_pk_bf16_f32 v55, v178, v179
s_nop 0
v_permlane32_swap_b32 v52, v54
v_permlane32_swap_b32 v53, v55
s_add_u32 s8, s8, 4096
buffer_store_dwordx4 v[52:55], v3, s[52:55], s8 offen offset:0
ds_read_b128 v[20:23], v225 offset:768
ds_read_b128 v[24:27], v225 offset:800
ds_read_b128 v[28:31], v225 offset:832
ds_read_b128 v[32:35], v225 offset:864
s_waitcnt lgkmcnt(7)
v_pk_fma_f32 v[188:189], v[36:37], v[220:221], v[188:189] op_sel_hi:[1,0,1]
v_pk_fma_f32 v[190:191], v[38:39], v[220:221], v[190:191] op_sel_hi:[1,0,1]
s_waitcnt lgkmcnt(6)
v_pk_fma_f32 v[192:193], v[40:41], v[220:221], v[192:193] op_sel_hi:[1,0,1]
v_pk_fma_f32 v[194:195], v[42:43], v[220:221], v[194:195] op_sel_hi:[1,0,1]
s_waitcnt lgkmcnt(5)
v_pk_fma_f32 v[196:197], v[44:45], v[220:221], v[196:197] op_sel_hi:[1,0,1]
v_pk_fma_f32 v[198:199], v[46:47], v[220:221], v[198:199] op_sel_hi:[1,0,1]
s_waitcnt lgkmcnt(4)
v_pk_fma_f32 v[200:201], v[48:49], v[220:221], v[200:201] op_sel_hi:[1,0,1]
v_pk_fma_f32 v[202:203], v[50:51], v[220:221], v[202:203] op_sel_hi:[1,0,1]
v_max_f32 v188, 0, v188
v_max_f32 v189, 0, v189
v_max_f32 v190, 0, v190
v_max_f32 v191, 0, v191
v_max_f32 v192, 0, v192
v_max_f32 v193, 0, v193
v_max_f32 v194, 0, v194
v_max_f32 v195, 0, v195
v_pk_mul_f32 v[188:189], v[188:189], v[196:197]
v_pk_mul_f32 v[190:191], v[190:191], v[198:199]
v_pk_mul_f32 v[192:193], v[192:193], v[200:201]
v_pk_mul_f32 v[194:195], v[194:195], v[202:203]
v_pk_mul_f32 v[188:189], v[188:189], v[226:227] op_sel_hi:[1,0]
v_pk_mul_f32 v[190:191], v[190:191], v[226:227] op_sel_hi:[1,0]
v_pk_mul_f32 v[192:193], v[192:193], v[226:227] op_sel_hi:[1,0]
v_pk_mul_f32 v[194:195], v[194:195], v[226:227] op_sel_hi:[1,0]
v_cvt_pk_bf16_f32 v56, v188, v189
v_cvt_pk_bf16_f32 v57, v190, v191
v_cvt_pk_bf16_f32 v58, v192, v193
v_cvt_pk_bf16_f32 v59, v194, v195
s_nop 0
v_permlane32_swap_b32 v56, v58
v_permlane32_swap_b32 v57, v59
buffer_store_dwordx4 v[56:59], v3, s[52:55], s8 offen offset:1024
s_waitcnt lgkmcnt(3)
v_pk_fma_f32 v[204:205], v[20:21], v[220:221], v[204:205] op_sel_hi:[1,0,1]
v_pk_fma_f32 v[206:207], v[22:23], v[220:221], v[206:207] op_sel_hi:[1,0,1]
s_waitcnt lgkmcnt(2)
v_pk_fma_f32 v[208:209], v[24:25], v[220:221], v[208:209] op_sel_hi:[1,0,1]
v_pk_fma_f32 v[210:211], v[26:27], v[220:221], v[210:211] op_sel_hi:[1,0,1]
s_waitcnt lgkmcnt(1)
v_pk_fma_f32 v[212:213], v[28:29], v[220:221], v[212:213] op_sel_hi:[1,0,1]
v_pk_fma_f32 v[214:215], v[30:31], v[220:221], v[214:215] op_sel_hi:[1,0,1]
s_waitcnt lgkmcnt(0)
v_pk_fma_f32 v[216:217], v[32:33], v[220:221], v[216:217] op_sel_hi:[1,0,1]
v_pk_fma_f32 v[218:219], v[34:35], v[220:221], v[218:219] op_sel_hi:[1,0,1]
v_max_f32 v204, 0, v204
v_max_f32 v205, 0, v205
v_max_f32 v206, 0, v206
v_max_f32 v207, 0, v207
v_max_f32 v208, 0, v208
v_max_f32 v209, 0, v209
v_max_f32 v210, 0, v210
v_max_f32 v211, 0, v211
v_pk_mul_f32 v[204:205], v[204:205], v[212:213]
v_pk_mul_f32 v[206:207], v[206:207], v[214:215]
v_pk_mul_f32 v[208:209], v[208:209], v[216:217]
v_pk_mul_f32 v[210:211], v[210:211], v[218:219]
v_pk_mul_f32 v[204:205], v[204:205], v[226:227] op_sel_hi:[1,0]
v_pk_mul_f32 v[206:207], v[206:207], v[226:227] op_sel_hi:[1,0]
v_pk_mul_f32 v[208:209], v[208:209], v[226:227] op_sel_hi:[1,0]
v_pk_mul_f32 v[210:211], v[210:211], v[226:227] op_sel_hi:[1,0]
v_cvt_pk_bf16_f32 v52, v204, v205
v_cvt_pk_bf16_f32 v53, v206, v207
v_cvt_pk_bf16_f32 v54, v208, v209
v_cvt_pk_bf16_f32 v55, v210, v211
s_nop 0
v_permlane32_swap_b32 v52, v54
v_permlane32_swap_b32 v53, v55
buffer_store_dwordx4 v[52:55], v3, s[52:55], s8 offen offset:2048
s_waitcnt vmcnt(0)
s_branch k4_kernel_end
k4_kernel_w2:
v_mul_u32_u24 v14, 224, v7
v_lshl_add_u32 v14, v8, 3, v14
v_mul_u32_u24 v15, 14464, v6
v_add_u32 v9, v14, v15
s_mov_b32 s60, 65536
buffer_load_dwordx4 v[76:79], v3, s[40:43], s60 offen
s_mov_b32 s60, 66560
buffer_load_dwordx4 v[80:83], v3, s[40:43], s60 offen
s_mov_b32 s60, 67584
buffer_load_dwordx4 v[84:87], v3, s[40:43], s60 offen
s_mov_b32 s60, 68608
buffer_load_dwordx4 v[88:91], v3, s[40:43], s60 offen
s_mov_b32 s60, 69632
buffer_load_dwordx4 v[92:95], v3, s[40:43], s60 offen
s_mov_b32 s60, 70656
buffer_load_dwordx4 v[96:99], v3, s[40:43], s60 offen
s_mov_b32 s60, 71680
buffer_load_dwordx4 v[100:103], v3, s[40:43], s60 offen
s_barrier
v_add_u32 v10, 0, v9
ds_read_b64_tr_b16 v[20:21], v10 offset:0
ds_read_b64_tr_b16 v[22:23], v10 offset:896
ds_read_b64_tr_b16 v[24:25], v10 offset:32
ds_read_b64_tr_b16 v[26:27], v10 offset:928
ds_read_b64_tr_b16 v[28:29], v10 offset:64
ds_read_b64_tr_b16 v[30:31], v10 offset:960
ds_read_b64_tr_b16 v[32:33], v10 offset:96
ds_read_b64_tr_b16 v[34:35], v10 offset:992
ds_read_b64_tr_b16 v[36:37], v10 offset:128
ds_read_b64_tr_b16 v[38:39], v10 offset:1024
ds_read_b64_tr_b16 v[40:41], v10 offset:160
ds_read_b64_tr_b16 v[42:43], v10 offset:1056
ds_read_b64_tr_b16 v[44:45], v10 offset:192
ds_read_b64_tr_b16 v[46:47], v10 offset:1088
s_waitcnt vmcnt(6) lgkmcnt(12)
v_mfma_f32_32x32x16_bf16 v[108:123], v[20:23], v[76:79], 0
ds_read_b64_tr_b16 v[48:49], v10 offset:3584
ds_read_b64_tr_b16 v[50:51], v10 offset:4480
s_waitcnt lgkmcnt(12)
v_mfma_f32_32x32x16_bf16 v[124:139], v[24:27], v[76:79], 0
ds_read_b64_tr_b16 v[52:53], v10 offset:3616
ds_read_b64_tr_b16 v[54:55], v10 offset:4512
s_waitcnt lgkmcnt(12)
v_mfma_f32_32x32x16_bf16 v[140:155], v[28:31], v[76:79], 0
ds_read_b64_tr_b16 v[56:57], v10 offset:3648
ds_read_b64_tr_b16 v[58:59], v10 offset:4544
s_waitcnt lgkmcnt(12)
v_mfma_f32_32x32x16_bf16 v[156:171], v[32:35], v[76:79], 0
ds_read_b64_tr_b16 v[60:61], v10 offset:3680
ds_read_b64_tr_b16 v[62:63], v10 offset:4576
s_waitcnt lgkmcnt(12)
v_mfma_f32_32x32x16_bf16 v[172:187], v[36:39], v[76:79], 0
ds_read_b64_tr_b16 v[64:65], v10 offset:3712
ds_read_b64_tr_b16 v[66:67], v10 offset:4608
s_waitcnt lgkmcnt(12)
v_mfma_f32_32x32x16_bf16 v[188:203], v[40:43], v[76:79], 0
ds_read_b64_tr_b16 v[68:69], v10 offset:3744
ds_read_b64_tr_b16 v[70:71], v10 offset:4640
s_waitcnt lgkmcnt(12)
v_mfma_f32_32x32x16_bf16 v[204:219], v[44:47], v[76:79], 0
s_mov_b32 s60, 72704
buffer_load_dwordx4 v[104:107], v3, s[40:43], s60 offen
ds_read_b64_tr_b16 v[72:73], v10 offset:3776
ds_read_b64_tr_b16 v[74:75], v10 offset:4672
s_waitcnt vmcnt(6) lgkmcnt(12)
v_mfma_f32_32x32x16_bf16 v[108:123], v[48:51], v[80:83], v[108:123]
ds_read_b64_tr_b16 v[20:21], v10 offset:7168
ds_read_b64_tr_b16 v[22:23], v10 offset:8064
s_waitcnt lgkmcnt(12)
v_mfma_f32_32x32x16_bf16 v[124:139], v[52:55], v[80:83], v[124:139]
ds_read_b64_tr_b16 v[24:25], v10 offset:7200
ds_read_b64_tr_b16 v[26:27], v10 offset:8096
s_waitcnt lgkmcnt(12)
v_mfma_f32_32x32x16_bf16 v[140:155], v[56:59], v[80:83], v[140:155]
ds_read_b64_tr_b16 v[28:29], v10 offset:7232
ds_read_b64_tr_b16 v[30:31], v10 offset:8128
s_waitcnt lgkmcnt(12)
v_mfma_f32_32x32x16_bf16 v[156:171], v[60:63], v[80:83], v[156:171]
ds_read_b64_tr_b16 v[32:33], v10 offset:7264
ds_read_b64_tr_b16 v[34:35], v10 offset:8160
s_waitcnt lgkmcnt(12)
v_mfma_f32_32x32x16_bf16 v[172:187], v[64:67], v[80:83], v[172:187]
ds_read_b64_tr_b16 v[36:37], v10 offset:7296
ds_read_b64_tr_b16 v[38:39], v10 offset:8192
s_waitcnt lgkmcnt(12)
v_mfma_f32_32x32x16_bf16 v[188:203], v[68:71], v[80:83], v[188:203]
ds_read_b64_tr_b16 v[40:41], v10 offset:7328
ds_read_b64_tr_b16 v[42:43], v10 offset:8224
s_waitcnt lgkmcnt(12)
v_mfma_f32_32x32x16_bf16 v[204:219], v[72:75], v[80:83], v[204:219]
s_mov_b32 s60, 73728
buffer_load_dwordx4 v[76:79], v3, s[40:43], s60 offen
ds_read_b64_tr_b16 v[44:45], v10 offset:7360
ds_read_b64_tr_b16 v[46:47], v10 offset:8256
s_waitcnt vmcnt(6) lgkmcnt(12)
v_mfma_f32_32x32x16_bf16 v[108:123], v[20:23], v[84:87], v[108:123]
ds_read_b64_tr_b16 v[48:49], v10 offset:10752
ds_read_b64_tr_b16 v[50:51], v10 offset:11648
s_waitcnt lgkmcnt(12)
v_mfma_f32_32x32x16_bf16 v[124:139], v[24:27], v[84:87], v[124:139]
ds_read_b64_tr_b16 v[52:53], v10 offset:10784
ds_read_b64_tr_b16 v[54:55], v10 offset:11680
s_waitcnt lgkmcnt(12)
v_mfma_f32_32x32x16_bf16 v[140:155], v[28:31], v[84:87], v[140:155]
ds_read_b64_tr_b16 v[56:57], v10 offset:10816
ds_read_b64_tr_b16 v[58:59], v10 offset:11712
s_waitcnt lgkmcnt(12)
v_mfma_f32_32x32x16_bf16 v[156:171], v[32:35], v[84:87], v[156:171]
ds_read_b64_tr_b16 v[60:61], v10 offset:10848
ds_read_b64_tr_b16 v[62:63], v10 offset:11744
s_waitcnt lgkmcnt(12)
v_mfma_f32_32x32x16_bf16 v[172:187], v[36:39], v[84:87], v[172:187]
ds_read_b64_tr_b16 v[64:65], v10 offset:10880
ds_read_b64_tr_b16 v[66:67], v10 offset:11776
s_waitcnt lgkmcnt(12)
v_mfma_f32_32x32x16_bf16 v[188:203], v[40:43], v[84:87], v[188:203]
ds_read_b64_tr_b16 v[68:69], v10 offset:10912
ds_read_b64_tr_b16 v[70:71], v10 offset:11808
s_waitcnt lgkmcnt(12)
v_mfma_f32_32x32x16_bf16 v[204:219], v[44:47], v[84:87], v[204:219]
s_mov_b32 s60, 74752
buffer_load_dwordx4 v[80:83], v3, s[40:43], s60 offen
ds_read_b64_tr_b16 v[72:73], v10 offset:10944
ds_read_b64_tr_b16 v[74:75], v10 offset:11840
s_barrier
v_add_u32 v11, 28928, v9
s_waitcnt vmcnt(6) lgkmcnt(12)
v_mfma_f32_32x32x16_bf16 v[108:123], v[48:51], v[88:91], v[108:123]
ds_read_b64_tr_b16 v[20:21], v11 offset:0
ds_read_b64_tr_b16 v[22:23], v11 offset:896
s_waitcnt lgkmcnt(12)
v_mfma_f32_32x32x16_bf16 v[124:139], v[52:55], v[88:91], v[124:139]
ds_read_b64_tr_b16 v[24:25], v11 offset:32
ds_read_b64_tr_b16 v[26:27], v11 offset:928
s_waitcnt lgkmcnt(12)
v_mfma_f32_32x32x16_bf16 v[140:155], v[56:59], v[88:91], v[140:155]
ds_read_b64_tr_b16 v[28:29], v11 offset:64
ds_read_b64_tr_b16 v[30:31], v11 offset:960
s_waitcnt lgkmcnt(12)
v_mfma_f32_32x32x16_bf16 v[156:171], v[60:63], v[88:91], v[156:171]
ds_read_b64_tr_b16 v[32:33], v11 offset:96
ds_read_b64_tr_b16 v[34:35], v11 offset:992
s_waitcnt lgkmcnt(12)
v_mfma_f32_32x32x16_bf16 v[172:187], v[64:67], v[88:91], v[172:187]
ds_read_b64_tr_b16 v[36:37], v11 offset:128
ds_read_b64_tr_b16 v[38:39], v11 offset:1024
s_waitcnt lgkmcnt(12)
v_mfma_f32_32x32x16_bf16 v[188:203], v[68:71], v[88:91], v[188:203]
ds_read_b64_tr_b16 v[40:41], v11 offset:160
ds_read_b64_tr_b16 v[42:43], v11 offset:1056
s_waitcnt lgkmcnt(12)
v_mfma_f32_32x32x16_bf16 v[204:219], v[72:75], v[88:91], v[204:219]
s_mov_b32 s60, 75776
buffer_load_dwordx4 v[84:87], v3, s[40:43], s60 offen
ds_read_b64_tr_b16 v[44:45], v11 offset:192
ds_read_b64_tr_b16 v[46:47], v11 offset:1088
s_waitcnt vmcnt(6) lgkmcnt(12)
v_mfma_f32_32x32x16_bf16 v[108:123], v[20:23], v[92:95], v[108:123]
ds_read_b64_tr_b16 v[48:49], v11 offset:3584
ds_read_b64_tr_b16 v[50:51], v11 offset:4480
s_waitcnt lgkmcnt(12)
v_mfma_f32_32x32x16_bf16 v[124:139], v[24:27], v[92:95], v[124:139]
ds_read_b64_tr_b16 v[52:53], v11 offset:3616
ds_read_b64_tr_b16 v[54:55], v11 offset:4512
s_waitcnt lgkmcnt(12)
v_mfma_f32_32x32x16_bf16 v[140:155], v[28:31], v[92:95], v[140:155]
ds_read_b64_tr_b16 v[56:57], v11 offset:3648
ds_read_b64_tr_b16 v[58:59], v11 offset:4544
s_waitcnt lgkmcnt(12)
v_mfma_f32_32x32x16_bf16 v[156:171], v[32:35], v[92:95], v[156:171]
ds_read_b64_tr_b16 v[60:61], v11 offset:3680
ds_read_b64_tr_b16 v[62:63], v11 offset:4576
s_waitcnt lgkmcnt(12)
v_mfma_f32_32x32x16_bf16 v[172:187], v[36:39], v[92:95], v[172:187]
ds_read_b64_tr_b16 v[64:65], v11 offset:3712
ds_read_b64_tr_b16 v[66:67], v11 offset:4608
s_waitcnt lgkmcnt(12)
v_mfma_f32_32x32x16_bf16 v[188:203], v[40:43], v[92:95], v[188:203]
ds_read_b64_tr_b16 v[68:69], v11 offset:3744
ds_read_b64_tr_b16 v[70:71], v11 offset:4640
s_waitcnt lgkmcnt(12)
v_mfma_f32_32x32x16_bf16 v[204:219], v[44:47], v[92:95], v[204:219]
s_mov_b32 s60, 76800
buffer_load_dwordx4 v[88:91], v3, s[40:43], s60 offen
ds_read_b64_tr_b16 v[72:73], v11 offset:3776
ds_read_b64_tr_b16 v[74:75], v11 offset:4672
s_waitcnt vmcnt(6) lgkmcnt(12)
v_mfma_f32_32x32x16_bf16 v[108:123], v[48:51], v[96:99], v[108:123]
ds_read_b64_tr_b16 v[20:21], v11 offset:7168
ds_read_b64_tr_b16 v[22:23], v11 offset:8064
s_waitcnt lgkmcnt(12)
v_mfma_f32_32x32x16_bf16 v[124:139], v[52:55], v[96:99], v[124:139]
ds_read_b64_tr_b16 v[24:25], v11 offset:7200
ds_read_b64_tr_b16 v[26:27], v11 offset:8096
s_waitcnt lgkmcnt(12)
v_mfma_f32_32x32x16_bf16 v[140:155], v[56:59], v[96:99], v[140:155]
ds_read_b64_tr_b16 v[28:29], v11 offset:7232
ds_read_b64_tr_b16 v[30:31], v11 offset:8128
s_waitcnt lgkmcnt(12)
v_mfma_f32_32x32x16_bf16 v[156:171], v[60:63], v[96:99], v[156:171]
ds_read_b64_tr_b16 v[32:33], v11 offset:7264
ds_read_b64_tr_b16 v[34:35], v11 offset:8160
s_waitcnt lgkmcnt(12)
v_mfma_f32_32x32x16_bf16 v[172:187], v[64:67], v[96:99], v[172:187]
ds_read_b64_tr_b16 v[36:37], v11 offset:7296
ds_read_b64_tr_b16 v[38:39], v11 offset:8192
s_waitcnt lgkmcnt(12)
v_mfma_f32_32x32x16_bf16 v[188:203], v[68:71], v[96:99], v[188:203]
ds_read_b64_tr_b16 v[40:41], v11 offset:7328
ds_read_b64_tr_b16 v[42:43], v11 offset:8224
s_waitcnt lgkmcnt(12)
v_mfma_f32_32x32x16_bf16 v[204:219], v[72:75], v[96:99], v[204:219]
s_mov_b32 s60, 77824
buffer_load_dwordx4 v[92:95], v3, s[40:43], s60 offen
ds_read_b64_tr_b16 v[44:45], v11 offset:7360
ds_read_b64_tr_b16 v[46:47], v11 offset:8256
s_waitcnt vmcnt(6) lgkmcnt(12)
v_mfma_f32_32x32x16_bf16 v[108:123], v[20:23], v[100:103], v[108:123]
ds_read_b64_tr_b16 v[48:49], v11 offset:10752
ds_read_b64_tr_b16 v[50:51], v11 offset:11648
s_waitcnt lgkmcnt(12)
v_mfma_f32_32x32x16_bf16 v[124:139], v[24:27], v[100:103], v[124:139]
ds_read_b64_tr_b16 v[52:53], v11 offset:10784
ds_read_b64_tr_b16 v[54:55], v11 offset:11680
s_waitcnt lgkmcnt(12)
v_mfma_f32_32x32x16_bf16 v[140:155], v[28:31], v[100:103], v[140:155]
ds_read_b64_tr_b16 v[56:57], v11 offset:10816
ds_read_b64_tr_b16 v[58:59], v11 offset:11712
s_waitcnt lgkmcnt(12)
v_mfma_f32_32x32x16_bf16 v[156:171], v[32:35], v[100:103], v[156:171]
ds_read_b64_tr_b16 v[60:61], v11 offset:10848
ds_read_b64_tr_b16 v[62:63], v11 offset:11744
s_waitcnt lgkmcnt(12)
v_mfma_f32_32x32x16_bf16 v[172:187], v[36:39], v[100:103], v[172:187]
ds_read_b64_tr_b16 v[64:65], v11 offset:10880
ds_read_b64_tr_b16 v[66:67], v11 offset:11776
s_waitcnt lgkmcnt(12)
v_mfma_f32_32x32x16_bf16 v[188:203], v[40:43], v[100:103], v[188:203]
ds_read_b64_tr_b16 v[68:69], v11 offset:10912
ds_read_b64_tr_b16 v[70:71], v11 offset:11808
s_waitcnt lgkmcnt(12)
v_mfma_f32_32x32x16_bf16 v[204:219], v[44:47], v[100:103], v[204:219]
s_mov_b32 s60, 78848
buffer_load_dwordx4 v[96:99], v3, s[40:43], s60 offen
ds_read_b64_tr_b16 v[72:73], v11 offset:10944
ds_read_b64_tr_b16 v[74:75], v11 offset:11840
s_barrier
v_add_u32 v10, 57856, v9
s_waitcnt vmcnt(6) lgkmcnt(12)
v_mfma_f32_32x32x16_bf16 v[108:123], v[48:51], v[104:107], v[108:123]
ds_read_b64_tr_b16 v[20:21], v10 offset:0
ds_read_b64_tr_b16 v[22:23], v10 offset:896
s_waitcnt lgkmcnt(12)
v_mfma_f32_32x32x16_bf16 v[124:139], v[52:55], v[104:107], v[124:139]
ds_read_b64_tr_b16 v[24:25], v10 offset:32
ds_read_b64_tr_b16 v[26:27], v10 offset:928
s_waitcnt lgkmcnt(12)
v_mfma_f32_32x32x16_bf16 v[140:155], v[56:59], v[104:107], v[140:155]
ds_read_b64_tr_b16 v[28:29], v10 offset:64
ds_read_b64_tr_b16 v[30:31], v10 offset:960
s_waitcnt lgkmcnt(12)
v_mfma_f32_32x32x16_bf16 v[156:171], v[60:63], v[104:107], v[156:171]
ds_read_b64_tr_b16 v[32:33], v10 offset:96
ds_read_b64_tr_b16 v[34:35], v10 offset:992
s_waitcnt lgkmcnt(12)
v_mfma_f32_32x32x16_bf16 v[172:187], v[64:67], v[104:107], v[172:187]
ds_read_b64_tr_b16 v[36:37], v10 offset:128
ds_read_b64_tr_b16 v[38:39], v10 offset:1024
s_waitcnt lgkmcnt(12)
v_mfma_f32_32x32x16_bf16 v[188:203], v[68:71], v[104:107], v[188:203]
ds_read_b64_tr_b16 v[40:41], v10 offset:160
ds_read_b64_tr_b16 v[42:43], v10 offset:1056
s_waitcnt lgkmcnt(12)
v_mfma_f32_32x32x16_bf16 v[204:219], v[72:75], v[104:107], v[204:219]
s_mov_b32 s60, 79872
buffer_load_dwordx4 v[100:103], v3, s[40:43], s60 offen
ds_read_b64_tr_b16 v[44:45], v10 offset:192
ds_read_b64_tr_b16 v[46:47], v10 offset:1088
s_waitcnt vmcnt(6) lgkmcnt(12)
v_mfma_f32_32x32x16_bf16 v[108:123], v[20:23], v[76:79], v[108:123]
ds_read_b64_tr_b16 v[48:49], v10 offset:3584
ds_read_b64_tr_b16 v[50:51], v10 offset:4480
s_waitcnt lgkmcnt(12)
v_mfma_f32_32x32x16_bf16 v[124:139], v[24:27], v[76:79], v[124:139]
ds_read_b64_tr_b16 v[52:53], v10 offset:3616
ds_read_b64_tr_b16 v[54:55], v10 offset:4512
s_waitcnt lgkmcnt(12)
v_mfma_f32_32x32x16_bf16 v[140:155], v[28:31], v[76:79], v[140:155]
ds_read_b64_tr_b16 v[56:57], v10 offset:3648
ds_read_b64_tr_b16 v[58:59], v10 offset:4544
s_waitcnt lgkmcnt(12)
v_mfma_f32_32x32x16_bf16 v[156:171], v[32:35], v[76:79], v[156:171]
ds_read_b64_tr_b16 v[60:61], v10 offset:3680
ds_read_b64_tr_b16 v[62:63], v10 offset:4576
s_waitcnt lgkmcnt(12)
v_mfma_f32_32x32x16_bf16 v[172:187], v[36:39], v[76:79], v[172:187]
ds_read_b64_tr_b16 v[64:65], v10 offset:3712
ds_read_b64_tr_b16 v[66:67], v10 offset:4608
s_waitcnt lgkmcnt(12)
v_mfma_f32_32x32x16_bf16 v[188:203], v[40:43], v[76:79], v[188:203]
ds_read_b64_tr_b16 v[68:69], v10 offset:3744
ds_read_b64_tr_b16 v[70:71], v10 offset:4640
s_waitcnt lgkmcnt(12)
v_mfma_f32_32x32x16_bf16 v[204:219], v[44:47], v[76:79], v[204:219]
s_mov_b32 s60, 80896
buffer_load_dwordx4 v[104:107], v3, s[40:43], s60 offen
ds_read_b64_tr_b16 v[72:73], v10 offset:3776
ds_read_b64_tr_b16 v[74:75], v10 offset:4672
s_waitcnt vmcnt(6) lgkmcnt(12)
v_mfma_f32_32x32x16_bf16 v[108:123], v[48:51], v[80:83], v[108:123]
ds_read_b64_tr_b16 v[20:21], v10 offset:7168
ds_read_b64_tr_b16 v[22:23], v10 offset:8064
s_waitcnt lgkmcnt(12)
v_mfma_f32_32x32x16_bf16 v[124:139], v[52:55], v[80:83], v[124:139]
ds_read_b64_tr_b16 v[24:25], v10 offset:7200
ds_read_b64_tr_b16 v[26:27], v10 offset:8096
s_waitcnt lgkmcnt(12)
v_mfma_f32_32x32x16_bf16 v[140:155], v[56:59], v[80:83], v[140:155]
ds_read_b64_tr_b16 v[28:29], v10 offset:7232
ds_read_b64_tr_b16 v[30:31], v10 offset:8128
s_waitcnt lgkmcnt(12)
v_mfma_f32_32x32x16_bf16 v[156:171], v[60:63], v[80:83], v[156:171]
ds_read_b64_tr_b16 v[32:33], v10 offset:7264
ds_read_b64_tr_b16 v[34:35], v10 offset:8160
s_waitcnt lgkmcnt(12)
v_mfma_f32_32x32x16_bf16 v[172:187], v[64:67], v[80:83], v[172:187]
ds_read_b64_tr_b16 v[36:37], v10 offset:7296
ds_read_b64_tr_b16 v[38:39], v10 offset:8192
s_waitcnt lgkmcnt(12)
v_mfma_f32_32x32x16_bf16 v[188:203], v[68:71], v[80:83], v[188:203]
ds_read_b64_tr_b16 v[40:41], v10 offset:7328
ds_read_b64_tr_b16 v[42:43], v10 offset:8224
s_waitcnt lgkmcnt(12)
v_mfma_f32_32x32x16_bf16 v[204:219], v[72:75], v[80:83], v[204:219]
s_mov_b32 s60, 81920
buffer_load_dwordx4 v[76:79], v3, s[40:43], s60 offen
ds_read_b64_tr_b16 v[44:45], v10 offset:7360
ds_read_b64_tr_b16 v[46:47], v10 offset:8256
s_waitcnt vmcnt(6) lgkmcnt(12)
v_mfma_f32_32x32x16_bf16 v[108:123], v[20:23], v[84:87], v[108:123]
ds_read_b64_tr_b16 v[48:49], v10 offset:10752
ds_read_b64_tr_b16 v[50:51], v10 offset:11648
s_waitcnt lgkmcnt(12)
v_mfma_f32_32x32x16_bf16 v[124:139], v[24:27], v[84:87], v[124:139]
ds_read_b64_tr_b16 v[52:53], v10 offset:10784
ds_read_b64_tr_b16 v[54:55], v10 offset:11680
s_waitcnt lgkmcnt(12)
v_mfma_f32_32x32x16_bf16 v[140:155], v[28:31], v[84:87], v[140:155]
ds_read_b64_tr_b16 v[56:57], v10 offset:10816
ds_read_b64_tr_b16 v[58:59], v10 offset:11712
s_waitcnt lgkmcnt(12)
v_mfma_f32_32x32x16_bf16 v[156:171], v[32:35], v[84:87], v[156:171]
ds_read_b64_tr_b16 v[60:61], v10 offset:10848
ds_read_b64_tr_b16 v[62:63], v10 offset:11744
s_waitcnt lgkmcnt(12)
v_mfma_f32_32x32x16_bf16 v[172:187], v[36:39], v[84:87], v[172:187]
ds_read_b64_tr_b16 v[64:65], v10 offset:10880
ds_read_b64_tr_b16 v[66:67], v10 offset:11776
s_waitcnt lgkmcnt(12)
v_mfma_f32_32x32x16_bf16 v[188:203], v[40:43], v[84:87], v[188:203]
ds_read_b64_tr_b16 v[68:69], v10 offset:10912
ds_read_b64_tr_b16 v[70:71], v10 offset:11808
s_waitcnt lgkmcnt(12)
v_mfma_f32_32x32x16_bf16 v[204:219], v[44:47], v[84:87], v[204:219]
s_mov_b32 s60, 82944
buffer_load_dwordx4 v[80:83], v3, s[40:43], s60 offen
ds_read_b64_tr_b16 v[72:73], v10 offset:10944
ds_read_b64_tr_b16 v[74:75], v10 offset:11840
s_barrier
v_add_u32 v11, 86784, v9
s_waitcnt vmcnt(6) lgkmcnt(12)
v_mfma_f32_32x32x16_bf16 v[108:123], v[48:51], v[88:91], v[108:123]
ds_read_b64_tr_b16 v[20:21], v11 offset:0
ds_read_b64_tr_b16 v[22:23], v11 offset:896
s_waitcnt lgkmcnt(12)
v_mfma_f32_32x32x16_bf16 v[124:139], v[52:55], v[88:91], v[124:139]
ds_read_b64_tr_b16 v[24:25], v11 offset:32
ds_read_b64_tr_b16 v[26:27], v11 offset:928
s_waitcnt lgkmcnt(12)
v_mfma_f32_32x32x16_bf16 v[140:155], v[56:59], v[88:91], v[140:155]
ds_read_b64_tr_b16 v[28:29], v11 offset:64
ds_read_b64_tr_b16 v[30:31], v11 offset:960
s_waitcnt lgkmcnt(12)
v_mfma_f32_32x32x16_bf16 v[156:171], v[60:63], v[88:91], v[156:171]
ds_read_b64_tr_b16 v[32:33], v11 offset:96
ds_read_b64_tr_b16 v[34:35], v11 offset:992
s_waitcnt lgkmcnt(12)
v_mfma_f32_32x32x16_bf16 v[172:187], v[64:67], v[88:91], v[172:187]
ds_read_b64_tr_b16 v[36:37], v11 offset:128
ds_read_b64_tr_b16 v[38:39], v11 offset:1024
s_waitcnt lgkmcnt(12)
v_mfma_f32_32x32x16_bf16 v[188:203], v[68:71], v[88:91], v[188:203]
ds_read_b64_tr_b16 v[40:41], v11 offset:160
ds_read_b64_tr_b16 v[42:43], v11 offset:1056
s_waitcnt lgkmcnt(12)
v_mfma_f32_32x32x16_bf16 v[204:219], v[72:75], v[88:91], v[204:219]
s_mov_b32 s60, 83968
buffer_load_dwordx4 v[84:87], v3, s[40:43], s60 offen
ds_read_b64_tr_b16 v[44:45], v11 offset:192
ds_read_b64_tr_b16 v[46:47], v11 offset:1088
s_waitcnt vmcnt(6) lgkmcnt(12)
v_mfma_f32_32x32x16_bf16 v[108:123], v[20:23], v[92:95], v[108:123]
ds_read_b64_tr_b16 v[48:49], v11 offset:3584
ds_read_b64_tr_b16 v[50:51], v11 offset:4480
s_waitcnt lgkmcnt(12)
v_mfma_f32_32x32x16_bf16 v[124:139], v[24:27], v[92:95], v[124:139]
ds_read_b64_tr_b16 v[52:53], v11 offset:3616
ds_read_b64_tr_b16 v[54:55], v11 offset:4512
s_waitcnt lgkmcnt(12)
v_mfma_f32_32x32x16_bf16 v[140:155], v[28:31], v[92:95], v[140:155]
ds_read_b64_tr_b16 v[56:57], v11 offset:3648
ds_read_b64_tr_b16 v[58:59], v11 offset:4544
s_waitcnt lgkmcnt(12)
v_mfma_f32_32x32x16_bf16 v[156:171], v[32:35], v[92:95], v[156:171]
ds_read_b64_tr_b16 v[60:61], v11 offset:3680
ds_read_b64_tr_b16 v[62:63], v11 offset:4576
s_waitcnt lgkmcnt(12)
v_mfma_f32_32x32x16_bf16 v[172:187], v[36:39], v[92:95], v[172:187]
ds_read_b64_tr_b16 v[64:65], v11 offset:3712
ds_read_b64_tr_b16 v[66:67], v11 offset:4608
s_waitcnt lgkmcnt(12)
v_mfma_f32_32x32x16_bf16 v[188:203], v[40:43], v[92:95], v[188:203]
ds_read_b64_tr_b16 v[68:69], v11 offset:3744
ds_read_b64_tr_b16 v[70:71], v11 offset:4640
s_waitcnt lgkmcnt(12)
v_mfma_f32_32x32x16_bf16 v[204:219], v[44:47], v[92:95], v[204:219]
s_mov_b32 s60, 84992
buffer_load_dwordx4 v[88:91], v3, s[40:43], s60 offen
ds_read_b64_tr_b16 v[72:73], v11 offset:3776
ds_read_b64_tr_b16 v[74:75], v11 offset:4672
s_waitcnt vmcnt(6) lgkmcnt(12)
v_mfma_f32_32x32x16_bf16 v[108:123], v[48:51], v[96:99], v[108:123]
ds_read_b64_tr_b16 v[20:21], v11 offset:7168
ds_read_b64_tr_b16 v[22:23], v11 offset:8064
s_waitcnt lgkmcnt(12)
v_mfma_f32_32x32x16_bf16 v[124:139], v[52:55], v[96:99], v[124:139]
ds_read_b64_tr_b16 v[24:25], v11 offset:7200
ds_read_b64_tr_b16 v[26:27], v11 offset:8096
s_waitcnt lgkmcnt(12)
v_mfma_f32_32x32x16_bf16 v[140:155], v[56:59], v[96:99], v[140:155]
ds_read_b64_tr_b16 v[28:29], v11 offset:7232
ds_read_b64_tr_b16 v[30:31], v11 offset:8128
s_waitcnt lgkmcnt(12)
v_mfma_f32_32x32x16_bf16 v[156:171], v[60:63], v[96:99], v[156:171]
ds_read_b64_tr_b16 v[32:33], v11 offset:7264
ds_read_b64_tr_b16 v[34:35], v11 offset:8160
s_waitcnt lgkmcnt(12)
v_mfma_f32_32x32x16_bf16 v[172:187], v[64:67], v[96:99], v[172:187]
ds_read_b64_tr_b16 v[36:37], v11 offset:7296
ds_read_b64_tr_b16 v[38:39], v11 offset:8192
s_waitcnt lgkmcnt(12)
v_mfma_f32_32x32x16_bf16 v[188:203], v[68:71], v[96:99], v[188:203]
ds_read_b64_tr_b16 v[40:41], v11 offset:7328
ds_read_b64_tr_b16 v[42:43], v11 offset:8224
s_waitcnt lgkmcnt(12)
v_mfma_f32_32x32x16_bf16 v[204:219], v[72:75], v[96:99], v[204:219]
s_mov_b32 s60, 86016
buffer_load_dwordx4 v[92:95], v3, s[40:43], s60 offen
ds_read_b64_tr_b16 v[44:45], v11 offset:7360
ds_read_b64_tr_b16 v[46:47], v11 offset:8256
s_waitcnt vmcnt(6) lgkmcnt(12)
v_mfma_f32_32x32x16_bf16 v[108:123], v[20:23], v[100:103], v[108:123]
ds_read_b64_tr_b16 v[48:49], v11 offset:10752
ds_read_b64_tr_b16 v[50:51], v11 offset:11648
s_waitcnt lgkmcnt(12)
v_mfma_f32_32x32x16_bf16 v[124:139], v[24:27], v[100:103], v[124:139]
ds_read_b64_tr_b16 v[52:53], v11 offset:10784
ds_read_b64_tr_b16 v[54:55], v11 offset:11680
s_waitcnt lgkmcnt(12)
v_mfma_f32_32x32x16_bf16 v[140:155], v[28:31], v[100:103], v[140:155]
ds_read_b64_tr_b16 v[56:57], v11 offset:10816
ds_read_b64_tr_b16 v[58:59], v11 offset:11712
s_waitcnt lgkmcnt(12)
v_mfma_f32_32x32x16_bf16 v[156:171], v[32:35], v[100:103], v[156:171]
ds_read_b64_tr_b16 v[60:61], v11 offset:10848
ds_read_b64_tr_b16 v[62:63], v11 offset:11744
s_waitcnt lgkmcnt(12)
v_mfma_f32_32x32x16_bf16 v[172:187], v[36:39], v[100:103], v[172:187]
ds_read_b64_tr_b16 v[64:65], v11 offset:10880
ds_read_b64_tr_b16 v[66:67], v11 offset:11776
s_waitcnt lgkmcnt(12)
v_mfma_f32_32x32x16_bf16 v[188:203], v[40:43], v[100:103], v[188:203]
ds_read_b64_tr_b16 v[68:69], v11 offset:10912
ds_read_b64_tr_b16 v[70:71], v11 offset:11808
s_waitcnt lgkmcnt(12)
v_mfma_f32_32x32x16_bf16 v[204:219], v[44:47], v[100:103], v[204:219]
s_mov_b32 s60, 87040
buffer_load_dwordx4 v[96:99], v3, s[40:43], s60 offen
ds_read_b64_tr_b16 v[72:73], v11 offset:10944
ds_read_b64_tr_b16 v[74:75], v11 offset:11840
s_barrier
v_add_u32 v10, 115712, v9
s_waitcnt vmcnt(6) lgkmcnt(12)
v_mfma_f32_32x32x16_bf16 v[108:123], v[48:51], v[104:107], v[108:123]
ds_read_b64_tr_b16 v[20:21], v10 offset:0
ds_read_b64_tr_b16 v[22:23], v10 offset:896
s_waitcnt lgkmcnt(12)
v_mfma_f32_32x32x16_bf16 v[124:139], v[52:55], v[104:107], v[124:139]
ds_read_b64_tr_b16 v[24:25], v10 offset:32
ds_read_b64_tr_b16 v[26:27], v10 offset:928
s_waitcnt lgkmcnt(12)
v_mfma_f32_32x32x16_bf16 v[140:155], v[56:59], v[104:107], v[140:155]
ds_read_b64_tr_b16 v[28:29], v10 offset:64
ds_read_b64_tr_b16 v[30:31], v10 offset:960
s_waitcnt lgkmcnt(12)
v_mfma_f32_32x32x16_bf16 v[156:171], v[60:63], v[104:107], v[156:171]
ds_read_b64_tr_b16 v[32:33], v10 offset:96
ds_read_b64_tr_b16 v[34:35], v10 offset:992
s_waitcnt lgkmcnt(12)
v_mfma_f32_32x32x16_bf16 v[172:187], v[64:67], v[104:107], v[172:187]
ds_read_b64_tr_b16 v[36:37], v10 offset:128
ds_read_b64_tr_b16 v[38:39], v10 offset:1024
s_waitcnt lgkmcnt(12)
v_mfma_f32_32x32x16_bf16 v[188:203], v[68:71], v[104:107], v[188:203]
ds_read_b64_tr_b16 v[40:41], v10 offset:160
ds_read_b64_tr_b16 v[42:43], v10 offset:1056
s_waitcnt lgkmcnt(12)
v_mfma_f32_32x32x16_bf16 v[204:219], v[72:75], v[104:107], v[204:219]
s_mov_b32 s60, 88064
buffer_load_dwordx4 v[100:103], v3, s[40:43], s60 offen
ds_read_b64_tr_b16 v[44:45], v10 offset:192
ds_read_b64_tr_b16 v[46:47], v10 offset:1088
s_waitcnt vmcnt(6) lgkmcnt(12)
v_mfma_f32_32x32x16_bf16 v[108:123], v[20:23], v[76:79], v[108:123]
ds_read_b64_tr_b16 v[48:49], v10 offset:3584
ds_read_b64_tr_b16 v[50:51], v10 offset:4480
s_waitcnt lgkmcnt(12)
v_mfma_f32_32x32x16_bf16 v[124:139], v[24:27], v[76:79], v[124:139]
ds_read_b64_tr_b16 v[52:53], v10 offset:3616
ds_read_b64_tr_b16 v[54:55], v10 offset:4512
s_waitcnt lgkmcnt(12)
v_mfma_f32_32x32x16_bf16 v[140:155], v[28:31], v[76:79], v[140:155]
ds_read_b64_tr_b16 v[56:57], v10 offset:3648
ds_read_b64_tr_b16 v[58:59], v10 offset:4544
s_waitcnt lgkmcnt(12)
v_mfma_f32_32x32x16_bf16 v[156:171], v[32:35], v[76:79], v[156:171]
ds_read_b64_tr_b16 v[60:61], v10 offset:3680
ds_read_b64_tr_b16 v[62:63], v10 offset:4576
s_waitcnt lgkmcnt(12)
v_mfma_f32_32x32x16_bf16 v[172:187], v[36:39], v[76:79], v[172:187]
ds_read_b64_tr_b16 v[64:65], v10 offset:3712
ds_read_b64_tr_b16 v[66:67], v10 offset:4608
s_waitcnt lgkmcnt(12)
v_mfma_f32_32x32x16_bf16 v[188:203], v[40:43], v[76:79], v[188:203]
ds_read_b64_tr_b16 v[68:69], v10 offset:3744
ds_read_b64_tr_b16 v[70:71], v10 offset:4640
s_waitcnt lgkmcnt(12)
v_mfma_f32_32x32x16_bf16 v[204:219], v[44:47], v[76:79], v[204:219]
s_mov_b32 s60, 89088
buffer_load_dwordx4 v[104:107], v3, s[40:43], s60 offen
ds_read_b64_tr_b16 v[72:73], v10 offset:3776
ds_read_b64_tr_b16 v[74:75], v10 offset:4672
s_waitcnt vmcnt(6) lgkmcnt(12)
v_mfma_f32_32x32x16_bf16 v[108:123], v[48:51], v[80:83], v[108:123]
ds_read_b64_tr_b16 v[20:21], v10 offset:7168
ds_read_b64_tr_b16 v[22:23], v10 offset:8064
s_waitcnt lgkmcnt(12)
v_mfma_f32_32x32x16_bf16 v[124:139], v[52:55], v[80:83], v[124:139]
ds_read_b64_tr_b16 v[24:25], v10 offset:7200
ds_read_b64_tr_b16 v[26:27], v10 offset:8096
s_waitcnt lgkmcnt(12)
v_mfma_f32_32x32x16_bf16 v[140:155], v[56:59], v[80:83], v[140:155]
ds_read_b64_tr_b16 v[28:29], v10 offset:7232
ds_read_b64_tr_b16 v[30:31], v10 offset:8128
s_waitcnt lgkmcnt(12)
v_mfma_f32_32x32x16_bf16 v[156:171], v[60:63], v[80:83], v[156:171]
ds_read_b64_tr_b16 v[32:33], v10 offset:7264
ds_read_b64_tr_b16 v[34:35], v10 offset:8160
s_waitcnt lgkmcnt(12)
v_mfma_f32_32x32x16_bf16 v[172:187], v[64:67], v[80:83], v[172:187]
ds_read_b64_tr_b16 v[36:37], v10 offset:7296
ds_read_b64_tr_b16 v[38:39], v10 offset:8192
s_waitcnt lgkmcnt(12)
v_mfma_f32_32x32x16_bf16 v[188:203], v[68:71], v[80:83], v[188:203]
ds_read_b64_tr_b16 v[40:41], v10 offset:7328
ds_read_b64_tr_b16 v[42:43], v10 offset:8224
s_waitcnt lgkmcnt(12)
v_mfma_f32_32x32x16_bf16 v[204:219], v[72:75], v[80:83], v[204:219]
s_mov_b32 s60, 90112
buffer_load_dwordx4 v[76:79], v3, s[40:43], s60 offen
ds_read_b64_tr_b16 v[44:45], v10 offset:7360
ds_read_b64_tr_b16 v[46:47], v10 offset:8256
s_waitcnt vmcnt(6) lgkmcnt(12)
v_mfma_f32_32x32x16_bf16 v[108:123], v[20:23], v[84:87], v[108:123]
ds_read_b64_tr_b16 v[48:49], v10 offset:10752
ds_read_b64_tr_b16 v[50:51], v10 offset:11648
s_waitcnt lgkmcnt(12)
v_mfma_f32_32x32x16_bf16 v[124:139], v[24:27], v[84:87], v[124:139]
ds_read_b64_tr_b16 v[52:53], v10 offset:10784
ds_read_b64_tr_b16 v[54:55], v10 offset:11680
s_waitcnt lgkmcnt(12)
v_mfma_f32_32x32x16_bf16 v[140:155], v[28:31], v[84:87], v[140:155]
ds_read_b64_tr_b16 v[56:57], v10 offset:10816
ds_read_b64_tr_b16 v[58:59], v10 offset:11712
s_waitcnt lgkmcnt(12)
v_mfma_f32_32x32x16_bf16 v[156:171], v[32:35], v[84:87], v[156:171]
ds_read_b64_tr_b16 v[60:61], v10 offset:10848
ds_read_b64_tr_b16 v[62:63], v10 offset:11744
s_waitcnt lgkmcnt(12)
v_mfma_f32_32x32x16_bf16 v[172:187], v[36:39], v[84:87], v[172:187]
ds_read_b64_tr_b16 v[64:65], v10 offset:10880
ds_read_b64_tr_b16 v[66:67], v10 offset:11776
s_waitcnt lgkmcnt(12)
v_mfma_f32_32x32x16_bf16 v[188:203], v[40:43], v[84:87], v[188:203]
ds_read_b64_tr_b16 v[68:69], v10 offset:10912
ds_read_b64_tr_b16 v[70:71], v10 offset:11808
s_waitcnt lgkmcnt(12)
v_mfma_f32_32x32x16_bf16 v[204:219], v[44:47], v[84:87], v[204:219]
s_mov_b32 s60, 91136
buffer_load_dwordx4 v[80:83], v3, s[40:43], s60 offen
ds_read_b64_tr_b16 v[72:73], v10 offset:10944
ds_read_b64_tr_b16 v[74:75], v10 offset:11840
s_barrier
v_add_u32 v11, 0, v9
s_waitcnt vmcnt(6) lgkmcnt(12)
v_mfma_f32_32x32x16_bf16 v[108:123], v[48:51], v[88:91], v[108:123]
ds_read_b64_tr_b16 v[20:21], v11 offset:0
ds_read_b64_tr_b16 v[22:23], v11 offset:896
s_waitcnt lgkmcnt(12)
v_mfma_f32_32x32x16_bf16 v[124:139], v[52:55], v[88:91], v[124:139]
ds_read_b64_tr_b16 v[24:25], v11 offset:32
ds_read_b64_tr_b16 v[26:27], v11 offset:928
s_waitcnt lgkmcnt(12)
v_mfma_f32_32x32x16_bf16 v[140:155], v[56:59], v[88:91], v[140:155]
ds_read_b64_tr_b16 v[28:29], v11 offset:64
ds_read_b64_tr_b16 v[30:31], v11 offset:960
s_waitcnt lgkmcnt(12)
v_mfma_f32_32x32x16_bf16 v[156:171], v[60:63], v[88:91], v[156:171]
ds_read_b64_tr_b16 v[32:33], v11 offset:96
ds_read_b64_tr_b16 v[34:35], v11 offset:992
s_waitcnt lgkmcnt(12)
v_mfma_f32_32x32x16_bf16 v[172:187], v[64:67], v[88:91], v[172:187]
ds_read_b64_tr_b16 v[36:37], v11 offset:128
ds_read_b64_tr_b16 v[38:39], v11 offset:1024
s_waitcnt lgkmcnt(12)
v_mfma_f32_32x32x16_bf16 v[188:203], v[68:71], v[88:91], v[188:203]
ds_read_b64_tr_b16 v[40:41], v11 offset:160
ds_read_b64_tr_b16 v[42:43], v11 offset:1056
s_waitcnt lgkmcnt(12)
v_mfma_f32_32x32x16_bf16 v[204:219], v[72:75], v[88:91], v[204:219]
s_mov_b32 s60, 92160
buffer_load_dwordx4 v[84:87], v3, s[40:43], s60 offen
ds_read_b64_tr_b16 v[44:45], v11 offset:192
ds_read_b64_tr_b16 v[46:47], v11 offset:1088
s_waitcnt vmcnt(6) lgkmcnt(12)
v_mfma_f32_32x32x16_bf16 v[108:123], v[20:23], v[92:95], v[108:123]
ds_read_b64_tr_b16 v[48:49], v11 offset:3584
ds_read_b64_tr_b16 v[50:51], v11 offset:4480
s_waitcnt lgkmcnt(12)
v_mfma_f32_32x32x16_bf16 v[124:139], v[24:27], v[92:95], v[124:139]
ds_read_b64_tr_b16 v[52:53], v11 offset:3616
ds_read_b64_tr_b16 v[54:55], v11 offset:4512
s_waitcnt lgkmcnt(12)
v_mfma_f32_32x32x16_bf16 v[140:155], v[28:31], v[92:95], v[140:155]
ds_read_b64_tr_b16 v[56:57], v11 offset:3648
ds_read_b64_tr_b16 v[58:59], v11 offset:4544
s_waitcnt lgkmcnt(12)
v_mfma_f32_32x32x16_bf16 v[156:171], v[32:35], v[92:95], v[156:171]
ds_read_b64_tr_b16 v[60:61], v11 offset:3680
ds_read_b64_tr_b16 v[62:63], v11 offset:4576
s_waitcnt lgkmcnt(12)
v_mfma_f32_32x32x16_bf16 v[172:187], v[36:39], v[92:95], v[172:187]
ds_read_b64_tr_b16 v[64:65], v11 offset:3712
ds_read_b64_tr_b16 v[66:67], v11 offset:4608
s_waitcnt lgkmcnt(12)
v_mfma_f32_32x32x16_bf16 v[188:203], v[40:43], v[92:95], v[188:203]
ds_read_b64_tr_b16 v[68:69], v11 offset:3744
ds_read_b64_tr_b16 v[70:71], v11 offset:4640
s_waitcnt lgkmcnt(12)
v_mfma_f32_32x32x16_bf16 v[204:219], v[44:47], v[92:95], v[204:219]
s_mov_b32 s60, 93184
buffer_load_dwordx4 v[88:91], v3, s[40:43], s60 offen
ds_read_b64_tr_b16 v[72:73], v11 offset:3776
ds_read_b64_tr_b16 v[74:75], v11 offset:4672
s_waitcnt vmcnt(6) lgkmcnt(12)
v_mfma_f32_32x32x16_bf16 v[108:123], v[48:51], v[96:99], v[108:123]
ds_read_b64_tr_b16 v[20:21], v11 offset:7168
ds_read_b64_tr_b16 v[22:23], v11 offset:8064
s_waitcnt lgkmcnt(12)
v_mfma_f32_32x32x16_bf16 v[124:139], v[52:55], v[96:99], v[124:139]
ds_read_b64_tr_b16 v[24:25], v11 offset:7200
ds_read_b64_tr_b16 v[26:27], v11 offset:8096
s_waitcnt lgkmcnt(12)
v_mfma_f32_32x32x16_bf16 v[140:155], v[56:59], v[96:99], v[140:155]
ds_read_b64_tr_b16 v[28:29], v11 offset:7232
ds_read_b64_tr_b16 v[30:31], v11 offset:8128
s_waitcnt lgkmcnt(12)
v_mfma_f32_32x32x16_bf16 v[156:171], v[60:63], v[96:99], v[156:171]
ds_read_b64_tr_b16 v[32:33], v11 offset:7264
ds_read_b64_tr_b16 v[34:35], v11 offset:8160
s_waitcnt lgkmcnt(12)
v_mfma_f32_32x32x16_bf16 v[172:187], v[64:67], v[96:99], v[172:187]
ds_read_b64_tr_b16 v[36:37], v11 offset:7296
ds_read_b64_tr_b16 v[38:39], v11 offset:8192
s_waitcnt lgkmcnt(12)
v_mfma_f32_32x32x16_bf16 v[188:203], v[68:71], v[96:99], v[188:203]
ds_read_b64_tr_b16 v[40:41], v11 offset:7328
ds_read_b64_tr_b16 v[42:43], v11 offset:8224
s_waitcnt lgkmcnt(12)
v_mfma_f32_32x32x16_bf16 v[204:219], v[72:75], v[96:99], v[204:219]
s_mov_b32 s60, 94208
buffer_load_dwordx4 v[92:95], v3, s[40:43], s60 offen
ds_read_b64_tr_b16 v[44:45], v11 offset:7360
ds_read_b64_tr_b16 v[46:47], v11 offset:8256
s_waitcnt vmcnt(6) lgkmcnt(12)
v_mfma_f32_32x32x16_bf16 v[108:123], v[20:23], v[100:103], v[108:123]
ds_read_b64_tr_b16 v[48:49], v11 offset:10752
ds_read_b64_tr_b16 v[50:51], v11 offset:11648
s_waitcnt lgkmcnt(12)
v_mfma_f32_32x32x16_bf16 v[124:139], v[24:27], v[100:103], v[124:139]
ds_read_b64_tr_b16 v[52:53], v11 offset:10784
ds_read_b64_tr_b16 v[54:55], v11 offset:11680
s_waitcnt lgkmcnt(12)
v_mfma_f32_32x32x16_bf16 v[140:155], v[28:31], v[100:103], v[140:155]
ds_read_b64_tr_b16 v[56:57], v11 offset:10816
ds_read_b64_tr_b16 v[58:59], v11 offset:11712
s_waitcnt lgkmcnt(12)
v_mfma_f32_32x32x16_bf16 v[156:171], v[32:35], v[100:103], v[156:171]
ds_read_b64_tr_b16 v[60:61], v11 offset:10848
ds_read_b64_tr_b16 v[62:63], v11 offset:11744
s_waitcnt lgkmcnt(12)
v_mfma_f32_32x32x16_bf16 v[172:187], v[36:39], v[100:103], v[172:187]
ds_read_b64_tr_b16 v[64:65], v11 offset:10880
ds_read_b64_tr_b16 v[66:67], v11 offset:11776
s_waitcnt lgkmcnt(12)
v_mfma_f32_32x32x16_bf16 v[188:203], v[40:43], v[100:103], v[188:203]
ds_read_b64_tr_b16 v[68:69], v11 offset:10912
ds_read_b64_tr_b16 v[70:71], v11 offset:11808
s_waitcnt lgkmcnt(12)
v_mfma_f32_32x32x16_bf16 v[204:219], v[44:47], v[100:103], v[204:219]
s_mov_b32 s60, 95232
buffer_load_dwordx4 v[96:99], v3, s[40:43], s60 offen
ds_read_b64_tr_b16 v[72:73], v11 offset:10944
ds_read_b64_tr_b16 v[74:75], v11 offset:11840
s_barrier
v_add_u32 v10, 28928, v9
s_waitcnt vmcnt(6) lgkmcnt(12)
v_mfma_f32_32x32x16_bf16 v[108:123], v[48:51], v[104:107], v[108:123]
ds_read_b64_tr_b16 v[20:21], v10 offset:0
ds_read_b64_tr_b16 v[22:23], v10 offset:896
s_waitcnt lgkmcnt(12)
v_mfma_f32_32x32x16_bf16 v[124:139], v[52:55], v[104:107], v[124:139]
ds_read_b64_tr_b16 v[24:25], v10 offset:32
ds_read_b64_tr_b16 v[26:27], v10 offset:928
s_waitcnt lgkmcnt(12)
v_mfma_f32_32x32x16_bf16 v[140:155], v[56:59], v[104:107], v[140:155]
ds_read_b64_tr_b16 v[28:29], v10 offset:64
ds_read_b64_tr_b16 v[30:31], v10 offset:960
s_waitcnt lgkmcnt(12)
v_mfma_f32_32x32x16_bf16 v[156:171], v[60:63], v[104:107], v[156:171]
ds_read_b64_tr_b16 v[32:33], v10 offset:96
ds_read_b64_tr_b16 v[34:35], v10 offset:992
s_waitcnt lgkmcnt(12)
v_mfma_f32_32x32x16_bf16 v[172:187], v[64:67], v[104:107], v[172:187]
ds_read_b64_tr_b16 v[36:37], v10 offset:128
ds_read_b64_tr_b16 v[38:39], v10 offset:1024
s_waitcnt lgkmcnt(12)
v_mfma_f32_32x32x16_bf16 v[188:203], v[68:71], v[104:107], v[188:203]
ds_read_b64_tr_b16 v[40:41], v10 offset:160
ds_read_b64_tr_b16 v[42:43], v10 offset:1056
s_waitcnt lgkmcnt(12)
v_mfma_f32_32x32x16_bf16 v[204:219], v[72:75], v[104:107], v[204:219]
s_mov_b32 s60, 96256
buffer_load_dwordx4 v[100:103], v3, s[40:43], s60 offen
ds_read_b64_tr_b16 v[44:45], v10 offset:192
ds_read_b64_tr_b16 v[46:47], v10 offset:1088
s_waitcnt vmcnt(6) lgkmcnt(12)
v_mfma_f32_32x32x16_bf16 v[108:123], v[20:23], v[76:79], v[108:123]
ds_read_b64_tr_b16 v[48:49], v10 offset:3584
ds_read_b64_tr_b16 v[50:51], v10 offset:4480
s_waitcnt lgkmcnt(12)
v_mfma_f32_32x32x16_bf16 v[124:139], v[24:27], v[76:79], v[124:139]
ds_read_b64_tr_b16 v[52:53], v10 offset:3616
ds_read_b64_tr_b16 v[54:55], v10 offset:4512
s_waitcnt lgkmcnt(12)
v_mfma_f32_32x32x16_bf16 v[140:155], v[28:31], v[76:79], v[140:155]
ds_read_b64_tr_b16 v[56:57], v10 offset:3648
ds_read_b64_tr_b16 v[58:59], v10 offset:4544
s_waitcnt lgkmcnt(12)
v_mfma_f32_32x32x16_bf16 v[156:171], v[32:35], v[76:79], v[156:171]
ds_read_b64_tr_b16 v[60:61], v10 offset:3680
ds_read_b64_tr_b16 v[62:63], v10 offset:4576
s_waitcnt lgkmcnt(12)
v_mfma_f32_32x32x16_bf16 v[172:187], v[36:39], v[76:79], v[172:187]
ds_read_b64_tr_b16 v[64:65], v10 offset:3712
ds_read_b64_tr_b16 v[66:67], v10 offset:4608
s_waitcnt lgkmcnt(12)
v_mfma_f32_32x32x16_bf16 v[188:203], v[40:43], v[76:79], v[188:203]
ds_read_b64_tr_b16 v[68:69], v10 offset:3744
ds_read_b64_tr_b16 v[70:71], v10 offset:4640
s_waitcnt lgkmcnt(12)
v_mfma_f32_32x32x16_bf16 v[204:219], v[44:47], v[76:79], v[204:219]
s_mov_b32 s60, 97280
buffer_load_dwordx4 v[104:107], v3, s[40:43], s60 offen
ds_read_b64_tr_b16 v[72:73], v10 offset:3776
ds_read_b64_tr_b16 v[74:75], v10 offset:4672
s_waitcnt vmcnt(6) lgkmcnt(12)
v_mfma_f32_32x32x16_bf16 v[108:123], v[48:51], v[80:83], v[108:123]
ds_read_b64_tr_b16 v[20:21], v10 offset:7168
ds_read_b64_tr_b16 v[22:23], v10 offset:8064
s_waitcnt lgkmcnt(12)
v_mfma_f32_32x32x16_bf16 v[124:139], v[52:55], v[80:83], v[124:139]
ds_read_b64_tr_b16 v[24:25], v10 offset:7200
ds_read_b64_tr_b16 v[26:27], v10 offset:8096
s_waitcnt lgkmcnt(12)
v_mfma_f32_32x32x16_bf16 v[140:155], v[56:59], v[80:83], v[140:155]
ds_read_b64_tr_b16 v[28:29], v10 offset:7232
ds_read_b64_tr_b16 v[30:31], v10 offset:8128
s_waitcnt lgkmcnt(12)
v_mfma_f32_32x32x16_bf16 v[156:171], v[60:63], v[80:83], v[156:171]
ds_read_b64_tr_b16 v[32:33], v10 offset:7264
ds_read_b64_tr_b16 v[34:35], v10 offset:8160
s_waitcnt lgkmcnt(12)
v_mfma_f32_32x32x16_bf16 v[172:187], v[64:67], v[80:83], v[172:187]
ds_read_b64_tr_b16 v[36:37], v10 offset:7296
ds_read_b64_tr_b16 v[38:39], v10 offset:8192
s_waitcnt lgkmcnt(12)
v_mfma_f32_32x32x16_bf16 v[188:203], v[68:71], v[80:83], v[188:203]
ds_read_b64_tr_b16 v[40:41], v10 offset:7328
ds_read_b64_tr_b16 v[42:43], v10 offset:8224
s_waitcnt lgkmcnt(12)
v_mfma_f32_32x32x16_bf16 v[204:219], v[72:75], v[80:83], v[204:219]
ds_read_b64_tr_b16 v[44:45], v10 offset:7360
ds_read_b64_tr_b16 v[46:47], v10 offset:8256
s_waitcnt vmcnt(5) lgkmcnt(12)
v_mfma_f32_32x32x16_bf16 v[108:123], v[20:23], v[84:87], v[108:123]
ds_read_b64_tr_b16 v[48:49], v10 offset:10752
ds_read_b64_tr_b16 v[50:51], v10 offset:11648
s_waitcnt lgkmcnt(12)
v_mfma_f32_32x32x16_bf16 v[124:139], v[24:27], v[84:87], v[124:139]
ds_read_b64_tr_b16 v[52:53], v10 offset:10784
ds_read_b64_tr_b16 v[54:55], v10 offset:11680
s_waitcnt lgkmcnt(12)
v_mfma_f32_32x32x16_bf16 v[140:155], v[28:31], v[84:87], v[140:155]
ds_read_b64_tr_b16 v[56:57], v10 offset:10816
ds_read_b64_tr_b16 v[58:59], v10 offset:11712
s_waitcnt lgkmcnt(12)
v_mfma_f32_32x32x16_bf16 v[156:171], v[32:35], v[84:87], v[156:171]
ds_read_b64_tr_b16 v[60:61], v10 offset:10848
ds_read_b64_tr_b16 v[62:63], v10 offset:11744
s_waitcnt lgkmcnt(12)
v_mfma_f32_32x32x16_bf16 v[172:187], v[36:39], v[84:87], v[172:187]
ds_read_b64_tr_b16 v[64:65], v10 offset:10880
ds_read_b64_tr_b16 v[66:67], v10 offset:11776
s_waitcnt lgkmcnt(12)
v_mfma_f32_32x32x16_bf16 v[188:203], v[40:43], v[84:87], v[188:203]
ds_read_b64_tr_b16 v[68:69], v10 offset:10912
ds_read_b64_tr_b16 v[70:71], v10 offset:11808
s_waitcnt lgkmcnt(12)
v_mfma_f32_32x32x16_bf16 v[204:219], v[44:47], v[84:87], v[204:219]
ds_read_b64_tr_b16 v[72:73], v10 offset:10944
ds_read_b64_tr_b16 v[74:75], v10 offset:11840
s_barrier
v_add_u32 v11, 57856, v9
s_waitcnt vmcnt(4) lgkmcnt(12)
v_mfma_f32_32x32x16_bf16 v[108:123], v[48:51], v[88:91], v[108:123]
ds_read_b64_tr_b16 v[20:21], v11 offset:0
ds_read_b64_tr_b16 v[22:23], v11 offset:896
s_waitcnt lgkmcnt(12)
v_mfma_f32_32x32x16_bf16 v[124:139], v[52:55], v[88:91], v[124:139]
ds_read_b64_tr_b16 v[24:25], v11 offset:32
ds_read_b64_tr_b16 v[26:27], v11 offset:928
s_waitcnt lgkmcnt(12)
v_mfma_f32_32x32x16_bf16 v[140:155], v[56:59], v[88:91], v[140:155]
ds_read_b64_tr_b16 v[28:29], v11 offset:64
ds_read_b64_tr_b16 v[30:31], v11 offset:960
s_waitcnt lgkmcnt(12)
v_mfma_f32_32x32x16_bf16 v[156:171], v[60:63], v[88:91], v[156:171]
ds_read_b64_tr_b16 v[32:33], v11 offset:96
ds_read_b64_tr_b16 v[34:35], v11 offset:992
s_waitcnt lgkmcnt(12)
v_mfma_f32_32x32x16_bf16 v[172:187], v[64:67], v[88:91], v[172:187]
ds_read_b64_tr_b16 v[36:37], v11 offset:128
ds_read_b64_tr_b16 v[38:39], v11 offset:1024
s_waitcnt lgkmcnt(12)
v_mfma_f32_32x32x16_bf16 v[188:203], v[68:71], v[88:91], v[188:203]
ds_read_b64_tr_b16 v[40:41], v11 offset:160
ds_read_b64_tr_b16 v[42:43], v11 offset:1056
s_waitcnt lgkmcnt(12)
v_mfma_f32_32x32x16_bf16 v[204:219], v[72:75], v[88:91], v[204:219]
ds_read_b64_tr_b16 v[44:45], v11 offset:192
ds_read_b64_tr_b16 v[46:47], v11 offset:1088
s_waitcnt vmcnt(3) lgkmcnt(12)
v_mfma_f32_32x32x16_bf16 v[108:123], v[20:23], v[92:95], v[108:123]
ds_read_b64_tr_b16 v[48:49], v11 offset:3584
ds_read_b64_tr_b16 v[50:51], v11 offset:4480
s_waitcnt lgkmcnt(12)
v_mfma_f32_32x32x16_bf16 v[124:139], v[24:27], v[92:95], v[124:139]
ds_read_b64_tr_b16 v[52:53], v11 offset:3616
ds_read_b64_tr_b16 v[54:55], v11 offset:4512
s_waitcnt lgkmcnt(12)
v_mfma_f32_32x32x16_bf16 v[140:155], v[28:31], v[92:95], v[140:155]
ds_read_b64_tr_b16 v[56:57], v11 offset:3648
ds_read_b64_tr_b16 v[58:59], v11 offset:4544
s_waitcnt lgkmcnt(12)
v_mfma_f32_32x32x16_bf16 v[156:171], v[32:35], v[92:95], v[156:171]
ds_read_b64_tr_b16 v[60:61], v11 offset:3680
ds_read_b64_tr_b16 v[62:63], v11 offset:4576
s_waitcnt lgkmcnt(12)
v_mfma_f32_32x32x16_bf16 v[172:187], v[36:39], v[92:95], v[172:187]
ds_read_b64_tr_b16 v[64:65], v11 offset:3712
ds_read_b64_tr_b16 v[66:67], v11 offset:4608
s_waitcnt lgkmcnt(12)
v_mfma_f32_32x32x16_bf16 v[188:203], v[40:43], v[92:95], v[188:203]
ds_read_b64_tr_b16 v[68:69], v11 offset:3744
ds_read_b64_tr_b16 v[70:71], v11 offset:4640
s_waitcnt lgkmcnt(12)
v_mfma_f32_32x32x16_bf16 v[204:219], v[44:47], v[92:95], v[204:219]
ds_read_b64_tr_b16 v[72:73], v11 offset:3776
ds_read_b64_tr_b16 v[74:75], v11 offset:4672
s_waitcnt vmcnt(2) lgkmcnt(12)
v_mfma_f32_32x32x16_bf16 v[108:123], v[48:51], v[96:99], v[108:123]
ds_read_b64_tr_b16 v[20:21], v11 offset:7168
ds_read_b64_tr_b16 v[22:23], v11 offset:8064
s_waitcnt lgkmcnt(12)
v_mfma_f32_32x32x16_bf16 v[124:139], v[52:55], v[96:99], v[124:139]
ds_read_b64_tr_b16 v[24:25], v11 offset:7200
ds_read_b64_tr_b16 v[26:27], v11 offset:8096
s_waitcnt lgkmcnt(12)
v_mfma_f32_32x32x16_bf16 v[140:155], v[56:59], v[96:99], v[140:155]
ds_read_b64_tr_b16 v[28:29], v11 offset:7232
ds_read_b64_tr_b16 v[30:31], v11 offset:8128
s_waitcnt lgkmcnt(12)
v_mfma_f32_32x32x16_bf16 v[156:171], v[60:63], v[96:99], v[156:171]
ds_read_b64_tr_b16 v[32:33], v11 offset:7264
ds_read_b64_tr_b16 v[34:35], v11 offset:8160
s_waitcnt lgkmcnt(12)
v_mfma_f32_32x32x16_bf16 v[172:187], v[64:67], v[96:99], v[172:187]
ds_read_b64_tr_b16 v[36:37], v11 offset:7296
ds_read_b64_tr_b16 v[38:39], v11 offset:8192
s_waitcnt lgkmcnt(12)
v_mfma_f32_32x32x16_bf16 v[188:203], v[68:71], v[96:99], v[188:203]
ds_read_b64_tr_b16 v[40:41], v11 offset:7328
ds_read_b64_tr_b16 v[42:43], v11 offset:8224
s_waitcnt lgkmcnt(12)
v_mfma_f32_32x32x16_bf16 v[204:219], v[72:75], v[96:99], v[204:219]
ds_read_b64_tr_b16 v[44:45], v11 offset:7360
ds_read_b64_tr_b16 v[46:47], v11 offset:8256
s_waitcnt vmcnt(1) lgkmcnt(12)
v_mfma_f32_32x32x16_bf16 v[108:123], v[20:23], v[100:103], v[108:123]
ds_read_b64_tr_b16 v[48:49], v11 offset:10752
ds_read_b64_tr_b16 v[50:51], v11 offset:11648
s_waitcnt lgkmcnt(12)
v_mfma_f32_32x32x16_bf16 v[124:139], v[24:27], v[100:103], v[124:139]
ds_read_b64_tr_b16 v[52:53], v11 offset:10784
ds_read_b64_tr_b16 v[54:55], v11 offset:11680
s_waitcnt lgkmcnt(12)
v_mfma_f32_32x32x16_bf16 v[140:155], v[28:31], v[100:103], v[140:155]
ds_read_b64_tr_b16 v[56:57], v11 offset:10816
ds_read_b64_tr_b16 v[58:59], v11 offset:11712
s_waitcnt lgkmcnt(12)
v_mfma_f32_32x32x16_bf16 v[156:171], v[32:35], v[100:103], v[156:171]
ds_read_b64_tr_b16 v[60:61], v11 offset:10848
ds_read_b64_tr_b16 v[62:63], v11 offset:11744
s_waitcnt lgkmcnt(12)
v_mfma_f32_32x32x16_bf16 v[172:187], v[36:39], v[100:103], v[172:187]
ds_read_b64_tr_b16 v[64:65], v11 offset:10880
ds_read_b64_tr_b16 v[66:67], v11 offset:11776
s_waitcnt lgkmcnt(12)
v_mfma_f32_32x32x16_bf16 v[188:203], v[40:43], v[100:103], v[188:203]
ds_read_b64_tr_b16 v[68:69], v11 offset:10912
ds_read_b64_tr_b16 v[70:71], v11 offset:11808
s_waitcnt lgkmcnt(12)
v_mfma_f32_32x32x16_bf16 v[204:219], v[44:47], v[100:103], v[204:219]
ds_read_b64_tr_b16 v[72:73], v11 offset:10944
ds_read_b64_tr_b16 v[74:75], v11 offset:11840
s_waitcnt vmcnt(0) lgkmcnt(12)
v_mfma_f32_32x32x16_bf16 v[108:123], v[48:51], v[104:107], v[108:123]
s_waitcnt lgkmcnt(10)
v_mfma_f32_32x32x16_bf16 v[124:139], v[52:55], v[104:107], v[124:139]
s_waitcnt lgkmcnt(8)
v_mfma_f32_32x32x16_bf16 v[140:155], v[56:59], v[104:107], v[140:155]
s_waitcnt lgkmcnt(6)
v_mfma_f32_32x32x16_bf16 v[156:171], v[60:63], v[104:107], v[156:171]
s_waitcnt lgkmcnt(4)
v_mfma_f32_32x32x16_bf16 v[172:187], v[64:67], v[104:107], v[172:187]
s_waitcnt lgkmcnt(2)
v_mfma_f32_32x32x16_bf16 v[188:203], v[68:71], v[104:107], v[188:203]
s_waitcnt lgkmcnt(0)
v_mfma_f32_32x32x16_bf16 v[204:219], v[72:75], v[104:107], v[204:219]
s_barrier
v_and_b32 v222, 31, v1
v_lshlrev_b32 v222, 3, v222
v_add_u32 v222, 2560, v222
ds_read_b64 v[220:221], v222
v_lshlrev_b32 v225, 4, v5
v_add_u32 v225, 0, v225
ds_read_b128 v[20:23], v225 offset:0
ds_read_b128 v[24:27], v225 offset:32
ds_read_b128 v[28:31], v225 offset:64
ds_read_b128 v[32:35], v225 offset:96
s_waitcnt lgkmcnt(4)
v_mul_f32 v226, v221, v221
s_lshl_b32 s7, s4, 2
s_add_u32 s7, s7, 2
s_mul_i32 s8, s7, 112
s_mul_i32 s9, s5, 7
s_add_u32 s8, s8, s9
s_lshl_b32 s8, s8, 10
s_add_u32 s8, s8, 16777216
ds_read_b128 v[36:39], v225 offset:128
ds_read_b128 v[40:43], v225 offset:160
ds_read_b128 v[44:47], v225 offset:192
ds_read_b128 v[48:51], v225 offset:224
s_waitcnt lgkmcnt(7)
v_pk_fma_f32 v[108:109], v[20:21], v[220:221], v[108:109] op_sel_hi:[1,0,1]
v_pk_fma_f32 v[110:111], v[22:23], v[220:221], v[110:111] op_sel_hi:[1,0,1]
s_waitcnt lgkmcnt(6)
v_pk_fma_f32 v[112:113], v[24:25], v[220:221], v[112:113] op_sel_hi:[1,0,1]
v_pk_fma_f32 v[114:115], v[26:27], v[220:221], v[114:115] op_sel_hi:[1,0,1]
s_waitcnt lgkmcnt(5)
v_pk_fma_f32 v[116:117], v[28:29], v[220:221], v[116:117] op_sel_hi:[1,0,1]
v_pk_fma_f32 v[118:119], v[30:31], v[220:221], v[118:119] op_sel_hi:[1,0,1]
s_waitcnt lgkmcnt(4)
v_pk_fma_f32 v[120:121], v[32:33], v[220:221], v[120:121] op_sel_hi:[1,0,1]
v_pk_fma_f32 v[122:123], v[34:35], v[220:221], v[122:123] op_sel_hi:[1,0,1]
v_max_f32 v108, 0, v108
v_max_f32 v109, 0, v109
v_max_f32 v110, 0, v110
v_max_f32 v111, 0, v111
v_max_f32 v112, 0, v112
v_max_f32 v113, 0, v113
v_max_f32 v114, 0, v114
v_max_f32 v115, 0, v115
v_pk_mul_f32 v[108:109], v[108:109], v[116:117]
v_pk_mul_f32 v[110:111], v[110:111], v[118:119]
v_pk_mul_f32 v[112:113], v[112:113], v[120:121]
v_pk_mul_f32 v[114:115], v[114:115], v[122:123]
v_pk_mul_f32 v[108:109], v[108:109], v[226:227] op_sel_hi:[1,0]
v_pk_mul_f32 v[110:111], v[110:111], v[226:227] op_sel_hi:[1,0]
v_pk_mul_f32 v[112:113], v[112:113], v[226:227] op_sel_hi:[1,0]
v_pk_mul_f32 v[114:115], v[114:115], v[226:227] op_sel_hi:[1,0]
v_cvt_pk_bf16_f32 v52, v108, v109
v_cvt_pk_bf16_f32 v53, v110, v111
v_cvt_pk_bf16_f32 v54, v112, v113
v_cvt_pk_bf16_f32 v55, v114, v115
s_nop 0
v_permlane32_swap_b32 v52, v54
v_permlane32_swap_b32 v53, v55
buffer_store_dwordx4 v[52:55], v3, s[52:55], s8 offen offset:0
ds_read_b128 v[20:23], v225 offset:256
ds_read_b128 v[24:27], v225 offset:288
ds_read_b128 v[28:31], v225 offset:320
ds_read_b128 v[32:35], v225 offset:352
s_waitcnt lgkmcnt(7)
v_pk_fma_f32 v[124:125], v[36:37], v[220:221], v[124:125] op_sel_hi:[1,0,1]
v_pk_fma_f32 v[126:127], v[38:39], v[220:221], v[126:127] op_sel_hi:[1,0,1]
s_waitcnt lgkmcnt(6)
v_pk_fma_f32 v[128:129], v[40:41], v[220:221], v[128:129] op_sel_hi:[1,0,1]
v_pk_fma_f32 v[130:131], v[42:43], v[220:221], v[130:131] op_sel_hi:[1,0,1]
s_waitcnt lgkmcnt(5)
v_pk_fma_f32 v[132:133], v[44:45], v[220:221], v[132:133] op_sel_hi:[1,0,1]
v_pk_fma_f32 v[134:135], v[46:47], v[220:221], v[134:135] op_sel_hi:[1,0,1]
s_waitcnt lgkmcnt(4)
v_pk_fma_f32 v[136:137], v[48:49], v[220:221], v[136:137] op_sel_hi:[1,0,1]
v_pk_fma_f32 v[138:139], v[50:51], v[220:221], v[138:139] op_sel_hi:[1,0,1]
v_max_f32 v124, 0, v124
v_max_f32 v125, 0, v125
v_max_f32 v126, 0, v126
v_max_f32 v127, 0, v127
v_max_f32 v128, 0, v128
v_max_f32 v129, 0, v129
v_max_f32 v130, 0, v130
v_max_f32 v131, 0, v131
v_pk_mul_f32 v[124:125], v[124:125], v[132:133]
v_pk_mul_f32 v[126:127], v[126:127], v[134:135]
v_pk_mul_f32 v[128:129], v[128:129], v[136:137]
v_pk_mul_f32 v[130:131], v[130:131], v[138:139]
v_pk_mul_f32 v[124:125], v[124:125], v[226:227] op_sel_hi:[1,0]
v_pk_mul_f32 v[126:127], v[126:127], v[226:227] op_sel_hi:[1,0]
v_pk_mul_f32 v[128:129], v[128:129], v[226:227] op_sel_hi:[1,0]
v_pk_mul_f32 v[130:131], v[130:131], v[226:227] op_sel_hi:[1,0]
v_cvt_pk_bf16_f32 v56, v124, v125
v_cvt_pk_bf16_f32 v57, v126, v127
v_cvt_pk_bf16_f32 v58, v128, v129
v_cvt_pk_bf16_f32 v59, v130, v131
s_nop 0
v_permlane32_swap_b32 v56, v58
v_permlane32_swap_b32 v57, v59
buffer_store_dwordx4 v[56:59], v3, s[52:55], s8 offen offset:1024
ds_read_b128 v[36:39], v225 offset:384
ds_read_b128 v[40:43], v225 offset:416
ds_read_b128 v[44:47], v225 offset:448
ds_read_b128 v[48:51], v225 offset:480
s_waitcnt lgkmcnt(7)
v_pk_fma_f32 v[140:141], v[20:21], v[220:221], v[140:141] op_sel_hi:[1,0,1]
v_pk_fma_f32 v[142:143], v[22:23], v[220:221], v[142:143] op_sel_hi:[1,0,1]
s_waitcnt lgkmcnt(6)
v_pk_fma_f32 v[144:145], v[24:25], v[220:221], v[144:145] op_sel_hi:[1,0,1]
v_pk_fma_f32 v[146:147], v[26:27], v[220:221], v[146:147] op_sel_hi:[1,0,1]
s_waitcnt lgkmcnt(5)
v_pk_fma_f32 v[148:149], v[28:29], v[220:221], v[148:149] op_sel_hi:[1,0,1]
v_pk_fma_f32 v[150:151], v[30:31], v[220:221], v[150:151] op_sel_hi:[1,0,1]
s_waitcnt lgkmcnt(4)
v_pk_fma_f32 v[152:153], v[32:33], v[220:221], v[152:153] op_sel_hi:[1,0,1]
v_pk_fma_f32 v[154:155], v[34:35], v[220:221], v[154:155] op_sel_hi:[1,0,1]
v_max_f32 v140, 0, v140
v_max_f32 v141, 0, v141
v_max_f32 v142, 0, v142
v_max_f32 v143, 0, v143
v_max_f32 v144, 0, v144
v_max_f32 v145, 0, v145
v_max_f32 v146, 0, v146
v_max_f32 v147, 0, v147
v_pk_mul_f32 v[140:141], v[140:141], v[148:149]
v_pk_mul_f32 v[142:143], v[142:143], v[150:151]
v_pk_mul_f32 v[144:145], v[144:145], v[152:153]
v_pk_mul_f32 v[146:147], v[146:147], v[154:155]
v_pk_mul_f32 v[140:141], v[140:141], v[226:227] op_sel_hi:[1,0]
v_pk_mul_f32 v[142:143], v[142:143], v[226:227] op_sel_hi:[1,0]
v_pk_mul_f32 v[144:145], v[144:145], v[226:227] op_sel_hi:[1,0]
v_pk_mul_f32 v[146:147], v[146:147], v[226:227] op_sel_hi:[1,0]
v_cvt_pk_bf16_f32 v52, v140, v141
v_cvt_pk_bf16_f32 v53, v142, v143
v_cvt_pk_bf16_f32 v54, v144, v145
v_cvt_pk_bf16_f32 v55, v146, v147
s_nop 0
v_permlane32_swap_b32 v52, v54
v_permlane32_swap_b32 v53, v55
buffer_store_dwordx4 v[52:55], v3, s[52:55], s8 offen offset:2048
ds_read_b128 v[20:23], v225 offset:512
ds_read_b128 v[24:27], v225 offset:544
ds_read_b128 v[28:31], v225 offset:576
ds_read_b128 v[32:35], v225 offset:608
s_waitcnt lgkmcnt(7)
v_pk_fma_f32 v[156:157], v[36:37], v[220:221], v[156:157] op_sel_hi:[1,0,1]
v_pk_fma_f32 v[158:159], v[38:39], v[220:221], v[158:159] op_sel_hi:[1,0,1]
s_waitcnt lgkmcnt(6)
v_pk_fma_f32 v[160:161], v[40:41], v[220:221], v[160:161] op_sel_hi:[1,0,1]
v_pk_fma_f32 v[162:163], v[42:43], v[220:221], v[162:163] op_sel_hi:[1,0,1]
s_waitcnt lgkmcnt(5)
v_pk_fma_f32 v[164:165], v[44:45], v[220:221], v[164:165] op_sel_hi:[1,0,1]
v_pk_fma_f32 v[166:167], v[46:47], v[220:221], v[166:167] op_sel_hi:[1,0,1]
s_waitcnt lgkmcnt(4)
v_pk_fma_f32 v[168:169], v[48:49], v[220:221], v[168:169] op_sel_hi:[1,0,1]
v_pk_fma_f32 v[170:171], v[50:51], v[220:221], v[170:171] op_sel_hi:[1,0,1]
v_max_f32 v156, 0, v156
v_max_f32 v157, 0, v157
v_max_f32 v158, 0, v158
v_max_f32 v159, 0, v159
v_max_f32 v160, 0, v160
v_max_f32 v161, 0, v161
v_max_f32 v162, 0, v162
v_max_f32 v163, 0, v163
v_pk_mul_f32 v[156:157], v[156:157], v[164:165]
v_pk_mul_f32 v[158:159], v[158:159], v[166:167]
v_pk_mul_f32 v[160:161], v[160:161], v[168:169]
v_pk_mul_f32 v[162:163], v[162:163], v[170:171]
v_pk_mul_f32 v[156:157], v[156:157], v[226:227] op_sel_hi:[1,0]
v_pk_mul_f32 v[158:159], v[158:159], v[226:227] op_sel_hi:[1,0]
v_pk_mul_f32 v[160:161], v[160:161], v[226:227] op_sel_hi:[1,0]
v_pk_mul_f32 v[162:163], v[162:163], v[226:227] op_sel_hi:[1,0]
v_cvt_pk_bf16_f32 v56, v156, v157
v_cvt_pk_bf16_f32 v57, v158, v159
v_cvt_pk_bf16_f32 v58, v160, v161
v_cvt_pk_bf16_f32 v59, v162, v163
s_nop 0
v_permlane32_swap_b32 v56, v58
v_permlane32_swap_b32 v57, v59
buffer_store_dwordx4 v[56:59], v3, s[52:55], s8 offen offset:3072
ds_read_b128 v[36:39], v225 offset:640
ds_read_b128 v[40:43], v225 offset:672
ds_read_b128 v[44:47], v225 offset:704
ds_read_b128 v[48:51], v225 offset:736
s_waitcnt lgkmcnt(7)
v_pk_fma_f32 v[172:173], v[20:21], v[220:221], v[172:173] op_sel_hi:[1,0,1]
v_pk_fma_f32 v[174:175], v[22:23], v[220:221], v[174:175] op_sel_hi:[1,0,1]
s_waitcnt lgkmcnt(6)
v_pk_fma_f32 v[176:177], v[24:25], v[220:221], v[176:177] op_sel_hi:[1,0,1]
v_pk_fma_f32 v[178:179], v[26:27], v[220:221], v[178:179] op_sel_hi:[1,0,1]
s_waitcnt lgkmcnt(5)
v_pk_fma_f32 v[180:181], v[28:29], v[220:221], v[180:181] op_sel_hi:[1,0,1]
v_pk_fma_f32 v[182:183], v[30:31], v[220:221], v[182:183] op_sel_hi:[1,0,1]
s_waitcnt lgkmcnt(4)
v_pk_fma_f32 v[184:185], v[32:33], v[220:221], v[184:185] op_sel_hi:[1,0,1]
v_pk_fma_f32 v[186:187], v[34:35], v[220:221], v[186:187] op_sel_hi:[1,0,1]
v_max_f32 v172, 0, v172
v_max_f32 v173, 0, v173
v_max_f32 v174, 0, v174
v_max_f32 v175, 0, v175
v_max_f32 v176, 0, v176
v_max_f32 v177, 0, v177
v_max_f32 v178, 0, v178
v_max_f32 v179, 0, v179
v_pk_mul_f32 v[172:173], v[172:173], v[180:181]
v_pk_mul_f32 v[174:175], v[174:175], v[182:183]
v_pk_mul_f32 v[176:177], v[176:177], v[184:185]
v_pk_mul_f32 v[178:179], v[178:179], v[186:187]
v_pk_mul_f32 v[172:173], v[172:173], v[226:227] op_sel_hi:[1,0]
v_pk_mul_f32 v[174:175], v[174:175], v[226:227] op_sel_hi:[1,0]
v_pk_mul_f32 v[176:177], v[176:177], v[226:227] op_sel_hi:[1,0]
v_pk_mul_f32 v[178:179], v[178:179], v[226:227] op_sel_hi:[1,0]
v_cvt_pk_bf16_f32 v52, v172, v173
v_cvt_pk_bf16_f32 v53, v174, v175
v_cvt_pk_bf16_f32 v54, v176, v177
v_cvt_pk_bf16_f32 v55, v178, v179
s_nop 0
v_permlane32_swap_b32 v52, v54
v_permlane32_swap_b32 v53, v55
s_add_u32 s8, s8, 4096
buffer_store_dwordx4 v[52:55], v3, s[52:55], s8 offen offset:0
ds_read_b128 v[20:23], v225 offset:768
ds_read_b128 v[24:27], v225 offset:800
ds_read_b128 v[28:31], v225 offset:832
ds_read_b128 v[32:35], v225 offset:864
s_waitcnt lgkmcnt(7)
v_pk_fma_f32 v[188:189], v[36:37], v[220:221], v[188:189] op_sel_hi:[1,0,1]
v_pk_fma_f32 v[190:191], v[38:39], v[220:221], v[190:191] op_sel_hi:[1,0,1]
s_waitcnt lgkmcnt(6)
v_pk_fma_f32 v[192:193], v[40:41], v[220:221], v[192:193] op_sel_hi:[1,0,1]
v_pk_fma_f32 v[194:195], v[42:43], v[220:221], v[194:195] op_sel_hi:[1,0,1]
s_waitcnt lgkmcnt(5)
v_pk_fma_f32 v[196:197], v[44:45], v[220:221], v[196:197] op_sel_hi:[1,0,1]
v_pk_fma_f32 v[198:199], v[46:47], v[220:221], v[198:199] op_sel_hi:[1,0,1]
s_waitcnt lgkmcnt(4)
v_pk_fma_f32 v[200:201], v[48:49], v[220:221], v[200:201] op_sel_hi:[1,0,1]
v_pk_fma_f32 v[202:203], v[50:51], v[220:221], v[202:203] op_sel_hi:[1,0,1]
v_max_f32 v188, 0, v188
v_max_f32 v189, 0, v189
v_max_f32 v190, 0, v190
v_max_f32 v191, 0, v191
v_max_f32 v192, 0, v192
v_max_f32 v193, 0, v193
v_max_f32 v194, 0, v194
v_max_f32 v195, 0, v195
v_pk_mul_f32 v[188:189], v[188:189], v[196:197]
v_pk_mul_f32 v[190:191], v[190:191], v[198:199]
v_pk_mul_f32 v[192:193], v[192:193], v[200:201]
v_pk_mul_f32 v[194:195], v[194:195], v[202:203]
v_pk_mul_f32 v[188:189], v[188:189], v[226:227] op_sel_hi:[1,0]
v_pk_mul_f32 v[190:191], v[190:191], v[226:227] op_sel_hi:[1,0]
v_pk_mul_f32 v[192:193], v[192:193], v[226:227] op_sel_hi:[1,0]
v_pk_mul_f32 v[194:195], v[194:195], v[226:227] op_sel_hi:[1,0]
v_cvt_pk_bf16_f32 v56, v188, v189
v_cvt_pk_bf16_f32 v57, v190, v191
v_cvt_pk_bf16_f32 v58, v192, v193
v_cvt_pk_bf16_f32 v59, v194, v195
s_nop 0
v_permlane32_swap_b32 v56, v58
v_permlane32_swap_b32 v57, v59
buffer_store_dwordx4 v[56:59], v3, s[52:55], s8 offen offset:1024
s_waitcnt lgkmcnt(3)
v_pk_fma_f32 v[204:205], v[20:21], v[220:221], v[204:205] op_sel_hi:[1,0,1]
v_pk_fma_f32 v[206:207], v[22:23], v[220:221], v[206:207] op_sel_hi:[1,0,1]
s_waitcnt lgkmcnt(2)
v_pk_fma_f32 v[208:209], v[24:25], v[220:221], v[208:209] op_sel_hi:[1,0,1]
v_pk_fma_f32 v[210:211], v[26:27], v[220:221], v[210:211] op_sel_hi:[1,0,1]
s_waitcnt lgkmcnt(1)
v_pk_fma_f32 v[212:213], v[28:29], v[220:221], v[212:213] op_sel_hi:[1,0,1]
v_pk_fma_f32 v[214:215], v[30:31], v[220:221], v[214:215] op_sel_hi:[1,0,1]
s_waitcnt lgkmcnt(0)
v_pk_fma_f32 v[216:217], v[32:33], v[220:221], v[216:217] op_sel_hi:[1,0,1]
v_pk_fma_f32 v[218:219], v[34:35], v[220:221], v[218:219] op_sel_hi:[1,0,1]
v_max_f32 v204, 0, v204
v_max_f32 v205, 0, v205
v_max_f32 v206, 0, v206
v_max_f32 v207, 0, v207
v_max_f32 v208, 0, v208
v_max_f32 v209, 0, v209
v_max_f32 v210, 0, v210
v_max_f32 v211, 0, v211
v_pk_mul_f32 v[204:205], v[204:205], v[212:213]
v_pk_mul_f32 v[206:207], v[206:207], v[214:215]
v_pk_mul_f32 v[208:209], v[208:209], v[216:217]
v_pk_mul_f32 v[210:211], v[210:211], v[218:219]
v_pk_mul_f32 v[204:205], v[204:205], v[226:227] op_sel_hi:[1,0]
v_pk_mul_f32 v[206:207], v[206:207], v[226:227] op_sel_hi:[1,0]
v_pk_mul_f32 v[208:209], v[208:209], v[226:227] op_sel_hi:[1,0]
v_pk_mul_f32 v[210:211], v[210:211], v[226:227] op_sel_hi:[1,0]
v_cvt_pk_bf16_f32 v52, v204, v205
v_cvt_pk_bf16_f32 v53, v206, v207
v_cvt_pk_bf16_f32 v54, v208, v209
v_cvt_pk_bf16_f32 v55, v210, v211
s_nop 0
v_permlane32_swap_b32 v52, v54
v_permlane32_swap_b32 v53, v55
buffer_store_dwordx4 v[52:55], v3, s[52:55], s8 offen offset:2048
s_waitcnt vmcnt(0)
s_branch k4_kernel_end
k4_kernel_w3:
v_mul_u32_u24 v14, 224, v7
v_lshl_add_u32 v14, v8, 3, v14
v_mul_u32_u24 v15, 14464, v6
v_add_u32 v9, v14, v15
s_mov_b32 s60, 98304
buffer_load_dwordx4 v[76:79], v3, s[40:43], s60 offen
s_mov_b32 s60, 99328
buffer_load_dwordx4 v[80:83], v3, s[40:43], s60 offen
s_mov_b32 s60, 100352
buffer_load_dwordx4 v[84:87], v3, s[40:43], s60 offen
s_mov_b32 s60, 101376
buffer_load_dwordx4 v[88:91], v3, s[40:43], s60 offen
s_mov_b32 s60, 102400
buffer_load_dwordx4 v[92:95], v3, s[40:43], s60 offen
s_mov_b32 s60, 103424
buffer_load_dwordx4 v[96:99], v3, s[40:43], s60 offen
s_mov_b32 s60, 104448
buffer_load_dwordx4 v[100:103], v3, s[40:43], s60 offen
s_barrier
v_add_u32 v10, 0, v9
ds_read_b64_tr_b16 v[20:21], v10 offset:0
ds_read_b64_tr_b16 v[22:23], v10 offset:896
ds_read_b64_tr_b16 v[24:25], v10 offset:32
ds_read_b64_tr_b16 v[26:27], v10 offset:928
ds_read_b64_tr_b16 v[28:29], v10 offset:64
ds_read_b64_tr_b16 v[30:31], v10 offset:960
ds_read_b64_tr_b16 v[32:33], v10 offset:96
ds_read_b64_tr_b16 v[34:35], v10 offset:992
ds_read_b64_tr_b16 v[36:37], v10 offset:128
ds_read_b64_tr_b16 v[38:39], v10 offset:1024
ds_read_b64_tr_b16 v[40:41], v10 offset:160
ds_read_b64_tr_b16 v[42:43], v10 offset:1056
ds_read_b64_tr_b16 v[44:45], v10 offset:192
ds_read_b64_tr_b16 v[46:47], v10 offset:1088
s_waitcnt vmcnt(6) lgkmcnt(12)
v_mfma_f32_32x32x16_bf16 v[108:123], v[20:23], v[76:79], 0
ds_read_b64_tr_b16 v[48:49], v10 offset:3584
ds_read_b64_tr_b16 v[50:51], v10 offset:4480
s_waitcnt lgkmcnt(12)
v_mfma_f32_32x32x16_bf16 v[124:139], v[24:27], v[76:79], 0
ds_read_b64_tr_b16 v[52:53], v10 offset:3616
ds_read_b64_tr_b16 v[54:55], v10 offset:4512
s_waitcnt lgkmcnt(12)
v_mfma_f32_32x32x16_bf16 v[140:155], v[28:31], v[76:79], 0
ds_read_b64_tr_b16 v[56:57], v10 offset:3648
ds_read_b64_tr_b16 v[58:59], v10 offset:4544
s_waitcnt lgkmcnt(12)
v_mfma_f32_32x32x16_bf16 v[156:171], v[32:35], v[76:79], 0
ds_read_b64_tr_b16 v[60:61], v10 offset:3680
ds_read_b64_tr_b16 v[62:63], v10 offset:4576
s_waitcnt lgkmcnt(12)
v_mfma_f32_32x32x16_bf16 v[172:187], v[36:39], v[76:79], 0
ds_read_b64_tr_b16 v[64:65], v10 offset:3712
ds_read_b64_tr_b16 v[66:67], v10 offset:4608
s_waitcnt lgkmcnt(12)
v_mfma_f32_32x32x16_bf16 v[188:203], v[40:43], v[76:79], 0
ds_read_b64_tr_b16 v[68:69], v10 offset:3744
ds_read_b64_tr_b16 v[70:71], v10 offset:4640
s_waitcnt lgkmcnt(12)
v_mfma_f32_32x32x16_bf16 v[204:219], v[44:47], v[76:79], 0
s_mov_b32 s60, 105472
buffer_load_dwordx4 v[104:107], v3, s[40:43], s60 offen
ds_read_b64_tr_b16 v[72:73], v10 offset:3776
ds_read_b64_tr_b16 v[74:75], v10 offset:4672
s_waitcnt vmcnt(6) lgkmcnt(12)
v_mfma_f32_32x32x16_bf16 v[108:123], v[48:51], v[80:83], v[108:123]
ds_read_b64_tr_b16 v[20:21], v10 offset:7168
ds_read_b64_tr_b16 v[22:23], v10 offset:8064
s_waitcnt lgkmcnt(12)
v_mfma_f32_32x32x16_bf16 v[124:139], v[52:55], v[80:83], v[124:139]
ds_read_b64_tr_b16 v[24:25], v10 offset:7200
ds_read_b64_tr_b16 v[26:27], v10 offset:8096
s_waitcnt lgkmcnt(12)
v_mfma_f32_32x32x16_bf16 v[140:155], v[56:59], v[80:83], v[140:155]
ds_read_b64_tr_b16 v[28:29], v10 offset:7232
ds_read_b64_tr_b16 v[30:31], v10 offset:8128
s_waitcnt lgkmcnt(12)
v_mfma_f32_32x32x16_bf16 v[156:171], v[60:63], v[80:83], v[156:171]
ds_read_b64_tr_b16 v[32:33], v10 offset:7264
ds_read_b64_tr_b16 v[34:35], v10 offset:8160
s_waitcnt lgkmcnt(12)
v_mfma_f32_32x32x16_bf16 v[172:187], v[64:67], v[80:83], v[172:187]
ds_read_b64_tr_b16 v[36:37], v10 offset:7296
ds_read_b64_tr_b16 v[38:39], v10 offset:8192
s_waitcnt lgkmcnt(12)
v_mfma_f32_32x32x16_bf16 v[188:203], v[68:71], v[80:83], v[188:203]
ds_read_b64_tr_b16 v[40:41], v10 offset:7328
ds_read_b64_tr_b16 v[42:43], v10 offset:8224
s_waitcnt lgkmcnt(12)
v_mfma_f32_32x32x16_bf16 v[204:219], v[72:75], v[80:83], v[204:219]
s_mov_b32 s60, 106496
buffer_load_dwordx4 v[76:79], v3, s[40:43], s60 offen
ds_read_b64_tr_b16 v[44:45], v10 offset:7360
ds_read_b64_tr_b16 v[46:47], v10 offset:8256
s_waitcnt vmcnt(6) lgkmcnt(12)
v_mfma_f32_32x32x16_bf16 v[108:123], v[20:23], v[84:87], v[108:123]
ds_read_b64_tr_b16 v[48:49], v10 offset:10752
ds_read_b64_tr_b16 v[50:51], v10 offset:11648
s_waitcnt lgkmcnt(12)
v_mfma_f32_32x32x16_bf16 v[124:139], v[24:27], v[84:87], v[124:139]
ds_read_b64_tr_b16 v[52:53], v10 offset:10784
ds_read_b64_tr_b16 v[54:55], v10 offset:11680
s_waitcnt lgkmcnt(12)
v_mfma_f32_32x32x16_bf16 v[140:155], v[28:31], v[84:87], v[140:155]
ds_read_b64_tr_b16 v[56:57], v10 offset:10816
ds_read_b64_tr_b16 v[58:59], v10 offset:11712
s_waitcnt lgkmcnt(12)
v_mfma_f32_32x32x16_bf16 v[156:171], v[32:35], v[84:87], v[156:171]
ds_read_b64_tr_b16 v[60:61], v10 offset:10848
ds_read_b64_tr_b16 v[62:63], v10 offset:11744
s_waitcnt lgkmcnt(12)
v_mfma_f32_32x32x16_bf16 v[172:187], v[36:39], v[84:87], v[172:187]
ds_read_b64_tr_b16 v[64:65], v10 offset:10880
ds_read_b64_tr_b16 v[66:67], v10 offset:11776
s_waitcnt lgkmcnt(12)
v_mfma_f32_32x32x16_bf16 v[188:203], v[40:43], v[84:87], v[188:203]
ds_read_b64_tr_b16 v[68:69], v10 offset:10912
ds_read_b64_tr_b16 v[70:71], v10 offset:11808
s_waitcnt lgkmcnt(12)
v_mfma_f32_32x32x16_bf16 v[204:219], v[44:47], v[84:87], v[204:219]
s_mov_b32 s60, 107520
buffer_load_dwordx4 v[80:83], v3, s[40:43], s60 offen
ds_read_b64_tr_b16 v[72:73], v10 offset:10944
ds_read_b64_tr_b16 v[74:75], v10 offset:11840
s_barrier
v_add_u32 v11, 28928, v9
s_waitcnt vmcnt(6) lgkmcnt(12)
v_mfma_f32_32x32x16_bf16 v[108:123], v[48:51], v[88:91], v[108:123]
ds_read_b64_tr_b16 v[20:21], v11 offset:0
ds_read_b64_tr_b16 v[22:23], v11 offset:896
s_waitcnt lgkmcnt(12)
v_mfma_f32_32x32x16_bf16 v[124:139], v[52:55], v[88:91], v[124:139]
ds_read_b64_tr_b16 v[24:25], v11 offset:32
ds_read_b64_tr_b16 v[26:27], v11 offset:928
s_waitcnt lgkmcnt(12)
v_mfma_f32_32x32x16_bf16 v[140:155], v[56:59], v[88:91], v[140:155]
ds_read_b64_tr_b16 v[28:29], v11 offset:64
ds_read_b64_tr_b16 v[30:31], v11 offset:960
s_waitcnt lgkmcnt(12)
v_mfma_f32_32x32x16_bf16 v[156:171], v[60:63], v[88:91], v[156:171]
ds_read_b64_tr_b16 v[32:33], v11 offset:96
ds_read_b64_tr_b16 v[34:35], v11 offset:992
s_waitcnt lgkmcnt(12)
v_mfma_f32_32x32x16_bf16 v[172:187], v[64:67], v[88:91], v[172:187]
ds_read_b64_tr_b16 v[36:37], v11 offset:128
ds_read_b64_tr_b16 v[38:39], v11 offset:1024
s_waitcnt lgkmcnt(12)
v_mfma_f32_32x32x16_bf16 v[188:203], v[68:71], v[88:91], v[188:203]
ds_read_b64_tr_b16 v[40:41], v11 offset:160
ds_read_b64_tr_b16 v[42:43], v11 offset:1056
s_waitcnt lgkmcnt(12)
v_mfma_f32_32x32x16_bf16 v[204:219], v[72:75], v[88:91], v[204:219]
s_mov_b32 s60, 108544
buffer_load_dwordx4 v[84:87], v3, s[40:43], s60 offen
ds_read_b64_tr_b16 v[44:45], v11 offset:192
ds_read_b64_tr_b16 v[46:47], v11 offset:1088
s_waitcnt vmcnt(6) lgkmcnt(12)
v_mfma_f32_32x32x16_bf16 v[108:123], v[20:23], v[92:95], v[108:123]
ds_read_b64_tr_b16 v[48:49], v11 offset:3584
ds_read_b64_tr_b16 v[50:51], v11 offset:4480
s_waitcnt lgkmcnt(12)
v_mfma_f32_32x32x16_bf16 v[124:139], v[24:27], v[92:95], v[124:139]
ds_read_b64_tr_b16 v[52:53], v11 offset:3616
ds_read_b64_tr_b16 v[54:55], v11 offset:4512
s_waitcnt lgkmcnt(12)
v_mfma_f32_32x32x16_bf16 v[140:155], v[28:31], v[92:95], v[140:155]
ds_read_b64_tr_b16 v[56:57], v11 offset:3648
ds_read_b64_tr_b16 v[58:59], v11 offset:4544
s_waitcnt lgkmcnt(12)
v_mfma_f32_32x32x16_bf16 v[156:171], v[32:35], v[92:95], v[156:171]
ds_read_b64_tr_b16 v[60:61], v11 offset:3680
ds_read_b64_tr_b16 v[62:63], v11 offset:4576
s_waitcnt lgkmcnt(12)
v_mfma_f32_32x32x16_bf16 v[172:187], v[36:39], v[92:95], v[172:187]
ds_read_b64_tr_b16 v[64:65], v11 offset:3712
ds_read_b64_tr_b16 v[66:67], v11 offset:4608
s_waitcnt lgkmcnt(12)
v_mfma_f32_32x32x16_bf16 v[188:203], v[40:43], v[92:95], v[188:203]
ds_read_b64_tr_b16 v[68:69], v11 offset:3744
ds_read_b64_tr_b16 v[70:71], v11 offset:4640
s_waitcnt lgkmcnt(12)
v_mfma_f32_32x32x16_bf16 v[204:219], v[44:47], v[92:95], v[204:219]
s_mov_b32 s60, 109568
buffer_load_dwordx4 v[88:91], v3, s[40:43], s60 offen
ds_read_b64_tr_b16 v[72:73], v11 offset:3776
ds_read_b64_tr_b16 v[74:75], v11 offset:4672
s_waitcnt vmcnt(6) lgkmcnt(12)
v_mfma_f32_32x32x16_bf16 v[108:123], v[48:51], v[96:99], v[108:123]
ds_read_b64_tr_b16 v[20:21], v11 offset:7168
ds_read_b64_tr_b16 v[22:23], v11 offset:8064
s_waitcnt lgkmcnt(12)
v_mfma_f32_32x32x16_bf16 v[124:139], v[52:55], v[96:99], v[124:139]
ds_read_b64_tr_b16 v[24:25], v11 offset:7200
ds_read_b64_tr_b16 v[26:27], v11 offset:8096
s_waitcnt lgkmcnt(12)
v_mfma_f32_32x32x16_bf16 v[140:155], v[56:59], v[96:99], v[140:155]
ds_read_b64_tr_b16 v[28:29], v11 offset:7232
ds_read_b64_tr_b16 v[30:31], v11 offset:8128
s_waitcnt lgkmcnt(12)
v_mfma_f32_32x32x16_bf16 v[156:171], v[60:63], v[96:99], v[156:171]
ds_read_b64_tr_b16 v[32:33], v11 offset:7264
ds_read_b64_tr_b16 v[34:35], v11 offset:8160
s_waitcnt lgkmcnt(12)
v_mfma_f32_32x32x16_bf16 v[172:187], v[64:67], v[96:99], v[172:187]
ds_read_b64_tr_b16 v[36:37], v11 offset:7296
ds_read_b64_tr_b16 v[38:39], v11 offset:8192
s_waitcnt lgkmcnt(12)
v_mfma_f32_32x32x16_bf16 v[188:203], v[68:71], v[96:99], v[188:203]
ds_read_b64_tr_b16 v[40:41], v11 offset:7328
ds_read_b64_tr_b16 v[42:43], v11 offset:8224
s_waitcnt lgkmcnt(12)
v_mfma_f32_32x32x16_bf16 v[204:219], v[72:75], v[96:99], v[204:219]
s_mov_b32 s60, 110592
buffer_load_dwordx4 v[92:95], v3, s[40:43], s60 offen
ds_read_b64_tr_b16 v[44:45], v11 offset:7360
ds_read_b64_tr_b16 v[46:47], v11 offset:8256
s_waitcnt vmcnt(6) lgkmcnt(12)
v_mfma_f32_32x32x16_bf16 v[108:123], v[20:23], v[100:103], v[108:123]
ds_read_b64_tr_b16 v[48:49], v11 offset:10752
ds_read_b64_tr_b16 v[50:51], v11 offset:11648
s_waitcnt lgkmcnt(12)
v_mfma_f32_32x32x16_bf16 v[124:139], v[24:27], v[100:103], v[124:139]
ds_read_b64_tr_b16 v[52:53], v11 offset:10784
ds_read_b64_tr_b16 v[54:55], v11 offset:11680
s_waitcnt lgkmcnt(12)
v_mfma_f32_32x32x16_bf16 v[140:155], v[28:31], v[100:103], v[140:155]
ds_read_b64_tr_b16 v[56:57], v11 offset:10816
ds_read_b64_tr_b16 v[58:59], v11 offset:11712
s_waitcnt lgkmcnt(12)
v_mfma_f32_32x32x16_bf16 v[156:171], v[32:35], v[100:103], v[156:171]
ds_read_b64_tr_b16 v[60:61], v11 offset:10848
ds_read_b64_tr_b16 v[62:63], v11 offset:11744
s_waitcnt lgkmcnt(12)
v_mfma_f32_32x32x16_bf16 v[172:187], v[36:39], v[100:103], v[172:187]
ds_read_b64_tr_b16 v[64:65], v11 offset:10880
ds_read_b64_tr_b16 v[66:67], v11 offset:11776
s_waitcnt lgkmcnt(12)
v_mfma_f32_32x32x16_bf16 v[188:203], v[40:43], v[100:103], v[188:203]
ds_read_b64_tr_b16 v[68:69], v11 offset:10912
ds_read_b64_tr_b16 v[70:71], v11 offset:11808
s_waitcnt lgkmcnt(12)
v_mfma_f32_32x32x16_bf16 v[204:219], v[44:47], v[100:103], v[204:219]
s_mov_b32 s60, 111616
buffer_load_dwordx4 v[96:99], v3, s[40:43], s60 offen
ds_read_b64_tr_b16 v[72:73], v11 offset:10944
ds_read_b64_tr_b16 v[74:75], v11 offset:11840
s_barrier
v_add_u32 v10, 57856, v9
s_waitcnt vmcnt(6) lgkmcnt(12)
v_mfma_f32_32x32x16_bf16 v[108:123], v[48:51], v[104:107], v[108:123]
ds_read_b64_tr_b16 v[20:21], v10 offset:0
ds_read_b64_tr_b16 v[22:23], v10 offset:896
s_waitcnt lgkmcnt(12)
v_mfma_f32_32x32x16_bf16 v[124:139], v[52:55], v[104:107], v[124:139]
ds_read_b64_tr_b16 v[24:25], v10 offset:32
ds_read_b64_tr_b16 v[26:27], v10 offset:928
s_waitcnt lgkmcnt(12)
v_mfma_f32_32x32x16_bf16 v[140:155], v[56:59], v[104:107], v[140:155]
ds_read_b64_tr_b16 v[28:29], v10 offset:64
ds_read_b64_tr_b16 v[30:31], v10 offset:960
s_waitcnt lgkmcnt(12)
v_mfma_f32_32x32x16_bf16 v[156:171], v[60:63], v[104:107], v[156:171]
ds_read_b64_tr_b16 v[32:33], v10 offset:96
ds_read_b64_tr_b16 v[34:35], v10 offset:992
s_waitcnt lgkmcnt(12)
v_mfma_f32_32x32x16_bf16 v[172:187], v[64:67], v[104:107], v[172:187]
ds_read_b64_tr_b16 v[36:37], v10 offset:128
ds_read_b64_tr_b16 v[38:39], v10 offset:1024
s_waitcnt lgkmcnt(12)
v_mfma_f32_32x32x16_bf16 v[188:203], v[68:71], v[104:107], v[188:203]
ds_read_b64_tr_b16 v[40:41], v10 offset:160
ds_read_b64_tr_b16 v[42:43], v10 offset:1056
s_waitcnt lgkmcnt(12)
v_mfma_f32_32x32x16_bf16 v[204:219], v[72:75], v[104:107], v[204:219]
s_mov_b32 s60, 112640
buffer_load_dwordx4 v[100:103], v3, s[40:43], s60 offen
ds_read_b64_tr_b16 v[44:45], v10 offset:192
ds_read_b64_tr_b16 v[46:47], v10 offset:1088
s_waitcnt vmcnt(6) lgkmcnt(12)
v_mfma_f32_32x32x16_bf16 v[108:123], v[20:23], v[76:79], v[108:123]
ds_read_b64_tr_b16 v[48:49], v10 offset:3584
ds_read_b64_tr_b16 v[50:51], v10 offset:4480
s_waitcnt lgkmcnt(12)
v_mfma_f32_32x32x16_bf16 v[124:139], v[24:27], v[76:79], v[124:139]
ds_read_b64_tr_b16 v[52:53], v10 offset:3616
ds_read_b64_tr_b16 v[54:55], v10 offset:4512
s_waitcnt lgkmcnt(12)
v_mfma_f32_32x32x16_bf16 v[140:155], v[28:31], v[76:79], v[140:155]
ds_read_b64_tr_b16 v[56:57], v10 offset:3648
ds_read_b64_tr_b16 v[58:59], v10 offset:4544
s_waitcnt lgkmcnt(12)
v_mfma_f32_32x32x16_bf16 v[156:171], v[32:35], v[76:79], v[156:171]
ds_read_b64_tr_b16 v[60:61], v10 offset:3680
ds_read_b64_tr_b16 v[62:63], v10 offset:4576
s_waitcnt lgkmcnt(12)
v_mfma_f32_32x32x16_bf16 v[172:187], v[36:39], v[76:79], v[172:187]
ds_read_b64_tr_b16 v[64:65], v10 offset:3712
ds_read_b64_tr_b16 v[66:67], v10 offset:4608
s_waitcnt lgkmcnt(12)
v_mfma_f32_32x32x16_bf16 v[188:203], v[40:43], v[76:79], v[188:203]
ds_read_b64_tr_b16 v[68:69], v10 offset:3744
ds_read_b64_tr_b16 v[70:71], v10 offset:4640
s_waitcnt lgkmcnt(12)
v_mfma_f32_32x32x16_bf16 v[204:219], v[44:47], v[76:79], v[204:219]
s_mov_b32 s60, 113664
buffer_load_dwordx4 v[104:107], v3, s[40:43], s60 offen
ds_read_b64_tr_b16 v[72:73], v10 offset:3776
ds_read_b64_tr_b16 v[74:75], v10 offset:4672
s_waitcnt vmcnt(6) lgkmcnt(12)
v_mfma_f32_32x32x16_bf16 v[108:123], v[48:51], v[80:83], v[108:123]
ds_read_b64_tr_b16 v[20:21], v10 offset:7168
ds_read_b64_tr_b16 v[22:23], v10 offset:8064
s_waitcnt lgkmcnt(12)
v_mfma_f32_32x32x16_bf16 v[124:139], v[52:55], v[80:83], v[124:139]
ds_read_b64_tr_b16 v[24:25], v10 offset:7200
ds_read_b64_tr_b16 v[26:27], v10 offset:8096
s_waitcnt lgkmcnt(12)
v_mfma_f32_32x32x16_bf16 v[140:155], v[56:59], v[80:83], v[140:155]
ds_read_b64_tr_b16 v[28:29], v10 offset:7232
ds_read_b64_tr_b16 v[30:31], v10 offset:8128
s_waitcnt lgkmcnt(12)
v_mfma_f32_32x32x16_bf16 v[156:171], v[60:63], v[80:83], v[156:171]
ds_read_b64_tr_b16 v[32:33], v10 offset:7264
ds_read_b64_tr_b16 v[34:35], v10 offset:8160
s_waitcnt lgkmcnt(12)
v_mfma_f32_32x32x16_bf16 v[172:187], v[64:67], v[80:83], v[172:187]
ds_read_b64_tr_b16 v[36:37], v10 offset:7296
ds_read_b64_tr_b16 v[38:39], v10 offset:8192
s_waitcnt lgkmcnt(12)
v_mfma_f32_32x32x16_bf16 v[188:203], v[68:71], v[80:83], v[188:203]
ds_read_b64_tr_b16 v[40:41], v10 offset:7328
ds_read_b64_tr_b16 v[42:43], v10 offset:8224
s_waitcnt lgkmcnt(12)
v_mfma_f32_32x32x16_bf16 v[204:219], v[72:75], v[80:83], v[204:219]
s_mov_b32 s60, 114688
buffer_load_dwordx4 v[76:79], v3, s[40:43], s60 offen
ds_read_b64_tr_b16 v[44:45], v10 offset:7360
ds_read_b64_tr_b16 v[46:47], v10 offset:8256
s_waitcnt vmcnt(6) lgkmcnt(12)
v_mfma_f32_32x32x16_bf16 v[108:123], v[20:23], v[84:87], v[108:123]
ds_read_b64_tr_b16 v[48:49], v10 offset:10752
ds_read_b64_tr_b16 v[50:51], v10 offset:11648
s_waitcnt lgkmcnt(12)
v_mfma_f32_32x32x16_bf16 v[124:139], v[24:27], v[84:87], v[124:139]
ds_read_b64_tr_b16 v[52:53], v10 offset:10784
ds_read_b64_tr_b16 v[54:55], v10 offset:11680
s_waitcnt lgkmcnt(12)
v_mfma_f32_32x32x16_bf16 v[140:155], v[28:31], v[84:87], v[140:155]
ds_read_b64_tr_b16 v[56:57], v10 offset:10816
ds_read_b64_tr_b16 v[58:59], v10 offset:11712
s_waitcnt lgkmcnt(12)
v_mfma_f32_32x32x16_bf16 v[156:171], v[32:35], v[84:87], v[156:171]
ds_read_b64_tr_b16 v[60:61], v10 offset:10848
ds_read_b64_tr_b16 v[62:63], v10 offset:11744
s_waitcnt lgkmcnt(12)
v_mfma_f32_32x32x16_bf16 v[172:187], v[36:39], v[84:87], v[172:187]
ds_read_b64_tr_b16 v[64:65], v10 offset:10880
ds_read_b64_tr_b16 v[66:67], v10 offset:11776
s_waitcnt lgkmcnt(12)
v_mfma_f32_32x32x16_bf16 v[188:203], v[40:43], v[84:87], v[188:203]
ds_read_b64_tr_b16 v[68:69], v10 offset:10912
ds_read_b64_tr_b16 v[70:71], v10 offset:11808
s_waitcnt lgkmcnt(12)
v_mfma_f32_32x32x16_bf16 v[204:219], v[44:47], v[84:87], v[204:219]
s_mov_b32 s60, 115712
buffer_load_dwordx4 v[80:83], v3, s[40:43], s60 offen
ds_read_b64_tr_b16 v[72:73], v10 offset:10944
ds_read_b64_tr_b16 v[74:75], v10 offset:11840
s_barrier
v_add_u32 v11, 86784, v9
s_waitcnt vmcnt(6) lgkmcnt(12)
v_mfma_f32_32x32x16_bf16 v[108:123], v[48:51], v[88:91], v[108:123]
ds_read_b64_tr_b16 v[20:21], v11 offset:0
ds_read_b64_tr_b16 v[22:23], v11 offset:896
s_waitcnt lgkmcnt(12)
v_mfma_f32_32x32x16_bf16 v[124:139], v[52:55], v[88:91], v[124:139]
ds_read_b64_tr_b16 v[24:25], v11 offset:32
ds_read_b64_tr_b16 v[26:27], v11 offset:928
s_waitcnt lgkmcnt(12)
v_mfma_f32_32x32x16_bf16 v[140:155], v[56:59], v[88:91], v[140:155]
ds_read_b64_tr_b16 v[28:29], v11 offset:64
ds_read_b64_tr_b16 v[30:31], v11 offset:960
s_waitcnt lgkmcnt(12)
v_mfma_f32_32x32x16_bf16 v[156:171], v[60:63], v[88:91], v[156:171]
ds_read_b64_tr_b16 v[32:33], v11 offset:96
ds_read_b64_tr_b16 v[34:35], v11 offset:992
s_waitcnt lgkmcnt(12)
v_mfma_f32_32x32x16_bf16 v[172:187], v[64:67], v[88:91], v[172:187]
ds_read_b64_tr_b16 v[36:37], v11 offset:128
ds_read_b64_tr_b16 v[38:39], v11 offset:1024
s_waitcnt lgkmcnt(12)
v_mfma_f32_32x32x16_bf16 v[188:203], v[68:71], v[88:91], v[188:203]
ds_read_b64_tr_b16 v[40:41], v11 offset:160
ds_read_b64_tr_b16 v[42:43], v11 offset:1056
s_waitcnt lgkmcnt(12)
v_mfma_f32_32x32x16_bf16 v[204:219], v[72:75], v[88:91], v[204:219]
s_mov_b32 s60, 116736
buffer_load_dwordx4 v[84:87], v3, s[40:43], s60 offen
ds_read_b64_tr_b16 v[44:45], v11 offset:192
ds_read_b64_tr_b16 v[46:47], v11 offset:1088
s_waitcnt vmcnt(6) lgkmcnt(12)
v_mfma_f32_32x32x16_bf16 v[108:123], v[20:23], v[92:95], v[108:123]
ds_read_b64_tr_b16 v[48:49], v11 offset:3584
ds_read_b64_tr_b16 v[50:51], v11 offset:4480
s_waitcnt lgkmcnt(12)
v_mfma_f32_32x32x16_bf16 v[124:139], v[24:27], v[92:95], v[124:139]
ds_read_b64_tr_b16 v[52:53], v11 offset:3616
ds_read_b64_tr_b16 v[54:55], v11 offset:4512
s_waitcnt lgkmcnt(12)
v_mfma_f32_32x32x16_bf16 v[140:155], v[28:31], v[92:95], v[140:155]
ds_read_b64_tr_b16 v[56:57], v11 offset:3648
ds_read_b64_tr_b16 v[58:59], v11 offset:4544
s_waitcnt lgkmcnt(12)
v_mfma_f32_32x32x16_bf16 v[156:171], v[32:35], v[92:95], v[156:171]
ds_read_b64_tr_b16 v[60:61], v11 offset:3680
ds_read_b64_tr_b16 v[62:63], v11 offset:4576
s_waitcnt lgkmcnt(12)
v_mfma_f32_32x32x16_bf16 v[172:187], v[36:39], v[92:95], v[172:187]
ds_read_b64_tr_b16 v[64:65], v11 offset:3712
ds_read_b64_tr_b16 v[66:67], v11 offset:4608
s_waitcnt lgkmcnt(12)
v_mfma_f32_32x32x16_bf16 v[188:203], v[40:43], v[92:95], v[188:203]
ds_read_b64_tr_b16 v[68:69], v11 offset:3744
ds_read_b64_tr_b16 v[70:71], v11 offset:4640
s_waitcnt lgkmcnt(12)
v_mfma_f32_32x32x16_bf16 v[204:219], v[44:47], v[92:95], v[204:219]
s_mov_b32 s60, 117760
buffer_load_dwordx4 v[88:91], v3, s[40:43], s60 offen
ds_read_b64_tr_b16 v[72:73], v11 offset:3776
ds_read_b64_tr_b16 v[74:75], v11 offset:4672
s_waitcnt vmcnt(6) lgkmcnt(12)
v_mfma_f32_32x32x16_bf16 v[108:123], v[48:51], v[96:99], v[108:123]
ds_read_b64_tr_b16 v[20:21], v11 offset:7168
ds_read_b64_tr_b16 v[22:23], v11 offset:8064
s_waitcnt lgkmcnt(12)
v_mfma_f32_32x32x16_bf16 v[124:139], v[52:55], v[96:99], v[124:139]
ds_read_b64_tr_b16 v[24:25], v11 offset:7200
ds_read_b64_tr_b16 v[26:27], v11 offset:8096
s_waitcnt lgkmcnt(12)
v_mfma_f32_32x32x16_bf16 v[140:155], v[56:59], v[96:99], v[140:155]
ds_read_b64_tr_b16 v[28:29], v11 offset:7232
ds_read_b64_tr_b16 v[30:31], v11 offset:8128
s_waitcnt lgkmcnt(12)
v_mfma_f32_32x32x16_bf16 v[156:171], v[60:63], v[96:99], v[156:171]
ds_read_b64_tr_b16 v[32:33], v11 offset:7264
ds_read_b64_tr_b16 v[34:35], v11 offset:8160
s_waitcnt lgkmcnt(12)
v_mfma_f32_32x32x16_bf16 v[172:187], v[64:67], v[96:99], v[172:187]
ds_read_b64_tr_b16 v[36:37], v11 offset:7296
ds_read_b64_tr_b16 v[38:39], v11 offset:8192
s_waitcnt lgkmcnt(12)
v_mfma_f32_32x32x16_bf16 v[188:203], v[68:71], v[96:99], v[188:203]
ds_read_b64_tr_b16 v[40:41], v11 offset:7328
ds_read_b64_tr_b16 v[42:43], v11 offset:8224
s_waitcnt lgkmcnt(12)
v_mfma_f32_32x32x16_bf16 v[204:219], v[72:75], v[96:99], v[204:219]
s_mov_b32 s60, 118784
buffer_load_dwordx4 v[92:95], v3, s[40:43], s60 offen
ds_read_b64_tr_b16 v[44:45], v11 offset:7360
ds_read_b64_tr_b16 v[46:47], v11 offset:8256
s_waitcnt vmcnt(6) lgkmcnt(12)
v_mfma_f32_32x32x16_bf16 v[108:123], v[20:23], v[100:103], v[108:123]
ds_read_b64_tr_b16 v[48:49], v11 offset:10752
ds_read_b64_tr_b16 v[50:51], v11 offset:11648
s_waitcnt lgkmcnt(12)
v_mfma_f32_32x32x16_bf16 v[124:139], v[24:27], v[100:103], v[124:139]
ds_read_b64_tr_b16 v[52:53], v11 offset:10784
ds_read_b64_tr_b16 v[54:55], v11 offset:11680
s_waitcnt lgkmcnt(12)
v_mfma_f32_32x32x16_bf16 v[140:155], v[28:31], v[100:103], v[140:155]
ds_read_b64_tr_b16 v[56:57], v11 offset:10816
ds_read_b64_tr_b16 v[58:59], v11 offset:11712
s_waitcnt lgkmcnt(12)
v_mfma_f32_32x32x16_bf16 v[156:171], v[32:35], v[100:103], v[156:171]
ds_read_b64_tr_b16 v[60:61], v11 offset:10848
ds_read_b64_tr_b16 v[62:63], v11 offset:11744
s_waitcnt lgkmcnt(12)
v_mfma_f32_32x32x16_bf16 v[172:187], v[36:39], v[100:103], v[172:187]
ds_read_b64_tr_b16 v[64:65], v11 offset:10880
ds_read_b64_tr_b16 v[66:67], v11 offset:11776
s_waitcnt lgkmcnt(12)
v_mfma_f32_32x32x16_bf16 v[188:203], v[40:43], v[100:103], v[188:203]
ds_read_b64_tr_b16 v[68:69], v11 offset:10912
ds_read_b64_tr_b16 v[70:71], v11 offset:11808
s_waitcnt lgkmcnt(12)
v_mfma_f32_32x32x16_bf16 v[204:219], v[44:47], v[100:103], v[204:219]
s_mov_b32 s60, 119808
buffer_load_dwordx4 v[96:99], v3, s[40:43], s60 offen
ds_read_b64_tr_b16 v[72:73], v11 offset:10944
ds_read_b64_tr_b16 v[74:75], v11 offset:11840
s_barrier
v_add_u32 v10, 115712, v9
s_waitcnt vmcnt(6) lgkmcnt(12)
v_mfma_f32_32x32x16_bf16 v[108:123], v[48:51], v[104:107], v[108:123]
ds_read_b64_tr_b16 v[20:21], v10 offset:0
ds_read_b64_tr_b16 v[22:23], v10 offset:896
s_waitcnt lgkmcnt(12)
v_mfma_f32_32x32x16_bf16 v[124:139], v[52:55], v[104:107], v[124:139]
ds_read_b64_tr_b16 v[24:25], v10 offset:32
ds_read_b64_tr_b16 v[26:27], v10 offset:928
s_waitcnt lgkmcnt(12)
v_mfma_f32_32x32x16_bf16 v[140:155], v[56:59], v[104:107], v[140:155]
ds_read_b64_tr_b16 v[28:29], v10 offset:64
ds_read_b64_tr_b16 v[30:31], v10 offset:960
s_waitcnt lgkmcnt(12)
v_mfma_f32_32x32x16_bf16 v[156:171], v[60:63], v[104:107], v[156:171]
ds_read_b64_tr_b16 v[32:33], v10 offset:96
ds_read_b64_tr_b16 v[34:35], v10 offset:992
s_waitcnt lgkmcnt(12)
v_mfma_f32_32x32x16_bf16 v[172:187], v[64:67], v[104:107], v[172:187]
ds_read_b64_tr_b16 v[36:37], v10 offset:128
ds_read_b64_tr_b16 v[38:39], v10 offset:1024
s_waitcnt lgkmcnt(12)
v_mfma_f32_32x32x16_bf16 v[188:203], v[68:71], v[104:107], v[188:203]
ds_read_b64_tr_b16 v[40:41], v10 offset:160
ds_read_b64_tr_b16 v[42:43], v10 offset:1056
s_waitcnt lgkmcnt(12)
v_mfma_f32_32x32x16_bf16 v[204:219], v[72:75], v[104:107], v[204:219]
s_mov_b32 s60, 120832
buffer_load_dwordx4 v[100:103], v3, s[40:43], s60 offen
ds_read_b64_tr_b16 v[44:45], v10 offset:192
ds_read_b64_tr_b16 v[46:47], v10 offset:1088
s_waitcnt vmcnt(6) lgkmcnt(12)
v_mfma_f32_32x32x16_bf16 v[108:123], v[20:23], v[76:79], v[108:123]
ds_read_b64_tr_b16 v[48:49], v10 offset:3584
ds_read_b64_tr_b16 v[50:51], v10 offset:4480
s_waitcnt lgkmcnt(12)
v_mfma_f32_32x32x16_bf16 v[124:139], v[24:27], v[76:79], v[124:139]
ds_read_b64_tr_b16 v[52:53], v10 offset:3616
ds_read_b64_tr_b16 v[54:55], v10 offset:4512
s_waitcnt lgkmcnt(12)
v_mfma_f32_32x32x16_bf16 v[140:155], v[28:31], v[76:79], v[140:155]
ds_read_b64_tr_b16 v[56:57], v10 offset:3648
ds_read_b64_tr_b16 v[58:59], v10 offset:4544
s_waitcnt lgkmcnt(12)
v_mfma_f32_32x32x16_bf16 v[156:171], v[32:35], v[76:79], v[156:171]
ds_read_b64_tr_b16 v[60:61], v10 offset:3680
ds_read_b64_tr_b16 v[62:63], v10 offset:4576
s_waitcnt lgkmcnt(12)
v_mfma_f32_32x32x16_bf16 v[172:187], v[36:39], v[76:79], v[172:187]
ds_read_b64_tr_b16 v[64:65], v10 offset:3712
ds_read_b64_tr_b16 v[66:67], v10 offset:4608
s_waitcnt lgkmcnt(12)
v_mfma_f32_32x32x16_bf16 v[188:203], v[40:43], v[76:79], v[188:203]
ds_read_b64_tr_b16 v[68:69], v10 offset:3744
ds_read_b64_tr_b16 v[70:71], v10 offset:4640
s_waitcnt lgkmcnt(12)
v_mfma_f32_32x32x16_bf16 v[204:219], v[44:47], v[76:79], v[204:219]
s_mov_b32 s60, 121856
buffer_load_dwordx4 v[104:107], v3, s[40:43], s60 offen
ds_read_b64_tr_b16 v[72:73], v10 offset:3776
ds_read_b64_tr_b16 v[74:75], v10 offset:4672
s_waitcnt vmcnt(6) lgkmcnt(12)
v_mfma_f32_32x32x16_bf16 v[108:123], v[48:51], v[80:83], v[108:123]
ds_read_b64_tr_b16 v[20:21], v10 offset:7168
ds_read_b64_tr_b16 v[22:23], v10 offset:8064
s_waitcnt lgkmcnt(12)
v_mfma_f32_32x32x16_bf16 v[124:139], v[52:55], v[80:83], v[124:139]
ds_read_b64_tr_b16 v[24:25], v10 offset:7200
ds_read_b64_tr_b16 v[26:27], v10 offset:8096
s_waitcnt lgkmcnt(12)
v_mfma_f32_32x32x16_bf16 v[140:155], v[56:59], v[80:83], v[140:155]
ds_read_b64_tr_b16 v[28:29], v10 offset:7232
ds_read_b64_tr_b16 v[30:31], v10 offset:8128
s_waitcnt lgkmcnt(12)
v_mfma_f32_32x32x16_bf16 v[156:171], v[60:63], v[80:83], v[156:171]
ds_read_b64_tr_b16 v[32:33], v10 offset:7264
ds_read_b64_tr_b16 v[34:35], v10 offset:8160
s_waitcnt lgkmcnt(12)
v_mfma_f32_32x32x16_bf16 v[172:187], v[64:67], v[80:83], v[172:187]
ds_read_b64_tr_b16 v[36:37], v10 offset:7296
ds_read_b64_tr_b16 v[38:39], v10 offset:8192
s_waitcnt lgkmcnt(12)
v_mfma_f32_32x32x16_bf16 v[188:203], v[68:71], v[80:83], v[188:203]
ds_read_b64_tr_b16 v[40:41], v10 offset:7328
ds_read_b64_tr_b16 v[42:43], v10 offset:8224
s_waitcnt lgkmcnt(12)
v_mfma_f32_32x32x16_bf16 v[204:219], v[72:75], v[80:83], v[204:219]
s_mov_b32 s60, 122880
buffer_load_dwordx4 v[76:79], v3, s[40:43], s60 offen
ds_read_b64_tr_b16 v[44:45], v10 offset:7360
ds_read_b64_tr_b16 v[46:47], v10 offset:8256
s_waitcnt vmcnt(6) lgkmcnt(12)
v_mfma_f32_32x32x16_bf16 v[108:123], v[20:23], v[84:87], v[108:123]
ds_read_b64_tr_b16 v[48:49], v10 offset:10752
ds_read_b64_tr_b16 v[50:51], v10 offset:11648
s_waitcnt lgkmcnt(12)
v_mfma_f32_32x32x16_bf16 v[124:139], v[24:27], v[84:87], v[124:139]
ds_read_b64_tr_b16 v[52:53], v10 offset:10784
ds_read_b64_tr_b16 v[54:55], v10 offset:11680
s_waitcnt lgkmcnt(12)
v_mfma_f32_32x32x16_bf16 v[140:155], v[28:31], v[84:87], v[140:155]
ds_read_b64_tr_b16 v[56:57], v10 offset:10816
ds_read_b64_tr_b16 v[58:59], v10 offset:11712
s_waitcnt lgkmcnt(12)
v_mfma_f32_32x32x16_bf16 v[156:171], v[32:35], v[84:87], v[156:171]
ds_read_b64_tr_b16 v[60:61], v10 offset:10848
ds_read_b64_tr_b16 v[62:63], v10 offset:11744
s_waitcnt lgkmcnt(12)
v_mfma_f32_32x32x16_bf16 v[172:187], v[36:39], v[84:87], v[172:187]
ds_read_b64_tr_b16 v[64:65], v10 offset:10880
ds_read_b64_tr_b16 v[66:67], v10 offset:11776
s_waitcnt lgkmcnt(12)
v_mfma_f32_32x32x16_bf16 v[188:203], v[40:43], v[84:87], v[188:203]
ds_read_b64_tr_b16 v[68:69], v10 offset:10912
ds_read_b64_tr_b16 v[70:71], v10 offset:11808
s_waitcnt lgkmcnt(12)
v_mfma_f32_32x32x16_bf16 v[204:219], v[44:47], v[84:87], v[204:219]
s_mov_b32 s60, 123904
buffer_load_dwordx4 v[80:83], v3, s[40:43], s60 offen
ds_read_b64_tr_b16 v[72:73], v10 offset:10944
ds_read_b64_tr_b16 v[74:75], v10 offset:11840
s_barrier
v_add_u32 v11, 0, v9
s_waitcnt vmcnt(6) lgkmcnt(12)
v_mfma_f32_32x32x16_bf16 v[108:123], v[48:51], v[88:91], v[108:123]
ds_read_b64_tr_b16 v[20:21], v11 offset:0
ds_read_b64_tr_b16 v[22:23], v11 offset:896
s_waitcnt lgkmcnt(12)
v_mfma_f32_32x32x16_bf16 v[124:139], v[52:55], v[88:91], v[124:139]
ds_read_b64_tr_b16 v[24:25], v11 offset:32
ds_read_b64_tr_b16 v[26:27], v11 offset:928
s_waitcnt lgkmcnt(12)
v_mfma_f32_32x32x16_bf16 v[140:155], v[56:59], v[88:91], v[140:155]
ds_read_b64_tr_b16 v[28:29], v11 offset:64
ds_read_b64_tr_b16 v[30:31], v11 offset:960
s_waitcnt lgkmcnt(12)
v_mfma_f32_32x32x16_bf16 v[156:171], v[60:63], v[88:91], v[156:171]
ds_read_b64_tr_b16 v[32:33], v11 offset:96
ds_read_b64_tr_b16 v[34:35], v11 offset:992
s_waitcnt lgkmcnt(12)
v_mfma_f32_32x32x16_bf16 v[172:187], v[64:67], v[88:91], v[172:187]
ds_read_b64_tr_b16 v[36:37], v11 offset:128
ds_read_b64_tr_b16 v[38:39], v11 offset:1024
s_waitcnt lgkmcnt(12)
v_mfma_f32_32x32x16_bf16 v[188:203], v[68:71], v[88:91], v[188:203]
ds_read_b64_tr_b16 v[40:41], v11 offset:160
ds_read_b64_tr_b16 v[42:43], v11 offset:1056
s_waitcnt lgkmcnt(12)
v_mfma_f32_32x32x16_bf16 v[204:219], v[72:75], v[88:91], v[204:219]
s_mov_b32 s60, 124928
buffer_load_dwordx4 v[84:87], v3, s[40:43], s60 offen
ds_read_b64_tr_b16 v[44:45], v11 offset:192
ds_read_b64_tr_b16 v[46:47], v11 offset:1088
s_waitcnt vmcnt(6) lgkmcnt(12)
v_mfma_f32_32x32x16_bf16 v[108:123], v[20:23], v[92:95], v[108:123]
ds_read_b64_tr_b16 v[48:49], v11 offset:3584
ds_read_b64_tr_b16 v[50:51], v11 offset:4480
s_waitcnt lgkmcnt(12)
v_mfma_f32_32x32x16_bf16 v[124:139], v[24:27], v[92:95], v[124:139]
ds_read_b64_tr_b16 v[52:53], v11 offset:3616
ds_read_b64_tr_b16 v[54:55], v11 offset:4512
s_waitcnt lgkmcnt(12)
v_mfma_f32_32x32x16_bf16 v[140:155], v[28:31], v[92:95], v[140:155]
ds_read_b64_tr_b16 v[56:57], v11 offset:3648
ds_read_b64_tr_b16 v[58:59], v11 offset:4544
s_waitcnt lgkmcnt(12)
v_mfma_f32_32x32x16_bf16 v[156:171], v[32:35], v[92:95], v[156:171]
ds_read_b64_tr_b16 v[60:61], v11 offset:3680
ds_read_b64_tr_b16 v[62:63], v11 offset:4576
s_waitcnt lgkmcnt(12)
v_mfma_f32_32x32x16_bf16 v[172:187], v[36:39], v[92:95], v[172:187]
ds_read_b64_tr_b16 v[64:65], v11 offset:3712
ds_read_b64_tr_b16 v[66:67], v11 offset:4608
s_waitcnt lgkmcnt(12)
v_mfma_f32_32x32x16_bf16 v[188:203], v[40:43], v[92:95], v[188:203]
ds_read_b64_tr_b16 v[68:69], v11 offset:3744
ds_read_b64_tr_b16 v[70:71], v11 offset:4640
s_waitcnt lgkmcnt(12)
v_mfma_f32_32x32x16_bf16 v[204:219], v[44:47], v[92:95], v[204:219]
s_mov_b32 s60, 125952
buffer_load_dwordx4 v[88:91], v3, s[40:43], s60 offen
ds_read_b64_tr_b16 v[72:73], v11 offset:3776
ds_read_b64_tr_b16 v[74:75], v11 offset:4672
s_waitcnt vmcnt(6) lgkmcnt(12)
v_mfma_f32_32x32x16_bf16 v[108:123], v[48:51], v[96:99], v[108:123]
ds_read_b64_tr_b16 v[20:21], v11 offset:7168
ds_read_b64_tr_b16 v[22:23], v11 offset:8064
s_waitcnt lgkmcnt(12)
v_mfma_f32_32x32x16_bf16 v[124:139], v[52:55], v[96:99], v[124:139]
ds_read_b64_tr_b16 v[24:25], v11 offset:7200
ds_read_b64_tr_b16 v[26:27], v11 offset:8096
s_waitcnt lgkmcnt(12)
v_mfma_f32_32x32x16_bf16 v[140:155], v[56:59], v[96:99], v[140:155]
ds_read_b64_tr_b16 v[28:29], v11 offset:7232
ds_read_b64_tr_b16 v[30:31], v11 offset:8128
s_waitcnt lgkmcnt(12)
v_mfma_f32_32x32x16_bf16 v[156:171], v[60:63], v[96:99], v[156:171]
ds_read_b64_tr_b16 v[32:33], v11 offset:7264
ds_read_b64_tr_b16 v[34:35], v11 offset:8160
s_waitcnt lgkmcnt(12)
v_mfma_f32_32x32x16_bf16 v[172:187], v[64:67], v[96:99], v[172:187]
ds_read_b64_tr_b16 v[36:37], v11 offset:7296
ds_read_b64_tr_b16 v[38:39], v11 offset:8192
s_waitcnt lgkmcnt(12)
v_mfma_f32_32x32x16_bf16 v[188:203], v[68:71], v[96:99], v[188:203]
ds_read_b64_tr_b16 v[40:41], v11 offset:7328
ds_read_b64_tr_b16 v[42:43], v11 offset:8224
s_waitcnt lgkmcnt(12)
v_mfma_f32_32x32x16_bf16 v[204:219], v[72:75], v[96:99], v[204:219]
s_mov_b32 s60, 126976
buffer_load_dwordx4 v[92:95], v3, s[40:43], s60 offen
ds_read_b64_tr_b16 v[44:45], v11 offset:7360
ds_read_b64_tr_b16 v[46:47], v11 offset:8256
s_waitcnt vmcnt(6) lgkmcnt(12)
v_mfma_f32_32x32x16_bf16 v[108:123], v[20:23], v[100:103], v[108:123]
ds_read_b64_tr_b16 v[48:49], v11 offset:10752
ds_read_b64_tr_b16 v[50:51], v11 offset:11648
s_waitcnt lgkmcnt(12)
v_mfma_f32_32x32x16_bf16 v[124:139], v[24:27], v[100:103], v[124:139]
ds_read_b64_tr_b16 v[52:53], v11 offset:10784
ds_read_b64_tr_b16 v[54:55], v11 offset:11680
s_waitcnt lgkmcnt(12)
v_mfma_f32_32x32x16_bf16 v[140:155], v[28:31], v[100:103], v[140:155]
ds_read_b64_tr_b16 v[56:57], v11 offset:10816
ds_read_b64_tr_b16 v[58:59], v11 offset:11712
s_waitcnt lgkmcnt(12)
v_mfma_f32_32x32x16_bf16 v[156:171], v[32:35], v[100:103], v[156:171]
ds_read_b64_tr_b16 v[60:61], v11 offset:10848
ds_read_b64_tr_b16 v[62:63], v11 offset:11744
s_waitcnt lgkmcnt(12)
v_mfma_f32_32x32x16_bf16 v[172:187], v[36:39], v[100:103], v[172:187]
ds_read_b64_tr_b16 v[64:65], v11 offset:10880
ds_read_b64_tr_b16 v[66:67], v11 offset:11776
s_waitcnt lgkmcnt(12)
v_mfma_f32_32x32x16_bf16 v[188:203], v[40:43], v[100:103], v[188:203]
ds_read_b64_tr_b16 v[68:69], v11 offset:10912
ds_read_b64_tr_b16 v[70:71], v11 offset:11808
s_waitcnt lgkmcnt(12)
v_mfma_f32_32x32x16_bf16 v[204:219], v[44:47], v[100:103], v[204:219]
s_mov_b32 s60, 128000
buffer_load_dwordx4 v[96:99], v3, s[40:43], s60 offen
ds_read_b64_tr_b16 v[72:73], v11 offset:10944
ds_read_b64_tr_b16 v[74:75], v11 offset:11840
s_barrier
v_add_u32 v10, 28928, v9
s_waitcnt vmcnt(6) lgkmcnt(12)
v_mfma_f32_32x32x16_bf16 v[108:123], v[48:51], v[104:107], v[108:123]
ds_read_b64_tr_b16 v[20:21], v10 offset:0
ds_read_b64_tr_b16 v[22:23], v10 offset:896
s_waitcnt lgkmcnt(12)
v_mfma_f32_32x32x16_bf16 v[124:139], v[52:55], v[104:107], v[124:139]
ds_read_b64_tr_b16 v[24:25], v10 offset:32
ds_read_b64_tr_b16 v[26:27], v10 offset:928
s_waitcnt lgkmcnt(12)
v_mfma_f32_32x32x16_bf16 v[140:155], v[56:59], v[104:107], v[140:155]
ds_read_b64_tr_b16 v[28:29], v10 offset:64
ds_read_b64_tr_b16 v[30:31], v10 offset:960
s_waitcnt lgkmcnt(12)
v_mfma_f32_32x32x16_bf16 v[156:171], v[60:63], v[104:107], v[156:171]
ds_read_b64_tr_b16 v[32:33], v10 offset:96
ds_read_b64_tr_b16 v[34:35], v10 offset:992
s_waitcnt lgkmcnt(12)
v_mfma_f32_32x32x16_bf16 v[172:187], v[64:67], v[104:107], v[172:187]
ds_read_b64_tr_b16 v[36:37], v10 offset:128
ds_read_b64_tr_b16 v[38:39], v10 offset:1024
s_waitcnt lgkmcnt(12)
v_mfma_f32_32x32x16_bf16 v[188:203], v[68:71], v[104:107], v[188:203]
ds_read_b64_tr_b16 v[40:41], v10 offset:160
ds_read_b64_tr_b16 v[42:43], v10 offset:1056
s_waitcnt lgkmcnt(12)
v_mfma_f32_32x32x16_bf16 v[204:219], v[72:75], v[104:107], v[204:219]
s_mov_b32 s60, 129024
buffer_load_dwordx4 v[100:103], v3, s[40:43], s60 offen
ds_read_b64_tr_b16 v[44:45], v10 offset:192
ds_read_b64_tr_b16 v[46:47], v10 offset:1088
s_waitcnt vmcnt(6) lgkmcnt(12)
v_mfma_f32_32x32x16_bf16 v[108:123], v[20:23], v[76:79], v[108:123]
ds_read_b64_tr_b16 v[48:49], v10 offset:3584
ds_read_b64_tr_b16 v[50:51], v10 offset:4480
s_waitcnt lgkmcnt(12)
v_mfma_f32_32x32x16_bf16 v[124:139], v[24:27], v[76:79], v[124:139]
ds_read_b64_tr_b16 v[52:53], v10 offset:3616
ds_read_b64_tr_b16 v[54:55], v10 offset:4512
s_waitcnt lgkmcnt(12)
v_mfma_f32_32x32x16_bf16 v[140:155], v[28:31], v[76:79], v[140:155]
ds_read_b64_tr_b16 v[56:57], v10 offset:3648
ds_read_b64_tr_b16 v[58:59], v10 offset:4544
s_waitcnt lgkmcnt(12)
v_mfma_f32_32x32x16_bf16 v[156:171], v[32:35], v[76:79], v[156:171]
ds_read_b64_tr_b16 v[60:61], v10 offset:3680
ds_read_b64_tr_b16 v[62:63], v10 offset:4576
s_waitcnt lgkmcnt(12)
v_mfma_f32_32x32x16_bf16 v[172:187], v[36:39], v[76:79], v[172:187]
ds_read_b64_tr_b16 v[64:65], v10 offset:3712
ds_read_b64_tr_b16 v[66:67], v10 offset:4608
s_waitcnt lgkmcnt(12)
v_mfma_f32_32x32x16_bf16 v[188:203], v[40:43], v[76:79], v[188:203]
ds_read_b64_tr_b16 v[68:69], v10 offset:3744
ds_read_b64_tr_b16 v[70:71], v10 offset:4640
s_waitcnt lgkmcnt(12)
v_mfma_f32_32x32x16_bf16 v[204:219], v[44:47], v[76:79], v[204:219]
s_mov_b32 s60, 130048
buffer_load_dwordx4 v[104:107], v3, s[40:43], s60 offen
ds_read_b64_tr_b16 v[72:73], v10 offset:3776
ds_read_b64_tr_b16 v[74:75], v10 offset:4672
s_waitcnt vmcnt(6) lgkmcnt(12)
v_mfma_f32_32x32x16_bf16 v[108:123], v[48:51], v[80:83], v[108:123]
ds_read_b64_tr_b16 v[20:21], v10 offset:7168
ds_read_b64_tr_b16 v[22:23], v10 offset:8064
s_waitcnt lgkmcnt(12)
v_mfma_f32_32x32x16_bf16 v[124:139], v[52:55], v[80:83], v[124:139]
ds_read_b64_tr_b16 v[24:25], v10 offset:7200
ds_read_b64_tr_b16 v[26:27], v10 offset:8096
s_waitcnt lgkmcnt(12)
v_mfma_f32_32x32x16_bf16 v[140:155], v[56:59], v[80:83], v[140:155]
ds_read_b64_tr_b16 v[28:29], v10 offset:7232
ds_read_b64_tr_b16 v[30:31], v10 offset:8128
s_waitcnt lgkmcnt(12)
v_mfma_f32_32x32x16_bf16 v[156:171], v[60:63], v[80:83], v[156:171]
ds_read_b64_tr_b16 v[32:33], v10 offset:7264
ds_read_b64_tr_b16 v[34:35], v10 offset:8160
s_waitcnt lgkmcnt(12)
v_mfma_f32_32x32x16_bf16 v[172:187], v[64:67], v[80:83], v[172:187]
ds_read_b64_tr_b16 v[36:37], v10 offset:7296
ds_read_b64_tr_b16 v[38:39], v10 offset:8192
s_waitcnt lgkmcnt(12)
v_mfma_f32_32x32x16_bf16 v[188:203], v[68:71], v[80:83], v[188:203]
ds_read_b64_tr_b16 v[40:41], v10 offset:7328
ds_read_b64_tr_b16 v[42:43], v10 offset:8224
s_waitcnt lgkmcnt(12)
v_mfma_f32_32x32x16_bf16 v[204:219], v[72:75], v[80:83], v[204:219]
ds_read_b64_tr_b16 v[44:45], v10 offset:7360
ds_read_b64_tr_b16 v[46:47], v10 offset:8256
s_waitcnt vmcnt(5) lgkmcnt(12)
v_mfma_f32_32x32x16_bf16 v[108:123], v[20:23], v[84:87], v[108:123]
ds_read_b64_tr_b16 v[48:49], v10 offset:10752
ds_read_b64_tr_b16 v[50:51], v10 offset:11648
s_waitcnt lgkmcnt(12)
v_mfma_f32_32x32x16_bf16 v[124:139], v[24:27], v[84:87], v[124:139]
ds_read_b64_tr_b16 v[52:53], v10 offset:10784
ds_read_b64_tr_b16 v[54:55], v10 offset:11680
s_waitcnt lgkmcnt(12)
v_mfma_f32_32x32x16_bf16 v[140:155], v[28:31], v[84:87], v[140:155]
ds_read_b64_tr_b16 v[56:57], v10 offset:10816
ds_read_b64_tr_b16 v[58:59], v10 offset:11712
s_waitcnt lgkmcnt(12)
v_mfma_f32_32x32x16_bf16 v[156:171], v[32:35], v[84:87], v[156:171]
ds_read_b64_tr_b16 v[60:61], v10 offset:10848
ds_read_b64_tr_b16 v[62:63], v10 offset:11744
s_waitcnt lgkmcnt(12)
v_mfma_f32_32x32x16_bf16 v[172:187], v[36:39], v[84:87], v[172:187]
ds_read_b64_tr_b16 v[64:65], v10 offset:10880
ds_read_b64_tr_b16 v[66:67], v10 offset:11776
s_waitcnt lgkmcnt(12)
v_mfma_f32_32x32x16_bf16 v[188:203], v[40:43], v[84:87], v[188:203]
ds_read_b64_tr_b16 v[68:69], v10 offset:10912
ds_read_b64_tr_b16 v[70:71], v10 offset:11808
s_waitcnt lgkmcnt(12)
v_mfma_f32_32x32x16_bf16 v[204:219], v[44:47], v[84:87], v[204:219]
ds_read_b64_tr_b16 v[72:73], v10 offset:10944
ds_read_b64_tr_b16 v[74:75], v10 offset:11840
s_barrier
v_add_u32 v11, 57856, v9
s_waitcnt vmcnt(4) lgkmcnt(12)
v_mfma_f32_32x32x16_bf16 v[108:123], v[48:51], v[88:91], v[108:123]
ds_read_b64_tr_b16 v[20:21], v11 offset:0
ds_read_b64_tr_b16 v[22:23], v11 offset:896
s_waitcnt lgkmcnt(12)
v_mfma_f32_32x32x16_bf16 v[124:139], v[52:55], v[88:91], v[124:139]
ds_read_b64_tr_b16 v[24:25], v11 offset:32
ds_read_b64_tr_b16 v[26:27], v11 offset:928
s_waitcnt lgkmcnt(12)
v_mfma_f32_32x32x16_bf16 v[140:155], v[56:59], v[88:91], v[140:155]
ds_read_b64_tr_b16 v[28:29], v11 offset:64
ds_read_b64_tr_b16 v[30:31], v11 offset:960
s_waitcnt lgkmcnt(12)
v_mfma_f32_32x32x16_bf16 v[156:171], v[60:63], v[88:91], v[156:171]
ds_read_b64_tr_b16 v[32:33], v11 offset:96
ds_read_b64_tr_b16 v[34:35], v11 offset:992
s_waitcnt lgkmcnt(12)
v_mfma_f32_32x32x16_bf16 v[172:187], v[64:67], v[88:91], v[172:187]
ds_read_b64_tr_b16 v[36:37], v11 offset:128
ds_read_b64_tr_b16 v[38:39], v11 offset:1024
s_waitcnt lgkmcnt(12)
v_mfma_f32_32x32x16_bf16 v[188:203], v[68:71], v[88:91], v[188:203]
ds_read_b64_tr_b16 v[40:41], v11 offset:160
ds_read_b64_tr_b16 v[42:43], v11 offset:1056
s_waitcnt lgkmcnt(12)
v_mfma_f32_32x32x16_bf16 v[204:219], v[72:75], v[88:91], v[204:219]
ds_read_b64_tr_b16 v[44:45], v11 offset:192
ds_read_b64_tr_b16 v[46:47], v11 offset:1088
s_waitcnt vmcnt(3) lgkmcnt(12)
v_mfma_f32_32x32x16_bf16 v[108:123], v[20:23], v[92:95], v[108:123]
ds_read_b64_tr_b16 v[48:49], v11 offset:3584
ds_read_b64_tr_b16 v[50:51], v11 offset:4480
s_waitcnt lgkmcnt(12)
v_mfma_f32_32x32x16_bf16 v[124:139], v[24:27], v[92:95], v[124:139]
ds_read_b64_tr_b16 v[52:53], v11 offset:3616
ds_read_b64_tr_b16 v[54:55], v11 offset:4512
s_waitcnt lgkmcnt(12)
v_mfma_f32_32x32x16_bf16 v[140:155], v[28:31], v[92:95], v[140:155]
ds_read_b64_tr_b16 v[56:57], v11 offset:3648
ds_read_b64_tr_b16 v[58:59], v11 offset:4544
s_waitcnt lgkmcnt(12)
v_mfma_f32_32x32x16_bf16 v[156:171], v[32:35], v[92:95], v[156:171]
ds_read_b64_tr_b16 v[60:61], v11 offset:3680
ds_read_b64_tr_b16 v[62:63], v11 offset:4576
s_waitcnt lgkmcnt(12)
v_mfma_f32_32x32x16_bf16 v[172:187], v[36:39], v[92:95], v[172:187]
ds_read_b64_tr_b16 v[64:65], v11 offset:3712
ds_read_b64_tr_b16 v[66:67], v11 offset:4608
s_waitcnt lgkmcnt(12)
v_mfma_f32_32x32x16_bf16 v[188:203], v[40:43], v[92:95], v[188:203]
ds_read_b64_tr_b16 v[68:69], v11 offset:3744
ds_read_b64_tr_b16 v[70:71], v11 offset:4640
s_waitcnt lgkmcnt(12)
v_mfma_f32_32x32x16_bf16 v[204:219], v[44:47], v[92:95], v[204:219]
ds_read_b64_tr_b16 v[72:73], v11 offset:3776
ds_read_b64_tr_b16 v[74:75], v11 offset:4672
s_waitcnt vmcnt(2) lgkmcnt(12)
v_mfma_f32_32x32x16_bf16 v[108:123], v[48:51], v[96:99], v[108:123]
ds_read_b64_tr_b16 v[20:21], v11 offset:7168
ds_read_b64_tr_b16 v[22:23], v11 offset:8064
s_waitcnt lgkmcnt(12)
v_mfma_f32_32x32x16_bf16 v[124:139], v[52:55], v[96:99], v[124:139]
ds_read_b64_tr_b16 v[24:25], v11 offset:7200
ds_read_b64_tr_b16 v[26:27], v11 offset:8096
s_waitcnt lgkmcnt(12)
v_mfma_f32_32x32x16_bf16 v[140:155], v[56:59], v[96:99], v[140:155]
ds_read_b64_tr_b16 v[28:29], v11 offset:7232
ds_read_b64_tr_b16 v[30:31], v11 offset:8128
s_waitcnt lgkmcnt(12)
v_mfma_f32_32x32x16_bf16 v[156:171], v[60:63], v[96:99], v[156:171]
ds_read_b64_tr_b16 v[32:33], v11 offset:7264
ds_read_b64_tr_b16 v[34:35], v11 offset:8160
s_waitcnt lgkmcnt(12)
v_mfma_f32_32x32x16_bf16 v[172:187], v[64:67], v[96:99], v[172:187]
ds_read_b64_tr_b16 v[36:37], v11 offset:7296
ds_read_b64_tr_b16 v[38:39], v11 offset:8192
s_waitcnt lgkmcnt(12)
v_mfma_f32_32x32x16_bf16 v[188:203], v[68:71], v[96:99], v[188:203]
ds_read_b64_tr_b16 v[40:41], v11 offset:7328
ds_read_b64_tr_b16 v[42:43], v11 offset:8224
s_waitcnt lgkmcnt(12)
v_mfma_f32_32x32x16_bf16 v[204:219], v[72:75], v[96:99], v[204:219]
ds_read_b64_tr_b16 v[44:45], v11 offset:7360
ds_read_b64_tr_b16 v[46:47], v11 offset:8256
s_waitcnt vmcnt(1) lgkmcnt(12)
v_mfma_f32_32x32x16_bf16 v[108:123], v[20:23], v[100:103], v[108:123]
ds_read_b64_tr_b16 v[48:49], v11 offset:10752
ds_read_b64_tr_b16 v[50:51], v11 offset:11648
s_waitcnt lgkmcnt(12)
v_mfma_f32_32x32x16_bf16 v[124:139], v[24:27], v[100:103], v[124:139]
ds_read_b64_tr_b16 v[52:53], v11 offset:10784
ds_read_b64_tr_b16 v[54:55], v11 offset:11680
s_waitcnt lgkmcnt(12)
v_mfma_f32_32x32x16_bf16 v[140:155], v[28:31], v[100:103], v[140:155]
ds_read_b64_tr_b16 v[56:57], v11 offset:10816
ds_read_b64_tr_b16 v[58:59], v11 offset:11712
s_waitcnt lgkmcnt(12)
v_mfma_f32_32x32x16_bf16 v[156:171], v[32:35], v[100:103], v[156:171]
ds_read_b64_tr_b16 v[60:61], v11 offset:10848
ds_read_b64_tr_b16 v[62:63], v11 offset:11744
s_waitcnt lgkmcnt(12)
v_mfma_f32_32x32x16_bf16 v[172:187], v[36:39], v[100:103], v[172:187]
ds_read_b64_tr_b16 v[64:65], v11 offset:10880
ds_read_b64_tr_b16 v[66:67], v11 offset:11776
s_waitcnt lgkmcnt(12)
v_mfma_f32_32x32x16_bf16 v[188:203], v[40:43], v[100:103], v[188:203]
ds_read_b64_tr_b16 v[68:69], v11 offset:10912
ds_read_b64_tr_b16 v[70:71], v11 offset:11808
s_waitcnt lgkmcnt(12)
v_mfma_f32_32x32x16_bf16 v[204:219], v[44:47], v[100:103], v[204:219]
ds_read_b64_tr_b16 v[72:73], v11 offset:10944
ds_read_b64_tr_b16 v[74:75], v11 offset:11840
s_waitcnt vmcnt(0) lgkmcnt(12)
v_mfma_f32_32x32x16_bf16 v[108:123], v[48:51], v[104:107], v[108:123]
s_waitcnt lgkmcnt(10)
v_mfma_f32_32x32x16_bf16 v[124:139], v[52:55], v[104:107], v[124:139]
s_waitcnt lgkmcnt(8)
v_mfma_f32_32x32x16_bf16 v[140:155], v[56:59], v[104:107], v[140:155]
s_waitcnt lgkmcnt(6)
v_mfma_f32_32x32x16_bf16 v[156:171], v[60:63], v[104:107], v[156:171]
s_waitcnt lgkmcnt(4)
v_mfma_f32_32x32x16_bf16 v[172:187], v[64:67], v[104:107], v[172:187]
s_waitcnt lgkmcnt(2)
v_mfma_f32_32x32x16_bf16 v[188:203], v[68:71], v[104:107], v[188:203]
s_waitcnt lgkmcnt(0)
v_mfma_f32_32x32x16_bf16 v[204:219], v[72:75], v[104:107], v[204:219]
s_barrier
v_and_b32 v222, 31, v1
v_lshlrev_b32 v222, 3, v222
v_add_u32 v222, 2816, v222
ds_read_b64 v[220:221], v222
v_lshlrev_b32 v225, 4, v5
v_add_u32 v225, 0, v225
ds_read_b128 v[20:23], v225 offset:0
ds_read_b128 v[24:27], v225 offset:32
ds_read_b128 v[28:31], v225 offset:64
ds_read_b128 v[32:35], v225 offset:96
s_waitcnt lgkmcnt(4)
v_mul_f32 v226, v221, v221
s_lshl_b32 s7, s4, 2
s_add_u32 s7, s7, 3
s_mul_i32 s8, s7, 112
s_mul_i32 s9, s5, 7
s_add_u32 s8, s8, s9
s_lshl_b32 s8, s8, 10
s_add_u32 s8, s8, 16777216
ds_read_b128 v[36:39], v225 offset:128
ds_read_b128 v[40:43], v225 offset:160
ds_read_b128 v[44:47], v225 offset:192
ds_read_b128 v[48:51], v225 offset:224
s_waitcnt lgkmcnt(7)
v_pk_fma_f32 v[108:109], v[20:21], v[220:221], v[108:109] op_sel_hi:[1,0,1]
v_pk_fma_f32 v[110:111], v[22:23], v[220:221], v[110:111] op_sel_hi:[1,0,1]
s_waitcnt lgkmcnt(6)
v_pk_fma_f32 v[112:113], v[24:25], v[220:221], v[112:113] op_sel_hi:[1,0,1]
v_pk_fma_f32 v[114:115], v[26:27], v[220:221], v[114:115] op_sel_hi:[1,0,1]
s_waitcnt lgkmcnt(5)
v_pk_fma_f32 v[116:117], v[28:29], v[220:221], v[116:117] op_sel_hi:[1,0,1]
v_pk_fma_f32 v[118:119], v[30:31], v[220:221], v[118:119] op_sel_hi:[1,0,1]
s_waitcnt lgkmcnt(4)
v_pk_fma_f32 v[120:121], v[32:33], v[220:221], v[120:121] op_sel_hi:[1,0,1]
v_pk_fma_f32 v[122:123], v[34:35], v[220:221], v[122:123] op_sel_hi:[1,0,1]
v_max_f32 v108, 0, v108
v_max_f32 v109, 0, v109
v_max_f32 v110, 0, v110
v_max_f32 v111, 0, v111
v_max_f32 v112, 0, v112
v_max_f32 v113, 0, v113
v_max_f32 v114, 0, v114
v_max_f32 v115, 0, v115
v_pk_mul_f32 v[108:109], v[108:109], v[116:117]
v_pk_mul_f32 v[110:111], v[110:111], v[118:119]
v_pk_mul_f32 v[112:113], v[112:113], v[120:121]
v_pk_mul_f32 v[114:115], v[114:115], v[122:123]
v_pk_mul_f32 v[108:109], v[108:109], v[226:227] op_sel_hi:[1,0]
v_pk_mul_f32 v[110:111], v[110:111], v[226:227] op_sel_hi:[1,0]
v_pk_mul_f32 v[112:113], v[112:113], v[226:227] op_sel_hi:[1,0]
v_pk_mul_f32 v[114:115], v[114:115], v[226:227] op_sel_hi:[1,0]
v_cvt_pk_bf16_f32 v52, v108, v109
v_cvt_pk_bf16_f32 v53, v110, v111
v_cvt_pk_bf16_f32 v54, v112, v113
v_cvt_pk_bf16_f32 v55, v114, v115
s_nop 0
v_permlane32_swap_b32 v52, v54
v_permlane32_swap_b32 v53, v55
buffer_store_dwordx4 v[52:55], v3, s[52:55], s8 offen offset:0
ds_read_b128 v[20:23], v225 offset:256
ds_read_b128 v[24:27], v225 offset:288
ds_read_b128 v[28:31], v225 offset:320
ds_read_b128 v[32:35], v225 offset:352
s_waitcnt lgkmcnt(7)
v_pk_fma_f32 v[124:125], v[36:37], v[220:221], v[124:125] op_sel_hi:[1,0,1]
v_pk_fma_f32 v[126:127], v[38:39], v[220:221], v[126:127] op_sel_hi:[1,0,1]
s_waitcnt lgkmcnt(6)
v_pk_fma_f32 v[128:129], v[40:41], v[220:221], v[128:129] op_sel_hi:[1,0,1]
v_pk_fma_f32 v[130:131], v[42:43], v[220:221], v[130:131] op_sel_hi:[1,0,1]
s_waitcnt lgkmcnt(5)
v_pk_fma_f32 v[132:133], v[44:45], v[220:221], v[132:133] op_sel_hi:[1,0,1]
v_pk_fma_f32 v[134:135], v[46:47], v[220:221], v[134:135] op_sel_hi:[1,0,1]
s_waitcnt lgkmcnt(4)
v_pk_fma_f32 v[136:137], v[48:49], v[220:221], v[136:137] op_sel_hi:[1,0,1]
v_pk_fma_f32 v[138:139], v[50:51], v[220:221], v[138:139] op_sel_hi:[1,0,1]
v_max_f32 v124, 0, v124
v_max_f32 v125, 0, v125
v_max_f32 v126, 0, v126
v_max_f32 v127, 0, v127
v_max_f32 v128, 0, v128
v_max_f32 v129, 0, v129
v_max_f32 v130, 0, v130
v_max_f32 v131, 0, v131
v_pk_mul_f32 v[124:125], v[124:125], v[132:133]
v_pk_mul_f32 v[126:127], v[126:127], v[134:135]
v_pk_mul_f32 v[128:129], v[128:129], v[136:137]
v_pk_mul_f32 v[130:131], v[130:131], v[138:139]
v_pk_mul_f32 v[124:125], v[124:125], v[226:227] op_sel_hi:[1,0]
v_pk_mul_f32 v[126:127], v[126:127], v[226:227] op_sel_hi:[1,0]
v_pk_mul_f32 v[128:129], v[128:129], v[226:227] op_sel_hi:[1,0]
v_pk_mul_f32 v[130:131], v[130:131], v[226:227] op_sel_hi:[1,0]
v_cvt_pk_bf16_f32 v56, v124, v125
v_cvt_pk_bf16_f32 v57, v126, v127
v_cvt_pk_bf16_f32 v58, v128, v129
v_cvt_pk_bf16_f32 v59, v130, v131
s_nop 0
v_permlane32_swap_b32 v56, v58
v_permlane32_swap_b32 v57, v59
buffer_store_dwordx4 v[56:59], v3, s[52:55], s8 offen offset:1024
ds_read_b128 v[36:39], v225 offset:384
ds_read_b128 v[40:43], v225 offset:416
ds_read_b128 v[44:47], v225 offset:448
ds_read_b128 v[48:51], v225 offset:480
s_waitcnt lgkmcnt(7)
v_pk_fma_f32 v[140:141], v[20:21], v[220:221], v[140:141] op_sel_hi:[1,0,1]
v_pk_fma_f32 v[142:143], v[22:23], v[220:221], v[142:143] op_sel_hi:[1,0,1]
s_waitcnt lgkmcnt(6)
v_pk_fma_f32 v[144:145], v[24:25], v[220:221], v[144:145] op_sel_hi:[1,0,1]
v_pk_fma_f32 v[146:147], v[26:27], v[220:221], v[146:147] op_sel_hi:[1,0,1]
s_waitcnt lgkmcnt(5)
v_pk_fma_f32 v[148:149], v[28:29], v[220:221], v[148:149] op_sel_hi:[1,0,1]
v_pk_fma_f32 v[150:151], v[30:31], v[220:221], v[150:151] op_sel_hi:[1,0,1]
s_waitcnt lgkmcnt(4)
v_pk_fma_f32 v[152:153], v[32:33], v[220:221], v[152:153] op_sel_hi:[1,0,1]
v_pk_fma_f32 v[154:155], v[34:35], v[220:221], v[154:155] op_sel_hi:[1,0,1]
v_max_f32 v140, 0, v140
v_max_f32 v141, 0, v141
v_max_f32 v142, 0, v142
v_max_f32 v143, 0, v143
v_max_f32 v144, 0, v144
v_max_f32 v145, 0, v145
v_max_f32 v146, 0, v146
v_max_f32 v147, 0, v147
v_pk_mul_f32 v[140:141], v[140:141], v[148:149]
v_pk_mul_f32 v[142:143], v[142:143], v[150:151]
v_pk_mul_f32 v[144:145], v[144:145], v[152:153]
v_pk_mul_f32 v[146:147], v[146:147], v[154:155]
v_pk_mul_f32 v[140:141], v[140:141], v[226:227] op_sel_hi:[1,0]
v_pk_mul_f32 v[142:143], v[142:143], v[226:227] op_sel_hi:[1,0]
v_pk_mul_f32 v[144:145], v[144:145], v[226:227] op_sel_hi:[1,0]
v_pk_mul_f32 v[146:147], v[146:147], v[226:227] op_sel_hi:[1,0]
v_cvt_pk_bf16_f32 v52, v140, v141
v_cvt_pk_bf16_f32 v53, v142, v143
v_cvt_pk_bf16_f32 v54, v144, v145
v_cvt_pk_bf16_f32 v55, v146, v147
s_nop 0
v_permlane32_swap_b32 v52, v54
v_permlane32_swap_b32 v53, v55
buffer_store_dwordx4 v[52:55], v3, s[52:55], s8 offen offset:2048
ds_read_b128 v[20:23], v225 offset:512
ds_read_b128 v[24:27], v225 offset:544
ds_read_b128 v[28:31], v225 offset:576
ds_read_b128 v[32:35], v225 offset:608
s_waitcnt lgkmcnt(7)
v_pk_fma_f32 v[156:157], v[36:37], v[220:221], v[156:157] op_sel_hi:[1,0,1]
v_pk_fma_f32 v[158:159], v[38:39], v[220:221], v[158:159] op_sel_hi:[1,0,1]
s_waitcnt lgkmcnt(6)
v_pk_fma_f32 v[160:161], v[40:41], v[220:221], v[160:161] op_sel_hi:[1,0,1]
v_pk_fma_f32 v[162:163], v[42:43], v[220:221], v[162:163] op_sel_hi:[1,0,1]
s_waitcnt lgkmcnt(5)
v_pk_fma_f32 v[164:165], v[44:45], v[220:221], v[164:165] op_sel_hi:[1,0,1]
v_pk_fma_f32 v[166:167], v[46:47], v[220:221], v[166:167] op_sel_hi:[1,0,1]
s_waitcnt lgkmcnt(4)
v_pk_fma_f32 v[168:169], v[48:49], v[220:221], v[168:169] op_sel_hi:[1,0,1]
v_pk_fma_f32 v[170:171], v[50:51], v[220:221], v[170:171] op_sel_hi:[1,0,1]
v_max_f32 v156, 0, v156
v_max_f32 v157, 0, v157
v_max_f32 v158, 0, v158
v_max_f32 v159, 0, v159
v_max_f32 v160, 0, v160
v_max_f32 v161, 0, v161
v_max_f32 v162, 0, v162
v_max_f32 v163, 0, v163
v_pk_mul_f32 v[156:157], v[156:157], v[164:165]
v_pk_mul_f32 v[158:159], v[158:159], v[166:167]
v_pk_mul_f32 v[160:161], v[160:161], v[168:169]
v_pk_mul_f32 v[162:163], v[162:163], v[170:171]
v_pk_mul_f32 v[156:157], v[156:157], v[226:227] op_sel_hi:[1,0]
v_pk_mul_f32 v[158:159], v[158:159], v[226:227] op_sel_hi:[1,0]
v_pk_mul_f32 v[160:161], v[160:161], v[226:227] op_sel_hi:[1,0]
v_pk_mul_f32 v[162:163], v[162:163], v[226:227] op_sel_hi:[1,0]
v_cvt_pk_bf16_f32 v56, v156, v157
v_cvt_pk_bf16_f32 v57, v158, v159
v_cvt_pk_bf16_f32 v58, v160, v161
v_cvt_pk_bf16_f32 v59, v162, v163
s_nop 0
v_permlane32_swap_b32 v56, v58
v_permlane32_swap_b32 v57, v59
buffer_store_dwordx4 v[56:59], v3, s[52:55], s8 offen offset:3072
ds_read_b128 v[36:39], v225 offset:640
ds_read_b128 v[40:43], v225 offset:672
ds_read_b128 v[44:47], v225 offset:704
ds_read_b128 v[48:51], v225 offset:736
s_waitcnt lgkmcnt(7)
v_pk_fma_f32 v[172:173], v[20:21], v[220:221], v[172:173] op_sel_hi:[1,0,1]
v_pk_fma_f32 v[174:175], v[22:23], v[220:221], v[174:175] op_sel_hi:[1,0,1]
s_waitcnt lgkmcnt(6)
v_pk_fma_f32 v[176:177], v[24:25], v[220:221], v[176:177] op_sel_hi:[1,0,1]
v_pk_fma_f32 v[178:179], v[26:27], v[220:221], v[178:179] op_sel_hi:[1,0,1]
s_waitcnt lgkmcnt(5)
v_pk_fma_f32 v[180:181], v[28:29], v[220:221], v[180:181] op_sel_hi:[1,0,1]
v_pk_fma_f32 v[182:183], v[30:31], v[220:221], v[182:183] op_sel_hi:[1,0,1]
s_waitcnt lgkmcnt(4)
v_pk_fma_f32 v[184:185], v[32:33], v[220:221], v[184:185] op_sel_hi:[1,0,1]
v_pk_fma_f32 v[186:187], v[34:35], v[220:221], v[186:187] op_sel_hi:[1,0,1]
v_max_f32 v172, 0, v172
v_max_f32 v173, 0, v173
v_max_f32 v174, 0, v174
v_max_f32 v175, 0, v175
v_max_f32 v176, 0, v176
v_max_f32 v177, 0, v177
v_max_f32 v178, 0, v178
v_max_f32 v179, 0, v179
v_pk_mul_f32 v[172:173], v[172:173], v[180:181]
v_pk_mul_f32 v[174:175], v[174:175], v[182:183]
v_pk_mul_f32 v[176:177], v[176:177], v[184:185]
v_pk_mul_f32 v[178:179], v[178:179], v[186:187]
v_pk_mul_f32 v[172:173], v[172:173], v[226:227] op_sel_hi:[1,0]
v_pk_mul_f32 v[174:175], v[174:175], v[226:227] op_sel_hi:[1,0]
v_pk_mul_f32 v[176:177], v[176:177], v[226:227] op_sel_hi:[1,0]
v_pk_mul_f32 v[178:179], v[178:179], v[226:227] op_sel_hi:[1,0]
v_cvt_pk_bf16_f32 v52, v172, v173
v_cvt_pk_bf16_f32 v53, v174, v175
v_cvt_pk_bf16_f32 v54, v176, v177
v_cvt_pk_bf16_f32 v55, v178, v179
s_nop 0
v_permlane32_swap_b32 v52, v54
v_permlane32_swap_b32 v53, v55
s_add_u32 s8, s8, 4096
buffer_store_dwordx4 v[52:55], v3, s[52:55], s8 offen offset:0
ds_read_b128 v[20:23], v225 offset:768
ds_read_b128 v[24:27], v225 offset:800
ds_read_b128 v[28:31], v225 offset:832
ds_read_b128 v[32:35], v225 offset:864
s_waitcnt lgkmcnt(7)
v_pk_fma_f32 v[188:189], v[36:37], v[220:221], v[188:189] op_sel_hi:[1,0,1]
v_pk_fma_f32 v[190:191], v[38:39], v[220:221], v[190:191] op_sel_hi:[1,0,1]
s_waitcnt lgkmcnt(6)
v_pk_fma_f32 v[192:193], v[40:41], v[220:221], v[192:193] op_sel_hi:[1,0,1]
v_pk_fma_f32 v[194:195], v[42:43], v[220:221], v[194:195] op_sel_hi:[1,0,1]
s_waitcnt lgkmcnt(5)
v_pk_fma_f32 v[196:197], v[44:45], v[220:221], v[196:197] op_sel_hi:[1,0,1]
v_pk_fma_f32 v[198:199], v[46:47], v[220:221], v[198:199] op_sel_hi:[1,0,1]
s_waitcnt lgkmcnt(4)
v_pk_fma_f32 v[200:201], v[48:49], v[220:221], v[200:201] op_sel_hi:[1,0,1]
v_pk_fma_f32 v[202:203], v[50:51], v[220:221], v[202:203] op_sel_hi:[1,0,1]
v_max_f32 v188, 0, v188
v_max_f32 v189, 0, v189
v_max_f32 v190, 0, v190
v_max_f32 v191, 0, v191
v_max_f32 v192, 0, v192
v_max_f32 v193, 0, v193
v_max_f32 v194, 0, v194
v_max_f32 v195, 0, v195
v_pk_mul_f32 v[188:189], v[188:189], v[196:197]
v_pk_mul_f32 v[190:191], v[190:191], v[198:199]
v_pk_mul_f32 v[192:193], v[192:193], v[200:201]
v_pk_mul_f32 v[194:195], v[194:195], v[202:203]
v_pk_mul_f32 v[188:189], v[188:189], v[226:227] op_sel_hi:[1,0]
v_pk_mul_f32 v[190:191], v[190:191], v[226:227] op_sel_hi:[1,0]
v_pk_mul_f32 v[192:193], v[192:193], v[226:227] op_sel_hi:[1,0]
v_pk_mul_f32 v[194:195], v[194:195], v[226:227] op_sel_hi:[1,0]
v_cvt_pk_bf16_f32 v56, v188, v189
v_cvt_pk_bf16_f32 v57, v190, v191
v_cvt_pk_bf16_f32 v58, v192, v193
v_cvt_pk_bf16_f32 v59, v194, v195
s_nop 0
v_permlane32_swap_b32 v56, v58
v_permlane32_swap_b32 v57, v59
buffer_store_dwordx4 v[56:59], v3, s[52:55], s8 offen offset:1024
s_waitcnt lgkmcnt(3)
v_pk_fma_f32 v[204:205], v[20:21], v[220:221], v[204:205] op_sel_hi:[1,0,1]
v_pk_fma_f32 v[206:207], v[22:23], v[220:221], v[206:207] op_sel_hi:[1,0,1]
s_waitcnt lgkmcnt(2)
v_pk_fma_f32 v[208:209], v[24:25], v[220:221], v[208:209] op_sel_hi:[1,0,1]
v_pk_fma_f32 v[210:211], v[26:27], v[220:221], v[210:211] op_sel_hi:[1,0,1]
s_waitcnt lgkmcnt(1)
v_pk_fma_f32 v[212:213], v[28:29], v[220:221], v[212:213] op_sel_hi:[1,0,1]
v_pk_fma_f32 v[214:215], v[30:31], v[220:221], v[214:215] op_sel_hi:[1,0,1]
s_waitcnt lgkmcnt(0)
v_pk_fma_f32 v[216:217], v[32:33], v[220:221], v[216:217] op_sel_hi:[1,0,1]
v_pk_fma_f32 v[218:219], v[34:35], v[220:221], v[218:219] op_sel_hi:[1,0,1]
v_max_f32 v204, 0, v204
v_max_f32 v205, 0, v205
v_max_f32 v206, 0, v206
v_max_f32 v207, 0, v207
v_max_f32 v208, 0, v208
v_max_f32 v209, 0, v209
v_max_f32 v210, 0, v210
v_max_f32 v211, 0, v211
v_pk_mul_f32 v[204:205], v[204:205], v[212:213]
v_pk_mul_f32 v[206:207], v[206:207], v[214:215]
v_pk_mul_f32 v[208:209], v[208:209], v[216:217]
v_pk_mul_f32 v[210:211], v[210:211], v[218:219]
v_pk_mul_f32 v[204:205], v[204:205], v[226:227] op_sel_hi:[1,0]
v_pk_mul_f32 v[206:207], v[206:207], v[226:227] op_sel_hi:[1,0]
v_pk_mul_f32 v[208:209], v[208:209], v[226:227] op_sel_hi:[1,0]
v_pk_mul_f32 v[210:211], v[210:211], v[226:227] op_sel_hi:[1,0]
v_cvt_pk_bf16_f32 v52, v204, v205
v_cvt_pk_bf16_f32 v53, v206, v207
v_cvt_pk_bf16_f32 v54, v208, v209
v_cvt_pk_bf16_f32 v55, v210, v211
s_nop 0
v_permlane32_swap_b32 v52, v54
v_permlane32_swap_b32 v53, v55
buffer_store_dwordx4 v[52:55], v3, s[52:55], s8 offen offset:2048
s_waitcnt vmcnt(0)
s_branch k4_kernel_end
k4_kernel_w4:
v_add_u32 v9, 0, v1
s_mov_b32 s7, 4682
v_mul_lo_u32 v10, v9, s7
v_lshrrev_b32 v10, 16, v10
v_mul_u32_u24 v11, 14, v10
v_sub_u32 v11, v9, v11
v_lshlrev_b32 v11, 4, v11
s_mov_b32 s7, 3584
v_mul_lo_u32 v10, v10, s7
v_add_u32 v15, v10, v11
v_add_u32 v9, 64, v1
s_mov_b32 s7, 4682
v_mul_lo_u32 v10, v9, s7
v_lshrrev_b32 v10, 16, v10
v_mul_u32_u24 v11, 14, v10
v_sub_u32 v11, v9, v11
v_lshlrev_b32 v11, 4, v11
s_mov_b32 s7, 3584
v_mul_lo_u32 v10, v10, s7
v_add_u32 v16, v10, v11
v_add_u32 v9, 128, v1
s_mov_b32 s7, 4682
v_mul_lo_u32 v10, v9, s7
v_lshrrev_b32 v10, 16, v10
v_mul_u32_u24 v11, 14, v10
v_sub_u32 v11, v9, v11
v_lshlrev_b32 v11, 4, v11
s_mov_b32 s7, 3584
v_mul_lo_u32 v10, v10, s7
v_add_u32 v17, v10, v11
v_add_u32 v9, 192, v1
s_mov_b32 s7, 4682
v_mul_lo_u32 v10, v9, s7
v_lshrrev_b32 v10, 16, v10
v_mul_u32_u24 v11, 14, v10
v_sub_u32 v11, v9, v11
v_lshlrev_b32 v11, 4, v11
s_mov_b32 s7, 3584
v_mul_lo_u32 v10, v10, s7
v_add_u32 v18, v10, v11
v_add_u32 v9, 256, v1
s_mov_b32 s7, 4682
v_mul_lo_u32 v10, v9, s7
v_lshrrev_b32 v10, 16, v10
v_mul_u32_u24 v11, 14, v10
v_sub_u32 v11, v9, v11
v_lshlrev_b32 v11, 4, v11
s_mov_b32 s7, 3584
v_mul_lo_u32 v10, v10, s7
v_add_u32 v19, v10, v11
v_add_u32 v9, 320, v1
s_mov_b32 s7, 4682
v_mul_lo_u32 v10, v9, s7
v_lshrrev_b32 v10, 16, v10
v_mul_u32_u24 v11, 14, v10
v_sub_u32 v11, v9, v11
v_lshlrev_b32 v11, 4, v11
s_mov_b32 s7, 3584
v_mul_lo_u32 v10, v10, s7
v_add_u32 v20, v10, v11
v_add_u32 v9, 384, v1
s_mov_b32 s7, 4682
v_mul_lo_u32 v10, v9, s7
v_lshrrev_b32 v10, 16, v10
v_mul_u32_u24 v11, 14, v10
v_sub_u32 v11, v9, v11
v_lshlrev_b32 v11, 4, v11
s_mov_b32 s7, 3584
v_mul_lo_u32 v10, v10, s7
v_add_u32 v21, v10, v11
s_mov_b32 m0, 0
s_mov_b32 s60, 0
buffer_load_dwordx4 v15, s[44:47], s60 offen lds
s_mov_b32 m0, 1024
s_mov_b32 s60, 0
buffer_load_dwordx4 v16, s[44:47], s60 offen lds
s_mov_b32 m0, 2048
s_mov_b32 s60, 0
buffer_load_dwordx4 v17, s[44:47], s60 offen lds
s_mov_b32 m0, 3072
s_mov_b32 s60, 0
buffer_load_dwordx4 v18, s[44:47], s60 offen lds
s_mov_b32 m0, 4096
s_mov_b32 s60, 0
buffer_load_dwordx4 v19, s[44:47], s60 offen lds
s_mov_b32 m0, 5120
s_mov_b32 s60, 0
buffer_load_dwordx4 v20, s[44:47], s60 offen lds
s_mov_b32 m0, 6144
s_mov_b32 s60, 0
buffer_load_dwordx4 v21, s[44:47], s60 offen lds
s_mov_b32 m0, 28928
s_mov_b32 s60, 229376
buffer_load_dwordx4 v15, s[44:47], s60 offen lds
s_mov_b32 m0, 29952
s_mov_b32 s60, 229376
buffer_load_dwordx4 v16, s[44:47], s60 offen lds
s_mov_b32 m0, 30976
s_mov_b32 s60, 229376
buffer_load_dwordx4 v17, s[44:47], s60 offen lds
s_mov_b32 m0, 32000
s_mov_b32 s60, 229376
buffer_load_dwordx4 v18, s[44:47], s60 offen lds
s_mov_b32 m0, 33024
s_mov_b32 s60, 229376
buffer_load_dwordx4 v19, s[44:47], s60 offen lds
s_mov_b32 m0, 34048
s_mov_b32 s60, 229376
buffer_load_dwordx4 v20, s[44:47], s60 offen lds
s_mov_b32 m0, 35072
s_mov_b32 s60, 229376
buffer_load_dwordx4 v21, s[44:47], s60 offen lds
s_mov_b32 m0, 57856
s_mov_b32 s60, 458752
buffer_load_dwordx4 v15, s[44:47], s60 offen lds
s_mov_b32 m0, 58880
s_mov_b32 s60, 458752
buffer_load_dwordx4 v16, s[44:47], s60 offen lds
s_mov_b32 m0, 59904
s_mov_b32 s60, 458752
buffer_load_dwordx4 v17, s[44:47], s60 offen lds
s_mov_b32 m0, 60928
s_mov_b32 s60, 458752
buffer_load_dwordx4 v18, s[44:47], s60 offen lds
s_mov_b32 m0, 61952
s_mov_b32 s60, 458752
buffer_load_dwordx4 v19, s[44:47], s60 offen lds
s_mov_b32 m0, 62976
s_mov_b32 s60, 458752
buffer_load_dwordx4 v20, s[44:47], s60 offen lds
s_mov_b32 m0, 64000
s_mov_b32 s60, 458752
buffer_load_dwordx4 v21, s[44:47], s60 offen lds
s_lshl_b32 s7, s4, 2
s_add_u32 s7, s7, 0
s_lshl_b32 s7, s7, 12
s_add_u32 s7, s7, 14680064
buffer_load_dwordx4 v[24:27], v3, s[52:55], s7 offen offset:0
buffer_load_dwordx4 v[28:31], v3, s[52:55], s7 offen offset:1024
buffer_load_dwordx4 v[32:35], v3, s[52:55], s7 offen offset:2048
buffer_load_dwordx4 v[36:39], v3, s[52:55], s7 offen offset:3072
v_mov_b32 v168, 0
v_cmp_le_u32 vcc, 28, v1
s_nop 1
v_cndmask_b32 v168, 0, v168, vcc
v_mov_b32 v168, v1
v_subrev_u32 v40, 28, v1
v_cndmask_b32 v168, v1, v40, vcc
v_lshlrev_b32 v168, 4, v168
v_mov_b32 v40, 0
v_mov_b32 v41, 7168
v_cndmask_b32 v40, v40, v41, vcc
v_add_u32 v168, v168, v40
s_mul_i32 s7, s5, 448
s_add_u32 s7, s7, 15728640
s_add_u32 s60, s7, 0
buffer_load_dwordx4 v[40:43], v168, s[52:55], s60 offen
s_add_u32 s60, s7, 14336
buffer_load_dwordx4 v[44:47], v168, s[52:55], s60 offen
s_add_u32 s60, s7, 28672
buffer_load_dwordx4 v[48:51], v168, s[52:55], s60 offen
s_add_u32 s60, s7, 43008
buffer_load_dwordx4 v[52:55], v168, s[52:55], s60 offen
s_add_u32 s60, s7, 57344
buffer_load_dwordx4 v[56:59], v168, s[52:55], s60 offen
s_add_u32 s60, s7, 71680
buffer_load_dwordx4 v[60:63], v168, s[52:55], s60 offen
s_add_u32 s60, s7, 86016
buffer_load_dwordx4 v[64:67], v168, s[52:55], s60 offen
s_add_u32 s60, s7, 100352
buffer_load_dwordx4 v[68:71], v168, s[52:55], s60 offen
s_add_u32 s60, s7, 114688
buffer_load_dwordx4 v[72:75], v168, s[52:55], s60 offen
s_add_u32 s60, s7, 129024
buffer_load_dwordx4 v[76:79], v168, s[52:55], s60 offen
s_add_u32 s60, s7, 143360
buffer_load_dwordx4 v[80:83], v168, s[52:55], s60 offen
s_add_u32 s60, s7, 157696
buffer_load_dwordx4 v[84:87], v168, s[52:55], s60 offen
s_add_u32 s60, s7, 172032
buffer_load_dwordx4 v[88:91], v168, s[52:55], s60 offen
s_add_u32 s60, s7, 186368
buffer_load_dwordx4 v[92:95], v168, s[52:55], s60 offen
s_add_u32 s60, s7, 200704
buffer_load_dwordx4 v[96:99], v168, s[52:55], s60 offen
s_add_u32 s60, s7, 215040
buffer_load_dwordx4 v[100:103], v168, s[52:55], s60 offen
s_add_u32 s60, s7, 229376
buffer_load_dwordx4 v[104:107], v168, s[52:55], s60 offen
s_add_u32 s60, s7, 243712
buffer_load_dwordx4 v[108:111], v168, s[52:55], s60 offen
s_add_u32 s60, s7, 258048
buffer_load_dwordx4 v[112:115], v168, s[52:55], s60 offen
s_add_u32 s60, s7, 272384
buffer_load_dwordx4 v[116:119], v168, s[52:55], s60 offen
s_add_u32 s60, s7, 286720
buffer_load_dwordx4 v[120:123], v168, s[52:55], s60 offen
s_add_u32 s60, s7, 301056
buffer_load_dwordx4 v[124:127], v168, s[52:55], s60 offen
s_add_u32 s60, s7, 315392
buffer_load_dwordx4 v[128:131], v168, s[52:55], s60 offen
s_add_u32 s60, s7, 329728
buffer_load_dwordx4 v[132:135], v168, s[52:55], s60 offen
s_add_u32 s60, s7, 344064
buffer_load_dwordx4 v[136:139], v168, s[52:55], s60 offen
s_add_u32 s60, s7, 358400
buffer_load_dwordx4 v[140:143], v168, s[52:55], s60 offen
s_add_u32 s60, s7, 372736
buffer_load_dwordx4 v[144:147], v168, s[52:55], s60 offen
s_add_u32 s60, s7, 387072
buffer_load_dwordx4 v[148:151], v168, s[52:55], s60 offen
s_add_u32 s60, s7, 401408
buffer_load_dwordx4 v[152:155], v168, s[52:55], s60 offen
s_add_u32 s60, s7, 415744
buffer_load_dwordx4 v[156:159], v168, s[52:55], s60 offen
s_add_u32 s60, s7, 430080
buffer_load_dwordx4 v[160:163], v168, s[52:55], s60 offen
s_add_u32 s60, s7, 444416
buffer_load_dwordx4 v[164:167], v168, s[52:55], s60 offen
v_lshlrev_b32 v169, 2, v1
v_subrev_u32 v168, 112, v169
v_cndmask_b32 v169, v169, v168, vcc
v_lshrrev_b32 v168, 4, v169
v_and_b32 v169, 15, v169
v_lshl_add_u32 v169, v168, 5, v169
v_mov_b32 v168, 0
v_cndmask_b32 v168, 0, 16, vcc
v_add_u32 v169, v169, v168
v_lshlrev_b32 v169, 2, v169
v_mul_u32_u24 v9, 224, v7
v_lshl_add_u32 v9, v8, 3, v9
v_mul_u32_u24 v10, 14464, v6
v_add_u32 v170, v9, v10
s_waitcnt vmcnt(50)
s_barrier
s_mov_b32 m0, 86784
s_mov_b32 s60, 688128
buffer_load_dwordx4 v15, s[44:47], s60 offen lds
s_mov_b32 m0, 87808
s_mov_b32 s60, 688128
buffer_load_dwordx4 v16, s[44:47], s60 offen lds
s_mov_b32 m0, 88832
s_mov_b32 s60, 688128
buffer_load_dwordx4 v17, s[44:47], s60 offen lds
s_mov_b32 m0, 89856
s_mov_b32 s60, 688128
buffer_load_dwordx4 v18, s[44:47], s60 offen lds
s_mov_b32 m0, 90880
s_mov_b32 s60, 688128
buffer_load_dwordx4 v19, s[44:47], s60 offen lds
s_mov_b32 m0, 91904
s_mov_b32 s60, 688128
buffer_load_dwordx4 v20, s[44:47], s60 offen lds
s_mov_b32 m0, 92928
s_mov_b32 s60, 688128
buffer_load_dwordx4 v21, s[44:47], s60 offen lds
s_waitcnt vmcnt(50)
s_barrier
s_mov_b32 m0, 115712
s_mov_b32 s60, 917504
buffer_load_dwordx4 v15, s[44:47], s60 offen lds
s_mov_b32 m0, 116736
s_mov_b32 s60, 917504
buffer_load_dwordx4 v16, s[44:47], s60 offen lds
s_mov_b32 m0, 117760
s_mov_b32 s60, 917504
buffer_load_dwordx4 v17, s[44:47], s60 offen lds
s_mov_b32 m0, 118784
s_mov_b32 s60, 917504
buffer_load_dwordx4 v18, s[44:47], s60 offen lds
s_mov_b32 m0, 119808
s_mov_b32 s60, 917504
buffer_load_dwordx4 v19, s[44:47], s60 offen lds
s_mov_b32 m0, 120832
s_mov_b32 s60, 917504
buffer_load_dwordx4 v20, s[44:47], s60 offen lds
s_mov_b32 m0, 121856
s_mov_b32 s60, 917504
buffer_load_dwordx4 v21, s[44:47], s60 offen lds
s_waitcnt vmcnt(50)
s_barrier
s_mov_b32 m0, 0
s_mov_b32 s60, 1146880
buffer_load_dwordx4 v15, s[44:47], s60 offen lds
s_mov_b32 m0, 1024
s_mov_b32 s60, 1146880
buffer_load_dwordx4 v16, s[44:47], s60 offen lds
s_mov_b32 m0, 2048
s_mov_b32 s60, 1146880
buffer_load_dwordx4 v17, s[44:47], s60 offen lds
s_mov_b32 m0, 3072
s_mov_b32 s60, 1146880
buffer_load_dwordx4 v18, s[44:47], s60 offen lds
s_mov_b32 m0, 4096
s_mov_b32 s60, 1146880
buffer_load_dwordx4 v19, s[44:47], s60 offen lds
s_mov_b32 m0, 5120
s_mov_b32 s60, 1146880
buffer_load_dwordx4 v20, s[44:47], s60 offen lds
s_mov_b32 m0, 6144
s_mov_b32 s60, 1146880
buffer_load_dwordx4 v21, s[44:47], s60 offen lds
s_waitcnt vmcnt(14)
s_barrier
s_mov_b32 m0, 28928
s_mov_b32 s60, 1376256
buffer_load_dwordx4 v15, s[44:47], s60 offen lds
s_mov_b32 m0, 29952
s_mov_b32 s60, 1376256
buffer_load_dwordx4 v16, s[44:47], s60 offen lds
s_mov_b32 m0, 30976
s_mov_b32 s60, 1376256
buffer_load_dwordx4 v17, s[44:47], s60 offen lds
s_mov_b32 m0, 32000
s_mov_b32 s60, 1376256
buffer_load_dwordx4 v18, s[44:47], s60 offen lds
s_mov_b32 m0, 33024
s_mov_b32 s60, 1376256
buffer_load_dwordx4 v19, s[44:47], s60 offen lds
s_mov_b32 m0, 34048
s_mov_b32 s60, 1376256
buffer_load_dwordx4 v20, s[44:47], s60 offen lds
s_mov_b32 m0, 35072
s_mov_b32 s60, 1376256
buffer_load_dwordx4 v21, s[44:47], s60 offen lds
s_waitcnt vmcnt(14)
s_barrier
s_mov_b32 m0, 57856
s_mov_b32 s60, 1605632
buffer_load_dwordx4 v15, s[44:47], s60 offen lds
s_mov_b32 m0, 58880
s_mov_b32 s60, 1605632
buffer_load_dwordx4 v16, s[44:47], s60 offen lds
s_mov_b32 m0, 59904
s_mov_b32 s60, 1605632
buffer_load_dwordx4 v17, s[44:47], s60 offen lds
s_mov_b32 m0, 60928
s_mov_b32 s60, 1605632
buffer_load_dwordx4 v18, s[44:47], s60 offen lds
s_mov_b32 m0, 61952
s_mov_b32 s60, 1605632
buffer_load_dwordx4 v19, s[44:47], s60 offen lds
s_mov_b32 m0, 62976
s_mov_b32 s60, 1605632
buffer_load_dwordx4 v20, s[44:47], s60 offen lds
s_mov_b32 m0, 64000
s_mov_b32 s60, 1605632
buffer_load_dwordx4 v21, s[44:47], s60 offen lds
s_waitcnt vmcnt(14)
s_barrier
s_waitcnt vmcnt(7)
s_barrier
s_waitcnt vmcnt(0)
s_barrier
v_and_b32 v9, 31, v1
v_lshlrev_b32 v10, 2, v9
v_add_u32 v10, 0, v10
v_lshlrev_b32 v11, 3, v9
v_add_u32 v11, 2048, v11
v_add_f32 v172, v24, v26
v_add_f32 v173, v25, v27
v_add_f32 v172, v172, v28
v_add_f32 v173, v173, v29
v_add_f32 v172, v172, v30
v_add_f32 v173, v173, v31
v_add_f32 v172, v172, v32
v_add_f32 v173, v173, v33
v_add_f32 v172, v172, v34
v_add_f32 v173, v173, v35
v_add_f32 v172, v172, v36
v_add_f32 v173, v173, v37
v_add_f32 v172, v172, v38
v_add_f32 v173, v173, v39
v_mov_b32 v174, v172
v_mov_b32 v175, v172
s_nop 1
v_permlane32_swap_b32 v174, v175
v_add_f32 v172, v174, v175
v_mov_b32 v176, v173
v_mov_b32 v177, v173
s_nop 1
v_permlane32_swap_b32 v176, v177
v_add_f32 v173, v176, v177
v_mul_f32 v172, 0x3b000000, v172
v_mul_f32 v173, 0x3b000000, v173
v_fma_f32 v173, -v172, v172, v173
v_max_f32 v173, 0, v173
v_cvt_pk_bf16_f32 v172, v172, v172
v_cvt_pk_bf16_f32 v173, v173, v173
v_lshlrev_b32 v172, 16, v172
v_lshlrev_b32 v173, 16, v173
v_add_f32 v173, 0x3727c5ac, v173
v_cvt_pk_bf16_f32 v173, v173, v173
v_lshlrev_b32 v173, 16, v173
v_sqrt_f32 v173, v173
s_nop 0
v_cvt_pk_bf16_f32 v173, v173, v173
v_lshlrev_b32 v173, 16, v173
v_rcp_f32 v173, v173
v_sub_f32 v172, 0, v172
v_add_f32 v40, v40, v44
v_add_f32 v41, v41, v45
v_add_f32 v42, v42, v46
v_add_f32 v43, v43, v47
v_add_f32 v40, v40, v48
v_add_f32 v41, v41, v49
v_add_f32 v42, v42, v50
v_add_f32 v43, v43, v51
v_add_f32 v40, v40, v52
v_add_f32 v41, v41, v53
v_add_f32 v42, v42, v54
v_add_f32 v43, v43, v55
v_add_f32 v40, v40, v56
v_add_f32 v41, v41, v57
v_add_f32 v42, v42, v58
v_add_f32 v43, v43, v59
v_add_f32 v40, v40, v60
v_add_f32 v41, v41, v61
v_add_f32 v42, v42, v62
v_add_f32 v43, v43, v63
v_add_f32 v40, v40, v64
v_add_f32 v41, v41, v65
v_add_f32 v42, v42, v66
v_add_f32 v43, v43, v67
v_add_f32 v40, v40, v68
v_add_f32 v41, v41, v69
v_add_f32 v42, v42, v70
v_add_f32 v43, v43, v71
v_add_f32 v40, v40, v72
v_add_f32 v41, v41, v73
v_add_f32 v42, v42, v74
v_add_f32 v43, v43, v75
v_add_f32 v40, v40, v76
v_add_f32 v41, v41, v77
v_add_f32 v42, v42, v78
v_add_f32 v43, v43, v79
v_add_f32 v40, v40, v80
v_add_f32 v41, v41, v81
v_add_f32 v42, v42, v82
v_add_f32 v43, v43, v83
v_add_f32 v40, v40, v84
v_add_f32 v41, v41, v85
v_add_f32 v42, v42, v86
v_add_f32 v43, v43, v87
v_add_f32 v40, v40, v88
v_add_f32 v41, v41, v89
v_add_f32 v42, v42, v90
v_add_f32 v43, v43, v91
v_add_f32 v40, v40, v92
v_add_f32 v41, v41, v93
v_add_f32 v42, v42, v94
v_add_f32 v43, v43, v95
v_add_f32 v40, v40, v96
v_add_f32 v41, v41, v97
v_add_f32 v42, v42, v98
v_add_f32 v43, v43, v99
v_add_f32 v40, v40, v100
v_add_f32 v41, v41, v101
v_add_f32 v42, v42, v102
v_add_f32 v43, v43, v103
v_add_f32 v40, v40, v104
v_add_f32 v41, v41, v105
v_add_f32 v42, v42, v106
v_add_f32 v43, v43, v107
v_add_f32 v40, v40, v108
v_add_f32 v41, v41, v109
v_add_f32 v42, v42, v110
v_add_f32 v43, v43, v111
v_add_f32 v40, v40, v112
v_add_f32 v41, v41, v113
v_add_f32 v42, v42, v114
v_add_f32 v43, v43, v115
v_add_f32 v40, v40, v116
v_add_f32 v41, v41, v117
v_add_f32 v42, v42, v118
v_add_f32 v43, v43, v119
v_add_f32 v40, v40, v120
v_add_f32 v41, v41, v121
v_add_f32 v42, v42, v122
v_add_f32 v43, v43, v123
v_add_f32 v40, v40, v124
v_add_f32 v41, v41, v125
v_add_f32 v42, v42, v126
v_add_f32 v43, v43, v127
v_add_f32 v40, v40, v128
v_add_f32 v41, v41, v129
v_add_f32 v42, v42, v130
v_add_f32 v43, v43, v131
v_add_f32 v40, v40, v132
v_add_f32 v41, v41, v133
v_add_f32 v42, v42, v134
v_add_f32 v43, v43, v135
v_add_f32 v40, v40, v136
v_add_f32 v41, v41, v137
v_add_f32 v42, v42, v138
v_add_f32 v43, v43, v139
v_add_f32 v40, v40, v140
v_add_f32 v41, v41, v141
v_add_f32 v42, v42, v142
v_add_f32 v43, v43, v143
v_add_f32 v40, v40, v144
v_add_f32 v41, v41, v145
v_add_f32 v42, v42, v146
v_add_f32 v43, v43, v147
v_add_f32 v40, v40, v148
v_add_f32 v41, v41, v149
v_add_f32 v42, v42, v150
v_add_f32 v43, v43, v151
v_add_f32 v40, v40, v152
v_add_f32 v41, v41, v153
v_add_f32 v42, v42, v154
v_add_f32 v43, v43, v155
v_add_f32 v40, v40, v156
v_add_f32 v41, v41, v157
v_add_f32 v42, v42, v158
v_add_f32 v43, v43, v159
v_add_f32 v40, v40, v160
v_add_f32 v41, v41, v161
v_add_f32 v42, v42, v162
v_add_f32 v43, v43, v163
v_add_f32 v40, v40, v164
v_add_f32 v41, v41, v165
v_add_f32 v42, v42, v166
v_add_f32 v43, v43, v167
v_add_u32 v169, 0, v169
s_mov_b32 exec_lo, -1
s_mov_b32 exec_hi, 0x00ffffff
ds_write_b128 v169, v[40:43]
s_mov_b64 exec, -1
s_mov_b64 exec, 0xffffffff
ds_write_b64 v11, v[172:173]
s_mov_b64 exec, -1
s_waitcnt lgkmcnt(0)
s_barrier
s_branch k4_kernel_end
k4_kernel_w5:
v_add_u32 v9, 448, v1
s_mov_b32 s7, 4682
v_mul_lo_u32 v10, v9, s7
v_lshrrev_b32 v10, 16, v10
v_mul_u32_u24 v11, 14, v10
v_sub_u32 v11, v9, v11
v_lshlrev_b32 v11, 4, v11
s_mov_b32 s7, 3584
v_mul_lo_u32 v10, v10, s7
v_add_u32 v15, v10, v11
v_add_u32 v9, 512, v1
s_mov_b32 s7, 4682
v_mul_lo_u32 v10, v9, s7
v_lshrrev_b32 v10, 16, v10
v_mul_u32_u24 v11, 14, v10
v_sub_u32 v11, v9, v11
v_lshlrev_b32 v11, 4, v11
s_mov_b32 s7, 3584
v_mul_lo_u32 v10, v10, s7
v_add_u32 v16, v10, v11
v_add_u32 v9, 576, v1
s_mov_b32 s7, 4682
v_mul_lo_u32 v10, v9, s7
v_lshrrev_b32 v10, 16, v10
v_mul_u32_u24 v11, 14, v10
v_sub_u32 v11, v9, v11
v_lshlrev_b32 v11, 4, v11
s_mov_b32 s7, 3584
v_mul_lo_u32 v10, v10, s7
v_add_u32 v17, v10, v11
v_add_u32 v9, 640, v1
s_mov_b32 s7, 4682
v_mul_lo_u32 v10, v9, s7
v_lshrrev_b32 v10, 16, v10
v_mul_u32_u24 v11, 14, v10
v_sub_u32 v11, v9, v11
v_lshlrev_b32 v11, 4, v11
s_mov_b32 s7, 3584
v_mul_lo_u32 v10, v10, s7
v_add_u32 v18, v10, v11
v_add_u32 v9, 704, v1
s_mov_b32 s7, 4682
v_mul_lo_u32 v10, v9, s7
v_lshrrev_b32 v10, 16, v10
v_mul_u32_u24 v11, 14, v10
v_sub_u32 v11, v9, v11
v_lshlrev_b32 v11, 4, v11
s_mov_b32 s7, 3584
v_mul_lo_u32 v10, v10, s7
v_add_u32 v19, v10, v11
v_add_u32 v9, 768, v1
s_mov_b32 s7, 4682
v_mul_lo_u32 v10, v9, s7
v_lshrrev_b32 v10, 16, v10
v_mul_u32_u24 v11, 14, v10
v_sub_u32 v11, v9, v11
v_lshlrev_b32 v11, 4, v11
s_mov_b32 s7, 3584
v_mul_lo_u32 v10, v10, s7
v_add_u32 v20, v10, v11
v_add_u32 v9, 832, v1
s_mov_b32 s7, 4682
v_mul_lo_u32 v10, v9, s7
v_lshrrev_b32 v10, 16, v10
v_mul_u32_u24 v11, 14, v10
v_sub_u32 v11, v9, v11
v_lshlrev_b32 v11, 4, v11
s_mov_b32 s7, 3584
v_mul_lo_u32 v10, v10, s7
v_add_u32 v21, v10, v11
s_mov_b32 m0, 7168
s_mov_b32 s60, 0
buffer_load_dwordx4 v15, s[44:47], s60 offen lds
s_mov_b32 m0, 8192
s_mov_b32 s60, 0
buffer_load_dwordx4 v16, s[44:47], s60 offen lds
s_mov_b32 m0, 9216
s_mov_b32 s60, 0
buffer_load_dwordx4 v17, s[44:47], s60 offen lds
s_mov_b32 m0, 10240
s_mov_b32 s60, 0
buffer_load_dwordx4 v18, s[44:47], s60 offen lds
s_mov_b32 m0, 11264
s_mov_b32 s60, 0
buffer_load_dwordx4 v19, s[44:47], s60 offen lds
s_mov_b32 m0, 12288
s_mov_b32 s60, 0
buffer_load_dwordx4 v20, s[44:47], s60 offen lds
s_mov_b32 m0, 13312
s_mov_b32 s60, 0
buffer_load_dwordx4 v21, s[44:47], s60 offen lds
s_mov_b32 m0, 36096
s_mov_b32 s60, 229376
buffer_load_dwordx4 v15, s[44:47], s60 offen lds
s_mov_b32 m0, 37120
s_mov_b32 s60, 229376
buffer_load_dwordx4 v16, s[44:47], s60 offen lds
s_mov_b32 m0, 38144
s_mov_b32 s60, 229376
buffer_load_dwordx4 v17, s[44:47], s60 offen lds
s_mov_b32 m0, 39168
s_mov_b32 s60, 229376
buffer_load_dwordx4 v18, s[44:47], s60 offen lds
s_mov_b32 m0, 40192
s_mov_b32 s60, 229376
buffer_load_dwordx4 v19, s[44:47], s60 offen lds
s_mov_b32 m0, 41216
s_mov_b32 s60, 229376
buffer_load_dwordx4 v20, s[44:47], s60 offen lds
s_mov_b32 m0, 42240
s_mov_b32 s60, 229376
buffer_load_dwordx4 v21, s[44:47], s60 offen lds
s_mov_b32 m0, 65024
s_mov_b32 s60, 458752
buffer_load_dwordx4 v15, s[44:47], s60 offen lds
s_mov_b32 m0, 66048
s_mov_b32 s60, 458752
buffer_load_dwordx4 v16, s[44:47], s60 offen lds
s_mov_b32 m0, 67072
s_mov_b32 s60, 458752
buffer_load_dwordx4 v17, s[44:47], s60 offen lds
s_mov_b32 m0, 68096
s_mov_b32 s60, 458752
buffer_load_dwordx4 v18, s[44:47], s60 offen lds
s_mov_b32 m0, 69120
s_mov_b32 s60, 458752
buffer_load_dwordx4 v19, s[44:47], s60 offen lds
s_mov_b32 m0, 70144
s_mov_b32 s60, 458752
buffer_load_dwordx4 v20, s[44:47], s60 offen lds
s_mov_b32 m0, 71168
s_mov_b32 s60, 458752
buffer_load_dwordx4 v21, s[44:47], s60 offen lds
s_lshl_b32 s7, s4, 2
s_add_u32 s7, s7, 1
s_lshl_b32 s7, s7, 12
s_add_u32 s7, s7, 14680064
buffer_load_dwordx4 v[24:27], v3, s[52:55], s7 offen offset:0
buffer_load_dwordx4 v[28:31], v3, s[52:55], s7 offen offset:1024
buffer_load_dwordx4 v[32:35], v3, s[52:55], s7 offen offset:2048
buffer_load_dwordx4 v[36:39], v3, s[52:55], s7 offen offset:3072
v_mul_u32_u24 v9, 224, v7
v_lshl_add_u32 v9, v8, 3, v9
v_mul_u32_u24 v10, 14464, v6
v_add_u32 v40, v9, v10
s_waitcnt vmcnt(18)
s_barrier
s_mov_b32 m0, 93952
s_mov_b32 s60, 688128
buffer_load_dwordx4 v15, s[44:47], s60 offen lds
s_mov_b32 m0, 94976
s_mov_b32 s60, 688128
buffer_load_dwordx4 v16, s[44:47], s60 offen lds
s_mov_b32 m0, 96000
s_mov_b32 s60, 688128
buffer_load_dwordx4 v17, s[44:47], s60 offen lds
s_mov_b32 m0, 97024
s_mov_b32 s60, 688128
buffer_load_dwordx4 v18, s[44:47], s60 offen lds
s_mov_b32 m0, 98048
s_mov_b32 s60, 688128
buffer_load_dwordx4 v19, s[44:47], s60 offen lds
s_mov_b32 m0, 99072
s_mov_b32 s60, 688128
buffer_load_dwordx4 v20, s[44:47], s60 offen lds
s_mov_b32 m0, 100096
s_mov_b32 s60, 688128
buffer_load_dwordx4 v21, s[44:47], s60 offen lds
s_waitcnt vmcnt(18)
s_barrier
s_mov_b32 m0, 122880
s_mov_b32 s60, 917504
buffer_load_dwordx4 v15, s[44:47], s60 offen lds
s_mov_b32 m0, 123904
s_mov_b32 s60, 917504
buffer_load_dwordx4 v16, s[44:47], s60 offen lds
s_mov_b32 m0, 124928
s_mov_b32 s60, 917504
buffer_load_dwordx4 v17, s[44:47], s60 offen lds
s_mov_b32 m0, 125952
s_mov_b32 s60, 917504
buffer_load_dwordx4 v18, s[44:47], s60 offen lds
s_mov_b32 m0, 126976
s_mov_b32 s60, 917504
buffer_load_dwordx4 v19, s[44:47], s60 offen lds
s_mov_b32 m0, 128000
s_mov_b32 s60, 917504
buffer_load_dwordx4 v20, s[44:47], s60 offen lds
s_mov_b32 m0, 129024
s_mov_b32 s60, 917504
buffer_load_dwordx4 v21, s[44:47], s60 offen lds
s_waitcnt vmcnt(18)
s_barrier
s_mov_b32 m0, 7168
s_mov_b32 s60, 1146880
buffer_load_dwordx4 v15, s[44:47], s60 offen lds
s_mov_b32 m0, 8192
s_mov_b32 s60, 1146880
buffer_load_dwordx4 v16, s[44:47], s60 offen lds
s_mov_b32 m0, 9216
s_mov_b32 s60, 1146880
buffer_load_dwordx4 v17, s[44:47], s60 offen lds
s_mov_b32 m0, 10240
s_mov_b32 s60, 1146880
buffer_load_dwordx4 v18, s[44:47], s60 offen lds
s_mov_b32 m0, 11264
s_mov_b32 s60, 1146880
buffer_load_dwordx4 v19, s[44:47], s60 offen lds
s_mov_b32 m0, 12288
s_mov_b32 s60, 1146880
buffer_load_dwordx4 v20, s[44:47], s60 offen lds
s_mov_b32 m0, 13312
s_mov_b32 s60, 1146880
buffer_load_dwordx4 v21, s[44:47], s60 offen lds
s_waitcnt vmcnt(14)
s_barrier
s_mov_b32 m0, 36096
s_mov_b32 s60, 1376256
buffer_load_dwordx4 v15, s[44:47], s60 offen lds
s_mov_b32 m0, 37120
s_mov_b32 s60, 1376256
buffer_load_dwordx4 v16, s[44:47], s60 offen lds
s_mov_b32 m0, 38144
s_mov_b32 s60, 1376256
buffer_load_dwordx4 v17, s[44:47], s60 offen lds
s_mov_b32 m0, 39168
s_mov_b32 s60, 1376256
buffer_load_dwordx4 v18, s[44:47], s60 offen lds
s_mov_b32 m0, 40192
s_mov_b32 s60, 1376256
buffer_load_dwordx4 v19, s[44:47], s60 offen lds
s_mov_b32 m0, 41216
s_mov_b32 s60, 1376256
buffer_load_dwordx4 v20, s[44:47], s60 offen lds
s_mov_b32 m0, 42240
s_mov_b32 s60, 1376256
buffer_load_dwordx4 v21, s[44:47], s60 offen lds
s_waitcnt vmcnt(14)
s_barrier
s_mov_b32 m0, 65024
s_mov_b32 s60, 1605632
buffer_load_dwordx4 v15, s[44:47], s60 offen lds
s_mov_b32 m0, 66048
s_mov_b32 s60, 1605632
buffer_load_dwordx4 v16, s[44:47], s60 offen lds
s_mov_b32 m0, 67072
s_mov_b32 s60, 1605632
buffer_load_dwordx4 v17, s[44:47], s60 offen lds
s_mov_b32 m0, 68096
s_mov_b32 s60, 1605632
buffer_load_dwordx4 v18, s[44:47], s60 offen lds
s_mov_b32 m0, 69120
s_mov_b32 s60, 1605632
buffer_load_dwordx4 v19, s[44:47], s60 offen lds
s_mov_b32 m0, 70144
s_mov_b32 s60, 1605632
buffer_load_dwordx4 v20, s[44:47], s60 offen lds
s_mov_b32 m0, 71168
s_mov_b32 s60, 1605632
buffer_load_dwordx4 v21, s[44:47], s60 offen lds
s_waitcnt vmcnt(14)
s_barrier
s_waitcnt vmcnt(7)
s_barrier
s_waitcnt vmcnt(0)
s_barrier
v_and_b32 v9, 31, v1
v_lshlrev_b32 v10, 2, v9
v_add_u32 v10, 0, v10
v_lshlrev_b32 v11, 3, v9
v_add_u32 v11, 2304, v11
v_add_f32 v42, v24, v26
v_add_f32 v43, v25, v27
v_add_f32 v42, v42, v28
v_add_f32 v43, v43, v29
v_add_f32 v42, v42, v30
v_add_f32 v43, v43, v31
v_add_f32 v42, v42, v32
v_add_f32 v43, v43, v33
v_add_f32 v42, v42, v34
v_add_f32 v43, v43, v35
v_add_f32 v42, v42, v36
v_add_f32 v43, v43, v37
v_add_f32 v42, v42, v38
v_add_f32 v43, v43, v39
v_mov_b32 v44, v42
v_mov_b32 v45, v42
s_nop 1
v_permlane32_swap_b32 v44, v45
v_add_f32 v42, v44, v45
v_mov_b32 v46, v43
v_mov_b32 v47, v43
s_nop 1
v_permlane32_swap_b32 v46, v47
v_add_f32 v43, v46, v47
v_mul_f32 v42, 0x3b000000, v42
v_mul_f32 v43, 0x3b000000, v43
v_fma_f32 v43, -v42, v42, v43
v_max_f32 v43, 0, v43
v_cvt_pk_bf16_f32 v42, v42, v42
v_cvt_pk_bf16_f32 v43, v43, v43
v_lshlrev_b32 v42, 16, v42
v_lshlrev_b32 v43, 16, v43
v_add_f32 v43, 0x3727c5ac, v43
v_cvt_pk_bf16_f32 v43, v43, v43
v_lshlrev_b32 v43, 16, v43
v_sqrt_f32 v43, v43
s_nop 0
v_cvt_pk_bf16_f32 v43, v43, v43
v_lshlrev_b32 v43, 16, v43
v_rcp_f32 v43, v43
v_sub_f32 v42, 0, v42
s_mov_b64 exec, 0xffffffff
ds_write_b64 v11, v[42:43]
s_mov_b64 exec, -1
s_waitcnt lgkmcnt(0)
s_barrier
s_branch k4_kernel_end
k4_kernel_w6:
v_add_u32 v9, 0, v1
s_mov_b32 s7, 4682
v_mul_lo_u32 v10, v9, s7
v_lshrrev_b32 v10, 16, v10
v_mul_u32_u24 v11, 14, v10
v_sub_u32 v11, v9, v11
v_lshlrev_b32 v11, 4, v11
s_mov_b32 s7, 3584
v_mul_lo_u32 v10, v10, s7
v_add_u32 v15, v10, v11
v_add_u32 v9, 64, v1
s_mov_b32 s7, 4682
v_mul_lo_u32 v10, v9, s7
v_lshrrev_b32 v10, 16, v10
v_mul_u32_u24 v11, 14, v10
v_sub_u32 v11, v9, v11
v_lshlrev_b32 v11, 4, v11
s_mov_b32 s7, 3584
v_mul_lo_u32 v10, v10, s7
v_add_u32 v16, v10, v11
v_add_u32 v9, 128, v1
s_mov_b32 s7, 4682
v_mul_lo_u32 v10, v9, s7
v_lshrrev_b32 v10, 16, v10
v_mul_u32_u24 v11, 14, v10
v_sub_u32 v11, v9, v11
v_lshlrev_b32 v11, 4, v11
s_mov_b32 s7, 3584
v_mul_lo_u32 v10, v10, s7
v_add_u32 v17, v10, v11
v_add_u32 v9, 192, v1
s_mov_b32 s7, 4682
v_mul_lo_u32 v10, v9, s7
v_lshrrev_b32 v10, 16, v10
v_mul_u32_u24 v11, 14, v10
v_sub_u32 v11, v9, v11
v_lshlrev_b32 v11, 4, v11
s_mov_b32 s7, 3584
v_mul_lo_u32 v10, v10, s7
v_add_u32 v18, v10, v11
v_add_u32 v9, 256, v1
s_mov_b32 s7, 4682
v_mul_lo_u32 v10, v9, s7
v_lshrrev_b32 v10, 16, v10
v_mul_u32_u24 v11, 14, v10
v_sub_u32 v11, v9, v11
v_lshlrev_b32 v11, 4, v11
s_mov_b32 s7, 3584
v_mul_lo_u32 v10, v10, s7
v_add_u32 v19, v10, v11
v_add_u32 v9, 320, v1
s_mov_b32 s7, 4682
v_mul_lo_u32 v10, v9, s7
v_lshrrev_b32 v10, 16, v10
v_mul_u32_u24 v11, 14, v10
v_sub_u32 v11, v9, v11
v_lshlrev_b32 v11, 4, v11
s_mov_b32 s7, 3584
v_mul_lo_u32 v10, v10, s7
v_add_u32 v20, v10, v11
v_add_u32 v9, 384, v1
s_mov_b32 s7, 4682
v_mul_lo_u32 v10, v9, s7
v_lshrrev_b32 v10, 16, v10
v_mul_u32_u24 v11, 14, v10
v_sub_u32 v11, v9, v11
v_lshlrev_b32 v11, 4, v11
s_mov_b32 s7, 3584
v_mul_lo_u32 v10, v10, s7
v_add_u32 v21, v10, v11
s_mov_b32 m0, 14464
s_mov_b32 s60, 0
buffer_load_dwordx4 v15, s[48:51], s60 offen lds
s_mov_b32 m0, 15488
s_mov_b32 s60, 0
buffer_load_dwordx4 v16, s[48:51], s60 offen lds
s_mov_b32 m0, 16512
s_mov_b32 s60, 0
buffer_load_dwordx4 v17, s[48:51], s60 offen lds
s_mov_b32 m0, 17536
s_mov_b32 s60, 0
buffer_load_dwordx4 v18, s[48:51], s60 offen lds
s_mov_b32 m0, 18560
s_mov_b32 s60, 0
buffer_load_dwordx4 v19, s[48:51], s60 offen lds
s_mov_b32 m0, 19584
s_mov_b32 s60, 0
buffer_load_dwordx4 v20, s[48:51], s60 offen lds
s_mov_b32 m0, 20608
s_mov_b32 s60, 0
buffer_load_dwordx4 v21, s[48:51], s60 offen lds
s_mov_b32 m0, 43392
s_mov_b32 s60, 229376
buffer_load_dwordx4 v15, s[48:51], s60 offen lds
s_mov_b32 m0, 44416
s_mov_b32 s60, 229376
buffer_load_dwordx4 v16, s[48:51], s60 offen lds
s_mov_b32 m0, 45440
s_mov_b32 s60, 229376
buffer_load_dwordx4 v17, s[48:51], s60 offen lds
s_mov_b32 m0, 46464
s_mov_b32 s60, 229376
buffer_load_dwordx4 v18, s[48:51], s60 offen lds
s_mov_b32 m0, 47488
s_mov_b32 s60, 229376
buffer_load_dwordx4 v19, s[48:51], s60 offen lds
s_mov_b32 m0, 48512
s_mov_b32 s60, 229376
buffer_load_dwordx4 v20, s[48:51], s60 offen lds
s_mov_b32 m0, 49536
s_mov_b32 s60, 229376
buffer_load_dwordx4 v21, s[48:51], s60 offen lds
s_mov_b32 m0, 72320
s_mov_b32 s60, 458752
buffer_load_dwordx4 v15, s[48:51], s60 offen lds
s_mov_b32 m0, 73344
s_mov_b32 s60, 458752
buffer_load_dwordx4 v16, s[48:51], s60 offen lds
s_mov_b32 m0, 74368
s_mov_b32 s60, 458752
buffer_load_dwordx4 v17, s[48:51], s60 offen lds
s_mov_b32 m0, 75392
s_mov_b32 s60, 458752
buffer_load_dwordx4 v18, s[48:51], s60 offen lds
s_mov_b32 m0, 76416
s_mov_b32 s60, 458752
buffer_load_dwordx4 v19, s[48:51], s60 offen lds
s_mov_b32 m0, 77440
s_mov_b32 s60, 458752
buffer_load_dwordx4 v20, s[48:51], s60 offen lds
s_mov_b32 m0, 78464
s_mov_b32 s60, 458752
buffer_load_dwordx4 v21, s[48:51], s60 offen lds
s_lshl_b32 s7, s4, 2
s_add_u32 s7, s7, 2
s_lshl_b32 s7, s7, 12
s_add_u32 s7, s7, 14680064
buffer_load_dwordx4 v[24:27], v3, s[52:55], s7 offen offset:0
buffer_load_dwordx4 v[28:31], v3, s[52:55], s7 offen offset:1024
buffer_load_dwordx4 v[32:35], v3, s[52:55], s7 offen offset:2048
buffer_load_dwordx4 v[36:39], v3, s[52:55], s7 offen offset:3072
v_mul_u32_u24 v9, 224, v7
v_lshl_add_u32 v9, v8, 3, v9
v_mul_u32_u24 v10, 14464, v6
v_add_u32 v40, v9, v10
s_waitcnt vmcnt(18)
s_barrier
s_mov_b32 m0, 101248
s_mov_b32 s60, 688128
buffer_load_dwordx4 v15, s[48:51], s60 offen lds
s_mov_b32 m0, 102272
s_mov_b32 s60, 688128
buffer_load_dwordx4 v16, s[48:51], s60 offen lds
s_mov_b32 m0, 103296
s_mov_b32 s60, 688128
buffer_load_dwordx4 v17, s[48:51], s60 offen lds
s_mov_b32 m0, 104320
s_mov_b32 s60, 688128
buffer_load_dwordx4 v18, s[48:51], s60 offen lds
s_mov_b32 m0, 105344
s_mov_b32 s60, 688128
buffer_load_dwordx4 v19, s[48:51], s60 offen lds
s_mov_b32 m0, 106368
s_mov_b32 s60, 688128
buffer_load_dwordx4 v20, s[48:51], s60 offen lds
s_mov_b32 m0, 107392
s_mov_b32 s60, 688128
buffer_load_dwordx4 v21, s[48:51], s60 offen lds
s_waitcnt vmcnt(18)
s_barrier
s_mov_b32 m0, 130176
s_mov_b32 s60, 917504
buffer_load_dwordx4 v15, s[48:51], s60 offen lds
s_mov_b32 m0, 131200
s_mov_b32 s60, 917504
buffer_load_dwordx4 v16, s[48:51], s60 offen lds
s_mov_b32 m0, 132224
s_mov_b32 s60, 917504
buffer_load_dwordx4 v17, s[48:51], s60 offen lds
s_mov_b32 m0, 133248
s_mov_b32 s60, 917504
buffer_load_dwordx4 v18, s[48:51], s60 offen lds
s_mov_b32 m0, 134272
s_mov_b32 s60, 917504
buffer_load_dwordx4 v19, s[48:51], s60 offen lds
s_mov_b32 m0, 135296
s_mov_b32 s60, 917504
buffer_load_dwordx4 v20, s[48:51], s60 offen lds
s_mov_b32 m0, 136320
s_mov_b32 s60, 917504
buffer_load_dwordx4 v21, s[48:51], s60 offen lds
s_waitcnt vmcnt(18)
s_barrier
s_mov_b32 m0, 14464
s_mov_b32 s60, 1146880
buffer_load_dwordx4 v15, s[48:51], s60 offen lds
s_mov_b32 m0, 15488
s_mov_b32 s60, 1146880
buffer_load_dwordx4 v16, s[48:51], s60 offen lds
s_mov_b32 m0, 16512
s_mov_b32 s60, 1146880
buffer_load_dwordx4 v17, s[48:51], s60 offen lds
s_mov_b32 m0, 17536
s_mov_b32 s60, 1146880
buffer_load_dwordx4 v18, s[48:51], s60 offen lds
s_mov_b32 m0, 18560
s_mov_b32 s60, 1146880
buffer_load_dwordx4 v19, s[48:51], s60 offen lds
s_mov_b32 m0, 19584
s_mov_b32 s60, 1146880
buffer_load_dwordx4 v20, s[48:51], s60 offen lds
s_mov_b32 m0, 20608
s_mov_b32 s60, 1146880
buffer_load_dwordx4 v21, s[48:51], s60 offen lds
s_waitcnt vmcnt(14)
s_barrier
s_mov_b32 m0, 43392
s_mov_b32 s60, 1376256
buffer_load_dwordx4 v15, s[48:51], s60 offen lds
s_mov_b32 m0, 44416
s_mov_b32 s60, 1376256
buffer_load_dwordx4 v16, s[48:51], s60 offen lds
s_mov_b32 m0, 45440
s_mov_b32 s60, 1376256
buffer_load_dwordx4 v17, s[48:51], s60 offen lds
s_mov_b32 m0, 46464
s_mov_b32 s60, 1376256
buffer_load_dwordx4 v18, s[48:51], s60 offen lds
s_mov_b32 m0, 47488
s_mov_b32 s60, 1376256
buffer_load_dwordx4 v19, s[48:51], s60 offen lds
s_mov_b32 m0, 48512
s_mov_b32 s60, 1376256
buffer_load_dwordx4 v20, s[48:51], s60 offen lds
s_mov_b32 m0, 49536
s_mov_b32 s60, 1376256
buffer_load_dwordx4 v21, s[48:51], s60 offen lds
s_waitcnt vmcnt(14)
s_barrier
s_mov_b32 m0, 72320
s_mov_b32 s60, 1605632
buffer_load_dwordx4 v15, s[48:51], s60 offen lds
s_mov_b32 m0, 73344
s_mov_b32 s60, 1605632
buffer_load_dwordx4 v16, s[48:51], s60 offen lds
s_mov_b32 m0, 74368
s_mov_b32 s60, 1605632
buffer_load_dwordx4 v17, s[48:51], s60 offen lds
s_mov_b32 m0, 75392
s_mov_b32 s60, 1605632
buffer_load_dwordx4 v18, s[48:51], s60 offen lds
s_mov_b32 m0, 76416
s_mov_b32 s60, 1605632
buffer_load_dwordx4 v19, s[48:51], s60 offen lds
s_mov_b32 m0, 77440
s_mov_b32 s60, 1605632
buffer_load_dwordx4 v20, s[48:51], s60 offen lds
s_mov_b32 m0, 78464
s_mov_b32 s60, 1605632
buffer_load_dwordx4 v21, s[48:51], s60 offen lds
s_waitcnt vmcnt(14)
s_barrier
s_waitcnt vmcnt(7)
s_barrier
s_waitcnt vmcnt(0)
s_barrier
v_and_b32 v9, 31, v1
v_lshlrev_b32 v10, 2, v9
v_add_u32 v10, 0, v10
v_lshlrev_b32 v11, 3, v9
v_add_u32 v11, 2560, v11
v_add_f32 v42, v24, v26
v_add_f32 v43, v25, v27
v_add_f32 v42, v42, v28
v_add_f32 v43, v43, v29
v_add_f32 v42, v42, v30
v_add_f32 v43, v43, v31
v_add_f32 v42, v42, v32
v_add_f32 v43, v43, v33
v_add_f32 v42, v42, v34
v_add_f32 v43, v43, v35
v_add_f32 v42, v42, v36
v_add_f32 v43, v43, v37
v_add_f32 v42, v42, v38
v_add_f32 v43, v43, v39
v_mov_b32 v44, v42
v_mov_b32 v45, v42
s_nop 1
v_permlane32_swap_b32 v44, v45
v_add_f32 v42, v44, v45
v_mov_b32 v46, v43
v_mov_b32 v47, v43
s_nop 1
v_permlane32_swap_b32 v46, v47
v_add_f32 v43, v46, v47
v_mul_f32 v42, 0x3b000000, v42
v_mul_f32 v43, 0x3b000000, v43
v_fma_f32 v43, -v42, v42, v43
v_max_f32 v43, 0, v43
v_cvt_pk_bf16_f32 v42, v42, v42
v_cvt_pk_bf16_f32 v43, v43, v43
v_lshlrev_b32 v42, 16, v42
v_lshlrev_b32 v43, 16, v43
v_add_f32 v43, 0x3727c5ac, v43
v_cvt_pk_bf16_f32 v43, v43, v43
v_lshlrev_b32 v43, 16, v43
v_sqrt_f32 v43, v43
s_nop 0
v_cvt_pk_bf16_f32 v43, v43, v43
v_lshlrev_b32 v43, 16, v43
v_rcp_f32 v43, v43
v_sub_f32 v42, 0, v42
s_mov_b64 exec, 0xffffffff
ds_write_b64 v11, v[42:43]
s_mov_b64 exec, -1
s_waitcnt lgkmcnt(0)
s_barrier
s_branch k4_kernel_end
k4_kernel_w7:
v_add_u32 v9, 448, v1
s_mov_b32 s7, 4682
v_mul_lo_u32 v10, v9, s7
v_lshrrev_b32 v10, 16, v10
v_mul_u32_u24 v11, 14, v10
v_sub_u32 v11, v9, v11
v_lshlrev_b32 v11, 4, v11
s_mov_b32 s7, 3584
v_mul_lo_u32 v10, v10, s7
v_add_u32 v15, v10, v11
v_add_u32 v9, 512, v1
s_mov_b32 s7, 4682
v_mul_lo_u32 v10, v9, s7
v_lshrrev_b32 v10, 16, v10
v_mul_u32_u24 v11, 14, v10
v_sub_u32 v11, v9, v11
v_lshlrev_b32 v11, 4, v11
s_mov_b32 s7, 3584
v_mul_lo_u32 v10, v10, s7
v_add_u32 v16, v10, v11
v_add_u32 v9, 576, v1
s_mov_b32 s7, 4682
v_mul_lo_u32 v10, v9, s7
v_lshrrev_b32 v10, 16, v10
v_mul_u32_u24 v11, 14, v10
v_sub_u32 v11, v9, v11
v_lshlrev_b32 v11, 4, v11
s_mov_b32 s7, 3584
v_mul_lo_u32 v10, v10, s7
v_add_u32 v17, v10, v11
v_add_u32 v9, 640, v1
s_mov_b32 s7, 4682
v_mul_lo_u32 v10, v9, s7
v_lshrrev_b32 v10, 16, v10
v_mul_u32_u24 v11, 14, v10
v_sub_u32 v11, v9, v11
v_lshlrev_b32 v11, 4, v11
s_mov_b32 s7, 3584
v_mul_lo_u32 v10, v10, s7
v_add_u32 v18, v10, v11
v_add_u32 v9, 704, v1
s_mov_b32 s7, 4682
v_mul_lo_u32 v10, v9, s7
v_lshrrev_b32 v10, 16, v10
v_mul_u32_u24 v11, 14, v10
v_sub_u32 v11, v9, v11
v_lshlrev_b32 v11, 4, v11
s_mov_b32 s7, 3584
v_mul_lo_u32 v10, v10, s7
v_add_u32 v19, v10, v11
v_add_u32 v9, 768, v1
s_mov_b32 s7, 4682
v_mul_lo_u32 v10, v9, s7
v_lshrrev_b32 v10, 16, v10
v_mul_u32_u24 v11, 14, v10
v_sub_u32 v11, v9, v11
v_lshlrev_b32 v11, 4, v11
s_mov_b32 s7, 3584
v_mul_lo_u32 v10, v10, s7
v_add_u32 v20, v10, v11
v_add_u32 v9, 832, v1
s_mov_b32 s7, 4682
v_mul_lo_u32 v10, v9, s7
v_lshrrev_b32 v10, 16, v10
v_mul_u32_u24 v11, 14, v10
v_sub_u32 v11, v9, v11
v_lshlrev_b32 v11, 4, v11
s_mov_b32 s7, 3584
v_mul_lo_u32 v10, v10, s7
v_add_u32 v21, v10, v11
s_mov_b32 m0, 21632
s_mov_b32 s60, 0
buffer_load_dwordx4 v15, s[48:51], s60 offen lds
s_mov_b32 m0, 22656
s_mov_b32 s60, 0
buffer_load_dwordx4 v16, s[48:51], s60 offen lds
s_mov_b32 m0, 23680
s_mov_b32 s60, 0
buffer_load_dwordx4 v17, s[48:51], s60 offen lds
s_mov_b32 m0, 24704
s_mov_b32 s60, 0
buffer_load_dwordx4 v18, s[48:51], s60 offen lds
s_mov_b32 m0, 25728
s_mov_b32 s60, 0
buffer_load_dwordx4 v19, s[48:51], s60 offen lds
s_mov_b32 m0, 26752
s_mov_b32 s60, 0
buffer_load_dwordx4 v20, s[48:51], s60 offen lds
s_mov_b32 m0, 27776
s_mov_b32 s60, 0
buffer_load_dwordx4 v21, s[48:51], s60 offen lds
s_mov_b32 m0, 50560
s_mov_b32 s60, 229376
buffer_load_dwordx4 v15, s[48:51], s60 offen lds
s_mov_b32 m0, 51584
s_mov_b32 s60, 229376
buffer_load_dwordx4 v16, s[48:51], s60 offen lds
s_mov_b32 m0, 52608
s_mov_b32 s60, 229376
buffer_load_dwordx4 v17, s[48:51], s60 offen lds
s_mov_b32 m0, 53632
s_mov_b32 s60, 229376
buffer_load_dwordx4 v18, s[48:51], s60 offen lds
s_mov_b32 m0, 54656
s_mov_b32 s60, 229376
buffer_load_dwordx4 v19, s[48:51], s60 offen lds
s_mov_b32 m0, 55680
s_mov_b32 s60, 229376
buffer_load_dwordx4 v20, s[48:51], s60 offen lds
s_mov_b32 m0, 56704
s_mov_b32 s60, 229376
buffer_load_dwordx4 v21, s[48:51], s60 offen lds
s_mov_b32 m0, 79488
s_mov_b32 s60, 458752
buffer_load_dwordx4 v15, s[48:51], s60 offen lds
s_mov_b32 m0, 80512
s_mov_b32 s60, 458752
buffer_load_dwordx4 v16, s[48:51], s60 offen lds
s_mov_b32 m0, 81536
s_mov_b32 s60, 458752
buffer_load_dwordx4 v17, s[48:51], s60 offen lds
s_mov_b32 m0, 82560
s_mov_b32 s60, 458752
buffer_load_dwordx4 v18, s[48:51], s60 offen lds
s_mov_b32 m0, 83584
s_mov_b32 s60, 458752
buffer_load_dwordx4 v19, s[48:51], s60 offen lds
s_mov_b32 m0, 84608
s_mov_b32 s60, 458752
buffer_load_dwordx4 v20, s[48:51], s60 offen lds
s_mov_b32 m0, 85632
s_mov_b32 s60, 458752
buffer_load_dwordx4 v21, s[48:51], s60 offen lds
s_lshl_b32 s7, s4, 2
s_add_u32 s7, s7, 3
s_lshl_b32 s7, s7, 12
s_add_u32 s7, s7, 14680064
buffer_load_dwordx4 v[24:27], v3, s[52:55], s7 offen offset:0
buffer_load_dwordx4 v[28:31], v3, s[52:55], s7 offen offset:1024
buffer_load_dwordx4 v[32:35], v3, s[52:55], s7 offen offset:2048
buffer_load_dwordx4 v[36:39], v3, s[52:55], s7 offen offset:3072
v_mul_u32_u24 v9, 224, v7
v_lshl_add_u32 v9, v8, 3, v9
v_mul_u32_u24 v10, 14464, v6
v_add_u32 v40, v9, v10
s_waitcnt vmcnt(18)
s_barrier
s_mov_b32 m0, 108416
s_mov_b32 s60, 688128
buffer_load_dwordx4 v15, s[48:51], s60 offen lds
s_mov_b32 m0, 109440
s_mov_b32 s60, 688128
buffer_load_dwordx4 v16, s[48:51], s60 offen lds
s_mov_b32 m0, 110464
s_mov_b32 s60, 688128
buffer_load_dwordx4 v17, s[48:51], s60 offen lds
s_mov_b32 m0, 111488
s_mov_b32 s60, 688128
buffer_load_dwordx4 v18, s[48:51], s60 offen lds
s_mov_b32 m0, 112512
s_mov_b32 s60, 688128
buffer_load_dwordx4 v19, s[48:51], s60 offen lds
s_mov_b32 m0, 113536
s_mov_b32 s60, 688128
buffer_load_dwordx4 v20, s[48:51], s60 offen lds
s_mov_b32 m0, 114560
s_mov_b32 s60, 688128
buffer_load_dwordx4 v21, s[48:51], s60 offen lds
s_waitcnt vmcnt(18)
s_barrier
s_mov_b32 m0, 137344
s_mov_b32 s60, 917504
buffer_load_dwordx4 v15, s[48:51], s60 offen lds
s_mov_b32 m0, 138368
s_mov_b32 s60, 917504
buffer_load_dwordx4 v16, s[48:51], s60 offen lds
s_mov_b32 m0, 139392
s_mov_b32 s60, 917504
buffer_load_dwordx4 v17, s[48:51], s60 offen lds
s_mov_b32 m0, 140416
s_mov_b32 s60, 917504
buffer_load_dwordx4 v18, s[48:51], s60 offen lds
s_mov_b32 m0, 141440
s_mov_b32 s60, 917504
buffer_load_dwordx4 v19, s[48:51], s60 offen lds
s_mov_b32 m0, 142464
s_mov_b32 s60, 917504
buffer_load_dwordx4 v20, s[48:51], s60 offen lds
s_mov_b32 m0, 143488
s_mov_b32 s60, 917504
buffer_load_dwordx4 v21, s[48:51], s60 offen lds
s_waitcnt vmcnt(18)
s_barrier
s_mov_b32 m0, 21632
s_mov_b32 s60, 1146880
buffer_load_dwordx4 v15, s[48:51], s60 offen lds
s_mov_b32 m0, 22656
s_mov_b32 s60, 1146880
buffer_load_dwordx4 v16, s[48:51], s60 offen lds
s_mov_b32 m0, 23680
s_mov_b32 s60, 1146880
buffer_load_dwordx4 v17, s[48:51], s60 offen lds
s_mov_b32 m0, 24704
s_mov_b32 s60, 1146880
buffer_load_dwordx4 v18, s[48:51], s60 offen lds
s_mov_b32 m0, 25728
s_mov_b32 s60, 1146880
buffer_load_dwordx4 v19, s[48:51], s60 offen lds
s_mov_b32 m0, 26752
s_mov_b32 s60, 1146880
buffer_load_dwordx4 v20, s[48:51], s60 offen lds
s_mov_b32 m0, 27776
s_mov_b32 s60, 1146880
buffer_load_dwordx4 v21, s[48:51], s60 offen lds
s_waitcnt vmcnt(14)
s_barrier
s_mov_b32 m0, 50560
s_mov_b32 s60, 1376256
buffer_load_dwordx4 v15, s[48:51], s60 offen lds
s_mov_b32 m0, 51584
s_mov_b32 s60, 1376256
buffer_load_dwordx4 v16, s[48:51], s60 offen lds
s_mov_b32 m0, 52608
s_mov_b32 s60, 1376256
buffer_load_dwordx4 v17, s[48:51], s60 offen lds
s_mov_b32 m0, 53632
s_mov_b32 s60, 1376256
buffer_load_dwordx4 v18, s[48:51], s60 offen lds
s_mov_b32 m0, 54656
s_mov_b32 s60, 1376256
buffer_load_dwordx4 v19, s[48:51], s60 offen lds
s_mov_b32 m0, 55680
s_mov_b32 s60, 1376256
buffer_load_dwordx4 v20, s[48:51], s60 offen lds
s_mov_b32 m0, 56704
s_mov_b32 s60, 1376256
buffer_load_dwordx4 v21, s[48:51], s60 offen lds
s_waitcnt vmcnt(14)
s_barrier
s_mov_b32 m0, 79488
s_mov_b32 s60, 1605632
buffer_load_dwordx4 v15, s[48:51], s60 offen lds
s_mov_b32 m0, 80512
s_mov_b32 s60, 1605632
buffer_load_dwordx4 v16, s[48:51], s60 offen lds
s_mov_b32 m0, 81536
s_mov_b32 s60, 1605632
buffer_load_dwordx4 v17, s[48:51], s60 offen lds
s_mov_b32 m0, 82560
s_mov_b32 s60, 1605632
buffer_load_dwordx4 v18, s[48:51], s60 offen lds
s_mov_b32 m0, 83584
s_mov_b32 s60, 1605632
buffer_load_dwordx4 v19, s[48:51], s60 offen lds
s_mov_b32 m0, 84608
s_mov_b32 s60, 1605632
buffer_load_dwordx4 v20, s[48:51], s60 offen lds
s_mov_b32 m0, 85632
s_mov_b32 s60, 1605632
buffer_load_dwordx4 v21, s[48:51], s60 offen lds
s_waitcnt vmcnt(14)
s_barrier
s_waitcnt vmcnt(7)
s_barrier
s_waitcnt vmcnt(0)
s_barrier
v_and_b32 v9, 31, v1
v_lshlrev_b32 v10, 2, v9
v_add_u32 v10, 0, v10
v_lshlrev_b32 v11, 3, v9
v_add_u32 v11, 2816, v11
v_add_f32 v42, v24, v26
v_add_f32 v43, v25, v27
v_add_f32 v42, v42, v28
v_add_f32 v43, v43, v29
v_add_f32 v42, v42, v30
v_add_f32 v43, v43, v31
v_add_f32 v42, v42, v32
v_add_f32 v43, v43, v33
v_add_f32 v42, v42, v34
v_add_f32 v43, v43, v35
v_add_f32 v42, v42, v36
v_add_f32 v43, v43, v37
v_add_f32 v42, v42, v38
v_add_f32 v43, v43, v39
v_mov_b32 v44, v42
v_mov_b32 v45, v42
s_nop 1
v_permlane32_swap_b32 v44, v45
v_add_f32 v42, v44, v45
v_mov_b32 v46, v43
v_mov_b32 v47, v43
s_nop 1
v_permlane32_swap_b32 v46, v47
v_add_f32 v43, v46, v47
v_mul_f32 v42, 0x3b000000, v42
v_mul_f32 v43, 0x3b000000, v43
v_fma_f32 v43, -v42, v42, v43
v_max_f32 v43, 0, v43
v_cvt_pk_bf16_f32 v42, v42, v42
v_cvt_pk_bf16_f32 v43, v43, v43
v_lshlrev_b32 v42, 16, v42
v_lshlrev_b32 v43, 16, v43
v_add_f32 v43, 0x3727c5ac, v43
v_cvt_pk_bf16_f32 v43, v43, v43
v_lshlrev_b32 v43, 16, v43
v_sqrt_f32 v43, v43
s_nop 0
v_cvt_pk_bf16_f32 v43, v43, v43
v_lshlrev_b32 v43, 16, v43
v_rcp_f32 v43, v43
v_sub_f32 v42, 0, v42
s_mov_b64 exec, 0xffffffff
ds_write_b64 v11, v[42:43]
s_mov_b64 exec, -1
s_waitcnt lgkmcnt(0)
s_barrier
k4_kernel_end:
s_endpgm
.section .rodata,"a"
.p2align 6
.amdhsa_kernel k4_kernel
  .amdhsa_next_free_vgpr 232
  .amdhsa_next_free_sgpr 96
  .amdhsa_accum_offset 232
  .amdhsa_group_segment_fixed_size 0
  .amdhsa_kernarg_size 80
  .amdhsa_user_sgpr_count 2
  .amdhsa_user_sgpr_kernarg_segment_ptr 1
  .amdhsa_system_sgpr_workgroup_id_x 1
.end_amdhsa_kernel
.text
.globl k5_kernel
.p2align 8
.type k5_kernel,@function
k5_kernel:
s_cmp_ge_u32 s2, 256
s_cbranch_scc1 k5_kernel_end
s_load_dwordx16 s[16:31], s[0:1], 0
s_load_dwordx4 s[32:35], s[0:1], 64
v_and_b32 v1, 63, v0
v_lshrrev_b32 v2, 6, v0
v_lshlrev_b32 v3, 4, v1
s_nop 0
v_readfirstlane_b32 s6, v2
s_and_b32 s7, s2, 7
s_lshr_b32 s8, s2, 3
s_lshl_b32 s9, s7, 2
s_and_b32 s10, s8, 3
s_add_u32 s4, s9, s10
s_lshr_b32 s5, s8, 2
s_mov_b32 s61, 0x3f803f80
s_waitcnt lgkmcnt(0)
s_mul_i32 s7, s4, 229376
s_add_u32 s40, s34, s7
s_addc_u32 s41, s35, 0
s_add_u32 s40, s40, 16777216
s_addc_u32 s41, s41, 0
s_and_b32 s41, s41, 0xffff
s_mov_b32 s42, 229376
s_mov_b32 s43, 0x00020000
s_mul_i32 s7, s5, 128
s_add_u32 s44, s28, s7
s_addc_u32 s45, s29, 0
s_and_b32 s45, s45, 0xffff
s_mov_b32 s46, 0
s_mov_b32 s47, 0x00020000
s_sub_u32 s46, 1835008, s7
s_mov_b32 s52, s30
s_mov_b32 s53, s31
s_and_b32 s53, s53, 0xffff
s_mov_b32 s54, 2097152
s_mov_b32 s55, 0x00020000
s_add_u32 s56, s34, 10485760
s_addc_u32 s57, s35, 0
s_and_b32 s57, s57, 0xffff
s_mov_b32 s58, 2097152
s_mov_b32 s59, 0x00020000
v_and_b32 v4, 15, v1
v_lshrrev_b32 v5, 5, v1
v_bfe_u32 v6, v1, 4, 1
v_lshrrev_b32 v7, 2, v4
v_lshl_add_u32 v7, v5, 3, v7
v_and_b32 v8, 3, v4
s_cmp_eq_u32 s6, 1
s_cbranch_scc1 k5_kernel_w1
s_cmp_eq_u32 s6, 2
s_cbranch_scc1 k5_kernel_w2
s_cmp_eq_u32 s6, 3
s_cbranch_scc1 k5_kernel_w3
s_cmp_eq_u32 s6, 4
s_cbranch_scc1 k5_kernel_w4
s_cmp_eq_u32 s6, 5
s_cbranch_scc1 k5_kernel_w5
s_cmp_eq_u32 s6, 6
s_cbranch_scc1 k5_kernel_w6
s_cmp_eq_u32 s6, 7
s_cbranch_scc1 k5_kernel_w7
s_lshl_b32 s7, s4, 1
s_add_u32 s7, s7, 0
s_lshl_b32 s8, s5, 7
s_add_u32 s8, s8, 0
s_lshl_b32 s10, s7, 5
s_lshr_b32 s11, s8, 5
s_add_u32 s10, s10, s11
s_lshl_b32 s10, s10, 10
v_and_b32 v86, 31, v1
v_lshlrev_b32 v87, 4, v86
v_lshl_add_u32 v87, v5, 3, v87
buffer_load_dwordx2 v[88:89], v87, s[56:59], s10 offen offset:0
buffer_load_dwordx2 v[90:91], v87, s[56:59], s10 offen offset:512
buffer_load_dwordx2 v[92:93], v87, s[56:59], s10 offen offset:1024
buffer_load_dwordx2 v[94:95], v87, s[56:59], s10 offen offset:1536
s_lshl_b32 s9, s7, 15
s_add_u32 s9, s9, s8
v_lshlrev_b32 v86, 10, v86
v_lshl_add_u32 v86, v5, 4, v86
v_lshrrev_b32 v14, 1, v8
v_lshl_add_u32 v14, v6, 1, v14
v_add_u32 v14, 0, v14
v_bfe_u32 v15, v4, 3, 1
v_lshlrev_b32 v15, 2, v15
v_xor_b32 v14, v14, v15
v_lshlrev_b32 v14, 4, v14
v_and_b32 v15, 1, v4
v_lshl_add_u32 v14, v15, 3, v14
v_lshl_add_u32 v9, v7, 7, v14
s_barrier
v_add_u32 v10, 8192, v9
v_add_u32 v12, 0, v3
ds_read_b128 v[40:43], v12 offset:0
ds_read_b64_tr_b16 v[20:21], v10 offset:0
ds_read_b64_tr_b16 v[22:23], v10 offset:512
ds_read_b128 v[44:47], v12 offset:1024
ds_read_b64_tr_b16 v[24:25], v10 offset:2048
ds_read_b64_tr_b16 v[26:27], v10 offset:2560
ds_read_b128 v[48:51], v12 offset:2048
ds_read_b64_tr_b16 v[28:29], v10 offset:4096
ds_read_b64_tr_b16 v[30:31], v10 offset:4608
ds_read_b128 v[52:55], v12 offset:3072
ds_read_b64_tr_b16 v[32:33], v10 offset:6144
ds_read_b64_tr_b16 v[34:35], v10 offset:6656
s_barrier
v_add_u32 v11, 24576, v9
v_add_u32 v13, 16384, v3
ds_read_b128 v[56:59], v13 offset:0
s_waitcnt lgkmcnt(10)
v_mfma_f32_32x32x16_bf16 v[60:75], v[20:23], v[40:43], 0
ds_read_b64_tr_b16 v[36:37], v11 offset:0
ds_read_b64_tr_b16 v[38:39], v11 offset:512
ds_read_b128 v[40:43], v13 offset:1024
s_waitcnt lgkmcnt(10)
v_mfma_f32_32x32x16_bf16 v[60:75], v[24:27], v[44:47], v[60:75]
ds_read_b64_tr_b16 v[20:21], v11 offset:2048
ds_read_b64_tr_b16 v[22:23], v11 offset:2560
ds_read_b128 v[44:47], v13 offset:2048
s_waitcnt lgkmcnt(10)
v_mfma_f32_32x32x16_bf16 v[60:75], v[28:31], v[48:51], v[60:75]
ds_read_b64_tr_b16 v[24:25], v11 offset:4096
ds_read_b64_tr_b16 v[26:27], v11 offset:4608
ds_read_b128 v[48:51], v13 offset:3072
s_waitcnt lgkmcnt(10)
v_mfma_f32_32x32x16_bf16 v[60:75], v[32:35], v[52:55], v[60:75]
ds_read_b64_tr_b16 v[28:29], v11 offset:6144
ds_read_b64_tr_b16 v[30:31], v11 offset:6656
s_barrier
v_add_u32 v10, 40960, v9
v_add_u32 v12, 32768, v3
ds_read_b128 v[52:55], v12 offset:0
s_waitcnt lgkmcnt(10)
v_mfma_f32_32x32x16_bf16 v[60:75], v[36:39], v[56:59], v[60:75]
ds_read_b64_tr_b16 v[32:33], v10 offset:0
ds_read_b64_tr_b16 v[34:35], v10 offset:512
ds_read_b128 v[56:59], v12 offset:1024
s_waitcnt lgkmcnt(10)
v_mfma_f32_32x32x16_bf16 v[60:75], v[20:23], v[40:43], v[60:75]
ds_read_b64_tr_b16 v[36:37], v10 offset:2048
ds_read_b64_tr_b16 v[38:39], v10 offset:2560
ds_read_b128 v[40:43], v12 offset:2048
s_waitcnt lgkmcnt(10)
v_mfma_f32_32x32x16_bf16 v[60:75], v[24:27], v[44:47], v[60:75]
ds_read_b64_tr_b16 v[20:21], v10 offset:4096
ds_read_b64_tr_b16 v[22:23], v10 offset:4608
ds_read_b128 v[44:47], v12 offset:3072
s_waitcnt lgkmcnt(10)
v_mfma_f32_32x32x16_bf16 v[60:75], v[28:31], v[48:51], v[60:75]
ds_read_b64_tr_b16 v[24:25], v10 offset:6144
ds_read_b64_tr_b16 v[26:27], v10 offset:6656
s_barrier
v_add_u32 v11, 57344, v9
v_add_u32 v13, 49152, v3
ds_read_b128 v[48:51], v13 offset:0
s_waitcnt lgkmcnt(10)
v_mfma_f32_32x32x16_bf16 v[60:75], v[32:35], v[52:55], v[60:75]
ds_read_b64_tr_b16 v[28:29], v11 offset:0
ds_read_b64_tr_b16 v[30:31], v11 offset:512
ds_read_b128 v[52:55], v13 offset:1024
s_waitcnt lgkmcnt(10)
v_mfma_f32_32x32x16_bf16 v[60:75], v[36:39], v[56:59], v[60:75]
ds_read_b64_tr_b16 v[32:33], v11 offset:2048
ds_read_b64_tr_b16 v[34:35], v11 offset:2560
ds_read_b128 v[56:59], v13 offset:2048
s_waitcnt lgkmcnt(10)
v_mfma_f32_32x32x16_bf16 v[60:75], v[20:23], v[40:43], v[60:75]
ds_read_b64_tr_b16 v[36:37], v11 offset:4096
ds_read_b64_tr_b16 v[38:39], v11 offset:4608
ds_read_b128 v[40:43], v13 offset:3072
s_waitcnt lgkmcnt(10)
v_mfma_f32_32x32x16_bf16 v[60:75], v[24:27], v[44:47], v[60:75]
ds_read_b64_tr_b16 v[20:21], v11 offset:6144
ds_read_b64_tr_b16 v[22:23], v11 offset:6656
s_barrier
v_add_u32 v10, 73728, v9
v_add_u32 v12, 65536, v3
ds_read_b128 v[44:47], v12 offset:0
s_waitcnt lgkmcnt(10)
v_mfma_f32_32x32x16_bf16 v[60:75], v[28:31], v[48:51], v[60:75]
ds_read_b64_tr_b16 v[24:25], v10 offset:0
ds_read_b64_tr_b16 v[26:27], v10 offset:512
ds_read_b128 v[48:51], v12 offset:1024
s_waitcnt lgkmcnt(10)
v_mfma_f32_32x32x16_bf16 v[60:75], v[32:35], v[52:55], v[60:75]
ds_read_b64_tr_b16 v[28:29], v10 offset:2048
ds_read_b64_tr_b16 v[30:31], v10 offset:2560
ds_read_b128 v[52:55], v12 offset:2048
s_waitcnt lgkmcnt(10)
v_mfma_f32_32x32x16_bf16 v[60:75], v[36:39], v[56:59], v[60:75]
ds_read_b64_tr_b16 v[32:33], v10 offset:4096
ds_read_b64_tr_b16 v[34:35], v10 offset:4608
ds_read_b128 v[56:59], v12 offset:3072
s_waitcnt lgkmcnt(10)
v_mfma_f32_32x32x16_bf16 v[60:75], v[20:23], v[40:43], v[60:75]
ds_read_b64_tr_b16 v[36:37], v10 offset:6144
ds_read_b64_tr_b16 v[38:39], v10 offset:6656
s_barrier
v_add_u32 v11, 90112, v9
v_add_u32 v13, 81920, v3
ds_read_b128 v[40:43], v13 offset:0
s_waitcnt lgkmcnt(10)
v_mfma_f32_32x32x16_bf16 v[60:75], v[24:27], v[44:47], v[60:75]
ds_read_b64_tr_b16 v[20:21], v11 offset:0
ds_read_b64_tr_b16 v[22:23], v11 offset:512
ds_read_b128 v[44:47], v13 offset:1024
s_waitcnt lgkmcnt(10)
v_mfma_f32_32x32x16_bf16 v[60:75], v[28:31], v[48:51], v[60:75]
ds_read_b64_tr_b16 v[24:25], v11 offset:2048
ds_read_b64_tr_b16 v[26:27], v11 offset:2560
ds_read_b128 v[48:51], v13 offset:2048
s_waitcnt lgkmcnt(10)
v_mfma_f32_32x32x16_bf16 v[60:75], v[32:35], v[52:55], v[60:75]
ds_read_b64_tr_b16 v[28:29], v11 offset:4096
ds_read_b64_tr_b16 v[30:31], v11 offset:4608
ds_read_b128 v[52:55], v13 offset:3072
s_waitcnt lgkmcnt(10)
v_mfma_f32_32x32x16_bf16 v[60:75], v[36:39], v[56:59], v[60:75]
ds_read_b64_tr_b16 v[32:33], v11 offset:6144
ds_read_b64_tr_b16 v[34:35], v11 offset:6656
s_barrier
v_add_u32 v10, 106496, v9
v_add_u32 v12, 98304, v3
ds_read_b128 v[56:59], v12 offset:0
s_waitcnt lgkmcnt(10)
v_mfma_f32_32x32x16_bf16 v[60:75], v[20:23], v[40:43], v[60:75]
ds_read_b64_tr_b16 v[36:37], v10 offset:0
ds_read_b64_tr_b16 v[38:39], v10 offset:512
ds_read_b128 v[40:43], v12 offset:1024
s_waitcnt lgkmcnt(10)
v_mfma_f32_32x32x16_bf16 v[60:75], v[24:27], v[44:47], v[60:75]
ds_read_b64_tr_b16 v[20:21], v10 offset:2048
ds_read_b64_tr_b16 v[22:23], v10 offset:2560
ds_read_b128 v[44:47], v12 offset:2048
s_waitcnt lgkmcnt(10)
v_mfma_f32_32x32x16_bf16 v[60:75], v[28:31], v[48:51], v[60:75]
ds_read_b64_tr_b16 v[24:25], v10 offset:4096
ds_read_b64_tr_b16 v[26:27], v10 offset:4608
ds_read_b128 v[48:51], v12 offset:3072
s_waitcnt lgkmcnt(10)
v_mfma_f32_32x32x16_bf16 v[60:75], v[32:35], v[52:55], v[60:75]
ds_read_b64_tr_b16 v[28:29], v10 offset:6144
ds_read_b64_tr_b16 v[30:31], v10 offset:6656
s_barrier
v_add_u32 v11, 122880, v9
v_add_u32 v13, 114688, v3
ds_read_b128 v[52:55], v13 offset:0
s_waitcnt lgkmcnt(10)
v_mfma_f32_32x32x16_bf16 v[60:75], v[36:39], v[56:59], v[60:75]
ds_read_b64_tr_b16 v[32:33], v11 offset:0
ds_read_b64_tr_b16 v[34:35], v11 offset:512
ds_read_b128 v[56:59], v13 offset:1024
s_waitcnt lgkmcnt(10)
v_mfma_f32_32x32x16_bf16 v[60:75], v[20:23], v[40:43], v[60:75]
ds_read_b64_tr_b16 v[36:37], v11 offset:2048
ds_read_b64_tr_b16 v[38:39], v11 offset:2560
ds_read_b128 v[40:43], v13 offset:2048
s_waitcnt lgkmcnt(10)
v_mfma_f32_32x32x16_bf16 v[60:75], v[24:27], v[44:47], v[60:75]
ds_read_b64_tr_b16 v[20:21], v11 offset:4096
ds_read_b64_tr_b16 v[22:23], v11 offset:4608
ds_read_b128 v[44:47], v13 offset:3072
s_waitcnt lgkmcnt(10)
v_mfma_f32_32x32x16_bf16 v[60:75], v[28:31], v[48:51], v[60:75]
ds_read_b64_tr_b16 v[24:25], v11 offset:6144
ds_read_b64_tr_b16 v[26:27], v11 offset:6656
s_barrier
v_add_u32 v10, 139264, v9
v_add_u32 v12, 131072, v3
ds_read_b128 v[48:51], v12 offset:0
s_waitcnt lgkmcnt(10)
v_mfma_f32_32x32x16_bf16 v[60:75], v[32:35], v[52:55], v[60:75]
ds_read_b64_tr_b16 v[28:29], v10 offset:0
ds_read_b64_tr_b16 v[30:31], v10 offset:512
ds_read_b128 v[52:55], v12 offset:1024
s_waitcnt lgkmcnt(10)
v_mfma_f32_32x32x16_bf16 v[60:75], v[36:39], v[56:59], v[60:75]
ds_read_b64_tr_b16 v[32:33], v10 offset:2048
ds_read_b64_tr_b16 v[34:35], v10 offset:2560
ds_read_b128 v[56:59], v12 offset:2048
s_waitcnt lgkmcnt(10)
v_mfma_f32_32x32x16_bf16 v[60:75], v[20:23], v[40:43], v[60:75]
ds_read_b64_tr_b16 v[36:37], v10 offset:4096
ds_read_b64_tr_b16 v[38:39], v10 offset:4608
ds_read_b128 v[40:43], v12 offset:3072
s_waitcnt lgkmcnt(10)
v_mfma_f32_32x32x16_bf16 v[60:75], v[24:27], v[44:47], v[60:75]
ds_read_b64_tr_b16 v[20:21], v10 offset:6144
ds_read_b64_tr_b16 v[22:23], v10 offset:6656
s_barrier
v_add_u32 v11, 8192, v9
v_add_u32 v13, 0, v3
ds_read_b128 v[44:47], v13 offset:0
s_waitcnt lgkmcnt(10)
v_mfma_f32_32x32x16_bf16 v[60:75], v[28:31], v[48:51], v[60:75]
ds_read_b64_tr_b16 v[24:25], v11 offset:0
ds_read_b64_tr_b16 v[26:27], v11 offset:512
ds_read_b128 v[48:51], v13 offset:1024
s_waitcnt lgkmcnt(10)
v_mfma_f32_32x32x16_bf16 v[60:75], v[32:35], v[52:55], v[60:75]
ds_read_b64_tr_b16 v[28:29], v11 offset:2048
ds_read_b64_tr_b16 v[30:31], v11 offset:2560
ds_read_b128 v[52:55], v13 offset:2048
s_waitcnt lgkmcnt(10)
v_mfma_f32_32x32x16_bf16 v[60:75], v[36:39], v[56:59], v[60:75]
ds_read_b64_tr_b16 v[32:33], v11 offset:4096
ds_read_b64_tr_b16 v[34:35], v11 offset:4608
ds_read_b128 v[56:59], v13 offset:3072
s_waitcnt lgkmcnt(10)
v_mfma_f32_32x32x16_bf16 v[60:75], v[20:23], v[40:43], v[60:75]
ds_read_b64_tr_b16 v[36:37], v11 offset:6144
ds_read_b64_tr_b16 v[38:39], v11 offset:6656
s_barrier
v_add_u32 v10, 24576, v9
v_add_u32 v12, 16384, v3
ds_read_b128 v[40:43], v12 offset:0
s_waitcnt lgkmcnt(10)
v_mfma_f32_32x32x16_bf16 v[60:75], v[24:27], v[44:47], v[60:75]
ds_read_b64_tr_b16 v[20:21], v10 offset:0
ds_read_b64_tr_b16 v[22:23], v10 offset:512
ds_read_b128 v[44:47], v12 offset:1024
s_waitcnt lgkmcnt(10)
v_mfma_f32_32x32x16_bf16 v[60:75], v[28:31], v[48:51], v[60:75]
ds_read_b64_tr_b16 v[24:25], v10 offset:2048
ds_read_b64_tr_b16 v[26:27], v10 offset:2560
ds_read_b128 v[48:51], v12 offset:2048
s_waitcnt lgkmcnt(10)
v_mfma_f32_32x32x16_bf16 v[60:75], v[32:35], v[52:55], v[60:75]
ds_read_b64_tr_b16 v[28:29], v10 offset:4096
ds_read_b64_tr_b16 v[30:31], v10 offset:4608
ds_read_b128 v[52:55], v12 offset:3072
s_waitcnt lgkmcnt(10)
v_mfma_f32_32x32x16_bf16 v[60:75], v[36:39], v[56:59], v[60:75]
ds_read_b64_tr_b16 v[32:33], v10 offset:6144
ds_read_b64_tr_b16 v[34:35], v10 offset:6656
s_barrier
v_add_u32 v11, 40960, v9
v_add_u32 v13, 32768, v3
ds_read_b128 v[56:59], v13 offset:0
s_waitcnt lgkmcnt(10)
v_mfma_f32_32x32x16_bf16 v[60:75], v[20:23], v[40:43], v[60:75]
ds_read_b64_tr_b16 v[36:37], v11 offset:0
ds_read_b64_tr_b16 v[38:39], v11 offset:512
ds_read_b128 v[40:43], v13 offset:1024
s_waitcnt lgkmcnt(10)
v_mfma_f32_32x32x16_bf16 v[60:75], v[24:27], v[44:47], v[60:75]
ds_read_b64_tr_b16 v[20:21], v11 offset:2048
ds_read_b64_tr_b16 v[22:23], v11 offset:2560
ds_read_b128 v[44:47], v13 offset:2048
s_waitcnt lgkmcnt(10)
v_mfma_f32_32x32x16_bf16 v[60:75], v[28:31], v[48:51], v[60:75]
ds_read_b64_tr_b16 v[24:25], v11 offset:4096
ds_read_b64_tr_b16 v[26:27], v11 offset:4608
ds_read_b128 v[48:51], v13 offset:3072
s_waitcnt lgkmcnt(10)
v_mfma_f32_32x32x16_bf16 v[60:75], v[32:35], v[52:55], v[60:75]
ds_read_b64_tr_b16 v[28:29], v11 offset:6144
ds_read_b64_tr_b16 v[30:31], v11 offset:6656
s_barrier
v_add_u32 v10, 57344, v9
v_add_u32 v12, 49152, v3
ds_read_b128 v[52:55], v12 offset:0
s_waitcnt lgkmcnt(10)
v_mfma_f32_32x32x16_bf16 v[60:75], v[36:39], v[56:59], v[60:75]
ds_read_b64_tr_b16 v[32:33], v10 offset:0
ds_read_b64_tr_b16 v[34:35], v10 offset:512
ds_read_b128 v[56:59], v12 offset:1024
s_waitcnt lgkmcnt(10)
v_mfma_f32_32x32x16_bf16 v[60:75], v[20:23], v[40:43], v[60:75]
ds_read_b64_tr_b16 v[36:37], v10 offset:2048
ds_read_b64_tr_b16 v[38:39], v10 offset:2560
ds_read_b128 v[40:43], v12 offset:2048
s_waitcnt lgkmcnt(10)
v_mfma_f32_32x32x16_bf16 v[60:75], v[24:27], v[44:47], v[60:75]
ds_read_b64_tr_b16 v[20:21], v10 offset:4096
ds_read_b64_tr_b16 v[22:23], v10 offset:4608
ds_read_b128 v[44:47], v12 offset:3072
s_waitcnt lgkmcnt(10)
v_mfma_f32_32x32x16_bf16 v[60:75], v[28:31], v[48:51], v[60:75]
ds_read_b64_tr_b16 v[24:25], v10 offset:6144
ds_read_b64_tr_b16 v[26:27], v10 offset:6656
s_barrier
v_add_u32 v11, 73728, v9
v_add_u32 v13, 65536, v3
ds_read_b128 v[48:51], v13 offset:0
s_waitcnt lgkmcnt(10)
v_mfma_f32_32x32x16_bf16 v[60:75], v[32:35], v[52:55], v[60:75]
ds_read_b64_tr_b16 v[28:29], v11 offset:0
ds_read_b64_tr_b16 v[30:31], v11 offset:512
ds_read_b128 v[52:55], v13 offset:1024
s_waitcnt lgkmcnt(10)
v_mfma_f32_32x32x16_bf16 v[60:75], v[36:39], v[56:59], v[60:75]
ds_read_b64_tr_b16 v[32:33], v11 offset:2048
ds_read_b64_tr_b16 v[34:35], v11 offset:2560
ds_read_b128 v[56:59], v13 offset:2048
s_waitcnt lgkmcnt(10)
v_mfma_f32_32x32x16_bf16 v[60:75], v[20:23], v[40:43], v[60:75]
ds_read_b64_tr_b16 v[36:37], v11 offset:4096
ds_read_b64_tr_b16 v[38:39], v11 offset:4608
ds_read_b128 v[40:43], v13 offset:3072
s_waitcnt lgkmcnt(10)
v_mfma_f32_32x32x16_bf16 v[60:75], v[24:27], v[44:47], v[60:75]
ds_read_b64_tr_b16 v[20:21], v11 offset:6144
ds_read_b64_tr_b16 v[22:23], v11 offset:6656
s_barrier
v_add_u32 v10, 90112, v9
v_add_u32 v12, 81920, v3
ds_read_b128 v[44:47], v12 offset:0
s_waitcnt lgkmcnt(10)
v_mfma_f32_32x32x16_bf16 v[60:75], v[28:31], v[48:51], v[60:75]
ds_read_b64_tr_b16 v[24:25], v10 offset:0
ds_read_b64_tr_b16 v[26:27], v10 offset:512
ds_read_b128 v[48:51], v12 offset:1024
s_waitcnt lgkmcnt(10)
v_mfma_f32_32x32x16_bf16 v[60:75], v[32:35], v[52:55], v[60:75]
ds_read_b64_tr_b16 v[28:29], v10 offset:2048
ds_read_b64_tr_b16 v[30:31], v10 offset:2560
ds_read_b128 v[52:55], v12 offset:2048
s_waitcnt lgkmcnt(10)
v_mfma_f32_32x32x16_bf16 v[60:75], v[36:39], v[56:59], v[60:75]
ds_read_b64_tr_b16 v[32:33], v10 offset:4096
ds_read_b64_tr_b16 v[34:35], v10 offset:4608
ds_read_b128 v[56:59], v12 offset:3072
s_waitcnt lgkmcnt(10)
v_mfma_f32_32x32x16_bf16 v[60:75], v[20:23], v[40:43], v[60:75]
ds_read_b64_tr_b16 v[36:37], v10 offset:6144
ds_read_b64_tr_b16 v[38:39], v10 offset:6656
s_barrier
v_add_u32 v11, 106496, v9
v_add_u32 v13, 98304, v3
ds_read_b128 v[40:43], v13 offset:0
s_waitcnt lgkmcnt(10)
v_mfma_f32_32x32x16_bf16 v[60:75], v[24:27], v[44:47], v[60:75]
ds_read_b64_tr_b16 v[20:21], v11 offset:0
ds_read_b64_tr_b16 v[22:23], v11 offset:512
ds_read_b128 v[44:47], v13 offset:1024
s_waitcnt lgkmcnt(10)
v_mfma_f32_32x32x16_bf16 v[60:75], v[28:31], v[48:51], v[60:75]
ds_read_b64_tr_b16 v[24:25], v11 offset:2048
ds_read_b64_tr_b16 v[26:27], v11 offset:2560
ds_read_b128 v[48:51], v13 offset:2048
s_waitcnt lgkmcnt(10)
v_mfma_f32_32x32x16_bf16 v[60:75], v[32:35], v[52:55], v[60:75]
ds_read_b64_tr_b16 v[28:29], v11 offset:4096
ds_read_b64_tr_b16 v[30:31], v11 offset:4608
ds_read_b128 v[52:55], v13 offset:3072
s_waitcnt lgkmcnt(10)
v_mfma_f32_32x32x16_bf16 v[60:75], v[36:39], v[56:59], v[60:75]
ds_read_b64_tr_b16 v[32:33], v11 offset:6144
ds_read_b64_tr_b16 v[34:35], v11 offset:6656
s_barrier
v_add_u32 v10, 122880, v9
v_add_u32 v12, 114688, v3
ds_read_b128 v[56:59], v12 offset:0
s_waitcnt lgkmcnt(10)
v_mfma_f32_32x32x16_bf16 v[60:75], v[20:23], v[40:43], v[60:75]
ds_read_b64_tr_b16 v[36:37], v10 offset:0
ds_read_b64_tr_b16 v[38:39], v10 offset:512
ds_read_b128 v[40:43], v12 offset:1024
s_waitcnt lgkmcnt(10)
v_mfma_f32_32x32x16_bf16 v[60:75], v[24:27], v[44:47], v[60:75]
ds_read_b64_tr_b16 v[20:21], v10 offset:2048
ds_read_b64_tr_b16 v[22:23], v10 offset:2560
ds_read_b128 v[44:47], v12 offset:2048
s_waitcnt lgkmcnt(10)
v_mfma_f32_32x32x16_bf16 v[60:75], v[28:31], v[48:51], v[60:75]
ds_read_b64_tr_b16 v[24:25], v10 offset:4096
ds_read_b64_tr_b16 v[26:27], v10 offset:4608
ds_read_b128 v[48:51], v12 offset:3072
s_waitcnt lgkmcnt(10)
v_mfma_f32_32x32x16_bf16 v[60:75], v[32:35], v[52:55], v[60:75]
ds_read_b64_tr_b16 v[28:29], v10 offset:6144
ds_read_b64_tr_b16 v[30:31], v10 offset:6656
s_barrier
v_add_u32 v11, 139264, v9
v_add_u32 v13, 131072, v3
ds_read_b128 v[52:55], v13 offset:0
s_waitcnt lgkmcnt(10)
v_mfma_f32_32x32x16_bf16 v[60:75], v[36:39], v[56:59], v[60:75]
ds_read_b64_tr_b16 v[32:33], v11 offset:0
ds_read_b64_tr_b16 v[34:35], v11 offset:512
ds_read_b128 v[56:59], v13 offset:1024
s_waitcnt lgkmcnt(10)
v_mfma_f32_32x32x16_bf16 v[60:75], v[20:23], v[40:43], v[60:75]
ds_read_b64_tr_b16 v[36:37], v11 offset:2048
ds_read_b64_tr_b16 v[38:39], v11 offset:2560
ds_read_b128 v[40:43], v13 offset:2048
s_waitcnt lgkmcnt(10)
v_mfma_f32_32x32x16_bf16 v[60:75], v[24:27], v[44:47], v[60:75]
ds_read_b64_tr_b16 v[20:21], v11 offset:4096
ds_read_b64_tr_b16 v[22:23], v11 offset:4608
ds_read_b128 v[44:47], v13 offset:3072
s_waitcnt lgkmcnt(10)
v_mfma_f32_32x32x16_bf16 v[60:75], v[28:31], v[48:51], v[60:75]
ds_read_b64_tr_b16 v[24:25], v11 offset:6144
ds_read_b64_tr_b16 v[26:27], v11 offset:6656
s_barrier
v_add_u32 v10, 8192, v9
v_add_u32 v12, 0, v3
ds_read_b128 v[48:51], v12 offset:0
s_waitcnt lgkmcnt(10)
v_mfma_f32_32x32x16_bf16 v[60:75], v[32:35], v[52:55], v[60:75]
ds_read_b64_tr_b16 v[28:29], v10 offset:0
ds_read_b64_tr_b16 v[30:31], v10 offset:512
ds_read_b128 v[52:55], v12 offset:1024
s_waitcnt lgkmcnt(10)
v_mfma_f32_32x32x16_bf16 v[60:75], v[36:39], v[56:59], v[60:75]
ds_read_b64_tr_b16 v[32:33], v10 offset:2048
ds_read_b64_tr_b16 v[34:35], v10 offset:2560
ds_read_b128 v[56:59], v12 offset:2048
s_waitcnt lgkmcnt(10)
v_mfma_f32_32x32x16_bf16 v[60:75], v[20:23], v[40:43], v[60:75]
ds_read_b64_tr_b16 v[36:37], v10 offset:4096
ds_read_b64_tr_b16 v[38:39], v10 offset:4608
ds_read_b128 v[40:43], v12 offset:3072
s_waitcnt lgkmcnt(10)
v_mfma_f32_32x32x16_bf16 v[60:75], v[24:27], v[44:47], v[60:75]
ds_read_b64_tr_b16 v[20:21], v10 offset:6144
ds_read_b64_tr_b16 v[22:23], v10 offset:6656
s_barrier
v_add_u32 v11, 24576, v9
v_add_u32 v13, 16384, v3
ds_read_b128 v[44:47], v13 offset:0
s_waitcnt lgkmcnt(10)
v_mfma_f32_32x32x16_bf16 v[60:75], v[28:31], v[48:51], v[60:75]
ds_read_b64_tr_b16 v[24:25], v11 offset:0
ds_read_b64_tr_b16 v[26:27], v11 offset:512
ds_read_b128 v[48:51], v13 offset:1024
s_waitcnt lgkmcnt(10)
v_mfma_f32_32x32x16_bf16 v[60:75], v[32:35], v[52:55], v[60:75]
ds_read_b64_tr_b16 v[28:29], v11 offset:2048
ds_read_b64_tr_b16 v[30:31], v11 offset:2560
ds_read_b128 v[52:55], v13 offset:2048
s_waitcnt lgkmcnt(10)
v_mfma_f32_32x32x16_bf16 v[60:75], v[36:39], v[56:59], v[60:75]
ds_read_b64_tr_b16 v[32:33], v11 offset:4096
ds_read_b64_tr_b16 v[34:35], v11 offset:4608
ds_read_b128 v[56:59], v13 offset:3072
s_waitcnt lgkmcnt(10)
v_mfma_f32_32x32x16_bf16 v[60:75], v[20:23], v[40:43], v[60:75]
ds_read_b64_tr_b16 v[36:37], v11 offset:6144
ds_read_b64_tr_b16 v[38:39], v11 offset:6656
s_barrier
v_add_u32 v10, 40960, v9
v_add_u32 v12, 32768, v3
ds_read_b128 v[40:43], v12 offset:0
s_waitcnt lgkmcnt(10)
v_mfma_f32_32x32x16_bf16 v[60:75], v[24:27], v[44:47], v[60:75]
ds_read_b64_tr_b16 v[20:21], v10 offset:0
ds_read_b64_tr_b16 v[22:23], v10 offset:512
ds_read_b128 v[44:47], v12 offset:1024
s_waitcnt lgkmcnt(10)
v_mfma_f32_32x32x16_bf16 v[60:75], v[28:31], v[48:51], v[60:75]
ds_read_b64_tr_b16 v[24:25], v10 offset:2048
ds_read_b64_tr_b16 v[26:27], v10 offset:2560
ds_read_b128 v[48:51], v12 offset:2048
s_waitcnt lgkmcnt(10)
v_mfma_f32_32x32x16_bf16 v[60:75], v[32:35], v[52:55], v[60:75]
ds_read_b64_tr_b16 v[28:29], v10 offset:4096
ds_read_b64_tr_b16 v[30:31], v10 offset:4608
ds_read_b128 v[52:55], v12 offset:3072
s_waitcnt lgkmcnt(10)
v_mfma_f32_32x32x16_bf16 v[60:75], v[36:39], v[56:59], v[60:75]
ds_read_b64_tr_b16 v[32:33], v10 offset:6144
ds_read_b64_tr_b16 v[34:35], v10 offset:6656
s_barrier
v_add_u32 v11, 57344, v9
v_add_u32 v13, 49152, v3
ds_read_b128 v[56:59], v13 offset:0
s_waitcnt lgkmcnt(10)
v_mfma_f32_32x32x16_bf16 v[60:75], v[20:23], v[40:43], v[60:75]
ds_read_b64_tr_b16 v[36:37], v11 offset:0
ds_read_b64_tr_b16 v[38:39], v11 offset:512
ds_read_b128 v[40:43], v13 offset:1024
s_waitcnt lgkmcnt(10)
v_mfma_f32_32x32x16_bf16 v[60:75], v[24:27], v[44:47], v[60:75]
ds_read_b64_tr_b16 v[20:21], v11 offset:2048
ds_read_b64_tr_b16 v[22:23], v11 offset:2560
ds_read_b128 v[44:47], v13 offset:2048
s_waitcnt lgkmcnt(10)
v_mfma_f32_32x32x16_bf16 v[60:75], v[28:31], v[48:51], v[60:75]
ds_read_b64_tr_b16 v[24:25], v11 offset:4096
ds_read_b64_tr_b16 v[26:27], v11 offset:4608
ds_read_b128 v[48:51], v13 offset:3072
s_waitcnt lgkmcnt(10)
v_mfma_f32_32x32x16_bf16 v[60:75], v[32:35], v[52:55], v[60:75]
ds_read_b64_tr_b16 v[28:29], v11 offset:6144
ds_read_b64_tr_b16 v[30:31], v11 offset:6656
s_barrier
v_add_u32 v10, 73728, v9
v_add_u32 v12, 65536, v3
ds_read_b128 v[52:55], v12 offset:0
s_waitcnt lgkmcnt(10)
v_mfma_f32_32x32x16_bf16 v[60:75], v[36:39], v[56:59], v[60:75]
ds_read_b64_tr_b16 v[32:33], v10 offset:0
ds_read_b64_tr_b16 v[34:35], v10 offset:512
ds_read_b128 v[56:59], v12 offset:1024
s_waitcnt lgkmcnt(10)
v_mfma_f32_32x32x16_bf16 v[60:75], v[20:23], v[40:43], v[60:75]
ds_read_b64_tr_b16 v[36:37], v10 offset:2048
ds_read_b64_tr_b16 v[38:39], v10 offset:2560
ds_read_b128 v[40:43], v12 offset:2048
s_waitcnt lgkmcnt(10)
v_mfma_f32_32x32x16_bf16 v[60:75], v[24:27], v[44:47], v[60:75]
ds_read_b64_tr_b16 v[20:21], v10 offset:4096
ds_read_b64_tr_b16 v[22:23], v10 offset:4608
ds_read_b128 v[44:47], v12 offset:3072
s_waitcnt lgkmcnt(10)
v_mfma_f32_32x32x16_bf16 v[60:75], v[28:31], v[48:51], v[60:75]
ds_read_b64_tr_b16 v[24:25], v10 offset:6144
ds_read_b64_tr_b16 v[26:27], v10 offset:6656
s_barrier
v_add_u32 v11, 90112, v9
v_add_u32 v13, 81920, v3
ds_read_b128 v[48:51], v13 offset:0
s_waitcnt lgkmcnt(10)
v_mfma_f32_32x32x16_bf16 v[60:75], v[32:35], v[52:55], v[60:75]
ds_read_b64_tr_b16 v[28:29], v11 offset:0
ds_read_b64_tr_b16 v[30:31], v11 offset:512
ds_read_b128 v[52:55], v13 offset:1024
s_waitcnt lgkmcnt(10)
v_mfma_f32_32x32x16_bf16 v[60:75], v[36:39], v[56:59], v[60:75]
ds_read_b64_tr_b16 v[32:33], v11 offset:2048
ds_read_b64_tr_b16 v[34:35], v11 offset:2560
ds_read_b128 v[56:59], v13 offset:2048
s_waitcnt lgkmcnt(10)
v_mfma_f32_32x32x16_bf16 v[60:75], v[20:23], v[40:43], v[60:75]
ds_read_b64_tr_b16 v[36:37], v11 offset:4096
ds_read_b64_tr_b16 v[38:39], v11 offset:4608
ds_read_b128 v[40:43], v13 offset:3072
s_waitcnt lgkmcnt(10)
v_mfma_f32_32x32x16_bf16 v[60:75], v[24:27], v[44:47], v[60:75]
ds_read_b64_tr_b16 v[20:21], v11 offset:6144
ds_read_b64_tr_b16 v[22:23], v11 offset:6656
s_barrier
v_add_u32 v10, 106496, v9
v_add_u32 v12, 98304, v3
ds_read_b128 v[44:47], v12 offset:0
s_waitcnt lgkmcnt(10)
v_mfma_f32_32x32x16_bf16 v[60:75], v[28:31], v[48:51], v[60:75]
ds_read_b64_tr_b16 v[24:25], v10 offset:0
ds_read_b64_tr_b16 v[26:27], v10 offset:512
ds_read_b128 v[48:51], v12 offset:1024
s_waitcnt lgkmcnt(10)
v_mfma_f32_32x32x16_bf16 v[60:75], v[32:35], v[52:55], v[60:75]
ds_read_b64_tr_b16 v[28:29], v10 offset:2048
ds_read_b64_tr_b16 v[30:31], v10 offset:2560
ds_read_b128 v[52:55], v12 offset:2048
s_waitcnt lgkmcnt(10)
v_mfma_f32_32x32x16_bf16 v[60:75], v[36:39], v[56:59], v[60:75]
ds_read_b64_tr_b16 v[32:33], v10 offset:4096
ds_read_b64_tr_b16 v[34:35], v10 offset:4608
ds_read_b128 v[56:59], v12 offset:3072
s_waitcnt lgkmcnt(10)
v_mfma_f32_32x32x16_bf16 v[60:75], v[20:23], v[40:43], v[60:75]
ds_read_b64_tr_b16 v[36:37], v10 offset:6144
ds_read_b64_tr_b16 v[38:39], v10 offset:6656
s_barrier
v_add_u32 v11, 122880, v9
v_add_u32 v13, 114688, v3
ds_read_b128 v[40:43], v13 offset:0
s_waitcnt lgkmcnt(10)
v_mfma_f32_32x32x16_bf16 v[60:75], v[24:27], v[44:47], v[60:75]
ds_read_b64_tr_b16 v[20:21], v11 offset:0
ds_read_b64_tr_b16 v[22:23], v11 offset:512
ds_read_b128 v[44:47], v13 offset:1024
s_waitcnt lgkmcnt(10)
v_mfma_f32_32x32x16_bf16 v[60:75], v[28:31], v[48:51], v[60:75]
ds_read_b64_tr_b16 v[24:25], v11 offset:2048
ds_read_b64_tr_b16 v[26:27], v11 offset:2560
ds_read_b128 v[48:51], v13 offset:2048
s_waitcnt lgkmcnt(10)
v_mfma_f32_32x32x16_bf16 v[60:75], v[32:35], v[52:55], v[60:75]
ds_read_b64_tr_b16 v[28:29], v11 offset:4096
ds_read_b64_tr_b16 v[30:31], v11 offset:4608
ds_read_b128 v[52:55], v13 offset:3072
s_waitcnt lgkmcnt(10)
v_mfma_f32_32x32x16_bf16 v[60:75], v[36:39], v[56:59], v[60:75]
ds_read_b64_tr_b16 v[32:33], v11 offset:6144
ds_read_b64_tr_b16 v[34:35], v11 offset:6656
s_barrier
v_add_u32 v10, 139264, v9
v_add_u32 v12, 131072, v3
ds_read_b128 v[56:59], v12 offset:0
s_waitcnt lgkmcnt(10)
v_mfma_f32_32x32x16_bf16 v[60:75], v[20:23], v[40:43], v[60:75]
ds_read_b64_tr_b16 v[36:37], v10 offset:0
ds_read_b64_tr_b16 v[38:39], v10 offset:512
ds_read_b128 v[40:43], v12 offset:1024
s_waitcnt lgkmcnt(10)
v_mfma_f32_32x32x16_bf16 v[60:75], v[24:27], v[44:47], v[60:75]
ds_read_b64_tr_b16 v[20:21], v10 offset:2048
ds_read_b64_tr_b16 v[22:23], v10 offset:2560
ds_read_b128 v[44:47], v12 offset:2048
s_waitcnt lgkmcnt(10)
v_mfma_f32_32x32x16_bf16 v[60:75], v[28:31], v[48:51], v[60:75]
ds_read_b64_tr_b16 v[24:25], v10 offset:4096
ds_read_b64_tr_b16 v[26:27], v10 offset:4608
ds_read_b128 v[48:51], v12 offset:3072
s_waitcnt lgkmcnt(10)
v_mfma_f32_32x32x16_bf16 v[60:75], v[32:35], v[52:55], v[60:75]
ds_read_b64_tr_b16 v[28:29], v10 offset:6144
ds_read_b64_tr_b16 v[30:31], v10 offset:6656
s_barrier
v_add_u32 v11, 8192, v9
v_add_u32 v13, 0, v3
ds_read_b128 v[52:55], v13 offset:0
s_waitcnt lgkmcnt(10)
v_mfma_f32_32x32x16_bf16 v[60:75], v[36:39], v[56:59], v[60:75]
ds_read_b64_tr_b16 v[32:33], v11 offset:0
ds_read_b64_tr_b16 v[34:35], v11 offset:512
ds_read_b128 v[56:59], v13 offset:1024
s_waitcnt lgkmcnt(10)
v_mfma_f32_32x32x16_bf16 v[60:75], v[20:23], v[40:43], v[60:75]
ds_read_b64_tr_b16 v[36:37], v11 offset:2048
ds_read_b64_tr_b16 v[38:39], v11 offset:2560
ds_read_b128 v[40:43], v13 offset:2048
s_waitcnt lgkmcnt(10)
v_mfma_f32_32x32x16_bf16 v[60:75], v[24:27], v[44:47], v[60:75]
ds_read_b64_tr_b16 v[20:21], v11 offset:4096
ds_read_b64_tr_b16 v[22:23], v11 offset:4608
ds_read_b128 v[44:47], v13 offset:3072
s_waitcnt lgkmcnt(10)
v_mfma_f32_32x32x16_bf16 v[60:75], v[28:31], v[48:51], v[60:75]
ds_read_b64_tr_b16 v[24:25], v11 offset:6144
ds_read_b64_tr_b16 v[26:27], v11 offset:6656
s_waitcnt lgkmcnt(9)
v_mfma_f32_32x32x16_bf16 v[60:75], v[32:35], v[52:55], v[60:75]
s_waitcnt lgkmcnt(6)
v_mfma_f32_32x32x16_bf16 v[60:75], v[36:39], v[56:59], v[60:75]
s_waitcnt lgkmcnt(3)
v_mfma_f32_32x32x16_bf16 v[60:75], v[20:23], v[40:43], v[60:75]
s_waitcnt lgkmcnt(0)
v_mfma_f32_32x32x16_bf16 v[60:75], v[24:27], v[44:47], v[60:75]
s_nop 11
v_cvt_pk_bf16_f32 v76, v60, v61
v_cvt_pk_bf16_f32 v77, v62, v63
v_cvt_pk_bf16_f32 v78, v64, v65
v_cvt_pk_bf16_f32 v79, v66, v67
v_cvt_pk_bf16_f32 v80, v68, v69
v_cvt_pk_bf16_f32 v81, v70, v71
v_cvt_pk_bf16_f32 v82, v72, v73
v_cvt_pk_bf16_f32 v83, v74, v75
v_lshlrev_b32 v60, 16, v76
v_and_b32 v61, 0xffff0000, v76
v_lshlrev_b32 v62, 16, v77
v_and_b32 v63, 0xffff0000, v77
v_lshlrev_b32 v64, 16, v78
v_and_b32 v65, 0xffff0000, v78
v_lshlrev_b32 v66, 16, v79
v_and_b32 v67, 0xffff0000, v79
v_lshlrev_b32 v68, 16, v80
v_and_b32 v69, 0xffff0000, v80
v_lshlrev_b32 v70, 16, v81
v_and_b32 v71, 0xffff0000, v81
v_lshlrev_b32 v72, 16, v82
v_and_b32 v73, 0xffff0000, v82
v_lshlrev_b32 v74, 16, v83
v_and_b32 v75, 0xffff0000, v83
s_waitcnt vmcnt(3)
v_lshlrev_b32 v84, 16, v88
v_and_b32 v85, 0xffff0000, v88
v_add_f32 v60, v60, v84
v_add_f32 v61, v61, v85
v_lshlrev_b32 v84, 16, v89
v_and_b32 v85, 0xffff0000, v89
v_add_f32 v62, v62, v84
v_add_f32 v63, v63, v85
s_waitcnt vmcnt(2)
v_lshlrev_b32 v84, 16, v90
v_and_b32 v85, 0xffff0000, v90
v_add_f32 v64, v64, v84
v_add_f32 v65, v65, v85
v_lshlrev_b32 v84, 16, v91
v_and_b32 v85, 0xffff0000, v91
v_add_f32 v66, v66, v84
v_add_f32 v67, v67, v85
s_waitcnt vmcnt(1)
v_lshlrev_b32 v84, 16, v92
v_and_b32 v85, 0xffff0000, v92
v_add_f32 v68, v68, v84
v_add_f32 v69, v69, v85
v_lshlrev_b32 v84, 16, v93
v_and_b32 v85, 0xffff0000, v93
v_add_f32 v70, v70, v84
v_add_f32 v71, v71, v85
s_waitcnt vmcnt(0)
v_lshlrev_b32 v84, 16, v94
v_and_b32 v85, 0xffff0000, v94
v_add_f32 v72, v72, v84
v_add_f32 v73, v73, v85
v_lshlrev_b32 v84, 16, v95
v_and_b32 v85, 0xffff0000, v95
v_add_f32 v74, v74, v84
v_add_f32 v75, v75, v85
v_cvt_pk_bf16_f32 v76, v60, v61
v_cvt_pk_bf16_f32 v77, v62, v63
v_cvt_pk_bf16_f32 v78, v64, v65
v_cvt_pk_bf16_f32 v79, v66, v67
v_cvt_pk_bf16_f32 v80, v68, v69
v_cvt_pk_bf16_f32 v81, v70, v71
v_cvt_pk_bf16_f32 v82, v72, v73
v_cvt_pk_bf16_f32 v83, v74, v75
v_permlane32_swap_b32 v76, v78
v_permlane32_swap_b32 v77, v79
v_permlane32_swap_b32 v80, v82
v_permlane32_swap_b32 v81, v83
buffer_store_dwordx4 v[76:79], v86, s[52:55], s9 offen
buffer_store_dwordx4 v[80:83], v86, s[52:55], s9 offen offset:32
s_waitcnt vmcnt(0)
s_branch k5_kernel_end
k5_kernel_w1:
s_lshl_b32 s7, s4, 1
s_add_u32 s7, s7, 0
s_lshl_b32 s8, s5, 7
s_add_u32 s8, s8, 64
s_lshl_b32 s10, s7, 5
s_lshr_b32 s11, s8, 5
s_add_u32 s10, s10, s11
s_lshl_b32 s10, s10, 10
v_and_b32 v86, 31, v1
v_lshlrev_b32 v87, 4, v86
v_lshl_add_u32 v87, v5, 3, v87
buffer_load_dwordx2 v[88:89], v87, s[56:59], s10 offen offset:0
buffer_load_dwordx2 v[90:91], v87, s[56:59], s10 offen offset:512
buffer_load_dwordx2 v[92:93], v87, s[56:59], s10 offen offset:1024
buffer_load_dwordx2 v[94:95], v87, s[56:59], s10 offen offset:1536
s_lshl_b32 s9, s7, 15
s_add_u32 s9, s9, s8
v_lshlrev_b32 v86, 10, v86
v_lshl_add_u32 v86, v5, 4, v86
v_lshrrev_b32 v14, 1, v8
v_lshl_add_u32 v14, v6, 1, v14
v_add_u32 v14, 4, v14
v_bfe_u32 v15, v4, 3, 1
v_lshlrev_b32 v15, 2, v15
v_xor_b32 v14, v14, v15
v_lshlrev_b32 v14, 4, v14
v_and_b32 v15, 1, v4
v_lshl_add_u32 v14, v15, 3, v14
v_lshl_add_u32 v9, v7, 7, v14
s_barrier
v_add_u32 v10, 8192, v9
v_add_u32 v12, 0, v3
ds_read_b128 v[40:43], v12 offset:0
ds_read_b64_tr_b16 v[20:21], v10 offset:0
ds_read_b64_tr_b16 v[22:23], v10 offset:512
ds_read_b128 v[44:47], v12 offset:1024
ds_read_b64_tr_b16 v[24:25], v10 offset:2048
ds_read_b64_tr_b16 v[26:27], v10 offset:2560
ds_read_b128 v[48:51], v12 offset:2048
ds_read_b64_tr_b16 v[28:29], v10 offset:4096
ds_read_b64_tr_b16 v[30:31], v10 offset:4608
ds_read_b128 v[52:55], v12 offset:3072
ds_read_b64_tr_b16 v[32:33], v10 offset:6144
ds_read_b64_tr_b16 v[34:35], v10 offset:6656
s_barrier
v_add_u32 v11, 24576, v9
v_add_u32 v13, 16384, v3
ds_read_b128 v[56:59], v13 offset:0
s_waitcnt lgkmcnt(10)
v_mfma_f32_32x32x16_bf16 v[60:75], v[20:23], v[40:43], 0
ds_read_b64_tr_b16 v[36:37], v11 offset:0
ds_read_b64_tr_b16 v[38:39], v11 offset:512
ds_read_b128 v[40:43], v13 offset:1024
s_waitcnt lgkmcnt(10)
v_mfma_f32_32x32x16_bf16 v[60:75], v[24:27], v[44:47], v[60:75]
ds_read_b64_tr_b16 v[20:21], v11 offset:2048
ds_read_b64_tr_b16 v[22:23], v11 offset:2560
ds_read_b128 v[44:47], v13 offset:2048
s_waitcnt lgkmcnt(10)
v_mfma_f32_32x32x16_bf16 v[60:75], v[28:31], v[48:51], v[60:75]
ds_read_b64_tr_b16 v[24:25], v11 offset:4096
ds_read_b64_tr_b16 v[26:27], v11 offset:4608
ds_read_b128 v[48:51], v13 offset:3072
s_waitcnt lgkmcnt(10)
v_mfma_f32_32x32x16_bf16 v[60:75], v[32:35], v[52:55], v[60:75]
ds_read_b64_tr_b16 v[28:29], v11 offset:6144
ds_read_b64_tr_b16 v[30:31], v11 offset:6656
s_barrier
v_add_u32 v10, 40960, v9
v_add_u32 v12, 32768, v3
ds_read_b128 v[52:55], v12 offset:0
s_waitcnt lgkmcnt(10)
v_mfma_f32_32x32x16_bf16 v[60:75], v[36:39], v[56:59], v[60:75]
ds_read_b64_tr_b16 v[32:33], v10 offset:0
ds_read_b64_tr_b16 v[34:35], v10 offset:512
ds_read_b128 v[56:59], v12 offset:1024
s_waitcnt lgkmcnt(10)
v_mfma_f32_32x32x16_bf16 v[60:75], v[20:23], v[40:43], v[60:75]
ds_read_b64_tr_b16 v[36:37], v10 offset:2048
ds_read_b64_tr_b16 v[38:39], v10 offset:2560
ds_read_b128 v[40:43], v12 offset:2048
s_waitcnt lgkmcnt(10)
v_mfma_f32_32x32x16_bf16 v[60:75], v[24:27], v[44:47], v[60:75]
ds_read_b64_tr_b16 v[20:21], v10 offset:4096
ds_read_b64_tr_b16 v[22:23], v10 offset:4608
ds_read_b128 v[44:47], v12 offset:3072
s_waitcnt lgkmcnt(10)
v_mfma_f32_32x32x16_bf16 v[60:75], v[28:31], v[48:51], v[60:75]
ds_read_b64_tr_b16 v[24:25], v10 offset:6144
ds_read_b64_tr_b16 v[26:27], v10 offset:6656
s_barrier
v_add_u32 v11, 57344, v9
v_add_u32 v13, 49152, v3
ds_read_b128 v[48:51], v13 offset:0
s_waitcnt lgkmcnt(10)
v_mfma_f32_32x32x16_bf16 v[60:75], v[32:35], v[52:55], v[60:75]
ds_read_b64_tr_b16 v[28:29], v11 offset:0
ds_read_b64_tr_b16 v[30:31], v11 offset:512
ds_read_b128 v[52:55], v13 offset:1024
s_waitcnt lgkmcnt(10)
v_mfma_f32_32x32x16_bf16 v[60:75], v[36:39], v[56:59], v[60:75]
ds_read_b64_tr_b16 v[32:33], v11 offset:2048
ds_read_b64_tr_b16 v[34:35], v11 offset:2560
ds_read_b128 v[56:59], v13 offset:2048
s_waitcnt lgkmcnt(10)
v_mfma_f32_32x32x16_bf16 v[60:75], v[20:23], v[40:43], v[60:75]
ds_read_b64_tr_b16 v[36:37], v11 offset:4096
ds_read_b64_tr_b16 v[38:39], v11 offset:4608
ds_read_b128 v[40:43], v13 offset:3072
s_waitcnt lgkmcnt(10)
v_mfma_f32_32x32x16_bf16 v[60:75], v[24:27], v[44:47], v[60:75]
ds_read_b64_tr_b16 v[20:21], v11 offset:6144
ds_read_b64_tr_b16 v[22:23], v11 offset:6656
s_barrier
v_add_u32 v10, 73728, v9
v_add_u32 v12, 65536, v3
ds_read_b128 v[44:47], v12 offset:0
s_waitcnt lgkmcnt(10)
v_mfma_f32_32x32x16_bf16 v[60:75], v[28:31], v[48:51], v[60:75]
ds_read_b64_tr_b16 v[24:25], v10 offset:0
ds_read_b64_tr_b16 v[26:27], v10 offset:512
ds_read_b128 v[48:51], v12 offset:1024
s_waitcnt lgkmcnt(10)
v_mfma_f32_32x32x16_bf16 v[60:75], v[32:35], v[52:55], v[60:75]
ds_read_b64_tr_b16 v[28:29], v10 offset:2048
ds_read_b64_tr_b16 v[30:31], v10 offset:2560
ds_read_b128 v[52:55], v12 offset:2048
s_waitcnt lgkmcnt(10)
v_mfma_f32_32x32x16_bf16 v[60:75], v[36:39], v[56:59], v[60:75]
ds_read_b64_tr_b16 v[32:33], v10 offset:4096
ds_read_b64_tr_b16 v[34:35], v10 offset:4608
ds_read_b128 v[56:59], v12 offset:3072
s_waitcnt lgkmcnt(10)
v_mfma_f32_32x32x16_bf16 v[60:75], v[20:23], v[40:43], v[60:75]
ds_read_b64_tr_b16 v[36:37], v10 offset:6144
ds_read_b64_tr_b16 v[38:39], v10 offset:6656
s_barrier
v_add_u32 v11, 90112, v9
v_add_u32 v13, 81920, v3
ds_read_b128 v[40:43], v13 offset:0
s_waitcnt lgkmcnt(10)
v_mfma_f32_32x32x16_bf16 v[60:75], v[24:27], v[44:47], v[60:75]
ds_read_b64_tr_b16 v[20:21], v11 offset:0
ds_read_b64_tr_b16 v[22:23], v11 offset:512
ds_read_b128 v[44:47], v13 offset:1024
s_waitcnt lgkmcnt(10)
v_mfma_f32_32x32x16_bf16 v[60:75], v[28:31], v[48:51], v[60:75]
ds_read_b64_tr_b16 v[24:25], v11 offset:2048
ds_read_b64_tr_b16 v[26:27], v11 offset:2560
ds_read_b128 v[48:51], v13 offset:2048
s_waitcnt lgkmcnt(10)
v_mfma_f32_32x32x16_bf16 v[60:75], v[32:35], v[52:55], v[60:75]
ds_read_b64_tr_b16 v[28:29], v11 offset:4096
ds_read_b64_tr_b16 v[30:31], v11 offset:4608
ds_read_b128 v[52:55], v13 offset:3072
s_waitcnt lgkmcnt(10)
v_mfma_f32_32x32x16_bf16 v[60:75], v[36:39], v[56:59], v[60:75]
ds_read_b64_tr_b16 v[32:33], v11 offset:6144
ds_read_b64_tr_b16 v[34:35], v11 offset:6656
s_barrier
v_add_u32 v10, 106496, v9
v_add_u32 v12, 98304, v3
ds_read_b128 v[56:59], v12 offset:0
s_waitcnt lgkmcnt(10)
v_mfma_f32_32x32x16_bf16 v[60:75], v[20:23], v[40:43], v[60:75]
ds_read_b64_tr_b16 v[36:37], v10 offset:0
ds_read_b64_tr_b16 v[38:39], v10 offset:512
ds_read_b128 v[40:43], v12 offset:1024
s_waitcnt lgkmcnt(10)
v_mfma_f32_32x32x16_bf16 v[60:75], v[24:27], v[44:47], v[60:75]
ds_read_b64_tr_b16 v[20:21], v10 offset:2048
ds_read_b64_tr_b16 v[22:23], v10 offset:2560
ds_read_b128 v[44:47], v12 offset:2048
s_waitcnt lgkmcnt(10)
v_mfma_f32_32x32x16_bf16 v[60:75], v[28:31], v[48:51], v[60:75]
ds_read_b64_tr_b16 v[24:25], v10 offset:4096
ds_read_b64_tr_b16 v[26:27], v10 offset:4608
ds_read_b128 v[48:51], v12 offset:3072
s_waitcnt lgkmcnt(10)
v_mfma_f32_32x32x16_bf16 v[60:75], v[32:35], v[52:55], v[60:75]
ds_read_b64_tr_b16 v[28:29], v10 offset:6144
ds_read_b64_tr_b16 v[30:31], v10 offset:6656
s_barrier
v_add_u32 v11, 122880, v9
v_add_u32 v13, 114688, v3
ds_read_b128 v[52:55], v13 offset:0
s_waitcnt lgkmcnt(10)
v_mfma_f32_32x32x16_bf16 v[60:75], v[36:39], v[56:59], v[60:75]
ds_read_b64_tr_b16 v[32:33], v11 offset:0
ds_read_b64_tr_b16 v[34:35], v11 offset:512
ds_read_b128 v[56:59], v13 offset:1024
s_waitcnt lgkmcnt(10)
v_mfma_f32_32x32x16_bf16 v[60:75], v[20:23], v[40:43], v[60:75]
ds_read_b64_tr_b16 v[36:37], v11 offset:2048
ds_read_b64_tr_b16 v[38:39], v11 offset:2560
ds_read_b128 v[40:43], v13 offset:2048
s_waitcnt lgkmcnt(10)
v_mfma_f32_32x32x16_bf16 v[60:75], v[24:27], v[44:47], v[60:75]
ds_read_b64_tr_b16 v[20:21], v11 offset:4096
ds_read_b64_tr_b16 v[22:23], v11 offset:4608
ds_read_b128 v[44:47], v13 offset:3072
s_waitcnt lgkmcnt(10)
v_mfma_f32_32x32x16_bf16 v[60:75], v[28:31], v[48:51], v[60:75]
ds_read_b64_tr_b16 v[24:25], v11 offset:6144
ds_read_b64_tr_b16 v[26:27], v11 offset:6656
s_barrier
v_add_u32 v10, 139264, v9
v_add_u32 v12, 131072, v3
ds_read_b128 v[48:51], v12 offset:0
s_waitcnt lgkmcnt(10)
v_mfma_f32_32x32x16_bf16 v[60:75], v[32:35], v[52:55], v[60:75]
ds_read_b64_tr_b16 v[28:29], v10 offset:0
ds_read_b64_tr_b16 v[30:31], v10 offset:512
ds_read_b128 v[52:55], v12 offset:1024
s_waitcnt lgkmcnt(10)
v_mfma_f32_32x32x16_bf16 v[60:75], v[36:39], v[56:59], v[60:75]
ds_read_b64_tr_b16 v[32:33], v10 offset:2048
ds_read_b64_tr_b16 v[34:35], v10 offset:2560
ds_read_b128 v[56:59], v12 offset:2048
s_waitcnt lgkmcnt(10)
v_mfma_f32_32x32x16_bf16 v[60:75], v[20:23], v[40:43], v[60:75]
ds_read_b64_tr_b16 v[36:37], v10 offset:4096
ds_read_b64_tr_b16 v[38:39], v10 offset:4608
ds_read_b128 v[40:43], v12 offset:3072
s_waitcnt lgkmcnt(10)
v_mfma_f32_32x32x16_bf16 v[60:75], v[24:27], v[44:47], v[60:75]
ds_read_b64_tr_b16 v[20:21], v10 offset:6144
ds_read_b64_tr_b16 v[22:23], v10 offset:6656
s_barrier
v_add_u32 v11, 8192, v9
v_add_u32 v13, 0, v3
ds_read_b128 v[44:47], v13 offset:0
s_waitcnt lgkmcnt(10)
v_mfma_f32_32x32x16_bf16 v[60:75], v[28:31], v[48:51], v[60:75]
ds_read_b64_tr_b16 v[24:25], v11 offset:0
ds_read_b64_tr_b16 v[26:27], v11 offset:512
ds_read_b128 v[48:51], v13 offset:1024
s_waitcnt lgkmcnt(10)
v_mfma_f32_32x32x16_bf16 v[60:75], v[32:35], v[52:55], v[60:75]
ds_read_b64_tr_b16 v[28:29], v11 offset:2048
ds_read_b64_tr_b16 v[30:31], v11 offset:2560
ds_read_b128 v[52:55], v13 offset:2048
s_waitcnt lgkmcnt(10)
v_mfma_f32_32x32x16_bf16 v[60:75], v[36:39], v[56:59], v[60:75]
ds_read_b64_tr_b16 v[32:33], v11 offset:4096
ds_read_b64_tr_b16 v[34:35], v11 offset:4608
ds_read_b128 v[56:59], v13 offset:3072
s_waitcnt lgkmcnt(10)
v_mfma_f32_32x32x16_bf16 v[60:75], v[20:23], v[40:43], v[60:75]
ds_read_b64_tr_b16 v[36:37], v11 offset:6144
ds_read_b64_tr_b16 v[38:39], v11 offset:6656
s_barrier
v_add_u32 v10, 24576, v9
v_add_u32 v12, 16384, v3
ds_read_b128 v[40:43], v12 offset:0
s_waitcnt lgkmcnt(10)
v_mfma_f32_32x32x16_bf16 v[60:75], v[24:27], v[44:47], v[60:75]
ds_read_b64_tr_b16 v[20:21], v10 offset:0
ds_read_b64_tr_b16 v[22:23], v10 offset:512
ds_read_b128 v[44:47], v12 offset:1024
s_waitcnt lgkmcnt(10)
v_mfma_f32_32x32x16_bf16 v[60:75], v[28:31], v[48:51], v[60:75]
ds_read_b64_tr_b16 v[24:25], v10 offset:2048
ds_read_b64_tr_b16 v[26:27], v10 offset:2560
ds_read_b128 v[48:51], v12 offset:2048
s_waitcnt lgkmcnt(10)
v_mfma_f32_32x32x16_bf16 v[60:75], v[32:35], v[52:55], v[60:75]
ds_read_b64_tr_b16 v[28:29], v10 offset:4096
ds_read_b64_tr_b16 v[30:31], v10 offset:4608
ds_read_b128 v[52:55], v12 offset:3072
s_waitcnt lgkmcnt(10)
v_mfma_f32_32x32x16_bf16 v[60:75], v[36:39], v[56:59], v[60:75]
ds_read_b64_tr_b16 v[32:33], v10 offset:6144
ds_read_b64_tr_b16 v[34:35], v10 offset:6656
s_barrier
v_add_u32 v11, 40960, v9
v_add_u32 v13, 32768, v3
ds_read_b128 v[56:59], v13 offset:0
s_waitcnt lgkmcnt(10)
v_mfma_f32_32x32x16_bf16 v[60:75], v[20:23], v[40:43], v[60:75]
ds_read_b64_tr_b16 v[36:37], v11 offset:0
ds_read_b64_tr_b16 v[38:39], v11 offset:512
ds_read_b128 v[40:43], v13 offset:1024
s_waitcnt lgkmcnt(10)
v_mfma_f32_32x32x16_bf16 v[60:75], v[24:27], v[44:47], v[60:75]
ds_read_b64_tr_b16 v[20:21], v11 offset:2048
ds_read_b64_tr_b16 v[22:23], v11 offset:2560
ds_read_b128 v[44:47], v13 offset:2048
s_waitcnt lgkmcnt(10)
v_mfma_f32_32x32x16_bf16 v[60:75], v[28:31], v[48:51], v[60:75]
ds_read_b64_tr_b16 v[24:25], v11 offset:4096
ds_read_b64_tr_b16 v[26:27], v11 offset:4608
ds_read_b128 v[48:51], v13 offset:3072
s_waitcnt lgkmcnt(10)
v_mfma_f32_32x32x16_bf16 v[60:75], v[32:35], v[52:55], v[60:75]
ds_read_b64_tr_b16 v[28:29], v11 offset:6144
ds_read_b64_tr_b16 v[30:31], v11 offset:6656
s_barrier
v_add_u32 v10, 57344, v9
v_add_u32 v12, 49152, v3
ds_read_b128 v[52:55], v12 offset:0
s_waitcnt lgkmcnt(10)
v_mfma_f32_32x32x16_bf16 v[60:75], v[36:39], v[56:59], v[60:75]
ds_read_b64_tr_b16 v[32:33], v10 offset:0
ds_read_b64_tr_b16 v[34:35], v10 offset:512
ds_read_b128 v[56:59], v12 offset:1024
s_waitcnt lgkmcnt(10)
v_mfma_f32_32x32x16_bf16 v[60:75], v[20:23], v[40:43], v[60:75]
ds_read_b64_tr_b16 v[36:37], v10 offset:2048
ds_read_b64_tr_b16 v[38:39], v10 offset:2560
ds_read_b128 v[40:43], v12 offset:2048
s_waitcnt lgkmcnt(10)
v_mfma_f32_32x32x16_bf16 v[60:75], v[24:27], v[44:47], v[60:75]
ds_read_b64_tr_b16 v[20:21], v10 offset:4096
ds_read_b64_tr_b16 v[22:23], v10 offset:4608
ds_read_b128 v[44:47], v12 offset:3072
s_waitcnt lgkmcnt(10)
v_mfma_f32_32x32x16_bf16 v[60:75], v[28:31], v[48:51], v[60:75]
ds_read_b64_tr_b16 v[24:25], v10 offset:6144
ds_read_b64_tr_b16 v[26:27], v10 offset:6656
s_barrier
v_add_u32 v11, 73728, v9
v_add_u32 v13, 65536, v3
ds_read_b128 v[48:51], v13 offset:0
s_waitcnt lgkmcnt(10)
v_mfma_f32_32x32x16_bf16 v[60:75], v[32:35], v[52:55], v[60:75]
ds_read_b64_tr_b16 v[28:29], v11 offset:0
ds_read_b64_tr_b16 v[30:31], v11 offset:512
ds_read_b128 v[52:55], v13 offset:1024
s_waitcnt lgkmcnt(10)
v_mfma_f32_32x32x16_bf16 v[60:75], v[36:39], v[56:59], v[60:75]
ds_read_b64_tr_b16 v[32:33], v11 offset:2048
ds_read_b64_tr_b16 v[34:35], v11 offset:2560
ds_read_b128 v[56:59], v13 offset:2048
s_waitcnt lgkmcnt(10)
v_mfma_f32_32x32x16_bf16 v[60:75], v[20:23], v[40:43], v[60:75]
ds_read_b64_tr_b16 v[36:37], v11 offset:4096
ds_read_b64_tr_b16 v[38:39], v11 offset:4608
ds_read_b128 v[40:43], v13 offset:3072
s_waitcnt lgkmcnt(10)
v_mfma_f32_32x32x16_bf16 v[60:75], v[24:27], v[44:47], v[60:75]
ds_read_b64_tr_b16 v[20:21], v11 offset:6144
ds_read_b64_tr_b16 v[22:23], v11 offset:6656
s_barrier
v_add_u32 v10, 90112, v9
v_add_u32 v12, 81920, v3
ds_read_b128 v[44:47], v12 offset:0
s_waitcnt lgkmcnt(10)
v_mfma_f32_32x32x16_bf16 v[60:75], v[28:31], v[48:51], v[60:75]
ds_read_b64_tr_b16 v[24:25], v10 offset:0
ds_read_b64_tr_b16 v[26:27], v10 offset:512
ds_read_b128 v[48:51], v12 offset:1024
s_waitcnt lgkmcnt(10)
v_mfma_f32_32x32x16_bf16 v[60:75], v[32:35], v[52:55], v[60:75]
ds_read_b64_tr_b16 v[28:29], v10 offset:2048
ds_read_b64_tr_b16 v[30:31], v10 offset:2560
ds_read_b128 v[52:55], v12 offset:2048
s_waitcnt lgkmcnt(10)
v_mfma_f32_32x32x16_bf16 v[60:75], v[36:39], v[56:59], v[60:75]
ds_read_b64_tr_b16 v[32:33], v10 offset:4096
ds_read_b64_tr_b16 v[34:35], v10 offset:4608
ds_read_b128 v[56:59], v12 offset:3072
s_waitcnt lgkmcnt(10)
v_mfma_f32_32x32x16_bf16 v[60:75], v[20:23], v[40:43], v[60:75]
ds_read_b64_tr_b16 v[36:37], v10 offset:6144
ds_read_b64_tr_b16 v[38:39], v10 offset:6656
s_barrier
v_add_u32 v11, 106496, v9
v_add_u32 v13, 98304, v3
ds_read_b128 v[40:43], v13 offset:0
s_waitcnt lgkmcnt(10)
v_mfma_f32_32x32x16_bf16 v[60:75], v[24:27], v[44:47], v[60:75]
ds_read_b64_tr_b16 v[20:21], v11 offset:0
ds_read_b64_tr_b16 v[22:23], v11 offset:512
ds_read_b128 v[44:47], v13 offset:1024
s_waitcnt lgkmcnt(10)
v_mfma_f32_32x32x16_bf16 v[60:75], v[28:31], v[48:51], v[60:75]
ds_read_b64_tr_b16 v[24:25], v11 offset:2048
ds_read_b64_tr_b16 v[26:27], v11 offset:2560
ds_read_b128 v[48:51], v13 offset:2048
s_waitcnt lgkmcnt(10)
v_mfma_f32_32x32x16_bf16 v[60:75], v[32:35], v[52:55], v[60:75]
ds_read_b64_tr_b16 v[28:29], v11 offset:4096
ds_read_b64_tr_b16 v[30:31], v11 offset:4608
ds_read_b128 v[52:55], v13 offset:3072
s_waitcnt lgkmcnt(10)
v_mfma_f32_32x32x16_bf16 v[60:75], v[36:39], v[56:59], v[60:75]
ds_read_b64_tr_b16 v[32:33], v11 offset:6144
ds_read_b64_tr_b16 v[34:35], v11 offset:6656
s_barrier
v_add_u32 v10, 122880, v9
v_add_u32 v12, 114688, v3
ds_read_b128 v[56:59], v12 offset:0
s_waitcnt lgkmcnt(10)
v_mfma_f32_32x32x16_bf16 v[60:75], v[20:23], v[40:43], v[60:75]
ds_read_b64_tr_b16 v[36:37], v10 offset:0
ds_read_b64_tr_b16 v[38:39], v10 offset:512
ds_read_b128 v[40:43], v12 offset:1024
s_waitcnt lgkmcnt(10)
v_mfma_f32_32x32x16_bf16 v[60:75], v[24:27], v[44:47], v[60:75]
ds_read_b64_tr_b16 v[20:21], v10 offset:2048
ds_read_b64_tr_b16 v[22:23], v10 offset:2560
ds_read_b128 v[44:47], v12 offset:2048
s_waitcnt lgkmcnt(10)
v_mfma_f32_32x32x16_bf16 v[60:75], v[28:31], v[48:51], v[60:75]
ds_read_b64_tr_b16 v[24:25], v10 offset:4096
ds_read_b64_tr_b16 v[26:27], v10 offset:4608
ds_read_b128 v[48:51], v12 offset:3072
s_waitcnt lgkmcnt(10)
v_mfma_f32_32x32x16_bf16 v[60:75], v[32:35], v[52:55], v[60:75]
ds_read_b64_tr_b16 v[28:29], v10 offset:6144
ds_read_b64_tr_b16 v[30:31], v10 offset:6656
s_barrier
v_add_u32 v11, 139264, v9
v_add_u32 v13, 131072, v3
ds_read_b128 v[52:55], v13 offset:0
s_waitcnt lgkmcnt(10)
v_mfma_f32_32x32x16_bf16 v[60:75], v[36:39], v[56:59], v[60:75]
ds_read_b64_tr_b16 v[32:33], v11 offset:0
ds_read_b64_tr_b16 v[34:35], v11 offset:512
ds_read_b128 v[56:59], v13 offset:1024
s_waitcnt lgkmcnt(10)
v_mfma_f32_32x32x16_bf16 v[60:75], v[20:23], v[40:43], v[60:75]
ds_read_b64_tr_b16 v[36:37], v11 offset:2048
ds_read_b64_tr_b16 v[38:39], v11 offset:2560
ds_read_b128 v[40:43], v13 offset:2048
s_waitcnt lgkmcnt(10)
v_mfma_f32_32x32x16_bf16 v[60:75], v[24:27], v[44:47], v[60:75]
ds_read_b64_tr_b16 v[20:21], v11 offset:4096
ds_read_b64_tr_b16 v[22:23], v11 offset:4608
ds_read_b128 v[44:47], v13 offset:3072
s_waitcnt lgkmcnt(10)
v_mfma_f32_32x32x16_bf16 v[60:75], v[28:31], v[48:51], v[60:75]
ds_read_b64_tr_b16 v[24:25], v11 offset:6144
ds_read_b64_tr_b16 v[26:27], v11 offset:6656
s_barrier
v_add_u32 v10, 8192, v9
v_add_u32 v12, 0, v3
ds_read_b128 v[48:51], v12 offset:0
s_waitcnt lgkmcnt(10)
v_mfma_f32_32x32x16_bf16 v[60:75], v[32:35], v[52:55], v[60:75]
ds_read_b64_tr_b16 v[28:29], v10 offset:0
ds_read_b64_tr_b16 v[30:31], v10 offset:512
ds_read_b128 v[52:55], v12 offset:1024
s_waitcnt lgkmcnt(10)
v_mfma_f32_32x32x16_bf16 v[60:75], v[36:39], v[56:59], v[60:75]
ds_read_b64_tr_b16 v[32:33], v10 offset:2048
ds_read_b64_tr_b16 v[34:35], v10 offset:2560
ds_read_b128 v[56:59], v12 offset:2048
s_waitcnt lgkmcnt(10)
v_mfma_f32_32x32x16_bf16 v[60:75], v[20:23], v[40:43], v[60:75]
ds_read_b64_tr_b16 v[36:37], v10 offset:4096
ds_read_b64_tr_b16 v[38:39], v10 offset:4608
ds_read_b128 v[40:43], v12 offset:3072
s_waitcnt lgkmcnt(10)
v_mfma_f32_32x32x16_bf16 v[60:75], v[24:27], v[44:47], v[60:75]
ds_read_b64_tr_b16 v[20:21], v10 offset:6144
ds_read_b64_tr_b16 v[22:23], v10 offset:6656
s_barrier
v_add_u32 v11, 24576, v9
v_add_u32 v13, 16384, v3
ds_read_b128 v[44:47], v13 offset:0
s_waitcnt lgkmcnt(10)
v_mfma_f32_32x32x16_bf16 v[60:75], v[28:31], v[48:51], v[60:75]
ds_read_b64_tr_b16 v[24:25], v11 offset:0
ds_read_b64_tr_b16 v[26:27], v11 offset:512
ds_read_b128 v[48:51], v13 offset:1024
s_waitcnt lgkmcnt(10)
v_mfma_f32_32x32x16_bf16 v[60:75], v[32:35], v[52:55], v[60:75]
ds_read_b64_tr_b16 v[28:29], v11 offset:2048
ds_read_b64_tr_b16 v[30:31], v11 offset:2560
ds_read_b128 v[52:55], v13 offset:2048
s_waitcnt lgkmcnt(10)
v_mfma_f32_32x32x16_bf16 v[60:75], v[36:39], v[56:59], v[60:75]
ds_read_b64_tr_b16 v[32:33], v11 offset:4096
ds_read_b64_tr_b16 v[34:35], v11 offset:4608
ds_read_b128 v[56:59], v13 offset:3072
s_waitcnt lgkmcnt(10)
v_mfma_f32_32x32x16_bf16 v[60:75], v[20:23], v[40:43], v[60:75]
ds_read_b64_tr_b16 v[36:37], v11 offset:6144
ds_read_b64_tr_b16 v[38:39], v11 offset:6656
s_barrier
v_add_u32 v10, 40960, v9
v_add_u32 v12, 32768, v3
ds_read_b128 v[40:43], v12 offset:0
s_waitcnt lgkmcnt(10)
v_mfma_f32_32x32x16_bf16 v[60:75], v[24:27], v[44:47], v[60:75]
ds_read_b64_tr_b16 v[20:21], v10 offset:0
ds_read_b64_tr_b16 v[22:23], v10 offset:512
ds_read_b128 v[44:47], v12 offset:1024
s_waitcnt lgkmcnt(10)
v_mfma_f32_32x32x16_bf16 v[60:75], v[28:31], v[48:51], v[60:75]
ds_read_b64_tr_b16 v[24:25], v10 offset:2048
ds_read_b64_tr_b16 v[26:27], v10 offset:2560
ds_read_b128 v[48:51], v12 offset:2048
s_waitcnt lgkmcnt(10)
v_mfma_f32_32x32x16_bf16 v[60:75], v[32:35], v[52:55], v[60:75]
ds_read_b64_tr_b16 v[28:29], v10 offset:4096
ds_read_b64_tr_b16 v[30:31], v10 offset:4608
ds_read_b128 v[52:55], v12 offset:3072
s_waitcnt lgkmcnt(10)
v_mfma_f32_32x32x16_bf16 v[60:75], v[36:39], v[56:59], v[60:75]
ds_read_b64_tr_b16 v[32:33], v10 offset:6144
ds_read_b64_tr_b16 v[34:35], v10 offset:6656
s_barrier
v_add_u32 v11, 57344, v9
v_add_u32 v13, 49152, v3
ds_read_b128 v[56:59], v13 offset:0
s_waitcnt lgkmcnt(10)
v_mfma_f32_32x32x16_bf16 v[60:75], v[20:23], v[40:43], v[60:75]
ds_read_b64_tr_b16 v[36:37], v11 offset:0
ds_read_b64_tr_b16 v[38:39], v11 offset:512
ds_read_b128 v[40:43], v13 offset:1024
s_waitcnt lgkmcnt(10)
v_mfma_f32_32x32x16_bf16 v[60:75], v[24:27], v[44:47], v[60:75]
ds_read_b64_tr_b16 v[20:21], v11 offset:2048
ds_read_b64_tr_b16 v[22:23], v11 offset:2560
ds_read_b128 v[44:47], v13 offset:2048
s_waitcnt lgkmcnt(10)
v_mfma_f32_32x32x16_bf16 v[60:75], v[28:31], v[48:51], v[60:75]
ds_read_b64_tr_b16 v[24:25], v11 offset:4096
ds_read_b64_tr_b16 v[26:27], v11 offset:4608
ds_read_b128 v[48:51], v13 offset:3072
s_waitcnt lgkmcnt(10)
v_mfma_f32_32x32x16_bf16 v[60:75], v[32:35], v[52:55], v[60:75]
ds_read_b64_tr_b16 v[28:29], v11 offset:6144
ds_read_b64_tr_b16 v[30:31], v11 offset:6656
s_barrier
v_add_u32 v10, 73728, v9
v_add_u32 v12, 65536, v3
ds_read_b128 v[52:55], v12 offset:0
s_waitcnt lgkmcnt(10)
v_mfma_f32_32x32x16_bf16 v[60:75], v[36:39], v[56:59], v[60:75]
ds_read_b64_tr_b16 v[32:33], v10 offset:0
ds_read_b64_tr_b16 v[34:35], v10 offset:512
ds_read_b128 v[56:59], v12 offset:1024
s_waitcnt lgkmcnt(10)
v_mfma_f32_32x32x16_bf16 v[60:75], v[20:23], v[40:43], v[60:75]
ds_read_b64_tr_b16 v[36:37], v10 offset:2048
ds_read_b64_tr_b16 v[38:39], v10 offset:2560
ds_read_b128 v[40:43], v12 offset:2048
s_waitcnt lgkmcnt(10)
v_mfma_f32_32x32x16_bf16 v[60:75], v[24:27], v[44:47], v[60:75]
ds_read_b64_tr_b16 v[20:21], v10 offset:4096
ds_read_b64_tr_b16 v[22:23], v10 offset:4608
ds_read_b128 v[44:47], v12 offset:3072
s_waitcnt lgkmcnt(10)
v_mfma_f32_32x32x16_bf16 v[60:75], v[28:31], v[48:51], v[60:75]
ds_read_b64_tr_b16 v[24:25], v10 offset:6144
ds_read_b64_tr_b16 v[26:27], v10 offset:6656
s_barrier
v_add_u32 v11, 90112, v9
v_add_u32 v13, 81920, v3
ds_read_b128 v[48:51], v13 offset:0
s_waitcnt lgkmcnt(10)
v_mfma_f32_32x32x16_bf16 v[60:75], v[32:35], v[52:55], v[60:75]
ds_read_b64_tr_b16 v[28:29], v11 offset:0
ds_read_b64_tr_b16 v[30:31], v11 offset:512
ds_read_b128 v[52:55], v13 offset:1024
s_waitcnt lgkmcnt(10)
v_mfma_f32_32x32x16_bf16 v[60:75], v[36:39], v[56:59], v[60:75]
ds_read_b64_tr_b16 v[32:33], v11 offset:2048
ds_read_b64_tr_b16 v[34:35], v11 offset:2560
ds_read_b128 v[56:59], v13 offset:2048
s_waitcnt lgkmcnt(10)
v_mfma_f32_32x32x16_bf16 v[60:75], v[20:23], v[40:43], v[60:75]
ds_read_b64_tr_b16 v[36:37], v11 offset:4096
ds_read_b64_tr_b16 v[38:39], v11 offset:4608
ds_read_b128 v[40:43], v13 offset:3072
s_waitcnt lgkmcnt(10)
v_mfma_f32_32x32x16_bf16 v[60:75], v[24:27], v[44:47], v[60:75]
ds_read_b64_tr_b16 v[20:21], v11 offset:6144
ds_read_b64_tr_b16 v[22:23], v11 offset:6656
s_barrier
v_add_u32 v10, 106496, v9
v_add_u32 v12, 98304, v3
ds_read_b128 v[44:47], v12 offset:0
s_waitcnt lgkmcnt(10)
v_mfma_f32_32x32x16_bf16 v[60:75], v[28:31], v[48:51], v[60:75]
ds_read_b64_tr_b16 v[24:25], v10 offset:0
ds_read_b64_tr_b16 v[26:27], v10 offset:512
ds_read_b128 v[48:51], v12 offset:1024
s_waitcnt lgkmcnt(10)
v_mfma_f32_32x32x16_bf16 v[60:75], v[32:35], v[52:55], v[60:75]
ds_read_b64_tr_b16 v[28:29], v10 offset:2048
ds_read_b64_tr_b16 v[30:31], v10 offset:2560
ds_read_b128 v[52:55], v12 offset:2048
s_waitcnt lgkmcnt(10)
v_mfma_f32_32x32x16_bf16 v[60:75], v[36:39], v[56:59], v[60:75]
ds_read_b64_tr_b16 v[32:33], v10 offset:4096
ds_read_b64_tr_b16 v[34:35], v10 offset:4608
ds_read_b128 v[56:59], v12 offset:3072
s_waitcnt lgkmcnt(10)
v_mfma_f32_32x32x16_bf16 v[60:75], v[20:23], v[40:43], v[60:75]
ds_read_b64_tr_b16 v[36:37], v10 offset:6144
ds_read_b64_tr_b16 v[38:39], v10 offset:6656
s_barrier
v_add_u32 v11, 122880, v9
v_add_u32 v13, 114688, v3
ds_read_b128 v[40:43], v13 offset:0
s_waitcnt lgkmcnt(10)
v_mfma_f32_32x32x16_bf16 v[60:75], v[24:27], v[44:47], v[60:75]
ds_read_b64_tr_b16 v[20:21], v11 offset:0
ds_read_b64_tr_b16 v[22:23], v11 offset:512
ds_read_b128 v[44:47], v13 offset:1024
s_waitcnt lgkmcnt(10)
v_mfma_f32_32x32x16_bf16 v[60:75], v[28:31], v[48:51], v[60:75]
ds_read_b64_tr_b16 v[24:25], v11 offset:2048
ds_read_b64_tr_b16 v[26:27], v11 offset:2560
ds_read_b128 v[48:51], v13 offset:2048
s_waitcnt lgkmcnt(10)
v_mfma_f32_32x32x16_bf16 v[60:75], v[32:35], v[52:55], v[60:75]
ds_read_b64_tr_b16 v[28:29], v11 offset:4096
ds_read_b64_tr_b16 v[30:31], v11 offset:4608
ds_read_b128 v[52:55], v13 offset:3072
s_waitcnt lgkmcnt(10)
v_mfma_f32_32x32x16_bf16 v[60:75], v[36:39], v[56:59], v[60:75]
ds_read_b64_tr_b16 v[32:33], v11 offset:6144
ds_read_b64_tr_b16 v[34:35], v11 offset:6656
s_barrier
v_add_u32 v10, 139264, v9
v_add_u32 v12, 131072, v3
ds_read_b128 v[56:59], v12 offset:0
s_waitcnt lgkmcnt(10)
v_mfma_f32_32x32x16_bf16 v[60:75], v[20:23], v[40:43], v[60:75]
ds_read_b64_tr_b16 v[36:37], v10 offset:0
ds_read_b64_tr_b16 v[38:39], v10 offset:512
ds_read_b128 v[40:43], v12 offset:1024
s_waitcnt lgkmcnt(10)
v_mfma_f32_32x32x16_bf16 v[60:75], v[24:27], v[44:47], v[60:75]
ds_read_b64_tr_b16 v[20:21], v10 offset:2048
ds_read_b64_tr_b16 v[22:23], v10 offset:2560
ds_read_b128 v[44:47], v12 offset:2048
s_waitcnt lgkmcnt(10)
v_mfma_f32_32x32x16_bf16 v[60:75], v[28:31], v[48:51], v[60:75]
ds_read_b64_tr_b16 v[24:25], v10 offset:4096
ds_read_b64_tr_b16 v[26:27], v10 offset:4608
ds_read_b128 v[48:51], v12 offset:3072
s_waitcnt lgkmcnt(10)
v_mfma_f32_32x32x16_bf16 v[60:75], v[32:35], v[52:55], v[60:75]
ds_read_b64_tr_b16 v[28:29], v10 offset:6144
ds_read_b64_tr_b16 v[30:31], v10 offset:6656
s_barrier
v_add_u32 v11, 8192, v9
v_add_u32 v13, 0, v3
ds_read_b128 v[52:55], v13 offset:0
s_waitcnt lgkmcnt(10)
v_mfma_f32_32x32x16_bf16 v[60:75], v[36:39], v[56:59], v[60:75]
ds_read_b64_tr_b16 v[32:33], v11 offset:0
ds_read_b64_tr_b16 v[34:35], v11 offset:512
ds_read_b128 v[56:59], v13 offset:1024
s_waitcnt lgkmcnt(10)
v_mfma_f32_32x32x16_bf16 v[60:75], v[20:23], v[40:43], v[60:75]
ds_read_b64_tr_b16 v[36:37], v11 offset:2048
ds_read_b64_tr_b16 v[38:39], v11 offset:2560
ds_read_b128 v[40:43], v13 offset:2048
s_waitcnt lgkmcnt(10)
v_mfma_f32_32x32x16_bf16 v[60:75], v[24:27], v[44:47], v[60:75]
ds_read_b64_tr_b16 v[20:21], v11 offset:4096
ds_read_b64_tr_b16 v[22:23], v11 offset:4608
ds_read_b128 v[44:47], v13 offset:3072
s_waitcnt lgkmcnt(10)
v_mfma_f32_32x32x16_bf16 v[60:75], v[28:31], v[48:51], v[60:75]
ds_read_b64_tr_b16 v[24:25], v11 offset:6144
ds_read_b64_tr_b16 v[26:27], v11 offset:6656
s_waitcnt lgkmcnt(9)
v_mfma_f32_32x32x16_bf16 v[60:75], v[32:35], v[52:55], v[60:75]
s_waitcnt lgkmcnt(6)
v_mfma_f32_32x32x16_bf16 v[60:75], v[36:39], v[56:59], v[60:75]
s_waitcnt lgkmcnt(3)
v_mfma_f32_32x32x16_bf16 v[60:75], v[20:23], v[40:43], v[60:75]
s_waitcnt lgkmcnt(0)
v_mfma_f32_32x32x16_bf16 v[60:75], v[24:27], v[44:47], v[60:75]
s_nop 11
v_cvt_pk_bf16_f32 v76, v60, v61
v_cvt_pk_bf16_f32 v77, v62, v63
v_cvt_pk_bf16_f32 v78, v64, v65
v_cvt_pk_bf16_f32 v79, v66, v67
v_cvt_pk_bf16_f32 v80, v68, v69
v_cvt_pk_bf16_f32 v81, v70, v71
v_cvt_pk_bf16_f32 v82, v72, v73
v_cvt_pk_bf16_f32 v83, v74, v75
v_lshlrev_b32 v60, 16, v76
v_and_b32 v61, 0xffff0000, v76
v_lshlrev_b32 v62, 16, v77
v_and_b32 v63, 0xffff0000, v77
v_lshlrev_b32 v64, 16, v78
v_and_b32 v65, 0xffff0000, v78
v_lshlrev_b32 v66, 16, v79
v_and_b32 v67, 0xffff0000, v79
v_lshlrev_b32 v68, 16, v80
v_and_b32 v69, 0xffff0000, v80
v_lshlrev_b32 v70, 16, v81
v_and_b32 v71, 0xffff0000, v81
v_lshlrev_b32 v72, 16, v82
v_and_b32 v73, 0xffff0000, v82
v_lshlrev_b32 v74, 16, v83
v_and_b32 v75, 0xffff0000, v83
s_waitcnt vmcnt(3)
v_lshlrev_b32 v84, 16, v88
v_and_b32 v85, 0xffff0000, v88
v_add_f32 v60, v60, v84
v_add_f32 v61, v61, v85
v_lshlrev_b32 v84, 16, v89
v_and_b32 v85, 0xffff0000, v89
v_add_f32 v62, v62, v84
v_add_f32 v63, v63, v85
s_waitcnt vmcnt(2)
v_lshlrev_b32 v84, 16, v90
v_and_b32 v85, 0xffff0000, v90
v_add_f32 v64, v64, v84
v_add_f32 v65, v65, v85
v_lshlrev_b32 v84, 16, v91
v_and_b32 v85, 0xffff0000, v91
v_add_f32 v66, v66, v84
v_add_f32 v67, v67, v85
s_waitcnt vmcnt(1)
v_lshlrev_b32 v84, 16, v92
v_and_b32 v85, 0xffff0000, v92
v_add_f32 v68, v68, v84
v_add_f32 v69, v69, v85
v_lshlrev_b32 v84, 16, v93
v_and_b32 v85, 0xffff0000, v93
v_add_f32 v70, v70, v84
v_add_f32 v71, v71, v85
s_waitcnt vmcnt(0)
v_lshlrev_b32 v84, 16, v94
v_and_b32 v85, 0xffff0000, v94
v_add_f32 v72, v72, v84
v_add_f32 v73, v73, v85
v_lshlrev_b32 v84, 16, v95
v_and_b32 v85, 0xffff0000, v95
v_add_f32 v74, v74, v84
v_add_f32 v75, v75, v85
v_cvt_pk_bf16_f32 v76, v60, v61
v_cvt_pk_bf16_f32 v77, v62, v63
v_cvt_pk_bf16_f32 v78, v64, v65
v_cvt_pk_bf16_f32 v79, v66, v67
v_cvt_pk_bf16_f32 v80, v68, v69
v_cvt_pk_bf16_f32 v81, v70, v71
v_cvt_pk_bf16_f32 v82, v72, v73
v_cvt_pk_bf16_f32 v83, v74, v75
v_permlane32_swap_b32 v76, v78
v_permlane32_swap_b32 v77, v79
v_permlane32_swap_b32 v80, v82
v_permlane32_swap_b32 v81, v83
buffer_store_dwordx4 v[76:79], v86, s[52:55], s9 offen
buffer_store_dwordx4 v[80:83], v86, s[52:55], s9 offen offset:32
s_waitcnt vmcnt(0)
s_branch k5_kernel_end
k5_kernel_w2:
s_lshl_b32 s7, s4, 1
s_add_u32 s7, s7, 1
s_lshl_b32 s8, s5, 7
s_add_u32 s8, s8, 0
s_lshl_b32 s10, s7, 5
s_lshr_b32 s11, s8, 5
s_add_u32 s10, s10, s11
s_lshl_b32 s10, s10, 10
v_and_b32 v86, 31, v1
v_lshlrev_b32 v87, 4, v86
v_lshl_add_u32 v87, v5, 3, v87
buffer_load_dwordx2 v[88:89], v87, s[56:59], s10 offen offset:0
buffer_load_dwordx2 v[90:91], v87, s[56:59], s10 offen offset:512
buffer_load_dwordx2 v[92:93], v87, s[56:59], s10 offen offset:1024
buffer_load_dwordx2 v[94:95], v87, s[56:59], s10 offen offset:1536
s_lshl_b32 s9, s7, 15
s_add_u32 s9, s9, s8
v_lshlrev_b32 v86, 10, v86
v_lshl_add_u32 v86, v5, 4, v86
v_lshrrev_b32 v14, 1, v8
v_lshl_add_u32 v14, v6, 1, v14
v_add_u32 v14, 0, v14
v_bfe_u32 v15, v4, 3, 1
v_lshlrev_b32 v15, 2, v15
v_xor_b32 v14, v14, v15
v_lshlrev_b32 v14, 4, v14
v_and_b32 v15, 1, v4
v_lshl_add_u32 v14, v15, 3, v14
v_lshl_add_u32 v9, v7, 7, v14
s_barrier
v_add_u32 v10, 8192, v9
v_add_u32 v12, 4096, v3
ds_read_b128 v[40:43], v12 offset:0
ds_read_b64_tr_b16 v[20:21], v10 offset:0
ds_read_b64_tr_b16 v[22:23], v10 offset:512
ds_read_b128 v[44:47], v12 offset:1024
ds_read_b64_tr_b16 v[24:25], v10 offset:2048
ds_read_b64_tr_b16 v[26:27], v10 offset:2560
ds_read_b128 v[48:51], v12 offset:2048
ds_read_b64_tr_b16 v[28:29], v10 offset:4096
ds_read_b64_tr_b16 v[30:31], v10 offset:4608
ds_read_b128 v[52:55], v12 offset:3072
ds_read_b64_tr_b16 v[32:33], v10 offset:6144
ds_read_b64_tr_b16 v[34:35], v10 offset:6656
s_barrier
v_add_u32 v11, 24576, v9
v_add_u32 v13, 20480, v3
ds_read_b128 v[56:59], v13 offset:0
s_waitcnt lgkmcnt(10)
v_mfma_f32_32x32x16_bf16 v[60:75], v[20:23], v[40:43], 0
ds_read_b64_tr_b16 v[36:37], v11 offset:0
ds_read_b64_tr_b16 v[38:39], v11 offset:512
ds_read_b128 v[40:43], v13 offset:1024
s_waitcnt lgkmcnt(10)
v_mfma_f32_32x32x16_bf16 v[60:75], v[24:27], v[44:47], v[60:75]
ds_read_b64_tr_b16 v[20:21], v11 offset:2048
ds_read_b64_tr_b16 v[22:23], v11 offset:2560
ds_read_b128 v[44:47], v13 offset:2048
s_waitcnt lgkmcnt(10)
v_mfma_f32_32x32x16_bf16 v[60:75], v[28:31], v[48:51], v[60:75]
ds_read_b64_tr_b16 v[24:25], v11 offset:4096
ds_read_b64_tr_b16 v[26:27], v11 offset:4608
ds_read_b128 v[48:51], v13 offset:3072
s_waitcnt lgkmcnt(10)
v_mfma_f32_32x32x16_bf16 v[60:75], v[32:35], v[52:55], v[60:75]
ds_read_b64_tr_b16 v[28:29], v11 offset:6144
ds_read_b64_tr_b16 v[30:31], v11 offset:6656
s_barrier
v_add_u32 v10, 40960, v9
v_add_u32 v12, 36864, v3
ds_read_b128 v[52:55], v12 offset:0
s_waitcnt lgkmcnt(10)
v_mfma_f32_32x32x16_bf16 v[60:75], v[36:39], v[56:59], v[60:75]
ds_read_b64_tr_b16 v[32:33], v10 offset:0
ds_read_b64_tr_b16 v[34:35], v10 offset:512
ds_read_b128 v[56:59], v12 offset:1024
s_waitcnt lgkmcnt(10)
v_mfma_f32_32x32x16_bf16 v[60:75], v[20:23], v[40:43], v[60:75]
ds_read_b64_tr_b16 v[36:37], v10 offset:2048
ds_read_b64_tr_b16 v[38:39], v10 offset:2560
ds_read_b128 v[40:43], v12 offset:2048
s_waitcnt lgkmcnt(10)
v_mfma_f32_32x32x16_bf16 v[60:75], v[24:27], v[44:47], v[60:75]
ds_read_b64_tr_b16 v[20:21], v10 offset:4096
ds_read_b64_tr_b16 v[22:23], v10 offset:4608
ds_read_b128 v[44:47], v12 offset:3072
s_waitcnt lgkmcnt(10)
v_mfma_f32_32x32x16_bf16 v[60:75], v[28:31], v[48:51], v[60:75]
ds_read_b64_tr_b16 v[24:25], v10 offset:6144
ds_read_b64_tr_b16 v[26:27], v10 offset:6656
s_barrier
v_add_u32 v11, 57344, v9
v_add_u32 v13, 53248, v3
ds_read_b128 v[48:51], v13 offset:0
s_waitcnt lgkmcnt(10)
v_mfma_f32_32x32x16_bf16 v[60:75], v[32:35], v[52:55], v[60:75]
ds_read_b64_tr_b16 v[28:29], v11 offset:0
ds_read_b64_tr_b16 v[30:31], v11 offset:512
ds_read_b128 v[52:55], v13 offset:1024
s_waitcnt lgkmcnt(10)
v_mfma_f32_32x32x16_bf16 v[60:75], v[36:39], v[56:59], v[60:75]
ds_read_b64_tr_b16 v[32:33], v11 offset:2048
ds_read_b64_tr_b16 v[34:35], v11 offset:2560
ds_read_b128 v[56:59], v13 offset:2048
s_waitcnt lgkmcnt(10)
v_mfma_f32_32x32x16_bf16 v[60:75], v[20:23], v[40:43], v[60:75]
ds_read_b64_tr_b16 v[36:37], v11 offset:4096
ds_read_b64_tr_b16 v[38:39], v11 offset:4608
ds_read_b128 v[40:43], v13 offset:3072
s_waitcnt lgkmcnt(10)
v_mfma_f32_32x32x16_bf16 v[60:75], v[24:27], v[44:47], v[60:75]
ds_read_b64_tr_b16 v[20:21], v11 offset:6144
ds_read_b64_tr_b16 v[22:23], v11 offset:6656
s_barrier
v_add_u32 v10, 73728, v9
v_add_u32 v12, 69632, v3
ds_read_b128 v[44:47], v12 offset:0
s_waitcnt lgkmcnt(10)
v_mfma_f32_32x32x16_bf16 v[60:75], v[28:31], v[48:51], v[60:75]
ds_read_b64_tr_b16 v[24:25], v10 offset:0
ds_read_b64_tr_b16 v[26:27], v10 offset:512
ds_read_b128 v[48:51], v12 offset:1024
s_waitcnt lgkmcnt(10)
v_mfma_f32_32x32x16_bf16 v[60:75], v[32:35], v[52:55], v[60:75]
ds_read_b64_tr_b16 v[28:29], v10 offset:2048
ds_read_b64_tr_b16 v[30:31], v10 offset:2560
ds_read_b128 v[52:55], v12 offset:2048
s_waitcnt lgkmcnt(10)
v_mfma_f32_32x32x16_bf16 v[60:75], v[36:39], v[56:59], v[60:75]
ds_read_b64_tr_b16 v[32:33], v10 offset:4096
ds_read_b64_tr_b16 v[34:35], v10 offset:4608
ds_read_b128 v[56:59], v12 offset:3072
s_waitcnt lgkmcnt(10)
v_mfma_f32_32x32x16_bf16 v[60:75], v[20:23], v[40:43], v[60:75]
ds_read_b64_tr_b16 v[36:37], v10 offset:6144
ds_read_b64_tr_b16 v[38:39], v10 offset:6656
s_barrier
v_add_u32 v11, 90112, v9
v_add_u32 v13, 86016, v3
ds_read_b128 v[40:43], v13 offset:0
s_waitcnt lgkmcnt(10)
v_mfma_f32_32x32x16_bf16 v[60:75], v[24:27], v[44:47], v[60:75]
ds_read_b64_tr_b16 v[20:21], v11 offset:0
ds_read_b64_tr_b16 v[22:23], v11 offset:512
ds_read_b128 v[44:47], v13 offset:1024
s_waitcnt lgkmcnt(10)
v_mfma_f32_32x32x16_bf16 v[60:75], v[28:31], v[48:51], v[60:75]
ds_read_b64_tr_b16 v[24:25], v11 offset:2048
ds_read_b64_tr_b16 v[26:27], v11 offset:2560
ds_read_b128 v[48:51], v13 offset:2048
s_waitcnt lgkmcnt(10)
v_mfma_f32_32x32x16_bf16 v[60:75], v[32:35], v[52:55], v[60:75]
ds_read_b64_tr_b16 v[28:29], v11 offset:4096
ds_read_b64_tr_b16 v[30:31], v11 offset:4608
ds_read_b128 v[52:55], v13 offset:3072
s_waitcnt lgkmcnt(10)
v_mfma_f32_32x32x16_bf16 v[60:75], v[36:39], v[56:59], v[60:75]
ds_read_b64_tr_b16 v[32:33], v11 offset:6144
ds_read_b64_tr_b16 v[34:35], v11 offset:6656
s_barrier
v_add_u32 v10, 106496, v9
v_add_u32 v12, 102400, v3
ds_read_b128 v[56:59], v12 offset:0
s_waitcnt lgkmcnt(10)
v_mfma_f32_32x32x16_bf16 v[60:75], v[20:23], v[40:43], v[60:75]
ds_read_b64_tr_b16 v[36:37], v10 offset:0
ds_read_b64_tr_b16 v[38:39], v10 offset:512
ds_read_b128 v[40:43], v12 offset:1024
s_waitcnt lgkmcnt(10)
v_mfma_f32_32x32x16_bf16 v[60:75], v[24:27], v[44:47], v[60:75]
ds_read_b64_tr_b16 v[20:21], v10 offset:2048
ds_read_b64_tr_b16 v[22:23], v10 offset:2560
ds_read_b128 v[44:47], v12 offset:2048
s_waitcnt lgkmcnt(10)
v_mfma_f32_32x32x16_bf16 v[60:75], v[28:31], v[48:51], v[60:75]
ds_read_b64_tr_b16 v[24:25], v10 offset:4096
ds_read_b64_tr_b16 v[26:27], v10 offset:4608
ds_read_b128 v[48:51], v12 offset:3072
s_waitcnt lgkmcnt(10)
v_mfma_f32_32x32x16_bf16 v[60:75], v[32:35], v[52:55], v[60:75]
ds_read_b64_tr_b16 v[28:29], v10 offset:6144
ds_read_b64_tr_b16 v[30:31], v10 offset:6656
s_barrier
v_add_u32 v11, 122880, v9
v_add_u32 v13, 118784, v3
ds_read_b128 v[52:55], v13 offset:0
s_waitcnt lgkmcnt(10)
v_mfma_f32_32x32x16_bf16 v[60:75], v[36:39], v[56:59], v[60:75]
ds_read_b64_tr_b16 v[32:33], v11 offset:0
ds_read_b64_tr_b16 v[34:35], v11 offset:512
ds_read_b128 v[56:59], v13 offset:1024
s_waitcnt lgkmcnt(10)
v_mfma_f32_32x32x16_bf16 v[60:75], v[20:23], v[40:43], v[60:75]
ds_read_b64_tr_b16 v[36:37], v11 offset:2048
ds_read_b64_tr_b16 v[38:39], v11 offset:2560
ds_read_b128 v[40:43], v13 offset:2048
s_waitcnt lgkmcnt(10)
v_mfma_f32_32x32x16_bf16 v[60:75], v[24:27], v[44:47], v[60:75]
ds_read_b64_tr_b16 v[20:21], v11 offset:4096
ds_read_b64_tr_b16 v[22:23], v11 offset:4608
ds_read_b128 v[44:47], v13 offset:3072
s_waitcnt lgkmcnt(10)
v_mfma_f32_32x32x16_bf16 v[60:75], v[28:31], v[48:51], v[60:75]
ds_read_b64_tr_b16 v[24:25], v11 offset:6144
ds_read_b64_tr_b16 v[26:27], v11 offset:6656
s_barrier
v_add_u32 v10, 139264, v9
v_add_u32 v12, 135168, v3
ds_read_b128 v[48:51], v12 offset:0
s_waitcnt lgkmcnt(10)
v_mfma_f32_32x32x16_bf16 v[60:75], v[32:35], v[52:55], v[60:75]
ds_read_b64_tr_b16 v[28:29], v10 offset:0
ds_read_b64_tr_b16 v[30:31], v10 offset:512
ds_read_b128 v[52:55], v12 offset:1024
s_waitcnt lgkmcnt(10)
v_mfma_f32_32x32x16_bf16 v[60:75], v[36:39], v[56:59], v[60:75]
ds_read_b64_tr_b16 v[32:33], v10 offset:2048
ds_read_b64_tr_b16 v[34:35], v10 offset:2560
ds_read_b128 v[56:59], v12 offset:2048
s_waitcnt lgkmcnt(10)
v_mfma_f32_32x32x16_bf16 v[60:75], v[20:23], v[40:43], v[60:75]
ds_read_b64_tr_b16 v[36:37], v10 offset:4096
ds_read_b64_tr_b16 v[38:39], v10 offset:4608
ds_read_b128 v[40:43], v12 offset:3072
s_waitcnt lgkmcnt(10)
v_mfma_f32_32x32x16_bf16 v[60:75], v[24:27], v[44:47], v[60:75]
ds_read_b64_tr_b16 v[20:21], v10 offset:6144
ds_read_b64_tr_b16 v[22:23], v10 offset:6656
s_barrier
v_add_u32 v11, 8192, v9
v_add_u32 v13, 4096, v3
ds_read_b128 v[44:47], v13 offset:0
s_waitcnt lgkmcnt(10)
v_mfma_f32_32x32x16_bf16 v[60:75], v[28:31], v[48:51], v[60:75]
ds_read_b64_tr_b16 v[24:25], v11 offset:0
ds_read_b64_tr_b16 v[26:27], v11 offset:512
ds_read_b128 v[48:51], v13 offset:1024
s_waitcnt lgkmcnt(10)
v_mfma_f32_32x32x16_bf16 v[60:75], v[32:35], v[52:55], v[60:75]
ds_read_b64_tr_b16 v[28:29], v11 offset:2048
ds_read_b64_tr_b16 v[30:31], v11 offset:2560
ds_read_b128 v[52:55], v13 offset:2048
s_waitcnt lgkmcnt(10)
v_mfma_f32_32x32x16_bf16 v[60:75], v[36:39], v[56:59], v[60:75]
ds_read_b64_tr_b16 v[32:33], v11 offset:4096
ds_read_b64_tr_b16 v[34:35], v11 offset:4608
ds_read_b128 v[56:59], v13 offset:3072
s_waitcnt lgkmcnt(10)
v_mfma_f32_32x32x16_bf16 v[60:75], v[20:23], v[40:43], v[60:75]
ds_read_b64_tr_b16 v[36:37], v11 offset:6144
ds_read_b64_tr_b16 v[38:39], v11 offset:6656
s_barrier
v_add_u32 v10, 24576, v9
v_add_u32 v12, 20480, v3
ds_read_b128 v[40:43], v12 offset:0
s_waitcnt lgkmcnt(10)
v_mfma_f32_32x32x16_bf16 v[60:75], v[24:27], v[44:47], v[60:75]
ds_read_b64_tr_b16 v[20:21], v10 offset:0
ds_read_b64_tr_b16 v[22:23], v10 offset:512
ds_read_b128 v[44:47], v12 offset:1024
s_waitcnt lgkmcnt(10)
v_mfma_f32_32x32x16_bf16 v[60:75], v[28:31], v[48:51], v[60:75]
ds_read_b64_tr_b16 v[24:25], v10 offset:2048
ds_read_b64_tr_b16 v[26:27], v10 offset:2560
ds_read_b128 v[48:51], v12 offset:2048
s_waitcnt lgkmcnt(10)
v_mfma_f32_32x32x16_bf16 v[60:75], v[32:35], v[52:55], v[60:75]
ds_read_b64_tr_b16 v[28:29], v10 offset:4096
ds_read_b64_tr_b16 v[30:31], v10 offset:4608
ds_read_b128 v[52:55], v12 offset:3072
s_waitcnt lgkmcnt(10)
v_mfma_f32_32x32x16_bf16 v[60:75], v[36:39], v[56:59], v[60:75]
ds_read_b64_tr_b16 v[32:33], v10 offset:6144
ds_read_b64_tr_b16 v[34:35], v10 offset:6656
s_barrier
v_add_u32 v11, 40960, v9
v_add_u32 v13, 36864, v3
ds_read_b128 v[56:59], v13 offset:0
s_waitcnt lgkmcnt(10)
v_mfma_f32_32x32x16_bf16 v[60:75], v[20:23], v[40:43], v[60:75]
ds_read_b64_tr_b16 v[36:37], v11 offset:0
ds_read_b64_tr_b16 v[38:39], v11 offset:512
ds_read_b128 v[40:43], v13 offset:1024
s_waitcnt lgkmcnt(10)
v_mfma_f32_32x32x16_bf16 v[60:75], v[24:27], v[44:47], v[60:75]
ds_read_b64_tr_b16 v[20:21], v11 offset:2048
ds_read_b64_tr_b16 v[22:23], v11 offset:2560
ds_read_b128 v[44:47], v13 offset:2048
s_waitcnt lgkmcnt(10)
v_mfma_f32_32x32x16_bf16 v[60:75], v[28:31], v[48:51], v[60:75]
ds_read_b64_tr_b16 v[24:25], v11 offset:4096
ds_read_b64_tr_b16 v[26:27], v11 offset:4608
ds_read_b128 v[48:51], v13 offset:3072
s_waitcnt lgkmcnt(10)
v_mfma_f32_32x32x16_bf16 v[60:75], v[32:35], v[52:55], v[60:75]
ds_read_b64_tr_b16 v[28:29], v11 offset:6144
ds_read_b64_tr_b16 v[30:31], v11 offset:6656
s_barrier
v_add_u32 v10, 57344, v9
v_add_u32 v12, 53248, v3
ds_read_b128 v[52:55], v12 offset:0
s_waitcnt lgkmcnt(10)
v_mfma_f32_32x32x16_bf16 v[60:75], v[36:39], v[56:59], v[60:75]
ds_read_b64_tr_b16 v[32:33], v10 offset:0
ds_read_b64_tr_b16 v[34:35], v10 offset:512
ds_read_b128 v[56:59], v12 offset:1024
s_waitcnt lgkmcnt(10)
v_mfma_f32_32x32x16_bf16 v[60:75], v[20:23], v[40:43], v[60:75]
ds_read_b64_tr_b16 v[36:37], v10 offset:2048
ds_read_b64_tr_b16 v[38:39], v10 offset:2560
ds_read_b128 v[40:43], v12 offset:2048
s_waitcnt lgkmcnt(10)
v_mfma_f32_32x32x16_bf16 v[60:75], v[24:27], v[44:47], v[60:75]
ds_read_b64_tr_b16 v[20:21], v10 offset:4096
ds_read_b64_tr_b16 v[22:23], v10 offset:4608
ds_read_b128 v[44:47], v12 offset:3072
s_waitcnt lgkmcnt(10)
v_mfma_f32_32x32x16_bf16 v[60:75], v[28:31], v[48:51], v[60:75]
ds_read_b64_tr_b16 v[24:25], v10 offset:6144
ds_read_b64_tr_b16 v[26:27], v10 offset:6656
s_barrier
v_add_u32 v11, 73728, v9
v_add_u32 v13, 69632, v3
ds_read_b128 v[48:51], v13 offset:0
s_waitcnt lgkmcnt(10)
v_mfma_f32_32x32x16_bf16 v[60:75], v[32:35], v[52:55], v[60:75]
ds_read_b64_tr_b16 v[28:29], v11 offset:0
ds_read_b64_tr_b16 v[30:31], v11 offset:512
ds_read_b128 v[52:55], v13 offset:1024
s_waitcnt lgkmcnt(10)
v_mfma_f32_32x32x16_bf16 v[60:75], v[36:39], v[56:59], v[60:75]
ds_read_b64_tr_b16 v[32:33], v11 offset:2048
ds_read_b64_tr_b16 v[34:35], v11 offset:2560
ds_read_b128 v[56:59], v13 offset:2048
s_waitcnt lgkmcnt(10)
v_mfma_f32_32x32x16_bf16 v[60:75], v[20:23], v[40:43], v[60:75]
ds_read_b64_tr_b16 v[36:37], v11 offset:4096
ds_read_b64_tr_b16 v[38:39], v11 offset:4608
ds_read_b128 v[40:43], v13 offset:3072
s_waitcnt lgkmcnt(10)
v_mfma_f32_32x32x16_bf16 v[60:75], v[24:27], v[44:47], v[60:75]
ds_read_b64_tr_b16 v[20:21], v11 offset:6144
ds_read_b64_tr_b16 v[22:23], v11 offset:6656
s_barrier
v_add_u32 v10, 90112, v9
v_add_u32 v12, 86016, v3
ds_read_b128 v[44:47], v12 offset:0
s_waitcnt lgkmcnt(10)
v_mfma_f32_32x32x16_bf16 v[60:75], v[28:31], v[48:51], v[60:75]
ds_read_b64_tr_b16 v[24:25], v10 offset:0
ds_read_b64_tr_b16 v[26:27], v10 offset:512
ds_read_b128 v[48:51], v12 offset:1024
s_waitcnt lgkmcnt(10)
v_mfma_f32_32x32x16_bf16 v[60:75], v[32:35], v[52:55], v[60:75]
ds_read_b64_tr_b16 v[28:29], v10 offset:2048
ds_read_b64_tr_b16 v[30:31], v10 offset:2560
ds_read_b128 v[52:55], v12 offset:2048
s_waitcnt lgkmcnt(10)
v_mfma_f32_32x32x16_bf16 v[60:75], v[36:39], v[56:59], v[60:75]
ds_read_b64_tr_b16 v[32:33], v10 offset:4096
ds_read_b64_tr_b16 v[34:35], v10 offset:4608
ds_read_b128 v[56:59], v12 offset:3072
s_waitcnt lgkmcnt(10)
v_mfma_f32_32x32x16_bf16 v[60:75], v[20:23], v[40:43], v[60:75]
ds_read_b64_tr_b16 v[36:37], v10 offset:6144
ds_read_b64_tr_b16 v[38:39], v10 offset:6656
s_barrier
v_add_u32 v11, 106496, v9
v_add_u32 v13, 102400, v3
ds_read_b128 v[40:43], v13 offset:0
s_waitcnt lgkmcnt(10)
v_mfma_f32_32x32x16_bf16 v[60:75], v[24:27], v[44:47], v[60:75]
ds_read_b64_tr_b16 v[20:21], v11 offset:0
ds_read_b64_tr_b16 v[22:23], v11 offset:512
ds_read_b128 v[44:47], v13 offset:1024
s_waitcnt lgkmcnt(10)
v_mfma_f32_32x32x16_bf16 v[60:75], v[28:31], v[48:51], v[60:75]
ds_read_b64_tr_b16 v[24:25], v11 offset:2048
ds_read_b64_tr_b16 v[26:27], v11 offset:2560
ds_read_b128 v[48:51], v13 offset:2048
s_waitcnt lgkmcnt(10)
v_mfma_f32_32x32x16_bf16 v[60:75], v[32:35], v[52:55], v[60:75]
ds_read_b64_tr_b16 v[28:29], v11 offset:4096
ds_read_b64_tr_b16 v[30:31], v11 offset:4608
ds_read_b128 v[52:55], v13 offset:3072
s_waitcnt lgkmcnt(10)
v_mfma_f32_32x32x16_bf16 v[60:75], v[36:39], v[56:59], v[60:75]
ds_read_b64_tr_b16 v[32:33], v11 offset:6144
ds_read_b64_tr_b16 v[34:35], v11 offset:6656
s_barrier
v_add_u32 v10, 122880, v9
v_add_u32 v12, 118784, v3
ds_read_b128 v[56:59], v12 offset:0
s_waitcnt lgkmcnt(10)
v_mfma_f32_32x32x16_bf16 v[60:75], v[20:23], v[40:43], v[60:75]
ds_read_b64_tr_b16 v[36:37], v10 offset:0
ds_read_b64_tr_b16 v[38:39], v10 offset:512
ds_read_b128 v[40:43], v12 offset:1024
s_waitcnt lgkmcnt(10)
v_mfma_f32_32x32x16_bf16 v[60:75], v[24:27], v[44:47], v[60:75]
ds_read_b64_tr_b16 v[20:21], v10 offset:2048
ds_read_b64_tr_b16 v[22:23], v10 offset:2560
ds_read_b128 v[44:47], v12 offset:2048
s_waitcnt lgkmcnt(10)
v_mfma_f32_32x32x16_bf16 v[60:75], v[28:31], v[48:51], v[60:75]
ds_read_b64_tr_b16 v[24:25], v10 offset:4096
ds_read_b64_tr_b16 v[26:27], v10 offset:4608
ds_read_b128 v[48:51], v12 offset:3072
s_waitcnt lgkmcnt(10)
v_mfma_f32_32x32x16_bf16 v[60:75], v[32:35], v[52:55], v[60:75]
ds_read_b64_tr_b16 v[28:29], v10 offset:6144
ds_read_b64_tr_b16 v[30:31], v10 offset:6656
s_barrier
v_add_u32 v11, 139264, v9
v_add_u32 v13, 135168, v3
ds_read_b128 v[52:55], v13 offset:0
s_waitcnt lgkmcnt(10)
v_mfma_f32_32x32x16_bf16 v[60:75], v[36:39], v[56:59], v[60:75]
ds_read_b64_tr_b16 v[32:33], v11 offset:0
ds_read_b64_tr_b16 v[34:35], v11 offset:512
ds_read_b128 v[56:59], v13 offset:1024
s_waitcnt lgkmcnt(10)
v_mfma_f32_32x32x16_bf16 v[60:75], v[20:23], v[40:43], v[60:75]
ds_read_b64_tr_b16 v[36:37], v11 offset:2048
ds_read_b64_tr_b16 v[38:39], v11 offset:2560
ds_read_b128 v[40:43], v13 offset:2048
s_waitcnt lgkmcnt(10)
v_mfma_f32_32x32x16_bf16 v[60:75], v[24:27], v[44:47], v[60:75]
ds_read_b64_tr_b16 v[20:21], v11 offset:4096
ds_read_b64_tr_b16 v[22:23], v11 offset:4608
ds_read_b128 v[44:47], v13 offset:3072
s_waitcnt lgkmcnt(10)
v_mfma_f32_32x32x16_bf16 v[60:75], v[28:31], v[48:51], v[60:75]
ds_read_b64_tr_b16 v[24:25], v11 offset:6144
ds_read_b64_tr_b16 v[26:27], v11 offset:6656
s_barrier
v_add_u32 v10, 8192, v9
v_add_u32 v12, 4096, v3
ds_read_b128 v[48:51], v12 offset:0
s_waitcnt lgkmcnt(10)
v_mfma_f32_32x32x16_bf16 v[60:75], v[32:35], v[52:55], v[60:75]
ds_read_b64_tr_b16 v[28:29], v10 offset:0
ds_read_b64_tr_b16 v[30:31], v10 offset:512
ds_read_b128 v[52:55], v12 offset:1024
s_waitcnt lgkmcnt(10)
v_mfma_f32_32x32x16_bf16 v[60:75], v[36:39], v[56:59], v[60:75]
ds_read_b64_tr_b16 v[32:33], v10 offset:2048
ds_read_b64_tr_b16 v[34:35], v10 offset:2560
ds_read_b128 v[56:59], v12 offset:2048
s_waitcnt lgkmcnt(10)
v_mfma_f32_32x32x16_bf16 v[60:75], v[20:23], v[40:43], v[60:75]
ds_read_b64_tr_b16 v[36:37], v10 offset:4096
ds_read_b64_tr_b16 v[38:39], v10 offset:4608
ds_read_b128 v[40:43], v12 offset:3072
s_waitcnt lgkmcnt(10)
v_mfma_f32_32x32x16_bf16 v[60:75], v[24:27], v[44:47], v[60:75]
ds_read_b64_tr_b16 v[20:21], v10 offset:6144
ds_read_b64_tr_b16 v[22:23], v10 offset:6656
s_barrier
v_add_u32 v11, 24576, v9
v_add_u32 v13, 20480, v3
ds_read_b128 v[44:47], v13 offset:0
s_waitcnt lgkmcnt(10)
v_mfma_f32_32x32x16_bf16 v[60:75], v[28:31], v[48:51], v[60:75]
ds_read_b64_tr_b16 v[24:25], v11 offset:0
ds_read_b64_tr_b16 v[26:27], v11 offset:512
ds_read_b128 v[48:51], v13 offset:1024
s_waitcnt lgkmcnt(10)
v_mfma_f32_32x32x16_bf16 v[60:75], v[32:35], v[52:55], v[60:75]
ds_read_b64_tr_b16 v[28:29], v11 offset:2048
ds_read_b64_tr_b16 v[30:31], v11 offset:2560
ds_read_b128 v[52:55], v13 offset:2048
s_waitcnt lgkmcnt(10)
v_mfma_f32_32x32x16_bf16 v[60:75], v[36:39], v[56:59], v[60:75]
ds_read_b64_tr_b16 v[32:33], v11 offset:4096
ds_read_b64_tr_b16 v[34:35], v11 offset:4608
ds_read_b128 v[56:59], v13 offset:3072
s_waitcnt lgkmcnt(10)
v_mfma_f32_32x32x16_bf16 v[60:75], v[20:23], v[40:43], v[60:75]
ds_read_b64_tr_b16 v[36:37], v11 offset:6144
ds_read_b64_tr_b16 v[38:39], v11 offset:6656
s_barrier
v_add_u32 v10, 40960, v9
v_add_u32 v12, 36864, v3
ds_read_b128 v[40:43], v12 offset:0
s_waitcnt lgkmcnt(10)
v_mfma_f32_32x32x16_bf16 v[60:75], v[24:27], v[44:47], v[60:75]
ds_read_b64_tr_b16 v[20:21], v10 offset:0
ds_read_b64_tr_b16 v[22:23], v10 offset:512
ds_read_b128 v[44:47], v12 offset:1024
s_waitcnt lgkmcnt(10)
v_mfma_f32_32x32x16_bf16 v[60:75], v[28:31], v[48:51], v[60:75]
ds_read_b64_tr_b16 v[24:25], v10 offset:2048
ds_read_b64_tr_b16 v[26:27], v10 offset:2560
ds_read_b128 v[48:51], v12 offset:2048
s_waitcnt lgkmcnt(10)
v_mfma_f32_32x32x16_bf16 v[60:75], v[32:35], v[52:55], v[60:75]
ds_read_b64_tr_b16 v[28:29], v10 offset:4096
ds_read_b64_tr_b16 v[30:31], v10 offset:4608
ds_read_b128 v[52:55], v12 offset:3072
s_waitcnt lgkmcnt(10)
v_mfma_f32_32x32x16_bf16 v[60:75], v[36:39], v[56:59], v[60:75]
ds_read_b64_tr_b16 v[32:33], v10 offset:6144
ds_read_b64_tr_b16 v[34:35], v10 offset:6656
s_barrier
v_add_u32 v11, 57344, v9
v_add_u32 v13, 53248, v3
ds_read_b128 v[56:59], v13 offset:0
s_waitcnt lgkmcnt(10)
v_mfma_f32_32x32x16_bf16 v[60:75], v[20:23], v[40:43], v[60:75]
ds_read_b64_tr_b16 v[36:37], v11 offset:0
ds_read_b64_tr_b16 v[38:39], v11 offset:512
ds_read_b128 v[40:43], v13 offset:1024
s_waitcnt lgkmcnt(10)
v_mfma_f32_32x32x16_bf16 v[60:75], v[24:27], v[44:47], v[60:75]
ds_read_b64_tr_b16 v[20:21], v11 offset:2048
ds_read_b64_tr_b16 v[22:23], v11 offset:2560
ds_read_b128 v[44:47], v13 offset:2048
s_waitcnt lgkmcnt(10)
v_mfma_f32_32x32x16_bf16 v[60:75], v[28:31], v[48:51], v[60:75]
ds_read_b64_tr_b16 v[24:25], v11 offset:4096
ds_read_b64_tr_b16 v[26:27], v11 offset:4608
ds_read_b128 v[48:51], v13 offset:3072
s_waitcnt lgkmcnt(10)
v_mfma_f32_32x32x16_bf16 v[60:75], v[32:35], v[52:55], v[60:75]
ds_read_b64_tr_b16 v[28:29], v11 offset:6144
ds_read_b64_tr_b16 v[30:31], v11 offset:6656
s_barrier
v_add_u32 v10, 73728, v9
v_add_u32 v12, 69632, v3
ds_read_b128 v[52:55], v12 offset:0
s_waitcnt lgkmcnt(10)
v_mfma_f32_32x32x16_bf16 v[60:75], v[36:39], v[56:59], v[60:75]
ds_read_b64_tr_b16 v[32:33], v10 offset:0
ds_read_b64_tr_b16 v[34:35], v10 offset:512
ds_read_b128 v[56:59], v12 offset:1024
s_waitcnt lgkmcnt(10)
v_mfma_f32_32x32x16_bf16 v[60:75], v[20:23], v[40:43], v[60:75]
ds_read_b64_tr_b16 v[36:37], v10 offset:2048
ds_read_b64_tr_b16 v[38:39], v10 offset:2560
ds_read_b128 v[40:43], v12 offset:2048
s_waitcnt lgkmcnt(10)
v_mfma_f32_32x32x16_bf16 v[60:75], v[24:27], v[44:47], v[60:75]
ds_read_b64_tr_b16 v[20:21], v10 offset:4096
ds_read_b64_tr_b16 v[22:23], v10 offset:4608
ds_read_b128 v[44:47], v12 offset:3072
s_waitcnt lgkmcnt(10)
v_mfma_f32_32x32x16_bf16 v[60:75], v[28:31], v[48:51], v[60:75]
ds_read_b64_tr_b16 v[24:25], v10 offset:6144
ds_read_b64_tr_b16 v[26:27], v10 offset:6656
s_barrier
v_add_u32 v11, 90112, v9
v_add_u32 v13, 86016, v3
ds_read_b128 v[48:51], v13 offset:0
s_waitcnt lgkmcnt(10)
v_mfma_f32_32x32x16_bf16 v[60:75], v[32:35], v[52:55], v[60:75]
ds_read_b64_tr_b16 v[28:29], v11 offset:0
ds_read_b64_tr_b16 v[30:31], v11 offset:512
ds_read_b128 v[52:55], v13 offset:1024
s_waitcnt lgkmcnt(10)
v_mfma_f32_32x32x16_bf16 v[60:75], v[36:39], v[56:59], v[60:75]
ds_read_b64_tr_b16 v[32:33], v11 offset:2048
ds_read_b64_tr_b16 v[34:35], v11 offset:2560
ds_read_b128 v[56:59], v13 offset:2048
s_waitcnt lgkmcnt(10)
v_mfma_f32_32x32x16_bf16 v[60:75], v[20:23], v[40:43], v[60:75]
ds_read_b64_tr_b16 v[36:37], v11 offset:4096
ds_read_b64_tr_b16 v[38:39], v11 offset:4608
ds_read_b128 v[40:43], v13 offset:3072
s_waitcnt lgkmcnt(10)
v_mfma_f32_32x32x16_bf16 v[60:75], v[24:27], v[44:47], v[60:75]
ds_read_b64_tr_b16 v[20:21], v11 offset:6144
ds_read_b64_tr_b16 v[22:23], v11 offset:6656
s_barrier
v_add_u32 v10, 106496, v9
v_add_u32 v12, 102400, v3
ds_read_b128 v[44:47], v12 offset:0
s_waitcnt lgkmcnt(10)
v_mfma_f32_32x32x16_bf16 v[60:75], v[28:31], v[48:51], v[60:75]
ds_read_b64_tr_b16 v[24:25], v10 offset:0
ds_read_b64_tr_b16 v[26:27], v10 offset:512
ds_read_b128 v[48:51], v12 offset:1024
s_waitcnt lgkmcnt(10)
v_mfma_f32_32x32x16_bf16 v[60:75], v[32:35], v[52:55], v[60:75]
ds_read_b64_tr_b16 v[28:29], v10 offset:2048
ds_read_b64_tr_b16 v[30:31], v10 offset:2560
ds_read_b128 v[52:55], v12 offset:2048
s_waitcnt lgkmcnt(10)
v_mfma_f32_32x32x16_bf16 v[60:75], v[36:39], v[56:59], v[60:75]
ds_read_b64_tr_b16 v[32:33], v10 offset:4096
ds_read_b64_tr_b16 v[34:35], v10 offset:4608
ds_read_b128 v[56:59], v12 offset:3072
s_waitcnt lgkmcnt(10)
v_mfma_f32_32x32x16_bf16 v[60:75], v[20:23], v[40:43], v[60:75]
ds_read_b64_tr_b16 v[36:37], v10 offset:6144
ds_read_b64_tr_b16 v[38:39], v10 offset:6656
s_barrier
v_add_u32 v11, 122880, v9
v_add_u32 v13, 118784, v3
ds_read_b128 v[40:43], v13 offset:0
s_waitcnt lgkmcnt(10)
v_mfma_f32_32x32x16_bf16 v[60:75], v[24:27], v[44:47], v[60:75]
ds_read_b64_tr_b16 v[20:21], v11 offset:0
ds_read_b64_tr_b16 v[22:23], v11 offset:512
ds_read_b128 v[44:47], v13 offset:1024
s_waitcnt lgkmcnt(10)
v_mfma_f32_32x32x16_bf16 v[60:75], v[28:31], v[48:51], v[60:75]
ds_read_b64_tr_b16 v[24:25], v11 offset:2048
ds_read_b64_tr_b16 v[26:27], v11 offset:2560
ds_read_b128 v[48:51], v13 offset:2048
s_waitcnt lgkmcnt(10)
v_mfma_f32_32x32x16_bf16 v[60:75], v[32:35], v[52:55], v[60:75]
ds_read_b64_tr_b16 v[28:29], v11 offset:4096
ds_read_b64_tr_b16 v[30:31], v11 offset:4608
ds_read_b128 v[52:55], v13 offset:3072
s_waitcnt lgkmcnt(10)
v_mfma_f32_32x32x16_bf16 v[60:75], v[36:39], v[56:59], v[60:75]
ds_read_b64_tr_b16 v[32:33], v11 offset:6144
ds_read_b64_tr_b16 v[34:35], v11 offset:6656
s_barrier
v_add_u32 v10, 139264, v9
v_add_u32 v12, 135168, v3
ds_read_b128 v[56:59], v12 offset:0
s_waitcnt lgkmcnt(10)
v_mfma_f32_32x32x16_bf16 v[60:75], v[20:23], v[40:43], v[60:75]
ds_read_b64_tr_b16 v[36:37], v10 offset:0
ds_read_b64_tr_b16 v[38:39], v10 offset:512
ds_read_b128 v[40:43], v12 offset:1024
s_waitcnt lgkmcnt(10)
v_mfma_f32_32x32x16_bf16 v[60:75], v[24:27], v[44:47], v[60:75]
ds_read_b64_tr_b16 v[20:21], v10 offset:2048
ds_read_b64_tr_b16 v[22:23], v10 offset:2560
ds_read_b128 v[44:47], v12 offset:2048
s_waitcnt lgkmcnt(10)
v_mfma_f32_32x32x16_bf16 v[60:75], v[28:31], v[48:51], v[60:75]
ds_read_b64_tr_b16 v[24:25], v10 offset:4096
ds_read_b64_tr_b16 v[26:27], v10 offset:4608
ds_read_b128 v[48:51], v12 offset:3072
s_waitcnt lgkmcnt(10)
v_mfma_f32_32x32x16_bf16 v[60:75], v[32:35], v[52:55], v[60:75]
ds_read_b64_tr_b16 v[28:29], v10 offset:6144
ds_read_b64_tr_b16 v[30:31], v10 offset:6656
s_barrier
v_add_u32 v11, 8192, v9
v_add_u32 v13, 4096, v3
ds_read_b128 v[52:55], v13 offset:0
s_waitcnt lgkmcnt(10)
v_mfma_f32_32x32x16_bf16 v[60:75], v[36:39], v[56:59], v[60:75]
ds_read_b64_tr_b16 v[32:33], v11 offset:0
ds_read_b64_tr_b16 v[34:35], v11 offset:512
ds_read_b128 v[56:59], v13 offset:1024
s_waitcnt lgkmcnt(10)
v_mfma_f32_32x32x16_bf16 v[60:75], v[20:23], v[40:43], v[60:75]
ds_read_b64_tr_b16 v[36:37], v11 offset:2048
ds_read_b64_tr_b16 v[38:39], v11 offset:2560
ds_read_b128 v[40:43], v13 offset:2048
s_waitcnt lgkmcnt(10)
v_mfma_f32_32x32x16_bf16 v[60:75], v[24:27], v[44:47], v[60:75]
ds_read_b64_tr_b16 v[20:21], v11 offset:4096
ds_read_b64_tr_b16 v[22:23], v11 offset:4608
ds_read_b128 v[44:47], v13 offset:3072
s_waitcnt lgkmcnt(10)
v_mfma_f32_32x32x16_bf16 v[60:75], v[28:31], v[48:51], v[60:75]
ds_read_b64_tr_b16 v[24:25], v11 offset:6144
ds_read_b64_tr_b16 v[26:27], v11 offset:6656
s_waitcnt lgkmcnt(9)
v_mfma_f32_32x32x16_bf16 v[60:75], v[32:35], v[52:55], v[60:75]
s_waitcnt lgkmcnt(6)
v_mfma_f32_32x32x16_bf16 v[60:75], v[36:39], v[56:59], v[60:75]
s_waitcnt lgkmcnt(3)
v_mfma_f32_32x32x16_bf16 v[60:75], v[20:23], v[40:43], v[60:75]
s_waitcnt lgkmcnt(0)
v_mfma_f32_32x32x16_bf16 v[60:75], v[24:27], v[44:47], v[60:75]
s_nop 11
v_cvt_pk_bf16_f32 v76, v60, v61
v_cvt_pk_bf16_f32 v77, v62, v63
v_cvt_pk_bf16_f32 v78, v64, v65
v_cvt_pk_bf16_f32 v79, v66, v67
v_cvt_pk_bf16_f32 v80, v68, v69
v_cvt_pk_bf16_f32 v81, v70, v71
v_cvt_pk_bf16_f32 v82, v72, v73
v_cvt_pk_bf16_f32 v83, v74, v75
v_lshlrev_b32 v60, 16, v76
v_and_b32 v61, 0xffff0000, v76
v_lshlrev_b32 v62, 16, v77
v_and_b32 v63, 0xffff0000, v77
v_lshlrev_b32 v64, 16, v78
v_and_b32 v65, 0xffff0000, v78
v_lshlrev_b32 v66, 16, v79
v_and_b32 v67, 0xffff0000, v79
v_lshlrev_b32 v68, 16, v80
v_and_b32 v69, 0xffff0000, v80
v_lshlrev_b32 v70, 16, v81
v_and_b32 v71, 0xffff0000, v81
v_lshlrev_b32 v72, 16, v82
v_and_b32 v73, 0xffff0000, v82
v_lshlrev_b32 v74, 16, v83
v_and_b32 v75, 0xffff0000, v83
s_waitcnt vmcnt(3)
v_lshlrev_b32 v84, 16, v88
v_and_b32 v85, 0xffff0000, v88
v_add_f32 v60, v60, v84
v_add_f32 v61, v61, v85
v_lshlrev_b32 v84, 16, v89
v_and_b32 v85, 0xffff0000, v89
v_add_f32 v62, v62, v84
v_add_f32 v63, v63, v85
s_waitcnt vmcnt(2)
v_lshlrev_b32 v84, 16, v90
v_and_b32 v85, 0xffff0000, v90
v_add_f32 v64, v64, v84
v_add_f32 v65, v65, v85
v_lshlrev_b32 v84, 16, v91
v_and_b32 v85, 0xffff0000, v91
v_add_f32 v66, v66, v84
v_add_f32 v67, v67, v85
s_waitcnt vmcnt(1)
v_lshlrev_b32 v84, 16, v92
v_and_b32 v85, 0xffff0000, v92
v_add_f32 v68, v68, v84
v_add_f32 v69, v69, v85
v_lshlrev_b32 v84, 16, v93
v_and_b32 v85, 0xffff0000, v93
v_add_f32 v70, v70, v84
v_add_f32 v71, v71, v85
s_waitcnt vmcnt(0)
v_lshlrev_b32 v84, 16, v94
v_and_b32 v85, 0xffff0000, v94
v_add_f32 v72, v72, v84
v_add_f32 v73, v73, v85
v_lshlrev_b32 v84, 16, v95
v_and_b32 v85, 0xffff0000, v95
v_add_f32 v74, v74, v84
v_add_f32 v75, v75, v85
v_cvt_pk_bf16_f32 v76, v60, v61
v_cvt_pk_bf16_f32 v77, v62, v63
v_cvt_pk_bf16_f32 v78, v64, v65
v_cvt_pk_bf16_f32 v79, v66, v67
v_cvt_pk_bf16_f32 v80, v68, v69
v_cvt_pk_bf16_f32 v81, v70, v71
v_cvt_pk_bf16_f32 v82, v72, v73
v_cvt_pk_bf16_f32 v83, v74, v75
v_permlane32_swap_b32 v76, v78
v_permlane32_swap_b32 v77, v79
v_permlane32_swap_b32 v80, v82
v_permlane32_swap_b32 v81, v83
buffer_store_dwordx4 v[76:79], v86, s[52:55], s9 offen
buffer_store_dwordx4 v[80:83], v86, s[52:55], s9 offen offset:32
s_waitcnt vmcnt(0)
s_branch k5_kernel_end
k5_kernel_w3:
s_lshl_b32 s7, s4, 1
s_add_u32 s7, s7, 1
s_lshl_b32 s8, s5, 7
s_add_u32 s8, s8, 64
s_lshl_b32 s10, s7, 5
s_lshr_b32 s11, s8, 5
s_add_u32 s10, s10, s11
s_lshl_b32 s10, s10, 10
v_and_b32 v86, 31, v1
v_lshlrev_b32 v87, 4, v86
v_lshl_add_u32 v87, v5, 3, v87
buffer_load_dwordx2 v[88:89], v87, s[56:59], s10 offen offset:0
buffer_load_dwordx2 v[90:91], v87, s[56:59], s10 offen offset:512
buffer_load_dwordx2 v[92:93], v87, s[56:59], s10 offen offset:1024
buffer_load_dwordx2 v[94:95], v87, s[56:59], s10 offen offset:1536
s_lshl_b32 s9, s7, 15
s_add_u32 s9, s9, s8
v_lshlrev_b32 v86, 10, v86
v_lshl_add_u32 v86, v5, 4, v86
v_lshrrev_b32 v14, 1, v8
v_lshl_add_u32 v14, v6, 1, v14
v_add_u32 v14, 4, v14
v_bfe_u32 v15, v4, 3, 1
v_lshlrev_b32 v15, 2, v15
v_xor_b32 v14, v14, v15
v_lshlrev_b32 v14, 4, v14
v_and_b32 v15, 1, v4
v_lshl_add_u32 v14, v15, 3, v14
v_lshl_add_u32 v9, v7, 7, v14
s_barrier
v_add_u32 v10, 8192, v9
v_add_u32 v12, 4096, v3
ds_read_b128 v[40:43], v12 offset:0
ds_read_b64_tr_b16 v[20:21], v10 offset:0
ds_read_b64_tr_b16 v[22:23], v10 offset:512
ds_read_b128 v[44:47], v12 offset:1024
ds_read_b64_tr_b16 v[24:25], v10 offset:2048
ds_read_b64_tr_b16 v[26:27], v10 offset:2560
ds_read_b128 v[48:51], v12 offset:2048
ds_read_b64_tr_b16 v[28:29], v10 offset:4096
ds_read_b64_tr_b16 v[30:31], v10 offset:4608
ds_read_b128 v[52:55], v12 offset:3072
ds_read_b64_tr_b16 v[32:33], v10 offset:6144
ds_read_b64_tr_b16 v[34:35], v10 offset:6656
s_barrier
v_add_u32 v11, 24576, v9
v_add_u32 v13, 20480, v3
ds_read_b128 v[56:59], v13 offset:0
s_waitcnt lgkmcnt(10)
v_mfma_f32_32x32x16_bf16 v[60:75], v[20:23], v[40:43], 0
ds_read_b64_tr_b16 v[36:37], v11 offset:0
ds_read_b64_tr_b16 v[38:39], v11 offset:512
ds_read_b128 v[40:43], v13 offset:1024
s_waitcnt lgkmcnt(10)
v_mfma_f32_32x32x16_bf16 v[60:75], v[24:27], v[44:47], v[60:75]
ds_read_b64_tr_b16 v[20:21], v11 offset:2048
ds_read_b64_tr_b16 v[22:23], v11 offset:2560
ds_read_b128 v[44:47], v13 offset:2048
s_waitcnt lgkmcnt(10)
v_mfma_f32_32x32x16_bf16 v[60:75], v[28:31], v[48:51], v[60:75]
ds_read_b64_tr_b16 v[24:25], v11 offset:4096
ds_read_b64_tr_b16 v[26:27], v11 offset:4608
ds_read_b128 v[48:51], v13 offset:3072
s_waitcnt lgkmcnt(10)
v_mfma_f32_32x32x16_bf16 v[60:75], v[32:35], v[52:55], v[60:75]
ds_read_b64_tr_b16 v[28:29], v11 offset:6144
ds_read_b64_tr_b16 v[30:31], v11 offset:6656
s_barrier
v_add_u32 v10, 40960, v9
v_add_u32 v12, 36864, v3
ds_read_b128 v[52:55], v12 offset:0
s_waitcnt lgkmcnt(10)
v_mfma_f32_32x32x16_bf16 v[60:75], v[36:39], v[56:59], v[60:75]
ds_read_b64_tr_b16 v[32:33], v10 offset:0
ds_read_b64_tr_b16 v[34:35], v10 offset:512
ds_read_b128 v[56:59], v12 offset:1024
s_waitcnt lgkmcnt(10)
v_mfma_f32_32x32x16_bf16 v[60:75], v[20:23], v[40:43], v[60:75]
ds_read_b64_tr_b16 v[36:37], v10 offset:2048
ds_read_b64_tr_b16 v[38:39], v10 offset:2560
ds_read_b128 v[40:43], v12 offset:2048
s_waitcnt lgkmcnt(10)
v_mfma_f32_32x32x16_bf16 v[60:75], v[24:27], v[44:47], v[60:75]
ds_read_b64_tr_b16 v[20:21], v10 offset:4096
ds_read_b64_tr_b16 v[22:23], v10 offset:4608
ds_read_b128 v[44:47], v12 offset:3072
s_waitcnt lgkmcnt(10)
v_mfma_f32_32x32x16_bf16 v[60:75], v[28:31], v[48:51], v[60:75]
ds_read_b64_tr_b16 v[24:25], v10 offset:6144
ds_read_b64_tr_b16 v[26:27], v10 offset:6656
s_barrier
v_add_u32 v11, 57344, v9
v_add_u32 v13, 53248, v3
ds_read_b128 v[48:51], v13 offset:0
s_waitcnt lgkmcnt(10)
v_mfma_f32_32x32x16_bf16 v[60:75], v[32:35], v[52:55], v[60:75]
ds_read_b64_tr_b16 v[28:29], v11 offset:0
ds_read_b64_tr_b16 v[30:31], v11 offset:512
ds_read_b128 v[52:55], v13 offset:1024
s_waitcnt lgkmcnt(10)
v_mfma_f32_32x32x16_bf16 v[60:75], v[36:39], v[56:59], v[60:75]
ds_read_b64_tr_b16 v[32:33], v11 offset:2048
ds_read_b64_tr_b16 v[34:35], v11 offset:2560
ds_read_b128 v[56:59], v13 offset:2048
s_waitcnt lgkmcnt(10)
v_mfma_f32_32x32x16_bf16 v[60:75], v[20:23], v[40:43], v[60:75]
ds_read_b64_tr_b16 v[36:37], v11 offset:4096
ds_read_b64_tr_b16 v[38:39], v11 offset:4608
ds_read_b128 v[40:43], v13 offset:3072
s_waitcnt lgkmcnt(10)
v_mfma_f32_32x32x16_bf16 v[60:75], v[24:27], v[44:47], v[60:75]
ds_read_b64_tr_b16 v[20:21], v11 offset:6144
ds_read_b64_tr_b16 v[22:23], v11 offset:6656
s_barrier
v_add_u32 v10, 73728, v9
v_add_u32 v12, 69632, v3
ds_read_b128 v[44:47], v12 offset:0
s_waitcnt lgkmcnt(10)
v_mfma_f32_32x32x16_bf16 v[60:75], v[28:31], v[48:51], v[60:75]
ds_read_b64_tr_b16 v[24:25], v10 offset:0
ds_read_b64_tr_b16 v[26:27], v10 offset:512
ds_read_b128 v[48:51], v12 offset:1024
s_waitcnt lgkmcnt(10)
v_mfma_f32_32x32x16_bf16 v[60:75], v[32:35], v[52:55], v[60:75]
ds_read_b64_tr_b16 v[28:29], v10 offset:2048
ds_read_b64_tr_b16 v[30:31], v10 offset:2560
ds_read_b128 v[52:55], v12 offset:2048
s_waitcnt lgkmcnt(10)
v_mfma_f32_32x32x16_bf16 v[60:75], v[36:39], v[56:59], v[60:75]
ds_read_b64_tr_b16 v[32:33], v10 offset:4096
ds_read_b64_tr_b16 v[34:35], v10 offset:4608
ds_read_b128 v[56:59], v12 offset:3072
s_waitcnt lgkmcnt(10)
v_mfma_f32_32x32x16_bf16 v[60:75], v[20:23], v[40:43], v[60:75]
ds_read_b64_tr_b16 v[36:37], v10 offset:6144
ds_read_b64_tr_b16 v[38:39], v10 offset:6656
s_barrier
v_add_u32 v11, 90112, v9
v_add_u32 v13, 86016, v3
ds_read_b128 v[40:43], v13 offset:0
s_waitcnt lgkmcnt(10)
v_mfma_f32_32x32x16_bf16 v[60:75], v[24:27], v[44:47], v[60:75]
ds_read_b64_tr_b16 v[20:21], v11 offset:0
ds_read_b64_tr_b16 v[22:23], v11 offset:512
ds_read_b128 v[44:47], v13 offset:1024
s_waitcnt lgkmcnt(10)
v_mfma_f32_32x32x16_bf16 v[60:75], v[28:31], v[48:51], v[60:75]
ds_read_b64_tr_b16 v[24:25], v11 offset:2048
ds_read_b64_tr_b16 v[26:27], v11 offset:2560
ds_read_b128 v[48:51], v13 offset:2048
s_waitcnt lgkmcnt(10)
v_mfma_f32_32x32x16_bf16 v[60:75], v[32:35], v[52:55], v[60:75]
ds_read_b64_tr_b16 v[28:29], v11 offset:4096
ds_read_b64_tr_b16 v[30:31], v11 offset:4608
ds_read_b128 v[52:55], v13 offset:3072
s_waitcnt lgkmcnt(10)
v_mfma_f32_32x32x16_bf16 v[60:75], v[36:39], v[56:59], v[60:75]
ds_read_b64_tr_b16 v[32:33], v11 offset:6144
ds_read_b64_tr_b16 v[34:35], v11 offset:6656
s_barrier
v_add_u32 v10, 106496, v9
v_add_u32 v12, 102400, v3
ds_read_b128 v[56:59], v12 offset:0
s_waitcnt lgkmcnt(10)
v_mfma_f32_32x32x16_bf16 v[60:75], v[20:23], v[40:43], v[60:75]
ds_read_b64_tr_b16 v[36:37], v10 offset:0
ds_read_b64_tr_b16 v[38:39], v10 offset:512
ds_read_b128 v[40:43], v12 offset:1024
s_waitcnt lgkmcnt(10)
v_mfma_f32_32x32x16_bf16 v[60:75], v[24:27], v[44:47], v[60:75]
ds_read_b64_tr_b16 v[20:21], v10 offset:2048
ds_read_b64_tr_b16 v[22:23], v10 offset:2560
ds_read_b128 v[44:47], v12 offset:2048
s_waitcnt lgkmcnt(10)
v_mfma_f32_32x32x16_bf16 v[60:75], v[28:31], v[48:51], v[60:75]
ds_read_b64_tr_b16 v[24:25], v10 offset:4096
ds_read_b64_tr_b16 v[26:27], v10 offset:4608
ds_read_b128 v[48:51], v12 offset:3072
s_waitcnt lgkmcnt(10)
v_mfma_f32_32x32x16_bf16 v[60:75], v[32:35], v[52:55], v[60:75]
ds_read_b64_tr_b16 v[28:29], v10 offset:6144
ds_read_b64_tr_b16 v[30:31], v10 offset:6656
s_barrier
v_add_u32 v11, 122880, v9
v_add_u32 v13, 118784, v3
ds_read_b128 v[52:55], v13 offset:0
s_waitcnt lgkmcnt(10)
v_mfma_f32_32x32x16_bf16 v[60:75], v[36:39], v[56:59], v[60:75]
ds_read_b64_tr_b16 v[32:33], v11 offset:0
ds_read_b64_tr_b16 v[34:35], v11 offset:512
ds_read_b128 v[56:59], v13 offset:1024
s_waitcnt lgkmcnt(10)
v_mfma_f32_32x32x16_bf16 v[60:75], v[20:23], v[40:43], v[60:75]
ds_read_b64_tr_b16 v[36:37], v11 offset:2048
ds_read_b64_tr_b16 v[38:39], v11 offset:2560
ds_read_b128 v[40:43], v13 offset:2048
s_waitcnt lgkmcnt(10)
v_mfma_f32_32x32x16_bf16 v[60:75], v[24:27], v[44:47], v[60:75]
ds_read_b64_tr_b16 v[20:21], v11 offset:4096
ds_read_b64_tr_b16 v[22:23], v11 offset:4608
ds_read_b128 v[44:47], v13 offset:3072
s_waitcnt lgkmcnt(10)
v_mfma_f32_32x32x16_bf16 v[60:75], v[28:31], v[48:51], v[60:75]
ds_read_b64_tr_b16 v[24:25], v11 offset:6144
ds_read_b64_tr_b16 v[26:27], v11 offset:6656
s_barrier
v_add_u32 v10, 139264, v9
v_add_u32 v12, 135168, v3
ds_read_b128 v[48:51], v12 offset:0
s_waitcnt lgkmcnt(10)
v_mfma_f32_32x32x16_bf16 v[60:75], v[32:35], v[52:55], v[60:75]
ds_read_b64_tr_b16 v[28:29], v10 offset:0
ds_read_b64_tr_b16 v[30:31], v10 offset:512
ds_read_b128 v[52:55], v12 offset:1024
s_waitcnt lgkmcnt(10)
v_mfma_f32_32x32x16_bf16 v[60:75], v[36:39], v[56:59], v[60:75]
ds_read_b64_tr_b16 v[32:33], v10 offset:2048
ds_read_b64_tr_b16 v[34:35], v10 offset:2560
ds_read_b128 v[56:59], v12 offset:2048
s_waitcnt lgkmcnt(10)
v_mfma_f32_32x32x16_bf16 v[60:75], v[20:23], v[40:43], v[60:75]
ds_read_b64_tr_b16 v[36:37], v10 offset:4096
ds_read_b64_tr_b16 v[38:39], v10 offset:4608
ds_read_b128 v[40:43], v12 offset:3072
s_waitcnt lgkmcnt(10)
v_mfma_f32_32x32x16_bf16 v[60:75], v[24:27], v[44:47], v[60:75]
ds_read_b64_tr_b16 v[20:21], v10 offset:6144
ds_read_b64_tr_b16 v[22:23], v10 offset:6656
s_barrier
v_add_u32 v11, 8192, v9
v_add_u32 v13, 4096, v3
ds_read_b128 v[44:47], v13 offset:0
s_waitcnt lgkmcnt(10)
v_mfma_f32_32x32x16_bf16 v[60:75], v[28:31], v[48:51], v[60:75]
ds_read_b64_tr_b16 v[24:25], v11 offset:0
ds_read_b64_tr_b16 v[26:27], v11 offset:512
ds_read_b128 v[48:51], v13 offset:1024
s_waitcnt lgkmcnt(10)
v_mfma_f32_32x32x16_bf16 v[60:75], v[32:35], v[52:55], v[60:75]
ds_read_b64_tr_b16 v[28:29], v11 offset:2048
ds_read_b64_tr_b16 v[30:31], v11 offset:2560
ds_read_b128 v[52:55], v13 offset:2048
s_waitcnt lgkmcnt(10)
v_mfma_f32_32x32x16_bf16 v[60:75], v[36:39], v[56:59], v[60:75]
ds_read_b64_tr_b16 v[32:33], v11 offset:4096
ds_read_b64_tr_b16 v[34:35], v11 offset:4608
ds_read_b128 v[56:59], v13 offset:3072
s_waitcnt lgkmcnt(10)
v_mfma_f32_32x32x16_bf16 v[60:75], v[20:23], v[40:43], v[60:75]
ds_read_b64_tr_b16 v[36:37], v11 offset:6144
ds_read_b64_tr_b16 v[38:39], v11 offset:6656
s_barrier
v_add_u32 v10, 24576, v9
v_add_u32 v12, 20480, v3
ds_read_b128 v[40:43], v12 offset:0
s_waitcnt lgkmcnt(10)
v_mfma_f32_32x32x16_bf16 v[60:75], v[24:27], v[44:47], v[60:75]
ds_read_b64_tr_b16 v[20:21], v10 offset:0
ds_read_b64_tr_b16 v[22:23], v10 offset:512
ds_read_b128 v[44:47], v12 offset:1024
s_waitcnt lgkmcnt(10)
v_mfma_f32_32x32x16_bf16 v[60:75], v[28:31], v[48:51], v[60:75]
ds_read_b64_tr_b16 v[24:25], v10 offset:2048
ds_read_b64_tr_b16 v[26:27], v10 offset:2560
ds_read_b128 v[48:51], v12 offset:2048
s_waitcnt lgkmcnt(10)
v_mfma_f32_32x32x16_bf16 v[60:75], v[32:35], v[52:55], v[60:75]
ds_read_b64_tr_b16 v[28:29], v10 offset:4096
ds_read_b64_tr_b16 v[30:31], v10 offset:4608
ds_read_b128 v[52:55], v12 offset:3072
s_waitcnt lgkmcnt(10)
v_mfma_f32_32x32x16_bf16 v[60:75], v[36:39], v[56:59], v[60:75]
ds_read_b64_tr_b16 v[32:33], v10 offset:6144
ds_read_b64_tr_b16 v[34:35], v10 offset:6656
s_barrier
v_add_u32 v11, 40960, v9
v_add_u32 v13, 36864, v3
ds_read_b128 v[56:59], v13 offset:0
s_waitcnt lgkmcnt(10)
v_mfma_f32_32x32x16_bf16 v[60:75], v[20:23], v[40:43], v[60:75]
ds_read_b64_tr_b16 v[36:37], v11 offset:0
ds_read_b64_tr_b16 v[38:39], v11 offset:512
ds_read_b128 v[40:43], v13 offset:1024
s_waitcnt lgkmcnt(10)
v_mfma_f32_32x32x16_bf16 v[60:75], v[24:27], v[44:47], v[60:75]
ds_read_b64_tr_b16 v[20:21], v11 offset:2048
ds_read_b64_tr_b16 v[22:23], v11 offset:2560
ds_read_b128 v[44:47], v13 offset:2048
s_waitcnt lgkmcnt(10)
v_mfma_f32_32x32x16_bf16 v[60:75], v[28:31], v[48:51], v[60:75]
ds_read_b64_tr_b16 v[24:25], v11 offset:4096
ds_read_b64_tr_b16 v[26:27], v11 offset:4608
ds_read_b128 v[48:51], v13 offset:3072
s_waitcnt lgkmcnt(10)
v_mfma_f32_32x32x16_bf16 v[60:75], v[32:35], v[52:55], v[60:75]
ds_read_b64_tr_b16 v[28:29], v11 offset:6144
ds_read_b64_tr_b16 v[30:31], v11 offset:6656
s_barrier
v_add_u32 v10, 57344, v9
v_add_u32 v12, 53248, v3
ds_read_b128 v[52:55], v12 offset:0
s_waitcnt lgkmcnt(10)
v_mfma_f32_32x32x16_bf16 v[60:75], v[36:39], v[56:59], v[60:75]
ds_read_b64_tr_b16 v[32:33], v10 offset:0
ds_read_b64_tr_b16 v[34:35], v10 offset:512
ds_read_b128 v[56:59], v12 offset:1024
s_waitcnt lgkmcnt(10)
v_mfma_f32_32x32x16_bf16 v[60:75], v[20:23], v[40:43], v[60:75]
ds_read_b64_tr_b16 v[36:37], v10 offset:2048
ds_read_b64_tr_b16 v[38:39], v10 offset:2560
ds_read_b128 v[40:43], v12 offset:2048
s_waitcnt lgkmcnt(10)
v_mfma_f32_32x32x16_bf16 v[60:75], v[24:27], v[44:47], v[60:75]
ds_read_b64_tr_b16 v[20:21], v10 offset:4096
ds_read_b64_tr_b16 v[22:23], v10 offset:4608
ds_read_b128 v[44:47], v12 offset:3072
s_waitcnt lgkmcnt(10)
v_mfma_f32_32x32x16_bf16 v[60:75], v[28:31], v[48:51], v[60:75]
ds_read_b64_tr_b16 v[24:25], v10 offset:6144
ds_read_b64_tr_b16 v[26:27], v10 offset:6656
s_barrier
v_add_u32 v11, 73728, v9
v_add_u32 v13, 69632, v3
ds_read_b128 v[48:51], v13 offset:0
s_waitcnt lgkmcnt(10)
v_mfma_f32_32x32x16_bf16 v[60:75], v[32:35], v[52:55], v[60:75]
ds_read_b64_tr_b16 v[28:29], v11 offset:0
ds_read_b64_tr_b16 v[30:31], v11 offset:512
ds_read_b128 v[52:55], v13 offset:1024
s_waitcnt lgkmcnt(10)
v_mfma_f32_32x32x16_bf16 v[60:75], v[36:39], v[56:59], v[60:75]
ds_read_b64_tr_b16 v[32:33], v11 offset:2048
ds_read_b64_tr_b16 v[34:35], v11 offset:2560
ds_read_b128 v[56:59], v13 offset:2048
s_waitcnt lgkmcnt(10)
v_mfma_f32_32x32x16_bf16 v[60:75], v[20:23], v[40:43], v[60:75]
ds_read_b64_tr_b16 v[36:37], v11 offset:4096
ds_read_b64_tr_b16 v[38:39], v11 offset:4608
ds_read_b128 v[40:43], v13 offset:3072
s_waitcnt lgkmcnt(10)
v_mfma_f32_32x32x16_bf16 v[60:75], v[24:27], v[44:47], v[60:75]
ds_read_b64_tr_b16 v[20:21], v11 offset:6144
ds_read_b64_tr_b16 v[22:23], v11 offset:6656
s_barrier
v_add_u32 v10, 90112, v9
v_add_u32 v12, 86016, v3
ds_read_b128 v[44:47], v12 offset:0
s_waitcnt lgkmcnt(10)
v_mfma_f32_32x32x16_bf16 v[60:75], v[28:31], v[48:51], v[60:75]
ds_read_b64_tr_b16 v[24:25], v10 offset:0
ds_read_b64_tr_b16 v[26:27], v10 offset:512
ds_read_b128 v[48:51], v12 offset:1024
s_waitcnt lgkmcnt(10)
v_mfma_f32_32x32x16_bf16 v[60:75], v[32:35], v[52:55], v[60:75]
ds_read_b64_tr_b16 v[28:29], v10 offset:2048
ds_read_b64_tr_b16 v[30:31], v10 offset:2560
ds_read_b128 v[52:55], v12 offset:2048
s_waitcnt lgkmcnt(10)
v_mfma_f32_32x32x16_bf16 v[60:75], v[36:39], v[56:59], v[60:75]
ds_read_b64_tr_b16 v[32:33], v10 offset:4096
ds_read_b64_tr_b16 v[34:35], v10 offset:4608
ds_read_b128 v[56:59], v12 offset:3072
s_waitcnt lgkmcnt(10)
v_mfma_f32_32x32x16_bf16 v[60:75], v[20:23], v[40:43], v[60:75]
ds_read_b64_tr_b16 v[36:37], v10 offset:6144
ds_read_b64_tr_b16 v[38:39], v10 offset:6656
s_barrier
v_add_u32 v11, 106496, v9
v_add_u32 v13, 102400, v3
ds_read_b128 v[40:43], v13 offset:0
s_waitcnt lgkmcnt(10)
v_mfma_f32_32x32x16_bf16 v[60:75], v[24:27], v[44:47], v[60:75]
ds_read_b64_tr_b16 v[20:21], v11 offset:0
ds_read_b64_tr_b16 v[22:23], v11 offset:512
ds_read_b128 v[44:47], v13 offset:1024
s_waitcnt lgkmcnt(10)
v_mfma_f32_32x32x16_bf16 v[60:75], v[28:31], v[48:51], v[60:75]
ds_read_b64_tr_b16 v[24:25], v11 offset:2048
ds_read_b64_tr_b16 v[26:27], v11 offset:2560
ds_read_b128 v[48:51], v13 offset:2048
s_waitcnt lgkmcnt(10)
v_mfma_f32_32x32x16_bf16 v[60:75], v[32:35], v[52:55], v[60:75]
ds_read_b64_tr_b16 v[28:29], v11 offset:4096
ds_read_b64_tr_b16 v[30:31], v11 offset:4608
ds_read_b128 v[52:55], v13 offset:3072
s_waitcnt lgkmcnt(10)
v_mfma_f32_32x32x16_bf16 v[60:75], v[36:39], v[56:59], v[60:75]
ds_read_b64_tr_b16 v[32:33], v11 offset:6144
ds_read_b64_tr_b16 v[34:35], v11 offset:6656
s_barrier
v_add_u32 v10, 122880, v9
v_add_u32 v12, 118784, v3
ds_read_b128 v[56:59], v12 offset:0
s_waitcnt lgkmcnt(10)
v_mfma_f32_32x32x16_bf16 v[60:75], v[20:23], v[40:43], v[60:75]
ds_read_b64_tr_b16 v[36:37], v10 offset:0
ds_read_b64_tr_b16 v[38:39], v10 offset:512
ds_read_b128 v[40:43], v12 offset:1024
s_waitcnt lgkmcnt(10)
v_mfma_f32_32x32x16_bf16 v[60:75], v[24:27], v[44:47], v[60:75]
ds_read_b64_tr_b16 v[20:21], v10 offset:2048
ds_read_b64_tr_b16 v[22:23], v10 offset:2560
ds_read_b128 v[44:47], v12 offset:2048
s_waitcnt lgkmcnt(10)
v_mfma_f32_32x32x16_bf16 v[60:75], v[28:31], v[48:51], v[60:75]
ds_read_b64_tr_b16 v[24:25], v10 offset:4096
ds_read_b64_tr_b16 v[26:27], v10 offset:4608
ds_read_b128 v[48:51], v12 offset:3072
s_waitcnt lgkmcnt(10)
v_mfma_f32_32x32x16_bf16 v[60:75], v[32:35], v[52:55], v[60:75]
ds_read_b64_tr_b16 v[28:29], v10 offset:6144
ds_read_b64_tr_b16 v[30:31], v10 offset:6656
s_barrier
v_add_u32 v11, 139264, v9
v_add_u32 v13, 135168, v3
ds_read_b128 v[52:55], v13 offset:0
s_waitcnt lgkmcnt(10)
v_mfma_f32_32x32x16_bf16 v[60:75], v[36:39], v[56:59], v[60:75]
ds_read_b64_tr_b16 v[32:33], v11 offset:0
ds_read_b64_tr_b16 v[34:35], v11 offset:512
ds_read_b128 v[56:59], v13 offset:1024
s_waitcnt lgkmcnt(10)
v_mfma_f32_32x32x16_bf16 v[60:75], v[20:23], v[40:43], v[60:75]
ds_read_b64_tr_b16 v[36:37], v11 offset:2048
ds_read_b64_tr_b16 v[38:39], v11 offset:2560
ds_read_b128 v[40:43], v13 offset:2048
s_waitcnt lgkmcnt(10)
v_mfma_f32_32x32x16_bf16 v[60:75], v[24:27], v[44:47], v[60:75]
ds_read_b64_tr_b16 v[20:21], v11 offset:4096
ds_read_b64_tr_b16 v[22:23], v11 offset:4608
ds_read_b128 v[44:47], v13 offset:3072
s_waitcnt lgkmcnt(10)
v_mfma_f32_32x32x16_bf16 v[60:75], v[28:31], v[48:51], v[60:75]
ds_read_b64_tr_b16 v[24:25], v11 offset:6144
ds_read_b64_tr_b16 v[26:27], v11 offset:6656
s_barrier
v_add_u32 v10, 8192, v9
v_add_u32 v12, 4096, v3
ds_read_b128 v[48:51], v12 offset:0
s_waitcnt lgkmcnt(10)
v_mfma_f32_32x32x16_bf16 v[60:75], v[32:35], v[52:55], v[60:75]
ds_read_b64_tr_b16 v[28:29], v10 offset:0
ds_read_b64_tr_b16 v[30:31], v10 offset:512
ds_read_b128 v[52:55], v12 offset:1024
s_waitcnt lgkmcnt(10)
v_mfma_f32_32x32x16_bf16 v[60:75], v[36:39], v[56:59], v[60:75]
ds_read_b64_tr_b16 v[32:33], v10 offset:2048
ds_read_b64_tr_b16 v[34:35], v10 offset:2560
ds_read_b128 v[56:59], v12 offset:2048
s_waitcnt lgkmcnt(10)
v_mfma_f32_32x32x16_bf16 v[60:75], v[20:23], v[40:43], v[60:75]
ds_read_b64_tr_b16 v[36:37], v10 offset:4096
ds_read_b64_tr_b16 v[38:39], v10 offset:4608
ds_read_b128 v[40:43], v12 offset:3072
s_waitcnt lgkmcnt(10)
v_mfma_f32_32x32x16_bf16 v[60:75], v[24:27], v[44:47], v[60:75]
ds_read_b64_tr_b16 v[20:21], v10 offset:6144
ds_read_b64_tr_b16 v[22:23], v10 offset:6656
s_barrier
v_add_u32 v11, 24576, v9
v_add_u32 v13, 20480, v3
ds_read_b128 v[44:47], v13 offset:0
s_waitcnt lgkmcnt(10)
v_mfma_f32_32x32x16_bf16 v[60:75], v[28:31], v[48:51], v[60:75]
ds_read_b64_tr_b16 v[24:25], v11 offset:0
ds_read_b64_tr_b16 v[26:27], v11 offset:512
ds_read_b128 v[48:51], v13 offset:1024
s_waitcnt lgkmcnt(10)
v_mfma_f32_32x32x16_bf16 v[60:75], v[32:35], v[52:55], v[60:75]
ds_read_b64_tr_b16 v[28:29], v11 offset:2048
ds_read_b64_tr_b16 v[30:31], v11 offset:2560
ds_read_b128 v[52:55], v13 offset:2048
s_waitcnt lgkmcnt(10)
v_mfma_f32_32x32x16_bf16 v[60:75], v[36:39], v[56:59], v[60:75]
ds_read_b64_tr_b16 v[32:33], v11 offset:4096
ds_read_b64_tr_b16 v[34:35], v11 offset:4608
ds_read_b128 v[56:59], v13 offset:3072
s_waitcnt lgkmcnt(10)
v_mfma_f32_32x32x16_bf16 v[60:75], v[20:23], v[40:43], v[60:75]
ds_read_b64_tr_b16 v[36:37], v11 offset:6144
ds_read_b64_tr_b16 v[38:39], v11 offset:6656
s_barrier
v_add_u32 v10, 40960, v9
v_add_u32 v12, 36864, v3
ds_read_b128 v[40:43], v12 offset:0
s_waitcnt lgkmcnt(10)
v_mfma_f32_32x32x16_bf16 v[60:75], v[24:27], v[44:47], v[60:75]
ds_read_b64_tr_b16 v[20:21], v10 offset:0
ds_read_b64_tr_b16 v[22:23], v10 offset:512
ds_read_b128 v[44:47], v12 offset:1024
s_waitcnt lgkmcnt(10)
v_mfma_f32_32x32x16_bf16 v[60:75], v[28:31], v[48:51], v[60:75]
ds_read_b64_tr_b16 v[24:25], v10 offset:2048
ds_read_b64_tr_b16 v[26:27], v10 offset:2560
ds_read_b128 v[48:51], v12 offset:2048
s_waitcnt lgkmcnt(10)
v_mfma_f32_32x32x16_bf16 v[60:75], v[32:35], v[52:55], v[60:75]
ds_read_b64_tr_b16 v[28:29], v10 offset:4096
ds_read_b64_tr_b16 v[30:31], v10 offset:4608
ds_read_b128 v[52:55], v12 offset:3072
s_waitcnt lgkmcnt(10)
v_mfma_f32_32x32x16_bf16 v[60:75], v[36:39], v[56:59], v[60:75]
ds_read_b64_tr_b16 v[32:33], v10 offset:6144
ds_read_b64_tr_b16 v[34:35], v10 offset:6656
s_barrier
v_add_u32 v11, 57344, v9
v_add_u32 v13, 53248, v3
ds_read_b128 v[56:59], v13 offset:0
s_waitcnt lgkmcnt(10)
v_mfma_f32_32x32x16_bf16 v[60:75], v[20:23], v[40:43], v[60:75]
ds_read_b64_tr_b16 v[36:37], v11 offset:0
ds_read_b64_tr_b16 v[38:39], v11 offset:512
ds_read_b128 v[40:43], v13 offset:1024
s_waitcnt lgkmcnt(10)
v_mfma_f32_32x32x16_bf16 v[60:75], v[24:27], v[44:47], v[60:75]
ds_read_b64_tr_b16 v[20:21], v11 offset:2048
ds_read_b64_tr_b16 v[22:23], v11 offset:2560
ds_read_b128 v[44:47], v13 offset:2048
s_waitcnt lgkmcnt(10)
v_mfma_f32_32x32x16_bf16 v[60:75], v[28:31], v[48:51], v[60:75]
ds_read_b64_tr_b16 v[24:25], v11 offset:4096
ds_read_b64_tr_b16 v[26:27], v11 offset:4608
ds_read_b128 v[48:51], v13 offset:3072
s_waitcnt lgkmcnt(10)
v_mfma_f32_32x32x16_bf16 v[60:75], v[32:35], v[52:55], v[60:75]
ds_read_b64_tr_b16 v[28:29], v11 offset:6144
ds_read_b64_tr_b16 v[30:31], v11 offset:6656
s_barrier
v_add_u32 v10, 73728, v9
v_add_u32 v12, 69632, v3
ds_read_b128 v[52:55], v12 offset:0
s_waitcnt lgkmcnt(10)
v_mfma_f32_32x32x16_bf16 v[60:75], v[36:39], v[56:59], v[60:75]
ds_read_b64_tr_b16 v[32:33], v10 offset:0
ds_read_b64_tr_b16 v[34:35], v10 offset:512
ds_read_b128 v[56:59], v12 offset:1024
s_waitcnt lgkmcnt(10)
v_mfma_f32_32x32x16_bf16 v[60:75], v[20:23], v[40:43], v[60:75]
ds_read_b64_tr_b16 v[36:37], v10 offset:2048
ds_read_b64_tr_b16 v[38:39], v10 offset:2560
ds_read_b128 v[40:43], v12 offset:2048
s_waitcnt lgkmcnt(10)
v_mfma_f32_32x32x16_bf16 v[60:75], v[24:27], v[44:47], v[60:75]
ds_read_b64_tr_b16 v[20:21], v10 offset:4096
ds_read_b64_tr_b16 v[22:23], v10 offset:4608
ds_read_b128 v[44:47], v12 offset:3072
s_waitcnt lgkmcnt(10)
v_mfma_f32_32x32x16_bf16 v[60:75], v[28:31], v[48:51], v[60:75]
ds_read_b64_tr_b16 v[24:25], v10 offset:6144
ds_read_b64_tr_b16 v[26:27], v10 offset:6656
s_barrier
v_add_u32 v11, 90112, v9
v_add_u32 v13, 86016, v3
ds_read_b128 v[48:51], v13 offset:0
s_waitcnt lgkmcnt(10)
v_mfma_f32_32x32x16_bf16 v[60:75], v[32:35], v[52:55], v[60:75]
ds_read_b64_tr_b16 v[28:29], v11 offset:0
ds_read_b64_tr_b16 v[30:31], v11 offset:512
ds_read_b128 v[52:55], v13 offset:1024
s_waitcnt lgkmcnt(10)
v_mfma_f32_32x32x16_bf16 v[60:75], v[36:39], v[56:59], v[60:75]
ds_read_b64_tr_b16 v[32:33], v11 offset:2048
ds_read_b64_tr_b16 v[34:35], v11 offset:2560
ds_read_b128 v[56:59], v13 offset:2048
s_waitcnt lgkmcnt(10)
v_mfma_f32_32x32x16_bf16 v[60:75], v[20:23], v[40:43], v[60:75]
ds_read_b64_tr_b16 v[36:37], v11 offset:4096
ds_read_b64_tr_b16 v[38:39], v11 offset:4608
ds_read_b128 v[40:43], v13 offset:3072
s_waitcnt lgkmcnt(10)
v_mfma_f32_32x32x16_bf16 v[60:75], v[24:27], v[44:47], v[60:75]
ds_read_b64_tr_b16 v[20:21], v11 offset:6144
ds_read_b64_tr_b16 v[22:23], v11 offset:6656
s_barrier
v_add_u32 v10, 106496, v9
v_add_u32 v12, 102400, v3
ds_read_b128 v[44:47], v12 offset:0
s_waitcnt lgkmcnt(10)
v_mfma_f32_32x32x16_bf16 v[60:75], v[28:31], v[48:51], v[60:75]
ds_read_b64_tr_b16 v[24:25], v10 offset:0
ds_read_b64_tr_b16 v[26:27], v10 offset:512
ds_read_b128 v[48:51], v12 offset:1024
s_waitcnt lgkmcnt(10)
v_mfma_f32_32x32x16_bf16 v[60:75], v[32:35], v[52:55], v[60:75]
ds_read_b64_tr_b16 v[28:29], v10 offset:2048
ds_read_b64_tr_b16 v[30:31], v10 offset:2560
ds_read_b128 v[52:55], v12 offset:2048
s_waitcnt lgkmcnt(10)
v_mfma_f32_32x32x16_bf16 v[60:75], v[36:39], v[56:59], v[60:75]
ds_read_b64_tr_b16 v[32:33], v10 offset:4096
ds_read_b64_tr_b16 v[34:35], v10 offset:4608
ds_read_b128 v[56:59], v12 offset:3072
s_waitcnt lgkmcnt(10)
v_mfma_f32_32x32x16_bf16 v[60:75], v[20:23], v[40:43], v[60:75]
ds_read_b64_tr_b16 v[36:37], v10 offset:6144
ds_read_b64_tr_b16 v[38:39], v10 offset:6656
s_barrier
v_add_u32 v11, 122880, v9
v_add_u32 v13, 118784, v3
ds_read_b128 v[40:43], v13 offset:0
s_waitcnt lgkmcnt(10)
v_mfma_f32_32x32x16_bf16 v[60:75], v[24:27], v[44:47], v[60:75]
ds_read_b64_tr_b16 v[20:21], v11 offset:0
ds_read_b64_tr_b16 v[22:23], v11 offset:512
ds_read_b128 v[44:47], v13 offset:1024
s_waitcnt lgkmcnt(10)
v_mfma_f32_32x32x16_bf16 v[60:75], v[28:31], v[48:51], v[60:75]
ds_read_b64_tr_b16 v[24:25], v11 offset:2048
ds_read_b64_tr_b16 v[26:27], v11 offset:2560
ds_read_b128 v[48:51], v13 offset:2048
s_waitcnt lgkmcnt(10)
v_mfma_f32_32x32x16_bf16 v[60:75], v[32:35], v[52:55], v[60:75]
ds_read_b64_tr_b16 v[28:29], v11 offset:4096
ds_read_b64_tr_b16 v[30:31], v11 offset:4608
ds_read_b128 v[52:55], v13 offset:3072
s_waitcnt lgkmcnt(10)
v_mfma_f32_32x32x16_bf16 v[60:75], v[36:39], v[56:59], v[60:75]
ds_read_b64_tr_b16 v[32:33], v11 offset:6144
ds_read_b64_tr_b16 v[34:35], v11 offset:6656
s_barrier
v_add_u32 v10, 139264, v9
v_add_u32 v12, 135168, v3
ds_read_b128 v[56:59], v12 offset:0
s_waitcnt lgkmcnt(10)
v_mfma_f32_32x32x16_bf16 v[60:75], v[20:23], v[40:43], v[60:75]
ds_read_b64_tr_b16 v[36:37], v10 offset:0
ds_read_b64_tr_b16 v[38:39], v10 offset:512
ds_read_b128 v[40:43], v12 offset:1024
s_waitcnt lgkmcnt(10)
v_mfma_f32_32x32x16_bf16 v[60:75], v[24:27], v[44:47], v[60:75]
ds_read_b64_tr_b16 v[20:21], v10 offset:2048
ds_read_b64_tr_b16 v[22:23], v10 offset:2560
ds_read_b128 v[44:47], v12 offset:2048
s_waitcnt lgkmcnt(10)
v_mfma_f32_32x32x16_bf16 v[60:75], v[28:31], v[48:51], v[60:75]
ds_read_b64_tr_b16 v[24:25], v10 offset:4096
ds_read_b64_tr_b16 v[26:27], v10 offset:4608
ds_read_b128 v[48:51], v12 offset:3072
s_waitcnt lgkmcnt(10)
v_mfma_f32_32x32x16_bf16 v[60:75], v[32:35], v[52:55], v[60:75]
ds_read_b64_tr_b16 v[28:29], v10 offset:6144
ds_read_b64_tr_b16 v[30:31], v10 offset:6656
s_barrier
v_add_u32 v11, 8192, v9
v_add_u32 v13, 4096, v3
ds_read_b128 v[52:55], v13 offset:0
s_waitcnt lgkmcnt(10)
v_mfma_f32_32x32x16_bf16 v[60:75], v[36:39], v[56:59], v[60:75]
ds_read_b64_tr_b16 v[32:33], v11 offset:0
ds_read_b64_tr_b16 v[34:35], v11 offset:512
ds_read_b128 v[56:59], v13 offset:1024
s_waitcnt lgkmcnt(10)
v_mfma_f32_32x32x16_bf16 v[60:75], v[20:23], v[40:43], v[60:75]
ds_read_b64_tr_b16 v[36:37], v11 offset:2048
ds_read_b64_tr_b16 v[38:39], v11 offset:2560
ds_read_b128 v[40:43], v13 offset:2048
s_waitcnt lgkmcnt(10)
v_mfma_f32_32x32x16_bf16 v[60:75], v[24:27], v[44:47], v[60:75]
ds_read_b64_tr_b16 v[20:21], v11 offset:4096
ds_read_b64_tr_b16 v[22:23], v11 offset:4608
ds_read_b128 v[44:47], v13 offset:3072
s_waitcnt lgkmcnt(10)
v_mfma_f32_32x32x16_bf16 v[60:75], v[28:31], v[48:51], v[60:75]
ds_read_b64_tr_b16 v[24:25], v11 offset:6144
ds_read_b64_tr_b16 v[26:27], v11 offset:6656
s_waitcnt lgkmcnt(9)
v_mfma_f32_32x32x16_bf16 v[60:75], v[32:35], v[52:55], v[60:75]
s_waitcnt lgkmcnt(6)
v_mfma_f32_32x32x16_bf16 v[60:75], v[36:39], v[56:59], v[60:75]
s_waitcnt lgkmcnt(3)
v_mfma_f32_32x32x16_bf16 v[60:75], v[20:23], v[40:43], v[60:75]
s_waitcnt lgkmcnt(0)
v_mfma_f32_32x32x16_bf16 v[60:75], v[24:27], v[44:47], v[60:75]
s_nop 11
v_cvt_pk_bf16_f32 v76, v60, v61
v_cvt_pk_bf16_f32 v77, v62, v63
v_cvt_pk_bf16_f32 v78, v64, v65
v_cvt_pk_bf16_f32 v79, v66, v67
v_cvt_pk_bf16_f32 v80, v68, v69
v_cvt_pk_bf16_f32 v81, v70, v71
v_cvt_pk_bf16_f32 v82, v72, v73
v_cvt_pk_bf16_f32 v83, v74, v75
v_lshlrev_b32 v60, 16, v76
v_and_b32 v61, 0xffff0000, v76
v_lshlrev_b32 v62, 16, v77
v_and_b32 v63, 0xffff0000, v77
v_lshlrev_b32 v64, 16, v78
v_and_b32 v65, 0xffff0000, v78
v_lshlrev_b32 v66, 16, v79
v_and_b32 v67, 0xffff0000, v79
v_lshlrev_b32 v68, 16, v80
v_and_b32 v69, 0xffff0000, v80
v_lshlrev_b32 v70, 16, v81
v_and_b32 v71, 0xffff0000, v81
v_lshlrev_b32 v72, 16, v82
v_and_b32 v73, 0xffff0000, v82
v_lshlrev_b32 v74, 16, v83
v_and_b32 v75, 0xffff0000, v83
s_waitcnt vmcnt(3)
v_lshlrev_b32 v84, 16, v88
v_and_b32 v85, 0xffff0000, v88
v_add_f32 v60, v60, v84
v_add_f32 v61, v61, v85
v_lshlrev_b32 v84, 16, v89
v_and_b32 v85, 0xffff0000, v89
v_add_f32 v62, v62, v84
v_add_f32 v63, v63, v85
s_waitcnt vmcnt(2)
v_lshlrev_b32 v84, 16, v90
v_and_b32 v85, 0xffff0000, v90
v_add_f32 v64, v64, v84
v_add_f32 v65, v65, v85
v_lshlrev_b32 v84, 16, v91
v_and_b32 v85, 0xffff0000, v91
v_add_f32 v66, v66, v84
v_add_f32 v67, v67, v85
s_waitcnt vmcnt(1)
v_lshlrev_b32 v84, 16, v92
v_and_b32 v85, 0xffff0000, v92
v_add_f32 v68, v68, v84
v_add_f32 v69, v69, v85
v_lshlrev_b32 v84, 16, v93
v_and_b32 v85, 0xffff0000, v93
v_add_f32 v70, v70, v84
v_add_f32 v71, v71, v85
s_waitcnt vmcnt(0)
v_lshlrev_b32 v84, 16, v94
v_and_b32 v85, 0xffff0000, v94
v_add_f32 v72, v72, v84
v_add_f32 v73, v73, v85
v_lshlrev_b32 v84, 16, v95
v_and_b32 v85, 0xffff0000, v95
v_add_f32 v74, v74, v84
v_add_f32 v75, v75, v85
v_cvt_pk_bf16_f32 v76, v60, v61
v_cvt_pk_bf16_f32 v77, v62, v63
v_cvt_pk_bf16_f32 v78, v64, v65
v_cvt_pk_bf16_f32 v79, v66, v67
v_cvt_pk_bf16_f32 v80, v68, v69
v_cvt_pk_bf16_f32 v81, v70, v71
v_cvt_pk_bf16_f32 v82, v72, v73
v_cvt_pk_bf16_f32 v83, v74, v75
v_permlane32_swap_b32 v76, v78
v_permlane32_swap_b32 v77, v79
v_permlane32_swap_b32 v80, v82
v_permlane32_swap_b32 v81, v83
buffer_store_dwordx4 v[76:79], v86, s[52:55], s9 offen
buffer_store_dwordx4 v[80:83], v86, s[52:55], s9 offen offset:32
s_waitcnt vmcnt(0)
s_branch k5_kernel_end
k5_kernel_w4:
v_add_u32 v9, 0, v1
v_lshrrev_b32 v10, 3, v9
v_and_b32 v11, 7, v9
v_bfe_u32 v12, v9, 4, 1
v_lshlrev_b32 v12, 2, v12
v_xor_b32 v11, v11, v12
v_lshlrev_b32 v11, 4, v11
s_mov_b32 s7, 1024
v_mul_lo_u32 v10, v10, s7
v_add_u32 v15, v10, v11
v_add_u32 v9, 64, v1
v_lshrrev_b32 v10, 3, v9
v_and_b32 v11, 7, v9
v_bfe_u32 v12, v9, 4, 1
v_lshlrev_b32 v12, 2, v12
v_xor_b32 v11, v11, v12
v_lshlrev_b32 v11, 4, v11
s_mov_b32 s7, 1024
v_mul_lo_u32 v10, v10, s7
v_add_u32 v16, v10, v11
s_mov_b32 m0, 0
s_mov_b32 s60, 0
buffer_load_dwordx4 v3, s[40:43], s60 offen lds
s_mov_b32 m0, 1024
s_mov_b32 s60, 1024
buffer_load_dwordx4 v3, s[40:43], s60 offen lds
s_mov_b32 m0, 8192
s_mov_b32 s60, 0
buffer_load_dwordx4 v15, s[44:47], s60 offen lds
s_mov_b32 m0, 9216
s_mov_b32 s60, 0
buffer_load_dwordx4 v16, s[44:47], s60 offen lds
s_mov_b32 m0, 16384
s_mov_b32 s60, 4096
buffer_load_dwordx4 v3, s[40:43], s60 offen lds
s_mov_b32 m0, 17408
s_mov_b32 s60, 5120
buffer_load_dwordx4 v3, s[40:43], s60 offen lds
s_mov_b32 m0, 24576
s_mov_b32 s60, 65536
buffer_load_dwordx4 v15, s[44:47], s60 offen lds
s_mov_b32 m0, 25600
s_mov_b32 s60, 65536
buffer_load_dwordx4 v16, s[44:47], s60 offen lds
s_mov_b32 m0, 32768
s_mov_b32 s60, 8192
buffer_load_dwordx4 v3, s[40:43], s60 offen lds
s_mov_b32 m0, 33792
s_mov_b32 s60, 9216
buffer_load_dwordx4 v3, s[40:43], s60 offen lds
s_mov_b32 m0, 40960
s_mov_b32 s60, 131072
buffer_load_dwordx4 v15, s[44:47], s60 offen lds
s_mov_b32 m0, 41984
s_mov_b32 s60, 131072
buffer_load_dwordx4 v16, s[44:47], s60 offen lds
s_mov_b32 m0, 49152
s_mov_b32 s60, 12288
buffer_load_dwordx4 v3, s[40:43], s60 offen lds
s_mov_b32 m0, 50176
s_mov_b32 s60, 13312
buffer_load_dwordx4 v3, s[40:43], s60 offen lds
s_mov_b32 m0, 57344
s_mov_b32 s60, 196608
buffer_load_dwordx4 v15, s[44:47], s60 offen lds
s_mov_b32 m0, 58368
s_mov_b32 s60, 196608
buffer_load_dwordx4 v16, s[44:47], s60 offen lds
s_mov_b32 m0, 65536
s_mov_b32 s60, 16384
buffer_load_dwordx4 v3, s[40:43], s60 offen lds
s_mov_b32 m0, 66560
s_mov_b32 s60, 17408
buffer_load_dwordx4 v3, s[40:43], s60 offen lds
s_mov_b32 m0, 73728
s_mov_b32 s60, 262144
buffer_load_dwordx4 v15, s[44:47], s60 offen lds
s_mov_b32 m0, 74752
s_mov_b32 s60, 262144
buffer_load_dwordx4 v16, s[44:47], s60 offen lds
s_mov_b32 m0, 81920
s_mov_b32 s60, 20480
buffer_load_dwordx4 v3, s[40:43], s60 offen lds
s_mov_b32 m0, 82944
s_mov_b32 s60, 21504
buffer_load_dwordx4 v3, s[40:43], s60 offen lds
s_mov_b32 m0, 90112
s_mov_b32 s60, 327680
buffer_load_dwordx4 v15, s[44:47], s60 offen lds
s_mov_b32 m0, 91136
s_mov_b32 s60, 327680
buffer_load_dwordx4 v16, s[44:47], s60 offen lds
s_waitcnt vmcnt(20)
s_barrier
s_mov_b32 m0, 98304
s_mov_b32 s60, 24576
buffer_load_dwordx4 v3, s[40:43], s60 offen lds
s_mov_b32 m0, 99328
s_mov_b32 s60, 25600
buffer_load_dwordx4 v3, s[40:43], s60 offen lds
s_mov_b32 m0, 106496
s_mov_b32 s60, 393216
buffer_load_dwordx4 v15, s[44:47], s60 offen lds
s_mov_b32 m0, 107520
s_mov_b32 s60, 393216
buffer_load_dwordx4 v16, s[44:47], s60 offen lds
s_mov_b32 m0, 114688
s_mov_b32 s60, 28672
buffer_load_dwordx4 v3, s[40:43], s60 offen lds
s_mov_b32 m0, 115712
s_mov_b32 s60, 29696
buffer_load_dwordx4 v3, s[40:43], s60 offen lds
s_mov_b32 m0, 122880
s_mov_b32 s60, 458752
buffer_load_dwordx4 v15, s[44:47], s60 offen lds
s_mov_b32 m0, 123904
s_mov_b32 s60, 458752
buffer_load_dwordx4 v16, s[44:47], s60 offen lds
s_waitcnt vmcnt(24)
s_barrier
s_mov_b32 m0, 131072
s_mov_b32 s60, 32768
buffer_load_dwordx4 v3, s[40:43], s60 offen lds
s_mov_b32 m0, 132096
s_mov_b32 s60, 33792
buffer_load_dwordx4 v3, s[40:43], s60 offen lds
s_mov_b32 m0, 139264
s_mov_b32 s60, 524288
buffer_load_dwordx4 v15, s[44:47], s60 offen lds
s_mov_b32 m0, 140288
s_mov_b32 s60, 524288
buffer_load_dwordx4 v16, s[44:47], s60 offen lds
s_waitcnt vmcnt(24)
s_barrier
s_mov_b32 m0, 0
s_mov_b32 s60, 36864
buffer_load_dwordx4 v3, s[40:43], s60 offen lds
s_mov_b32 m0, 1024
s_mov_b32 s60, 37888
buffer_load_dwordx4 v3, s[40:43], s60 offen lds
s_mov_b32 m0, 8192
s_mov_b32 s60, 589824
buffer_load_dwordx4 v15, s[44:47], s60 offen lds
s_mov_b32 m0, 9216
s_mov_b32 s60, 589824
buffer_load_dwordx4 v16, s[44:47], s60 offen lds
s_waitcnt vmcnt(24)
s_barrier
s_mov_b32 m0, 16384
s_mov_b32 s60, 40960
buffer_load_dwordx4 v3, s[40:43], s60 offen lds
s_mov_b32 m0, 17408
s_mov_b32 s60, 41984
buffer_load_dwordx4 v3, s[40:43], s60 offen lds
s_mov_b32 m0, 24576
s_mov_b32 s60, 655360
buffer_load_dwordx4 v15, s[44:47], s60 offen lds
s_mov_b32 m0, 25600
s_mov_b32 s60, 655360
buffer_load_dwordx4 v16, s[44:47], s60 offen lds
s_waitcnt vmcnt(24)
s_barrier
s_mov_b32 m0, 32768
s_mov_b32 s60, 45056
buffer_load_dwordx4 v3, s[40:43], s60 offen lds
s_mov_b32 m0, 33792
s_mov_b32 s60, 46080
buffer_load_dwordx4 v3, s[40:43], s60 offen lds
s_mov_b32 m0, 40960
s_mov_b32 s60, 720896
buffer_load_dwordx4 v15, s[44:47], s60 offen lds
s_mov_b32 m0, 41984
s_mov_b32 s60, 720896
buffer_load_dwordx4 v16, s[44:47], s60 offen lds
s_waitcnt vmcnt(24)
s_barrier
s_mov_b32 m0, 49152
s_mov_b32 s60, 49152
buffer_load_dwordx4 v3, s[40:43], s60 offen lds
s_mov_b32 m0, 50176
s_mov_b32 s60, 50176
buffer_load_dwordx4 v3, s[40:43], s60 offen lds
s_mov_b32 m0, 57344
s_mov_b32 s60, 786432
buffer_load_dwordx4 v15, s[44:47], s60 offen lds
s_mov_b32 m0, 58368
s_mov_b32 s60, 786432
buffer_load_dwordx4 v16, s[44:47], s60 offen lds
s_waitcnt vmcnt(24)
s_barrier
s_mov_b32 m0, 65536
s_mov_b32 s60, 53248
buffer_load_dwordx4 v3, s[40:43], s60 offen lds
s_mov_b32 m0, 66560
s_mov_b32 s60, 54272
buffer_load_dwordx4 v3, s[40:43], s60 offen lds
s_mov_b32 m0, 73728
s_mov_b32 s60, 851968
buffer_load_dwordx4 v15, s[44:47], s60 offen lds
s_mov_b32 m0, 74752
s_mov_b32 s60, 851968
buffer_load_dwordx4 v16, s[44:47], s60 offen lds
s_waitcnt vmcnt(24)
s_barrier
s_mov_b32 m0, 81920
s_mov_b32 s60, 57344
buffer_load_dwordx4 v3, s[40:43], s60 offen lds
s_mov_b32 m0, 82944
s_mov_b32 s60, 58368
buffer_load_dwordx4 v3, s[40:43], s60 offen lds
s_mov_b32 m0, 90112
s_mov_b32 s60, 917504
buffer_load_dwordx4 v15, s[44:47], s60 offen lds
s_mov_b32 m0, 91136
s_mov_b32 s60, 917504
buffer_load_dwordx4 v16, s[44:47], s60 offen lds
s_waitcnt vmcnt(24)
s_barrier
s_mov_b32 m0, 98304
s_mov_b32 s60, 61440
buffer_load_dwordx4 v3, s[40:43], s60 offen lds
s_mov_b32 m0, 99328
s_mov_b32 s60, 62464
buffer_load_dwordx4 v3, s[40:43], s60 offen lds
s_mov_b32 m0, 106496
s_mov_b32 s60, 983040
buffer_load_dwordx4 v15, s[44:47], s60 offen lds
s_mov_b32 m0, 107520
s_mov_b32 s60, 983040
buffer_load_dwordx4 v16, s[44:47], s60 offen lds
s_waitcnt vmcnt(24)
s_barrier
s_mov_b32 m0, 114688
s_mov_b32 s60, 65536
buffer_load_dwordx4 v3, s[40:43], s60 offen lds
s_mov_b32 m0, 115712
s_mov_b32 s60, 66560
buffer_load_dwordx4 v3, s[40:43], s60 offen lds
s_mov_b32 m0, 122880
s_mov_b32 s60, 1048576
buffer_load_dwordx4 v15, s[44:47], s60 offen lds
s_mov_b32 m0, 123904
s_mov_b32 s60, 1048576
buffer_load_dwordx4 v16, s[44:47], s60 offen lds
s_waitcnt vmcnt(24)
s_barrier
s_mov_b32 m0, 131072
s_mov_b32 s60, 69632
buffer_load_dwordx4 v3, s[40:43], s60 offen lds
s_mov_b32 m0, 132096
s_mov_b32 s60, 70656
buffer_load_dwordx4 v3, s[40:43], s60 offen lds
s_mov_b32 m0, 139264
s_mov_b32 s60, 1114112
buffer_load_dwordx4 v15, s[44:47], s60 offen lds
s_mov_b32 m0, 140288
s_mov_b32 s60, 1114112
buffer_load_dwordx4 v16, s[44:47], s60 offen lds
s_waitcnt vmcnt(24)
s_barrier
s_mov_b32 m0, 0
s_mov_b32 s60, 73728
buffer_load_dwordx4 v3, s[40:43], s60 offen lds
s_mov_b32 m0, 1024
s_mov_b32 s60, 74752
buffer_load_dwordx4 v3, s[40:43], s60 offen lds
s_mov_b32 m0, 8192
s_mov_b32 s60, 1179648
buffer_load_dwordx4 v15, s[44:47], s60 offen lds
s_mov_b32 m0, 9216
s_mov_b32 s60, 1179648
buffer_load_dwordx4 v16, s[44:47], s60 offen lds
s_waitcnt vmcnt(24)
s_barrier
s_mov_b32 m0, 16384
s_mov_b32 s60, 77824
buffer_load_dwordx4 v3, s[40:43], s60 offen lds
s_mov_b32 m0, 17408
s_mov_b32 s60, 78848
buffer_load_dwordx4 v3, s[40:43], s60 offen lds
s_mov_b32 m0, 24576
s_mov_b32 s60, 1245184
buffer_load_dwordx4 v15, s[44:47], s60 offen lds
s_mov_b32 m0, 25600
s_mov_b32 s60, 1245184
buffer_load_dwordx4 v16, s[44:47], s60 offen lds
s_waitcnt vmcnt(24)
s_barrier
s_mov_b32 m0, 32768
s_mov_b32 s60, 81920
buffer_load_dwordx4 v3, s[40:43], s60 offen lds
s_mov_b32 m0, 33792
s_mov_b32 s60, 82944
buffer_load_dwordx4 v3, s[40:43], s60 offen lds
s_mov_b32 m0, 40960
s_mov_b32 s60, 1310720
buffer_load_dwordx4 v15, s[44:47], s60 offen lds
s_mov_b32 m0, 41984
s_mov_b32 s60, 1310720
buffer_load_dwordx4 v16, s[44:47], s60 offen lds
s_waitcnt vmcnt(24)
s_barrier
s_mov_b32 m0, 49152
s_mov_b32 s60, 86016
buffer_load_dwordx4 v3, s[40:43], s60 offen lds
s_mov_b32 m0, 50176
s_mov_b32 s60, 87040
buffer_load_dwordx4 v3, s[40:43], s60 offen lds
s_mov_b32 m0, 57344
s_mov_b32 s60, 1376256
buffer_load_dwordx4 v15, s[44:47], s60 offen lds
s_mov_b32 m0, 58368
s_mov_b32 s60, 1376256
buffer_load_dwordx4 v16, s[44:47], s60 offen lds
s_waitcnt vmcnt(24)
s_barrier
s_mov_b32 m0, 65536
s_mov_b32 s60, 90112
buffer_load_dwordx4 v3, s[40:43], s60 offen lds
s_mov_b32 m0, 66560
s_mov_b32 s60, 91136
buffer_load_dwordx4 v3, s[40:43], s60 offen lds
s_mov_b32 m0, 73728
s_mov_b32 s60, 1441792
buffer_load_dwordx4 v15, s[44:47], s60 offen lds
s_mov_b32 m0, 74752
s_mov_b32 s60, 1441792
buffer_load_dwordx4 v16, s[44:47], s60 offen lds
s_waitcnt vmcnt(24)
s_barrier
s_mov_b32 m0, 81920
s_mov_b32 s60, 94208
buffer_load_dwordx4 v3, s[40:43], s60 offen lds
s_mov_b32 m0, 82944
s_mov_b32 s60, 95232
buffer_load_dwordx4 v3, s[40:43], s60 offen lds
s_mov_b32 m0, 90112
s_mov_b32 s60, 1507328
buffer_load_dwordx4 v15, s[44:47], s60 offen lds
s_mov_b32 m0, 91136
s_mov_b32 s60, 1507328
buffer_load_dwordx4 v16, s[44:47], s60 offen lds
s_waitcnt vmcnt(24)
s_barrier
s_mov_b32 m0, 98304
s_mov_b32 s60, 98304
buffer_load_dwordx4 v3, s[40:43], s60 offen lds
s_mov_b32 m0, 99328
s_mov_b32 s60, 99328
buffer_load_dwordx4 v3, s[40:43], s60 offen lds
s_mov_b32 m0, 106496
s_mov_b32 s60, 1572864
buffer_load_dwordx4 v15, s[44:47], s60 offen lds
s_mov_b32 m0, 107520
s_mov_b32 s60, 1572864
buffer_load_dwordx4 v16, s[44:47], s60 offen lds
s_waitcnt vmcnt(24)
s_barrier
s_mov_b32 m0, 114688
s_mov_b32 s60, 102400
buffer_load_dwordx4 v3, s[40:43], s60 offen lds
s_mov_b32 m0, 115712
s_mov_b32 s60, 103424
buffer_load_dwordx4 v3, s[40:43], s60 offen lds
s_mov_b32 m0, 122880
s_mov_b32 s60, 1638400
buffer_load_dwordx4 v15, s[44:47], s60 offen lds
s_mov_b32 m0, 123904
s_mov_b32 s60, 1638400
buffer_load_dwordx4 v16, s[44:47], s60 offen lds
s_waitcnt vmcnt(24)
s_barrier
s_mov_b32 m0, 131072
s_mov_b32 s60, 106496
buffer_load_dwordx4 v3, s[40:43], s60 offen lds
s_mov_b32 m0, 132096
s_mov_b32 s60, 107520
buffer_load_dwordx4 v3, s[40:43], s60 offen lds
s_mov_b32 m0, 139264
s_mov_b32 s60, 1703936
buffer_load_dwordx4 v15, s[44:47], s60 offen lds
s_mov_b32 m0, 140288
s_mov_b32 s60, 1703936
buffer_load_dwordx4 v16, s[44:47], s60 offen lds
s_waitcnt vmcnt(24)
s_barrier
s_mov_b32 m0, 0
s_mov_b32 s60, 110592
buffer_load_dwordx4 v3, s[40:43], s60 offen lds
s_mov_b32 m0, 1024
s_mov_b32 s60, 111616
buffer_load_dwordx4 v3, s[40:43], s60 offen lds
s_mov_b32 m0, 8192
s_mov_b32 s60, 1769472
buffer_load_dwordx4 v15, s[44:47], s60 offen lds
s_mov_b32 m0, 9216
s_mov_b32 s60, 1769472
buffer_load_dwordx4 v16, s[44:47], s60 offen lds
s_waitcnt vmcnt(24)
s_barrier
s_waitcnt vmcnt(20)
s_barrier
s_waitcnt vmcnt(16)
s_barrier
s_waitcnt vmcnt(12)
s_barrier
s_waitcnt vmcnt(8)
s_barrier
s_waitcnt vmcnt(4)
s_barrier
s_waitcnt vmcnt(0)
s_barrier
s_branch k5_kernel_end
k5_kernel_w5:
v_add_u32 v9, 128, v1
v_lshrrev_b32 v10, 3, v9
v_and_b32 v11, 7, v9
v_bfe_u32 v12, v9, 4, 1
v_lshlrev_b32 v12, 2, v12
v_xor_b32 v11, v11, v12
v_lshlrev_b32 v11, 4, v11
s_mov_b32 s7, 1024
v_mul_lo_u32 v10, v10, s7
v_add_u32 v15, v10, v11
v_add_u32 v9, 192, v1
v_lshrrev_b32 v10, 3, v9
v_and_b32 v11, 7, v9
v_bfe_u32 v12, v9, 4, 1
v_lshlrev_b32 v12, 2, v12
v_xor_b32 v11, v11, v12
v_lshlrev_b32 v11, 4, v11
s_mov_b32 s7, 1024
v_mul_lo_u32 v10, v10, s7
v_add_u32 v16, v10, v11
s_mov_b32 m0, 2048
s_mov_b32 s60, 2048
buffer_load_dwordx4 v3, s[40:43], s60 offen lds
s_mov_b32 m0, 3072
s_mov_b32 s60, 3072
buffer_load_dwordx4 v3, s[40:43], s60 offen lds
s_mov_b32 m0, 10240
s_mov_b32 s60, 0
buffer_load_dwordx4 v15, s[44:47], s60 offen lds
s_mov_b32 m0, 11264
s_mov_b32 s60, 0
buffer_load_dwordx4 v16, s[44:47], s60 offen lds
s_mov_b32 m0, 18432
s_mov_b32 s60, 6144
buffer_load_dwordx4 v3, s[40:43], s60 offen lds
s_mov_b32 m0, 19456
s_mov_b32 s60, 7168
buffer_load_dwordx4 v3, s[40:43], s60 offen lds
s_mov_b32 m0, 26624
s_mov_b32 s60, 65536
buffer_load_dwordx4 v15, s[44:47], s60 offen lds
s_mov_b32 m0, 27648
s_mov_b32 s60, 65536
buffer_load_dwordx4 v16, s[44:47], s60 offen lds
s_mov_b32 m0, 34816
s_mov_b32 s60, 10240
buffer_load_dwordx4 v3, s[40:43], s60 offen lds
s_mov_b32 m0, 35840
s_mov_b32 s60, 11264
buffer_load_dwordx4 v3, s[40:43], s60 offen lds
s_mov_b32 m0, 43008
s_mov_b32 s60, 131072
buffer_load_dwordx4 v15, s[44:47], s60 offen lds
s_mov_b32 m0, 44032
s_mov_b32 s60, 131072
buffer_load_dwordx4 v16, s[44:47], s60 offen lds
s_mov_b32 m0, 51200
s_mov_b32 s60, 14336
buffer_load_dwordx4 v3, s[40:43], s60 offen lds
s_mov_b32 m0, 52224
s_mov_b32 s60, 15360
buffer_load_dwordx4 v3, s[40:43], s60 offen lds
s_mov_b32 m0, 59392
s_mov_b32 s60, 196608
buffer_load_dwordx4 v15, s[44:47], s60 offen lds
s_mov_b32 m0, 60416
s_mov_b32 s60, 196608
buffer_load_dwordx4 v16, s[44:47], s60 offen lds
s_mov_b32 m0, 67584
s_mov_b32 s60, 18432
buffer_load_dwordx4 v3, s[40:43], s60 offen lds
s_mov_b32 m0, 68608
s_mov_b32 s60, 19456
buffer_load_dwordx4 v3, s[40:43], s60 offen lds
s_mov_b32 m0, 75776
s_mov_b32 s60, 262144
buffer_load_dwordx4 v15, s[44:47], s60 offen lds
s_mov_b32 m0, 76800
s_mov_b32 s60, 262144
buffer_load_dwordx4 v16, s[44:47], s60 offen lds
s_mov_b32 m0, 83968
s_mov_b32 s60, 22528
buffer_load_dwordx4 v3, s[40:43], s60 offen lds
s_mov_b32 m0, 84992
s_mov_b32 s60, 23552
buffer_load_dwordx4 v3, s[40:43], s60 offen lds
s_mov_b32 m0, 92160
s_mov_b32 s60, 327680
buffer_load_dwordx4 v15, s[44:47], s60 offen lds
s_mov_b32 m0, 93184
s_mov_b32 s60, 327680
buffer_load_dwordx4 v16, s[44:47], s60 offen lds
s_waitcnt vmcnt(20)
s_barrier
s_mov_b32 m0, 100352
s_mov_b32 s60, 26624
buffer_load_dwordx4 v3, s[40:43], s60 offen lds
s_mov_b32 m0, 101376
s_mov_b32 s60, 27648
buffer_load_dwordx4 v3, s[40:43], s60 offen lds
s_mov_b32 m0, 108544
s_mov_b32 s60, 393216
buffer_load_dwordx4 v15, s[44:47], s60 offen lds
s_mov_b32 m0, 109568
s_mov_b32 s60, 393216
buffer_load_dwordx4 v16, s[44:47], s60 offen lds
s_mov_b32 m0, 116736
s_mov_b32 s60, 30720
buffer_load_dwordx4 v3, s[40:43], s60 offen lds
s_mov_b32 m0, 117760
s_mov_b32 s60, 31744
buffer_load_dwordx4 v3, s[40:43], s60 offen lds
s_mov_b32 m0, 124928
s_mov_b32 s60, 458752
buffer_load_dwordx4 v15, s[44:47], s60 offen lds
s_mov_b32 m0, 125952
s_mov_b32 s60, 458752
buffer_load_dwordx4 v16, s[44:47], s60 offen lds
s_waitcnt vmcnt(24)
s_barrier
s_mov_b32 m0, 133120
s_mov_b32 s60, 34816
buffer_load_dwordx4 v3, s[40:43], s60 offen lds
s_mov_b32 m0, 134144
s_mov_b32 s60, 35840
buffer_load_dwordx4 v3, s[40:43], s60 offen lds
s_mov_b32 m0, 141312
s_mov_b32 s60, 524288
buffer_load_dwordx4 v15, s[44:47], s60 offen lds
s_mov_b32 m0, 142336
s_mov_b32 s60, 524288
buffer_load_dwordx4 v16, s[44:47], s60 offen lds
s_waitcnt vmcnt(24)
s_barrier
s_mov_b32 m0, 2048
s_mov_b32 s60, 38912
buffer_load_dwordx4 v3, s[40:43], s60 offen lds
s_mov_b32 m0, 3072
s_mov_b32 s60, 39936
buffer_load_dwordx4 v3, s[40:43], s60 offen lds
s_mov_b32 m0, 10240
s_mov_b32 s60, 589824
buffer_load_dwordx4 v15, s[44:47], s60 offen lds
s_mov_b32 m0, 11264
s_mov_b32 s60, 589824
buffer_load_dwordx4 v16, s[44:47], s60 offen lds
s_waitcnt vmcnt(24)
s_barrier
s_mov_b32 m0, 18432
s_mov_b32 s60, 43008
buffer_load_dwordx4 v3, s[40:43], s60 offen lds
s_mov_b32 m0, 19456
s_mov_b32 s60, 44032
buffer_load_dwordx4 v3, s[40:43], s60 offen lds
s_mov_b32 m0, 26624
s_mov_b32 s60, 655360
buffer_load_dwordx4 v15, s[44:47], s60 offen lds
s_mov_b32 m0, 27648
s_mov_b32 s60, 655360
buffer_load_dwordx4 v16, s[44:47], s60 offen lds
s_waitcnt vmcnt(24)
s_barrier
s_mov_b32 m0, 34816
s_mov_b32 s60, 47104
buffer_load_dwordx4 v3, s[40:43], s60 offen lds
s_mov_b32 m0, 35840
s_mov_b32 s60, 48128
buffer_load_dwordx4 v3, s[40:43], s60 offen lds
s_mov_b32 m0, 43008
s_mov_b32 s60, 720896
buffer_load_dwordx4 v15, s[44:47], s60 offen lds
s_mov_b32 m0, 44032
s_mov_b32 s60, 720896
buffer_load_dwordx4 v16, s[44:47], s60 offen lds
s_waitcnt vmcnt(24)
s_barrier
s_mov_b32 m0, 51200
s_mov_b32 s60, 51200
buffer_load_dwordx4 v3, s[40:43], s60 offen lds
s_mov_b32 m0, 52224
s_mov_b32 s60, 52224
buffer_load_dwordx4 v3, s[40:43], s60 offen lds
s_mov_b32 m0, 59392
s_mov_b32 s60, 786432
buffer_load_dwordx4 v15, s[44:47], s60 offen lds
s_mov_b32 m0, 60416
s_mov_b32 s60, 786432
buffer_load_dwordx4 v16, s[44:47], s60 offen lds
s_waitcnt vmcnt(24)
s_barrier
s_mov_b32 m0, 67584
s_mov_b32 s60, 55296
buffer_load_dwordx4 v3, s[40:43], s60 offen lds
s_mov_b32 m0, 68608
s_mov_b32 s60, 56320
buffer_load_dwordx4 v3, s[40:43], s60 offen lds
s_mov_b32 m0, 75776
s_mov_b32 s60, 851968
buffer_load_dwordx4 v15, s[44:47], s60 offen lds
s_mov_b32 m0, 76800
s_mov_b32 s60, 851968
buffer_load_dwordx4 v16, s[44:47], s60 offen lds
s_waitcnt vmcnt(24)
s_barrier
s_mov_b32 m0, 83968
s_mov_b32 s60, 59392
buffer_load_dwordx4 v3, s[40:43], s60 offen lds
s_mov_b32 m0, 84992
s_mov_b32 s60, 60416
buffer_load_dwordx4 v3, s[40:43], s60 offen lds
s_mov_b32 m0, 92160
s_mov_b32 s60, 917504
buffer_load_dwordx4 v15, s[44:47], s60 offen lds
s_mov_b32 m0, 93184
s_mov_b32 s60, 917504
buffer_load_dwordx4 v16, s[44:47], s60 offen lds
s_waitcnt vmcnt(24)
s_barrier
s_mov_b32 m0, 100352
s_mov_b32 s60, 63488
buffer_load_dwordx4 v3, s[40:43], s60 offen lds
s_mov_b32 m0, 101376
s_mov_b32 s60, 64512
buffer_load_dwordx4 v3, s[40:43], s60 offen lds
s_mov_b32 m0, 108544
s_mov_b32 s60, 983040
buffer_load_dwordx4 v15, s[44:47], s60 offen lds
s_mov_b32 m0, 109568
s_mov_b32 s60, 983040
buffer_load_dwordx4 v16, s[44:47], s60 offen lds
s_waitcnt vmcnt(24)
s_barrier
s_mov_b32 m0, 116736
s_mov_b32 s60, 67584
buffer_load_dwordx4 v3, s[40:43], s60 offen lds
s_mov_b32 m0, 117760
s_mov_b32 s60, 68608
buffer_load_dwordx4 v3, s[40:43], s60 offen lds
s_mov_b32 m0, 124928
s_mov_b32 s60, 1048576
buffer_load_dwordx4 v15, s[44:47], s60 offen lds
s_mov_b32 m0, 125952
s_mov_b32 s60, 1048576
buffer_load_dwordx4 v16, s[44:47], s60 offen lds
s_waitcnt vmcnt(24)
s_barrier
s_mov_b32 m0, 133120
s_mov_b32 s60, 71680
buffer_load_dwordx4 v3, s[40:43], s60 offen lds
s_mov_b32 m0, 134144
s_mov_b32 s60, 72704
buffer_load_dwordx4 v3, s[40:43], s60 offen lds
s_mov_b32 m0, 141312
s_mov_b32 s60, 1114112
buffer_load_dwordx4 v15, s[44:47], s60 offen lds
s_mov_b32 m0, 142336
s_mov_b32 s60, 1114112
buffer_load_dwordx4 v16, s[44:47], s60 offen lds
s_waitcnt vmcnt(24)
s_barrier
s_mov_b32 m0, 2048
s_mov_b32 s60, 75776
buffer_load_dwordx4 v3, s[40:43], s60 offen lds
s_mov_b32 m0, 3072
s_mov_b32 s60, 76800
buffer_load_dwordx4 v3, s[40:43], s60 offen lds
s_mov_b32 m0, 10240
s_mov_b32 s60, 1179648
buffer_load_dwordx4 v15, s[44:47], s60 offen lds
s_mov_b32 m0, 11264
s_mov_b32 s60, 1179648
buffer_load_dwordx4 v16, s[44:47], s60 offen lds
s_waitcnt vmcnt(24)
s_barrier
s_mov_b32 m0, 18432
s_mov_b32 s60, 79872
buffer_load_dwordx4 v3, s[40:43], s60 offen lds
s_mov_b32 m0, 19456
s_mov_b32 s60, 80896
buffer_load_dwordx4 v3, s[40:43], s60 offen lds
s_mov_b32 m0, 26624
s_mov_b32 s60, 1245184
buffer_load_dwordx4 v15, s[44:47], s60 offen lds
s_mov_b32 m0, 27648
s_mov_b32 s60, 1245184
buffer_load_dwordx4 v16, s[44:47], s60 offen lds
s_waitcnt vmcnt(24)
s_barrier
s_mov_b32 m0, 34816
s_mov_b32 s60, 83968
buffer_load_dwordx4 v3, s[40:43], s60 offen lds
s_mov_b32 m0, 35840
s_mov_b32 s60, 84992
buffer_load_dwordx4 v3, s[40:43], s60 offen lds
s_mov_b32 m0, 43008
s_mov_b32 s60, 1310720
buffer_load_dwordx4 v15, s[44:47], s60 offen lds
s_mov_b32 m0, 44032
s_mov_b32 s60, 1310720
buffer_load_dwordx4 v16, s[44:47], s60 offen lds
s_waitcnt vmcnt(24)
s_barrier
s_mov_b32 m0, 51200
s_mov_b32 s60, 88064
buffer_load_dwordx4 v3, s[40:43], s60 offen lds
s_mov_b32 m0, 52224
s_mov_b32 s60, 89088
buffer_load_dwordx4 v3, s[40:43], s60 offen lds
s_mov_b32 m0, 59392
s_mov_b32 s60, 1376256
buffer_load_dwordx4 v15, s[44:47], s60 offen lds
s_mov_b32 m0, 60416
s_mov_b32 s60, 1376256
buffer_load_dwordx4 v16, s[44:47], s60 offen lds
s_waitcnt vmcnt(24)
s_barrier
s_mov_b32 m0, 67584
s_mov_b32 s60, 92160
buffer_load_dwordx4 v3, s[40:43], s60 offen lds
s_mov_b32 m0, 68608
s_mov_b32 s60, 93184
buffer_load_dwordx4 v3, s[40:43], s60 offen lds
s_mov_b32 m0, 75776
s_mov_b32 s60, 1441792
buffer_load_dwordx4 v15, s[44:47], s60 offen lds
s_mov_b32 m0, 76800
s_mov_b32 s60, 1441792
buffer_load_dwordx4 v16, s[44:47], s60 offen lds
s_waitcnt vmcnt(24)
s_barrier
s_mov_b32 m0, 83968
s_mov_b32 s60, 96256
buffer_load_dwordx4 v3, s[40:43], s60 offen lds
s_mov_b32 m0, 84992
s_mov_b32 s60, 97280
buffer_load_dwordx4 v3, s[40:43], s60 offen lds
s_mov_b32 m0, 92160
s_mov_b32 s60, 1507328
buffer_load_dwordx4 v15, s[44:47], s60 offen lds
s_mov_b32 m0, 93184
s_mov_b32 s60, 1507328
buffer_load_dwordx4 v16, s[44:47], s60 offen lds
s_waitcnt vmcnt(24)
s_barrier
s_mov_b32 m0, 100352
s_mov_b32 s60, 100352
buffer_load_dwordx4 v3, s[40:43], s60 offen lds
s_mov_b32 m0, 101376
s_mov_b32 s60, 101376
buffer_load_dwordx4 v3, s[40:43], s60 offen lds
s_mov_b32 m0, 108544
s_mov_b32 s60, 1572864
buffer_load_dwordx4 v15, s[44:47], s60 offen lds
s_mov_b32 m0, 109568
s_mov_b32 s60, 1572864
buffer_load_dwordx4 v16, s[44:47], s60 offen lds
s_waitcnt vmcnt(24)
s_barrier
s_mov_b32 m0, 116736
s_mov_b32 s60, 104448
buffer_load_dwordx4 v3, s[40:43], s60 offen lds
s_mov_b32 m0, 117760
s_mov_b32 s60, 105472
buffer_load_dwordx4 v3, s[40:43], s60 offen lds
s_mov_b32 m0, 124928
s_mov_b32 s60, 1638400
buffer_load_dwordx4 v15, s[44:47], s60 offen lds
s_mov_b32 m0, 125952
s_mov_b32 s60, 1638400
buffer_load_dwordx4 v16, s[44:47], s60 offen lds
s_waitcnt vmcnt(24)
s_barrier
s_mov_b32 m0, 133120
s_mov_b32 s60, 108544
buffer_load_dwordx4 v3, s[40:43], s60 offen lds
s_mov_b32 m0, 134144
s_mov_b32 s60, 109568
buffer_load_dwordx4 v3, s[40:43], s60 offen lds
s_mov_b32 m0, 141312
s_mov_b32 s60, 1703936
buffer_load_dwordx4 v15, s[44:47], s60 offen lds
s_mov_b32 m0, 142336
s_mov_b32 s60, 1703936
buffer_load_dwordx4 v16, s[44:47], s60 offen lds
s_waitcnt vmcnt(24)
s_barrier
s_mov_b32 m0, 2048
s_mov_b32 s60, 112640
buffer_load_dwordx4 v3, s[40:43], s60 offen lds
s_mov_b32 m0, 3072
s_mov_b32 s60, 113664
buffer_load_dwordx4 v3, s[40:43], s60 offen lds
s_mov_b32 m0, 10240
s_mov_b32 s60, 1769472
buffer_load_dwordx4 v15, s[44:47], s60 offen lds
s_mov_b32 m0, 11264
s_mov_b32 s60, 1769472
buffer_load_dwordx4 v16, s[44:47], s60 offen lds
s_waitcnt vmcnt(24)
s_barrier
s_waitcnt vmcnt(20)
s_barrier
s_waitcnt vmcnt(16)
s_barrier
s_waitcnt vmcnt(12)
s_barrier
s_waitcnt vmcnt(8)
s_barrier
s_waitcnt vmcnt(4)
s_barrier
s_waitcnt vmcnt(0)
s_barrier
s_branch k5_kernel_end
k5_kernel_w6:
v_add_u32 v9, 256, v1
v_lshrrev_b32 v10, 3, v9
v_and_b32 v11, 7, v9
v_bfe_u32 v12, v9, 4, 1
v_lshlrev_b32 v12, 2, v12
v_xor_b32 v11, v11, v12
v_lshlrev_b32 v11, 4, v11
s_mov_b32 s7, 1024
v_mul_lo_u32 v10, v10, s7
v_add_u32 v15, v10, v11
v_add_u32 v9, 320, v1
v_lshrrev_b32 v10, 3, v9
v_and_b32 v11, 7, v9
v_bfe_u32 v12, v9, 4, 1
v_lshlrev_b32 v12, 2, v12
v_xor_b32 v11, v11, v12
v_lshlrev_b32 v11, 4, v11
s_mov_b32 s7, 1024
v_mul_lo_u32 v10, v10, s7
v_add_u32 v16, v10, v11
s_mov_b32 m0, 4096
s_mov_b32 s60, 114688
buffer_load_dwordx4 v3, s[40:43], s60 offen lds
s_mov_b32 m0, 5120
s_mov_b32 s60, 115712
buffer_load_dwordx4 v3, s[40:43], s60 offen lds
s_mov_b32 m0, 12288
s_mov_b32 s60, 0
buffer_load_dwordx4 v15, s[44:47], s60 offen lds
s_mov_b32 m0, 13312
s_mov_b32 s60, 0
buffer_load_dwordx4 v16, s[44:47], s60 offen lds
s_mov_b32 m0, 20480
s_mov_b32 s60, 118784
buffer_load_dwordx4 v3, s[40:43], s60 offen lds
s_mov_b32 m0, 21504
s_mov_b32 s60, 119808
buffer_load_dwordx4 v3, s[40:43], s60 offen lds
s_mov_b32 m0, 28672
s_mov_b32 s60, 65536
buffer_load_dwordx4 v15, s[44:47], s60 offen lds
s_mov_b32 m0, 29696
s_mov_b32 s60, 65536
buffer_load_dwordx4 v16, s[44:47], s60 offen lds
s_mov_b32 m0, 36864
s_mov_b32 s60, 122880
buffer_load_dwordx4 v3, s[40:43], s60 offen lds
s_mov_b32 m0, 37888
s_mov_b32 s60, 123904
buffer_load_dwordx4 v3, s[40:43], s60 offen lds
s_mov_b32 m0, 45056
s_mov_b32 s60, 131072
buffer_load_dwordx4 v15, s[44:47], s60 offen lds
s_mov_b32 m0, 46080
s_mov_b32 s60, 131072
buffer_load_dwordx4 v16, s[44:47], s60 offen lds
s_mov_b32 m0, 53248
s_mov_b32 s60, 126976
buffer_load_dwordx4 v3, s[40:43], s60 offen lds
s_mov_b32 m0, 54272
s_mov_b32 s60, 128000
buffer_load_dwordx4 v3, s[40:43], s60 offen lds
s_mov_b32 m0, 61440
s_mov_b32 s60, 196608
buffer_load_dwordx4 v15, s[44:47], s60 offen lds
s_mov_b32 m0, 62464
s_mov_b32 s60, 196608
buffer_load_dwordx4 v16, s[44:47], s60 offen lds
s_mov_b32 m0, 69632
s_mov_b32 s60, 131072
buffer_load_dwordx4 v3, s[40:43], s60 offen lds
s_mov_b32 m0, 70656
s_mov_b32 s60, 132096
buffer_load_dwordx4 v3, s[40:43], s60 offen lds
s_mov_b32 m0, 77824
s_mov_b32 s60, 262144
buffer_load_dwordx4 v15, s[44:47], s60 offen lds
s_mov_b32 m0, 78848
s_mov_b32 s60, 262144
buffer_load_dwordx4 v16, s[44:47], s60 offen lds
s_mov_b32 m0, 86016
s_mov_b32 s60, 135168
buffer_load_dwordx4 v3, s[40:43], s60 offen lds
s_mov_b32 m0, 87040
s_mov_b32 s60, 136192
buffer_load_dwordx4 v3, s[40:43], s60 offen lds
s_mov_b32 m0, 94208
s_mov_b32 s60, 327680
buffer_load_dwordx4 v15, s[44:47], s60 offen lds
s_mov_b32 m0, 95232
s_mov_b32 s60, 327680
buffer_load_dwordx4 v16, s[44:47], s60 offen lds
s_waitcnt vmcnt(20)
s_barrier
s_mov_b32 m0, 102400
s_mov_b32 s60, 139264
buffer_load_dwordx4 v3, s[40:43], s60 offen lds
s_mov_b32 m0, 103424
s_mov_b32 s60, 140288
buffer_load_dwordx4 v3, s[40:43], s60 offen lds
s_mov_b32 m0, 110592
s_mov_b32 s60, 393216
buffer_load_dwordx4 v15, s[44:47], s60 offen lds
s_mov_b32 m0, 111616
s_mov_b32 s60, 393216
buffer_load_dwordx4 v16, s[44:47], s60 offen lds
s_mov_b32 m0, 118784
s_mov_b32 s60, 143360
buffer_load_dwordx4 v3, s[40:43], s60 offen lds
s_mov_b32 m0, 119808
s_mov_b32 s60, 144384
buffer_load_dwordx4 v3, s[40:43], s60 offen lds
s_mov_b32 m0, 126976
s_mov_b32 s60, 458752
buffer_load_dwordx4 v15, s[44:47], s60 offen lds
s_mov_b32 m0, 128000
s_mov_b32 s60, 458752
buffer_load_dwordx4 v16, s[44:47], s60 offen lds
s_waitcnt vmcnt(24)
s_barrier
s_mov_b32 m0, 135168
s_mov_b32 s60, 147456
buffer_load_dwordx4 v3, s[40:43], s60 offen lds
s_mov_b32 m0, 136192
s_mov_b32 s60, 148480
buffer_load_dwordx4 v3, s[40:43], s60 offen lds
s_mov_b32 m0, 143360
s_mov_b32 s60, 524288
buffer_load_dwordx4 v15, s[44:47], s60 offen lds
s_mov_b32 m0, 144384
s_mov_b32 s60, 524288
buffer_load_dwordx4 v16, s[44:47], s60 offen lds
s_waitcnt vmcnt(24)
s_barrier
s_mov_b32 m0, 4096
s_mov_b32 s60, 151552
buffer_load_dwordx4 v3, s[40:43], s60 offen lds
s_mov_b32 m0, 5120
s_mov_b32 s60, 152576
buffer_load_dwordx4 v3, s[40:43], s60 offen lds
s_mov_b32 m0, 12288
s_mov_b32 s60, 589824
buffer_load_dwordx4 v15, s[44:47], s60 offen lds
s_mov_b32 m0, 13312
s_mov_b32 s60, 589824
buffer_load_dwordx4 v16, s[44:47], s60 offen lds
s_waitcnt vmcnt(24)
s_barrier
s_mov_b32 m0, 20480
s_mov_b32 s60, 155648
buffer_load_dwordx4 v3, s[40:43], s60 offen lds
s_mov_b32 m0, 21504
s_mov_b32 s60, 156672
buffer_load_dwordx4 v3, s[40:43], s60 offen lds
s_mov_b32 m0, 28672
s_mov_b32 s60, 655360
buffer_load_dwordx4 v15, s[44:47], s60 offen lds
s_mov_b32 m0, 29696
s_mov_b32 s60, 655360
buffer_load_dwordx4 v16, s[44:47], s60 offen lds
s_waitcnt vmcnt(24)
s_barrier
s_mov_b32 m0, 36864
s_mov_b32 s60, 159744
buffer_load_dwordx4 v3, s[40:43], s60 offen lds
s_mov_b32 m0, 37888
s_mov_b32 s60, 160768
buffer_load_dwordx4 v3, s[40:43], s60 offen lds
s_mov_b32 m0, 45056
s_mov_b32 s60, 720896
buffer_load_dwordx4 v15, s[44:47], s60 offen lds
s_mov_b32 m0, 46080
s_mov_b32 s60, 720896
buffer_load_dwordx4 v16, s[44:47], s60 offen lds
s_waitcnt vmcnt(24)
s_barrier
s_mov_b32 m0, 53248
s_mov_b32 s60, 163840
buffer_load_dwordx4 v3, s[40:43], s60 offen lds
s_mov_b32 m0, 54272
s_mov_b32 s60, 164864
buffer_load_dwordx4 v3, s[40:43], s60 offen lds
s_mov_b32 m0, 61440
s_mov_b32 s60, 786432
buffer_load_dwordx4 v15, s[44:47], s60 offen lds
s_mov_b32 m0, 62464
s_mov_b32 s60, 786432
buffer_load_dwordx4 v16, s[44:47], s60 offen lds
s_waitcnt vmcnt(24)
s_barrier
s_mov_b32 m0, 69632
s_mov_b32 s60, 167936
buffer_load_dwordx4 v3, s[40:43], s60 offen lds
s_mov_b32 m0, 70656
s_mov_b32 s60, 168960
buffer_load_dwordx4 v3, s[40:43], s60 offen lds
s_mov_b32 m0, 77824
s_mov_b32 s60, 851968
buffer_load_dwordx4 v15, s[44:47], s60 offen lds
s_mov_b32 m0, 78848
s_mov_b32 s60, 851968
buffer_load_dwordx4 v16, s[44:47], s60 offen lds
s_waitcnt vmcnt(24)
s_barrier
s_mov_b32 m0, 86016
s_mov_b32 s60, 172032
buffer_load_dwordx4 v3, s[40:43], s60 offen lds
s_mov_b32 m0, 87040
s_mov_b32 s60, 173056
buffer_load_dwordx4 v3, s[40:43], s60 offen lds
s_mov_b32 m0, 94208
s_mov_b32 s60, 917504
buffer_load_dwordx4 v15, s[44:47], s60 offen lds
s_mov_b32 m0, 95232
s_mov_b32 s60, 917504
buffer_load_dwordx4 v16, s[44:47], s60 offen lds
s_waitcnt vmcnt(24)
s_barrier
s_mov_b32 m0, 102400
s_mov_b32 s60, 176128
buffer_load_dwordx4 v3, s[40:43], s60 offen lds
s_mov_b32 m0, 103424
s_mov_b32 s60, 177152
buffer_load_dwordx4 v3, s[40:43], s60 offen lds
s_mov_b32 m0, 110592
s_mov_b32 s60, 983040
buffer_load_dwordx4 v15, s[44:47], s60 offen lds
s_mov_b32 m0, 111616
s_mov_b32 s60, 983040
buffer_load_dwordx4 v16, s[44:47], s60 offen lds
s_waitcnt vmcnt(24)
s_barrier
s_mov_b32 m0, 118784
s_mov_b32 s60, 180224
buffer_load_dwordx4 v3, s[40:43], s60 offen lds
s_mov_b32 m0, 119808
s_mov_b32 s60, 181248
buffer_load_dwordx4 v3, s[40:43], s60 offen lds
s_mov_b32 m0, 126976
s_mov_b32 s60, 1048576
buffer_load_dwordx4 v15, s[44:47], s60 offen lds
s_mov_b32 m0, 128000
s_mov_b32 s60, 1048576
buffer_load_dwordx4 v16, s[44:47], s60 offen lds
s_waitcnt vmcnt(24)
s_barrier
s_mov_b32 m0, 135168
s_mov_b32 s60, 184320
buffer_load_dwordx4 v3, s[40:43], s60 offen lds
s_mov_b32 m0, 136192
s_mov_b32 s60, 185344
buffer_load_dwordx4 v3, s[40:43], s60 offen lds
s_mov_b32 m0, 143360
s_mov_b32 s60, 1114112
buffer_load_dwordx4 v15, s[44:47], s60 offen lds
s_mov_b32 m0, 144384
s_mov_b32 s60, 1114112
buffer_load_dwordx4 v16, s[44:47], s60 offen lds
s_waitcnt vmcnt(24)
s_barrier
s_mov_b32 m0, 4096
s_mov_b32 s60, 188416
buffer_load_dwordx4 v3, s[40:43], s60 offen lds
s_mov_b32 m0, 5120
s_mov_b32 s60, 189440
buffer_load_dwordx4 v3, s[40:43], s60 offen lds
s_mov_b32 m0, 12288
s_mov_b32 s60, 1179648
buffer_load_dwordx4 v15, s[44:47], s60 offen lds
s_mov_b32 m0, 13312
s_mov_b32 s60, 1179648
buffer_load_dwordx4 v16, s[44:47], s60 offen lds
s_waitcnt vmcnt(24)
s_barrier
s_mov_b32 m0, 20480
s_mov_b32 s60, 192512
buffer_load_dwordx4 v3, s[40:43], s60 offen lds
s_mov_b32 m0, 21504
s_mov_b32 s60, 193536
buffer_load_dwordx4 v3, s[40:43], s60 offen lds
s_mov_b32 m0, 28672
s_mov_b32 s60, 1245184
buffer_load_dwordx4 v15, s[44:47], s60 offen lds
s_mov_b32 m0, 29696
s_mov_b32 s60, 1245184
buffer_load_dwordx4 v16, s[44:47], s60 offen lds
s_waitcnt vmcnt(24)
s_barrier
s_mov_b32 m0, 36864
s_mov_b32 s60, 196608
buffer_load_dwordx4 v3, s[40:43], s60 offen lds
s_mov_b32 m0, 37888
s_mov_b32 s60, 197632
buffer_load_dwordx4 v3, s[40:43], s60 offen lds
s_mov_b32 m0, 45056
s_mov_b32 s60, 1310720
buffer_load_dwordx4 v15, s[44:47], s60 offen lds
s_mov_b32 m0, 46080
s_mov_b32 s60, 1310720
buffer_load_dwordx4 v16, s[44:47], s60 offen lds
s_waitcnt vmcnt(24)
s_barrier
s_mov_b32 m0, 53248
s_mov_b32 s60, 200704
buffer_load_dwordx4 v3, s[40:43], s60 offen lds
s_mov_b32 m0, 54272
s_mov_b32 s60, 201728
buffer_load_dwordx4 v3, s[40:43], s60 offen lds
s_mov_b32 m0, 61440
s_mov_b32 s60, 1376256
buffer_load_dwordx4 v15, s[44:47], s60 offen lds
s_mov_b32 m0, 62464
s_mov_b32 s60, 1376256
buffer_load_dwordx4 v16, s[44:47], s60 offen lds
s_waitcnt vmcnt(24)
s_barrier
s_mov_b32 m0, 69632
s_mov_b32 s60, 204800
buffer_load_dwordx4 v3, s[40:43], s60 offen lds
s_mov_b32 m0, 70656
s_mov_b32 s60, 205824
buffer_load_dwordx4 v3, s[40:43], s60 offen lds
s_mov_b32 m0, 77824
s_mov_b32 s60, 1441792
buffer_load_dwordx4 v15, s[44:47], s60 offen lds
s_mov_b32 m0, 78848
s_mov_b32 s60, 1441792
buffer_load_dwordx4 v16, s[44:47], s60 offen lds
s_waitcnt vmcnt(24)
s_barrier
s_mov_b32 m0, 86016
s_mov_b32 s60, 208896
buffer_load_dwordx4 v3, s[40:43], s60 offen lds
s_mov_b32 m0, 87040
s_mov_b32 s60, 209920
buffer_load_dwordx4 v3, s[40:43], s60 offen lds
s_mov_b32 m0, 94208
s_mov_b32 s60, 1507328
buffer_load_dwordx4 v15, s[44:47], s60 offen lds
s_mov_b32 m0, 95232
s_mov_b32 s60, 1507328
buffer_load_dwordx4 v16, s[44:47], s60 offen lds
s_waitcnt vmcnt(24)
s_barrier
s_mov_b32 m0, 102400
s_mov_b32 s60, 212992
buffer_load_dwordx4 v3, s[40:43], s60 offen lds
s_mov_b32 m0, 103424
s_mov_b32 s60, 214016
buffer_load_dwordx4 v3, s[40:43], s60 offen lds
s_mov_b32 m0, 110592
s_mov_b32 s60, 1572864
buffer_load_dwordx4 v15, s[44:47], s60 offen lds
s_mov_b32 m0, 111616
s_mov_b32 s60, 1572864
buffer_load_dwordx4 v16, s[44:47], s60 offen lds
s_waitcnt vmcnt(24)
s_barrier
s_mov_b32 m0, 118784
s_mov_b32 s60, 217088
buffer_load_dwordx4 v3, s[40:43], s60 offen lds
s_mov_b32 m0, 119808
s_mov_b32 s60, 218112
buffer_load_dwordx4 v3, s[40:43], s60 offen lds
s_mov_b32 m0, 126976
s_mov_b32 s60, 1638400
buffer_load_dwordx4 v15, s[44:47], s60 offen lds
s_mov_b32 m0, 128000
s_mov_b32 s60, 1638400
buffer_load_dwordx4 v16, s[44:47], s60 offen lds
s_waitcnt vmcnt(24)
s_barrier
s_mov_b32 m0, 135168
s_mov_b32 s60, 221184
buffer_load_dwordx4 v3, s[40:43], s60 offen lds
s_mov_b32 m0, 136192
s_mov_b32 s60, 222208
buffer_load_dwordx4 v3, s[40:43], s60 offen lds
s_mov_b32 m0, 143360
s_mov_b32 s60, 1703936
buffer_load_dwordx4 v15, s[44:47], s60 offen lds
s_mov_b32 m0, 144384
s_mov_b32 s60, 1703936
buffer_load_dwordx4 v16, s[44:47], s60 offen lds
s_waitcnt vmcnt(24)
s_barrier
s_mov_b32 m0, 4096
s_mov_b32 s60, 225280
buffer_load_dwordx4 v3, s[40:43], s60 offen lds
s_mov_b32 m0, 5120
s_mov_b32 s60, 226304
buffer_load_dwordx4 v3, s[40:43], s60 offen lds
s_mov_b32 m0, 12288
s_mov_b32 s60, 1769472
buffer_load_dwordx4 v15, s[44:47], s60 offen lds
s_mov_b32 m0, 13312
s_mov_b32 s60, 1769472
buffer_load_dwordx4 v16, s[44:47], s60 offen lds
s_waitcnt vmcnt(24)
s_barrier
s_waitcnt vmcnt(20)
s_barrier
s_waitcnt vmcnt(16)
s_barrier
s_waitcnt vmcnt(12)
s_barrier
s_waitcnt vmcnt(8)
s_barrier
s_waitcnt vmcnt(4)
s_barrier
s_waitcnt vmcnt(0)
s_barrier
s_branch k5_kernel_end
k5_kernel_w7:
v_add_u32 v9, 384, v1
v_lshrrev_b32 v10, 3, v9
v_and_b32 v11, 7, v9
v_bfe_u32 v12, v9, 4, 1
v_lshlrev_b32 v12, 2, v12
v_xor_b32 v11, v11, v12
v_lshlrev_b32 v11, 4, v11
s_mov_b32 s7, 1024
v_mul_lo_u32 v10, v10, s7
v_add_u32 v15, v10, v11
v_add_u32 v9, 448, v1
v_lshrrev_b32 v10, 3, v9
v_and_b32 v11, 7, v9
v_bfe_u32 v12, v9, 4, 1
v_lshlrev_b32 v12, 2, v12
v_xor_b32 v11, v11, v12
v_lshlrev_b32 v11, 4, v11
s_mov_b32 s7, 1024
v_mul_lo_u32 v10, v10, s7
v_add_u32 v16, v10, v11
s_mov_b32 m0, 6144
s_mov_b32 s60, 116736
buffer_load_dwordx4 v3, s[40:43], s60 offen lds
s_mov_b32 m0, 7168
s_mov_b32 s60, 117760
buffer_load_dwordx4 v3, s[40:43], s60 offen lds
s_mov_b32 m0, 14336
s_mov_b32 s60, 0
buffer_load_dwordx4 v15, s[44:47], s60 offen lds
s_mov_b32 m0, 15360
s_mov_b32 s60, 0
buffer_load_dwordx4 v16, s[44:47], s60 offen lds
s_mov_b32 m0, 22528
s_mov_b32 s60, 120832
buffer_load_dwordx4 v3, s[40:43], s60 offen lds
s_mov_b32 m0, 23552
s_mov_b32 s60, 121856
buffer_load_dwordx4 v3, s[40:43], s60 offen lds
s_mov_b32 m0, 30720
s_mov_b32 s60, 65536
buffer_load_dwordx4 v15, s[44:47], s60 offen lds
s_mov_b32 m0, 31744
s_mov_b32 s60, 65536
buffer_load_dwordx4 v16, s[44:47], s60 offen lds
s_mov_b32 m0, 38912
s_mov_b32 s60, 124928
buffer_load_dwordx4 v3, s[40:43], s60 offen lds
s_mov_b32 m0, 39936
s_mov_b32 s60, 125952
buffer_load_dwordx4 v3, s[40:43], s60 offen lds
s_mov_b32 m0, 47104
s_mov_b32 s60, 131072
buffer_load_dwordx4 v15, s[44:47], s60 offen lds
s_mov_b32 m0, 48128
s_mov_b32 s60, 131072
buffer_load_dwordx4 v16, s[44:47], s60 offen lds
s_mov_b32 m0, 55296
s_mov_b32 s60, 129024
buffer_load_dwordx4 v3, s[40:43], s60 offen lds
s_mov_b32 m0, 56320
s_mov_b32 s60, 130048
buffer_load_dwordx4 v3, s[40:43], s60 offen lds
s_mov_b32 m0, 63488
s_mov_b32 s60, 196608
buffer_load_dwordx4 v15, s[44:47], s60 offen lds
s_mov_b32 m0, 64512
s_mov_b32 s60, 196608
buffer_load_dwordx4 v16, s[44:47], s60 offen lds
s_mov_b32 m0, 71680
s_mov_b32 s60, 133120
buffer_load_dwordx4 v3, s[40:43], s60 offen lds
s_mov_b32 m0, 72704
s_mov_b32 s60, 134144
buffer_load_dwordx4 v3, s[40:43], s60 offen lds
s_mov_b32 m0, 79872
s_mov_b32 s60, 262144
buffer_load_dwordx4 v15, s[44:47], s60 offen lds
s_mov_b32 m0, 80896
s_mov_b32 s60, 262144
buffer_load_dwordx4 v16, s[44:47], s60 offen lds
s_mov_b32 m0, 88064
s_mov_b32 s60, 137216
buffer_load_dwordx4 v3, s[40:43], s60 offen lds
s_mov_b32 m0, 89088
s_mov_b32 s60, 138240
buffer_load_dwordx4 v3, s[40:43], s60 offen lds
s_mov_b32 m0, 96256
s_mov_b32 s60, 327680
buffer_load_dwordx4 v15, s[44:47], s60 offen lds
s_mov_b32 m0, 97280
s_mov_b32 s60, 327680
buffer_load_dwordx4 v16, s[44:47], s60 offen lds
s_waitcnt vmcnt(20)
s_barrier
s_mov_b32 m0, 104448
s_mov_b32 s60, 141312
buffer_load_dwordx4 v3, s[40:43], s60 offen lds
s_mov_b32 m0, 105472
s_mov_b32 s60, 142336
buffer_load_dwordx4 v3, s[40:43], s60 offen lds
s_mov_b32 m0, 112640
s_mov_b32 s60, 393216
buffer_load_dwordx4 v15, s[44:47], s60 offen lds
s_mov_b32 m0, 113664
s_mov_b32 s60, 393216
buffer_load_dwordx4 v16, s[44:47], s60 offen lds
s_mov_b32 m0, 120832
s_mov_b32 s60, 145408
buffer_load_dwordx4 v3, s[40:43], s60 offen lds
s_mov_b32 m0, 121856
s_mov_b32 s60, 146432
buffer_load_dwordx4 v3, s[40:43], s60 offen lds
s_mov_b32 m0, 129024
s_mov_b32 s60, 458752
buffer_load_dwordx4 v15, s[44:47], s60 offen lds
s_mov_b32 m0, 130048
s_mov_b32 s60, 458752
buffer_load_dwordx4 v16, s[44:47], s60 offen lds
s_waitcnt vmcnt(24)
s_barrier
s_mov_b32 m0, 137216
s_mov_b32 s60, 149504
buffer_load_dwordx4 v3, s[40:43], s60 offen lds
s_mov_b32 m0, 138240
s_mov_b32 s60, 150528
buffer_load_dwordx4 v3, s[40:43], s60 offen lds
s_mov_b32 m0, 145408
s_mov_b32 s60, 524288
buffer_load_dwordx4 v15, s[44:47], s60 offen lds
s_mov_b32 m0, 146432
s_mov_b32 s60, 524288
buffer_load_dwordx4 v16, s[44:47], s60 offen lds
s_waitcnt vmcnt(24)
s_barrier
s_mov_b32 m0, 6144
s_mov_b32 s60, 153600
buffer_load_dwordx4 v3, s[40:43], s60 offen lds
s_mov_b32 m0, 7168
s_mov_b32 s60, 154624
buffer_load_dwordx4 v3, s[40:43], s60 offen lds
s_mov_b32 m0, 14336
s_mov_b32 s60, 589824
buffer_load_dwordx4 v15, s[44:47], s60 offen lds
s_mov_b32 m0, 15360
s_mov_b32 s60, 589824
buffer_load_dwordx4 v16, s[44:47], s60 offen lds
s_waitcnt vmcnt(24)
s_barrier
s_mov_b32 m0, 22528
s_mov_b32 s60, 157696
buffer_load_dwordx4 v3, s[40:43], s60 offen lds
s_mov_b32 m0, 23552
s_mov_b32 s60, 158720
buffer_load_dwordx4 v3, s[40:43], s60 offen lds
s_mov_b32 m0, 30720
s_mov_b32 s60, 655360
buffer_load_dwordx4 v15, s[44:47], s60 offen lds
s_mov_b32 m0, 31744
s_mov_b32 s60, 655360
buffer_load_dwordx4 v16, s[44:47], s60 offen lds
s_waitcnt vmcnt(24)
s_barrier
s_mov_b32 m0, 38912
s_mov_b32 s60, 161792
buffer_load_dwordx4 v3, s[40:43], s60 offen lds
s_mov_b32 m0, 39936
s_mov_b32 s60, 162816
buffer_load_dwordx4 v3, s[40:43], s60 offen lds
s_mov_b32 m0, 47104
s_mov_b32 s60, 720896
buffer_load_dwordx4 v15, s[44:47], s60 offen lds
s_mov_b32 m0, 48128
s_mov_b32 s60, 720896
buffer_load_dwordx4 v16, s[44:47], s60 offen lds
s_waitcnt vmcnt(24)
s_barrier
s_mov_b32 m0, 55296
s_mov_b32 s60, 165888
buffer_load_dwordx4 v3, s[40:43], s60 offen lds
s_mov_b32 m0, 56320
s_mov_b32 s60, 166912
buffer_load_dwordx4 v3, s[40:43], s60 offen lds
s_mov_b32 m0, 63488
s_mov_b32 s60, 786432
buffer_load_dwordx4 v15, s[44:47], s60 offen lds
s_mov_b32 m0, 64512
s_mov_b32 s60, 786432
buffer_load_dwordx4 v16, s[44:47], s60 offen lds
s_waitcnt vmcnt(24)
s_barrier
s_mov_b32 m0, 71680
s_mov_b32 s60, 169984
buffer_load_dwordx4 v3, s[40:43], s60 offen lds
s_mov_b32 m0, 72704
s_mov_b32 s60, 171008
buffer_load_dwordx4 v3, s[40:43], s60 offen lds
s_mov_b32 m0, 79872
s_mov_b32 s60, 851968
buffer_load_dwordx4 v15, s[44:47], s60 offen lds
s_mov_b32 m0, 80896
s_mov_b32 s60, 851968
buffer_load_dwordx4 v16, s[44:47], s60 offen lds
s_waitcnt vmcnt(24)
s_barrier
s_mov_b32 m0, 88064
s_mov_b32 s60, 174080
buffer_load_dwordx4 v3, s[40:43], s60 offen lds
s_mov_b32 m0, 89088
s_mov_b32 s60, 175104
buffer_load_dwordx4 v3, s[40:43], s60 offen lds
s_mov_b32 m0, 96256
s_mov_b32 s60, 917504
buffer_load_dwordx4 v15, s[44:47], s60 offen lds
s_mov_b32 m0, 97280
s_mov_b32 s60, 917504
buffer_load_dwordx4 v16, s[44:47], s60 offen lds
s_waitcnt vmcnt(24)
s_barrier
s_mov_b32 m0, 104448
s_mov_b32 s60, 178176
buffer_load_dwordx4 v3, s[40:43], s60 offen lds
s_mov_b32 m0, 105472
s_mov_b32 s60, 179200
buffer_load_dwordx4 v3, s[40:43], s60 offen lds
s_mov_b32 m0, 112640
s_mov_b32 s60, 983040
buffer_load_dwordx4 v15, s[44:47], s60 offen lds
s_mov_b32 m0, 113664
s_mov_b32 s60, 983040
buffer_load_dwordx4 v16, s[44:47], s60 offen lds
s_waitcnt vmcnt(24)
s_barrier
s_mov_b32 m0, 120832
s_mov_b32 s60, 182272
buffer_load_dwordx4 v3, s[40:43], s60 offen lds
s_mov_b32 m0, 121856
s_mov_b32 s60, 183296
buffer_load_dwordx4 v3, s[40:43], s60 offen lds
s_mov_b32 m0, 129024
s_mov_b32 s60, 1048576
buffer_load_dwordx4 v15, s[44:47], s60 offen lds
s_mov_b32 m0, 130048
s_mov_b32 s60, 1048576
buffer_load_dwordx4 v16, s[44:47], s60 offen lds
s_waitcnt vmcnt(24)
s_barrier
s_mov_b32 m0, 137216
s_mov_b32 s60, 186368
buffer_load_dwordx4 v3, s[40:43], s60 offen lds
s_mov_b32 m0, 138240
s_mov_b32 s60, 187392
buffer_load_dwordx4 v3, s[40:43], s60 offen lds
s_mov_b32 m0, 145408
s_mov_b32 s60, 1114112
buffer_load_dwordx4 v15, s[44:47], s60 offen lds
s_mov_b32 m0, 146432
s_mov_b32 s60, 1114112
buffer_load_dwordx4 v16, s[44:47], s60 offen lds
s_waitcnt vmcnt(24)
s_barrier
s_mov_b32 m0, 6144
s_mov_b32 s60, 190464
buffer_load_dwordx4 v3, s[40:43], s60 offen lds
s_mov_b32 m0, 7168
s_mov_b32 s60, 191488
buffer_load_dwordx4 v3, s[40:43], s60 offen lds
s_mov_b32 m0, 14336
s_mov_b32 s60, 1179648
buffer_load_dwordx4 v15, s[44:47], s60 offen lds
s_mov_b32 m0, 15360
s_mov_b32 s60, 1179648
buffer_load_dwordx4 v16, s[44:47], s60 offen lds
s_waitcnt vmcnt(24)
s_barrier
s_mov_b32 m0, 22528
s_mov_b32 s60, 194560
buffer_load_dwordx4 v3, s[40:43], s60 offen lds
s_mov_b32 m0, 23552
s_mov_b32 s60, 195584
buffer_load_dwordx4 v3, s[40:43], s60 offen lds
s_mov_b32 m0, 30720
s_mov_b32 s60, 1245184
buffer_load_dwordx4 v15, s[44:47], s60 offen lds
s_mov_b32 m0, 31744
s_mov_b32 s60, 1245184
buffer_load_dwordx4 v16, s[44:47], s60 offen lds
s_waitcnt vmcnt(24)
s_barrier
s_mov_b32 m0, 38912
s_mov_b32 s60, 198656
buffer_load_dwordx4 v3, s[40:43], s60 offen lds
s_mov_b32 m0, 39936
s_mov_b32 s60, 199680
buffer_load_dwordx4 v3, s[40:43], s60 offen lds
s_mov_b32 m0, 47104
s_mov_b32 s60, 1310720
buffer_load_dwordx4 v15, s[44:47], s60 offen lds
s_mov_b32 m0, 48128
s_mov_b32 s60, 1310720
buffer_load_dwordx4 v16, s[44:47], s60 offen lds
s_waitcnt vmcnt(24)
s_barrier
s_mov_b32 m0, 55296
s_mov_b32 s60, 202752
buffer_load_dwordx4 v3, s[40:43], s60 offen lds
s_mov_b32 m0, 56320
s_mov_b32 s60, 203776
buffer_load_dwordx4 v3, s[40:43], s60 offen lds
s_mov_b32 m0, 63488
s_mov_b32 s60, 1376256
buffer_load_dwordx4 v15, s[44:47], s60 offen lds
s_mov_b32 m0, 64512
s_mov_b32 s60, 1376256
buffer_load_dwordx4 v16, s[44:47], s60 offen lds
s_waitcnt vmcnt(24)
s_barrier
s_mov_b32 m0, 71680
s_mov_b32 s60, 206848
buffer_load_dwordx4 v3, s[40:43], s60 offen lds
s_mov_b32 m0, 72704
s_mov_b32 s60, 207872
buffer_load_dwordx4 v3, s[40:43], s60 offen lds
s_mov_b32 m0, 79872
s_mov_b32 s60, 1441792
buffer_load_dwordx4 v15, s[44:47], s60 offen lds
s_mov_b32 m0, 80896
s_mov_b32 s60, 1441792
buffer_load_dwordx4 v16, s[44:47], s60 offen lds
s_waitcnt vmcnt(24)
s_barrier
s_mov_b32 m0, 88064
s_mov_b32 s60, 210944
buffer_load_dwordx4 v3, s[40:43], s60 offen lds
s_mov_b32 m0, 89088
s_mov_b32 s60, 211968
buffer_load_dwordx4 v3, s[40:43], s60 offen lds
s_mov_b32 m0, 96256
s_mov_b32 s60, 1507328
buffer_load_dwordx4 v15, s[44:47], s60 offen lds
s_mov_b32 m0, 97280
s_mov_b32 s60, 1507328
buffer_load_dwordx4 v16, s[44:47], s60 offen lds
s_waitcnt vmcnt(24)
s_barrier
s_mov_b32 m0, 104448
s_mov_b32 s60, 215040
buffer_load_dwordx4 v3, s[40:43], s60 offen lds
s_mov_b32 m0, 105472
s_mov_b32 s60, 216064
buffer_load_dwordx4 v3, s[40:43], s60 offen lds
s_mov_b32 m0, 112640
s_mov_b32 s60, 1572864
buffer_load_dwordx4 v15, s[44:47], s60 offen lds
s_mov_b32 m0, 113664
s_mov_b32 s60, 1572864
buffer_load_dwordx4 v16, s[44:47], s60 offen lds
s_waitcnt vmcnt(24)
s_barrier
s_mov_b32 m0, 120832
s_mov_b32 s60, 219136
buffer_load_dwordx4 v3, s[40:43], s60 offen lds
s_mov_b32 m0, 121856
s_mov_b32 s60, 220160
buffer_load_dwordx4 v3, s[40:43], s60 offen lds
s_mov_b32 m0, 129024
s_mov_b32 s60, 1638400
buffer_load_dwordx4 v15, s[44:47], s60 offen lds
s_mov_b32 m0, 130048
s_mov_b32 s60, 1638400
buffer_load_dwordx4 v16, s[44:47], s60 offen lds
s_waitcnt vmcnt(24)
s_barrier
s_mov_b32 m0, 137216
s_mov_b32 s60, 223232
buffer_load_dwordx4 v3, s[40:43], s60 offen lds
s_mov_b32 m0, 138240
s_mov_b32 s60, 224256
buffer_load_dwordx4 v3, s[40:43], s60 offen lds
s_mov_b32 m0, 145408
s_mov_b32 s60, 1703936
buffer_load_dwordx4 v15, s[44:47], s60 offen lds
s_mov_b32 m0, 146432
s_mov_b32 s60, 1703936
buffer_load_dwordx4 v16, s[44:47], s60 offen lds
s_waitcnt vmcnt(24)
s_barrier
s_mov_b32 m0, 6144
s_mov_b32 s60, 227328
buffer_load_dwordx4 v3, s[40:43], s60 offen lds
s_mov_b32 m0, 7168
s_mov_b32 s60, 228352
buffer_load_dwordx4 v3, s[40:43], s60 offen lds
s_mov_b32 m0, 14336
s_mov_b32 s60, 1769472
buffer_load_dwordx4 v15, s[44:47], s60 offen lds
s_mov_b32 m0, 15360
s_mov_b32 s60, 1769472
buffer_load_dwordx4 v16, s[44:47], s60 offen lds
s_waitcnt vmcnt(24)
s_barrier
s_waitcnt vmcnt(20)
s_barrier
s_waitcnt vmcnt(16)
s_barrier
s_waitcnt vmcnt(12)
s_barrier
s_waitcnt vmcnt(8)
s_barrier
s_waitcnt vmcnt(4)
s_barrier
s_waitcnt vmcnt(0)
s_barrier
k5_kernel_end:
s_endpgm
.section .rodata,"a"
.p2align 6
.amdhsa_kernel k5_kernel
  .amdhsa_next_free_vgpr 104
  .amdhsa_next_free_sgpr 96
  .amdhsa_accum_offset 104
  .amdhsa_group_segment_fixed_size 0
  .amdhsa_kernarg_size 80
  .amdhsa_user_sgpr_count 2
  .amdhsa_user_sgpr_kernarg_segment_ptr 1
  .amdhsa_system_sgpr_workgroup_id_x 1
.end_amdhsa_kernel
.text
```
